```python
import torch

def _softmax(x, axis=-1):
    return torch.softmax(x, dim=axis)
def _gelu(x):
    return torch.nn.functional.gelu(x, approximate="tanh")
def _silu(x):
    return torch.nn.functional.silu(x)
def _sigmoid(x):
    return torch.sigmoid(x)
def _layernorm(x, axis=-1, eps=1e-5):
    m = x.mean(dim=axis, keepdim=True)
    v = x.var(dim=axis, keepdim=True, unbiased=False)
    return (x - m) / torch.sqrt(v + eps)
def _scatter_add(tgt, idx, src, axis=0):
    return tgt.clone().index_add_(axis, idx, src)
def _segment_sum(src, seg, n):
    out = torch.zeros((n,) + src.shape[1:], dtype=src.dtype)
    return out.index_add_(0, seg, src)
def _pad(x, pw):
    flat = tuple(v for pair in reversed(pw) for v in pair)
    return torch.nn.functional.pad(x, flat)

kernel_name = 'concat_heads__compressed_kv_cla__mha_block_cached__decode'

def setup_inputs():

    _w = (lambda a: (lambda t: t.to(torch.bfloat16) if t.is_floating_point() else t)(torch.as_tensor(a)))
    def _A_setup():
        B, H, Sq, Sk, D, M = 4, 32, 1, 4096, 128, 512
        Dc = 4 * D
        return {
            "x": _w((lambda *s: torch.randn(*s, dtype=torch.bfloat16) * 3.2)(B, Sq, M)),
            "c_kv": _w((lambda *s: torch.randn(*s, dtype=torch.bfloat16) * 0.1)(B, Sk, Dc)),
            "w_q": _w((lambda *s: torch.randn(*s, dtype=torch.bfloat16) * 6.4)(M, H, D) * (M ** -0.5)),
            "w_uk": _w((lambda *s: torch.randn(*s, dtype=torch.bfloat16) * 6.4)(Dc, H, D) * (Dc ** -0.5)),
            "w_uv": _w((lambda *s: torch.randn(*s, dtype=torch.bfloat16) * 0.1)(Dc, H, D) * (Dc ** -0.5)),
            "w_o": _w((lambda *s: torch.randn(*s, dtype=torch.bfloat16) * 0.1)(H, D, M) * ((H * D) ** -0.5)),
        }
    _A_in = _A_setup()

    def _B_setup():
        B, Sq, D = 4, 1, 512
        H, Sk, Dh = 32, 4096, 128
        return {
            "x": _w((lambda *s: torch.randn(*s, dtype=torch.bfloat16) * 1.6)(B, Sq, D)),
            "k_cache": _w((lambda *s: torch.randn(*s, dtype=torch.bfloat16) * 1.6)(B, H, Sk, Dh)),
            "v_cache": _w((lambda *s: torch.randn(*s, dtype=torch.bfloat16) * 0.05)(B, H, Sk, Dh)),
            "wq": _w((lambda *s: torch.randn(*s, dtype=torch.bfloat16) * 1.6)(D, H * Dh) * (D ** -0.5)),
            "wo": _w((lambda *s: torch.randn(*s, dtype=torch.bfloat16) * 0.05)(H * Dh, D) * ((H * Dh) ** -0.5)),
        }
    _B_in = _B_setup()

    return {
        "A_x": _A_in["x"],
        "A_c_kv": _A_in["c_kv"],
        "A_w_q": _A_in["w_q"],
        "A_w_uk": _A_in["w_uk"],
        "A_w_uv": _A_in["w_uv"],
        "A_w_o": _A_in["w_o"],
        "B_x": _B_in["x"],
        "B_k_cache": _B_in["k_cache"],
        "B_v_cache": _B_in["v_cache"],
        "B_wq": _B_in["wq"],
        "B_wo": _B_in["wo"],
    }

def reference(A_x, A_c_kv, A_w_q, A_w_uk, A_w_uv, A_w_o, B_x, B_k_cache, B_v_cache, B_wq, B_wo):
    def _A_ref(x, c_kv, w_q, w_uk, w_uv, w_o):
        B, Sq, M = x.shape[0], x.shape[1], x.shape[2]
        Sk = c_kv.shape[1]
        H, D = w_q.shape[1], w_q.shape[2]
        q = torch.einsum("bqm,mhd->bhqd", x, w_q)
        k = torch.einsum("bkc,chd->bhkd", c_kv, w_uk)
        v = torch.einsum("bkc,chd->bhkd", c_kv, w_uv)
        scores = torch.einsum("bhqd,bhkd->bhqk", q, k) * (D ** -0.5)
        off = Sk - Sq
        qi = torch.arange(Sq)[:, None]
        kj = torch.arange(Sk)[None, :]
        cmask = kj <= (qi + off)
        scores = torch.where(cmask[None, None], scores, -1e9)
        p = _softmax(scores, axis=-1)
        ctx = torch.einsum("bhqk,bhkd->bhqd", p, v)
        return torch.einsum("bhqd,hdm->bqm", ctx, w_o)

    def _B_ref(x, k_cache, v_cache, wq, wo):
        B, Sq, D = x.shape
        H, Dh = 32, 128
        q = (lambda x, *d: x.permute(*d))((x @ wq).reshape(B, Sq, H, Dh), 0, 2, 1, 3)
        scores = torch.einsum("bhqd,bhkd->bhqk", q, k_cache) * (Dh ** -0.5)
        p = _softmax(scores, axis=-1)
        o = torch.einsum("bhqk,bhkd->bhqd", p, v_cache)
        return (lambda x, *d: x.permute(*d))(o, 0, 2, 1, 3).reshape(B, Sq, H * Dh) @ wo

    a = _A_ref(A_x, A_c_kv, A_w_q, A_w_uk, A_w_uv, A_w_o)
    b = _B_ref(B_x, B_k_cache, B_v_cache, B_wq, B_wo)
    return torch.concatenate([a, b], axis=-1)
```

```asm
; @launch grid=(256,1,1) block=(256,1,1) lds=149504
.amdgcn_target "amdgcn-amd-amdhsa--gfx950"
.text
.globl concat_heads__compressed_kv_cla__mha_block_cached__decode_kernel
.p2align 8
.type concat_heads__compressed_kv_cla__mha_block_cached__decode_kernel,@function
concat_heads__compressed_kv_cla__mha_block_cached__decode_kernel:
    s_load_dwordx16 s[36:51], s[0:1], 0
    s_load_dwordx8 s[52:59], s[0:1], 64
    s_load_dwordx4 s[60:63], s[0:1], 96
    s_cmp_ge_u32 s2, 256
    s_cbranch_scc1 L_end
    v_lshrrev_b32 v1, 6, v0
    v_and_b32 v0, 63, v0
    v_readfirstlane_b32 s3, v1
    v_lshlrev_b32 v2, 4, v0
    s_cmp_lt_u32 s2, 32
    s_cbranch_scc1 L_W
    s_cmp_ge_u32 s2, 224
    s_cbranch_scc1 L_C
    s_sub_u32 s24, s2, 32
    s_and_b32 s25, s24, 7
    s_lshr_b32 s24, s24, 3
    s_mul_i32 s26, s24, 43
    s_lshr_b32 s26, s26, 8
    s_mul_i32 s27, s26, 6
    s_sub_u32 s27, s24, s27
    s_lshl_b32 s26, s26, 3
    s_add_u32 s26, s26, s25
    s_cmp_ge_u32 s27, 3
    s_cselect_b32 s28, 1, 0
    s_mul_i32 s29, s28, 3
    s_sub_u32 s29, s27, s29
    s_lshr_b32 s30, s3, 1
    s_lshl_b32 s24, s28, 1
    s_add_u32 s30, s30, s24
    s_and_b32 s31, s3, 1
    s_lshl_b32 s24, s29, 1
    s_add_u32 s31, s31, s24
    s_lshl_b32 s30, s30, 5
    s_add_u32 s30, s30, s26
    s_lshl_b32 s30, s30, 20
    v_lshrrev_b32 v3, 4, v0
    v_and_b32 v4, 15, v0
    v_lshlrev_b32 v5, 18, v3
    v_lshl_add_u32 v5, v4, 4, v5
    v_lshrrev_b32 v6, 3, v4
    v_lshlrev_b32 v6, 10, v6
    v_lshl_add_u32 v6, v3, 6, v6
    v_bfe_u32 v1, v0, 2, 2
    v_lshlrev_b32 v1, 8, v1
    v_lshl_add_u32 v1, v3, 6, v1
    v_and_b32 v4, 3, v0
    v_lshl_add_u32 v1, v4, 4, v1
    s_mul_i32 s35, s31, 1024
    s_mov_b32 s32, s35
    s_lshl_b32 s24, s28, 11
    s_lshl_b32 s25, s3, 8
    s_add_u32 s24, s24, s25
    s_lshl_b32 s25, s3, 20
    s_lshl_b32 s33, s26, 8
    s_add_u32 s25, s25, s33
    s_waitcnt lgkmcnt(0)
    s_mov_b32 s20, s48
    s_mov_b32 s21, s49
    s_mov_b32 s22, 0x1000
    s_mov_b32 s23, 0x20000
    s_mov_b32 s8, s54
    s_mov_b32 s9, s55
    s_mov_b32 s10, 0x400000
    s_mov_b32 s11, 0x20000
    s_add_u32 s4, s50, s30
    s_addc_u32 s5, s51, 0
    s_mov_b32 s6, 0x100000
    s_mov_b32 s7, 0x20000
    buffer_load_dwordx4 v[32:35], v6, s[20:23], s24 offen offset:0
    buffer_load_dwordx4 v[36:39], v6, s[20:23], s24 offen offset:16
    buffer_load_dwordx4 v[40:43], v6, s[20:23], s24 offen offset:32
    buffer_load_dwordx4 v[44:47], v6, s[20:23], s24 offen offset:48
    buffer_load_dwordx4 v[64:67], v1, s[4:7], s32 offen offset:0 nt
    s_add_u32 s32, s32, 6144
    buffer_load_dwordx4 v[128:131], v5, s[8:11], s25 offen
    s_add_u32 s25, s25, 8192
    buffer_load_dwordx4 v[132:135], v5, s[8:11], s25 offen
    s_add_u32 s25, s25, 8192
    buffer_load_dwordx4 v[136:139], v5, s[8:11], s25 offen
    s_add_u32 s25, s25, 8192
    buffer_load_dwordx4 v[140:143], v5, s[8:11], s25 offen
    s_add_u32 s25, s25, 8192
    buffer_load_dwordx4 v[68:71], v1, s[4:7], s32 offen offset:0 nt
    s_add_u32 s32, s32, 6144
    buffer_load_dwordx4 v[144:147], v5, s[8:11], s25 offen
    s_add_u32 s25, s25, 8192
    buffer_load_dwordx4 v[148:151], v5, s[8:11], s25 offen
    s_add_u32 s25, s25, 8192
    buffer_load_dwordx4 v[152:155], v5, s[8:11], s25 offen
    s_add_u32 s25, s25, 8192
    buffer_load_dwordx4 v[156:159], v5, s[8:11], s25 offen
    s_add_u32 s25, s25, 8192
    buffer_load_dwordx4 v[72:75], v1, s[4:7], s32 offen offset:0 nt
    s_add_u32 s32, s32, 6144
    buffer_load_dwordx4 v[160:163], v5, s[8:11], s25 offen
    s_add_u32 s25, s25, 8192
    buffer_load_dwordx4 v[164:167], v5, s[8:11], s25 offen
    s_add_u32 s25, s25, 8192
    buffer_load_dwordx4 v[168:171], v5, s[8:11], s25 offen
    s_add_u32 s25, s25, 8192
    buffer_load_dwordx4 v[172:175], v5, s[8:11], s25 offen
    s_add_u32 s25, s25, 8192
    buffer_load_dwordx4 v[76:79], v1, s[4:7], s32 offen offset:0 nt
    s_add_u32 s32, s32, 6144
    buffer_load_dwordx4 v[176:179], v5, s[8:11], s25 offen
    s_add_u32 s25, s25, 8192
    buffer_load_dwordx4 v[180:183], v5, s[8:11], s25 offen
    s_add_u32 s25, s25, 8192
    buffer_load_dwordx4 v[184:187], v5, s[8:11], s25 offen
    s_add_u32 s25, s25, 8192
    buffer_load_dwordx4 v[188:191], v5, s[8:11], s25 offen
    s_add_u32 s25, s25, 8192
    buffer_load_dwordx4 v[80:83], v1, s[4:7], s32 offen offset:0 nt
    s_add_u32 s32, s32, 6144
    buffer_load_dwordx4 v[192:195], v5, s[8:11], s25 offen
    s_add_u32 s25, s25, 8192
    buffer_load_dwordx4 v[196:199], v5, s[8:11], s25 offen
    s_add_u32 s25, s25, 8192
    buffer_load_dwordx4 v[200:203], v5, s[8:11], s25 offen
    s_add_u32 s25, s25, 8192
    buffer_load_dwordx4 v[204:207], v5, s[8:11], s25 offen
    s_add_u32 s25, s25, 8192
    buffer_load_dwordx4 v[84:87], v1, s[4:7], s32 offen offset:0 nt
    s_add_u32 s32, s32, 6144
    buffer_load_dwordx4 v[208:211], v5, s[8:11], s25 offen
    s_add_u32 s25, s25, 8192
    buffer_load_dwordx4 v[212:215], v5, s[8:11], s25 offen
    s_add_u32 s25, s25, 8192
    buffer_load_dwordx4 v[216:219], v5, s[8:11], s25 offen
    s_add_u32 s25, s25, 8192
    buffer_load_dwordx4 v[220:223], v5, s[8:11], s25 offen
    s_add_u32 s25, s25, 8192
    buffer_load_dwordx4 v[88:91], v1, s[4:7], s32 offen offset:0 nt
    s_add_u32 s32, s32, 6144
    buffer_load_dwordx4 v[224:227], v5, s[8:11], s25 offen
    s_add_u32 s25, s25, 8192
    buffer_load_dwordx4 v[228:231], v5, s[8:11], s25 offen
    s_add_u32 s25, s25, 8192
    buffer_load_dwordx4 v[232:235], v5, s[8:11], s25 offen
    s_add_u32 s25, s25, 8192
    buffer_load_dwordx4 v[236:239], v5, s[8:11], s25 offen
    s_add_u32 s25, s25, 8192
    buffer_load_dwordx4 v[92:95], v1, s[4:7], s32 offen offset:0 nt
    s_add_u32 s32, s32, 6144
    buffer_load_dwordx4 v[240:243], v5, s[8:11], s25 offen
    s_add_u32 s25, s25, 8192
    buffer_load_dwordx4 v[244:247], v5, s[8:11], s25 offen
    s_add_u32 s25, s25, 8192
    buffer_load_dwordx4 v[248:251], v5, s[8:11], s25 offen
    s_add_u32 s25, s25, 8192
    buffer_load_dwordx4 v[252:255], v5, s[8:11], s25 offen
    buffer_load_dwordx4 v[96:99], v1, s[4:7], s32 offen offset:0 nt
    s_add_u32 s32, s32, 6144
    buffer_load_dwordx4 v[100:103], v1, s[4:7], s32 offen offset:0 nt
    s_add_u32 s32, s32, 6144
    buffer_load_dwordx4 v[104:107], v1, s[4:7], s32 offen offset:0 nt
    s_add_u32 s32, s32, 6144
    buffer_load_dwordx4 v[108:111], v1, s[4:7], s32 offen offset:0 nt
    s_add_u32 s32, s32, 6144
    buffer_load_dwordx4 v[112:115], v1, s[4:7], s32 offen offset:0 nt
    s_add_u32 s32, s32, 6144
    buffer_load_dwordx4 v[116:119], v1, s[4:7], s32 offen offset:0 nt
    s_add_u32 s32, s32, 6144
    buffer_load_dwordx4 v[120:123], v1, s[4:7], s32 offen offset:0 nt
    s_add_u32 s32, s32, 6144
    buffer_load_dwordx4 v[124:127], v1, s[4:7], s32 offen offset:0 nt
    s_add_u32 s32, s32, 6144
    s_mov_b32 s12, s62
    s_mov_b32 s13, s63
    s_mov_b32 s14, 0x400000
    s_mov_b32 s15, 0x20000
    s_mov_b32 s16, s60
    s_mov_b32 s17, s61
    s_mov_b32 s18, 0x100
    s_mov_b32 s19, 0x20000
    s_mov_b32 s8, s56
    s_mov_b32 s9, s57
    s_mov_b32 s10, 0x400000
    s_mov_b32 s11, 0x20000
    v_and_b32 v3, 1, v0
    v_lshlrev_b32 v3, 4, v3
    v_mov_b32 v4, 0xffff
    v_lshlrev_b32 v4, v3, v4
    v_bfe_u32 v3, v0, 1, 2
    v_cmp_eq_u32 vcc, 0, v3
    s_nop 1
    v_cndmask_b32 v20, 0, v4, vcc
    v_cmp_eq_u32 vcc, 1, v3
    s_nop 1
    v_cndmask_b32 v21, 0, v4, vcc
    v_cmp_eq_u32 vcc, 2, v3
    s_nop 1
    v_cndmask_b32 v22, 0, v4, vcc
    v_cmp_eq_u32 vcc, 3, v3
    s_nop 1
    v_cndmask_b32 v23, 0, v4, vcc
    v_mov_b32 v3, 0x0c0c0c0c
    s_mov_b32 s24, 0x01000100
    s_mov_b32 s25, 0x03020302
    v_bfi_b32 v24, v20, s24, v3
    v_bfi_b32 v28, v20, s25, v3
    v_bfi_b32 v25, v21, s24, v3
    v_bfi_b32 v29, v21, s25, v3
    v_bfi_b32 v26, v22, s24, v3
    v_bfi_b32 v30, v22, s25, v3
    v_bfi_b32 v27, v23, s24, v3
    v_bfi_b32 v31, v23, s25, v3
    s_mov_b32 s64, 0x22222222
    s_mov_b32 s65, 0x22222222
    s_mov_b32 s66, 0x44444444
    s_mov_b32 s67, 0x44444444
    s_mov_b32 s68, 0x88888888
    s_mov_b32 s69, 0x88888888
    v_lshrrev_b32 v3, 4, v0
    v_lshlrev_b32 v7, 7, v3
    v_and_b32 v4, 3, v0
    v_lshl_add_u32 v7, v4, 5, v7
    s_lshr_b32 s24, s3, 1
    s_lshl_b32 s24, s24, 9
    s_add_u32 s24, s24, 135168
    v_add_u32 v60, s24, v7
    s_lshl_b32 s33, s26, 17
    s_lshl_b32 s24, s3, 15
    s_add_u32 s33, s33, s24
    s_mul_i32 s34, s3, 33792
    s_waitcnt vmcnt(48)
    v_perm_b32 v8, v32, v32, v24
    v_perm_b32 v9, v32, v32, v25
    v_perm_b32 v10, v32, v32, v26
    v_perm_b32 v11, v32, v32, v27
    s_waitcnt vmcnt(46)
    s_nop 0
    v_mfma_f32_16x16x32_bf16 v[12:15], v[128:131], v[8:11], 0
    v_perm_b32 v8, v32, v32, v28
    v_perm_b32 v9, v32, v32, v29
    v_perm_b32 v10, v32, v32, v30
    v_perm_b32 v11, v32, v32, v31
    s_waitcnt vmcnt(45)
    s_nop 0
    v_mfma_f32_16x16x32_bf16 v[12:15], v[132:135], v[8:11], v[12:15]
    v_perm_b32 v8, v33, v33, v24
    v_perm_b32 v9, v33, v33, v25
    v_perm_b32 v10, v33, v33, v26
    v_perm_b32 v11, v33, v33, v27
    s_waitcnt vmcnt(44)
    s_nop 0
    v_mfma_f32_16x16x32_bf16 v[12:15], v[136:139], v[8:11], v[12:15]
    v_perm_b32 v8, v33, v33, v28
    v_perm_b32 v9, v33, v33, v29
    v_perm_b32 v10, v33, v33, v30
    v_perm_b32 v11, v33, v33, v31
    s_waitcnt vmcnt(43)
    s_nop 0
    v_mfma_f32_16x16x32_bf16 v[12:15], v[140:143], v[8:11], v[12:15]
    v_perm_b32 v8, v34, v34, v24
    v_perm_b32 v9, v34, v34, v25
    v_perm_b32 v10, v34, v34, v26
    v_perm_b32 v11, v34, v34, v27
    s_waitcnt vmcnt(41)
    s_nop 0
    v_mfma_f32_16x16x32_bf16 v[12:15], v[144:147], v[8:11], v[12:15]
    v_perm_b32 v8, v34, v34, v28
    v_perm_b32 v9, v34, v34, v29
    v_perm_b32 v10, v34, v34, v30
    v_perm_b32 v11, v34, v34, v31
    s_waitcnt vmcnt(40)
    s_nop 0
    v_mfma_f32_16x16x32_bf16 v[12:15], v[148:151], v[8:11], v[12:15]
    v_perm_b32 v8, v35, v35, v24
    v_perm_b32 v9, v35, v35, v25
    v_perm_b32 v10, v35, v35, v26
    v_perm_b32 v11, v35, v35, v27
    s_waitcnt vmcnt(39)
    s_nop 0
    v_mfma_f32_16x16x32_bf16 v[12:15], v[152:155], v[8:11], v[12:15]
    v_perm_b32 v8, v35, v35, v28
    v_perm_b32 v9, v35, v35, v29
    v_perm_b32 v10, v35, v35, v30
    v_perm_b32 v11, v35, v35, v31
    s_waitcnt vmcnt(38)
    s_nop 0
    v_mfma_f32_16x16x32_bf16 v[12:15], v[156:159], v[8:11], v[12:15]
    v_perm_b32 v8, v36, v36, v24
    v_perm_b32 v9, v36, v36, v25
    v_perm_b32 v10, v36, v36, v26
    v_perm_b32 v11, v36, v36, v27
    s_waitcnt vmcnt(36)
    s_nop 0
    v_mfma_f32_16x16x32_bf16 v[12:15], v[160:163], v[8:11], v[12:15]
    v_perm_b32 v8, v36, v36, v28
    v_perm_b32 v9, v36, v36, v29
    v_perm_b32 v10, v36, v36, v30
    v_perm_b32 v11, v36, v36, v31
    s_waitcnt vmcnt(35)
    s_nop 0
    v_mfma_f32_16x16x32_bf16 v[12:15], v[164:167], v[8:11], v[12:15]
    v_perm_b32 v8, v37, v37, v24
    v_perm_b32 v9, v37, v37, v25
    v_perm_b32 v10, v37, v37, v26
    v_perm_b32 v11, v37, v37, v27
    s_waitcnt vmcnt(34)
    s_nop 0
    v_mfma_f32_16x16x32_bf16 v[12:15], v[168:171], v[8:11], v[12:15]
    v_perm_b32 v8, v37, v37, v28
    v_perm_b32 v9, v37, v37, v29
    v_perm_b32 v10, v37, v37, v30
    v_perm_b32 v11, v37, v37, v31
    s_waitcnt vmcnt(33)
    s_nop 0
    v_mfma_f32_16x16x32_bf16 v[12:15], v[172:175], v[8:11], v[12:15]
    v_perm_b32 v8, v38, v38, v24
    v_perm_b32 v9, v38, v38, v25
    v_perm_b32 v10, v38, v38, v26
    v_perm_b32 v11, v38, v38, v27
    s_waitcnt vmcnt(31)
    s_nop 0
    v_mfma_f32_16x16x32_bf16 v[12:15], v[176:179], v[8:11], v[12:15]
    v_perm_b32 v8, v38, v38, v28
    v_perm_b32 v9, v38, v38, v29
    v_perm_b32 v10, v38, v38, v30
    v_perm_b32 v11, v38, v38, v31
    s_waitcnt vmcnt(30)
    s_nop 0
    v_mfma_f32_16x16x32_bf16 v[12:15], v[180:183], v[8:11], v[12:15]
    v_perm_b32 v8, v39, v39, v24
    v_perm_b32 v9, v39, v39, v25
    v_perm_b32 v10, v39, v39, v26
    v_perm_b32 v11, v39, v39, v27
    s_waitcnt vmcnt(29)
    s_nop 0
    v_mfma_f32_16x16x32_bf16 v[12:15], v[184:187], v[8:11], v[12:15]
    v_perm_b32 v8, v39, v39, v28
    v_perm_b32 v9, v39, v39, v29
    v_perm_b32 v10, v39, v39, v30
    v_perm_b32 v11, v39, v39, v31
    s_waitcnt vmcnt(28)
    s_nop 0
    v_mfma_f32_16x16x32_bf16 v[12:15], v[188:191], v[8:11], v[12:15]
    v_perm_b32 v8, v40, v40, v24
    v_perm_b32 v9, v40, v40, v25
    v_perm_b32 v10, v40, v40, v26
    v_perm_b32 v11, v40, v40, v27
    s_waitcnt vmcnt(26)
    s_nop 0
    v_mfma_f32_16x16x32_bf16 v[12:15], v[192:195], v[8:11], v[12:15]
    v_perm_b32 v8, v40, v40, v28
    v_perm_b32 v9, v40, v40, v29
    v_perm_b32 v10, v40, v40, v30
    v_perm_b32 v11, v40, v40, v31
    s_waitcnt vmcnt(25)
    s_nop 0
    v_mfma_f32_16x16x32_bf16 v[12:15], v[196:199], v[8:11], v[12:15]
    v_perm_b32 v8, v41, v41, v24
    v_perm_b32 v9, v41, v41, v25
    v_perm_b32 v10, v41, v41, v26
    v_perm_b32 v11, v41, v41, v27
    s_waitcnt vmcnt(24)
    s_nop 0
    v_mfma_f32_16x16x32_bf16 v[12:15], v[200:203], v[8:11], v[12:15]
    v_perm_b32 v8, v41, v41, v28
    v_perm_b32 v9, v41, v41, v29
    v_perm_b32 v10, v41, v41, v30
    v_perm_b32 v11, v41, v41, v31
    s_waitcnt vmcnt(23)
    s_nop 0
    v_mfma_f32_16x16x32_bf16 v[12:15], v[204:207], v[8:11], v[12:15]
    v_perm_b32 v8, v42, v42, v24
    v_perm_b32 v9, v42, v42, v25
    v_perm_b32 v10, v42, v42, v26
    v_perm_b32 v11, v42, v42, v27
    s_waitcnt vmcnt(21)
    s_nop 0
    v_mfma_f32_16x16x32_bf16 v[12:15], v[208:211], v[8:11], v[12:15]
    v_perm_b32 v8, v42, v42, v28
    v_perm_b32 v9, v42, v42, v29
    v_perm_b32 v10, v42, v42, v30
    v_perm_b32 v11, v42, v42, v31
    s_waitcnt vmcnt(20)
    s_nop 0
    v_mfma_f32_16x16x32_bf16 v[12:15], v[212:215], v[8:11], v[12:15]
    v_perm_b32 v8, v43, v43, v24
    v_perm_b32 v9, v43, v43, v25
    v_perm_b32 v10, v43, v43, v26
    v_perm_b32 v11, v43, v43, v27
    s_waitcnt vmcnt(19)
    s_nop 0
    v_mfma_f32_16x16x32_bf16 v[12:15], v[216:219], v[8:11], v[12:15]
    v_perm_b32 v8, v43, v43, v28
    v_perm_b32 v9, v43, v43, v29
    v_perm_b32 v10, v43, v43, v30
    v_perm_b32 v11, v43, v43, v31
    s_waitcnt vmcnt(18)
    s_nop 0
    v_mfma_f32_16x16x32_bf16 v[12:15], v[220:223], v[8:11], v[12:15]
    v_perm_b32 v8, v44, v44, v24
    v_perm_b32 v9, v44, v44, v25
    v_perm_b32 v10, v44, v44, v26
    v_perm_b32 v11, v44, v44, v27
    s_waitcnt vmcnt(16)
    s_nop 0
    v_mfma_f32_16x16x32_bf16 v[12:15], v[224:227], v[8:11], v[12:15]
    v_perm_b32 v8, v44, v44, v28
    v_perm_b32 v9, v44, v44, v29
    v_perm_b32 v10, v44, v44, v30
    v_perm_b32 v11, v44, v44, v31
    s_waitcnt vmcnt(15)
    s_nop 0
    v_mfma_f32_16x16x32_bf16 v[12:15], v[228:231], v[8:11], v[12:15]
    v_perm_b32 v8, v45, v45, v24
    v_perm_b32 v9, v45, v45, v25
    v_perm_b32 v10, v45, v45, v26
    v_perm_b32 v11, v45, v45, v27
    s_waitcnt vmcnt(14)
    s_nop 0
    v_mfma_f32_16x16x32_bf16 v[12:15], v[232:235], v[8:11], v[12:15]
    v_perm_b32 v8, v45, v45, v28
    v_perm_b32 v9, v45, v45, v29
    v_perm_b32 v10, v45, v45, v30
    v_perm_b32 v11, v45, v45, v31
    s_waitcnt vmcnt(13)
    s_nop 0
    v_mfma_f32_16x16x32_bf16 v[12:15], v[236:239], v[8:11], v[12:15]
    v_perm_b32 v8, v46, v46, v24
    v_perm_b32 v9, v46, v46, v25
    v_perm_b32 v10, v46, v46, v26
    v_perm_b32 v11, v46, v46, v27
    s_waitcnt vmcnt(11)
    s_nop 0
    v_mfma_f32_16x16x32_bf16 v[12:15], v[240:243], v[8:11], v[12:15]
    v_perm_b32 v8, v46, v46, v28
    v_perm_b32 v9, v46, v46, v29
    v_perm_b32 v10, v46, v46, v30
    v_perm_b32 v11, v46, v46, v31
    s_waitcnt vmcnt(10)
    s_nop 0
    v_mfma_f32_16x16x32_bf16 v[12:15], v[244:247], v[8:11], v[12:15]
    v_perm_b32 v8, v47, v47, v24
    v_perm_b32 v9, v47, v47, v25
    v_perm_b32 v10, v47, v47, v26
    v_perm_b32 v11, v47, v47, v27
    s_waitcnt vmcnt(9)
    s_nop 0
    v_mfma_f32_16x16x32_bf16 v[12:15], v[248:251], v[8:11], v[12:15]
    v_perm_b32 v8, v47, v47, v28
    v_perm_b32 v9, v47, v47, v29
    v_perm_b32 v10, v47, v47, v30
    v_perm_b32 v11, v47, v47, v31
    s_waitcnt vmcnt(8)
    s_nop 0
    v_mfma_f32_16x16x32_bf16 v[12:15], v[252:255], v[8:11], v[12:15]
    v_lshrrev_b32 v3, 4, v0
    v_lshlrev_b32 v3, 7, v3
    v_and_b32 v4, 7, v0
    v_lshl_add_u32 v3, v4, 2, v3
    v_bfe_u32 v4, v0, 3, 1
    v_lshl_add_u32 v3, v4, 9, v3
    s_lshl_b32 s24, s3, 11
    s_add_u32 s24, s24, 135168
    v_add_u32 v3, s24, v3
    ds_write_b32 v3, v12 offset:0
    ds_write_b32 v3, v13 offset:32
    ds_write_b32 v3, v14 offset:64
    ds_write_b32 v3, v15 offset:96
    s_waitcnt lgkmcnt(0)
    s_barrier
    ds_read_b128 v[128:131], v60 offset:0
    ds_read_b128 v[132:135], v60 offset:16
    ds_read_b128 v[136:139], v60 offset:2048
    ds_read_b128 v[140:143], v60 offset:2064
    ds_read_b128 v[144:147], v60 offset:4096
    ds_read_b128 v[148:151], v60 offset:4112
    ds_read_b128 v[152:155], v60 offset:6144
    ds_read_b128 v[156:159], v60 offset:6160
    s_waitcnt lgkmcnt(4)
    v_add_f32 v128, v128, v136
    v_add_f32 v129, v129, v137
    v_add_f32 v130, v130, v138
    v_add_f32 v131, v131, v139
    v_add_f32 v132, v132, v140
    v_add_f32 v133, v133, v141
    v_add_f32 v134, v134, v142
    v_add_f32 v135, v135, v143
    s_waitcnt lgkmcnt(2)
    v_add_f32 v128, v128, v144
    v_add_f32 v129, v129, v145
    v_add_f32 v130, v130, v146
    v_add_f32 v131, v131, v147
    v_add_f32 v132, v132, v148
    v_add_f32 v133, v133, v149
    v_add_f32 v134, v134, v150
    v_add_f32 v135, v135, v151
    s_waitcnt lgkmcnt(0)
    v_add_f32 v128, v128, v152
    v_add_f32 v129, v129, v153
    v_add_f32 v130, v130, v154
    v_add_f32 v131, v131, v155
    v_add_f32 v132, v132, v156
    v_add_f32 v133, v133, v157
    v_add_f32 v134, v134, v158
    v_add_f32 v135, v135, v159
    v_cvt_pk_bf16_f32 v8, v128, v129
    v_cvt_pk_bf16_f32 v9, v130, v131
    v_cvt_pk_bf16_f32 v10, v132, v133
    v_cvt_pk_bf16_f32 v11, v134, v135
    v_mov_b32 v32, 0
    v_mov_b32 v33, 0
    v_mov_b32 v34, 0
    v_mov_b32 v35, 0
    v_mov_b32 v36, 0
    v_mov_b32 v37, 0
    v_mov_b32 v38, 0
    v_mov_b32 v39, 0
    v_mov_b32 v40, 0
    v_mov_b32 v41, 0
    v_mov_b32 v42, 0
    v_mov_b32 v43, 0
    v_mov_b32 v44, 0
    v_mov_b32 v45, 0
    v_mov_b32 v46, 0
    v_mov_b32 v47, 0
    v_mov_b32_dpp v32, v8 quad_perm:[0,1,2,3] row_mask:0xf bank_mask:0x1
    v_mov_b32_dpp v33, v9 quad_perm:[0,1,2,3] row_mask:0xf bank_mask:0x1
    v_mov_b32_dpp v34, v10 quad_perm:[0,1,2,3] row_mask:0xf bank_mask:0x1
    v_mov_b32_dpp v35, v11 quad_perm:[0,1,2,3] row_mask:0xf bank_mask:0x1
    v_mov_b32_dpp v36, v8 quad_perm:[0,1,2,3] row_mask:0xf bank_mask:0x2
    v_mov_b32_dpp v37, v9 quad_perm:[0,1,2,3] row_mask:0xf bank_mask:0x2
    v_mov_b32_dpp v38, v10 quad_perm:[0,1,2,3] row_mask:0xf bank_mask:0x2
    v_mov_b32_dpp v39, v11 quad_perm:[0,1,2,3] row_mask:0xf bank_mask:0x2
    v_mov_b32_dpp v40, v8 quad_perm:[0,1,2,3] row_mask:0xf bank_mask:0x4
    v_mov_b32_dpp v41, v9 quad_perm:[0,1,2,3] row_mask:0xf bank_mask:0x4
    v_mov_b32_dpp v42, v10 quad_perm:[0,1,2,3] row_mask:0xf bank_mask:0x4
    v_mov_b32_dpp v43, v11 quad_perm:[0,1,2,3] row_mask:0xf bank_mask:0x4
    v_mov_b32_dpp v44, v8 quad_perm:[0,1,2,3] row_mask:0xf bank_mask:0x8
    v_mov_b32_dpp v45, v9 quad_perm:[0,1,2,3] row_mask:0xf bank_mask:0x8
    v_mov_b32_dpp v46, v10 quad_perm:[0,1,2,3] row_mask:0xf bank_mask:0x8
    v_mov_b32_dpp v47, v11 quad_perm:[0,1,2,3] row_mask:0xf bank_mask:0x8
    s_mov_b32 s27, 0
L_BK:
    s_cmp_lg_u32 s27, 10
    s_cbranch_scc1 L_BK_a
    s_add_u32 s4, s52, s30
    s_addc_u32 s5, s53, 0
    s_mov_b32 s32, s35
    v_mov_b32 v1, v2
    buffer_load_dword v61, off, s[16:19], 0 offset:0 sc1
L_BK_a:
    s_sub_u32 s70, s27, 1
    s_cmp_ge_u32 s70, 8
    s_cbranch_scc1 L_BK_b
    s_and_b32 s24, s70, 3
    s_lshl_b32 s24, s24, 1
    s_lshr_b32 s25, s70, 2
    s_or_b32 s24, s24, s25
    s_lshl_b32 s24, s24, 10
    s_add_u32 s24, s24, s33
    s_mul_i32 s25, s70, 4224
    s_add_u32 m0, s25, s34
    s_nop 0
    buffer_load_dwordx4 v2, s[8:11], s24 offen  lds
    s_add_u32 s24, s24, 8192
    s_add_u32 m0, m0, 1056
    s_nop 0
    buffer_load_dwordx4 v2, s[8:11], s24 offen  lds
    s_add_u32 s24, s24, 8192
    s_add_u32 m0, m0, 1056
    s_nop 0
    buffer_load_dwordx4 v2, s[8:11], s24 offen  lds
    s_add_u32 s24, s24, 8192
    s_add_u32 m0, m0, 1056
    s_nop 0
    buffer_load_dwordx4 v2, s[8:11], s24 offen  lds
L_BK_b:
    v_mov_b32 v48, v49
    v_mov_b32 v49, v50
    v_mov_b32 v50, v51
    v_mov_b32 v51, v52
    v_mov_b32 v52, v53
    v_mov_b32 v53, v54
    v_mov_b32 v54, v55
    v_mov_b32 v55, v56
    v_mov_b32 v56, v57
    v_mov_b32 v57, v58
    s_waitcnt vmcnt(15)
    v_mfma_f32_16x16x32_bf16 v[12:15], v[64:67], v[32:35], 0
    buffer_load_dwordx4 v[64:67], v1, s[4:7], s32 offen offset:0 nt
    s_add_u32 s32, s32, 6144
    s_waitcnt vmcnt(15)
    v_mfma_f32_16x16x32_bf16 v[12:15], v[68:71], v[36:39], v[12:15]
    buffer_load_dwordx4 v[68:71], v1, s[4:7], s32 offen offset:0 nt
    s_add_u32 s32, s32, 6144
    s_waitcnt vmcnt(15)
    v_mfma_f32_16x16x32_bf16 v[12:15], v[72:75], v[40:43], v[12:15]
    buffer_load_dwordx4 v[72:75], v1, s[4:7], s32 offen offset:0 nt
    s_add_u32 s32, s32, 6144
    s_waitcnt vmcnt(15)
    v_mfma_f32_16x16x32_bf16 v[12:15], v[76:79], v[44:47], v[12:15]
    buffer_load_dwordx4 v[76:79], v1, s[4:7], s32 offen offset:0 nt
    s_add_u32 s32, s32, 6144
    s_nop 5
    v_add_f32_dpp v58, v13, v12 quad_perm:[1,1,1,1] row_mask:0xf bank_mask:0xf
    s_nop 1
    v_add_f32_dpp v58, v14, v58 quad_perm:[2,2,2,2] row_mask:0xf bank_mask:0xf
    s_nop 1
    v_add_f32_dpp v58, v15, v58 quad_perm:[3,3,3,3] row_mask:0xf bank_mask:0xf
    s_waitcnt vmcnt(15)
    v_mfma_f32_16x16x32_bf16 v[16:19], v[80:83], v[32:35], 0
    buffer_load_dwordx4 v[80:83], v1, s[4:7], s32 offen offset:0 nt
    s_add_u32 s32, s32, 6144
    s_waitcnt vmcnt(15)
    v_mfma_f32_16x16x32_bf16 v[16:19], v[84:87], v[36:39], v[16:19]
    buffer_load_dwordx4 v[84:87], v1, s[4:7], s32 offen offset:0 nt
    s_add_u32 s32, s32, 6144
    s_waitcnt vmcnt(15)
    v_mfma_f32_16x16x32_bf16 v[16:19], v[88:91], v[40:43], v[16:19]
    buffer_load_dwordx4 v[88:91], v1, s[4:7], s32 offen offset:0 nt
    s_add_u32 s32, s32, 6144
    s_waitcnt vmcnt(15)
    v_mfma_f32_16x16x32_bf16 v[16:19], v[92:95], v[44:47], v[16:19]
    buffer_load_dwordx4 v[92:95], v1, s[4:7], s32 offen offset:0 nt
    s_add_u32 s32, s32, 6144
    s_nop 5
    v_add_f32_dpp v3, v16, v17 quad_perm:[0,0,0,0] row_mask:0xf bank_mask:0xf
    s_nop 1
    v_add_f32_dpp v3, v18, v3 quad_perm:[2,2,2,2] row_mask:0xf bank_mask:0xf
    s_nop 1
    v_add_f32_dpp v3, v19, v3 quad_perm:[3,3,3,3] row_mask:0xf bank_mask:0xf
    v_cndmask_b32 v58, v58, v3, s[64:65]
    s_waitcnt vmcnt(15)
    v_mfma_f32_16x16x32_bf16 v[12:15], v[96:99], v[32:35], 0
    buffer_load_dwordx4 v[96:99], v1, s[4:7], s32 offen offset:0 nt
    s_add_u32 s32, s32, 6144
    s_waitcnt vmcnt(15)
    v_mfma_f32_16x16x32_bf16 v[12:15], v[100:103], v[36:39], v[12:15]
    buffer_load_dwordx4 v[100:103], v1, s[4:7], s32 offen offset:0 nt
    s_add_u32 s32, s32, 6144
    s_waitcnt vmcnt(15)
    v_mfma_f32_16x16x32_bf16 v[12:15], v[104:107], v[40:43], v[12:15]
    buffer_load_dwordx4 v[104:107], v1, s[4:7], s32 offen offset:0 nt
    s_add_u32 s32, s32, 6144
    s_waitcnt vmcnt(15)
    v_mfma_f32_16x16x32_bf16 v[12:15], v[108:111], v[44:47], v[12:15]
    buffer_load_dwordx4 v[108:111], v1, s[4:7], s32 offen offset:0 nt
    s_add_u32 s32, s32, 6144
    s_nop 5
    v_add_f32_dpp v3, v12, v14 quad_perm:[0,0,0,0] row_mask:0xf bank_mask:0xf
    s_nop 1
    v_add_f32_dpp v3, v13, v3 quad_perm:[1,1,1,1] row_mask:0xf bank_mask:0xf
    s_nop 1
    v_add_f32_dpp v3, v15, v3 quad_perm:[3,3,3,3] row_mask:0xf bank_mask:0xf
    v_cndmask_b32 v58, v58, v3, s[66:67]
    s_waitcnt vmcnt(15)
    v_mfma_f32_16x16x32_bf16 v[16:19], v[112:115], v[32:35], 0
    buffer_load_dwordx4 v[112:115], v1, s[4:7], s32 offen offset:0 nt
    s_add_u32 s32, s32, 6144
    s_waitcnt vmcnt(15)
    v_mfma_f32_16x16x32_bf16 v[16:19], v[116:119], v[36:39], v[16:19]
    buffer_load_dwordx4 v[116:119], v1, s[4:7], s32 offen offset:0 nt
    s_add_u32 s32, s32, 6144
    s_waitcnt vmcnt(15)
    v_mfma_f32_16x16x32_bf16 v[16:19], v[120:123], v[40:43], v[16:19]
    buffer_load_dwordx4 v[120:123], v1, s[4:7], s32 offen offset:0 nt
    s_add_u32 s32, s32, 6144
    s_waitcnt vmcnt(15)
    v_mfma_f32_16x16x32_bf16 v[16:19], v[124:127], v[44:47], v[16:19]
    buffer_load_dwordx4 v[124:127], v1, s[4:7], s32 offen offset:0 nt
    s_add_u32 s32, s32, 6144
    s_nop 5
    v_add_f32_dpp v3, v16, v19 quad_perm:[0,0,0,0] row_mask:0xf bank_mask:0xf
    s_nop 1
    v_add_f32_dpp v3, v17, v3 quad_perm:[1,1,1,1] row_mask:0xf bank_mask:0xf
    s_nop 1
    v_add_f32_dpp v3, v18, v3 quad_perm:[2,2,2,2] row_mask:0xf bank_mask:0xf
    v_cndmask_b32 v58, v58, v3, s[68:69]
    s_add_u32 s27, s27, 1
    s_cmp_lt_u32 s27, 11
    s_cbranch_scc1 L_BK
    v_and_b32 v3, 3, v0
    v_bfe_u32 v4, v0, 2, 2
    v_lshl_add_u32 v3, v3, 2, v4
    v_add_u32 v3, 160, v3
    v_lshrrev_b32 v3, 0, v3
    v_mul_u32_u24 v3, 6, v3
    v_add_u32 v3, s31, v3
    v_mov_b32 v4, 0xff800000
    v_cmp_gt_u32 vcc, 1024, v3
    s_nop 1
    v_cndmask_b32 v58, v4, v58, vcc
    v_max3_f32 v3, v48, v49, v50
    v_max3_f32 v3, v3, v51, v52
    v_max3_f32 v3, v3, v53, v54
    v_max3_f32 v3, v3, v55, v56
    v_max3_f32 v3, v3, v57, v58
    s_nop 1
    v_max_f32_dpp v3, v3, v3 row_ror:8 row_mask:0xf bank_mask:0xf
    s_nop 1
    v_max_f32_dpp v3, v3, v3 row_ror:4 row_mask:0xf bank_mask:0xf
    s_nop 1
    v_max_f32_dpp v3, v3, v3 row_ror:2 row_mask:0xf bank_mask:0xf
    s_nop 1
    v_max_f32_dpp v3, v3, v3 row_ror:1 row_mask:0xf bank_mask:0xf
    s_nop 1
    v_max_f32_dpp v3, v3, v3 row_bcast:15 row_mask:0xa bank_mask:0xf
    s_nop 1
    v_max_f32_dpp v3, v3, v3 row_bcast:31 row_mask:0xc bank_mask:0xf
    s_nop 0
    v_readlane_b32 s24, v3, 63
    s_lshl_b32 s25, s3, 2
    s_add_u32 s25, s25, 143360
    v_mov_b32 v4, s25
    v_mov_b32 v3, s24
    ds_write_b32 v4, v3
    v_xor_b32 v4, 4, v4
    v_readfirstlane_b32 s25, v61
    s_nop 0
    s_cmp_ge_u32 s25, 64
    s_cbranch_scc1 L_B_clr
    s_mov_b32 s24, 262144
L_B_clrw:
    buffer_load_dword v61, off, s[16:19], 0 offset:0 sc1
    s_waitcnt vmcnt(0)
    v_readfirstlane_b32 s25, v61
    s_nop 0
    s_cmp_ge_u32 s25, 64
    s_cbranch_scc1 L_B_clr
    s_sleep 16
    s_sub_u32 s24, s24, 1
    s_cmp_lg_u32 s24, 0
    s_cbranch_scc1 L_B_clrw
L_B_clr:
    s_waitcnt lgkmcnt(0)
    s_barrier
    ds_read_b32 v5, v4
    s_mov_b32 s71, 0x3e0293ee
    s_waitcnt lgkmcnt(0)
    v_max_f32 v5, v3, v5
    v_mul_f32 v6, s71, v5
    v_lshrrev_b32 v3, 2, v0
    v_mul_u32_u24 v3, 1056, v3
    v_and_b32 v4, 3, v0
    v_lshl_add_u32 v3, v4, 3, v3
    s_lshl_b32 s24, s3, 8
    v_add_u32 v3, s24, v3
    v_add_u32 v4, 67584, v3
    ds_read_b64_tr_b16 v[128:129], v3 offset:0
    ds_read_b64_tr_b16 v[130:131], v3 offset:16896
    ds_read_b64_tr_b16 v[132:133], v3 offset:33792
    ds_read_b64_tr_b16 v[134:135], v3 offset:50688
    ds_read_b64_tr_b16 v[136:137], v4 offset:0
    ds_read_b64_tr_b16 v[138:139], v4 offset:16896
    ds_read_b64_tr_b16 v[140:141], v4 offset:33792
    ds_read_b64_tr_b16 v[142:143], v4 offset:50688
    ds_read_b64_tr_b16 v[144:145], v3 offset:32
    ds_read_b64_tr_b16 v[146:147], v3 offset:16928
    ds_read_b64_tr_b16 v[148:149], v3 offset:33824
    ds_read_b64_tr_b16 v[150:151], v3 offset:50720
    ds_read_b64_tr_b16 v[152:153], v4 offset:32
    ds_read_b64_tr_b16 v[154:155], v4 offset:16928
    ds_read_b64_tr_b16 v[156:157], v4 offset:33824
    ds_read_b64_tr_b16 v[158:159], v4 offset:50720
    ds_read_b64_tr_b16 v[160:161], v3 offset:64
    ds_read_b64_tr_b16 v[162:163], v3 offset:16960
    ds_read_b64_tr_b16 v[164:165], v3 offset:33856
    ds_read_b64_tr_b16 v[166:167], v3 offset:50752
    ds_read_b64_tr_b16 v[168:169], v4 offset:64
    ds_read_b64_tr_b16 v[170:171], v4 offset:16960
    ds_read_b64_tr_b16 v[172:173], v4 offset:33856
    ds_read_b64_tr_b16 v[174:175], v4 offset:50752
    ds_read_b64_tr_b16 v[176:177], v3 offset:96
    ds_read_b64_tr_b16 v[178:179], v3 offset:16992
    ds_read_b64_tr_b16 v[180:181], v3 offset:33888
    ds_read_b64_tr_b16 v[182:183], v3 offset:50784
    ds_read_b64_tr_b16 v[184:185], v4 offset:96
    ds_read_b64_tr_b16 v[186:187], v4 offset:16992
    ds_read_b64_tr_b16 v[188:189], v4 offset:33888
    ds_read_b64_tr_b16 v[190:191], v4 offset:50784
    ds_read_b64_tr_b16 v[192:193], v3 offset:128
    ds_read_b64_tr_b16 v[194:195], v3 offset:17024
    ds_read_b64_tr_b16 v[196:197], v3 offset:33920
    ds_read_b64_tr_b16 v[198:199], v3 offset:50816
    ds_read_b64_tr_b16 v[200:201], v4 offset:128
    ds_read_b64_tr_b16 v[202:203], v4 offset:17024
    ds_read_b64_tr_b16 v[204:205], v4 offset:33920
    ds_read_b64_tr_b16 v[206:207], v4 offset:50816
    ds_read_b64_tr_b16 v[208:209], v3 offset:160
    ds_read_b64_tr_b16 v[210:211], v3 offset:17056
    ds_read_b64_tr_b16 v[212:213], v3 offset:33952
    ds_read_b64_tr_b16 v[214:215], v3 offset:50848
    ds_read_b64_tr_b16 v[216:217], v4 offset:160
    ds_read_b64_tr_b16 v[218:219], v4 offset:17056
    ds_read_b64_tr_b16 v[220:221], v4 offset:33952
    ds_read_b64_tr_b16 v[222:223], v4 offset:50848
    ds_read_b64_tr_b16 v[224:225], v3 offset:192
    ds_read_b64_tr_b16 v[226:227], v3 offset:17088
    ds_read_b64_tr_b16 v[228:229], v3 offset:33984
    ds_read_b64_tr_b16 v[230:231], v3 offset:50880
    ds_read_b64_tr_b16 v[232:233], v4 offset:192
    ds_read_b64_tr_b16 v[234:235], v4 offset:17088
    ds_read_b64_tr_b16 v[236:237], v4 offset:33984
    ds_read_b64_tr_b16 v[238:239], v4 offset:50880
    ds_read_b64_tr_b16 v[240:241], v3 offset:224
    ds_read_b64_tr_b16 v[242:243], v3 offset:17120
    ds_read_b64_tr_b16 v[244:245], v3 offset:34016
    ds_read_b64_tr_b16 v[246:247], v3 offset:50912
    ds_read_b64_tr_b16 v[248:249], v4 offset:224
    ds_read_b64_tr_b16 v[250:251], v4 offset:17120
    ds_read_b64_tr_b16 v[252:253], v4 offset:34016
    ds_read_b64_tr_b16 v[254:255], v4 offset:50912
    v_fma_f32 v48, v48, s71, -v6
    v_fma_f32 v49, v49, s71, -v6
    v_fma_f32 v50, v50, s71, -v6
    v_fma_f32 v51, v51, s71, -v6
    v_fma_f32 v52, v52, s71, -v6
    v_fma_f32 v53, v53, s71, -v6
    v_fma_f32 v54, v54, s71, -v6
    v_fma_f32 v55, v55, s71, -v6
    v_fma_f32 v56, v56, s71, -v6
    v_fma_f32 v57, v57, s71, -v6
    v_fma_f32 v58, v58, s71, -v6
    v_exp_f32 v48, v48
    v_exp_f32 v49, v49
    v_exp_f32 v50, v50
    v_exp_f32 v51, v51
    v_exp_f32 v52, v52
    v_exp_f32 v53, v53
    v_exp_f32 v54, v54
    v_exp_f32 v55, v55
    v_exp_f32 v56, v56
    v_exp_f32 v57, v57
    v_exp_f32 v58, v58
    v_add_f32 v7, v48, v49
    v_add_f32 v7, v7, v50
    v_add_f32 v7, v7, v51
    v_add_f32 v7, v7, v52
    v_add_f32 v7, v7, v53
    v_add_f32 v7, v7, v54
    v_add_f32 v7, v7, v55
    v_add_f32 v7, v7, v56
    v_add_f32 v7, v7, v57
    v_add_f32 v7, v7, v58
    v_cvt_pk_bf16_f32 v48, v48, v48
    v_cvt_pk_bf16_f32 v49, v49, v49
    v_cvt_pk_bf16_f32 v50, v50, v50
    v_cvt_pk_bf16_f32 v51, v51, v51
    v_cvt_pk_bf16_f32 v52, v52, v52
    v_cvt_pk_bf16_f32 v53, v53, v53
    v_cvt_pk_bf16_f32 v54, v54, v54
    v_cvt_pk_bf16_f32 v55, v55, v55
    v_cvt_pk_bf16_f32 v56, v56, v56
    v_cvt_pk_bf16_f32 v57, v57, v57
    v_cvt_pk_bf16_f32 v58, v58, v58
    v_add_f32_dpp v7, v7, v7 row_ror:8 row_mask:0xf bank_mask:0xf
    s_nop 1
    v_add_f32_dpp v7, v7, v7 row_ror:4 row_mask:0xf bank_mask:0xf
    s_nop 1
    v_add_f32_dpp v7, v7, v7 row_ror:2 row_mask:0xf bank_mask:0xf
    s_nop 1
    v_add_f32_dpp v7, v7, v7 row_ror:1 row_mask:0xf bank_mask:0xf
    s_nop 1
    v_add_f32_dpp v7, v7, v7 row_bcast:15 row_mask:0xa bank_mask:0xf
    s_nop 1
    v_add_f32_dpp v7, v7, v7 row_bcast:31 row_mask:0xc bank_mask:0xf
    s_nop 0
    v_readlane_b32 s24, v7, 63
    s_lshl_b32 s72, s28, 5
    s_add_u32 s72, s72, s26
    s_mul_i32 s72, s72, 3
    s_add_u32 s72, s72, s29
    s_lshl_b32 s25, s72, 2
    s_add_u32 s73, s25, s3
    s_lshl_b32 s25, s73, 3
    s_add_u32 s25, s25, 0x230000
    v_mov_b32 v7, s24
    s_mov_b64 exec, 1
    buffer_store_dwordx2 v[6:7], off, s[12:15], s25 sc1
    s_mov_b64 exec, -1
    s_lshl_b32 s73, s73, 10
    s_add_u32 s73, s73, 0x170000
    s_lshl_b32 s72, s72, 2
    s_add_u32 s72, s72, 0x232000
    v_lshrrev_b32 v3, 4, v0
    v_lshlrev_b32 v60, 6, v3
    v_and_b32 v4, 7, v0
    v_lshl_add_u32 v60, v4, 3, v60
    s_lshl_b32 s24, s3, 8
    s_add_u32 s24, s24, 143616
    v_add_u32 v60, s24, v60
    v_and_b32 v4, 3, v0
    v_lshlrev_b32 v61, 8, v4
    v_lshl_add_u32 v61, v3, 4, v61
    v_add_u32 v61, 143616, v61
    v_mov_b32 v12, 0
    v_mov_b32 v13, 0
    v_mov_b32 v14, 0
    v_mov_b32 v15, 0
    v_mov_b32 v62, 1
    s_mov_b32 s27, 0
L_BV:
    s_cmp_lg_u32 s27, 9
    s_cbranch_scc1 L_BV_a
    s_cmp_lg_u32 s3, 0
    s_cbranch_scc1 L_BV_a
    s_mov_b64 exec, 1
    buffer_store_dword v62, off, s[12:15], s72 sc1
    s_mov_b64 exec, -1
L_BV_a:
    v_and_b32_dpp v8, v48, v20 row_newbcast:0 row_mask:0xf bank_mask:0xf
    v_and_b32_dpp v9, v48, v21 row_newbcast:0 row_mask:0xf bank_mask:0xf
    v_and_b32_dpp v10, v48, v22 row_newbcast:0 row_mask:0xf bank_mask:0xf
    v_and_b32_dpp v11, v48, v23 row_newbcast:0 row_mask:0xf bank_mask:0xf
    s_waitcnt vmcnt(15)
    s_nop 0
    v_mfma_f32_16x16x32_bf16 v[12:15], v[64:67], v[8:11], v[12:15]
    buffer_load_dwordx4 v[64:67], v1, s[4:7], s32 offen offset:0 nt
    s_add_u32 s32, s32, 6144
    v_and_b32_dpp v8, v48, v20 row_newbcast:4 row_mask:0xf bank_mask:0xf
    v_and_b32_dpp v9, v48, v21 row_newbcast:4 row_mask:0xf bank_mask:0xf
    v_and_b32_dpp v10, v48, v22 row_newbcast:4 row_mask:0xf bank_mask:0xf
    v_and_b32_dpp v11, v48, v23 row_newbcast:4 row_mask:0xf bank_mask:0xf
    s_waitcnt vmcnt(15)
    s_nop 0
    v_mfma_f32_16x16x32_bf16 v[12:15], v[68:71], v[8:11], v[12:15]
    buffer_load_dwordx4 v[68:71], v1, s[4:7], s32 offen offset:0 nt
    s_add_u32 s32, s32, 6144
    v_and_b32_dpp v8, v48, v20 row_newbcast:8 row_mask:0xf bank_mask:0xf
    v_and_b32_dpp v9, v48, v21 row_newbcast:8 row_mask:0xf bank_mask:0xf
    v_and_b32_dpp v10, v48, v22 row_newbcast:8 row_mask:0xf bank_mask:0xf
    v_and_b32_dpp v11, v48, v23 row_newbcast:8 row_mask:0xf bank_mask:0xf
    s_waitcnt vmcnt(15)
    s_nop 0
    v_mfma_f32_16x16x32_bf16 v[12:15], v[72:75], v[8:11], v[12:15]
    buffer_load_dwordx4 v[72:75], v1, s[4:7], s32 offen offset:0 nt
    s_add_u32 s32, s32, 6144
    v_and_b32_dpp v8, v48, v20 row_newbcast:12 row_mask:0xf bank_mask:0xf
    v_and_b32_dpp v9, v48, v21 row_newbcast:12 row_mask:0xf bank_mask:0xf
    v_and_b32_dpp v10, v48, v22 row_newbcast:12 row_mask:0xf bank_mask:0xf
    v_and_b32_dpp v11, v48, v23 row_newbcast:12 row_mask:0xf bank_mask:0xf
    s_waitcnt vmcnt(15)
    s_nop 0
    v_mfma_f32_16x16x32_bf16 v[12:15], v[76:79], v[8:11], v[12:15]
    buffer_load_dwordx4 v[76:79], v1, s[4:7], s32 offen offset:0 nt
    s_add_u32 s32, s32, 6144
    v_and_b32_dpp v8, v48, v20 row_newbcast:1 row_mask:0xf bank_mask:0xf
    v_and_b32_dpp v9, v48, v21 row_newbcast:1 row_mask:0xf bank_mask:0xf
    v_and_b32_dpp v10, v48, v22 row_newbcast:1 row_mask:0xf bank_mask:0xf
    v_and_b32_dpp v11, v48, v23 row_newbcast:1 row_mask:0xf bank_mask:0xf
    s_waitcnt vmcnt(15)
    s_nop 0
    v_mfma_f32_16x16x32_bf16 v[12:15], v[80:83], v[8:11], v[12:15]
    buffer_load_dwordx4 v[80:83], v1, s[4:7], s32 offen offset:0 nt
    s_add_u32 s32, s32, 6144
    v_and_b32_dpp v8, v48, v20 row_newbcast:5 row_mask:0xf bank_mask:0xf
    v_and_b32_dpp v9, v48, v21 row_newbcast:5 row_mask:0xf bank_mask:0xf
    v_and_b32_dpp v10, v48, v22 row_newbcast:5 row_mask:0xf bank_mask:0xf
    v_and_b32_dpp v11, v48, v23 row_newbcast:5 row_mask:0xf bank_mask:0xf
    s_waitcnt vmcnt(15)
    s_nop 0
    v_mfma_f32_16x16x32_bf16 v[12:15], v[84:87], v[8:11], v[12:15]
    buffer_load_dwordx4 v[84:87], v1, s[4:7], s32 offen offset:0 nt
    s_add_u32 s32, s32, 6144
    v_and_b32_dpp v8, v48, v20 row_newbcast:9 row_mask:0xf bank_mask:0xf
    v_and_b32_dpp v9, v48, v21 row_newbcast:9 row_mask:0xf bank_mask:0xf
    v_and_b32_dpp v10, v48, v22 row_newbcast:9 row_mask:0xf bank_mask:0xf
    v_and_b32_dpp v11, v48, v23 row_newbcast:9 row_mask:0xf bank_mask:0xf
    s_waitcnt vmcnt(15)
    s_nop 0
    v_mfma_f32_16x16x32_bf16 v[12:15], v[88:91], v[8:11], v[12:15]
    buffer_load_dwordx4 v[88:91], v1, s[4:7], s32 offen offset:0 nt
    s_add_u32 s32, s32, 6144
    v_and_b32_dpp v8, v48, v20 row_newbcast:13 row_mask:0xf bank_mask:0xf
    v_and_b32_dpp v9, v48, v21 row_newbcast:13 row_mask:0xf bank_mask:0xf
    v_and_b32_dpp v10, v48, v22 row_newbcast:13 row_mask:0xf bank_mask:0xf
    v_and_b32_dpp v11, v48, v23 row_newbcast:13 row_mask:0xf bank_mask:0xf
    s_waitcnt vmcnt(15)
    s_nop 0
    v_mfma_f32_16x16x32_bf16 v[12:15], v[92:95], v[8:11], v[12:15]
    buffer_load_dwordx4 v[92:95], v1, s[4:7], s32 offen offset:0 nt
    s_add_u32 s32, s32, 6144
    v_and_b32_dpp v8, v48, v20 row_newbcast:2 row_mask:0xf bank_mask:0xf
    v_and_b32_dpp v9, v48, v21 row_newbcast:2 row_mask:0xf bank_mask:0xf
    v_and_b32_dpp v10, v48, v22 row_newbcast:2 row_mask:0xf bank_mask:0xf
    v_and_b32_dpp v11, v48, v23 row_newbcast:2 row_mask:0xf bank_mask:0xf
    s_waitcnt vmcnt(15)
    s_nop 0
    v_mfma_f32_16x16x32_bf16 v[12:15], v[96:99], v[8:11], v[12:15]
    buffer_load_dwordx4 v[96:99], v1, s[4:7], s32 offen offset:0 nt
    s_add_u32 s32, s32, 6144
    v_and_b32_dpp v8, v48, v20 row_newbcast:6 row_mask:0xf bank_mask:0xf
    v_and_b32_dpp v9, v48, v21 row_newbcast:6 row_mask:0xf bank_mask:0xf
    v_and_b32_dpp v10, v48, v22 row_newbcast:6 row_mask:0xf bank_mask:0xf
    v_and_b32_dpp v11, v48, v23 row_newbcast:6 row_mask:0xf bank_mask:0xf
    s_waitcnt vmcnt(15)
    s_nop 0
    v_mfma_f32_16x16x32_bf16 v[12:15], v[100:103], v[8:11], v[12:15]
    buffer_load_dwordx4 v[100:103], v1, s[4:7], s32 offen offset:0 nt
    s_add_u32 s32, s32, 6144
    v_and_b32_dpp v8, v48, v20 row_newbcast:10 row_mask:0xf bank_mask:0xf
    v_and_b32_dpp v9, v48, v21 row_newbcast:10 row_mask:0xf bank_mask:0xf
    v_and_b32_dpp v10, v48, v22 row_newbcast:10 row_mask:0xf bank_mask:0xf
    v_and_b32_dpp v11, v48, v23 row_newbcast:10 row_mask:0xf bank_mask:0xf
    s_waitcnt vmcnt(15)
    s_nop 0
    v_mfma_f32_16x16x32_bf16 v[12:15], v[104:107], v[8:11], v[12:15]
    buffer_load_dwordx4 v[104:107], v1, s[4:7], s32 offen offset:0 nt
    s_add_u32 s32, s32, 6144
    s_cmp_eq_u32 s27, 10
    s_cbranch_scc1 L_BT
    v_and_b32_dpp v8, v48, v20 row_newbcast:14 row_mask:0xf bank_mask:0xf
    v_and_b32_dpp v9, v48, v21 row_newbcast:14 row_mask:0xf bank_mask:0xf
    v_and_b32_dpp v10, v48, v22 row_newbcast:14 row_mask:0xf bank_mask:0xf
    v_and_b32_dpp v11, v48, v23 row_newbcast:14 row_mask:0xf bank_mask:0xf
    s_waitcnt vmcnt(15)
    s_nop 0
    v_mfma_f32_16x16x32_bf16 v[12:15], v[108:111], v[8:11], v[12:15]
    buffer_load_dwordx4 v[108:111], v1, s[4:7], s32 offen offset:0 nt
    s_add_u32 s32, s32, 6144
    v_and_b32_dpp v8, v48, v20 row_newbcast:3 row_mask:0xf bank_mask:0xf
    v_and_b32_dpp v9, v48, v21 row_newbcast:3 row_mask:0xf bank_mask:0xf
    v_and_b32_dpp v10, v48, v22 row_newbcast:3 row_mask:0xf bank_mask:0xf
    v_and_b32_dpp v11, v48, v23 row_newbcast:3 row_mask:0xf bank_mask:0xf
    s_waitcnt vmcnt(15)
    s_nop 0
    v_mfma_f32_16x16x32_bf16 v[12:15], v[112:115], v[8:11], v[12:15]
    buffer_load_dwordx4 v[112:115], v1, s[4:7], s32 offen offset:0 nt
    s_add_u32 s32, s32, 6144
    v_and_b32_dpp v8, v48, v20 row_newbcast:7 row_mask:0xf bank_mask:0xf
    v_and_b32_dpp v9, v48, v21 row_newbcast:7 row_mask:0xf bank_mask:0xf
    v_and_b32_dpp v10, v48, v22 row_newbcast:7 row_mask:0xf bank_mask:0xf
    v_and_b32_dpp v11, v48, v23 row_newbcast:7 row_mask:0xf bank_mask:0xf
    s_waitcnt vmcnt(15)
    s_nop 0
    v_mfma_f32_16x16x32_bf16 v[12:15], v[116:119], v[8:11], v[12:15]
    buffer_load_dwordx4 v[116:119], v1, s[4:7], s32 offen offset:0 nt
    s_add_u32 s32, s32, 6144
    v_and_b32_dpp v8, v48, v20 row_newbcast:11 row_mask:0xf bank_mask:0xf
    v_and_b32_dpp v9, v48, v21 row_newbcast:11 row_mask:0xf bank_mask:0xf
    v_and_b32_dpp v10, v48, v22 row_newbcast:11 row_mask:0xf bank_mask:0xf
    v_and_b32_dpp v11, v48, v23 row_newbcast:11 row_mask:0xf bank_mask:0xf
    s_waitcnt vmcnt(15)
    s_nop 0
    v_mfma_f32_16x16x32_bf16 v[12:15], v[120:123], v[8:11], v[12:15]
    buffer_load_dwordx4 v[120:123], v1, s[4:7], s32 offen offset:0 nt
    s_add_u32 s32, s32, 6144
    v_and_b32_dpp v8, v48, v20 row_newbcast:15 row_mask:0xf bank_mask:0xf
    v_and_b32_dpp v9, v48, v21 row_newbcast:15 row_mask:0xf bank_mask:0xf
    v_and_b32_dpp v10, v48, v22 row_newbcast:15 row_mask:0xf bank_mask:0xf
    v_and_b32_dpp v11, v48, v23 row_newbcast:15 row_mask:0xf bank_mask:0xf
    s_waitcnt vmcnt(15)
    s_nop 0
    v_mfma_f32_16x16x32_bf16 v[12:15], v[124:127], v[8:11], v[12:15]
    buffer_load_dwordx4 v[124:127], v1, s[4:7], s32 offen offset:0 nt
    s_add_u32 s32, s32, 6144
    v_mov_b32 v48, v49
    v_mov_b32 v49, v50
    v_mov_b32 v50, v51
    v_mov_b32 v51, v52
    v_mov_b32 v52, v53
    v_mov_b32 v53, v54
    v_mov_b32 v54, v55
    v_mov_b32 v55, v56
    v_mov_b32 v56, v57
    v_mov_b32 v57, v58
    s_add_u32 s27, s27, 1
    s_branch L_BV
L_BT:
    s_nop 4
    v_cvt_pk_bf16_f32 v4, v12, v13
    v_cvt_pk_bf16_f32 v5, v14, v15
    ds_write_b64 v60, v[4:5]
    s_waitcnt lgkmcnt(0)
    s_barrier
    ds_read_b128 v[8:11], v61 offset:0
    ds_read_b128 v[12:15], v61 offset:64
    ds_read_b128 v[16:19], v61 offset:128
    ds_read_b128 v[20:23], v61 offset:192
    s_waitcnt lgkmcnt(3)
    v_mfma_f32_16x16x32_bf16 v[24:27], v[8:11], v[128:131], 0
    s_waitcnt lgkmcnt(2)
    v_mfma_f32_16x16x32_bf16 v[24:27], v[12:15], v[132:135], v[24:27]
    s_waitcnt lgkmcnt(1)
    v_mfma_f32_16x16x32_bf16 v[24:27], v[16:19], v[136:139], v[24:27]
    s_waitcnt lgkmcnt(0)
    v_mfma_f32_16x16x32_bf16 v[24:27], v[20:23], v[140:143], v[24:27]
    v_mfma_f32_16x16x32_bf16 v[28:31], v[8:11], v[144:147], 0
    v_mfma_f32_16x16x32_bf16 v[28:31], v[12:15], v[148:151], v[28:31]
    v_mfma_f32_16x16x32_bf16 v[28:31], v[16:19], v[152:155], v[28:31]
    v_mfma_f32_16x16x32_bf16 v[28:31], v[20:23], v[156:159], v[28:31]
    v_mfma_f32_16x16x32_bf16 v[32:35], v[8:11], v[160:163], 0
    v_mfma_f32_16x16x32_bf16 v[32:35], v[12:15], v[164:167], v[32:35]
    v_mfma_f32_16x16x32_bf16 v[32:35], v[16:19], v[168:171], v[32:35]
    v_mfma_f32_16x16x32_bf16 v[32:35], v[20:23], v[172:175], v[32:35]
    v_add_f32_dpp v4, v24, v25 quad_perm:[0,1,2,3] row_mask:0x1 bank_mask:0xf
    v_add_f32_dpp v6, v26, v27 quad_perm:[0,1,2,3] row_mask:0x1 bank_mask:0xf
    v_mfma_f32_16x16x32_bf16 v[36:39], v[8:11], v[176:179], 0
    v_mfma_f32_16x16x32_bf16 v[36:39], v[12:15], v[180:183], v[36:39]
    v_mfma_f32_16x16x32_bf16 v[36:39], v[16:19], v[184:187], v[36:39]
    v_mfma_f32_16x16x32_bf16 v[36:39], v[20:23], v[188:191], v[36:39]
    v_add_f32_dpp v4, v28, v29 quad_perm:[0,1,2,3] row_mask:0x2 bank_mask:0xf
    v_add_f32_dpp v6, v30, v31 quad_perm:[0,1,2,3] row_mask:0x2 bank_mask:0xf
    v_mfma_f32_16x16x32_bf16 v[40:43], v[8:11], v[192:195], 0
    v_mfma_f32_16x16x32_bf16 v[40:43], v[12:15], v[196:199], v[40:43]
    v_mfma_f32_16x16x32_bf16 v[40:43], v[16:19], v[200:203], v[40:43]
    v_mfma_f32_16x16x32_bf16 v[40:43], v[20:23], v[204:207], v[40:43]
    v_add_f32_dpp v4, v32, v33 quad_perm:[0,1,2,3] row_mask:0x4 bank_mask:0xf
    v_add_f32_dpp v6, v34, v35 quad_perm:[0,1,2,3] row_mask:0x4 bank_mask:0xf
    v_mfma_f32_16x16x32_bf16 v[44:47], v[8:11], v[208:211], 0
    v_mfma_f32_16x16x32_bf16 v[44:47], v[12:15], v[212:215], v[44:47]
    v_mfma_f32_16x16x32_bf16 v[44:47], v[16:19], v[216:219], v[44:47]
    v_mfma_f32_16x16x32_bf16 v[44:47], v[20:23], v[220:223], v[44:47]
    v_add_f32_dpp v4, v36, v37 quad_perm:[0,1,2,3] row_mask:0x8 bank_mask:0xf
    v_add_f32_dpp v6, v38, v39 quad_perm:[0,1,2,3] row_mask:0x8 bank_mask:0xf
    v_mfma_f32_16x16x32_bf16 v[48:51], v[8:11], v[224:227], 0
    v_mfma_f32_16x16x32_bf16 v[48:51], v[12:15], v[228:231], v[48:51]
    v_mfma_f32_16x16x32_bf16 v[48:51], v[16:19], v[232:235], v[48:51]
    v_mfma_f32_16x16x32_bf16 v[48:51], v[20:23], v[236:239], v[48:51]
    v_add_f32_dpp v5, v40, v41 quad_perm:[0,1,2,3] row_mask:0x1 bank_mask:0xf
    v_add_f32_dpp v7, v42, v43 quad_perm:[0,1,2,3] row_mask:0x1 bank_mask:0xf
    v_mfma_f32_16x16x32_bf16 v[52:55], v[8:11], v[240:243], 0
    v_mfma_f32_16x16x32_bf16 v[52:55], v[12:15], v[244:247], v[52:55]
    v_mfma_f32_16x16x32_bf16 v[52:55], v[16:19], v[248:251], v[52:55]
    v_mfma_f32_16x16x32_bf16 v[52:55], v[20:23], v[252:255], v[52:55]
    v_add_f32_dpp v5, v44, v45 quad_perm:[0,1,2,3] row_mask:0x2 bank_mask:0xf
    v_add_f32_dpp v7, v46, v47 quad_perm:[0,1,2,3] row_mask:0x2 bank_mask:0xf
    s_nop 0
    v_add_f32_dpp v5, v48, v49 quad_perm:[0,1,2,3] row_mask:0x4 bank_mask:0xf
    v_add_f32_dpp v7, v50, v51 quad_perm:[0,1,2,3] row_mask:0x4 bank_mask:0xf
    s_nop 2
    v_add_f32_dpp v5, v52, v53 quad_perm:[0,1,2,3] row_mask:0x8 bank_mask:0xf
    v_add_f32_dpp v7, v54, v55 quad_perm:[0,1,2,3] row_mask:0x8 bank_mask:0xf
    buffer_store_dwordx4 v[4:7], v2, s[12:15], s73 offen sc1
    s_endpgm
L_W:
    s_mov_b32 s26, s2
    s_mov_b32 s74, s2
    v_lshrrev_b32 v3, 4, v0
    v_and_b32 v4, 15, v0
    v_lshlrev_b32 v18, 18, v3
    v_lshl_add_u32 v18, v4, 4, v18
    v_lshrrev_b32 v6, 3, v4
    v_lshlrev_b32 v6, 10, v6
    v_lshl_add_u32 v19, v3, 6, v6
    v_bfe_u32 v1, v0, 2, 2
    v_lshlrev_b32 v64, 18, v1
    v_lshl_add_u32 v64, v3, 6, v64
    v_and_b32 v4, 3, v0
    v_lshl_add_u32 v64, v4, 4, v64
    v_lshlrev_b32 v65, 9, v1
    v_lshl_add_u32 v65, v3, 7, v65
    v_lshl_add_u32 v65, v4, 5, v65
    v_add_u32 v65, 135168, v65
    v_lshlrev_b32 v66, 15, v1
    v_lshl_add_u32 v66, v3, 6, v66
    v_lshl_add_u32 v66, v4, 4, v66
    s_lshl_b32 s35, s3, 20
    s_lshl_b32 s24, s26, 8
    s_add_u32 s35, s35, s24
    s_waitcnt lgkmcnt(0)
    s_mov_b32 s20, s36
    s_mov_b32 s21, s37
    s_mov_b32 s22, 0x1000
    s_mov_b32 s23, 0x20000
    s_mov_b32 s4, s40
    s_mov_b32 s5, s41
    s_mov_b32 s6, 0x400000
    s_mov_b32 s7, 0x20000
    s_mov_b32 s12, s62
    s_mov_b32 s13, s63
    s_mov_b32 s14, 0x400000
    s_mov_b32 s15, 0x20000
    s_mov_b32 s16, s60
    s_mov_b32 s17, s61
    s_mov_b32 s18, 0x100
    s_mov_b32 s19, 0x20000
    s_lshl_b32 s24, s3, 8
    buffer_load_dwordx4 v[32:35], v19, s[20:23], s24 offen offset:0
    buffer_load_dwordx4 v[36:39], v19, s[20:23], s24 offen offset:16
    buffer_load_dwordx4 v[40:43], v19, s[20:23], s24 offen offset:32
    buffer_load_dwordx4 v[44:47], v19, s[20:23], s24 offen offset:48
    buffer_load_dwordx4 v[48:51], v19, s[20:23], s24 offen offset:2048
    buffer_load_dwordx4 v[52:55], v19, s[20:23], s24 offen offset:2064
    buffer_load_dwordx4 v[56:59], v19, s[20:23], s24 offen offset:2080
    buffer_load_dwordx4 v[60:63], v19, s[20:23], s24 offen offset:2096
    s_mov_b32 s32, s35
    buffer_load_dwordx4 v[128:131], v18, s[4:7], s32 offen nt
    s_add_u32 s32, s32, 8192
    buffer_load_dwordx4 v[132:135], v18, s[4:7], s32 offen nt
    s_add_u32 s32, s32, 8192
    buffer_load_dwordx4 v[136:139], v18, s[4:7], s32 offen nt
    s_add_u32 s32, s32, 8192
    buffer_load_dwordx4 v[140:143], v18, s[4:7], s32 offen nt
    s_add_u32 s32, s32, 8192
    buffer_load_dwordx4 v[144:147], v18, s[4:7], s32 offen nt
    s_add_u32 s32, s32, 8192
    buffer_load_dwordx4 v[148:151], v18, s[4:7], s32 offen nt
    s_add_u32 s32, s32, 8192
    buffer_load_dwordx4 v[152:155], v18, s[4:7], s32 offen nt
    s_add_u32 s32, s32, 8192
    buffer_load_dwordx4 v[156:159], v18, s[4:7], s32 offen nt
    s_add_u32 s32, s32, 8192
    buffer_load_dwordx4 v[160:163], v18, s[4:7], s32 offen nt
    s_add_u32 s32, s32, 8192
    buffer_load_dwordx4 v[164:167], v18, s[4:7], s32 offen nt
    s_add_u32 s32, s32, 8192
    buffer_load_dwordx4 v[168:171], v18, s[4:7], s32 offen nt
    s_add_u32 s32, s32, 8192
    buffer_load_dwordx4 v[172:175], v18, s[4:7], s32 offen nt
    s_add_u32 s32, s32, 8192
    buffer_load_dwordx4 v[176:179], v18, s[4:7], s32 offen nt
    s_add_u32 s32, s32, 8192
    buffer_load_dwordx4 v[180:183], v18, s[4:7], s32 offen nt
    s_add_u32 s32, s32, 8192
    buffer_load_dwordx4 v[184:187], v18, s[4:7], s32 offen nt
    s_add_u32 s32, s32, 8192
    buffer_load_dwordx4 v[188:191], v18, s[4:7], s32 offen nt
    s_add_u32 s32, s32, 8192
    buffer_load_dwordx4 v[192:195], v18, s[4:7], s32 offen nt
    s_add_u32 s32, s32, 8192
    buffer_load_dwordx4 v[196:199], v18, s[4:7], s32 offen nt
    s_add_u32 s32, s32, 8192
    buffer_load_dwordx4 v[200:203], v18, s[4:7], s32 offen nt
    s_add_u32 s32, s32, 8192
    buffer_load_dwordx4 v[204:207], v18, s[4:7], s32 offen nt
    s_add_u32 s32, s32, 8192
    buffer_load_dwordx4 v[208:211], v18, s[4:7], s32 offen nt
    s_add_u32 s32, s32, 8192
    buffer_load_dwordx4 v[212:215], v18, s[4:7], s32 offen nt
    s_add_u32 s32, s32, 8192
    buffer_load_dwordx4 v[216:219], v18, s[4:7], s32 offen nt
    s_add_u32 s32, s32, 8192
    buffer_load_dwordx4 v[220:223], v18, s[4:7], s32 offen nt
    s_add_u32 s32, s32, 8192
    buffer_load_dwordx4 v[224:227], v18, s[4:7], s32 offen nt
    s_add_u32 s32, s32, 8192
    buffer_load_dwordx4 v[228:231], v18, s[4:7], s32 offen nt
    s_add_u32 s32, s32, 8192
    buffer_load_dwordx4 v[232:235], v18, s[4:7], s32 offen nt
    s_add_u32 s32, s32, 8192
    buffer_load_dwordx4 v[236:239], v18, s[4:7], s32 offen nt
    s_add_u32 s32, s32, 8192
    buffer_load_dwordx4 v[240:243], v18, s[4:7], s32 offen nt
    s_add_u32 s32, s32, 8192
    buffer_load_dwordx4 v[244:247], v18, s[4:7], s32 offen nt
    s_add_u32 s32, s32, 8192
    buffer_load_dwordx4 v[248:251], v18, s[4:7], s32 offen nt
    s_add_u32 s32, s32, 8192
    buffer_load_dwordx4 v[252:255], v18, s[4:7], s32 offen nt
    s_add_u32 s32, s32, 8192
    s_lshr_b32 s24, s74, 5
    s_lshl_b32 s24, s24, 5
    s_lshl_b32 s25, s3, 3
    s_add_u32 s24, s24, s25
    v_lshrrev_b32 v3, 3, v0
    v_add_u32 v17, s24, v3
    v_mul_u32_u24 v16, 0x3000, v17
    v_and_b32 v3, 7, v0
    v_lshl_add_u32 v16, v3, 4, v16
    s_and_b32 s24, s74, 31
    s_lshl_b32 s24, s24, 7
    s_add_u32 s24, s24, 0x170000
    v_add_u32 v16, s24, v16
    v_mov_b32 v8, -1
    v_mov_b32 v9, -1
    v_mov_b32 v10, -1
    v_mov_b32 v11, -1
    s_mov_b32 s24, 0
    buffer_store_dwordx4 v[8:11], v16, s[12:15], s24 offen sc1
    s_mov_b32 s24, 4096
    buffer_store_dwordx4 v[8:11], v16, s[12:15], s24 offen sc1
    s_mov_b32 s24, 8192
    buffer_store_dwordx4 v[8:11], v16, s[12:15], s24 offen sc1
    s_lshl_b32 s24, s74, 2
    s_add_u32 s24, s24, s3
    s_cmp_ge_u32 s24, 9
    s_cbranch_scc1 L_rs1
    s_lshl_b32 s24, s24, 10
    s_add_u32 s24, s24, 0x230000
    buffer_store_dwordx4 v[8:11], v2, s[12:15], s24 offen sc1
L_rs1:
    s_mov_b32 s4, s42
    s_mov_b32 s5, s43
    s_mov_b32 s6, 0x400000
    s_mov_b32 s7, 0x20000
    s_mov_b32 s32, s35
    v_and_b32 v3, 1, v0
    v_lshlrev_b32 v3, 4, v3
    v_mov_b32 v4, 0xffff
    v_lshlrev_b32 v4, v3, v4
    v_bfe_u32 v3, v0, 1, 2
    v_cmp_eq_u32 vcc, 0, v3
    s_nop 1
    v_cndmask_b32 v20, 0, v4, vcc
    v_cmp_eq_u32 vcc, 1, v3
    s_nop 1
    v_cndmask_b32 v21, 0, v4, vcc
    v_cmp_eq_u32 vcc, 2, v3
    s_nop 1
    v_cndmask_b32 v22, 0, v4, vcc
    v_cmp_eq_u32 vcc, 3, v3
    s_nop 1
    v_cndmask_b32 v23, 0, v4, vcc
    v_mov_b32 v3, 0x0c0c0c0c
    s_mov_b32 s24, 0x01000100
    s_mov_b32 s25, 0x03020302
    v_bfi_b32 v24, v20, s24, v3
    v_bfi_b32 v28, v20, s25, v3
    v_bfi_b32 v25, v21, s24, v3
    v_bfi_b32 v29, v21, s25, v3
    v_bfi_b32 v26, v22, s24, v3
    v_bfi_b32 v30, v22, s25, v3
    v_bfi_b32 v27, v23, s24, v3
    v_bfi_b32 v31, v23, s25, v3
    s_mov_b32 s64, 0x22222222
    s_mov_b32 s65, 0x22222222
    s_mov_b32 s66, 0x44444444
    s_mov_b32 s67, 0x44444444
    s_mov_b32 s68, 0x88888888
    s_mov_b32 s69, 0x88888888
    s_waitcnt vmcnt(32)
    v_perm_b32 v8, v32, v32, v24
    v_perm_b32 v9, v32, v32, v25
    v_perm_b32 v10, v32, v32, v26
    v_perm_b32 v11, v32, v32, v27
    s_waitcnt vmcnt(31)
    s_nop 0
    v_mfma_f32_16x16x32_bf16 v[12:15], v[128:131], v[8:11], 0
    v_perm_b32 v4, v48, v48, v24
    v_perm_b32 v5, v48, v48, v25
    v_perm_b32 v6, v48, v48, v26
    v_perm_b32 v7, v48, v48, v27
    s_nop 1
    v_mfma_f32_16x16x32_bf16 v[68:71], v[128:131], v[4:7], 0
    buffer_load_dwordx4 v[128:131], v64, s[4:7], s32 offen nt
    s_add_u32 s32, s32, 8192
    v_perm_b32 v8, v32, v32, v28
    v_perm_b32 v9, v32, v32, v29
    v_perm_b32 v10, v32, v32, v30
    v_perm_b32 v11, v32, v32, v31
    s_waitcnt vmcnt(31)
    s_nop 0
    v_mfma_f32_16x16x32_bf16 v[12:15], v[132:135], v[8:11], v[12:15]
    v_perm_b32 v4, v48, v48, v28
    v_perm_b32 v5, v48, v48, v29
    v_perm_b32 v6, v48, v48, v30
    v_perm_b32 v7, v48, v48, v31
    s_nop 1
    v_mfma_f32_16x16x32_bf16 v[68:71], v[132:135], v[4:7], v[68:71]
    buffer_load_dwordx4 v[132:135], v64, s[4:7], s32 offen nt
    s_add_u32 s32, s32, 8192
    v_perm_b32 v8, v33, v33, v24
    v_perm_b32 v9, v33, v33, v25
    v_perm_b32 v10, v33, v33, v26
    v_perm_b32 v11, v33, v33, v27
    s_waitcnt vmcnt(31)
    s_nop 0
    v_mfma_f32_16x16x32_bf16 v[12:15], v[136:139], v[8:11], v[12:15]
    v_perm_b32 v4, v49, v49, v24
    v_perm_b32 v5, v49, v49, v25
    v_perm_b32 v6, v49, v49, v26
    v_perm_b32 v7, v49, v49, v27
    s_nop 1
    v_mfma_f32_16x16x32_bf16 v[68:71], v[136:139], v[4:7], v[68:71]
    buffer_load_dwordx4 v[136:139], v64, s[4:7], s32 offen nt
    s_add_u32 s32, s32, 8192
    v_perm_b32 v8, v33, v33, v28
    v_perm_b32 v9, v33, v33, v29
    v_perm_b32 v10, v33, v33, v30
    v_perm_b32 v11, v33, v33, v31
    s_waitcnt vmcnt(31)
    s_nop 0
    v_mfma_f32_16x16x32_bf16 v[12:15], v[140:143], v[8:11], v[12:15]
    v_perm_b32 v4, v49, v49, v28
    v_perm_b32 v5, v49, v49, v29
    v_perm_b32 v6, v49, v49, v30
    v_perm_b32 v7, v49, v49, v31
    s_nop 1
    v_mfma_f32_16x16x32_bf16 v[68:71], v[140:143], v[4:7], v[68:71]
    buffer_load_dwordx4 v[140:143], v64, s[4:7], s32 offen nt
    s_add_u32 s32, s32, 8192
    v_perm_b32 v8, v34, v34, v24
    v_perm_b32 v9, v34, v34, v25
    v_perm_b32 v10, v34, v34, v26
    v_perm_b32 v11, v34, v34, v27
    s_waitcnt vmcnt(31)
    s_nop 0
    v_mfma_f32_16x16x32_bf16 v[12:15], v[144:147], v[8:11], v[12:15]
    v_perm_b32 v4, v50, v50, v24
    v_perm_b32 v5, v50, v50, v25
    v_perm_b32 v6, v50, v50, v26
    v_perm_b32 v7, v50, v50, v27
    s_nop 1
    v_mfma_f32_16x16x32_bf16 v[68:71], v[144:147], v[4:7], v[68:71]
    buffer_load_dwordx4 v[144:147], v64, s[4:7], s32 offen nt
    s_add_u32 s32, s32, 8192
    v_perm_b32 v8, v34, v34, v28
    v_perm_b32 v9, v34, v34, v29
    v_perm_b32 v10, v34, v34, v30
    v_perm_b32 v11, v34, v34, v31
    s_waitcnt vmcnt(31)
    s_nop 0
    v_mfma_f32_16x16x32_bf16 v[12:15], v[148:151], v[8:11], v[12:15]
    v_perm_b32 v4, v50, v50, v28
    v_perm_b32 v5, v50, v50, v29
    v_perm_b32 v6, v50, v50, v30
    v_perm_b32 v7, v50, v50, v31
    s_nop 1
    v_mfma_f32_16x16x32_bf16 v[68:71], v[148:151], v[4:7], v[68:71]
    buffer_load_dwordx4 v[148:151], v64, s[4:7], s32 offen nt
    s_add_u32 s32, s32, 8192
    v_perm_b32 v8, v35, v35, v24
    v_perm_b32 v9, v35, v35, v25
    v_perm_b32 v10, v35, v35, v26
    v_perm_b32 v11, v35, v35, v27
    s_waitcnt vmcnt(31)
    s_nop 0
    v_mfma_f32_16x16x32_bf16 v[12:15], v[152:155], v[8:11], v[12:15]
    v_perm_b32 v4, v51, v51, v24
    v_perm_b32 v5, v51, v51, v25
    v_perm_b32 v6, v51, v51, v26
    v_perm_b32 v7, v51, v51, v27
    s_nop 1
    v_mfma_f32_16x16x32_bf16 v[68:71], v[152:155], v[4:7], v[68:71]
    buffer_load_dwordx4 v[152:155], v64, s[4:7], s32 offen nt
    s_add_u32 s32, s32, 8192
    v_perm_b32 v8, v35, v35, v28
    v_perm_b32 v9, v35, v35, v29
    v_perm_b32 v10, v35, v35, v30
    v_perm_b32 v11, v35, v35, v31
    s_waitcnt vmcnt(31)
    s_nop 0
    v_mfma_f32_16x16x32_bf16 v[12:15], v[156:159], v[8:11], v[12:15]
    v_perm_b32 v4, v51, v51, v28
    v_perm_b32 v5, v51, v51, v29
    v_perm_b32 v6, v51, v51, v30
    v_perm_b32 v7, v51, v51, v31
    s_nop 1
    v_mfma_f32_16x16x32_bf16 v[68:71], v[156:159], v[4:7], v[68:71]
    buffer_load_dwordx4 v[156:159], v64, s[4:7], s32 offen nt
    s_add_u32 s32, s32, 8192
    v_perm_b32 v8, v36, v36, v24
    v_perm_b32 v9, v36, v36, v25
    v_perm_b32 v10, v36, v36, v26
    v_perm_b32 v11, v36, v36, v27
    s_waitcnt vmcnt(31)
    s_nop 0
    v_mfma_f32_16x16x32_bf16 v[12:15], v[160:163], v[8:11], v[12:15]
    v_perm_b32 v4, v52, v52, v24
    v_perm_b32 v5, v52, v52, v25
    v_perm_b32 v6, v52, v52, v26
    v_perm_b32 v7, v52, v52, v27
    s_nop 1
    v_mfma_f32_16x16x32_bf16 v[68:71], v[160:163], v[4:7], v[68:71]
    buffer_load_dwordx4 v[160:163], v64, s[4:7], s32 offen nt
    s_add_u32 s32, s32, 8192
    v_perm_b32 v8, v36, v36, v28
    v_perm_b32 v9, v36, v36, v29
    v_perm_b32 v10, v36, v36, v30
    v_perm_b32 v11, v36, v36, v31
    s_waitcnt vmcnt(31)
    s_nop 0
    v_mfma_f32_16x16x32_bf16 v[12:15], v[164:167], v[8:11], v[12:15]
    v_perm_b32 v4, v52, v52, v28
    v_perm_b32 v5, v52, v52, v29
    v_perm_b32 v6, v52, v52, v30
    v_perm_b32 v7, v52, v52, v31
    s_nop 1
    v_mfma_f32_16x16x32_bf16 v[68:71], v[164:167], v[4:7], v[68:71]
    buffer_load_dwordx4 v[164:167], v64, s[4:7], s32 offen nt
    s_add_u32 s32, s32, 8192
    v_perm_b32 v8, v37, v37, v24
    v_perm_b32 v9, v37, v37, v25
    v_perm_b32 v10, v37, v37, v26
    v_perm_b32 v11, v37, v37, v27
    s_waitcnt vmcnt(31)
    s_nop 0
    v_mfma_f32_16x16x32_bf16 v[12:15], v[168:171], v[8:11], v[12:15]
    v_perm_b32 v4, v53, v53, v24
    v_perm_b32 v5, v53, v53, v25
    v_perm_b32 v6, v53, v53, v26
    v_perm_b32 v7, v53, v53, v27
    s_nop 1
    v_mfma_f32_16x16x32_bf16 v[68:71], v[168:171], v[4:7], v[68:71]
    buffer_load_dwordx4 v[168:171], v64, s[4:7], s32 offen nt
    s_add_u32 s32, s32, 8192
    v_perm_b32 v8, v37, v37, v28
    v_perm_b32 v9, v37, v37, v29
    v_perm_b32 v10, v37, v37, v30
    v_perm_b32 v11, v37, v37, v31
    s_waitcnt vmcnt(31)
    s_nop 0
    v_mfma_f32_16x16x32_bf16 v[12:15], v[172:175], v[8:11], v[12:15]
    v_perm_b32 v4, v53, v53, v28
    v_perm_b32 v5, v53, v53, v29
    v_perm_b32 v6, v53, v53, v30
    v_perm_b32 v7, v53, v53, v31
    s_nop 1
    v_mfma_f32_16x16x32_bf16 v[68:71], v[172:175], v[4:7], v[68:71]
    buffer_load_dwordx4 v[172:175], v64, s[4:7], s32 offen nt
    s_add_u32 s32, s32, 8192
    v_perm_b32 v8, v38, v38, v24
    v_perm_b32 v9, v38, v38, v25
    v_perm_b32 v10, v38, v38, v26
    v_perm_b32 v11, v38, v38, v27
    s_waitcnt vmcnt(31)
    s_nop 0
    v_mfma_f32_16x16x32_bf16 v[12:15], v[176:179], v[8:11], v[12:15]
    v_perm_b32 v4, v54, v54, v24
    v_perm_b32 v5, v54, v54, v25
    v_perm_b32 v6, v54, v54, v26
    v_perm_b32 v7, v54, v54, v27
    s_nop 1
    v_mfma_f32_16x16x32_bf16 v[68:71], v[176:179], v[4:7], v[68:71]
    buffer_load_dwordx4 v[176:179], v64, s[4:7], s32 offen nt
    s_add_u32 s32, s32, 8192
    v_perm_b32 v8, v38, v38, v28
    v_perm_b32 v9, v38, v38, v29
    v_perm_b32 v10, v38, v38, v30
    v_perm_b32 v11, v38, v38, v31
    s_waitcnt vmcnt(31)
    s_nop 0
    v_mfma_f32_16x16x32_bf16 v[12:15], v[180:183], v[8:11], v[12:15]
    v_perm_b32 v4, v54, v54, v28
    v_perm_b32 v5, v54, v54, v29
    v_perm_b32 v6, v54, v54, v30
    v_perm_b32 v7, v54, v54, v31
    s_nop 1
    v_mfma_f32_16x16x32_bf16 v[68:71], v[180:183], v[4:7], v[68:71]
    buffer_load_dwordx4 v[180:183], v64, s[4:7], s32 offen nt
    s_add_u32 s32, s32, 8192
    v_perm_b32 v8, v39, v39, v24
    v_perm_b32 v9, v39, v39, v25
    v_perm_b32 v10, v39, v39, v26
    v_perm_b32 v11, v39, v39, v27
    s_waitcnt vmcnt(31)
    s_nop 0
    v_mfma_f32_16x16x32_bf16 v[12:15], v[184:187], v[8:11], v[12:15]
    v_perm_b32 v4, v55, v55, v24
    v_perm_b32 v5, v55, v55, v25
    v_perm_b32 v6, v55, v55, v26
    v_perm_b32 v7, v55, v55, v27
    s_nop 1
    v_mfma_f32_16x16x32_bf16 v[68:71], v[184:187], v[4:7], v[68:71]
    buffer_load_dwordx4 v[184:187], v64, s[4:7], s32 offen nt
    s_add_u32 s32, s32, 8192
    v_perm_b32 v8, v39, v39, v28
    v_perm_b32 v9, v39, v39, v29
    v_perm_b32 v10, v39, v39, v30
    v_perm_b32 v11, v39, v39, v31
    s_waitcnt vmcnt(31)
    s_nop 0
    v_mfma_f32_16x16x32_bf16 v[12:15], v[188:191], v[8:11], v[12:15]
    v_perm_b32 v4, v55, v55, v28
    v_perm_b32 v5, v55, v55, v29
    v_perm_b32 v6, v55, v55, v30
    v_perm_b32 v7, v55, v55, v31
    s_nop 1
    v_mfma_f32_16x16x32_bf16 v[68:71], v[188:191], v[4:7], v[68:71]
    buffer_load_dwordx4 v[188:191], v64, s[4:7], s32 offen nt
    s_add_u32 s32, s32, 8192
    v_perm_b32 v8, v40, v40, v24
    v_perm_b32 v9, v40, v40, v25
    v_perm_b32 v10, v40, v40, v26
    v_perm_b32 v11, v40, v40, v27
    s_waitcnt vmcnt(31)
    s_nop 0
    v_mfma_f32_16x16x32_bf16 v[12:15], v[192:195], v[8:11], v[12:15]
    v_perm_b32 v4, v56, v56, v24
    v_perm_b32 v5, v56, v56, v25
    v_perm_b32 v6, v56, v56, v26
    v_perm_b32 v7, v56, v56, v27
    s_nop 1
    v_mfma_f32_16x16x32_bf16 v[68:71], v[192:195], v[4:7], v[68:71]
    buffer_load_dwordx4 v[192:195], v64, s[4:7], s32 offen nt
    s_add_u32 s32, s32, 8192
    v_perm_b32 v8, v40, v40, v28
    v_perm_b32 v9, v40, v40, v29
    v_perm_b32 v10, v40, v40, v30
    v_perm_b32 v11, v40, v40, v31
    s_waitcnt vmcnt(31)
    s_nop 0
    v_mfma_f32_16x16x32_bf16 v[12:15], v[196:199], v[8:11], v[12:15]
    v_perm_b32 v4, v56, v56, v28
    v_perm_b32 v5, v56, v56, v29
    v_perm_b32 v6, v56, v56, v30
    v_perm_b32 v7, v56, v56, v31
    s_nop 1
    v_mfma_f32_16x16x32_bf16 v[68:71], v[196:199], v[4:7], v[68:71]
    buffer_load_dwordx4 v[196:199], v64, s[4:7], s32 offen nt
    s_add_u32 s32, s32, 8192
    v_perm_b32 v8, v41, v41, v24
    v_perm_b32 v9, v41, v41, v25
    v_perm_b32 v10, v41, v41, v26
    v_perm_b32 v11, v41, v41, v27
    s_waitcnt vmcnt(31)
    s_nop 0
    v_mfma_f32_16x16x32_bf16 v[12:15], v[200:203], v[8:11], v[12:15]
    v_perm_b32 v4, v57, v57, v24
    v_perm_b32 v5, v57, v57, v25
    v_perm_b32 v6, v57, v57, v26
    v_perm_b32 v7, v57, v57, v27
    s_nop 1
    v_mfma_f32_16x16x32_bf16 v[68:71], v[200:203], v[4:7], v[68:71]
    buffer_load_dwordx4 v[200:203], v64, s[4:7], s32 offen nt
    s_add_u32 s32, s32, 8192
    v_perm_b32 v8, v41, v41, v28
    v_perm_b32 v9, v41, v41, v29
    v_perm_b32 v10, v41, v41, v30
    v_perm_b32 v11, v41, v41, v31
    s_waitcnt vmcnt(31)
    s_nop 0
    v_mfma_f32_16x16x32_bf16 v[12:15], v[204:207], v[8:11], v[12:15]
    v_perm_b32 v4, v57, v57, v28
    v_perm_b32 v5, v57, v57, v29
    v_perm_b32 v6, v57, v57, v30
    v_perm_b32 v7, v57, v57, v31
    s_nop 1
    v_mfma_f32_16x16x32_bf16 v[68:71], v[204:207], v[4:7], v[68:71]
    buffer_load_dwordx4 v[204:207], v64, s[4:7], s32 offen nt
    s_add_u32 s32, s32, 8192
    v_perm_b32 v8, v42, v42, v24
    v_perm_b32 v9, v42, v42, v25
    v_perm_b32 v10, v42, v42, v26
    v_perm_b32 v11, v42, v42, v27
    s_waitcnt vmcnt(31)
    s_nop 0
    v_mfma_f32_16x16x32_bf16 v[12:15], v[208:211], v[8:11], v[12:15]
    v_perm_b32 v4, v58, v58, v24
    v_perm_b32 v5, v58, v58, v25
    v_perm_b32 v6, v58, v58, v26
    v_perm_b32 v7, v58, v58, v27
    s_nop 1
    v_mfma_f32_16x16x32_bf16 v[68:71], v[208:211], v[4:7], v[68:71]
    buffer_load_dwordx4 v[208:211], v64, s[4:7], s32 offen nt
    s_add_u32 s32, s32, 8192
    v_perm_b32 v8, v42, v42, v28
    v_perm_b32 v9, v42, v42, v29
    v_perm_b32 v10, v42, v42, v30
    v_perm_b32 v11, v42, v42, v31
    s_waitcnt vmcnt(31)
    s_nop 0
    v_mfma_f32_16x16x32_bf16 v[12:15], v[212:215], v[8:11], v[12:15]
    v_perm_b32 v4, v58, v58, v28
    v_perm_b32 v5, v58, v58, v29
    v_perm_b32 v6, v58, v58, v30
    v_perm_b32 v7, v58, v58, v31
    s_nop 1
    v_mfma_f32_16x16x32_bf16 v[68:71], v[212:215], v[4:7], v[68:71]
    buffer_load_dwordx4 v[212:215], v64, s[4:7], s32 offen nt
    s_add_u32 s32, s32, 8192
    v_perm_b32 v8, v43, v43, v24
    v_perm_b32 v9, v43, v43, v25
    v_perm_b32 v10, v43, v43, v26
    v_perm_b32 v11, v43, v43, v27
    s_waitcnt vmcnt(31)
    s_nop 0
    v_mfma_f32_16x16x32_bf16 v[12:15], v[216:219], v[8:11], v[12:15]
    v_perm_b32 v4, v59, v59, v24
    v_perm_b32 v5, v59, v59, v25
    v_perm_b32 v6, v59, v59, v26
    v_perm_b32 v7, v59, v59, v27
    s_nop 1
    v_mfma_f32_16x16x32_bf16 v[68:71], v[216:219], v[4:7], v[68:71]
    buffer_load_dwordx4 v[216:219], v64, s[4:7], s32 offen nt
    s_add_u32 s32, s32, 8192
    v_perm_b32 v8, v43, v43, v28
    v_perm_b32 v9, v43, v43, v29
    v_perm_b32 v10, v43, v43, v30
    v_perm_b32 v11, v43, v43, v31
    s_waitcnt vmcnt(31)
    s_nop 0
    v_mfma_f32_16x16x32_bf16 v[12:15], v[220:223], v[8:11], v[12:15]
    v_perm_b32 v4, v59, v59, v28
    v_perm_b32 v5, v59, v59, v29
    v_perm_b32 v6, v59, v59, v30
    v_perm_b32 v7, v59, v59, v31
    s_nop 1
    v_mfma_f32_16x16x32_bf16 v[68:71], v[220:223], v[4:7], v[68:71]
    buffer_load_dwordx4 v[220:223], v64, s[4:7], s32 offen nt
    s_add_u32 s32, s32, 8192
    v_perm_b32 v8, v44, v44, v24
    v_perm_b32 v9, v44, v44, v25
    v_perm_b32 v10, v44, v44, v26
    v_perm_b32 v11, v44, v44, v27
    s_waitcnt vmcnt(31)
    s_nop 0
    v_mfma_f32_16x16x32_bf16 v[12:15], v[224:227], v[8:11], v[12:15]
    v_perm_b32 v4, v60, v60, v24
    v_perm_b32 v5, v60, v60, v25
    v_perm_b32 v6, v60, v60, v26
    v_perm_b32 v7, v60, v60, v27
    s_nop 1
    v_mfma_f32_16x16x32_bf16 v[68:71], v[224:227], v[4:7], v[68:71]
    buffer_load_dwordx4 v[224:227], v64, s[4:7], s32 offen nt
    s_add_u32 s32, s32, 8192
    v_perm_b32 v8, v44, v44, v28
    v_perm_b32 v9, v44, v44, v29
    v_perm_b32 v10, v44, v44, v30
    v_perm_b32 v11, v44, v44, v31
    s_waitcnt vmcnt(31)
    s_nop 0
    v_mfma_f32_16x16x32_bf16 v[12:15], v[228:231], v[8:11], v[12:15]
    v_perm_b32 v4, v60, v60, v28
    v_perm_b32 v5, v60, v60, v29
    v_perm_b32 v6, v60, v60, v30
    v_perm_b32 v7, v60, v60, v31
    s_nop 1
    v_mfma_f32_16x16x32_bf16 v[68:71], v[228:231], v[4:7], v[68:71]
    buffer_load_dwordx4 v[228:231], v64, s[4:7], s32 offen nt
    s_add_u32 s32, s32, 8192
    v_perm_b32 v8, v45, v45, v24
    v_perm_b32 v9, v45, v45, v25
    v_perm_b32 v10, v45, v45, v26
    v_perm_b32 v11, v45, v45, v27
    s_waitcnt vmcnt(31)
    s_nop 0
    v_mfma_f32_16x16x32_bf16 v[12:15], v[232:235], v[8:11], v[12:15]
    v_perm_b32 v4, v61, v61, v24
    v_perm_b32 v5, v61, v61, v25
    v_perm_b32 v6, v61, v61, v26
    v_perm_b32 v7, v61, v61, v27
    s_nop 1
    v_mfma_f32_16x16x32_bf16 v[68:71], v[232:235], v[4:7], v[68:71]
    buffer_load_dwordx4 v[232:235], v64, s[4:7], s32 offen nt
    s_add_u32 s32, s32, 8192
    v_perm_b32 v8, v45, v45, v28
    v_perm_b32 v9, v45, v45, v29
    v_perm_b32 v10, v45, v45, v30
    v_perm_b32 v11, v45, v45, v31
    s_waitcnt vmcnt(31)
    s_nop 0
    v_mfma_f32_16x16x32_bf16 v[12:15], v[236:239], v[8:11], v[12:15]
    v_perm_b32 v4, v61, v61, v28
    v_perm_b32 v5, v61, v61, v29
    v_perm_b32 v6, v61, v61, v30
    v_perm_b32 v7, v61, v61, v31
    s_nop 1
    v_mfma_f32_16x16x32_bf16 v[68:71], v[236:239], v[4:7], v[68:71]
    buffer_load_dwordx4 v[236:239], v64, s[4:7], s32 offen nt
    s_add_u32 s32, s32, 8192
    v_perm_b32 v8, v46, v46, v24
    v_perm_b32 v9, v46, v46, v25
    v_perm_b32 v10, v46, v46, v26
    v_perm_b32 v11, v46, v46, v27
    s_waitcnt vmcnt(31)
    s_nop 0
    v_mfma_f32_16x16x32_bf16 v[12:15], v[240:243], v[8:11], v[12:15]
    v_perm_b32 v4, v62, v62, v24
    v_perm_b32 v5, v62, v62, v25
    v_perm_b32 v6, v62, v62, v26
    v_perm_b32 v7, v62, v62, v27
    s_nop 1
    v_mfma_f32_16x16x32_bf16 v[68:71], v[240:243], v[4:7], v[68:71]
    buffer_load_dwordx4 v[240:243], v64, s[4:7], s32 offen nt
    s_add_u32 s32, s32, 8192
    v_perm_b32 v8, v46, v46, v28
    v_perm_b32 v9, v46, v46, v29
    v_perm_b32 v10, v46, v46, v30
    v_perm_b32 v11, v46, v46, v31
    s_waitcnt vmcnt(31)
    s_nop 0
    v_mfma_f32_16x16x32_bf16 v[12:15], v[244:247], v[8:11], v[12:15]
    v_perm_b32 v4, v62, v62, v28
    v_perm_b32 v5, v62, v62, v29
    v_perm_b32 v6, v62, v62, v30
    v_perm_b32 v7, v62, v62, v31
    s_nop 1
    v_mfma_f32_16x16x32_bf16 v[68:71], v[244:247], v[4:7], v[68:71]
    buffer_load_dwordx4 v[244:247], v64, s[4:7], s32 offen nt
    s_add_u32 s32, s32, 8192
    v_perm_b32 v8, v47, v47, v24
    v_perm_b32 v9, v47, v47, v25
    v_perm_b32 v10, v47, v47, v26
    v_perm_b32 v11, v47, v47, v27
    s_waitcnt vmcnt(31)
    s_nop 0
    v_mfma_f32_16x16x32_bf16 v[12:15], v[248:251], v[8:11], v[12:15]
    v_perm_b32 v4, v63, v63, v24
    v_perm_b32 v5, v63, v63, v25
    v_perm_b32 v6, v63, v63, v26
    v_perm_b32 v7, v63, v63, v27
    s_nop 1
    v_mfma_f32_16x16x32_bf16 v[68:71], v[248:251], v[4:7], v[68:71]
    buffer_load_dwordx4 v[248:251], v64, s[4:7], s32 offen nt
    s_add_u32 s32, s32, 8192
    v_perm_b32 v8, v47, v47, v28
    v_perm_b32 v9, v47, v47, v29
    v_perm_b32 v10, v47, v47, v30
    v_perm_b32 v11, v47, v47, v31
    s_waitcnt vmcnt(31)
    s_nop 0
    v_mfma_f32_16x16x32_bf16 v[12:15], v[252:255], v[8:11], v[12:15]
    v_perm_b32 v4, v63, v63, v28
    v_perm_b32 v5, v63, v63, v29
    v_perm_b32 v6, v63, v63, v30
    v_perm_b32 v7, v63, v63, v31
    s_nop 1
    v_mfma_f32_16x16x32_bf16 v[68:71], v[252:255], v[4:7], v[68:71]
    buffer_load_dwordx4 v[252:255], v64, s[4:7], s32 offen nt
    s_add_u32 s32, s32, 8192
    v_lshrrev_b32 v3, 4, v0
    v_lshlrev_b32 v3, 7, v3
    v_and_b32 v4, 7, v0
    v_lshl_add_u32 v3, v4, 2, v3
    v_bfe_u32 v4, v0, 3, 1
    v_lshl_add_u32 v3, v4, 9, v3
    s_lshl_b32 s24, s3, 11
    s_add_u32 s24, s24, 135168
    v_add_u32 v3, s24, v3
    ds_write_b32 v3, v12 offset:0
    ds_write_b32 v3, v13 offset:32
    ds_write_b32 v3, v14 offset:64
    ds_write_b32 v3, v15 offset:96
    ds_write_b32 v3, v68 offset:1024
    ds_write_b32 v3, v69 offset:1056
    ds_write_b32 v3, v70 offset:1088
    ds_write_b32 v3, v71 offset:1120
    s_waitcnt lgkmcnt(0)
    s_barrier
    ds_read_b128 v[72:75], v65 offset:0
    ds_read_b128 v[76:79], v65 offset:16
    ds_read_b128 v[80:83], v65 offset:2048
    ds_read_b128 v[84:87], v65 offset:2064
    ds_read_b128 v[88:91], v65 offset:4096
    ds_read_b128 v[92:95], v65 offset:4112
    ds_read_b128 v[96:99], v65 offset:6144
    ds_read_b128 v[100:103], v65 offset:6160
    s_waitcnt lgkmcnt(4)
    v_add_f32 v72, v72, v80
    v_add_f32 v73, v73, v81
    v_add_f32 v74, v74, v82
    v_add_f32 v75, v75, v83
    v_add_f32 v76, v76, v84
    v_add_f32 v77, v77, v85
    v_add_f32 v78, v78, v86
    v_add_f32 v79, v79, v87
    s_waitcnt lgkmcnt(2)
    v_add_f32 v72, v72, v88
    v_add_f32 v73, v73, v89
    v_add_f32 v74, v74, v90
    v_add_f32 v75, v75, v91
    v_add_f32 v76, v76, v92
    v_add_f32 v77, v77, v93
    v_add_f32 v78, v78, v94
    v_add_f32 v79, v79, v95
    s_waitcnt lgkmcnt(0)
    v_add_f32 v72, v72, v96
    v_add_f32 v73, v73, v97
    v_add_f32 v74, v74, v98
    v_add_f32 v75, v75, v99
    v_add_f32 v76, v76, v100
    v_add_f32 v77, v77, v101
    v_add_f32 v78, v78, v102
    v_add_f32 v79, v79, v103
    v_cvt_pk_bf16_f32 v8, v72, v73
    v_cvt_pk_bf16_f32 v9, v74, v75
    v_cvt_pk_bf16_f32 v10, v76, v77
    v_cvt_pk_bf16_f32 v11, v78, v79
    s_waitcnt vmcnt(31)
    s_nop 0
    v_mfma_f32_16x16x32_bf16 v[68:71], v[128:131], v[8:11], 0
    s_nop 7
    v_add_f32_dpp v72, v69, v68 quad_perm:[1,1,1,1] row_mask:0xf bank_mask:0xf
    s_nop 1
    v_add_f32_dpp v72, v70, v72 quad_perm:[2,2,2,2] row_mask:0xf bank_mask:0xf
    s_nop 1
    v_add_f32_dpp v72, v71, v72 quad_perm:[3,3,3,3] row_mask:0xf bank_mask:0xf
    s_waitcnt vmcnt(30)
    v_mfma_f32_16x16x32_bf16 v[12:15], v[132:135], v[8:11], 0
    s_nop 7
    v_add_f32_dpp v73, v13, v12 quad_perm:[1,1,1,1] row_mask:0xf bank_mask:0xf
    s_nop 1
    v_add_f32_dpp v73, v14, v73 quad_perm:[2,2,2,2] row_mask:0xf bank_mask:0xf
    s_nop 1
    v_add_f32_dpp v73, v15, v73 quad_perm:[3,3,3,3] row_mask:0xf bank_mask:0xf
    s_waitcnt vmcnt(29)
    v_mfma_f32_16x16x32_bf16 v[68:71], v[136:139], v[8:11], 0
    s_nop 7
    v_add_f32_dpp v74, v69, v68 quad_perm:[1,1,1,1] row_mask:0xf bank_mask:0xf
    s_nop 1
    v_add_f32_dpp v74, v70, v74 quad_perm:[2,2,2,2] row_mask:0xf bank_mask:0xf
    s_nop 1
    v_add_f32_dpp v74, v71, v74 quad_perm:[3,3,3,3] row_mask:0xf bank_mask:0xf
    s_waitcnt vmcnt(28)
    v_mfma_f32_16x16x32_bf16 v[12:15], v[140:143], v[8:11], 0
    s_nop 7
    v_add_f32_dpp v75, v13, v12 quad_perm:[1,1,1,1] row_mask:0xf bank_mask:0xf
    s_nop 1
    v_add_f32_dpp v75, v14, v75 quad_perm:[2,2,2,2] row_mask:0xf bank_mask:0xf
    s_nop 1
    v_add_f32_dpp v75, v15, v75 quad_perm:[3,3,3,3] row_mask:0xf bank_mask:0xf
    s_waitcnt vmcnt(27)
    v_mfma_f32_16x16x32_bf16 v[68:71], v[144:147], v[8:11], 0
    s_nop 7
    v_add_f32_dpp v76, v69, v68 quad_perm:[1,1,1,1] row_mask:0xf bank_mask:0xf
    s_nop 1
    v_add_f32_dpp v76, v70, v76 quad_perm:[2,2,2,2] row_mask:0xf bank_mask:0xf
    s_nop 1
    v_add_f32_dpp v76, v71, v76 quad_perm:[3,3,3,3] row_mask:0xf bank_mask:0xf
    s_waitcnt vmcnt(26)
    v_mfma_f32_16x16x32_bf16 v[12:15], v[148:151], v[8:11], 0
    s_nop 7
    v_add_f32_dpp v77, v13, v12 quad_perm:[1,1,1,1] row_mask:0xf bank_mask:0xf
    s_nop 1
    v_add_f32_dpp v77, v14, v77 quad_perm:[2,2,2,2] row_mask:0xf bank_mask:0xf
    s_nop 1
    v_add_f32_dpp v77, v15, v77 quad_perm:[3,3,3,3] row_mask:0xf bank_mask:0xf
    s_waitcnt vmcnt(25)
    v_mfma_f32_16x16x32_bf16 v[68:71], v[152:155], v[8:11], 0
    s_nop 7
    v_add_f32_dpp v78, v69, v68 quad_perm:[1,1,1,1] row_mask:0xf bank_mask:0xf
    s_nop 1
    v_add_f32_dpp v78, v70, v78 quad_perm:[2,2,2,2] row_mask:0xf bank_mask:0xf
    s_nop 1
    v_add_f32_dpp v78, v71, v78 quad_perm:[3,3,3,3] row_mask:0xf bank_mask:0xf
    s_waitcnt vmcnt(24)
    v_mfma_f32_16x16x32_bf16 v[12:15], v[156:159], v[8:11], 0
    s_nop 7
    v_add_f32_dpp v79, v13, v12 quad_perm:[1,1,1,1] row_mask:0xf bank_mask:0xf
    s_nop 1
    v_add_f32_dpp v79, v14, v79 quad_perm:[2,2,2,2] row_mask:0xf bank_mask:0xf
    s_nop 1
    v_add_f32_dpp v79, v15, v79 quad_perm:[3,3,3,3] row_mask:0xf bank_mask:0xf
    s_waitcnt vmcnt(23)
    v_mfma_f32_16x16x32_bf16 v[68:71], v[160:163], v[8:11], 0
    s_nop 7
    v_add_f32_dpp v3, v68, v69 quad_perm:[0,0,0,0] row_mask:0xf bank_mask:0xf
    s_nop 1
    v_add_f32_dpp v3, v70, v3 quad_perm:[2,2,2,2] row_mask:0xf bank_mask:0xf
    s_nop 1
    v_add_f32_dpp v3, v71, v3 quad_perm:[3,3,3,3] row_mask:0xf bank_mask:0xf
    v_cndmask_b32 v72, v72, v3, s[64:65]
    s_waitcnt vmcnt(22)
    v_mfma_f32_16x16x32_bf16 v[12:15], v[164:167], v[8:11], 0
    s_nop 7
    v_add_f32_dpp v3, v12, v13 quad_perm:[0,0,0,0] row_mask:0xf bank_mask:0xf
    s_nop 1
    v_add_f32_dpp v3, v14, v3 quad_perm:[2,2,2,2] row_mask:0xf bank_mask:0xf
    s_nop 1
    v_add_f32_dpp v3, v15, v3 quad_perm:[3,3,3,3] row_mask:0xf bank_mask:0xf
    v_cndmask_b32 v73, v73, v3, s[64:65]
    s_waitcnt vmcnt(21)
    v_mfma_f32_16x16x32_bf16 v[68:71], v[168:171], v[8:11], 0
    s_nop 7
    v_add_f32_dpp v3, v68, v69 quad_perm:[0,0,0,0] row_mask:0xf bank_mask:0xf
    s_nop 1
    v_add_f32_dpp v3, v70, v3 quad_perm:[2,2,2,2] row_mask:0xf bank_mask:0xf
    s_nop 1
    v_add_f32_dpp v3, v71, v3 quad_perm:[3,3,3,3] row_mask:0xf bank_mask:0xf
    v_cndmask_b32 v74, v74, v3, s[64:65]
    s_waitcnt vmcnt(20)
    v_mfma_f32_16x16x32_bf16 v[12:15], v[172:175], v[8:11], 0
    s_nop 7
    v_add_f32_dpp v3, v12, v13 quad_perm:[0,0,0,0] row_mask:0xf bank_mask:0xf
    s_nop 1
    v_add_f32_dpp v3, v14, v3 quad_perm:[2,2,2,2] row_mask:0xf bank_mask:0xf
    s_nop 1
    v_add_f32_dpp v3, v15, v3 quad_perm:[3,3,3,3] row_mask:0xf bank_mask:0xf
    v_cndmask_b32 v75, v75, v3, s[64:65]
    s_waitcnt vmcnt(19)
    v_mfma_f32_16x16x32_bf16 v[68:71], v[176:179], v[8:11], 0
    s_nop 7
    v_add_f32_dpp v3, v68, v69 quad_perm:[0,0,0,0] row_mask:0xf bank_mask:0xf
    s_nop 1
    v_add_f32_dpp v3, v70, v3 quad_perm:[2,2,2,2] row_mask:0xf bank_mask:0xf
    s_nop 1
    v_add_f32_dpp v3, v71, v3 quad_perm:[3,3,3,3] row_mask:0xf bank_mask:0xf
    v_cndmask_b32 v76, v76, v3, s[64:65]
    s_waitcnt vmcnt(18)
    v_mfma_f32_16x16x32_bf16 v[12:15], v[180:183], v[8:11], 0
    s_nop 7
    v_add_f32_dpp v3, v12, v13 quad_perm:[0,0,0,0] row_mask:0xf bank_mask:0xf
    s_nop 1
    v_add_f32_dpp v3, v14, v3 quad_perm:[2,2,2,2] row_mask:0xf bank_mask:0xf
    s_nop 1
    v_add_f32_dpp v3, v15, v3 quad_perm:[3,3,3,3] row_mask:0xf bank_mask:0xf
    v_cndmask_b32 v77, v77, v3, s[64:65]
    s_waitcnt vmcnt(17)
    v_mfma_f32_16x16x32_bf16 v[68:71], v[184:187], v[8:11], 0
    s_nop 7
    v_add_f32_dpp v3, v68, v69 quad_perm:[0,0,0,0] row_mask:0xf bank_mask:0xf
    s_nop 1
    v_add_f32_dpp v3, v70, v3 quad_perm:[2,2,2,2] row_mask:0xf bank_mask:0xf
    s_nop 1
    v_add_f32_dpp v3, v71, v3 quad_perm:[3,3,3,3] row_mask:0xf bank_mask:0xf
    v_cndmask_b32 v78, v78, v3, s[64:65]
    s_waitcnt vmcnt(16)
    v_mfma_f32_16x16x32_bf16 v[12:15], v[188:191], v[8:11], 0
    s_nop 7
    v_add_f32_dpp v3, v12, v13 quad_perm:[0,0,0,0] row_mask:0xf bank_mask:0xf
    s_nop 1
    v_add_f32_dpp v3, v14, v3 quad_perm:[2,2,2,2] row_mask:0xf bank_mask:0xf
    s_nop 1
    v_add_f32_dpp v3, v15, v3 quad_perm:[3,3,3,3] row_mask:0xf bank_mask:0xf
    v_cndmask_b32 v79, v79, v3, s[64:65]
    s_waitcnt vmcnt(15)
    v_mfma_f32_16x16x32_bf16 v[68:71], v[192:195], v[8:11], 0
    s_nop 7
    v_add_f32_dpp v3, v68, v70 quad_perm:[0,0,0,0] row_mask:0xf bank_mask:0xf
    s_nop 1
    v_add_f32_dpp v3, v69, v3 quad_perm:[1,1,1,1] row_mask:0xf bank_mask:0xf
    s_nop 1
    v_add_f32_dpp v3, v71, v3 quad_perm:[3,3,3,3] row_mask:0xf bank_mask:0xf
    v_cndmask_b32 v72, v72, v3, s[66:67]
    s_waitcnt vmcnt(14)
    v_mfma_f32_16x16x32_bf16 v[12:15], v[196:199], v[8:11], 0
    s_nop 7
    v_add_f32_dpp v3, v12, v14 quad_perm:[0,0,0,0] row_mask:0xf bank_mask:0xf
    s_nop 1
    v_add_f32_dpp v3, v13, v3 quad_perm:[1,1,1,1] row_mask:0xf bank_mask:0xf
    s_nop 1
    v_add_f32_dpp v3, v15, v3 quad_perm:[3,3,3,3] row_mask:0xf bank_mask:0xf
    v_cndmask_b32 v73, v73, v3, s[66:67]
    s_waitcnt vmcnt(13)
    v_mfma_f32_16x16x32_bf16 v[68:71], v[200:203], v[8:11], 0
    s_nop 7
    v_add_f32_dpp v3, v68, v70 quad_perm:[0,0,0,0] row_mask:0xf bank_mask:0xf
    s_nop 1
    v_add_f32_dpp v3, v69, v3 quad_perm:[1,1,1,1] row_mask:0xf bank_mask:0xf
    s_nop 1
    v_add_f32_dpp v3, v71, v3 quad_perm:[3,3,3,3] row_mask:0xf bank_mask:0xf
    v_cndmask_b32 v74, v74, v3, s[66:67]
    s_waitcnt vmcnt(12)
    v_mfma_f32_16x16x32_bf16 v[12:15], v[204:207], v[8:11], 0
    s_nop 7
    v_add_f32_dpp v3, v12, v14 quad_perm:[0,0,0,0] row_mask:0xf bank_mask:0xf
    s_nop 1
    v_add_f32_dpp v3, v13, v3 quad_perm:[1,1,1,1] row_mask:0xf bank_mask:0xf
    s_nop 1
    v_add_f32_dpp v3, v15, v3 quad_perm:[3,3,3,3] row_mask:0xf bank_mask:0xf
    v_cndmask_b32 v75, v75, v3, s[66:67]
    s_waitcnt vmcnt(11)
    v_mfma_f32_16x16x32_bf16 v[68:71], v[208:211], v[8:11], 0
    s_nop 7
    v_add_f32_dpp v3, v68, v70 quad_perm:[0,0,0,0] row_mask:0xf bank_mask:0xf
    s_nop 1
    v_add_f32_dpp v3, v69, v3 quad_perm:[1,1,1,1] row_mask:0xf bank_mask:0xf
    s_nop 1
    v_add_f32_dpp v3, v71, v3 quad_perm:[3,3,3,3] row_mask:0xf bank_mask:0xf
    v_cndmask_b32 v76, v76, v3, s[66:67]
    s_waitcnt vmcnt(10)
    v_mfma_f32_16x16x32_bf16 v[12:15], v[212:215], v[8:11], 0
    s_nop 7
    v_add_f32_dpp v3, v12, v14 quad_perm:[0,0,0,0] row_mask:0xf bank_mask:0xf
    s_nop 1
    v_add_f32_dpp v3, v13, v3 quad_perm:[1,1,1,1] row_mask:0xf bank_mask:0xf
    s_nop 1
    v_add_f32_dpp v3, v15, v3 quad_perm:[3,3,3,3] row_mask:0xf bank_mask:0xf
    v_cndmask_b32 v77, v77, v3, s[66:67]
    s_waitcnt vmcnt(9)
    v_mfma_f32_16x16x32_bf16 v[68:71], v[216:219], v[8:11], 0
    s_nop 7
    v_add_f32_dpp v3, v68, v70 quad_perm:[0,0,0,0] row_mask:0xf bank_mask:0xf
    s_nop 1
    v_add_f32_dpp v3, v69, v3 quad_perm:[1,1,1,1] row_mask:0xf bank_mask:0xf
    s_nop 1
    v_add_f32_dpp v3, v71, v3 quad_perm:[3,3,3,3] row_mask:0xf bank_mask:0xf
    v_cndmask_b32 v78, v78, v3, s[66:67]
    s_waitcnt vmcnt(8)
    v_mfma_f32_16x16x32_bf16 v[12:15], v[220:223], v[8:11], 0
    s_nop 7
    v_add_f32_dpp v3, v12, v14 quad_perm:[0,0,0,0] row_mask:0xf bank_mask:0xf
    s_nop 1
    v_add_f32_dpp v3, v13, v3 quad_perm:[1,1,1,1] row_mask:0xf bank_mask:0xf
    s_nop 1
    v_add_f32_dpp v3, v15, v3 quad_perm:[3,3,3,3] row_mask:0xf bank_mask:0xf
    v_cndmask_b32 v79, v79, v3, s[66:67]
    s_waitcnt vmcnt(7)
    v_mfma_f32_16x16x32_bf16 v[68:71], v[224:227], v[8:11], 0
    s_nop 7
    v_add_f32_dpp v3, v68, v71 quad_perm:[0,0,0,0] row_mask:0xf bank_mask:0xf
    s_nop 1
    v_add_f32_dpp v3, v69, v3 quad_perm:[1,1,1,1] row_mask:0xf bank_mask:0xf
    s_nop 1
    v_add_f32_dpp v3, v70, v3 quad_perm:[2,2,2,2] row_mask:0xf bank_mask:0xf
    v_cndmask_b32 v72, v72, v3, s[68:69]
    s_waitcnt vmcnt(6)
    v_mfma_f32_16x16x32_bf16 v[12:15], v[228:231], v[8:11], 0
    s_nop 7
    v_add_f32_dpp v3, v12, v15 quad_perm:[0,0,0,0] row_mask:0xf bank_mask:0xf
    s_nop 1
    v_add_f32_dpp v3, v13, v3 quad_perm:[1,1,1,1] row_mask:0xf bank_mask:0xf
    s_nop 1
    v_add_f32_dpp v3, v14, v3 quad_perm:[2,2,2,2] row_mask:0xf bank_mask:0xf
    v_cndmask_b32 v73, v73, v3, s[68:69]
    s_waitcnt vmcnt(5)
    v_mfma_f32_16x16x32_bf16 v[68:71], v[232:235], v[8:11], 0
    s_nop 7
    v_add_f32_dpp v3, v68, v71 quad_perm:[0,0,0,0] row_mask:0xf bank_mask:0xf
    s_nop 1
    v_add_f32_dpp v3, v69, v3 quad_perm:[1,1,1,1] row_mask:0xf bank_mask:0xf
    s_nop 1
    v_add_f32_dpp v3, v70, v3 quad_perm:[2,2,2,2] row_mask:0xf bank_mask:0xf
    v_cndmask_b32 v74, v74, v3, s[68:69]
    s_waitcnt vmcnt(4)
    v_mfma_f32_16x16x32_bf16 v[12:15], v[236:239], v[8:11], 0
    s_nop 7
    v_add_f32_dpp v3, v12, v15 quad_perm:[0,0,0,0] row_mask:0xf bank_mask:0xf
    s_nop 1
    v_add_f32_dpp v3, v13, v3 quad_perm:[1,1,1,1] row_mask:0xf bank_mask:0xf
    s_nop 1
    v_add_f32_dpp v3, v14, v3 quad_perm:[2,2,2,2] row_mask:0xf bank_mask:0xf
    v_cndmask_b32 v75, v75, v3, s[68:69]
    s_waitcnt vmcnt(3)
    v_mfma_f32_16x16x32_bf16 v[68:71], v[240:243], v[8:11], 0
    s_nop 7
    v_add_f32_dpp v3, v68, v71 quad_perm:[0,0,0,0] row_mask:0xf bank_mask:0xf
    s_nop 1
    v_add_f32_dpp v3, v69, v3 quad_perm:[1,1,1,1] row_mask:0xf bank_mask:0xf
    s_nop 1
    v_add_f32_dpp v3, v70, v3 quad_perm:[2,2,2,2] row_mask:0xf bank_mask:0xf
    v_cndmask_b32 v76, v76, v3, s[68:69]
    s_waitcnt vmcnt(2)
    v_mfma_f32_16x16x32_bf16 v[12:15], v[244:247], v[8:11], 0
    s_nop 7
    v_add_f32_dpp v3, v12, v15 quad_perm:[0,0,0,0] row_mask:0xf bank_mask:0xf
    s_nop 1
    v_add_f32_dpp v3, v13, v3 quad_perm:[1,1,1,1] row_mask:0xf bank_mask:0xf
    s_nop 1
    v_add_f32_dpp v3, v14, v3 quad_perm:[2,2,2,2] row_mask:0xf bank_mask:0xf
    v_cndmask_b32 v77, v77, v3, s[68:69]
    s_waitcnt vmcnt(1)
    v_mfma_f32_16x16x32_bf16 v[68:71], v[248:251], v[8:11], 0
    s_nop 7
    v_add_f32_dpp v3, v68, v71 quad_perm:[0,0,0,0] row_mask:0xf bank_mask:0xf
    s_nop 1
    v_add_f32_dpp v3, v69, v3 quad_perm:[1,1,1,1] row_mask:0xf bank_mask:0xf
    s_nop 1
    v_add_f32_dpp v3, v70, v3 quad_perm:[2,2,2,2] row_mask:0xf bank_mask:0xf
    v_cndmask_b32 v78, v78, v3, s[68:69]
    s_waitcnt vmcnt(0)
    v_mfma_f32_16x16x32_bf16 v[12:15], v[252:255], v[8:11], 0
    s_nop 7
    v_add_f32_dpp v3, v12, v15 quad_perm:[0,0,0,0] row_mask:0xf bank_mask:0xf
    s_nop 1
    v_add_f32_dpp v3, v13, v3 quad_perm:[1,1,1,1] row_mask:0xf bank_mask:0xf
    s_nop 1
    v_add_f32_dpp v3, v14, v3 quad_perm:[2,2,2,2] row_mask:0xf bank_mask:0xf
    v_cndmask_b32 v79, v79, v3, s[68:69]
    s_mov_b32 s71, 0x3e0293ee
    v_mul_f32 v72, s71, v72
    v_mul_f32 v73, s71, v73
    v_mul_f32 v74, s71, v74
    v_mul_f32 v75, s71, v75
    v_mul_f32 v76, s71, v76
    v_mul_f32 v77, s71, v77
    v_mul_f32 v78, s71, v78
    v_mul_f32 v79, s71, v79
    v_cvt_pk_bf16_f32 v4, v72, v73
    v_cvt_pk_bf16_f32 v5, v74, v75
    v_cvt_pk_bf16_f32 v6, v76, v77
    v_cvt_pk_bf16_f32 v7, v78, v79
    s_lshl_b32 s24, s26, 10
    s_lshl_b32 s25, s3, 8
    s_add_u32 s24, s24, s25
    s_add_u32 s24, s24, 0x0
    buffer_store_dwordx4 v[4:7], v66, s[12:15], s24 offen sc1
    s_waitcnt vmcnt(0)
    s_barrier
    s_cmp_lg_u32 s3, 0
    s_cbranch_scc1 L_sig2
    s_mov_b64 exec, 1
    v_mov_b32 v1, 1
    buffer_atomic_add v1, off, s[16:19], 0 offset:64
    s_mov_b64 exec, -1
L_sig2:
    s_cmp_lg_u32 s3, 0
    s_cbranch_scc1 L_cs3
    s_mov_b64 exec, 1
    v_mov_b32 v3, 1
    buffer_atomic_add v3, off, s[16:19], 0 offset:0
    s_mov_b64 exec, -1
L_cs3:
    s_mov_b32 s4, s44
    s_mov_b32 s5, s45
    s_mov_b32 s6, 0x400000
    s_mov_b32 s7, 0x20000
    s_mov_b32 s8, s46
    s_mov_b32 s9, s47
    s_mov_b32 s10, 0x400000
    s_mov_b32 s11, 0x20000
    s_mov_b32 s32, s35
    buffer_load_dwordx4 v[128:131], v18, s[4:7], s32 offen nt
    s_add_u32 s32, s32, 8192
    buffer_load_dwordx4 v[132:135], v18, s[4:7], s32 offen nt
    s_add_u32 s32, s32, 8192
    buffer_load_dwordx4 v[136:139], v18, s[4:7], s32 offen nt
    s_add_u32 s32, s32, 8192
    buffer_load_dwordx4 v[140:143], v18, s[4:7], s32 offen nt
    s_add_u32 s32, s32, 8192
    buffer_load_dwordx4 v[144:147], v18, s[4:7], s32 offen nt
    s_add_u32 s32, s32, 8192
    buffer_load_dwordx4 v[148:151], v18, s[4:7], s32 offen nt
    s_add_u32 s32, s32, 8192
    buffer_load_dwordx4 v[152:155], v18, s[4:7], s32 offen nt
    s_add_u32 s32, s32, 8192
    buffer_load_dwordx4 v[156:159], v18, s[4:7], s32 offen nt
    s_add_u32 s32, s32, 8192
    buffer_load_dwordx4 v[160:163], v18, s[4:7], s32 offen nt
    s_add_u32 s32, s32, 8192
    buffer_load_dwordx4 v[164:167], v18, s[4:7], s32 offen nt
    s_add_u32 s32, s32, 8192
    buffer_load_dwordx4 v[168:171], v18, s[4:7], s32 offen nt
    s_add_u32 s32, s32, 8192
    buffer_load_dwordx4 v[172:175], v18, s[4:7], s32 offen nt
    s_add_u32 s32, s32, 8192
    buffer_load_dwordx4 v[176:179], v18, s[4:7], s32 offen nt
    s_add_u32 s32, s32, 8192
    buffer_load_dwordx4 v[180:183], v18, s[4:7], s32 offen nt
    s_add_u32 s32, s32, 8192
    buffer_load_dwordx4 v[184:187], v18, s[4:7], s32 offen nt
    s_add_u32 s32, s32, 8192
    buffer_load_dwordx4 v[188:191], v18, s[4:7], s32 offen nt
    s_add_u32 s32, s32, 8192
    buffer_load_dwordx4 v[192:195], v18, s[4:7], s32 offen nt
    s_add_u32 s32, s32, 8192
    buffer_load_dwordx4 v[196:199], v18, s[4:7], s32 offen nt
    s_add_u32 s32, s32, 8192
    buffer_load_dwordx4 v[200:203], v18, s[4:7], s32 offen nt
    s_add_u32 s32, s32, 8192
    buffer_load_dwordx4 v[204:207], v18, s[4:7], s32 offen nt
    s_add_u32 s32, s32, 8192
    buffer_load_dwordx4 v[208:211], v18, s[4:7], s32 offen nt
    s_add_u32 s32, s32, 8192
    buffer_load_dwordx4 v[212:215], v18, s[4:7], s32 offen nt
    s_add_u32 s32, s32, 8192
    buffer_load_dwordx4 v[216:219], v18, s[4:7], s32 offen nt
    s_add_u32 s32, s32, 8192
    buffer_load_dwordx4 v[220:223], v18, s[4:7], s32 offen nt
    s_add_u32 s32, s32, 8192
    buffer_load_dwordx4 v[224:227], v18, s[4:7], s32 offen nt
    s_add_u32 s32, s32, 8192
    buffer_load_dwordx4 v[228:231], v18, s[4:7], s32 offen nt
    s_add_u32 s32, s32, 8192
    buffer_load_dwordx4 v[232:235], v18, s[4:7], s32 offen nt
    s_add_u32 s32, s32, 8192
    buffer_load_dwordx4 v[236:239], v18, s[4:7], s32 offen nt
    s_add_u32 s32, s32, 8192
    buffer_load_dwordx4 v[240:243], v18, s[4:7], s32 offen nt
    s_add_u32 s32, s32, 8192
    buffer_load_dwordx4 v[244:247], v18, s[4:7], s32 offen nt
    s_add_u32 s32, s32, 8192
    buffer_load_dwordx4 v[248:251], v18, s[4:7], s32 offen nt
    s_add_u32 s32, s32, 8192
    buffer_load_dwordx4 v[252:255], v18, s[4:7], s32 offen nt
    s_add_u32 s32, s32, 8192
    s_lshl_b32 s33, s26, 17
    s_lshl_b32 s24, s3, 15
    s_add_u32 s33, s33, s24
    s_mul_i32 s34, s3, 33792
    s_mov_b32 s70, 0
L_W_wo:
    s_waitcnt vmcnt(24)
    s_and_b32 s24, s70, 3
    s_lshl_b32 s24, s24, 1
    s_lshr_b32 s25, s70, 2
    s_or_b32 s24, s24, s25
    s_lshl_b32 s24, s24, 10
    s_add_u32 s24, s24, s33
    s_mul_i32 s25, s70, 4224
    s_add_u32 m0, s25, s34
    s_nop 0
    buffer_load_dwordx4 v2, s[8:11], s24 offen nt lds
    s_add_u32 s24, s24, 8192
    s_add_u32 m0, m0, 1056
    s_nop 0
    buffer_load_dwordx4 v2, s[8:11], s24 offen nt lds
    s_add_u32 s24, s24, 8192
    s_add_u32 m0, m0, 1056
    s_nop 0
    buffer_load_dwordx4 v2, s[8:11], s24 offen nt lds
    s_add_u32 s24, s24, 8192
    s_add_u32 m0, m0, 1056
    s_nop 0
    buffer_load_dwordx4 v2, s[8:11], s24 offen nt lds
    s_add_u32 s70, s70, 1
    s_cmp_lt_u32 s70, 8
    s_cbranch_scc1 L_W_wo
    s_waitcnt vmcnt(0)
    s_cmp_lg_u32 s3, 0
    s_cbranch_scc1 L_aw4_x
    s_mov_b32 s24, 262144
L_aw4:
    buffer_load_dword v1, off, s[16:19], 0 offset:128 sc1
    s_waitcnt vmcnt(0)
    v_readfirstlane_b32 s25, v1
    s_nop 0
    s_cmp_ge_u32 s25, 32
    s_cbranch_scc1 L_aw4_x
    s_sleep 16
    s_sub_u32 s24, s24, 1
    s_cmp_lg_u32 s24, 0
    s_cbranch_scc1 L_aw4
L_aw4_x:
    s_barrier
    s_lshl_b32 s24, s26, 2
    s_add_u32 s24, s24, s3
    s_lshl_b32 s25, s24, 6
    s_add_u32 s25, s25, 0x120000
    v_and_b32 v3, 7, v0
    v_lshlrev_b32 v3, 3, v3
    buffer_load_dwordx2 v[4:5], v3, s[12:15], s25 offen sc1
    s_lshl_b32 s24, s24, 13
    s_add_u32 s24, s24, 0x20000
    buffer_load_dwordx4 v[72:75], v2, s[12:15], s24 offen offset:0 sc1
    buffer_load_dwordx4 v[76:79], v2, s[12:15], s24 offen offset:1024 sc1
    buffer_load_dwordx4 v[80:83], v2, s[12:15], s24 offen offset:2048 sc1
    buffer_load_dwordx4 v[84:87], v2, s[12:15], s24 offen offset:3072 sc1
    s_add_u32 s24, s24, 4096
    buffer_load_dwordx4 v[88:91], v2, s[12:15], s24 offen offset:0 sc1
    buffer_load_dwordx4 v[92:95], v2, s[12:15], s24 offen offset:1024 sc1
    buffer_load_dwordx4 v[96:99], v2, s[12:15], s24 offen offset:2048 sc1
    buffer_load_dwordx4 v[100:103], v2, s[12:15], s24 offen offset:3072 sc1
    s_waitcnt vmcnt(8)
    v_mov_b32 v6, v4
    s_nop 1
    v_max_f32_dpp v6, v6, v6 row_ror:4 row_mask:0xf bank_mask:0xf
    s_nop 1
    v_max_f32_dpp v6, v6, v6 row_ror:2 row_mask:0xf bank_mask:0xf
    s_nop 1
    v_max_f32_dpp v6, v6, v6 row_ror:1 row_mask:0xf bank_mask:0xf
    v_sub_f32 v4, v4, v6
    v_exp_f32 v4, v4
    s_nop 0
    v_mul_f32 v5, v4, v5
    s_nop 1
    v_add_f32_dpp v5, v5, v5 row_ror:4 row_mask:0xf bank_mask:0xf
    s_nop 1
    v_add_f32_dpp v5, v5, v5 row_ror:2 row_mask:0xf bank_mask:0xf
    s_nop 1
    v_add_f32_dpp v5, v5, v5 row_ror:1 row_mask:0xf bank_mask:0xf
    v_rcp_f32 v5, v5
    s_nop 0
    v_mul_f32 v4, v4, v5
    s_nop 0
    v_readlane_b32 s24, v4, 0
    s_waitcnt vmcnt(7)
    v_lshlrev_b32 v5, 16, v72
    v_and_b32 v6, 0xffff0000, v72
    v_mul_f32 v104, s24, v5
    v_mul_f32 v105, s24, v6
    v_lshlrev_b32 v5, 16, v73
    v_and_b32 v6, 0xffff0000, v73
    v_mul_f32 v106, s24, v5
    v_mul_f32 v107, s24, v6
    v_lshlrev_b32 v5, 16, v74
    v_and_b32 v6, 0xffff0000, v74
    v_mul_f32 v108, s24, v5
    v_mul_f32 v109, s24, v6
    v_lshlrev_b32 v5, 16, v75
    v_and_b32 v6, 0xffff0000, v75
    v_mul_f32 v110, s24, v5
    v_mul_f32 v111, s24, v6
    v_readlane_b32 s24, v4, 1
    s_waitcnt vmcnt(6)
    v_lshlrev_b32 v5, 16, v76
    v_and_b32 v6, 0xffff0000, v76
    v_fmac_f32 v104, s24, v5
    v_fmac_f32 v105, s24, v6
    v_lshlrev_b32 v5, 16, v77
    v_and_b32 v6, 0xffff0000, v77
    v_fmac_f32 v106, s24, v5
    v_fmac_f32 v107, s24, v6
    v_lshlrev_b32 v5, 16, v78
    v_and_b32 v6, 0xffff0000, v78
    v_fmac_f32 v108, s24, v5
    v_fmac_f32 v109, s24, v6
    v_lshlrev_b32 v5, 16, v79
    v_and_b32 v6, 0xffff0000, v79
    v_fmac_f32 v110, s24, v5
    v_fmac_f32 v111, s24, v6
    v_readlane_b32 s24, v4, 2
    s_waitcnt vmcnt(5)
    v_lshlrev_b32 v5, 16, v80
    v_and_b32 v6, 0xffff0000, v80
    v_fmac_f32 v104, s24, v5
    v_fmac_f32 v105, s24, v6
    v_lshlrev_b32 v5, 16, v81
    v_and_b32 v6, 0xffff0000, v81
    v_fmac_f32 v106, s24, v5
    v_fmac_f32 v107, s24, v6
    v_lshlrev_b32 v5, 16, v82
    v_and_b32 v6, 0xffff0000, v82
    v_fmac_f32 v108, s24, v5
    v_fmac_f32 v109, s24, v6
    v_lshlrev_b32 v5, 16, v83
    v_and_b32 v6, 0xffff0000, v83
    v_fmac_f32 v110, s24, v5
    v_fmac_f32 v111, s24, v6
    v_readlane_b32 s24, v4, 3
    s_waitcnt vmcnt(4)
    v_lshlrev_b32 v5, 16, v84
    v_and_b32 v6, 0xffff0000, v84
    v_fmac_f32 v104, s24, v5
    v_fmac_f32 v105, s24, v6
    v_lshlrev_b32 v5, 16, v85
    v_and_b32 v6, 0xffff0000, v85
    v_fmac_f32 v106, s24, v5
    v_fmac_f32 v107, s24, v6
    v_lshlrev_b32 v5, 16, v86
    v_and_b32 v6, 0xffff0000, v86
    v_fmac_f32 v108, s24, v5
    v_fmac_f32 v109, s24, v6
    v_lshlrev_b32 v5, 16, v87
    v_and_b32 v6, 0xffff0000, v87
    v_fmac_f32 v110, s24, v5
    v_fmac_f32 v111, s24, v6
    v_readlane_b32 s24, v4, 4
    s_waitcnt vmcnt(3)
    v_lshlrev_b32 v5, 16, v88
    v_and_b32 v6, 0xffff0000, v88
    v_fmac_f32 v104, s24, v5
    v_fmac_f32 v105, s24, v6
    v_lshlrev_b32 v5, 16, v89
    v_and_b32 v6, 0xffff0000, v89
    v_fmac_f32 v106, s24, v5
    v_fmac_f32 v107, s24, v6
    v_lshlrev_b32 v5, 16, v90
    v_and_b32 v6, 0xffff0000, v90
    v_fmac_f32 v108, s24, v5
    v_fmac_f32 v109, s24, v6
    v_lshlrev_b32 v5, 16, v91
    v_and_b32 v6, 0xffff0000, v91
    v_fmac_f32 v110, s24, v5
    v_fmac_f32 v111, s24, v6
    v_readlane_b32 s24, v4, 5
    s_waitcnt vmcnt(2)
    v_lshlrev_b32 v5, 16, v92
    v_and_b32 v6, 0xffff0000, v92
    v_fmac_f32 v104, s24, v5
    v_fmac_f32 v105, s24, v6
    v_lshlrev_b32 v5, 16, v93
    v_and_b32 v6, 0xffff0000, v93
    v_fmac_f32 v106, s24, v5
    v_fmac_f32 v107, s24, v6
    v_lshlrev_b32 v5, 16, v94
    v_and_b32 v6, 0xffff0000, v94
    v_fmac_f32 v108, s24, v5
    v_fmac_f32 v109, s24, v6
    v_lshlrev_b32 v5, 16, v95
    v_and_b32 v6, 0xffff0000, v95
    v_fmac_f32 v110, s24, v5
    v_fmac_f32 v111, s24, v6
    v_readlane_b32 s24, v4, 6
    s_waitcnt vmcnt(1)
    v_lshlrev_b32 v5, 16, v96
    v_and_b32 v6, 0xffff0000, v96
    v_fmac_f32 v104, s24, v5
    v_fmac_f32 v105, s24, v6
    v_lshlrev_b32 v5, 16, v97
    v_and_b32 v6, 0xffff0000, v97
    v_fmac_f32 v106, s24, v5
    v_fmac_f32 v107, s24, v6
    v_lshlrev_b32 v5, 16, v98
    v_and_b32 v6, 0xffff0000, v98
    v_fmac_f32 v108, s24, v5
    v_fmac_f32 v109, s24, v6
    v_lshlrev_b32 v5, 16, v99
    v_and_b32 v6, 0xffff0000, v99
    v_fmac_f32 v110, s24, v5
    v_fmac_f32 v111, s24, v6
    v_readlane_b32 s24, v4, 7
    s_waitcnt vmcnt(0)
    v_lshlrev_b32 v5, 16, v100
    v_and_b32 v6, 0xffff0000, v100
    v_fmac_f32 v104, s24, v5
    v_fmac_f32 v105, s24, v6
    v_lshlrev_b32 v5, 16, v101
    v_and_b32 v6, 0xffff0000, v101
    v_fmac_f32 v106, s24, v5
    v_fmac_f32 v107, s24, v6
    v_lshlrev_b32 v5, 16, v102
    v_and_b32 v6, 0xffff0000, v102
    v_fmac_f32 v108, s24, v5
    v_fmac_f32 v109, s24, v6
    v_lshlrev_b32 v5, 16, v103
    v_and_b32 v6, 0xffff0000, v103
    v_fmac_f32 v110, s24, v5
    v_fmac_f32 v111, s24, v6
    v_cvt_pk_bf16_f32 v4, v104, v105
    v_cvt_pk_bf16_f32 v5, v106, v107
    v_cvt_pk_bf16_f32 v6, v108, v109
    v_cvt_pk_bf16_f32 v7, v110, v111
    s_lshl_b32 s24, s3, 10
    s_add_u32 s24, s24, 145408
    v_add_u32 v3, s24, v2
    ds_write_b128 v3, v[4:7]
    s_lshl_b32 s24, s3, 8
    s_add_u32 s24, s24, 145408
    v_add_u32 v3, s24, v19
    s_waitcnt lgkmcnt(0)
    s_barrier
    ds_read_b128 v[32:35], v3 offset:0
    ds_read_b128 v[36:39], v3 offset:16
    ds_read_b128 v[40:43], v3 offset:32
    ds_read_b128 v[44:47], v3 offset:48
    ds_read_b128 v[48:51], v3 offset:2048
    ds_read_b128 v[52:55], v3 offset:2064
    ds_read_b128 v[56:59], v3 offset:2080
    ds_read_b128 v[60:63], v3 offset:2096
    s_waitcnt lgkmcnt(0)
    v_perm_b32 v8, v32, v32, v24
    v_perm_b32 v9, v32, v32, v25
    v_perm_b32 v10, v32, v32, v26
    v_perm_b32 v11, v32, v32, v27
    s_nop 1
    v_mfma_f32_16x16x32_bf16 v[12:15], v[128:131], v[8:11], 0
    v_perm_b32 v4, v48, v48, v24
    v_perm_b32 v5, v48, v48, v25
    v_perm_b32 v6, v48, v48, v26
    v_perm_b32 v7, v48, v48, v27
    s_nop 1
    v_mfma_f32_16x16x32_bf16 v[68:71], v[128:131], v[4:7], 0
    v_perm_b32 v8, v32, v32, v28
    v_perm_b32 v9, v32, v32, v29
    v_perm_b32 v10, v32, v32, v30
    v_perm_b32 v11, v32, v32, v31
    s_nop 1
    v_mfma_f32_16x16x32_bf16 v[12:15], v[132:135], v[8:11], v[12:15]
    v_perm_b32 v4, v48, v48, v28
    v_perm_b32 v5, v48, v48, v29
    v_perm_b32 v6, v48, v48, v30
    v_perm_b32 v7, v48, v48, v31
    s_nop 1
    v_mfma_f32_16x16x32_bf16 v[68:71], v[132:135], v[4:7], v[68:71]
    v_perm_b32 v8, v33, v33, v24
    v_perm_b32 v9, v33, v33, v25
    v_perm_b32 v10, v33, v33, v26
    v_perm_b32 v11, v33, v33, v27
    s_nop 1
    v_mfma_f32_16x16x32_bf16 v[12:15], v[136:139], v[8:11], v[12:15]
    v_perm_b32 v4, v49, v49, v24
    v_perm_b32 v5, v49, v49, v25
    v_perm_b32 v6, v49, v49, v26
    v_perm_b32 v7, v49, v49, v27
    s_nop 1
    v_mfma_f32_16x16x32_bf16 v[68:71], v[136:139], v[4:7], v[68:71]
    v_perm_b32 v8, v33, v33, v28
    v_perm_b32 v9, v33, v33, v29
    v_perm_b32 v10, v33, v33, v30
    v_perm_b32 v11, v33, v33, v31
    s_nop 1
    v_mfma_f32_16x16x32_bf16 v[12:15], v[140:143], v[8:11], v[12:15]
    v_perm_b32 v4, v49, v49, v28
    v_perm_b32 v5, v49, v49, v29
    v_perm_b32 v6, v49, v49, v30
    v_perm_b32 v7, v49, v49, v31
    s_nop 1
    v_mfma_f32_16x16x32_bf16 v[68:71], v[140:143], v[4:7], v[68:71]
    v_perm_b32 v8, v34, v34, v24
    v_perm_b32 v9, v34, v34, v25
    v_perm_b32 v10, v34, v34, v26
    v_perm_b32 v11, v34, v34, v27
    s_nop 1
    v_mfma_f32_16x16x32_bf16 v[12:15], v[144:147], v[8:11], v[12:15]
    v_perm_b32 v4, v50, v50, v24
    v_perm_b32 v5, v50, v50, v25
    v_perm_b32 v6, v50, v50, v26
    v_perm_b32 v7, v50, v50, v27
    s_nop 1
    v_mfma_f32_16x16x32_bf16 v[68:71], v[144:147], v[4:7], v[68:71]
    v_perm_b32 v8, v34, v34, v28
    v_perm_b32 v9, v34, v34, v29
    v_perm_b32 v10, v34, v34, v30
    v_perm_b32 v11, v34, v34, v31
    s_nop 1
    v_mfma_f32_16x16x32_bf16 v[12:15], v[148:151], v[8:11], v[12:15]
    v_perm_b32 v4, v50, v50, v28
    v_perm_b32 v5, v50, v50, v29
    v_perm_b32 v6, v50, v50, v30
    v_perm_b32 v7, v50, v50, v31
    s_nop 1
    v_mfma_f32_16x16x32_bf16 v[68:71], v[148:151], v[4:7], v[68:71]
    v_perm_b32 v8, v35, v35, v24
    v_perm_b32 v9, v35, v35, v25
    v_perm_b32 v10, v35, v35, v26
    v_perm_b32 v11, v35, v35, v27
    s_nop 1
    v_mfma_f32_16x16x32_bf16 v[12:15], v[152:155], v[8:11], v[12:15]
    v_perm_b32 v4, v51, v51, v24
    v_perm_b32 v5, v51, v51, v25
    v_perm_b32 v6, v51, v51, v26
    v_perm_b32 v7, v51, v51, v27
    s_nop 1
    v_mfma_f32_16x16x32_bf16 v[68:71], v[152:155], v[4:7], v[68:71]
    v_perm_b32 v8, v35, v35, v28
    v_perm_b32 v9, v35, v35, v29
    v_perm_b32 v10, v35, v35, v30
    v_perm_b32 v11, v35, v35, v31
    s_nop 1
    v_mfma_f32_16x16x32_bf16 v[12:15], v[156:159], v[8:11], v[12:15]
    v_perm_b32 v4, v51, v51, v28
    v_perm_b32 v5, v51, v51, v29
    v_perm_b32 v6, v51, v51, v30
    v_perm_b32 v7, v51, v51, v31
    s_nop 1
    v_mfma_f32_16x16x32_bf16 v[68:71], v[156:159], v[4:7], v[68:71]
    v_perm_b32 v8, v36, v36, v24
    v_perm_b32 v9, v36, v36, v25
    v_perm_b32 v10, v36, v36, v26
    v_perm_b32 v11, v36, v36, v27
    s_nop 1
    v_mfma_f32_16x16x32_bf16 v[12:15], v[160:163], v[8:11], v[12:15]
    v_perm_b32 v4, v52, v52, v24
    v_perm_b32 v5, v52, v52, v25
    v_perm_b32 v6, v52, v52, v26
    v_perm_b32 v7, v52, v52, v27
    s_nop 1
    v_mfma_f32_16x16x32_bf16 v[68:71], v[160:163], v[4:7], v[68:71]
    v_perm_b32 v8, v36, v36, v28
    v_perm_b32 v9, v36, v36, v29
    v_perm_b32 v10, v36, v36, v30
    v_perm_b32 v11, v36, v36, v31
    s_nop 1
    v_mfma_f32_16x16x32_bf16 v[12:15], v[164:167], v[8:11], v[12:15]
    v_perm_b32 v4, v52, v52, v28
    v_perm_b32 v5, v52, v52, v29
    v_perm_b32 v6, v52, v52, v30
    v_perm_b32 v7, v52, v52, v31
    s_nop 1
    v_mfma_f32_16x16x32_bf16 v[68:71], v[164:167], v[4:7], v[68:71]
    v_perm_b32 v8, v37, v37, v24
    v_perm_b32 v9, v37, v37, v25
    v_perm_b32 v10, v37, v37, v26
    v_perm_b32 v11, v37, v37, v27
    s_nop 1
    v_mfma_f32_16x16x32_bf16 v[12:15], v[168:171], v[8:11], v[12:15]
    v_perm_b32 v4, v53, v53, v24
    v_perm_b32 v5, v53, v53, v25
    v_perm_b32 v6, v53, v53, v26
    v_perm_b32 v7, v53, v53, v27
    s_nop 1
    v_mfma_f32_16x16x32_bf16 v[68:71], v[168:171], v[4:7], v[68:71]
    v_perm_b32 v8, v37, v37, v28
    v_perm_b32 v9, v37, v37, v29
    v_perm_b32 v10, v37, v37, v30
    v_perm_b32 v11, v37, v37, v31
    s_nop 1
    v_mfma_f32_16x16x32_bf16 v[12:15], v[172:175], v[8:11], v[12:15]
    v_perm_b32 v4, v53, v53, v28
    v_perm_b32 v5, v53, v53, v29
    v_perm_b32 v6, v53, v53, v30
    v_perm_b32 v7, v53, v53, v31
    s_nop 1
    v_mfma_f32_16x16x32_bf16 v[68:71], v[172:175], v[4:7], v[68:71]
    v_perm_b32 v8, v38, v38, v24
    v_perm_b32 v9, v38, v38, v25
    v_perm_b32 v10, v38, v38, v26
    v_perm_b32 v11, v38, v38, v27
    s_nop 1
    v_mfma_f32_16x16x32_bf16 v[12:15], v[176:179], v[8:11], v[12:15]
    v_perm_b32 v4, v54, v54, v24
    v_perm_b32 v5, v54, v54, v25
    v_perm_b32 v6, v54, v54, v26
    v_perm_b32 v7, v54, v54, v27
    s_nop 1
    v_mfma_f32_16x16x32_bf16 v[68:71], v[176:179], v[4:7], v[68:71]
    v_perm_b32 v8, v38, v38, v28
    v_perm_b32 v9, v38, v38, v29
    v_perm_b32 v10, v38, v38, v30
    v_perm_b32 v11, v38, v38, v31
    s_nop 1
    v_mfma_f32_16x16x32_bf16 v[12:15], v[180:183], v[8:11], v[12:15]
    v_perm_b32 v4, v54, v54, v28
    v_perm_b32 v5, v54, v54, v29
    v_perm_b32 v6, v54, v54, v30
    v_perm_b32 v7, v54, v54, v31
    s_nop 1
    v_mfma_f32_16x16x32_bf16 v[68:71], v[180:183], v[4:7], v[68:71]
    v_perm_b32 v8, v39, v39, v24
    v_perm_b32 v9, v39, v39, v25
    v_perm_b32 v10, v39, v39, v26
    v_perm_b32 v11, v39, v39, v27
    s_nop 1
    v_mfma_f32_16x16x32_bf16 v[12:15], v[184:187], v[8:11], v[12:15]
    v_perm_b32 v4, v55, v55, v24
    v_perm_b32 v5, v55, v55, v25
    v_perm_b32 v6, v55, v55, v26
    v_perm_b32 v7, v55, v55, v27
    s_nop 1
    v_mfma_f32_16x16x32_bf16 v[68:71], v[184:187], v[4:7], v[68:71]
    v_perm_b32 v8, v39, v39, v28
    v_perm_b32 v9, v39, v39, v29
    v_perm_b32 v10, v39, v39, v30
    v_perm_b32 v11, v39, v39, v31
    s_nop 1
    v_mfma_f32_16x16x32_bf16 v[12:15], v[188:191], v[8:11], v[12:15]
    v_perm_b32 v4, v55, v55, v28
    v_perm_b32 v5, v55, v55, v29
    v_perm_b32 v6, v55, v55, v30
    v_perm_b32 v7, v55, v55, v31
    s_nop 1
    v_mfma_f32_16x16x32_bf16 v[68:71], v[188:191], v[4:7], v[68:71]
    v_perm_b32 v8, v40, v40, v24
    v_perm_b32 v9, v40, v40, v25
    v_perm_b32 v10, v40, v40, v26
    v_perm_b32 v11, v40, v40, v27
    s_nop 1
    v_mfma_f32_16x16x32_bf16 v[12:15], v[192:195], v[8:11], v[12:15]
    v_perm_b32 v4, v56, v56, v24
    v_perm_b32 v5, v56, v56, v25
    v_perm_b32 v6, v56, v56, v26
    v_perm_b32 v7, v56, v56, v27
    s_nop 1
    v_mfma_f32_16x16x32_bf16 v[68:71], v[192:195], v[4:7], v[68:71]
    v_perm_b32 v8, v40, v40, v28
    v_perm_b32 v9, v40, v40, v29
    v_perm_b32 v10, v40, v40, v30
    v_perm_b32 v11, v40, v40, v31
    s_nop 1
    v_mfma_f32_16x16x32_bf16 v[12:15], v[196:199], v[8:11], v[12:15]
    v_perm_b32 v4, v56, v56, v28
    v_perm_b32 v5, v56, v56, v29
    v_perm_b32 v6, v56, v56, v30
    v_perm_b32 v7, v56, v56, v31
    s_nop 1
    v_mfma_f32_16x16x32_bf16 v[68:71], v[196:199], v[4:7], v[68:71]
    v_perm_b32 v8, v41, v41, v24
    v_perm_b32 v9, v41, v41, v25
    v_perm_b32 v10, v41, v41, v26
    v_perm_b32 v11, v41, v41, v27
    s_nop 1
    v_mfma_f32_16x16x32_bf16 v[12:15], v[200:203], v[8:11], v[12:15]
    v_perm_b32 v4, v57, v57, v24
    v_perm_b32 v5, v57, v57, v25
    v_perm_b32 v6, v57, v57, v26
    v_perm_b32 v7, v57, v57, v27
    s_nop 1
    v_mfma_f32_16x16x32_bf16 v[68:71], v[200:203], v[4:7], v[68:71]
    v_perm_b32 v8, v41, v41, v28
    v_perm_b32 v9, v41, v41, v29
    v_perm_b32 v10, v41, v41, v30
    v_perm_b32 v11, v41, v41, v31
    s_nop 1
    v_mfma_f32_16x16x32_bf16 v[12:15], v[204:207], v[8:11], v[12:15]
    v_perm_b32 v4, v57, v57, v28
    v_perm_b32 v5, v57, v57, v29
    v_perm_b32 v6, v57, v57, v30
    v_perm_b32 v7, v57, v57, v31
    s_nop 1
    v_mfma_f32_16x16x32_bf16 v[68:71], v[204:207], v[4:7], v[68:71]
    v_perm_b32 v8, v42, v42, v24
    v_perm_b32 v9, v42, v42, v25
    v_perm_b32 v10, v42, v42, v26
    v_perm_b32 v11, v42, v42, v27
    s_nop 1
    v_mfma_f32_16x16x32_bf16 v[12:15], v[208:211], v[8:11], v[12:15]
    v_perm_b32 v4, v58, v58, v24
    v_perm_b32 v5, v58, v58, v25
    v_perm_b32 v6, v58, v58, v26
    v_perm_b32 v7, v58, v58, v27
    s_nop 1
    v_mfma_f32_16x16x32_bf16 v[68:71], v[208:211], v[4:7], v[68:71]
    v_perm_b32 v8, v42, v42, v28
    v_perm_b32 v9, v42, v42, v29
    v_perm_b32 v10, v42, v42, v30
    v_perm_b32 v11, v42, v42, v31
    s_nop 1
    v_mfma_f32_16x16x32_bf16 v[12:15], v[212:215], v[8:11], v[12:15]
    v_perm_b32 v4, v58, v58, v28
    v_perm_b32 v5, v58, v58, v29
    v_perm_b32 v6, v58, v58, v30
    v_perm_b32 v7, v58, v58, v31
    s_nop 1
    v_mfma_f32_16x16x32_bf16 v[68:71], v[212:215], v[4:7], v[68:71]
    v_perm_b32 v8, v43, v43, v24
    v_perm_b32 v9, v43, v43, v25
    v_perm_b32 v10, v43, v43, v26
    v_perm_b32 v11, v43, v43, v27
    s_nop 1
    v_mfma_f32_16x16x32_bf16 v[12:15], v[216:219], v[8:11], v[12:15]
    v_perm_b32 v4, v59, v59, v24
    v_perm_b32 v5, v59, v59, v25
    v_perm_b32 v6, v59, v59, v26
    v_perm_b32 v7, v59, v59, v27
    s_nop 1
    v_mfma_f32_16x16x32_bf16 v[68:71], v[216:219], v[4:7], v[68:71]
    v_perm_b32 v8, v43, v43, v28
    v_perm_b32 v9, v43, v43, v29
    v_perm_b32 v10, v43, v43, v30
    v_perm_b32 v11, v43, v43, v31
    s_nop 1
    v_mfma_f32_16x16x32_bf16 v[12:15], v[220:223], v[8:11], v[12:15]
    v_perm_b32 v4, v59, v59, v28
    v_perm_b32 v5, v59, v59, v29
    v_perm_b32 v6, v59, v59, v30
    v_perm_b32 v7, v59, v59, v31
    s_nop 1
    v_mfma_f32_16x16x32_bf16 v[68:71], v[220:223], v[4:7], v[68:71]
    v_perm_b32 v8, v44, v44, v24
    v_perm_b32 v9, v44, v44, v25
    v_perm_b32 v10, v44, v44, v26
    v_perm_b32 v11, v44, v44, v27
    s_nop 1
    v_mfma_f32_16x16x32_bf16 v[12:15], v[224:227], v[8:11], v[12:15]
    v_perm_b32 v4, v60, v60, v24
    v_perm_b32 v5, v60, v60, v25
    v_perm_b32 v6, v60, v60, v26
    v_perm_b32 v7, v60, v60, v27
    s_nop 1
    v_mfma_f32_16x16x32_bf16 v[68:71], v[224:227], v[4:7], v[68:71]
    v_perm_b32 v8, v44, v44, v28
    v_perm_b32 v9, v44, v44, v29
    v_perm_b32 v10, v44, v44, v30
    v_perm_b32 v11, v44, v44, v31
    s_nop 1
    v_mfma_f32_16x16x32_bf16 v[12:15], v[228:231], v[8:11], v[12:15]
    v_perm_b32 v4, v60, v60, v28
    v_perm_b32 v5, v60, v60, v29
    v_perm_b32 v6, v60, v60, v30
    v_perm_b32 v7, v60, v60, v31
    s_nop 1
    v_mfma_f32_16x16x32_bf16 v[68:71], v[228:231], v[4:7], v[68:71]
    v_perm_b32 v8, v45, v45, v24
    v_perm_b32 v9, v45, v45, v25
    v_perm_b32 v10, v45, v45, v26
    v_perm_b32 v11, v45, v45, v27
    s_nop 1
    v_mfma_f32_16x16x32_bf16 v[12:15], v[232:235], v[8:11], v[12:15]
    v_perm_b32 v4, v61, v61, v24
    v_perm_b32 v5, v61, v61, v25
    v_perm_b32 v6, v61, v61, v26
    v_perm_b32 v7, v61, v61, v27
    s_nop 1
    v_mfma_f32_16x16x32_bf16 v[68:71], v[232:235], v[4:7], v[68:71]
    v_perm_b32 v8, v45, v45, v28
    v_perm_b32 v9, v45, v45, v29
    v_perm_b32 v10, v45, v45, v30
    v_perm_b32 v11, v45, v45, v31
    s_nop 1
    v_mfma_f32_16x16x32_bf16 v[12:15], v[236:239], v[8:11], v[12:15]
    v_perm_b32 v4, v61, v61, v28
    v_perm_b32 v5, v61, v61, v29
    v_perm_b32 v6, v61, v61, v30
    v_perm_b32 v7, v61, v61, v31
    s_nop 1
    v_mfma_f32_16x16x32_bf16 v[68:71], v[236:239], v[4:7], v[68:71]
    v_perm_b32 v8, v46, v46, v24
    v_perm_b32 v9, v46, v46, v25
    v_perm_b32 v10, v46, v46, v26
    v_perm_b32 v11, v46, v46, v27
    s_nop 1
    v_mfma_f32_16x16x32_bf16 v[12:15], v[240:243], v[8:11], v[12:15]
    v_perm_b32 v4, v62, v62, v24
    v_perm_b32 v5, v62, v62, v25
    v_perm_b32 v6, v62, v62, v26
    v_perm_b32 v7, v62, v62, v27
    s_nop 1
    v_mfma_f32_16x16x32_bf16 v[68:71], v[240:243], v[4:7], v[68:71]
    v_perm_b32 v8, v46, v46, v28
    v_perm_b32 v9, v46, v46, v29
    v_perm_b32 v10, v46, v46, v30
    v_perm_b32 v11, v46, v46, v31
    s_nop 1
    v_mfma_f32_16x16x32_bf16 v[12:15], v[244:247], v[8:11], v[12:15]
    v_perm_b32 v4, v62, v62, v28
    v_perm_b32 v5, v62, v62, v29
    v_perm_b32 v6, v62, v62, v30
    v_perm_b32 v7, v62, v62, v31
    s_nop 1
    v_mfma_f32_16x16x32_bf16 v[68:71], v[244:247], v[4:7], v[68:71]
    v_perm_b32 v8, v47, v47, v24
    v_perm_b32 v9, v47, v47, v25
    v_perm_b32 v10, v47, v47, v26
    v_perm_b32 v11, v47, v47, v27
    s_nop 1
    v_mfma_f32_16x16x32_bf16 v[12:15], v[248:251], v[8:11], v[12:15]
    v_perm_b32 v4, v63, v63, v24
    v_perm_b32 v5, v63, v63, v25
    v_perm_b32 v6, v63, v63, v26
    v_perm_b32 v7, v63, v63, v27
    s_nop 1
    v_mfma_f32_16x16x32_bf16 v[68:71], v[248:251], v[4:7], v[68:71]
    v_perm_b32 v8, v47, v47, v28
    v_perm_b32 v9, v47, v47, v29
    v_perm_b32 v10, v47, v47, v30
    v_perm_b32 v11, v47, v47, v31
    s_nop 1
    v_mfma_f32_16x16x32_bf16 v[12:15], v[252:255], v[8:11], v[12:15]
    v_perm_b32 v4, v63, v63, v28
    v_perm_b32 v5, v63, v63, v29
    v_perm_b32 v6, v63, v63, v30
    v_perm_b32 v7, v63, v63, v31
    s_nop 1
    v_mfma_f32_16x16x32_bf16 v[68:71], v[252:255], v[4:7], v[68:71]
    v_lshrrev_b32 v3, 4, v0
    v_lshlrev_b32 v3, 7, v3
    v_and_b32 v4, 7, v0
    v_lshl_add_u32 v3, v4, 4, v3
    v_bfe_u32 v4, v0, 3, 1
    v_lshl_add_u32 v3, v4, 9, v3
    s_lshl_b32 s24, s3, 11
    s_add_u32 s24, s24, 135168
    v_add_u32 v3, s24, v3
    ds_write_b128 v3, v[12:15]
    ds_write_b128 v3, v[68:71] offset:1024
    s_waitcnt lgkmcnt(0)
    s_barrier
    v_and_b32 v5, 31, v0
    s_lshl_b32 s24, s3, 9
    s_add_u32 s24, s24, 135168
    v_lshl_add_u32 v3, v5, 4, s24
    ds_read_b128 v[72:75], v3 offset:0
    ds_read_b128 v[76:79], v3 offset:2048
    ds_read_b128 v[80:83], v3 offset:4096
    ds_read_b128 v[84:87], v3 offset:6144
    s_lshl_b32 s24, s3, 8
    s_add_u32 s24, s24, 143616
    v_lshl_add_u32 v5, v5, 3, s24
    s_waitcnt lgkmcnt(0)
    v_add_f32 v72, v72, v76
    v_add_f32 v73, v73, v77
    v_add_f32 v74, v74, v78
    v_add_f32 v75, v75, v79
    v_add_f32 v72, v72, v80
    v_add_f32 v73, v73, v81
    v_add_f32 v74, v74, v82
    v_add_f32 v75, v75, v83
    v_add_f32 v72, v72, v84
    v_add_f32 v73, v73, v85
    v_add_f32 v74, v74, v86
    v_add_f32 v75, v75, v87
    v_cvt_pk_bf16_f32 v6, v72, v73
    v_cvt_pk_bf16_f32 v7, v74, v75
    ds_write_b64 v5, v[6:7]
    v_lshrrev_b32 v3, 2, v0
    v_mul_u32_u24 v3, 1056, v3
    v_and_b32 v4, 3, v0
    v_lshl_add_u32 v3, v4, 3, v3
    s_lshl_b32 s24, s3, 8
    v_add_u32 v3, s24, v3
    v_add_u32 v4, 67584, v3
    ds_read_b64_tr_b16 v[128:129], v3 offset:0
    ds_read_b64_tr_b16 v[130:131], v3 offset:16896
    ds_read_b64_tr_b16 v[132:133], v3 offset:33792
    ds_read_b64_tr_b16 v[134:135], v3 offset:50688
    ds_read_b64_tr_b16 v[136:137], v4 offset:0
    ds_read_b64_tr_b16 v[138:139], v4 offset:16896
    ds_read_b64_tr_b16 v[140:141], v4 offset:33792
    ds_read_b64_tr_b16 v[142:143], v4 offset:50688
    ds_read_b64_tr_b16 v[144:145], v3 offset:32
    ds_read_b64_tr_b16 v[146:147], v3 offset:16928
    ds_read_b64_tr_b16 v[148:149], v3 offset:33824
    ds_read_b64_tr_b16 v[150:151], v3 offset:50720
    ds_read_b64_tr_b16 v[152:153], v4 offset:32
    ds_read_b64_tr_b16 v[154:155], v4 offset:16928
    ds_read_b64_tr_b16 v[156:157], v4 offset:33824
    ds_read_b64_tr_b16 v[158:159], v4 offset:50720
    ds_read_b64_tr_b16 v[160:161], v3 offset:64
    ds_read_b64_tr_b16 v[162:163], v3 offset:16960
    ds_read_b64_tr_b16 v[164:165], v3 offset:33856
    ds_read_b64_tr_b16 v[166:167], v3 offset:50752
    ds_read_b64_tr_b16 v[168:169], v4 offset:64
    ds_read_b64_tr_b16 v[170:171], v4 offset:16960
    ds_read_b64_tr_b16 v[172:173], v4 offset:33856
    ds_read_b64_tr_b16 v[174:175], v4 offset:50752
    ds_read_b64_tr_b16 v[176:177], v3 offset:96
    ds_read_b64_tr_b16 v[178:179], v3 offset:16992
    ds_read_b64_tr_b16 v[180:181], v3 offset:33888
    ds_read_b64_tr_b16 v[182:183], v3 offset:50784
    ds_read_b64_tr_b16 v[184:185], v4 offset:96
    ds_read_b64_tr_b16 v[186:187], v4 offset:16992
    ds_read_b64_tr_b16 v[188:189], v4 offset:33888
    ds_read_b64_tr_b16 v[190:191], v4 offset:50784
    ds_read_b64_tr_b16 v[192:193], v3 offset:128
    ds_read_b64_tr_b16 v[194:195], v3 offset:17024
    ds_read_b64_tr_b16 v[196:197], v3 offset:33920
    ds_read_b64_tr_b16 v[198:199], v3 offset:50816
    ds_read_b64_tr_b16 v[200:201], v4 offset:128
    ds_read_b64_tr_b16 v[202:203], v4 offset:17024
    ds_read_b64_tr_b16 v[204:205], v4 offset:33920
    ds_read_b64_tr_b16 v[206:207], v4 offset:50816
    ds_read_b64_tr_b16 v[208:209], v3 offset:160
    ds_read_b64_tr_b16 v[210:211], v3 offset:17056
    ds_read_b64_tr_b16 v[212:213], v3 offset:33952
    ds_read_b64_tr_b16 v[214:215], v3 offset:50848
    ds_read_b64_tr_b16 v[216:217], v4 offset:160
    ds_read_b64_tr_b16 v[218:219], v4 offset:17056
    ds_read_b64_tr_b16 v[220:221], v4 offset:33952
    ds_read_b64_tr_b16 v[222:223], v4 offset:50848
    ds_read_b64_tr_b16 v[224:225], v3 offset:192
    ds_read_b64_tr_b16 v[226:227], v3 offset:17088
    ds_read_b64_tr_b16 v[228:229], v3 offset:33984
    ds_read_b64_tr_b16 v[230:231], v3 offset:50880
    ds_read_b64_tr_b16 v[232:233], v4 offset:192
    ds_read_b64_tr_b16 v[234:235], v4 offset:17088
    ds_read_b64_tr_b16 v[236:237], v4 offset:33984
    ds_read_b64_tr_b16 v[238:239], v4 offset:50880
    ds_read_b64_tr_b16 v[240:241], v3 offset:224
    ds_read_b64_tr_b16 v[242:243], v3 offset:17120
    ds_read_b64_tr_b16 v[244:245], v3 offset:34016
    ds_read_b64_tr_b16 v[246:247], v3 offset:50912
    ds_read_b64_tr_b16 v[248:249], v4 offset:224
    ds_read_b64_tr_b16 v[250:251], v4 offset:17120
    ds_read_b64_tr_b16 v[252:253], v4 offset:34016
    ds_read_b64_tr_b16 v[254:255], v4 offset:50912
    v_lshrrev_b32 v3, 4, v0
    v_and_b32 v4, 3, v0
    v_lshlrev_b32 v5, 8, v4
    v_lshl_add_u32 v5, v3, 4, v5
    v_add_u32 v5, 143616, v5
    s_waitcnt lgkmcnt(0)
    s_barrier
    ds_read_b128 v[32:35], v5 offset:0
    ds_read_b128 v[36:39], v5 offset:64
    ds_read_b128 v[40:43], v5 offset:128
    ds_read_b128 v[44:47], v5 offset:192
    s_waitcnt lgkmcnt(3)
    v_mfma_f32_16x16x32_bf16 v[72:75], v[32:35], v[128:131], 0
    s_waitcnt lgkmcnt(2)
    v_mfma_f32_16x16x32_bf16 v[72:75], v[36:39], v[132:135], v[72:75]
    s_waitcnt lgkmcnt(1)
    v_mfma_f32_16x16x32_bf16 v[72:75], v[40:43], v[136:139], v[72:75]
    s_waitcnt lgkmcnt(0)
    v_mfma_f32_16x16x32_bf16 v[72:75], v[44:47], v[140:143], v[72:75]
    v_mfma_f32_16x16x32_bf16 v[76:79], v[32:35], v[144:147], 0
    v_mfma_f32_16x16x32_bf16 v[76:79], v[36:39], v[148:151], v[76:79]
    v_mfma_f32_16x16x32_bf16 v[76:79], v[40:43], v[152:155], v[76:79]
    v_mfma_f32_16x16x32_bf16 v[76:79], v[44:47], v[156:159], v[76:79]
    v_mfma_f32_16x16x32_bf16 v[80:83], v[32:35], v[160:163], 0
    v_mfma_f32_16x16x32_bf16 v[80:83], v[36:39], v[164:167], v[80:83]
    v_mfma_f32_16x16x32_bf16 v[80:83], v[40:43], v[168:171], v[80:83]
    v_mfma_f32_16x16x32_bf16 v[80:83], v[44:47], v[172:175], v[80:83]
    v_mov_b32_dpp v4, v72 quad_perm:[0,1,2,3] row_mask:0x1 bank_mask:0xf
    v_mov_b32_dpp v5, v73 quad_perm:[0,1,2,3] row_mask:0x1 bank_mask:0xf
    v_mov_b32_dpp v6, v74 quad_perm:[0,1,2,3] row_mask:0x1 bank_mask:0xf
    v_mov_b32_dpp v7, v75 quad_perm:[0,1,2,3] row_mask:0x1 bank_mask:0xf
    v_mfma_f32_16x16x32_bf16 v[84:87], v[32:35], v[176:179], 0
    v_mfma_f32_16x16x32_bf16 v[84:87], v[36:39], v[180:183], v[84:87]
    v_mfma_f32_16x16x32_bf16 v[84:87], v[40:43], v[184:187], v[84:87]
    v_mfma_f32_16x16x32_bf16 v[84:87], v[44:47], v[188:191], v[84:87]
    v_mov_b32_dpp v4, v76 quad_perm:[0,1,2,3] row_mask:0x2 bank_mask:0xf
    v_mov_b32_dpp v5, v77 quad_perm:[0,1,2,3] row_mask:0x2 bank_mask:0xf
    v_mov_b32_dpp v6, v78 quad_perm:[0,1,2,3] row_mask:0x2 bank_mask:0xf
    v_mov_b32_dpp v7, v79 quad_perm:[0,1,2,3] row_mask:0x2 bank_mask:0xf
    v_mfma_f32_16x16x32_bf16 v[88:91], v[32:35], v[192:195], 0
    v_mfma_f32_16x16x32_bf16 v[88:91], v[36:39], v[196:199], v[88:91]
    v_mfma_f32_16x16x32_bf16 v[88:91], v[40:43], v[200:203], v[88:91]
    v_mfma_f32_16x16x32_bf16 v[88:91], v[44:47], v[204:207], v[88:91]
    v_mov_b32_dpp v4, v80 quad_perm:[0,1,2,3] row_mask:0x4 bank_mask:0xf
    v_mov_b32_dpp v5, v81 quad_perm:[0,1,2,3] row_mask:0x4 bank_mask:0xf
    v_mov_b32_dpp v6, v82 quad_perm:[0,1,2,3] row_mask:0x4 bank_mask:0xf
    v_mov_b32_dpp v7, v83 quad_perm:[0,1,2,3] row_mask:0x4 bank_mask:0xf
    v_mfma_f32_16x16x32_bf16 v[92:95], v[32:35], v[208:211], 0
    v_mfma_f32_16x16x32_bf16 v[92:95], v[36:39], v[212:215], v[92:95]
    v_mfma_f32_16x16x32_bf16 v[92:95], v[40:43], v[216:219], v[92:95]
    v_mfma_f32_16x16x32_bf16 v[92:95], v[44:47], v[220:223], v[92:95]
    v_mov_b32_dpp v4, v84 quad_perm:[0,1,2,3] row_mask:0x8 bank_mask:0xf
    v_mov_b32_dpp v5, v85 quad_perm:[0,1,2,3] row_mask:0x8 bank_mask:0xf
    v_mov_b32_dpp v6, v86 quad_perm:[0,1,2,3] row_mask:0x8 bank_mask:0xf
    v_mov_b32_dpp v7, v87 quad_perm:[0,1,2,3] row_mask:0x8 bank_mask:0xf
    v_mfma_f32_16x16x32_bf16 v[96:99], v[32:35], v[224:227], 0
    v_mfma_f32_16x16x32_bf16 v[96:99], v[36:39], v[228:231], v[96:99]
    v_mfma_f32_16x16x32_bf16 v[96:99], v[40:43], v[232:235], v[96:99]
    v_mfma_f32_16x16x32_bf16 v[96:99], v[44:47], v[236:239], v[96:99]
    v_mov_b32_dpp v8, v88 quad_perm:[0,1,2,3] row_mask:0x1 bank_mask:0xf
    v_mov_b32_dpp v9, v89 quad_perm:[0,1,2,3] row_mask:0x1 bank_mask:0xf
    v_mov_b32_dpp v10, v90 quad_perm:[0,1,2,3] row_mask:0x1 bank_mask:0xf
    v_mov_b32_dpp v11, v91 quad_perm:[0,1,2,3] row_mask:0x1 bank_mask:0xf
    v_mfma_f32_16x16x32_bf16 v[100:103], v[32:35], v[240:243], 0
    v_mfma_f32_16x16x32_bf16 v[100:103], v[36:39], v[244:247], v[100:103]
    v_mfma_f32_16x16x32_bf16 v[100:103], v[40:43], v[248:251], v[100:103]
    v_mfma_f32_16x16x32_bf16 v[100:103], v[44:47], v[252:255], v[100:103]
    v_mov_b32_dpp v8, v92 quad_perm:[0,1,2,3] row_mask:0x2 bank_mask:0xf
    v_mov_b32_dpp v9, v93 quad_perm:[0,1,2,3] row_mask:0x2 bank_mask:0xf
    v_mov_b32_dpp v10, v94 quad_perm:[0,1,2,3] row_mask:0x2 bank_mask:0xf
    v_mov_b32_dpp v11, v95 quad_perm:[0,1,2,3] row_mask:0x2 bank_mask:0xf
    v_mov_b32_dpp v8, v96 quad_perm:[0,1,2,3] row_mask:0x4 bank_mask:0xf
    v_mov_b32_dpp v9, v97 quad_perm:[0,1,2,3] row_mask:0x4 bank_mask:0xf
    v_mov_b32_dpp v10, v98 quad_perm:[0,1,2,3] row_mask:0x4 bank_mask:0xf
    v_mov_b32_dpp v11, v99 quad_perm:[0,1,2,3] row_mask:0x4 bank_mask:0xf
    v_mov_b32_dpp v8, v100 quad_perm:[0,1,2,3] row_mask:0x8 bank_mask:0xf
    v_mov_b32_dpp v9, v101 quad_perm:[0,1,2,3] row_mask:0x8 bank_mask:0xf
    v_mov_b32_dpp v10, v102 quad_perm:[0,1,2,3] row_mask:0x8 bank_mask:0xf
    v_mov_b32_dpp v11, v103 quad_perm:[0,1,2,3] row_mask:0x8 bank_mask:0xf
    s_lshl_b32 s24, s26, 13
    s_lshl_b32 s25, s3, 11
    s_add_u32 s24, s24, s25
    s_add_u32 s24, s24, 0x124000
    buffer_store_dwordx4 v[4:7], v2, s[12:15], s24 offen sc1
    buffer_store_dwordx4 v[8:11], v2, s[12:15], s24 offen offset:1024 sc1
    s_waitcnt vmcnt(0)
    s_barrier
    s_cmp_lg_u32 s3, 0
    s_cbranch_scc1 L_sig5
    s_mov_b64 exec, 1
    v_mov_b32 v1, 1
    buffer_atomic_add v1, off, s[16:19], 0 offset:192
    s_mov_b64 exec, -1
L_sig5:
    s_branch L_R
L_C:
    s_sub_u32 s26, s2, 224
    s_add_u32 s74, s26, 32
    s_lshl_b32 s30, s26, 19
    s_waitcnt lgkmcnt(0)
    s_add_u32 s4, s38, s30
    s_addc_u32 s5, s39, 0
    s_mov_b32 s6, 0x80000
    s_mov_b32 s7, 0x20000
    s_mov_b32 s12, s62
    s_mov_b32 s13, s63
    s_mov_b32 s14, 0x400000
    s_mov_b32 s15, 0x20000
    s_mov_b32 s16, s60
    s_mov_b32 s17, s61
    s_mov_b32 s18, 0x100
    s_mov_b32 s19, 0x20000
    s_lshl_b32 s32, s3, 13
    s_mul_i32 s34, s3, 8320
    s_lshr_b32 s24, s74, 5
    s_lshl_b32 s24, s24, 5
    s_lshl_b32 s25, s3, 3
    s_add_u32 s24, s24, s25
    v_lshrrev_b32 v3, 3, v0
    v_add_u32 v17, s24, v3
    v_mul_u32_u24 v16, 0x3000, v17
    v_and_b32 v3, 7, v0
    v_lshl_add_u32 v16, v3, 4, v16
    s_and_b32 s24, s74, 31
    s_lshl_b32 s24, s24, 7
    s_add_u32 s24, s24, 0x170000
    v_add_u32 v16, s24, v16
    v_mov_b32 v8, -1
    v_mov_b32 v9, -1
    v_mov_b32 v10, -1
    v_mov_b32 v11, -1
    s_mov_b32 s24, 0
    buffer_store_dwordx4 v[8:11], v16, s[12:15], s24 offen sc1
    s_mov_b32 s24, 4096
    buffer_store_dwordx4 v[8:11], v16, s[12:15], s24 offen sc1
    s_mov_b32 s24, 8192
    buffer_store_dwordx4 v[8:11], v16, s[12:15], s24 offen sc1
    s_lshl_b32 s24, s74, 2
    s_add_u32 s24, s24, s3
    s_cmp_ge_u32 s24, 9
    s_cbranch_scc1 L_rs6
    s_lshl_b32 s24, s24, 10
    s_add_u32 s24, s24, 0x230000
    buffer_store_dwordx4 v[8:11], v2, s[12:15], s24 offen sc1
L_rs6:
    s_mov_b32 s33, 0
    s_add_u32 m0, s33, s34
    s_nop 0
    buffer_load_dwordx4 v2, s[4:7], s32 offen nt lds
    s_add_u32 s32, s32, 1024
    s_add_u32 m0, m0, 1040
    s_nop 0
    buffer_load_dwordx4 v2, s[4:7], s32 offen nt lds
    s_add_u32 s32, s32, 1024
    s_add_u32 m0, m0, 1040
    s_nop 0
    buffer_load_dwordx4 v2, s[4:7], s32 offen nt lds
    s_add_u32 s32, s32, 1024
    s_add_u32 m0, m0, 1040
    s_nop 0
    buffer_load_dwordx4 v2, s[4:7], s32 offen nt lds
    s_add_u32 s32, s32, 1024
    s_add_u32 m0, m0, 1040
    s_nop 0
    buffer_load_dwordx4 v2, s[4:7], s32 offen nt lds
    s_add_u32 s32, s32, 1024
    s_add_u32 m0, m0, 1040
    s_nop 0
    buffer_load_dwordx4 v2, s[4:7], s32 offen nt lds
    s_add_u32 s32, s32, 1024
    s_add_u32 m0, m0, 1040
    s_nop 0
    buffer_load_dwordx4 v2, s[4:7], s32 offen nt lds
    s_add_u32 s32, s32, 1024
    s_add_u32 m0, m0, 1040
    s_nop 0
    buffer_load_dwordx4 v2, s[4:7], s32 offen nt lds
    s_add_u32 s32, s32, 25600
    s_mov_b32 s33, 33280
    s_add_u32 m0, s33, s34
    s_nop 0
    buffer_load_dwordx4 v2, s[4:7], s32 offen nt lds
    s_add_u32 s32, s32, 1024
    s_add_u32 m0, m0, 1040
    s_nop 0
    buffer_load_dwordx4 v2, s[4:7], s32 offen nt lds
    s_add_u32 s32, s32, 1024
    s_add_u32 m0, m0, 1040
    s_nop 0
    buffer_load_dwordx4 v2, s[4:7], s32 offen nt lds
    s_add_u32 s32, s32, 1024
    s_add_u32 m0, m0, 1040
    s_nop 0
    buffer_load_dwordx4 v2, s[4:7], s32 offen nt lds
    s_add_u32 s32, s32, 1024
    s_add_u32 m0, m0, 1040
    s_nop 0
    buffer_load_dwordx4 v2, s[4:7], s32 offen nt lds
    s_add_u32 s32, s32, 1024
    s_add_u32 m0, m0, 1040
    s_nop 0
    buffer_load_dwordx4 v2, s[4:7], s32 offen nt lds
    s_add_u32 s32, s32, 1024
    s_add_u32 m0, m0, 1040
    s_nop 0
    buffer_load_dwordx4 v2, s[4:7], s32 offen nt lds
    s_add_u32 s32, s32, 1024
    s_add_u32 m0, m0, 1040
    s_nop 0
    buffer_load_dwordx4 v2, s[4:7], s32 offen nt lds
    s_add_u32 s32, s32, 25600
    s_mov_b32 s33, 66560
    s_add_u32 m0, s33, s34
    s_nop 0
    buffer_load_dwordx4 v2, s[4:7], s32 offen nt lds
    s_add_u32 s32, s32, 1024
    s_add_u32 m0, m0, 1040
    s_nop 0
    buffer_load_dwordx4 v2, s[4:7], s32 offen nt lds
    s_add_u32 s32, s32, 1024
    s_add_u32 m0, m0, 1040
    s_nop 0
    buffer_load_dwordx4 v2, s[4:7], s32 offen nt lds
    s_add_u32 s32, s32, 1024
    s_add_u32 m0, m0, 1040
    s_nop 0
    buffer_load_dwordx4 v2, s[4:7], s32 offen nt lds
    s_add_u32 s32, s32, 1024
    s_add_u32 m0, m0, 1040
    s_nop 0
    buffer_load_dwordx4 v2, s[4:7], s32 offen nt lds
    s_add_u32 s32, s32, 1024
    s_add_u32 m0, m0, 1040
    s_nop 0
    buffer_load_dwordx4 v2, s[4:7], s32 offen nt lds
    s_add_u32 s32, s32, 1024
    s_add_u32 m0, m0, 1040
    s_nop 0
    buffer_load_dwordx4 v2, s[4:7], s32 offen nt lds
    s_add_u32 s32, s32, 1024
    s_add_u32 m0, m0, 1040
    s_nop 0
    buffer_load_dwordx4 v2, s[4:7], s32 offen nt lds
    s_add_u32 s32, s32, 25600
    v_and_b32 v3, 31, v0
    v_lshrrev_b32 v4, 5, v0
    v_mul_u32_u24 v18, 1040, v3
    v_lshl_add_u32 v18, v4, 4, v18
    v_add_u32 v18, 99840, v18
    v_and_b32 v5, 16, v0
    v_and_b32 v6, 3, v0
    v_lshl_add_u32 v5, v6, 2, v5
    v_bfe_u32 v7, v0, 2, 2
    v_add_u32 v5, v5, v7
    v_mul_u32_u24 v19, 1040, v5
    v_lshl_add_u32 v19, v4, 4, v19
    v_lshl_add_u32 v5, v7, 2, v4
    v_mul_u32_u24 v20, 1040, v5
    v_lshl_add_u32 v20, v6, 3, v20
    v_bfe_u32 v5, v0, 4, 1
    v_lshl_add_u32 v20, v5, 5, v20
    s_lshl_b32 s24, s3, 8
    v_add_u32 v20, s24, v20
    s_cmp_lg_u32 s3, 0
    s_cbranch_scc1 L_aw7_x
    s_mov_b32 s24, 262144
L_aw7:
    buffer_load_dword v1, off, s[16:19], 0 offset:64 sc1
    s_waitcnt vmcnt(0)
    v_readfirstlane_b32 s25, v1
    s_nop 0
    s_cmp_ge_u32 s25, 32
    s_cbranch_scc1 L_aw7_x
    s_sleep 16
    s_sub_u32 s24, s24, 1
    s_cmp_lg_u32 s24, 0
    s_cbranch_scc1 L_aw7
L_aw7_x:
    s_barrier
    s_lshr_b32 s28, s26, 3
    s_lshl_b32 s24, s28, 15
    s_lshl_b32 s25, s3, 13
    s_add_u32 s24, s24, s25
    s_add_u32 s24, s24, 0x0
    buffer_load_dwordx4 v[32:35], v2, s[12:15], s24 offen offset:0 sc1
    buffer_load_dwordx4 v[36:39], v2, s[12:15], s24 offen offset:1024 sc1
    buffer_load_dwordx4 v[40:43], v2, s[12:15], s24 offen offset:2048 sc1
    buffer_load_dwordx4 v[44:47], v2, s[12:15], s24 offen offset:3072 sc1
    s_add_u32 s24, s24, 4096
    buffer_load_dwordx4 v[48:51], v2, s[12:15], s24 offen offset:0 sc1
    buffer_load_dwordx4 v[52:55], v2, s[12:15], s24 offen offset:1024 sc1
    buffer_load_dwordx4 v[56:59], v2, s[12:15], s24 offen offset:2048 sc1
    buffer_load_dwordx4 v[60:63], v2, s[12:15], s24 offen offset:3072 sc1
    s_add_u32 s24, s34, 99840
    v_add_u32 v3, s24, v2
    s_waitcnt vmcnt(7)
    ds_write_b128 v3, v[32:35] offset:0
    s_waitcnt vmcnt(6)
    ds_write_b128 v3, v[36:39] offset:1040
    s_waitcnt vmcnt(5)
    ds_write_b128 v3, v[40:43] offset:2080
    s_waitcnt vmcnt(4)
    ds_write_b128 v3, v[44:47] offset:3120
    s_waitcnt vmcnt(3)
    ds_write_b128 v3, v[48:51] offset:4160
    s_waitcnt vmcnt(2)
    ds_write_b128 v3, v[52:55] offset:5200
    s_waitcnt vmcnt(1)
    ds_write_b128 v3, v[56:59] offset:6240
    s_waitcnt vmcnt(0)
    ds_write_b128 v3, v[60:63] offset:7280
    s_waitcnt lgkmcnt(0)
    s_barrier
    s_cmp_lg_u32 s3, 0
    s_cbranch_scc1 L_cs8
    s_mov_b64 exec, 1
    v_mov_b32 v3, 1
    buffer_atomic_add v3, off, s[16:19], 0 offset:0
    s_mov_b64 exec, -1
L_cs8:
    ds_read_b128 a[0:3], v18 offset:0
    ds_read_b128 a[4:7], v18 offset:32
    ds_read_b128 a[8:11], v18 offset:64
    ds_read_b128 a[12:15], v18 offset:96
    ds_read_b128 a[16:19], v18 offset:128
    ds_read_b128 a[20:23], v18 offset:160
    ds_read_b128 a[24:27], v18 offset:192
    ds_read_b128 a[28:31], v18 offset:224
    ds_read_b128 a[32:35], v18 offset:256
    ds_read_b128 a[36:39], v18 offset:288
    ds_read_b128 a[40:43], v18 offset:320
    ds_read_b128 a[44:47], v18 offset:352
    ds_read_b128 a[48:51], v18 offset:384
    ds_read_b128 a[52:55], v18 offset:416
    ds_read_b128 a[56:59], v18 offset:448
    ds_read_b128 a[60:63], v18 offset:480
    ds_read_b128 a[64:67], v18 offset:512
    ds_read_b128 a[68:71], v18 offset:544
    ds_read_b128 a[72:75], v18 offset:576
    ds_read_b128 a[76:79], v18 offset:608
    ds_read_b128 a[80:83], v18 offset:640
    ds_read_b128 a[84:87], v18 offset:672
    ds_read_b128 a[88:91], v18 offset:704
    ds_read_b128 a[92:95], v18 offset:736
    ds_read_b128 a[96:99], v18 offset:768
    ds_read_b128 a[100:103], v18 offset:800
    ds_read_b128 a[104:107], v18 offset:832
    ds_read_b128 a[108:111], v18 offset:864
    ds_read_b128 a[112:115], v18 offset:896
    ds_read_b128 a[116:119], v18 offset:928
    ds_read_b128 a[120:123], v18 offset:960
    ds_read_b128 a[124:127], v18 offset:992
    v_mov_b32 v128, 0
    v_mov_b32 v129, 0
    v_mov_b32 v130, 0
    v_mov_b32 v131, 0
    v_mov_b32 v132, 0
    v_mov_b32 v133, 0
    v_mov_b32 v134, 0
    v_mov_b32 v135, 0
    v_mov_b32 v136, 0
    v_mov_b32 v137, 0
    v_mov_b32 v138, 0
    v_mov_b32 v139, 0
    v_mov_b32 v140, 0
    v_mov_b32 v141, 0
    v_mov_b32 v142, 0
    v_mov_b32 v143, 0
    v_mov_b32 v144, 0
    v_mov_b32 v145, 0
    v_mov_b32 v146, 0
    v_mov_b32 v147, 0
    v_mov_b32 v148, 0
    v_mov_b32 v149, 0
    v_mov_b32 v150, 0
    v_mov_b32 v151, 0
    v_mov_b32 v152, 0
    v_mov_b32 v153, 0
    v_mov_b32 v154, 0
    v_mov_b32 v155, 0
    v_mov_b32 v156, 0
    v_mov_b32 v157, 0
    v_mov_b32 v158, 0
    v_mov_b32 v159, 0
    v_mov_b32 v160, 0
    v_mov_b32 v161, 0
    v_mov_b32 v162, 0
    v_mov_b32 v163, 0
    v_mov_b32 v164, 0
    v_mov_b32 v165, 0
    v_mov_b32 v166, 0
    v_mov_b32 v167, 0
    v_mov_b32 v168, 0
    v_mov_b32 v169, 0
    v_mov_b32 v170, 0
    v_mov_b32 v171, 0
    v_mov_b32 v172, 0
    v_mov_b32 v173, 0
    v_mov_b32 v174, 0
    v_mov_b32 v175, 0
    v_mov_b32 v176, 0
    v_mov_b32 v177, 0
    v_mov_b32 v178, 0
    v_mov_b32 v179, 0
    v_mov_b32 v180, 0
    v_mov_b32 v181, 0
    v_mov_b32 v182, 0
    v_mov_b32 v183, 0
    v_mov_b32 v184, 0
    v_mov_b32 v185, 0
    v_mov_b32 v186, 0
    v_mov_b32 v187, 0
    v_mov_b32 v188, 0
    v_mov_b32 v189, 0
    v_mov_b32 v190, 0
    v_mov_b32 v191, 0
    v_mov_b32 v22, 0xff800000
    v_mov_b32 v23, 0
    s_mov_b32 s27, 0
    s_mov_b32 s33, 99840
    s_mov_b32 s35, 0
    s_waitcnt lgkmcnt(0)
L_CT:
    s_waitcnt vmcnt(16)
    s_barrier
    s_add_u32 m0, s33, s34
    s_nop 0
    buffer_load_dwordx4 v2, s[4:7], s32 offen nt lds
    s_add_u32 s32, s32, 1024
    s_add_u32 m0, m0, 1040
    s_nop 0
    buffer_load_dwordx4 v2, s[4:7], s32 offen nt lds
    s_add_u32 s32, s32, 1024
    s_add_u32 m0, m0, 1040
    s_nop 0
    buffer_load_dwordx4 v2, s[4:7], s32 offen nt lds
    s_add_u32 s32, s32, 1024
    s_add_u32 m0, m0, 1040
    s_nop 0
    buffer_load_dwordx4 v2, s[4:7], s32 offen nt lds
    s_add_u32 s32, s32, 1024
    s_add_u32 m0, m0, 1040
    s_nop 0
    buffer_load_dwordx4 v2, s[4:7], s32 offen nt lds
    s_add_u32 s32, s32, 1024
    s_add_u32 m0, m0, 1040
    s_nop 0
    buffer_load_dwordx4 v2, s[4:7], s32 offen nt lds
    s_add_u32 s32, s32, 1024
    s_add_u32 m0, m0, 1040
    s_nop 0
    buffer_load_dwordx4 v2, s[4:7], s32 offen nt lds
    s_add_u32 s32, s32, 1024
    s_add_u32 m0, m0, 1040
    s_nop 0
    buffer_load_dwordx4 v2, s[4:7], s32 offen nt lds
    s_add_u32 s32, s32, 25600
    v_add_u32 v24, s35, v19
    v_add_u32 v25, s35, v20
    s_mov_b32 s33, s35
    s_add_u32 s35, s35, 33280
    s_cmp_eq_u32 s35, 133120
    s_cselect_b32 s35, 0, s35
    ds_read_b128 v[32:35], v24 offset:0
    ds_read_b128 v[36:39], v24 offset:32
    ds_read_b128 v[40:43], v24 offset:64
    ds_read_b128 v[44:47], v24 offset:96
    ds_read_b128 v[48:51], v24 offset:128
    ds_read_b128 v[52:55], v24 offset:160
    ds_read_b128 v[56:59], v24 offset:192
    s_waitcnt lgkmcnt(6)
    v_mfma_f32_32x32x16_bf16 v[64:79], v[32:35], a[0:3], 0
    ds_read_b128 v[60:63], v24 offset:224
    s_waitcnt lgkmcnt(6)
    v_mfma_f32_32x32x16_bf16 v[64:79], v[36:39], a[4:7], v[64:79]
    ds_read_b128 v[32:35], v24 offset:256
    s_waitcnt lgkmcnt(6)
    v_mfma_f32_32x32x16_bf16 v[64:79], v[40:43], a[8:11], v[64:79]
    ds_read_b128 v[36:39], v24 offset:288
    s_waitcnt lgkmcnt(6)
    v_mfma_f32_32x32x16_bf16 v[64:79], v[44:47], a[12:15], v[64:79]
    ds_read_b128 v[40:43], v24 offset:320
    s_waitcnt lgkmcnt(6)
    v_mfma_f32_32x32x16_bf16 v[64:79], v[48:51], a[16:19], v[64:79]
    ds_read_b128 v[44:47], v24 offset:352
    s_waitcnt lgkmcnt(6)
    v_mfma_f32_32x32x16_bf16 v[64:79], v[52:55], a[20:23], v[64:79]
    ds_read_b128 v[48:51], v24 offset:384
    s_waitcnt lgkmcnt(6)
    v_mfma_f32_32x32x16_bf16 v[64:79], v[56:59], a[24:27], v[64:79]
    ds_read_b128 v[52:55], v24 offset:416
    s_waitcnt lgkmcnt(6)
    v_mfma_f32_32x32x16_bf16 v[64:79], v[60:63], a[28:31], v[64:79]
    ds_read_b128 v[56:59], v24 offset:448
    s_waitcnt lgkmcnt(6)
    v_mfma_f32_32x32x16_bf16 v[64:79], v[32:35], a[32:35], v[64:79]
    ds_read_b128 v[60:63], v24 offset:480
    s_waitcnt lgkmcnt(6)
    v_mfma_f32_32x32x16_bf16 v[64:79], v[36:39], a[36:39], v[64:79]
    ds_read_b128 v[32:35], v24 offset:512
    s_waitcnt lgkmcnt(6)
    v_mfma_f32_32x32x16_bf16 v[64:79], v[40:43], a[40:43], v[64:79]
    ds_read_b128 v[36:39], v24 offset:544
    s_waitcnt lgkmcnt(6)
    v_mfma_f32_32x32x16_bf16 v[64:79], v[44:47], a[44:47], v[64:79]
    ds_read_b128 v[40:43], v24 offset:576
    s_waitcnt lgkmcnt(6)
    v_mfma_f32_32x32x16_bf16 v[64:79], v[48:51], a[48:51], v[64:79]
    ds_read_b128 v[44:47], v24 offset:608
    s_waitcnt lgkmcnt(6)
    v_mfma_f32_32x32x16_bf16 v[64:79], v[52:55], a[52:55], v[64:79]
    ds_read_b128 v[48:51], v24 offset:640
    s_waitcnt lgkmcnt(6)
    v_mfma_f32_32x32x16_bf16 v[64:79], v[56:59], a[56:59], v[64:79]
    ds_read_b128 v[52:55], v24 offset:672
    s_waitcnt lgkmcnt(6)
    v_mfma_f32_32x32x16_bf16 v[64:79], v[60:63], a[60:63], v[64:79]
    ds_read_b128 v[56:59], v24 offset:704
    s_waitcnt lgkmcnt(6)
    v_mfma_f32_32x32x16_bf16 v[64:79], v[32:35], a[64:67], v[64:79]
    ds_read_b128 v[60:63], v24 offset:736
    s_waitcnt lgkmcnt(6)
    v_mfma_f32_32x32x16_bf16 v[64:79], v[36:39], a[68:71], v[64:79]
    ds_read_b128 v[32:35], v24 offset:768
    s_waitcnt lgkmcnt(6)
    v_mfma_f32_32x32x16_bf16 v[64:79], v[40:43], a[72:75], v[64:79]
    ds_read_b128 v[36:39], v24 offset:800
    s_waitcnt lgkmcnt(6)
    v_mfma_f32_32x32x16_bf16 v[64:79], v[44:47], a[76:79], v[64:79]
    ds_read_b128 v[40:43], v24 offset:832
    s_waitcnt lgkmcnt(6)
    v_mfma_f32_32x32x16_bf16 v[64:79], v[48:51], a[80:83], v[64:79]
    ds_read_b128 v[44:47], v24 offset:864
    s_waitcnt lgkmcnt(6)
    v_mfma_f32_32x32x16_bf16 v[64:79], v[52:55], a[84:87], v[64:79]
    ds_read_b128 v[48:51], v24 offset:896
    s_waitcnt lgkmcnt(6)
    v_mfma_f32_32x32x16_bf16 v[64:79], v[56:59], a[88:91], v[64:79]
    ds_read_b128 v[52:55], v24 offset:928
    s_waitcnt lgkmcnt(6)
    v_mfma_f32_32x32x16_bf16 v[64:79], v[60:63], a[92:95], v[64:79]
    ds_read_b128 v[56:59], v24 offset:960
    s_waitcnt lgkmcnt(6)
    v_mfma_f32_32x32x16_bf16 v[64:79], v[32:35], a[96:99], v[64:79]
    ds_read_b128 v[60:63], v24 offset:992
    s_waitcnt lgkmcnt(6)
    v_mfma_f32_32x32x16_bf16 v[64:79], v[36:39], a[100:103], v[64:79]
    ds_read_b64_tr_b16 v[96:97], v25 offset:0
    ds_read_b64_tr_b16 v[98:99], v25 offset:2080
    s_waitcnt lgkmcnt(7)
    v_mfma_f32_32x32x16_bf16 v[64:79], v[40:43], a[104:107], v[64:79]
    ds_read_b64_tr_b16 v[100:101], v25 offset:16640
    ds_read_b64_tr_b16 v[102:103], v25 offset:18720
    s_waitcnt lgkmcnt(8)
    v_mfma_f32_32x32x16_bf16 v[64:79], v[44:47], a[108:111], v[64:79]
    ds_read_b64_tr_b16 v[104:105], v25 offset:64
    ds_read_b64_tr_b16 v[106:107], v25 offset:2144
    s_waitcnt lgkmcnt(9)
    v_mfma_f32_32x32x16_bf16 v[64:79], v[48:51], a[112:115], v[64:79]
    ds_read_b64_tr_b16 v[108:109], v25 offset:16704
    ds_read_b64_tr_b16 v[110:111], v25 offset:18784
    s_waitcnt lgkmcnt(10)
    v_mfma_f32_32x32x16_bf16 v[64:79], v[52:55], a[116:119], v[64:79]
    ds_read_b64_tr_b16 v[112:113], v25 offset:128
    ds_read_b64_tr_b16 v[114:115], v25 offset:2208
    s_waitcnt lgkmcnt(11)
    v_mfma_f32_32x32x16_bf16 v[64:79], v[56:59], a[120:123], v[64:79]
    ds_read_b64_tr_b16 v[116:117], v25 offset:16768
    ds_read_b64_tr_b16 v[118:119], v25 offset:18848
    s_waitcnt lgkmcnt(12)
    v_mfma_f32_32x32x16_bf16 v[64:79], v[60:63], a[124:127], v[64:79]
    ds_read_b64_tr_b16 v[120:121], v25 offset:192
    ds_read_b64_tr_b16 v[122:123], v25 offset:2272
    ds_read_b64_tr_b16 v[124:125], v25 offset:16832
    ds_read_b64_tr_b16 v[126:127], v25 offset:18912
    s_nop 7
    v_max3_f32 v3, v64, v65, v22
    v_max3_f32 v3, v3, v66, v67
    v_max3_f32 v3, v3, v68, v69
    v_max3_f32 v3, v3, v70, v71
    v_max3_f32 v3, v3, v72, v73
    v_max3_f32 v3, v3, v74, v75
    v_max3_f32 v3, v3, v76, v77
    v_max3_f32 v3, v3, v78, v79
    v_mov_b32 v4, v3
    s_nop 1
    v_permlane32_swap_b32 v3, v4
    v_max_f32 v3, v3, v4
    v_sub_f32 v4, v22, v3
    v_exp_f32 v4, v4
    v_mov_b32 v22, v3
    v_sub_f32 v64, v64, v3
    v_sub_f32 v65, v65, v3
    v_sub_f32 v66, v66, v3
    v_sub_f32 v67, v67, v3
    v_sub_f32 v68, v68, v3
    v_sub_f32 v69, v69, v3
    v_sub_f32 v70, v70, v3
    v_sub_f32 v71, v71, v3
    v_sub_f32 v72, v72, v3
    v_sub_f32 v73, v73, v3
    v_sub_f32 v74, v74, v3
    v_sub_f32 v75, v75, v3
    v_sub_f32 v76, v76, v3
    v_sub_f32 v77, v77, v3
    v_sub_f32 v78, v78, v3
    v_sub_f32 v79, v79, v3
    v_exp_f32 v64, v64
    v_exp_f32 v65, v65
    v_exp_f32 v66, v66
    v_exp_f32 v67, v67
    v_exp_f32 v68, v68
    v_exp_f32 v69, v69
    v_exp_f32 v70, v70
    v_exp_f32 v71, v71
    v_exp_f32 v72, v72
    v_exp_f32 v73, v73
    v_exp_f32 v74, v74
    v_exp_f32 v75, v75
    v_exp_f32 v76, v76
    v_exp_f32 v77, v77
    v_exp_f32 v78, v78
    v_exp_f32 v79, v79
    v_pk_mul_f32 v[128:129], v[128:129], v[4:5] op_sel_hi:[1,0]
    v_pk_mul_f32 v[130:131], v[130:131], v[4:5] op_sel_hi:[1,0]
    v_pk_mul_f32 v[132:133], v[132:133], v[4:5] op_sel_hi:[1,0]
    v_pk_mul_f32 v[134:135], v[134:135], v[4:5] op_sel_hi:[1,0]
    v_pk_mul_f32 v[136:137], v[136:137], v[4:5] op_sel_hi:[1,0]
    v_pk_mul_f32 v[138:139], v[138:139], v[4:5] op_sel_hi:[1,0]
    v_pk_mul_f32 v[140:141], v[140:141], v[4:5] op_sel_hi:[1,0]
    v_pk_mul_f32 v[142:143], v[142:143], v[4:5] op_sel_hi:[1,0]
    v_pk_mul_f32 v[144:145], v[144:145], v[4:5] op_sel_hi:[1,0]
    v_pk_mul_f32 v[146:147], v[146:147], v[4:5] op_sel_hi:[1,0]
    v_pk_mul_f32 v[148:149], v[148:149], v[4:5] op_sel_hi:[1,0]
    v_pk_mul_f32 v[150:151], v[150:151], v[4:5] op_sel_hi:[1,0]
    v_pk_mul_f32 v[152:153], v[152:153], v[4:5] op_sel_hi:[1,0]
    v_pk_mul_f32 v[154:155], v[154:155], v[4:5] op_sel_hi:[1,0]
    v_pk_mul_f32 v[156:157], v[156:157], v[4:5] op_sel_hi:[1,0]
    v_pk_mul_f32 v[158:159], v[158:159], v[4:5] op_sel_hi:[1,0]
    v_pk_mul_f32 v[160:161], v[160:161], v[4:5] op_sel_hi:[1,0]
    v_pk_mul_f32 v[162:163], v[162:163], v[4:5] op_sel_hi:[1,0]
    v_pk_mul_f32 v[164:165], v[164:165], v[4:5] op_sel_hi:[1,0]
    v_pk_mul_f32 v[166:167], v[166:167], v[4:5] op_sel_hi:[1,0]
    v_pk_mul_f32 v[168:169], v[168:169], v[4:5] op_sel_hi:[1,0]
    v_pk_mul_f32 v[170:171], v[170:171], v[4:5] op_sel_hi:[1,0]
    v_pk_mul_f32 v[172:173], v[172:173], v[4:5] op_sel_hi:[1,0]
    v_pk_mul_f32 v[174:175], v[174:175], v[4:5] op_sel_hi:[1,0]
    v_pk_mul_f32 v[176:177], v[176:177], v[4:5] op_sel_hi:[1,0]
    v_pk_mul_f32 v[178:179], v[178:179], v[4:5] op_sel_hi:[1,0]
    v_pk_mul_f32 v[180:181], v[180:181], v[4:5] op_sel_hi:[1,0]
    v_pk_mul_f32 v[182:183], v[182:183], v[4:5] op_sel_hi:[1,0]
    v_pk_mul_f32 v[184:185], v[184:185], v[4:5] op_sel_hi:[1,0]
    v_pk_mul_f32 v[186:187], v[186:187], v[4:5] op_sel_hi:[1,0]
    v_pk_mul_f32 v[188:189], v[188:189], v[4:5] op_sel_hi:[1,0]
    v_pk_mul_f32 v[190:191], v[190:191], v[4:5] op_sel_hi:[1,0]
    v_fma_f32 v23, v23, v4, v64
    v_add_f32 v23, v23, v65
    v_add_f32 v23, v23, v66
    v_add_f32 v23, v23, v67
    v_add_f32 v23, v23, v68
    v_add_f32 v23, v23, v69
    v_add_f32 v23, v23, v70
    v_add_f32 v23, v23, v71
    v_add_f32 v23, v23, v72
    v_add_f32 v23, v23, v73
    v_add_f32 v23, v23, v74
    v_add_f32 v23, v23, v75
    v_add_f32 v23, v23, v76
    v_add_f32 v23, v23, v77
    v_add_f32 v23, v23, v78
    v_add_f32 v23, v23, v79
    v_cvt_pk_bf16_f32 v80, v64, v65
    v_cvt_pk_bf16_f32 v81, v66, v67
    v_cvt_pk_bf16_f32 v82, v68, v69
    v_cvt_pk_bf16_f32 v83, v70, v71
    v_cvt_pk_bf16_f32 v84, v72, v73
    v_cvt_pk_bf16_f32 v85, v74, v75
    v_cvt_pk_bf16_f32 v86, v76, v77
    v_cvt_pk_bf16_f32 v87, v78, v79
    s_waitcnt lgkmcnt(0)
    v_mfma_f32_32x32x16_bf16 v[128:143], v[96:99], v[80:83], v[128:143]
    v_mfma_f32_32x32x16_bf16 v[144:159], v[104:107], v[80:83], v[144:159]
    v_mfma_f32_32x32x16_bf16 v[160:175], v[112:115], v[80:83], v[160:175]
    v_mfma_f32_32x32x16_bf16 v[176:191], v[120:123], v[80:83], v[176:191]
    v_mfma_f32_32x32x16_bf16 v[128:143], v[100:103], v[84:87], v[128:143]
    v_mfma_f32_32x32x16_bf16 v[144:159], v[108:111], v[84:87], v[144:159]
    v_mfma_f32_32x32x16_bf16 v[160:175], v[116:119], v[84:87], v[160:175]
    v_mfma_f32_32x32x16_bf16 v[176:191], v[124:127], v[84:87], v[176:191]
    s_add_u32 s27, s27, 1
    s_cmp_lt_u32 s27, 16
    s_cbranch_scc1 L_CT
    s_waitcnt vmcnt(0)
    s_barrier
    v_mov_b32 v4, v23
    s_nop 1
    v_permlane32_swap_b32 v23, v4
    v_add_f32 v23, v23, v4
    v_and_b32 v3, 31, v0
    v_lshlrev_b32 v5, 8, v3
    s_lshl_b32 s24, s26, 3
    s_add_u32 s24, s24, 0x120000
    s_cmp_lg_u32 s3, 0
    s_cbranch_scc1 L_C_ml
    buffer_store_dwordx2 v[22:23], v5, s[12:15], s24 offen sc1
L_C_ml:
    v_lshrrev_b32 v4, 5, v0
    v_mul_u32_u24 v3, 272, v3
    v_lshl_add_u32 v3, v4, 3, v3
    s_mul_i32 s24, s3, 8704
    v_add_u32 v3, s24, v3
    v_cvt_pk_bf16_f32 v32, v128, v129
    v_cvt_pk_bf16_f32 v33, v130, v131
    ds_write_b64 v3, v[32:33] offset:0
    v_cvt_pk_bf16_f32 v34, v132, v133
    v_cvt_pk_bf16_f32 v35, v134, v135
    ds_write_b64 v3, v[34:35] offset:16
    v_cvt_pk_bf16_f32 v36, v136, v137
    v_cvt_pk_bf16_f32 v37, v138, v139
    ds_write_b64 v3, v[36:37] offset:32
    v_cvt_pk_bf16_f32 v38, v140, v141
    v_cvt_pk_bf16_f32 v39, v142, v143
    ds_write_b64 v3, v[38:39] offset:48
    v_cvt_pk_bf16_f32 v40, v144, v145
    v_cvt_pk_bf16_f32 v41, v146, v147
    ds_write_b64 v3, v[40:41] offset:64
    v_cvt_pk_bf16_f32 v42, v148, v149
    v_cvt_pk_bf16_f32 v43, v150, v151
    ds_write_b64 v3, v[42:43] offset:80
    v_cvt_pk_bf16_f32 v44, v152, v153
    v_cvt_pk_bf16_f32 v45, v154, v155
    ds_write_b64 v3, v[44:45] offset:96
    v_cvt_pk_bf16_f32 v46, v156, v157
    v_cvt_pk_bf16_f32 v47, v158, v159
    ds_write_b64 v3, v[46:47] offset:112
    v_cvt_pk_bf16_f32 v32, v160, v161
    v_cvt_pk_bf16_f32 v33, v162, v163
    ds_write_b64 v3, v[32:33] offset:128
    v_cvt_pk_bf16_f32 v34, v164, v165
    v_cvt_pk_bf16_f32 v35, v166, v167
    ds_write_b64 v3, v[34:35] offset:144
    v_cvt_pk_bf16_f32 v36, v168, v169
    v_cvt_pk_bf16_f32 v37, v170, v171
    ds_write_b64 v3, v[36:37] offset:160
    v_cvt_pk_bf16_f32 v38, v172, v173
    v_cvt_pk_bf16_f32 v39, v174, v175
    ds_write_b64 v3, v[38:39] offset:176
    v_cvt_pk_bf16_f32 v40, v176, v177
    v_cvt_pk_bf16_f32 v41, v178, v179
    ds_write_b64 v3, v[40:41] offset:192
    v_cvt_pk_bf16_f32 v42, v180, v181
    v_cvt_pk_bf16_f32 v43, v182, v183
    ds_write_b64 v3, v[42:43] offset:208
    v_cvt_pk_bf16_f32 v44, v184, v185
    v_cvt_pk_bf16_f32 v45, v186, v187
    ds_write_b64 v3, v[44:45] offset:224
    v_cvt_pk_bf16_f32 v46, v188, v189
    v_cvt_pk_bf16_f32 v47, v190, v191
    ds_write_b64 v3, v[46:47] offset:240
    v_lshrrev_b32 v4, 4, v0
    v_and_b32 v5, 15, v0
    v_mul_u32_u24 v3, 272, v4
    v_lshl_add_u32 v3, v5, 4, v3
    v_add_u32 v3, s24, v3
    v_lshlrev_b32 v4, 15, v4
    v_lshl_add_u32 v4, v5, 4, v4
    s_waitcnt lgkmcnt(0)
    ds_read_b128 v[64:67], v3 offset:0
    ds_read_b128 v[68:71], v3 offset:1088
    ds_read_b128 v[72:75], v3 offset:2176
    ds_read_b128 v[76:79], v3 offset:3264
    ds_read_b128 v[80:83], v3 offset:4352
    ds_read_b128 v[84:87], v3 offset:5440
    ds_read_b128 v[88:91], v3 offset:6528
    ds_read_b128 v[92:95], v3 offset:7616
    s_lshl_b32 s24, s26, 10
    s_lshl_b32 s25, s3, 8
    s_add_u32 s24, s24, s25
    s_add_u32 s24, s24, 0x20000
    s_waitcnt lgkmcnt(7)
    buffer_store_dwordx4 v[64:67], v4, s[12:15], s24 offen sc1
    s_add_u32 s24, s24, 0x20000
    s_waitcnt lgkmcnt(6)
    buffer_store_dwordx4 v[68:71], v4, s[12:15], s24 offen sc1
    s_add_u32 s24, s24, 0x20000
    s_waitcnt lgkmcnt(5)
    buffer_store_dwordx4 v[72:75], v4, s[12:15], s24 offen sc1
    s_add_u32 s24, s24, 0x20000
    s_waitcnt lgkmcnt(4)
    buffer_store_dwordx4 v[76:79], v4, s[12:15], s24 offen sc1
    s_add_u32 s24, s24, 0x20000
    s_waitcnt lgkmcnt(3)
    buffer_store_dwordx4 v[80:83], v4, s[12:15], s24 offen sc1
    s_add_u32 s24, s24, 0x20000
    s_waitcnt lgkmcnt(2)
    buffer_store_dwordx4 v[84:87], v4, s[12:15], s24 offen sc1
    s_add_u32 s24, s24, 0x20000
    s_waitcnt lgkmcnt(1)
    buffer_store_dwordx4 v[88:91], v4, s[12:15], s24 offen sc1
    s_add_u32 s24, s24, 0x20000
    s_waitcnt lgkmcnt(0)
    buffer_store_dwordx4 v[92:95], v4, s[12:15], s24 offen sc1
    s_add_u32 s24, s24, 0x20000
    s_waitcnt vmcnt(0)
    s_barrier
    s_cmp_lg_u32 s3, 0
    s_cbranch_scc1 L_sig9
    s_mov_b64 exec, 1
    v_mov_b32 v1, 1
    buffer_atomic_add v1, off, s[16:19], 0 offset:128
    s_mov_b64 exec, -1
L_sig9:
L_R:
    s_mov_b32 s20, s58
    s_mov_b32 s21, s59
    s_mov_b32 s22, 0x2000
    s_mov_b32 s23, 0x20000
    v_lshrrev_b32 v3, 4, v0
    v_and_b32 v4, 7, v0
    v_lshl_add_u32 v5, v3, 3, v4
    v_lshlrev_b32 v27, 4, v5
    v_add_u32 v27, 144640, v27
    s_lshl_b32 s24, s3, 2
    v_add_u32 v26, s24, v27
    v_lshlrev_b32 v28, 11, v3
    v_lshl_add_u32 v28, v4, 1, v28
    s_lshl_b32 s24, s74, 4
    v_add_u32 v28, s24, v28
    v_lshrrev_b32 v5, 1, v3
    v_lshlrev_b32 v29, 11, v5
    v_and_b32 v5, 1, v3
    v_lshl_add_u32 v29, v5, 7, v29
    v_lshl_add_u32 v29, v4, 1, v29
    s_lshr_b32 s28, s74, 5
    s_lshl_b32 s24, s28, 12
    s_bfe_u32 s25, s74, 0x20003
    s_lshl_b32 s25, s25, 8
    s_add_u32 s24, s24, s25
    s_and_b32 s25, s74, 7
    s_lshl_b32 s25, s25, 4
    s_add_u32 s24, s24, s25
    s_add_u32 s24, s24, 1024
    v_add_u32 v29, s24, v29
    v_and_b32 v5, 31, v17
    v_lshlrev_b32 v5, 13, v5
    v_lshl_add_u32 v30, v4, 4, v5
    s_cmp_lg_u32 s3, 0
    s_cbranch_scc1 L_aw10_x
    s_mov_b32 s24, 262144
L_aw10:
    buffer_load_dword v1, off, s[16:19], 0 offset:192 sc1
    s_waitcnt vmcnt(0)
    v_readfirstlane_b32 s25, v1
    s_nop 0
    s_cmp_ge_u32 s25, 32
    s_cbranch_scc1 L_aw10_x
    s_sleep 16
    s_sub_u32 s24, s24, 1
    s_cmp_lg_u32 s24, 0
    s_cbranch_scc1 L_aw10
L_aw10_x:
    s_barrier
    s_lshl_b32 s24, s74, 7
    s_add_u32 s24, s24, 0x124000
    buffer_load_dwordx4 v[4:7], v30, s[12:15], s24 offen sc1
    s_waitcnt vmcnt(0)
    v_permlane32_swap_b32 v4, v6
    v_permlane32_swap_b32 v5, v7
    v_add_f32 v4, v4, v6
    v_add_f32 v5, v5, v7
    s_nop 1
    v_permlane16_swap_b32 v4, v5
    v_add_f32 v4, v4, v5
    s_nop 1
    v_add_f32_dpp v4, v4, v4 row_ror:8 row_mask:0xf bank_mask:0xf
    ds_write_b32 v26, v4
    s_waitcnt lgkmcnt(0)
    s_barrier
    s_cmp_lg_u32 s3, 0
    s_cbranch_scc1 L_fr11
    ds_read_b128 v[4:7], v27
    s_waitcnt lgkmcnt(0)
    v_add_f32 v4, v4, v5
    v_add_f32 v6, v6, v7
    v_add_f32 v4, v4, v6
    v_cvt_pk_bf16_f32 v4, v4, v4
    buffer_store_short v4, v28, s[20:23], 0 offen
L_fr11:
    v_mul_u32_u24 v31, 96, v17
    s_mov_b32 s29, 0x230000
    s_mov_b32 s24, 262144
L_R_ml:
    buffer_load_dwordx4 v[32:35], v31, s[12:15], s29 offen offset:0 sc1
    buffer_load_dwordx4 v[36:39], v31, s[12:15], s29 offen offset:16 sc1
    buffer_load_dwordx4 v[40:43], v31, s[12:15], s29 offen offset:32 sc1
    buffer_load_dwordx4 v[44:47], v31, s[12:15], s29 offen offset:48 sc1
    buffer_load_dwordx4 v[48:51], v31, s[12:15], s29 offen offset:64 sc1
    buffer_load_dwordx4 v[52:55], v31, s[12:15], s29 offen offset:80 sc1
    s_waitcnt vmcnt(0)
    v_max3_u32 v3, v32, v33, v34
    v_max3_u32 v3, v3, v35, v36
    v_max3_u32 v3, v3, v37, v38
    v_max3_u32 v3, v3, v39, v40
    v_max3_u32 v3, v3, v41, v42
    v_max3_u32 v3, v3, v43, v44
    v_max3_u32 v3, v3, v45, v46
    v_max3_u32 v3, v3, v47, v48
    v_max3_u32 v3, v3, v49, v50
    v_max3_u32 v3, v3, v51, v52
    v_max3_u32 v3, v3, v53, v54
    v_max_u32 v3, v3, v55
    v_cmp_eq_u32 vcc, -1, v3
    s_nop 4
    s_cbranch_vccz L_R_mlx
    s_sleep 16
    s_sub_u32 s24, s24, 1
    s_cmp_lg_u32 s24, 0
    s_cbranch_scc1 L_R_ml
L_R_mlx:
    v_max3_f32 v3, v32, v40, v48
    v_sub_f32 v56, v32, v3
    v_exp_f32 v56, v56
    v_add_f32 v33, v33, v35
    v_sub_f32 v58, v40, v3
    v_exp_f32 v58, v58
    v_add_f32 v41, v41, v43
    v_sub_f32 v60, v48, v3
    v_exp_f32 v60, v60
    v_add_f32 v49, v49, v51
    v_mul_f32 v4, v56, v33
    v_fmac_f32 v4, v58, v41
    v_fmac_f32 v4, v60, v49
    v_rcp_f32 v4, v4
    s_nop 0
    v_mul_f32 v56, v56, v4
    v_mul_f32 v58, v58, v4
    v_mul_f32 v60, v60, v4
    v_max3_f32 v3, v36, v44, v52
    v_sub_f32 v57, v36, v3
    v_exp_f32 v57, v57
    v_add_f32 v37, v37, v39
    v_sub_f32 v59, v44, v3
    v_exp_f32 v59, v59
    v_add_f32 v45, v45, v47
    v_sub_f32 v61, v52, v3
    v_exp_f32 v61, v61
    v_add_f32 v53, v53, v55
    v_mul_f32 v4, v57, v37
    v_fmac_f32 v4, v59, v45
    v_fmac_f32 v4, v61, v53
    v_rcp_f32 v4, v4
    s_nop 0
    v_mul_f32 v57, v57, v4
    v_mul_f32 v59, v59, v4
    v_mul_f32 v61, v61, v4
    s_cmp_lg_u32 s3, 0
    s_cbranch_scc1 L_R_nx
    s_mul_i32 s29, s28, 384
    s_add_u32 s29, s29, 0x232000
    s_mov_b32 s24, 262144
    v_min_u32 v3, 23, v0
    v_lshlrev_b32 v3, 4, v3
L_R_n:
    buffer_load_dwordx4 v[4:7], v3, s[12:15], s29 offen sc1
    s_waitcnt vmcnt(0)
    v_max3_u32 v4, v4, v5, v6
    v_max_u32 v4, v4, v7
    v_cmp_eq_u32 vcc, -1, v4
    s_nop 4
    s_cbranch_vccz L_R_nx
    s_sleep 8
    s_sub_u32 s24, s24, 1
    s_cmp_lg_u32 s24, 0
    s_cbranch_scc1 L_R_n
L_R_nx:
    s_barrier
    s_mov_b32 s24, 262144
    s_mov_b32 s29, 4096
    s_mov_b32 s30, 8192
L_R_y:
    buffer_load_dwordx4 v[64:67], v16, s[12:15], 0 offen sc1
    buffer_load_dwordx4 v[68:71], v16, s[12:15], s29 offen sc1
    buffer_load_dwordx4 v[72:75], v16, s[12:15], s30 offen sc1
    s_waitcnt vmcnt(0)
    v_max3_u32 v3, v64, v65, v66
    v_max3_u32 v3, v3, v67, v68
    v_max3_u32 v3, v3, v69, v70
    v_max3_u32 v3, v3, v71, v72
    v_max3_u32 v3, v3, v73, v74
    v_max_u32 v3, v3, v75
    v_cmp_eq_u32 vcc, -1, v3
    s_sub_u32 s24, s24, 1
    s_cmp_eq_u32 s24, 0
    s_cbranch_scc1 L_R_yx
    s_and_b64 exec, exec, vcc
    s_cbranch_scc1 L_R_y
L_R_yx:
    s_mov_b64 exec, -1
    v_mul_f32 v4, v56, v64
    v_mul_f32 v5, v56, v65
    v_mul_f32 v6, v57, v66
    v_mul_f32 v7, v57, v67
    v_fmac_f32 v4, v58, v68
    v_fmac_f32 v5, v58, v69
    v_fmac_f32 v6, v59, v70
    v_fmac_f32 v7, v59, v71
    v_fmac_f32 v4, v60, v72
    v_fmac_f32 v5, v60, v73
    v_fmac_f32 v6, v61, v74
    v_fmac_f32 v7, v61, v75
    s_nop 0
    v_permlane32_swap_b32 v4, v6
    v_permlane32_swap_b32 v5, v7
    v_add_f32 v4, v4, v6
    v_add_f32 v5, v5, v7
    s_nop 1
    v_permlane16_swap_b32 v4, v5
    v_add_f32 v4, v4, v5
    s_nop 1
    v_add_f32_dpp v4, v4, v4 row_ror:8 row_mask:0xf bank_mask:0xf
    ds_write_b32 v26, v4
    s_waitcnt lgkmcnt(0)
    s_barrier
    s_cmp_lg_u32 s3, 0
    s_cbranch_scc1 L_fr12
    ds_read_b128 v[4:7], v27
    s_waitcnt lgkmcnt(0)
    v_add_f32 v4, v4, v5
    v_add_f32 v6, v6, v7
    v_add_f32 v4, v4, v6
    v_cvt_pk_bf16_f32 v4, v4, v4
    buffer_store_short v4, v29, s[20:23], 0 offen
L_fr12:
L_end:
    s_endpgm
.section .rodata,"a"
.p2align 6
.amdhsa_kernel concat_heads__compressed_kv_cla__mha_block_cached__decode_kernel
  .amdhsa_next_free_vgpr 384
  .amdhsa_next_free_sgpr 102
  .amdhsa_accum_offset 256
  .amdhsa_group_segment_fixed_size 0
  .amdhsa_kernarg_size 112
  .amdhsa_user_sgpr_count 2
  .amdhsa_user_sgpr_kernarg_segment_ptr 1
  .amdhsa_system_sgpr_workgroup_id_x 1
  .amdhsa_float_denorm_mode_32 3
.end_amdhsa_kernel
```

```asm
; @launch grid=(256,1,1) block=(256,1,1) lds=149504
.amdgcn_target "amdgcn-amd-amdhsa--gfx950"
.text
.globl concat_heads__compressed_kv_cla__mha_block_cached__decode_kernel
.p2align 8
.type concat_heads__compressed_kv_cla__mha_block_cached__decode_kernel,@function
concat_heads__compressed_kv_cla__mha_block_cached__decode_kernel:
    s_load_dwordx16 s[36:51], s[0:1], 0
    s_load_dwordx8 s[52:59], s[0:1], 64
    s_load_dwordx4 s[60:63], s[0:1], 96
    s_cmp_ge_u32 s2, 256
    s_cbranch_scc1 L_end
    v_lshrrev_b32 v1, 6, v0
    v_and_b32 v0, 63, v0
    v_readfirstlane_b32 s3, v1
    v_lshlrev_b32 v2, 4, v0
    s_cmp_lt_u32 s2, 64
    s_cbranch_scc1 L_A
L_B:
    s_getpc_b64 s[20:21]
L_pc1:
    s_sub_u32 s20, s20, L_pc1-L_B
    s_subb_u32 s21, s21, 0
    s_mov_b32 s22, L_A-L_B
    s_mov_b32 s23, 0x20000
    v_lshl_add_u32 v3, v0, 2, s3
    v_lshlrev_b32 v3, 7, v3
    buffer_load_dword v17, v3, s[20:23], 0 offen
    s_sub_u32 s24, s2, 64
    s_and_b32 s25, s24, 7
    s_lshr_b32 s24, s24, 3
    s_mul_i32 s26, s24, 43
    s_lshr_b32 s26, s26, 8
    s_mul_i32 s27, s26, 6
    s_sub_u32 s27, s24, s27
    s_lshl_b32 s25, s25, 2
    s_add_u32 s26, s26, s25
    s_cmp_ge_u32 s27, 3
    s_cselect_b32 s28, 1, 0
    s_mul_i32 s29, s28, 3
    s_sub_u32 s29, s27, s29
    s_lshr_b32 s72, s3, 1
    s_lshl_b32 s24, s28, 1
    s_add_u32 s72, s72, s24
    s_and_b32 s31, s3, 1
    s_lshl_b32 s24, s29, 1
    s_add_u32 s31, s31, s24
    s_lshl_b32 s30, s72, 5
    s_add_u32 s30, s30, s26
    s_lshl_b32 s30, s30, 20
    v_lshrrev_b32 v3, 4, v0
    v_and_b32 v4, 3, v0
    v_lshlrev_b32 v5, 6, v3
    v_lshl_add_u32 v5, v4, 4, v5
    v_bfe_u32 v1, v0, 2, 2
    v_lshl_add_u32 v1, v1, 8, v5
    s_mul_i32 s35, s31, 1024
    s_mov_b32 s32, s35
    s_mov_b32 s6, 0x100000
    s_mov_b32 s7, 0x20000
    s_waitcnt lgkmcnt(0)
    s_add_u32 s4, s50, s30
    s_addc_u32 s5, s51, 0
    buffer_load_dwordx4 a[0:3], v1, s[4:7], s32 offen offset:0 nt
    s_add_u32 s32, s32, 6144
    buffer_load_dwordx4 a[4:7], v1, s[4:7], s32 offen offset:0 nt
    s_add_u32 s32, s32, 6144
    buffer_load_dwordx4 a[8:11], v1, s[4:7], s32 offen offset:0 nt
    s_add_u32 s32, s32, 6144
    buffer_load_dwordx4 a[12:15], v1, s[4:7], s32 offen offset:0 nt
    s_add_u32 s32, s32, 6144
    buffer_load_dwordx4 a[16:19], v1, s[4:7], s32 offen offset:0 nt
    s_add_u32 s32, s32, 6144
    s_mov_b32 s12, s62
    s_mov_b32 s13, s63
    s_mov_b32 s14, 0x400000
    s_mov_b32 s15, 0x20000
    s_mov_b32 s16, s60
    s_mov_b32 s17, s61
    s_mov_b32 s18, 0x100
    s_mov_b32 s19, 0x20000
    v_and_b32 v3, 1, v0
    v_lshlrev_b32 v3, 4, v3
    v_mov_b32 v4, 0xffff
    v_lshlrev_b32 v4, v3, v4
    v_bfe_u32 v3, v0, 1, 2
    v_cmp_eq_u32 vcc, 0, v3
    s_nop 1
    v_cndmask_b32 v20, 0, v4, vcc
    v_cmp_eq_u32 vcc, 1, v3
    s_nop 1
    v_cndmask_b32 v21, 0, v4, vcc
    v_cmp_eq_u32 vcc, 2, v3
    s_nop 1
    v_cndmask_b32 v22, 0, v4, vcc
    v_cmp_eq_u32 vcc, 3, v3
    s_nop 1
    v_cndmask_b32 v23, 0, v4, vcc
    s_mov_b32 s64, 0x22222222
    s_mov_b32 s65, 0x22222222
    s_mov_b32 s66, 0x44444444
    s_mov_b32 s67, 0x44444444
    s_mov_b32 s68, 0x88888888
    s_mov_b32 s69, 0x88888888
    v_mov_b32 v32, 0
    v_mov_b32 v33, 0
    v_mov_b32 v34, 0
    v_mov_b32 v35, 0
    v_mov_b32 v36, 0
    v_mov_b32 v37, 0
    v_mov_b32 v38, 0
    v_mov_b32 v39, 0
    v_mov_b32 v40, 0
    v_mov_b32 v41, 0
    v_mov_b32 v42, 0
    v_mov_b32 v43, 0
    v_mov_b32 v44, 0
    v_mov_b32 v45, 0
    v_mov_b32 v46, 0
    v_mov_b32 v47, 0
    s_lshl_b32 s33, s26, 2
    s_add_u32 s33, s33, s72
    s_lshl_b32 s34, s33, 8
    s_add_u32 s34, s34, 0x164000
    s_waitcnt vmcnt(4)
    buffer_load_dwordx4 a[20:23], v1, s[4:7], s32 offen offset:0 nt
    s_add_u32 s32, s32, 6144
    s_waitcnt vmcnt(4)
    buffer_load_dwordx4 a[24:27], v1, s[4:7], s32 offen offset:0 nt
    s_add_u32 s32, s32, 6144
    s_waitcnt vmcnt(4)
    buffer_load_dwordx4 a[28:31], v1, s[4:7], s32 offen offset:0 nt
    s_add_u32 s32, s32, 6144
    s_waitcnt vmcnt(4)
    buffer_load_dwordx4 a[32:35], v1, s[4:7], s32 offen offset:0 nt
    s_add_u32 s32, s32, 6144
    s_waitcnt vmcnt(4)
    buffer_load_dwordx4 a[36:39], v1, s[4:7], s32 offen offset:0 nt
    s_add_u32 s32, s32, 6144
    s_waitcnt vmcnt(4)
    buffer_load_dwordx4 a[40:43], v1, s[4:7], s32 offen offset:0 nt
    s_add_u32 s32, s32, 6144
    s_waitcnt vmcnt(4)
    buffer_load_dwordx4 a[44:47], v1, s[4:7], s32 offen offset:0 nt
    s_add_u32 s32, s32, 6144
    s_waitcnt vmcnt(4)
    buffer_load_dwordx4 a[48:51], v1, s[4:7], s32 offen offset:0 nt
    s_add_u32 s32, s32, 6144
    s_waitcnt vmcnt(4)
    buffer_load_dwordx4 a[52:55], v1, s[4:7], s32 offen offset:0 nt
    s_add_u32 s32, s32, 6144
    s_waitcnt vmcnt(4)
    buffer_load_dwordx4 a[56:59], v1, s[4:7], s32 offen offset:0 nt
    s_add_u32 s32, s32, 6144
    s_waitcnt vmcnt(4)
    buffer_load_dwordx4 a[60:63], v1, s[4:7], s32 offen offset:0 nt
    s_add_u32 s32, s32, 6144
    s_waitcnt vmcnt(4)
    buffer_load_dwordx4 a[64:67], v1, s[4:7], s32 offen offset:0 nt
    s_add_u32 s32, s32, 6144
    s_waitcnt vmcnt(4)
    buffer_load_dwordx4 a[68:71], v1, s[4:7], s32 offen offset:0 nt
    s_add_u32 s32, s32, 6144
    s_waitcnt vmcnt(4)
    buffer_load_dwordx4 a[72:75], v1, s[4:7], s32 offen offset:0 nt
    s_add_u32 s32, s32, 6144
    s_waitcnt vmcnt(4)
    buffer_load_dwordx4 a[76:79], v1, s[4:7], s32 offen offset:0 nt
    s_add_u32 s32, s32, 6144
    s_waitcnt vmcnt(4)
    buffer_load_dwordx4 a[80:83], v1, s[4:7], s32 offen offset:0 nt
    s_add_u32 s32, s32, 6144
    s_waitcnt vmcnt(4)
    buffer_load_dwordx4 a[84:87], v1, s[4:7], s32 offen offset:0 nt
    s_add_u32 s32, s32, 6144
    s_waitcnt vmcnt(4)
    buffer_load_dwordx4 a[88:91], v1, s[4:7], s32 offen offset:0 nt
    s_add_u32 s32, s32, 6144
    s_waitcnt vmcnt(4)
    buffer_load_dwordx4 a[92:95], v1, s[4:7], s32 offen offset:0 nt
    s_add_u32 s32, s32, 6144
    s_waitcnt vmcnt(4)
    buffer_load_dwordx4 a[96:99], v1, s[4:7], s32 offen offset:0 nt
    s_add_u32 s32, s32, 6144
    s_waitcnt vmcnt(4)
    buffer_load_dwordx4 a[100:103], v1, s[4:7], s32 offen offset:0 nt
    s_add_u32 s32, s32, 6144
    s_waitcnt vmcnt(4)
    buffer_load_dwordx4 a[104:107], v1, s[4:7], s32 offen offset:0 nt
    s_add_u32 s32, s32, 6144
    s_waitcnt vmcnt(4)
    buffer_load_dwordx4 a[108:111], v1, s[4:7], s32 offen offset:0 nt
    s_add_u32 s32, s32, 6144
    s_waitcnt vmcnt(4)
    buffer_load_dwordx4 a[112:115], v1, s[4:7], s32 offen offset:0 nt
    s_add_u32 s32, s32, 6144
    s_waitcnt vmcnt(4)
    buffer_load_dwordx4 a[116:119], v1, s[4:7], s32 offen offset:0 nt
    s_add_u32 s32, s32, 6144
    s_waitcnt vmcnt(4)
    buffer_load_dwordx4 a[120:123], v1, s[4:7], s32 offen offset:0 nt
    s_add_u32 s32, s32, 6144
    s_waitcnt vmcnt(4)
    buffer_load_dwordx4 a[124:127], v1, s[4:7], s32 offen offset:0 nt
    s_add_u32 s32, s32, 6144
    s_waitcnt vmcnt(4)
    buffer_load_dwordx4 a[128:131], v1, s[4:7], s32 offen offset:0 nt
    s_add_u32 s32, s32, 6144
    s_waitcnt vmcnt(4)
    buffer_load_dwordx4 a[132:135], v1, s[4:7], s32 offen offset:0 nt
    s_add_u32 s32, s32, 6144
    s_waitcnt vmcnt(4)
    buffer_load_dwordx4 a[136:139], v1, s[4:7], s32 offen offset:0 nt
    s_add_u32 s32, s32, 6144
    s_waitcnt vmcnt(4)
    buffer_load_dwordx4 a[140:143], v1, s[4:7], s32 offen offset:0 nt
    s_add_u32 s32, s32, 6144
    s_waitcnt vmcnt(4)
    buffer_load_dwordx4 a[144:147], v1, s[4:7], s32 offen offset:0 nt
    s_add_u32 s32, s32, 6144
    s_waitcnt vmcnt(4)
    buffer_load_dwordx4 a[148:151], v1, s[4:7], s32 offen offset:0 nt
    s_add_u32 s32, s32, 6144
    s_waitcnt vmcnt(4)
    buffer_load_dwordx4 a[152:155], v1, s[4:7], s32 offen offset:0 nt
    s_add_u32 s32, s32, 6144
    s_waitcnt vmcnt(4)
    buffer_load_dwordx4 a[156:159], v1, s[4:7], s32 offen offset:0 nt
    s_add_u32 s32, s32, 6144
    s_waitcnt vmcnt(4)
    buffer_load_dwordx4 a[160:163], v1, s[4:7], s32 offen offset:0 nt
    s_add_u32 s32, s32, 6144
    s_waitcnt vmcnt(4)
    buffer_load_dwordx4 a[164:167], v1, s[4:7], s32 offen offset:0 nt
    s_add_u32 s32, s32, 6144
    s_waitcnt vmcnt(4)
    buffer_load_dwordx4 a[168:171], v1, s[4:7], s32 offen offset:0 nt
    s_add_u32 s32, s32, 6144
    s_waitcnt vmcnt(4)
    buffer_load_dwordx4 a[172:175], v1, s[4:7], s32 offen offset:0 nt
    s_add_u32 s32, s32, 6144
    s_waitcnt vmcnt(4)
    buffer_load_dwordx4 a[176:179], v1, s[4:7], s32 offen offset:0 nt
    s_add_u32 s32, s32, 6144
    s_waitcnt vmcnt(4)
    buffer_load_dwordx4 a[180:183], v1, s[4:7], s32 offen offset:0 nt
    s_add_u32 s32, s32, 6144
    s_waitcnt vmcnt(4)
    buffer_load_dwordx4 a[184:187], v1, s[4:7], s32 offen offset:0 nt
    s_add_u32 s32, s32, 6144
    s_waitcnt vmcnt(4)
    buffer_load_dwordx4 a[188:191], v1, s[4:7], s32 offen offset:0 nt
    s_add_u32 s32, s32, 6144
    s_waitcnt vmcnt(4)
    buffer_load_dwordx4 a[192:195], v1, s[4:7], s32 offen offset:0 nt
    s_add_u32 s32, s32, 6144
    s_waitcnt vmcnt(4)
    buffer_load_dwordx4 a[196:199], v1, s[4:7], s32 offen offset:0 nt
    s_add_u32 s32, s32, 6144
    s_waitcnt vmcnt(4)
    buffer_load_dwordx4 a[200:203], v1, s[4:7], s32 offen offset:0 nt
    s_add_u32 s32, s32, 6144
    s_waitcnt vmcnt(4)
    buffer_load_dwordx4 a[204:207], v1, s[4:7], s32 offen offset:0 nt
    s_add_u32 s32, s32, 6144
    s_waitcnt vmcnt(4)
    buffer_load_dwordx4 a[208:211], v1, s[4:7], s32 offen offset:0 nt
    s_add_u32 s32, s32, 6144
    s_waitcnt vmcnt(4)
    buffer_load_dwordx4 a[212:215], v1, s[4:7], s32 offen offset:0 nt
    s_add_u32 s32, s32, 6144
    s_waitcnt vmcnt(4)
    buffer_load_dwordx4 a[216:219], v1, s[4:7], s32 offen offset:0 nt
    s_add_u32 s32, s32, 6144
    s_waitcnt vmcnt(4)
    buffer_load_dwordx4 a[220:223], v1, s[4:7], s32 offen offset:0 nt
    s_add_u32 s32, s32, 6144
    s_waitcnt vmcnt(4)
    buffer_load_dwordx4 a[224:227], v1, s[4:7], s32 offen offset:0 nt
    s_add_u32 s32, s32, 6144
    s_waitcnt vmcnt(4)
    buffer_load_dwordx4 a[228:231], v1, s[4:7], s32 offen offset:0 nt
    s_add_u32 s32, s32, 6144
    s_waitcnt vmcnt(4)
    buffer_load_dwordx4 a[232:235], v1, s[4:7], s32 offen offset:0 nt
    s_add_u32 s32, s32, 6144
    s_waitcnt vmcnt(4)
    buffer_load_dwordx4 a[236:239], v1, s[4:7], s32 offen offset:0 nt
    s_add_u32 s32, s32, 6144
    s_waitcnt vmcnt(4)
    buffer_load_dwordx4 a[240:243], v1, s[4:7], s32 offen offset:0 nt
    s_add_u32 s32, s32, 6144
    s_waitcnt vmcnt(4)
    buffer_load_dwordx4 a[244:247], v1, s[4:7], s32 offen offset:0 nt
    s_add_u32 s32, s32, 6144
    s_waitcnt vmcnt(4)
    buffer_load_dwordx4 a[248:251], v1, s[4:7], s32 offen offset:0 nt
    s_add_u32 s32, s32, 6144
    s_waitcnt vmcnt(4)
    buffer_load_dwordx4 a[252:255], v1, s[4:7], s32 offen offset:0 nt
    s_add_u32 s32, s32, 6144
    s_waitcnt vmcnt(4)
    buffer_load_dwordx4 v[128:131], v1, s[4:7], s32 offen offset:0 nt
    s_add_u32 s32, s32, 6144
    s_waitcnt vmcnt(4)
    buffer_load_dwordx4 v[132:135], v1, s[4:7], s32 offen offset:0 nt
    s_add_u32 s32, s32, 6144
    s_waitcnt vmcnt(4)
    buffer_load_dwordx4 v[136:139], v1, s[4:7], s32 offen offset:0 nt
    s_add_u32 s32, s32, 6144
    s_waitcnt vmcnt(4)
    buffer_load_dwordx4 v[140:143], v1, s[4:7], s32 offen offset:0 nt
    s_add_u32 s32, s32, 6144
    s_waitcnt vmcnt(4)
    buffer_load_dwordx4 v[144:147], v1, s[4:7], s32 offen offset:0 nt
    s_add_u32 s32, s32, 6144
    s_waitcnt vmcnt(4)
    buffer_load_dwordx4 v[148:151], v1, s[4:7], s32 offen offset:0 nt
    s_add_u32 s32, s32, 6144
    s_waitcnt vmcnt(4)
    buffer_load_dwordx4 v[152:155], v1, s[4:7], s32 offen offset:0 nt
    s_add_u32 s32, s32, 6144
    s_waitcnt vmcnt(4)
    buffer_load_dwordx4 v[156:159], v1, s[4:7], s32 offen offset:0 nt
    s_add_u32 s32, s32, 6144
    s_waitcnt vmcnt(4)
    buffer_load_dwordx4 v[160:163], v1, s[4:7], s32 offen offset:0 nt
    s_add_u32 s32, s32, 6144
    s_waitcnt vmcnt(4)
    buffer_load_dwordx4 v[164:167], v1, s[4:7], s32 offen offset:0 nt
    s_add_u32 s32, s32, 6144
    s_waitcnt vmcnt(4)
    buffer_load_dwordx4 v[168:171], v1, s[4:7], s32 offen offset:0 nt
    s_add_u32 s32, s32, 6144
    s_waitcnt vmcnt(4)
    buffer_load_dwordx4 v[172:175], v1, s[4:7], s32 offen offset:0 nt
    s_add_u32 s32, s32, 6144
    s_waitcnt vmcnt(4)
    buffer_load_dwordx4 v[176:179], v1, s[4:7], s32 offen offset:0 nt
    s_add_u32 s32, s32, 6144
    s_waitcnt vmcnt(4)
    buffer_load_dwordx4 v[180:183], v1, s[4:7], s32 offen offset:0 nt
    s_add_u32 s32, s32, 6144
    s_waitcnt vmcnt(4)
    buffer_load_dwordx4 v[184:187], v1, s[4:7], s32 offen offset:0 nt
    s_add_u32 s32, s32, 6144
    s_waitcnt vmcnt(4)
    buffer_load_dwordx4 v[188:191], v1, s[4:7], s32 offen offset:0 nt
    s_add_u32 s32, s32, 6144
    s_mov_b64 exec, 1
    buffer_load_dword v61, off, s[16:19], 0 offset:128 sc1
    s_mov_b64 exec, -1
    s_waitcnt vmcnt(4)
    buffer_load_dwordx4 v[64:67], v1, s[4:7], s32 offen offset:0 nt
    s_add_u32 s32, s32, 6144
    s_waitcnt vmcnt(4)
    buffer_load_dwordx4 v[68:71], v1, s[4:7], s32 offen offset:0 nt
    s_add_u32 s32, s32, 6144
    s_waitcnt vmcnt(4)
    buffer_load_dwordx4 v[72:75], v1, s[4:7], s32 offen offset:0 nt
    s_add_u32 s32, s32, 6144
    s_waitcnt vmcnt(4)
    buffer_load_dwordx4 v[76:79], v1, s[4:7], s32 offen offset:0 nt
    s_add_u32 s32, s32, 6144
    s_waitcnt vmcnt(4)
    buffer_load_dwordx4 v[80:83], v1, s[4:7], s32 offen offset:0 nt
    s_add_u32 s32, s32, 6144
    s_waitcnt vmcnt(4)
    buffer_load_dwordx4 v[84:87], v1, s[4:7], s32 offen offset:0 nt
    s_add_u32 s32, s32, 6144
    s_waitcnt vmcnt(4)
    buffer_load_dwordx4 v[88:91], v1, s[4:7], s32 offen offset:0 nt
    s_add_u32 s32, s32, 6144
    s_waitcnt vmcnt(4)
    buffer_load_dwordx4 v[92:95], v1, s[4:7], s32 offen offset:0 nt
    s_add_u32 s32, s32, 6144
    s_waitcnt vmcnt(8)
    v_readfirstlane_b32 s25, v61
    s_nop 0
    s_cmp_eq_u32 s25, 32
    s_cbranch_scc1 L_B_q
    s_mov_b32 s24, 262144
    s_mov_b64 exec, 1
L_aw2:
    buffer_load_dword v61, off, s[16:19], 0 offset:128 sc1
    s_waitcnt vmcnt(0)
    v_readfirstlane_b32 s25, v61
    s_nop 0
    s_cmp_eq_u32 s25, 32
    s_cbranch_scc1 L_B_q
    s_sleep 16
    s_sub_u32 s24, s24, 1
    s_cmp_lg_u32 s24, 0
    s_cbranch_scc1 L_aw2
L_B_q:
    s_mov_b64 exec, -1
    buffer_load_dwordx4 v[8:11], v5, s[12:15], s34 offen sc1
    s_waitcnt vmcnt(4)
    buffer_load_dwordx4 v[96:99], v1, s[4:7], s32 offen offset:0 nt
    s_add_u32 s32, s32, 6144
    s_waitcnt vmcnt(4)
    buffer_load_dwordx4 v[100:103], v1, s[4:7], s32 offen offset:0 nt
    s_add_u32 s32, s32, 6144
    s_waitcnt vmcnt(4)
    buffer_load_dwordx4 v[104:107], v1, s[4:7], s32 offen offset:0 nt
    s_add_u32 s32, s32, 6144
    s_waitcnt vmcnt(4)
    buffer_load_dwordx4 v[108:111], v1, s[4:7], s32 offen offset:0 nt
    s_add_u32 s32, s32, 6144
    s_waitcnt vmcnt(4)
    buffer_load_dwordx4 v[112:115], v1, s[4:7], s32 offen offset:0 nt
    s_add_u32 s32, s32, 6144
    s_waitcnt vmcnt(4)
    buffer_load_dwordx4 v[116:119], v1, s[4:7], s32 offen offset:0 nt
    s_add_u32 s32, s32, 6144
    s_waitcnt vmcnt(4)
    buffer_load_dwordx4 v[120:123], v1, s[4:7], s32 offen offset:0 nt
    s_add_u32 s32, s32, 6144
    s_waitcnt vmcnt(4)
    buffer_load_dwordx4 v[124:127], v1, s[4:7], s32 offen offset:0 nt
    s_add_u32 s32, s32, 6144
    s_waitcnt vmcnt(8)
    v_mov_b32_dpp v32, v8 quad_perm:[0,1,2,3] row_mask:0xf bank_mask:0x1
    v_mov_b32_dpp v33, v9 quad_perm:[0,1,2,3] row_mask:0xf bank_mask:0x1
    v_mov_b32_dpp v34, v10 quad_perm:[0,1,2,3] row_mask:0xf bank_mask:0x1
    v_mov_b32_dpp v35, v11 quad_perm:[0,1,2,3] row_mask:0xf bank_mask:0x1
    v_mov_b32_dpp v36, v8 quad_perm:[0,1,2,3] row_mask:0xf bank_mask:0x2
    v_mov_b32_dpp v37, v9 quad_perm:[0,1,2,3] row_mask:0xf bank_mask:0x2
    v_mov_b32_dpp v38, v10 quad_perm:[0,1,2,3] row_mask:0xf bank_mask:0x2
    v_mov_b32_dpp v39, v11 quad_perm:[0,1,2,3] row_mask:0xf bank_mask:0x2
    v_mov_b32_dpp v40, v8 quad_perm:[0,1,2,3] row_mask:0xf bank_mask:0x4
    v_mov_b32_dpp v41, v9 quad_perm:[0,1,2,3] row_mask:0xf bank_mask:0x4
    v_mov_b32_dpp v42, v10 quad_perm:[0,1,2,3] row_mask:0xf bank_mask:0x4
    v_mov_b32_dpp v43, v11 quad_perm:[0,1,2,3] row_mask:0xf bank_mask:0x4
    v_mov_b32_dpp v44, v8 quad_perm:[0,1,2,3] row_mask:0xf bank_mask:0x8
    v_mov_b32_dpp v45, v9 quad_perm:[0,1,2,3] row_mask:0xf bank_mask:0x8
    v_mov_b32_dpp v46, v10 quad_perm:[0,1,2,3] row_mask:0xf bank_mask:0x8
    v_mov_b32_dpp v47, v11 quad_perm:[0,1,2,3] row_mask:0xf bank_mask:0x8
    s_mov_b32 s27, 5
L_BK:
    s_cmp_lg_u32 s27, 10
    s_cbranch_scc1 L_BK_a
    s_add_u32 s4, s52, s30
    s_addc_u32 s5, s53, 0
    s_mov_b32 s32, s35
    v_mov_b32 v1, v2
L_BK_a:
    s_barrier
    v_mov_b32 v53, v54
    v_mov_b32 v54, v55
    v_mov_b32 v55, v56
    v_mov_b32 v56, v57
    v_mov_b32 v57, v58
    s_waitcnt vmcnt(15)
    v_mfma_f32_16x16x32_bf16 v[12:15], v[64:67], v[32:35], 0
    buffer_load_dwordx4 v[64:67], v1, s[4:7], s32 offen offset:0 nt
    s_add_u32 s32, s32, 6144
    s_waitcnt vmcnt(15)
    v_mfma_f32_16x16x32_bf16 v[12:15], v[68:71], v[36:39], v[12:15]
    buffer_load_dwordx4 v[68:71], v1, s[4:7], s32 offen offset:0 nt
    s_add_u32 s32, s32, 6144
    s_waitcnt vmcnt(15)
    v_mfma_f32_16x16x32_bf16 v[12:15], v[72:75], v[40:43], v[12:15]
    buffer_load_dwordx4 v[72:75], v1, s[4:7], s32 offen offset:0 nt
    s_add_u32 s32, s32, 6144
    s_waitcnt vmcnt(15)
    v_mfma_f32_16x16x32_bf16 v[12:15], v[76:79], v[44:47], v[12:15]
    buffer_load_dwordx4 v[76:79], v1, s[4:7], s32 offen offset:0 nt
    s_add_u32 s32, s32, 6144
    s_nop 5
    v_add_f32_dpp v58, v13, v12 quad_perm:[1,1,1,1] row_mask:0xf bank_mask:0xf
    s_nop 1
    v_add_f32_dpp v58, v14, v58 quad_perm:[2,2,2,2] row_mask:0xf bank_mask:0xf
    s_nop 1
    v_add_f32_dpp v58, v15, v58 quad_perm:[3,3,3,3] row_mask:0xf bank_mask:0xf
    s_waitcnt vmcnt(15)
    v_mfma_f32_16x16x32_bf16 v[16:19], v[80:83], v[32:35], 0
    buffer_load_dwordx4 v[80:83], v1, s[4:7], s32 offen offset:0 nt
    s_add_u32 s32, s32, 6144
    s_waitcnt vmcnt(15)
    v_mfma_f32_16x16x32_bf16 v[16:19], v[84:87], v[36:39], v[16:19]
    buffer_load_dwordx4 v[84:87], v1, s[4:7], s32 offen offset:0 nt
    s_add_u32 s32, s32, 6144
    s_waitcnt vmcnt(15)
    v_mfma_f32_16x16x32_bf16 v[16:19], v[88:91], v[40:43], v[16:19]
    buffer_load_dwordx4 v[88:91], v1, s[4:7], s32 offen offset:0 nt
    s_add_u32 s32, s32, 6144
    s_waitcnt vmcnt(15)
    v_mfma_f32_16x16x32_bf16 v[16:19], v[92:95], v[44:47], v[16:19]
    buffer_load_dwordx4 v[92:95], v1, s[4:7], s32 offen offset:0 nt
    s_add_u32 s32, s32, 6144
    s_nop 5
    v_add_f32_dpp v3, v16, v17 quad_perm:[0,0,0,0] row_mask:0xf bank_mask:0xf
    s_nop 1
    v_add_f32_dpp v3, v18, v3 quad_perm:[2,2,2,2] row_mask:0xf bank_mask:0xf
    s_nop 1
    v_add_f32_dpp v3, v19, v3 quad_perm:[3,3,3,3] row_mask:0xf bank_mask:0xf
    v_cndmask_b32 v58, v58, v3, s[64:65]
    s_waitcnt vmcnt(15)
    v_mfma_f32_16x16x32_bf16 v[12:15], v[96:99], v[32:35], 0
    buffer_load_dwordx4 v[96:99], v1, s[4:7], s32 offen offset:0 nt
    s_add_u32 s32, s32, 6144
    s_waitcnt vmcnt(15)
    v_mfma_f32_16x16x32_bf16 v[12:15], v[100:103], v[36:39], v[12:15]
    buffer_load_dwordx4 v[100:103], v1, s[4:7], s32 offen offset:0 nt
    s_add_u32 s32, s32, 6144
    s_waitcnt vmcnt(15)
    v_mfma_f32_16x16x32_bf16 v[12:15], v[104:107], v[40:43], v[12:15]
    buffer_load_dwordx4 v[104:107], v1, s[4:7], s32 offen offset:0 nt
    s_add_u32 s32, s32, 6144
    s_waitcnt vmcnt(15)
    v_mfma_f32_16x16x32_bf16 v[12:15], v[108:111], v[44:47], v[12:15]
    buffer_load_dwordx4 v[108:111], v1, s[4:7], s32 offen offset:0 nt
    s_add_u32 s32, s32, 6144
    s_nop 5
    v_add_f32_dpp v3, v12, v14 quad_perm:[0,0,0,0] row_mask:0xf bank_mask:0xf
    s_nop 1
    v_add_f32_dpp v3, v13, v3 quad_perm:[1,1,1,1] row_mask:0xf bank_mask:0xf
    s_nop 1
    v_add_f32_dpp v3, v15, v3 quad_perm:[3,3,3,3] row_mask:0xf bank_mask:0xf
    v_cndmask_b32 v58, v58, v3, s[66:67]
    s_waitcnt vmcnt(15)
    v_mfma_f32_16x16x32_bf16 v[16:19], v[112:115], v[32:35], 0
    buffer_load_dwordx4 v[112:115], v1, s[4:7], s32 offen offset:0 nt
    s_add_u32 s32, s32, 6144
    s_waitcnt vmcnt(15)
    v_mfma_f32_16x16x32_bf16 v[16:19], v[116:119], v[36:39], v[16:19]
    buffer_load_dwordx4 v[116:119], v1, s[4:7], s32 offen offset:0 nt
    s_add_u32 s32, s32, 6144
    s_waitcnt vmcnt(15)
    v_mfma_f32_16x16x32_bf16 v[16:19], v[120:123], v[40:43], v[16:19]
    buffer_load_dwordx4 v[120:123], v1, s[4:7], s32 offen offset:0 nt
    s_add_u32 s32, s32, 6144
    s_waitcnt vmcnt(15)
    v_mfma_f32_16x16x32_bf16 v[16:19], v[124:127], v[44:47], v[16:19]
    buffer_load_dwordx4 v[124:127], v1, s[4:7], s32 offen offset:0 nt
    s_add_u32 s32, s32, 6144
    s_nop 5
    v_add_f32_dpp v3, v16, v19 quad_perm:[0,0,0,0] row_mask:0xf bank_mask:0xf
    s_nop 1
    v_add_f32_dpp v3, v17, v3 quad_perm:[1,1,1,1] row_mask:0xf bank_mask:0xf
    s_nop 1
    v_add_f32_dpp v3, v18, v3 quad_perm:[2,2,2,2] row_mask:0xf bank_mask:0xf
    v_cndmask_b32 v58, v58, v3, s[68:69]
    s_cmp_lg_u32 s27, 5
    s_cbranch_scc1 L_BK_b0
    v_mfma_f32_16x16x32_bf16 v[12:15], a[0:3], v[32:35], 0
    v_mfma_f32_16x16x32_bf16 v[12:15], a[4:7], v[36:39], v[12:15]
    v_mfma_f32_16x16x32_bf16 v[12:15], a[8:11], v[40:43], v[12:15]
    v_mfma_f32_16x16x32_bf16 v[12:15], a[12:15], v[44:47], v[12:15]
    s_nop 7
    v_add_f32_dpp v48, v13, v12 quad_perm:[1,1,1,1] row_mask:0xf bank_mask:0xf
    s_nop 1
    v_add_f32_dpp v48, v14, v48 quad_perm:[2,2,2,2] row_mask:0xf bank_mask:0xf
    s_nop 1
    v_add_f32_dpp v48, v15, v48 quad_perm:[3,3,3,3] row_mask:0xf bank_mask:0xf
    v_mfma_f32_16x16x32_bf16 v[16:19], a[16:19], v[32:35], 0
    v_mfma_f32_16x16x32_bf16 v[16:19], a[20:23], v[36:39], v[16:19]
    v_mfma_f32_16x16x32_bf16 v[16:19], a[24:27], v[40:43], v[16:19]
    v_mfma_f32_16x16x32_bf16 v[16:19], a[28:31], v[44:47], v[16:19]
    s_nop 7
    v_add_f32_dpp v3, v16, v17 quad_perm:[0,0,0,0] row_mask:0xf bank_mask:0xf
    s_nop 1
    v_add_f32_dpp v3, v18, v3 quad_perm:[2,2,2,2] row_mask:0xf bank_mask:0xf
    s_nop 1
    v_add_f32_dpp v3, v19, v3 quad_perm:[3,3,3,3] row_mask:0xf bank_mask:0xf
    v_cndmask_b32 v48, v48, v3, s[64:65]
    v_mfma_f32_16x16x32_bf16 v[12:15], a[32:35], v[32:35], 0
    v_mfma_f32_16x16x32_bf16 v[12:15], a[36:39], v[36:39], v[12:15]
    v_mfma_f32_16x16x32_bf16 v[12:15], a[40:43], v[40:43], v[12:15]
    v_mfma_f32_16x16x32_bf16 v[12:15], a[44:47], v[44:47], v[12:15]
    s_nop 7
    v_add_f32_dpp v3, v12, v14 quad_perm:[0,0,0,0] row_mask:0xf bank_mask:0xf
    s_nop 1
    v_add_f32_dpp v3, v13, v3 quad_perm:[1,1,1,1] row_mask:0xf bank_mask:0xf
    s_nop 1
    v_add_f32_dpp v3, v15, v3 quad_perm:[3,3,3,3] row_mask:0xf bank_mask:0xf
    v_cndmask_b32 v48, v48, v3, s[66:67]
    v_mfma_f32_16x16x32_bf16 v[16:19], a[48:51], v[32:35], 0
    v_mfma_f32_16x16x32_bf16 v[16:19], a[52:55], v[36:39], v[16:19]
    v_mfma_f32_16x16x32_bf16 v[16:19], a[56:59], v[40:43], v[16:19]
    v_mfma_f32_16x16x32_bf16 v[16:19], a[60:63], v[44:47], v[16:19]
    s_nop 7
    v_add_f32_dpp v3, v16, v19 quad_perm:[0,0,0,0] row_mask:0xf bank_mask:0xf
    s_nop 1
    v_add_f32_dpp v3, v17, v3 quad_perm:[1,1,1,1] row_mask:0xf bank_mask:0xf
    s_nop 1
    v_add_f32_dpp v3, v18, v3 quad_perm:[2,2,2,2] row_mask:0xf bank_mask:0xf
    v_cndmask_b32 v48, v48, v3, s[68:69]
L_BK_b0:
    s_cmp_lg_u32 s27, 6
    s_cbranch_scc1 L_BK_b1
    v_mfma_f32_16x16x32_bf16 v[12:15], a[64:67], v[32:35], 0
    v_mfma_f32_16x16x32_bf16 v[12:15], a[68:71], v[36:39], v[12:15]
    v_mfma_f32_16x16x32_bf16 v[12:15], a[72:75], v[40:43], v[12:15]
    v_mfma_f32_16x16x32_bf16 v[12:15], a[76:79], v[44:47], v[12:15]
    s_nop 7
    v_add_f32_dpp v49, v13, v12 quad_perm:[1,1,1,1] row_mask:0xf bank_mask:0xf
    s_nop 1
    v_add_f32_dpp v49, v14, v49 quad_perm:[2,2,2,2] row_mask:0xf bank_mask:0xf
    s_nop 1
    v_add_f32_dpp v49, v15, v49 quad_perm:[3,3,3,3] row_mask:0xf bank_mask:0xf
    v_mfma_f32_16x16x32_bf16 v[16:19], a[80:83], v[32:35], 0
    v_mfma_f32_16x16x32_bf16 v[16:19], a[84:87], v[36:39], v[16:19]
    v_mfma_f32_16x16x32_bf16 v[16:19], a[88:91], v[40:43], v[16:19]
    v_mfma_f32_16x16x32_bf16 v[16:19], a[92:95], v[44:47], v[16:19]
    s_nop 7
    v_add_f32_dpp v3, v16, v17 quad_perm:[0,0,0,0] row_mask:0xf bank_mask:0xf
    s_nop 1
    v_add_f32_dpp v3, v18, v3 quad_perm:[2,2,2,2] row_mask:0xf bank_mask:0xf
    s_nop 1
    v_add_f32_dpp v3, v19, v3 quad_perm:[3,3,3,3] row_mask:0xf bank_mask:0xf
    v_cndmask_b32 v49, v49, v3, s[64:65]
    v_mfma_f32_16x16x32_bf16 v[12:15], a[96:99], v[32:35], 0
    v_mfma_f32_16x16x32_bf16 v[12:15], a[100:103], v[36:39], v[12:15]
    v_mfma_f32_16x16x32_bf16 v[12:15], a[104:107], v[40:43], v[12:15]
    v_mfma_f32_16x16x32_bf16 v[12:15], a[108:111], v[44:47], v[12:15]
    s_nop 7
    v_add_f32_dpp v3, v12, v14 quad_perm:[0,0,0,0] row_mask:0xf bank_mask:0xf
    s_nop 1
    v_add_f32_dpp v3, v13, v3 quad_perm:[1,1,1,1] row_mask:0xf bank_mask:0xf
    s_nop 1
    v_add_f32_dpp v3, v15, v3 quad_perm:[3,3,3,3] row_mask:0xf bank_mask:0xf
    v_cndmask_b32 v49, v49, v3, s[66:67]
    v_mfma_f32_16x16x32_bf16 v[16:19], a[112:115], v[32:35], 0
    v_mfma_f32_16x16x32_bf16 v[16:19], a[116:119], v[36:39], v[16:19]
    v_mfma_f32_16x16x32_bf16 v[16:19], a[120:123], v[40:43], v[16:19]
    v_mfma_f32_16x16x32_bf16 v[16:19], a[124:127], v[44:47], v[16:19]
    s_nop 7
    v_add_f32_dpp v3, v16, v19 quad_perm:[0,0,0,0] row_mask:0xf bank_mask:0xf
    s_nop 1
    v_add_f32_dpp v3, v17, v3 quad_perm:[1,1,1,1] row_mask:0xf bank_mask:0xf
    s_nop 1
    v_add_f32_dpp v3, v18, v3 quad_perm:[2,2,2,2] row_mask:0xf bank_mask:0xf
    v_cndmask_b32 v49, v49, v3, s[68:69]
L_BK_b1:
    s_cmp_lg_u32 s27, 7
    s_cbranch_scc1 L_BK_b2
    v_mfma_f32_16x16x32_bf16 v[12:15], a[128:131], v[32:35], 0
    v_mfma_f32_16x16x32_bf16 v[12:15], a[132:135], v[36:39], v[12:15]
    v_mfma_f32_16x16x32_bf16 v[12:15], a[136:139], v[40:43], v[12:15]
    v_mfma_f32_16x16x32_bf16 v[12:15], a[140:143], v[44:47], v[12:15]
    s_nop 7
    v_add_f32_dpp v50, v13, v12 quad_perm:[1,1,1,1] row_mask:0xf bank_mask:0xf
    s_nop 1
    v_add_f32_dpp v50, v14, v50 quad_perm:[2,2,2,2] row_mask:0xf bank_mask:0xf
    s_nop 1
    v_add_f32_dpp v50, v15, v50 quad_perm:[3,3,3,3] row_mask:0xf bank_mask:0xf
    v_mfma_f32_16x16x32_bf16 v[16:19], a[144:147], v[32:35], 0
    v_mfma_f32_16x16x32_bf16 v[16:19], a[148:151], v[36:39], v[16:19]
    v_mfma_f32_16x16x32_bf16 v[16:19], a[152:155], v[40:43], v[16:19]
    v_mfma_f32_16x16x32_bf16 v[16:19], a[156:159], v[44:47], v[16:19]
    s_nop 7
    v_add_f32_dpp v3, v16, v17 quad_perm:[0,0,0,0] row_mask:0xf bank_mask:0xf
    s_nop 1
    v_add_f32_dpp v3, v18, v3 quad_perm:[2,2,2,2] row_mask:0xf bank_mask:0xf
    s_nop 1
    v_add_f32_dpp v3, v19, v3 quad_perm:[3,3,3,3] row_mask:0xf bank_mask:0xf
    v_cndmask_b32 v50, v50, v3, s[64:65]
    v_mfma_f32_16x16x32_bf16 v[12:15], a[160:163], v[32:35], 0
    v_mfma_f32_16x16x32_bf16 v[12:15], a[164:167], v[36:39], v[12:15]
    v_mfma_f32_16x16x32_bf16 v[12:15], a[168:171], v[40:43], v[12:15]
    v_mfma_f32_16x16x32_bf16 v[12:15], a[172:175], v[44:47], v[12:15]
    s_nop 7
    v_add_f32_dpp v3, v12, v14 quad_perm:[0,0,0,0] row_mask:0xf bank_mask:0xf
    s_nop 1
    v_add_f32_dpp v3, v13, v3 quad_perm:[1,1,1,1] row_mask:0xf bank_mask:0xf
    s_nop 1
    v_add_f32_dpp v3, v15, v3 quad_perm:[3,3,3,3] row_mask:0xf bank_mask:0xf
    v_cndmask_b32 v50, v50, v3, s[66:67]
    v_mfma_f32_16x16x32_bf16 v[16:19], a[176:179], v[32:35], 0
    v_mfma_f32_16x16x32_bf16 v[16:19], a[180:183], v[36:39], v[16:19]
    v_mfma_f32_16x16x32_bf16 v[16:19], a[184:187], v[40:43], v[16:19]
    v_mfma_f32_16x16x32_bf16 v[16:19], a[188:191], v[44:47], v[16:19]
    s_nop 7
    v_add_f32_dpp v3, v16, v19 quad_perm:[0,0,0,0] row_mask:0xf bank_mask:0xf
    s_nop 1
    v_add_f32_dpp v3, v17, v3 quad_perm:[1,1,1,1] row_mask:0xf bank_mask:0xf
    s_nop 1
    v_add_f32_dpp v3, v18, v3 quad_perm:[2,2,2,2] row_mask:0xf bank_mask:0xf
    v_cndmask_b32 v50, v50, v3, s[68:69]
L_BK_b2:
    s_cmp_lg_u32 s27, 8
    s_cbranch_scc1 L_BK_b3
    v_mfma_f32_16x16x32_bf16 v[12:15], a[192:195], v[32:35], 0
    v_mfma_f32_16x16x32_bf16 v[12:15], a[196:199], v[36:39], v[12:15]
    v_mfma_f32_16x16x32_bf16 v[12:15], a[200:203], v[40:43], v[12:15]
    v_mfma_f32_16x16x32_bf16 v[12:15], a[204:207], v[44:47], v[12:15]
    s_nop 7
    v_add_f32_dpp v51, v13, v12 quad_perm:[1,1,1,1] row_mask:0xf bank_mask:0xf
    s_nop 1
    v_add_f32_dpp v51, v14, v51 quad_perm:[2,2,2,2] row_mask:0xf bank_mask:0xf
    s_nop 1
    v_add_f32_dpp v51, v15, v51 quad_perm:[3,3,3,3] row_mask:0xf bank_mask:0xf
    v_mfma_f32_16x16x32_bf16 v[16:19], a[208:211], v[32:35], 0
    v_mfma_f32_16x16x32_bf16 v[16:19], a[212:215], v[36:39], v[16:19]
    v_mfma_f32_16x16x32_bf16 v[16:19], a[216:219], v[40:43], v[16:19]
    v_mfma_f32_16x16x32_bf16 v[16:19], a[220:223], v[44:47], v[16:19]
    s_nop 7
    v_add_f32_dpp v3, v16, v17 quad_perm:[0,0,0,0] row_mask:0xf bank_mask:0xf
    s_nop 1
    v_add_f32_dpp v3, v18, v3 quad_perm:[2,2,2,2] row_mask:0xf bank_mask:0xf
    s_nop 1
    v_add_f32_dpp v3, v19, v3 quad_perm:[3,3,3,3] row_mask:0xf bank_mask:0xf
    v_cndmask_b32 v51, v51, v3, s[64:65]
    v_mfma_f32_16x16x32_bf16 v[12:15], a[224:227], v[32:35], 0
    v_mfma_f32_16x16x32_bf16 v[12:15], a[228:231], v[36:39], v[12:15]
    v_mfma_f32_16x16x32_bf16 v[12:15], a[232:235], v[40:43], v[12:15]
    v_mfma_f32_16x16x32_bf16 v[12:15], a[236:239], v[44:47], v[12:15]
    s_nop 7
    v_add_f32_dpp v3, v12, v14 quad_perm:[0,0,0,0] row_mask:0xf bank_mask:0xf
    s_nop 1
    v_add_f32_dpp v3, v13, v3 quad_perm:[1,1,1,1] row_mask:0xf bank_mask:0xf
    s_nop 1
    v_add_f32_dpp v3, v15, v3 quad_perm:[3,3,3,3] row_mask:0xf bank_mask:0xf
    v_cndmask_b32 v51, v51, v3, s[66:67]
    v_mfma_f32_16x16x32_bf16 v[16:19], a[240:243], v[32:35], 0
    v_mfma_f32_16x16x32_bf16 v[16:19], a[244:247], v[36:39], v[16:19]
    v_mfma_f32_16x16x32_bf16 v[16:19], a[248:251], v[40:43], v[16:19]
    v_mfma_f32_16x16x32_bf16 v[16:19], a[252:255], v[44:47], v[16:19]
    s_nop 7
    v_add_f32_dpp v3, v16, v19 quad_perm:[0,0,0,0] row_mask:0xf bank_mask:0xf
    s_nop 1
    v_add_f32_dpp v3, v17, v3 quad_perm:[1,1,1,1] row_mask:0xf bank_mask:0xf
    s_nop 1
    v_add_f32_dpp v3, v18, v3 quad_perm:[2,2,2,2] row_mask:0xf bank_mask:0xf
    v_cndmask_b32 v51, v51, v3, s[68:69]
L_BK_b3:
    s_cmp_lg_u32 s27, 9
    s_cbranch_scc1 L_BK_b4
    v_mfma_f32_16x16x32_bf16 v[12:15], v[128:131], v[32:35], 0
    v_mfma_f32_16x16x32_bf16 v[12:15], v[132:135], v[36:39], v[12:15]
    v_mfma_f32_16x16x32_bf16 v[12:15], v[136:139], v[40:43], v[12:15]
    v_mfma_f32_16x16x32_bf16 v[12:15], v[140:143], v[44:47], v[12:15]
    s_nop 7
    v_add_f32_dpp v52, v13, v12 quad_perm:[1,1,1,1] row_mask:0xf bank_mask:0xf
    s_nop 1
    v_add_f32_dpp v52, v14, v52 quad_perm:[2,2,2,2] row_mask:0xf bank_mask:0xf
    s_nop 1
    v_add_f32_dpp v52, v15, v52 quad_perm:[3,3,3,3] row_mask:0xf bank_mask:0xf
    v_mfma_f32_16x16x32_bf16 v[16:19], v[144:147], v[32:35], 0
    v_mfma_f32_16x16x32_bf16 v[16:19], v[148:151], v[36:39], v[16:19]
    v_mfma_f32_16x16x32_bf16 v[16:19], v[152:155], v[40:43], v[16:19]
    v_mfma_f32_16x16x32_bf16 v[16:19], v[156:159], v[44:47], v[16:19]
    s_nop 7
    v_add_f32_dpp v3, v16, v17 quad_perm:[0,0,0,0] row_mask:0xf bank_mask:0xf
    s_nop 1
    v_add_f32_dpp v3, v18, v3 quad_perm:[2,2,2,2] row_mask:0xf bank_mask:0xf
    s_nop 1
    v_add_f32_dpp v3, v19, v3 quad_perm:[3,3,3,3] row_mask:0xf bank_mask:0xf
    v_cndmask_b32 v52, v52, v3, s[64:65]
    v_mfma_f32_16x16x32_bf16 v[12:15], v[160:163], v[32:35], 0
    v_mfma_f32_16x16x32_bf16 v[12:15], v[164:167], v[36:39], v[12:15]
    v_mfma_f32_16x16x32_bf16 v[12:15], v[168:171], v[40:43], v[12:15]
    v_mfma_f32_16x16x32_bf16 v[12:15], v[172:175], v[44:47], v[12:15]
    s_nop 7
    v_add_f32_dpp v3, v12, v14 quad_perm:[0,0,0,0] row_mask:0xf bank_mask:0xf
    s_nop 1
    v_add_f32_dpp v3, v13, v3 quad_perm:[1,1,1,1] row_mask:0xf bank_mask:0xf
    s_nop 1
    v_add_f32_dpp v3, v15, v3 quad_perm:[3,3,3,3] row_mask:0xf bank_mask:0xf
    v_cndmask_b32 v52, v52, v3, s[66:67]
    v_mfma_f32_16x16x32_bf16 v[16:19], v[176:179], v[32:35], 0
    v_mfma_f32_16x16x32_bf16 v[16:19], v[180:183], v[36:39], v[16:19]
    v_mfma_f32_16x16x32_bf16 v[16:19], v[184:187], v[40:43], v[16:19]
    v_mfma_f32_16x16x32_bf16 v[16:19], v[188:191], v[44:47], v[16:19]
    s_nop 7
    v_add_f32_dpp v3, v16, v19 quad_perm:[0,0,0,0] row_mask:0xf bank_mask:0xf
    s_nop 1
    v_add_f32_dpp v3, v17, v3 quad_perm:[1,1,1,1] row_mask:0xf bank_mask:0xf
    s_nop 1
    v_add_f32_dpp v3, v18, v3 quad_perm:[2,2,2,2] row_mask:0xf bank_mask:0xf
    v_cndmask_b32 v52, v52, v3, s[68:69]
L_BK_b4:
    s_add_u32 s27, s27, 1
    s_cmp_lt_u32 s27, 11
    s_cbranch_scc1 L_BK
    v_and_b32 v3, 3, v0
    v_bfe_u32 v4, v0, 2, 2
    v_lshl_add_u32 v3, v3, 2, v4
    v_add_u32 v3, 160, v3
    v_lshrrev_b32 v3, 0, v3
    v_mul_u32_u24 v3, 6, v3
    v_add_u32 v3, s31, v3
    v_mov_b32 v4, 0xff800000
    v_cmp_gt_u32 vcc, 1024, v3
    s_nop 1
    v_cndmask_b32 v58, v4, v58, vcc
    v_max3_f32 v3, v48, v49, v50
    v_max3_f32 v3, v3, v51, v52
    v_max3_f32 v3, v3, v53, v54
    v_max3_f32 v3, v3, v55, v56
    v_max3_f32 v3, v3, v57, v58
    s_nop 1
    v_max_f32_dpp v3, v3, v3 row_ror:8 row_mask:0xf bank_mask:0xf
    s_nop 1
    v_max_f32_dpp v3, v3, v3 row_ror:4 row_mask:0xf bank_mask:0xf
    s_nop 1
    v_max_f32_dpp v3, v3, v3 row_ror:2 row_mask:0xf bank_mask:0xf
    s_nop 1
    v_max_f32_dpp v3, v3, v3 row_ror:1 row_mask:0xf bank_mask:0xf
    s_nop 1
    v_max_f32_dpp v3, v3, v3 row_bcast:15 row_mask:0xa bank_mask:0xf
    s_nop 1
    v_max_f32_dpp v3, v3, v3 row_bcast:31 row_mask:0xc bank_mask:0xf
    s_nop 0
    v_readlane_b32 s24, v3, 63
    s_mov_b32 s71, 0x3e0293ee
    v_mov_b32 v6, s71
    v_mul_f32 v6, s24, v6
    v_fma_f32 v48, v48, s71, -v6
    v_fma_f32 v49, v49, s71, -v6
    v_fma_f32 v50, v50, s71, -v6
    v_fma_f32 v51, v51, s71, -v6
    v_fma_f32 v52, v52, s71, -v6
    v_fma_f32 v53, v53, s71, -v6
    v_fma_f32 v54, v54, s71, -v6
    v_fma_f32 v55, v55, s71, -v6
    v_fma_f32 v56, v56, s71, -v6
    v_fma_f32 v57, v57, s71, -v6
    v_fma_f32 v58, v58, s71, -v6
    v_exp_f32 v48, v48
    v_exp_f32 v49, v49
    v_exp_f32 v50, v50
    v_exp_f32 v51, v51
    v_exp_f32 v52, v52
    v_exp_f32 v53, v53
    v_exp_f32 v54, v54
    v_exp_f32 v55, v55
    v_exp_f32 v56, v56
    v_exp_f32 v57, v57
    v_exp_f32 v58, v58
    v_add_f32 v7, v48, v49
    v_add_f32 v7, v7, v50
    v_add_f32 v7, v7, v51
    v_add_f32 v7, v7, v52
    v_add_f32 v7, v7, v53
    v_add_f32 v7, v7, v54
    v_add_f32 v7, v7, v55
    v_add_f32 v7, v7, v56
    v_add_f32 v7, v7, v57
    v_add_f32 v7, v7, v58
    v_cvt_pk_bf16_f32 v48, v48, v48
    v_cvt_pk_bf16_f32 v49, v49, v49
    v_cvt_pk_bf16_f32 v50, v50, v50
    v_cvt_pk_bf16_f32 v51, v51, v51
    v_cvt_pk_bf16_f32 v52, v52, v52
    v_cvt_pk_bf16_f32 v53, v53, v53
    v_cvt_pk_bf16_f32 v54, v54, v54
    v_cvt_pk_bf16_f32 v55, v55, v55
    v_cvt_pk_bf16_f32 v56, v56, v56
    v_cvt_pk_bf16_f32 v57, v57, v57
    v_cvt_pk_bf16_f32 v58, v58, v58
    v_add_f32_dpp v7, v7, v7 row_ror:8 row_mask:0xf bank_mask:0xf
    s_nop 1
    v_add_f32_dpp v7, v7, v7 row_ror:4 row_mask:0xf bank_mask:0xf
    s_nop 1
    v_add_f32_dpp v7, v7, v7 row_ror:2 row_mask:0xf bank_mask:0xf
    s_nop 1
    v_add_f32_dpp v7, v7, v7 row_ror:1 row_mask:0xf bank_mask:0xf
    s_nop 1
    v_add_f32_dpp v7, v7, v7 row_bcast:15 row_mask:0xa bank_mask:0xf
    s_nop 1
    v_add_f32_dpp v7, v7, v7 row_bcast:31 row_mask:0xc bank_mask:0xf
    s_nop 0
    v_readlane_b32 s70, v7, 63
    s_lshl_b32 s25, s33, 3
    s_add_u32 s25, s25, s31
    s_lshl_b32 s25, s25, 4
    s_add_u32 s25, s25, 0x1b0000
    s_mov_b64 exec, 1
    v_mov_b32 v7, s70
    buffer_store_dwordx2 v[6:7], off, s[12:15], s25 sc1
    s_mov_b64 exec, -1
    s_mul_i32 s73, s33, 6
    s_add_u32 s73, s73, s31
    s_lshl_b32 s73, s73, 8
    s_add_u32 s73, s73, 0x180000
    v_lshrrev_b32 v3, 4, v0
    v_lshlrev_b32 v60, 6, v3
    v_and_b32 v4, 7, v0
    v_lshl_add_u32 v60, v4, 3, v60
    v_mov_b32 v12, 0
    v_mov_b32 v13, 0
    v_mov_b32 v14, 0
    v_mov_b32 v15, 0
    s_mov_b32 s27, 0
L_BV:
    s_barrier
    s_cmp_lg_u32 s27, 4
    s_cbranch_scc1 L_BV_x0
    s_lshl_b32 s24, s26, 7
    s_add_u32 s24, s24, 0x1b4000
    s_mov_b64 exec, 1
    buffer_load_dwordx2 v[62:63], off, s[12:15], s24 sc1
    s_mov_b64 exec, -1
L_BV_x0:
    s_cmp_lg_u32 s27, 5
    s_cbranch_scc1 L_BV_x1
    s_getreg_b32 s75, hwreg(HW_REG_XCC_ID, 0, 4)
    v_readfirstlane_b32 s24, v62
    v_readfirstlane_b32 s25, v63
    s_xor_b32 s24, s24, s75
    s_xor_b32 s25, s25, s75
    s_or_b32 s75, s24, s25
L_BV_x1:
    v_and_b32_dpp v8, v48, v20 row_newbcast:0 row_mask:0xf bank_mask:0xf
    v_and_b32_dpp v9, v48, v21 row_newbcast:0 row_mask:0xf bank_mask:0xf
    v_and_b32_dpp v10, v48, v22 row_newbcast:0 row_mask:0xf bank_mask:0xf
    v_and_b32_dpp v11, v48, v23 row_newbcast:0 row_mask:0xf bank_mask:0xf
    s_waitcnt vmcnt(15)
    s_nop 0
    v_mfma_f32_16x16x32_bf16 v[12:15], v[64:67], v[8:11], v[12:15]
    buffer_load_dwordx4 v[64:67], v1, s[4:7], s32 offen offset:0 nt
    s_add_u32 s32, s32, 6144
    v_and_b32_dpp v8, v48, v20 row_newbcast:4 row_mask:0xf bank_mask:0xf
    v_and_b32_dpp v9, v48, v21 row_newbcast:4 row_mask:0xf bank_mask:0xf
    v_and_b32_dpp v10, v48, v22 row_newbcast:4 row_mask:0xf bank_mask:0xf
    v_and_b32_dpp v11, v48, v23 row_newbcast:4 row_mask:0xf bank_mask:0xf
    s_waitcnt vmcnt(15)
    s_nop 0
    v_mfma_f32_16x16x32_bf16 v[12:15], v[68:71], v[8:11], v[12:15]
    buffer_load_dwordx4 v[68:71], v1, s[4:7], s32 offen offset:0 nt
    s_add_u32 s32, s32, 6144
    v_and_b32_dpp v8, v48, v20 row_newbcast:8 row_mask:0xf bank_mask:0xf
    v_and_b32_dpp v9, v48, v21 row_newbcast:8 row_mask:0xf bank_mask:0xf
    v_and_b32_dpp v10, v48, v22 row_newbcast:8 row_mask:0xf bank_mask:0xf
    v_and_b32_dpp v11, v48, v23 row_newbcast:8 row_mask:0xf bank_mask:0xf
    s_waitcnt vmcnt(15)
    s_nop 0
    v_mfma_f32_16x16x32_bf16 v[12:15], v[72:75], v[8:11], v[12:15]
    buffer_load_dwordx4 v[72:75], v1, s[4:7], s32 offen offset:0 nt
    s_add_u32 s32, s32, 6144
    v_and_b32_dpp v8, v48, v20 row_newbcast:12 row_mask:0xf bank_mask:0xf
    v_and_b32_dpp v9, v48, v21 row_newbcast:12 row_mask:0xf bank_mask:0xf
    v_and_b32_dpp v10, v48, v22 row_newbcast:12 row_mask:0xf bank_mask:0xf
    v_and_b32_dpp v11, v48, v23 row_newbcast:12 row_mask:0xf bank_mask:0xf
    s_waitcnt vmcnt(15)
    s_nop 0
    v_mfma_f32_16x16x32_bf16 v[12:15], v[76:79], v[8:11], v[12:15]
    buffer_load_dwordx4 v[76:79], v1, s[4:7], s32 offen offset:0 nt
    s_add_u32 s32, s32, 6144
    v_and_b32_dpp v8, v48, v20 row_newbcast:1 row_mask:0xf bank_mask:0xf
    v_and_b32_dpp v9, v48, v21 row_newbcast:1 row_mask:0xf bank_mask:0xf
    v_and_b32_dpp v10, v48, v22 row_newbcast:1 row_mask:0xf bank_mask:0xf
    v_and_b32_dpp v11, v48, v23 row_newbcast:1 row_mask:0xf bank_mask:0xf
    s_waitcnt vmcnt(15)
    s_nop 0
    v_mfma_f32_16x16x32_bf16 v[12:15], v[80:83], v[8:11], v[12:15]
    buffer_load_dwordx4 v[80:83], v1, s[4:7], s32 offen offset:0 nt
    s_add_u32 s32, s32, 6144
    v_and_b32_dpp v8, v48, v20 row_newbcast:5 row_mask:0xf bank_mask:0xf
    v_and_b32_dpp v9, v48, v21 row_newbcast:5 row_mask:0xf bank_mask:0xf
    v_and_b32_dpp v10, v48, v22 row_newbcast:5 row_mask:0xf bank_mask:0xf
    v_and_b32_dpp v11, v48, v23 row_newbcast:5 row_mask:0xf bank_mask:0xf
    s_waitcnt vmcnt(15)
    s_nop 0
    v_mfma_f32_16x16x32_bf16 v[12:15], v[84:87], v[8:11], v[12:15]
    buffer_load_dwordx4 v[84:87], v1, s[4:7], s32 offen offset:0 nt
    s_add_u32 s32, s32, 6144
    v_and_b32_dpp v8, v48, v20 row_newbcast:9 row_mask:0xf bank_mask:0xf
    v_and_b32_dpp v9, v48, v21 row_newbcast:9 row_mask:0xf bank_mask:0xf
    v_and_b32_dpp v10, v48, v22 row_newbcast:9 row_mask:0xf bank_mask:0xf
    v_and_b32_dpp v11, v48, v23 row_newbcast:9 row_mask:0xf bank_mask:0xf
    s_waitcnt vmcnt(15)
    s_nop 0
    v_mfma_f32_16x16x32_bf16 v[12:15], v[88:91], v[8:11], v[12:15]
    buffer_load_dwordx4 v[88:91], v1, s[4:7], s32 offen offset:0 nt
    s_add_u32 s32, s32, 6144
    v_and_b32_dpp v8, v48, v20 row_newbcast:13 row_mask:0xf bank_mask:0xf
    v_and_b32_dpp v9, v48, v21 row_newbcast:13 row_mask:0xf bank_mask:0xf
    v_and_b32_dpp v10, v48, v22 row_newbcast:13 row_mask:0xf bank_mask:0xf
    v_and_b32_dpp v11, v48, v23 row_newbcast:13 row_mask:0xf bank_mask:0xf
    s_waitcnt vmcnt(15)
    s_nop 0
    v_mfma_f32_16x16x32_bf16 v[12:15], v[92:95], v[8:11], v[12:15]
    buffer_load_dwordx4 v[92:95], v1, s[4:7], s32 offen offset:0 nt
    s_add_u32 s32, s32, 6144
    v_and_b32_dpp v8, v48, v20 row_newbcast:2 row_mask:0xf bank_mask:0xf
    v_and_b32_dpp v9, v48, v21 row_newbcast:2 row_mask:0xf bank_mask:0xf
    v_and_b32_dpp v10, v48, v22 row_newbcast:2 row_mask:0xf bank_mask:0xf
    v_and_b32_dpp v11, v48, v23 row_newbcast:2 row_mask:0xf bank_mask:0xf
    s_waitcnt vmcnt(15)
    s_nop 0
    v_mfma_f32_16x16x32_bf16 v[12:15], v[96:99], v[8:11], v[12:15]
    buffer_load_dwordx4 v[96:99], v1, s[4:7], s32 offen offset:0 nt
    s_add_u32 s32, s32, 6144
    v_and_b32_dpp v8, v48, v20 row_newbcast:6 row_mask:0xf bank_mask:0xf
    v_and_b32_dpp v9, v48, v21 row_newbcast:6 row_mask:0xf bank_mask:0xf
    v_and_b32_dpp v10, v48, v22 row_newbcast:6 row_mask:0xf bank_mask:0xf
    v_and_b32_dpp v11, v48, v23 row_newbcast:6 row_mask:0xf bank_mask:0xf
    s_waitcnt vmcnt(15)
    s_nop 0
    v_mfma_f32_16x16x32_bf16 v[12:15], v[100:103], v[8:11], v[12:15]
    buffer_load_dwordx4 v[100:103], v1, s[4:7], s32 offen offset:0 nt
    s_add_u32 s32, s32, 6144
    v_and_b32_dpp v8, v48, v20 row_newbcast:10 row_mask:0xf bank_mask:0xf
    v_and_b32_dpp v9, v48, v21 row_newbcast:10 row_mask:0xf bank_mask:0xf
    v_and_b32_dpp v10, v48, v22 row_newbcast:10 row_mask:0xf bank_mask:0xf
    v_and_b32_dpp v11, v48, v23 row_newbcast:10 row_mask:0xf bank_mask:0xf
    s_waitcnt vmcnt(15)
    s_nop 0
    v_mfma_f32_16x16x32_bf16 v[12:15], v[104:107], v[8:11], v[12:15]
    buffer_load_dwordx4 v[104:107], v1, s[4:7], s32 offen offset:0 nt
    s_add_u32 s32, s32, 6144
    s_cmp_lg_u32 s27, 10
    s_cbranch_scc1 L_BV_a
    s_mov_b32 exec_lo, 0x00ff00ff
    s_mov_b32 exec_hi, 0x00ff00ff
    s_cmp_eq_u32 s75, 0
    s_nop 0
    v_cvt_pk_bf16_f32 v4, v12, v13
    v_cvt_pk_bf16_f32 v5, v14, v15
    s_cbranch_scc0 L_BV_far
    buffer_store_dwordx2 v[4:5], v60, s[12:15], s73 offen
    s_branch L_BV_done
L_BV_far:
    buffer_store_dwordx2 v[4:5], v60, s[12:15], s73 offen sc1
L_BV_done:
    s_endpgm
L_BV_a:
    v_and_b32_dpp v8, v48, v20 row_newbcast:14 row_mask:0xf bank_mask:0xf
    v_and_b32_dpp v9, v48, v21 row_newbcast:14 row_mask:0xf bank_mask:0xf
    v_and_b32_dpp v10, v48, v22 row_newbcast:14 row_mask:0xf bank_mask:0xf
    v_and_b32_dpp v11, v48, v23 row_newbcast:14 row_mask:0xf bank_mask:0xf
    s_waitcnt vmcnt(15)
    s_nop 0
    v_mfma_f32_16x16x32_bf16 v[12:15], v[108:111], v[8:11], v[12:15]
    buffer_load_dwordx4 v[108:111], v1, s[4:7], s32 offen offset:0 nt
    s_add_u32 s32, s32, 6144
    v_and_b32_dpp v8, v48, v20 row_newbcast:3 row_mask:0xf bank_mask:0xf
    v_and_b32_dpp v9, v48, v21 row_newbcast:3 row_mask:0xf bank_mask:0xf
    v_and_b32_dpp v10, v48, v22 row_newbcast:3 row_mask:0xf bank_mask:0xf
    v_and_b32_dpp v11, v48, v23 row_newbcast:3 row_mask:0xf bank_mask:0xf
    s_waitcnt vmcnt(15)
    s_nop 0
    v_mfma_f32_16x16x32_bf16 v[12:15], v[112:115], v[8:11], v[12:15]
    buffer_load_dwordx4 v[112:115], v1, s[4:7], s32 offen offset:0 nt
    s_add_u32 s32, s32, 6144
    v_and_b32_dpp v8, v48, v20 row_newbcast:7 row_mask:0xf bank_mask:0xf
    v_and_b32_dpp v9, v48, v21 row_newbcast:7 row_mask:0xf bank_mask:0xf
    v_and_b32_dpp v10, v48, v22 row_newbcast:7 row_mask:0xf bank_mask:0xf
    v_and_b32_dpp v11, v48, v23 row_newbcast:7 row_mask:0xf bank_mask:0xf
    s_waitcnt vmcnt(15)
    s_nop 0
    v_mfma_f32_16x16x32_bf16 v[12:15], v[116:119], v[8:11], v[12:15]
    buffer_load_dwordx4 v[116:119], v1, s[4:7], s32 offen offset:0 nt
    s_add_u32 s32, s32, 6144
    v_and_b32_dpp v8, v48, v20 row_newbcast:11 row_mask:0xf bank_mask:0xf
    v_and_b32_dpp v9, v48, v21 row_newbcast:11 row_mask:0xf bank_mask:0xf
    v_and_b32_dpp v10, v48, v22 row_newbcast:11 row_mask:0xf bank_mask:0xf
    v_and_b32_dpp v11, v48, v23 row_newbcast:11 row_mask:0xf bank_mask:0xf
    s_waitcnt vmcnt(15)
    s_nop 0
    v_mfma_f32_16x16x32_bf16 v[12:15], v[120:123], v[8:11], v[12:15]
    buffer_load_dwordx4 v[120:123], v1, s[4:7], s32 offen offset:0 nt
    s_add_u32 s32, s32, 6144
    v_and_b32_dpp v8, v48, v20 row_newbcast:15 row_mask:0xf bank_mask:0xf
    v_and_b32_dpp v9, v48, v21 row_newbcast:15 row_mask:0xf bank_mask:0xf
    v_and_b32_dpp v10, v48, v22 row_newbcast:15 row_mask:0xf bank_mask:0xf
    v_and_b32_dpp v11, v48, v23 row_newbcast:15 row_mask:0xf bank_mask:0xf
    s_waitcnt vmcnt(15)
    s_nop 0
    v_mfma_f32_16x16x32_bf16 v[12:15], v[124:127], v[8:11], v[12:15]
    buffer_load_dwordx4 v[124:127], v1, s[4:7], s32 offen offset:0 nt
    s_add_u32 s32, s32, 6144
    v_mov_b32 v48, v49
    v_mov_b32 v49, v50
    v_mov_b32 v50, v51
    v_mov_b32 v51, v52
    v_mov_b32 v52, v53
    v_mov_b32 v53, v54
    v_mov_b32 v54, v55
    v_mov_b32 v55, v56
    v_mov_b32 v56, v57
    v_mov_b32 v57, v58
    s_add_u32 s27, s27, 1
    s_branch L_BV
L_A:
    s_getpc_b64 s[20:21]
L_pc3:
    s_sub_u32 s20, s20, L_pc3-L_A
    s_subb_u32 s21, s21, 0
    s_mov_b32 s22, L_A2-L_A
    s_mov_b32 s23, 0x20000
    v_lshl_add_u32 v3, v0, 2, s3
    v_lshlrev_b32 v3, 7, v3
    buffer_load_dword v17, v3, s[20:23], 0 offen
    s_mov_b32 s74, s2
    s_and_b32 s72, s2, 31
    s_and_b32 s26, s72, 7
    s_lshl_b32 s26, s26, 2
    s_lshr_b32 s24, s72, 3
    s_add_u32 s26, s26, s24
    v_lshrrev_b32 v3, 4, v0
    v_and_b32 v4, 15, v0
    v_lshlrev_b32 v18, 18, v3
    v_lshl_add_u32 v18, v4, 4, v18
    v_lshrrev_b32 v6, 3, v4
    v_lshlrev_b32 v6, 10, v6
    v_lshl_add_u32 v19, v3, 6, v6
    v_bfe_u32 v1, v0, 2, 2
    v_lshlrev_b32 v64, 18, v1
    v_lshl_add_u32 v64, v3, 6, v64
    v_and_b32 v4, 3, v0
    v_lshl_add_u32 v64, v4, 4, v64
    v_lshlrev_b32 v65, 9, v1
    v_lshl_add_u32 v65, v3, 7, v65
    v_lshl_add_u32 v65, v4, 5, v65
    v_add_u32 v65, 135168, v65
    v_lshlrev_b32 v66, 15, v1
    v_lshl_add_u32 v66, v3, 6, v66
    v_lshl_add_u32 v66, v4, 4, v66
    v_and_b32 v4, 15, v0
    v_lshlrev_b32 v67, 10, v3
    v_lshl_add_u32 v67, v4, 4, v67
    s_lshl_b32 s35, s3, 20
    s_lshl_b32 s24, s26, 8
    s_add_u32 s35, s35, s24
    s_waitcnt lgkmcnt(0)
    s_cmp_lt_u32 s74, 32
    s_cselect_b64 s[4:5], s[40:41], s[54:55]
    s_mov_b32 s6, 0x400000
    s_mov_b32 s7, 0x20000
    s_cselect_b64 s[20:21], s[36:37], s[48:49]
    s_mov_b32 s22, 4096
    s_mov_b32 s23, 0x20000
    s_cselect_b32 s75, 0x400000, 0
    s_lshl_b32 s24, s3, 8
    s_mov_b32 s32, s35
    buffer_load_dwordx4 v[12:15], v67, s[20:23], s24 offen
    buffer_load_dwordx4 v[128:131], v18, s[4:7], s32 offen nt
    s_add_u32 s32, s32, 8192
    buffer_load_dwordx4 v[132:135], v18, s[4:7], s32 offen nt
    s_add_u32 s32, s32, 8192
    buffer_load_dwordx4 v[136:139], v18, s[4:7], s32 offen nt
    s_add_u32 s32, s32, 8192
    buffer_load_dwordx4 v[140:143], v18, s[4:7], s32 offen nt
    s_add_u32 s32, s32, 8192
    buffer_load_dwordx4 v[144:147], v18, s[4:7], s32 offen nt
    s_add_u32 s32, s32, 8192
    buffer_load_dwordx4 v[148:151], v18, s[4:7], s32 offen nt
    s_add_u32 s32, s32, 8192
    buffer_load_dwordx4 v[152:155], v18, s[4:7], s32 offen nt
    s_add_u32 s32, s32, 8192
    buffer_load_dwordx4 v[156:159], v18, s[4:7], s32 offen nt
    s_add_u32 s32, s32, 8192
    buffer_load_dwordx4 v[160:163], v18, s[4:7], s32 offen nt
    s_add_u32 s32, s32, 8192
    buffer_load_dwordx4 v[164:167], v18, s[4:7], s32 offen nt
    s_add_u32 s32, s32, 8192
    buffer_load_dwordx4 v[168:171], v18, s[4:7], s32 offen nt
    s_add_u32 s32, s32, 8192
    buffer_load_dwordx4 v[172:175], v18, s[4:7], s32 offen nt
    s_add_u32 s32, s32, 8192
    buffer_load_dwordx4 v[176:179], v18, s[4:7], s32 offen nt
    s_add_u32 s32, s32, 8192
    buffer_load_dwordx4 v[180:183], v18, s[4:7], s32 offen nt
    s_add_u32 s32, s32, 8192
    buffer_load_dwordx4 v[184:187], v18, s[4:7], s32 offen nt
    s_add_u32 s32, s32, 8192
    buffer_load_dwordx4 v[188:191], v18, s[4:7], s32 offen nt
    s_add_u32 s32, s32, 8192
    s_mov_b32 s12, s62
    s_mov_b32 s13, s63
    s_mov_b32 s14, 0x400000
    s_mov_b32 s15, 0x20000
    s_mov_b32 s16, s60
    s_mov_b32 s17, s61
    s_mov_b32 s18, 0x100
    s_mov_b32 s19, 0x20000
    v_and_b32 v3, 1, v0
    v_lshlrev_b32 v3, 4, v3
    v_mov_b32 v4, 0xffff
    v_lshlrev_b32 v4, v3, v4
    v_bfe_u32 v3, v0, 1, 2
    v_cmp_eq_u32 vcc, 0, v3
    s_nop 1
    v_cndmask_b32 v20, 0, v4, vcc
    v_cmp_eq_u32 vcc, 1, v3
    s_nop 1
    v_cndmask_b32 v21, 0, v4, vcc
    v_cmp_eq_u32 vcc, 2, v3
    s_nop 1
    v_cndmask_b32 v22, 0, v4, vcc
    v_cmp_eq_u32 vcc, 3, v3
    s_nop 1
    v_cndmask_b32 v23, 0, v4, vcc
    v_mov_b32 v3, 0x0c0c0c0c
    s_mov_b32 s24, 0x01000100
    s_mov_b32 s25, 0x03020302
    v_bfi_b32 v24, v20, s24, v3
    v_bfi_b32 v28, v20, s25, v3
    v_bfi_b32 v25, v21, s24, v3
    v_bfi_b32 v29, v21, s25, v3
    v_bfi_b32 v26, v22, s24, v3
    v_bfi_b32 v30, v22, s25, v3
    v_bfi_b32 v27, v23, s24, v3
    v_bfi_b32 v31, v23, s25, v3
    s_mov_b32 s64, 0x22222222
    s_mov_b32 s65, 0x22222222
    s_mov_b32 s66, 0x44444444
    s_mov_b32 s67, 0x44444444
    s_mov_b32 s68, 0x88888888
    s_mov_b32 s69, 0x88888888
    s_lshl_b32 s24, s3, 8
    s_add_u32 s24, s24, 145408
    v_add_u32 v3, s24, v67
    v_add_u32 v4, s24, v19
    s_waitcnt vmcnt(16)
    ds_write_b128 v3, v[12:15]
    s_waitcnt lgkmcnt(0)
    ds_read_b128 v[32:35], v4 offset:0
    ds_read_b128 v[36:39], v4 offset:16
    ds_read_b128 v[40:43], v4 offset:32
    ds_read_b128 v[44:47], v4 offset:48
    ds_read_b128 v[48:51], v4 offset:2048
    ds_read_b128 v[52:55], v4 offset:2064
    ds_read_b128 v[56:59], v4 offset:2080
    ds_read_b128 v[60:63], v4 offset:2096
    s_waitcnt lgkmcnt(0)
    v_perm_b32 v8, v32, v32, v24
    v_perm_b32 v9, v32, v32, v25
    v_perm_b32 v10, v32, v32, v26
    v_perm_b32 v11, v32, v32, v27
    s_waitcnt vmcnt(15)
    s_nop 0
    v_mfma_f32_16x16x32_bf16 v[12:15], v[128:131], v[8:11], 0
    v_perm_b32 v4, v48, v48, v24
    v_perm_b32 v5, v48, v48, v25
    v_perm_b32 v6, v48, v48, v26
    v_perm_b32 v7, v48, v48, v27
    s_nop 1
    v_mfma_f32_16x16x32_bf16 v[68:71], v[128:131], v[4:7], 0
    buffer_load_dwordx4 v[192:195], v18, s[4:7], s32 offen nt
    s_add_u32 s32, s32, 8192
    v_perm_b32 v8, v32, v32, v28
    v_perm_b32 v9, v32, v32, v29
    v_perm_b32 v10, v32, v32, v30
    v_perm_b32 v11, v32, v32, v31
    s_waitcnt vmcnt(15)
    s_nop 0
    v_mfma_f32_16x16x32_bf16 v[12:15], v[132:135], v[8:11], v[12:15]
    v_perm_b32 v4, v48, v48, v28
    v_perm_b32 v5, v48, v48, v29
    v_perm_b32 v6, v48, v48, v30
    v_perm_b32 v7, v48, v48, v31
    s_nop 1
    v_mfma_f32_16x16x32_bf16 v[68:71], v[132:135], v[4:7], v[68:71]
    buffer_load_dwordx4 v[196:199], v18, s[4:7], s32 offen nt
    s_add_u32 s32, s32, 8192
    v_perm_b32 v8, v33, v33, v24
    v_perm_b32 v9, v33, v33, v25
    v_perm_b32 v10, v33, v33, v26
    v_perm_b32 v11, v33, v33, v27
    s_waitcnt vmcnt(15)
    s_nop 0
    v_mfma_f32_16x16x32_bf16 v[12:15], v[136:139], v[8:11], v[12:15]
    v_perm_b32 v4, v49, v49, v24
    v_perm_b32 v5, v49, v49, v25
    v_perm_b32 v6, v49, v49, v26
    v_perm_b32 v7, v49, v49, v27
    s_nop 1
    v_mfma_f32_16x16x32_bf16 v[68:71], v[136:139], v[4:7], v[68:71]
    buffer_load_dwordx4 v[200:203], v18, s[4:7], s32 offen nt
    s_add_u32 s32, s32, 8192
    v_perm_b32 v8, v33, v33, v28
    v_perm_b32 v9, v33, v33, v29
    v_perm_b32 v10, v33, v33, v30
    v_perm_b32 v11, v33, v33, v31
    s_waitcnt vmcnt(15)
    s_nop 0
    v_mfma_f32_16x16x32_bf16 v[12:15], v[140:143], v[8:11], v[12:15]
    v_perm_b32 v4, v49, v49, v28
    v_perm_b32 v5, v49, v49, v29
    v_perm_b32 v6, v49, v49, v30
    v_perm_b32 v7, v49, v49, v31
    s_nop 1
    v_mfma_f32_16x16x32_bf16 v[68:71], v[140:143], v[4:7], v[68:71]
    buffer_load_dwordx4 v[204:207], v18, s[4:7], s32 offen nt
    s_add_u32 s32, s32, 8192
    v_perm_b32 v8, v34, v34, v24
    v_perm_b32 v9, v34, v34, v25
    v_perm_b32 v10, v34, v34, v26
    v_perm_b32 v11, v34, v34, v27
    s_waitcnt vmcnt(15)
    s_nop 0
    v_mfma_f32_16x16x32_bf16 v[12:15], v[144:147], v[8:11], v[12:15]
    v_perm_b32 v4, v50, v50, v24
    v_perm_b32 v5, v50, v50, v25
    v_perm_b32 v6, v50, v50, v26
    v_perm_b32 v7, v50, v50, v27
    s_nop 1
    v_mfma_f32_16x16x32_bf16 v[68:71], v[144:147], v[4:7], v[68:71]
    buffer_load_dwordx4 v[208:211], v18, s[4:7], s32 offen nt
    s_add_u32 s32, s32, 8192
    v_perm_b32 v8, v34, v34, v28
    v_perm_b32 v9, v34, v34, v29
    v_perm_b32 v10, v34, v34, v30
    v_perm_b32 v11, v34, v34, v31
    s_waitcnt vmcnt(15)
    s_nop 0
    v_mfma_f32_16x16x32_bf16 v[12:15], v[148:151], v[8:11], v[12:15]
    v_perm_b32 v4, v50, v50, v28
    v_perm_b32 v5, v50, v50, v29
    v_perm_b32 v6, v50, v50, v30
    v_perm_b32 v7, v50, v50, v31
    s_nop 1
    v_mfma_f32_16x16x32_bf16 v[68:71], v[148:151], v[4:7], v[68:71]
    buffer_load_dwordx4 v[212:215], v18, s[4:7], s32 offen nt
    s_add_u32 s32, s32, 8192
    v_perm_b32 v8, v35, v35, v24
    v_perm_b32 v9, v35, v35, v25
    v_perm_b32 v10, v35, v35, v26
    v_perm_b32 v11, v35, v35, v27
    s_waitcnt vmcnt(15)
    s_nop 0
    v_mfma_f32_16x16x32_bf16 v[12:15], v[152:155], v[8:11], v[12:15]
    v_perm_b32 v4, v51, v51, v24
    v_perm_b32 v5, v51, v51, v25
    v_perm_b32 v6, v51, v51, v26
    v_perm_b32 v7, v51, v51, v27
    s_nop 1
    v_mfma_f32_16x16x32_bf16 v[68:71], v[152:155], v[4:7], v[68:71]
    buffer_load_dwordx4 v[216:219], v18, s[4:7], s32 offen nt
    s_add_u32 s32, s32, 8192
    v_perm_b32 v8, v35, v35, v28
    v_perm_b32 v9, v35, v35, v29
    v_perm_b32 v10, v35, v35, v30
    v_perm_b32 v11, v35, v35, v31
    s_waitcnt vmcnt(15)
    s_nop 0
    v_mfma_f32_16x16x32_bf16 v[12:15], v[156:159], v[8:11], v[12:15]
    v_perm_b32 v4, v51, v51, v28
    v_perm_b32 v5, v51, v51, v29
    v_perm_b32 v6, v51, v51, v30
    v_perm_b32 v7, v51, v51, v31
    s_nop 1
    v_mfma_f32_16x16x32_bf16 v[68:71], v[156:159], v[4:7], v[68:71]
    buffer_load_dwordx4 v[220:223], v18, s[4:7], s32 offen nt
    s_add_u32 s32, s32, 8192
    v_perm_b32 v8, v36, v36, v24
    v_perm_b32 v9, v36, v36, v25
    v_perm_b32 v10, v36, v36, v26
    v_perm_b32 v11, v36, v36, v27
    s_waitcnt vmcnt(15)
    s_nop 0
    v_mfma_f32_16x16x32_bf16 v[12:15], v[160:163], v[8:11], v[12:15]
    v_perm_b32 v4, v52, v52, v24
    v_perm_b32 v5, v52, v52, v25
    v_perm_b32 v6, v52, v52, v26
    v_perm_b32 v7, v52, v52, v27
    s_nop 1
    v_mfma_f32_16x16x32_bf16 v[68:71], v[160:163], v[4:7], v[68:71]
    buffer_load_dwordx4 v[224:227], v18, s[4:7], s32 offen nt
    s_add_u32 s32, s32, 8192
    v_perm_b32 v8, v36, v36, v28
    v_perm_b32 v9, v36, v36, v29
    v_perm_b32 v10, v36, v36, v30
    v_perm_b32 v11, v36, v36, v31
    s_waitcnt vmcnt(15)
    s_nop 0
    v_mfma_f32_16x16x32_bf16 v[12:15], v[164:167], v[8:11], v[12:15]
    v_perm_b32 v4, v52, v52, v28
    v_perm_b32 v5, v52, v52, v29
    v_perm_b32 v6, v52, v52, v30
    v_perm_b32 v7, v52, v52, v31
    s_nop 1
    v_mfma_f32_16x16x32_bf16 v[68:71], v[164:167], v[4:7], v[68:71]
    buffer_load_dwordx4 v[228:231], v18, s[4:7], s32 offen nt
    s_add_u32 s32, s32, 8192
    v_perm_b32 v8, v37, v37, v24
    v_perm_b32 v9, v37, v37, v25
    v_perm_b32 v10, v37, v37, v26
    v_perm_b32 v11, v37, v37, v27
    s_waitcnt vmcnt(15)
    s_nop 0
    v_mfma_f32_16x16x32_bf16 v[12:15], v[168:171], v[8:11], v[12:15]
    v_perm_b32 v4, v53, v53, v24
    v_perm_b32 v5, v53, v53, v25
    v_perm_b32 v6, v53, v53, v26
    v_perm_b32 v7, v53, v53, v27
    s_nop 1
    v_mfma_f32_16x16x32_bf16 v[68:71], v[168:171], v[4:7], v[68:71]
    buffer_load_dwordx4 v[232:235], v18, s[4:7], s32 offen nt
    s_add_u32 s32, s32, 8192
    v_perm_b32 v8, v37, v37, v28
    v_perm_b32 v9, v37, v37, v29
    v_perm_b32 v10, v37, v37, v30
    v_perm_b32 v11, v37, v37, v31
    s_waitcnt vmcnt(15)
    s_nop 0
    v_mfma_f32_16x16x32_bf16 v[12:15], v[172:175], v[8:11], v[12:15]
    v_perm_b32 v4, v53, v53, v28
    v_perm_b32 v5, v53, v53, v29
    v_perm_b32 v6, v53, v53, v30
    v_perm_b32 v7, v53, v53, v31
    s_nop 1
    v_mfma_f32_16x16x32_bf16 v[68:71], v[172:175], v[4:7], v[68:71]
    buffer_load_dwordx4 v[236:239], v18, s[4:7], s32 offen nt
    s_add_u32 s32, s32, 8192
    v_perm_b32 v8, v38, v38, v24
    v_perm_b32 v9, v38, v38, v25
    v_perm_b32 v10, v38, v38, v26
    v_perm_b32 v11, v38, v38, v27
    s_waitcnt vmcnt(15)
    s_nop 0
    v_mfma_f32_16x16x32_bf16 v[12:15], v[176:179], v[8:11], v[12:15]
    v_perm_b32 v4, v54, v54, v24
    v_perm_b32 v5, v54, v54, v25
    v_perm_b32 v6, v54, v54, v26
    v_perm_b32 v7, v54, v54, v27
    s_nop 1
    v_mfma_f32_16x16x32_bf16 v[68:71], v[176:179], v[4:7], v[68:71]
    buffer_load_dwordx4 v[240:243], v18, s[4:7], s32 offen nt
    s_add_u32 s32, s32, 8192
    v_perm_b32 v8, v38, v38, v28
    v_perm_b32 v9, v38, v38, v29
    v_perm_b32 v10, v38, v38, v30
    v_perm_b32 v11, v38, v38, v31
    s_waitcnt vmcnt(15)
    s_nop 0
    v_mfma_f32_16x16x32_bf16 v[12:15], v[180:183], v[8:11], v[12:15]
    v_perm_b32 v4, v54, v54, v28
    v_perm_b32 v5, v54, v54, v29
    v_perm_b32 v6, v54, v54, v30
    v_perm_b32 v7, v54, v54, v31
    s_nop 1
    v_mfma_f32_16x16x32_bf16 v[68:71], v[180:183], v[4:7], v[68:71]
    buffer_load_dwordx4 v[244:247], v18, s[4:7], s32 offen nt
    s_add_u32 s32, s32, 8192
    v_perm_b32 v8, v39, v39, v24
    v_perm_b32 v9, v39, v39, v25
    v_perm_b32 v10, v39, v39, v26
    v_perm_b32 v11, v39, v39, v27
    s_waitcnt vmcnt(15)
    s_nop 0
    v_mfma_f32_16x16x32_bf16 v[12:15], v[184:187], v[8:11], v[12:15]
    v_perm_b32 v4, v55, v55, v24
    v_perm_b32 v5, v55, v55, v25
    v_perm_b32 v6, v55, v55, v26
    v_perm_b32 v7, v55, v55, v27
    s_nop 1
    v_mfma_f32_16x16x32_bf16 v[68:71], v[184:187], v[4:7], v[68:71]
    buffer_load_dwordx4 v[248:251], v18, s[4:7], s32 offen nt
    s_add_u32 s32, s32, 8192
    v_perm_b32 v8, v39, v39, v28
    v_perm_b32 v9, v39, v39, v29
    v_perm_b32 v10, v39, v39, v30
    v_perm_b32 v11, v39, v39, v31
    s_waitcnt vmcnt(15)
    s_nop 0
    v_mfma_f32_16x16x32_bf16 v[12:15], v[188:191], v[8:11], v[12:15]
    v_perm_b32 v4, v55, v55, v28
    v_perm_b32 v5, v55, v55, v29
    v_perm_b32 v6, v55, v55, v30
    v_perm_b32 v7, v55, v55, v31
    s_nop 1
    v_mfma_f32_16x16x32_bf16 v[68:71], v[188:191], v[4:7], v[68:71]
    buffer_load_dwordx4 v[252:255], v18, s[4:7], s32 offen nt
    s_add_u32 s32, s32, 8192
    v_perm_b32 v8, v40, v40, v24
    v_perm_b32 v9, v40, v40, v25
    v_perm_b32 v10, v40, v40, v26
    v_perm_b32 v11, v40, v40, v27
    s_waitcnt vmcnt(15)
    s_nop 0
    v_mfma_f32_16x16x32_bf16 v[12:15], v[192:195], v[8:11], v[12:15]
    v_perm_b32 v4, v56, v56, v24
    v_perm_b32 v5, v56, v56, v25
    v_perm_b32 v6, v56, v56, v26
    v_perm_b32 v7, v56, v56, v27
    s_nop 1
    v_mfma_f32_16x16x32_bf16 v[68:71], v[192:195], v[4:7], v[68:71]
    v_mov_b32 v76, -1
    v_mov_b32 v77, -1
    v_mov_b32 v78, -1
    v_mov_b32 v79, -1
    s_lshl_b32 s73, s74, 7
    s_add_u32 s73, s73, 0x170000
    s_cmp_lg_u32 s3, 0
    s_cbranch_scc1 L_A_nofl
    s_mov_b64 exec, 1
    buffer_store_dwordx4 v[76:79], off, s[12:15], s73 sc1
    s_mov_b64 exec, -1
L_A_nofl:
    s_cmp_lt_u32 s74, 32
    s_cbranch_scc1 L_A_noclr
    s_lshl_b32 s24, s72, 2
    s_add_u32 s24, s24, s3
    s_lshl_b32 s24, s24, 12
    s_add_u32 s24, s24, 0x180000
    s_cmp_ge_u32 s24, 0x1f8000
    s_cbranch_scc1 L_A_noclr
    buffer_store_dwordx4 v[76:79], v2, s[12:15], s24 offen offset:0 sc1
    buffer_store_dwordx4 v[76:79], v2, s[12:15], s24 offen offset:1024 sc1
    buffer_store_dwordx4 v[76:79], v2, s[12:15], s24 offen offset:2048 sc1
    buffer_store_dwordx4 v[76:79], v2, s[12:15], s24 offen offset:3072 sc1
L_A_noclr:
    s_getpc_b64 s[20:21]
L_pc4:
    s_add_u32 s20, s20, L_A2-L_pc4
    s_addc_u32 s21, s21, 0
    s_mov_b32 s22, L_last-L_A2
    s_mov_b32 s23, 0x20000
    v_lshl_add_u32 v3, v0, 2, s3
    v_lshlrev_b32 v3, 7, v3
    buffer_load_dword v17, v3, s[20:23], 0 offen
    s_mov_b32 s4, s42
    s_mov_b32 s5, s43
    s_mov_b32 s6, s75
    s_mov_b32 s32, s35
    buffer_load_dwordx4 v[128:131], v64, s[4:7], s32 offen nt
    s_add_u32 s32, s32, 8192
    v_perm_b32 v8, v40, v40, v28
    v_perm_b32 v9, v40, v40, v29
    v_perm_b32 v10, v40, v40, v30
    v_perm_b32 v11, v40, v40, v31
    s_waitcnt vmcnt(15)
    s_nop 0
    v_mfma_f32_16x16x32_bf16 v[12:15], v[196:199], v[8:11], v[12:15]
    v_perm_b32 v4, v56, v56, v28
    v_perm_b32 v5, v56, v56, v29
    v_perm_b32 v6, v56, v56, v30
    v_perm_b32 v7, v56, v56, v31
    s_nop 1
    v_mfma_f32_16x16x32_bf16 v[68:71], v[196:199], v[4:7], v[68:71]
    buffer_load_dwordx4 v[132:135], v64, s[4:7], s32 offen nt
    s_add_u32 s32, s32, 8192
    v_perm_b32 v8, v41, v41, v24
    v_perm_b32 v9, v41, v41, v25
    v_perm_b32 v10, v41, v41, v26
    v_perm_b32 v11, v41, v41, v27
    s_waitcnt vmcnt(15)
    s_nop 0
    v_mfma_f32_16x16x32_bf16 v[12:15], v[200:203], v[8:11], v[12:15]
    v_perm_b32 v4, v57, v57, v24
    v_perm_b32 v5, v57, v57, v25
    v_perm_b32 v6, v57, v57, v26
    v_perm_b32 v7, v57, v57, v27
    s_nop 1
    v_mfma_f32_16x16x32_bf16 v[68:71], v[200:203], v[4:7], v[68:71]
    buffer_load_dwordx4 v[136:139], v64, s[4:7], s32 offen nt
    s_add_u32 s32, s32, 8192
    v_perm_b32 v8, v41, v41, v28
    v_perm_b32 v9, v41, v41, v29
    v_perm_b32 v10, v41, v41, v30
    v_perm_b32 v11, v41, v41, v31
    s_waitcnt vmcnt(15)
    s_nop 0
    v_mfma_f32_16x16x32_bf16 v[12:15], v[204:207], v[8:11], v[12:15]
    v_perm_b32 v4, v57, v57, v28
    v_perm_b32 v5, v57, v57, v29
    v_perm_b32 v6, v57, v57, v30
    v_perm_b32 v7, v57, v57, v31
    s_nop 1
    v_mfma_f32_16x16x32_bf16 v[68:71], v[204:207], v[4:7], v[68:71]
    buffer_load_dwordx4 v[140:143], v64, s[4:7], s32 offen nt
    s_add_u32 s32, s32, 8192
    v_perm_b32 v8, v42, v42, v24
    v_perm_b32 v9, v42, v42, v25
    v_perm_b32 v10, v42, v42, v26
    v_perm_b32 v11, v42, v42, v27
    s_waitcnt vmcnt(15)
    s_nop 0
    v_mfma_f32_16x16x32_bf16 v[12:15], v[208:211], v[8:11], v[12:15]
    v_perm_b32 v4, v58, v58, v24
    v_perm_b32 v5, v58, v58, v25
    v_perm_b32 v6, v58, v58, v26
    v_perm_b32 v7, v58, v58, v27
    s_nop 1
    v_mfma_f32_16x16x32_bf16 v[68:71], v[208:211], v[4:7], v[68:71]
    buffer_load_dwordx4 v[144:147], v64, s[4:7], s32 offen nt
    s_add_u32 s32, s32, 8192
    v_perm_b32 v8, v42, v42, v28
    v_perm_b32 v9, v42, v42, v29
    v_perm_b32 v10, v42, v42, v30
    v_perm_b32 v11, v42, v42, v31
    s_waitcnt vmcnt(15)
    s_nop 0
    v_mfma_f32_16x16x32_bf16 v[12:15], v[212:215], v[8:11], v[12:15]
    v_perm_b32 v4, v58, v58, v28
    v_perm_b32 v5, v58, v58, v29
    v_perm_b32 v6, v58, v58, v30
    v_perm_b32 v7, v58, v58, v31
    s_nop 1
    v_mfma_f32_16x16x32_bf16 v[68:71], v[212:215], v[4:7], v[68:71]
    buffer_load_dwordx4 v[148:151], v64, s[4:7], s32 offen nt
    s_add_u32 s32, s32, 8192
    v_perm_b32 v8, v43, v43, v24
    v_perm_b32 v9, v43, v43, v25
    v_perm_b32 v10, v43, v43, v26
    v_perm_b32 v11, v43, v43, v27
    s_waitcnt vmcnt(15)
    s_nop 0
    v_mfma_f32_16x16x32_bf16 v[12:15], v[216:219], v[8:11], v[12:15]
    v_perm_b32 v4, v59, v59, v24
    v_perm_b32 v5, v59, v59, v25
    v_perm_b32 v6, v59, v59, v26
    v_perm_b32 v7, v59, v59, v27
    s_nop 1
    v_mfma_f32_16x16x32_bf16 v[68:71], v[216:219], v[4:7], v[68:71]
    buffer_load_dwordx4 v[152:155], v64, s[4:7], s32 offen nt
    s_add_u32 s32, s32, 8192
    v_perm_b32 v8, v43, v43, v28
    v_perm_b32 v9, v43, v43, v29
    v_perm_b32 v10, v43, v43, v30
    v_perm_b32 v11, v43, v43, v31
    s_waitcnt vmcnt(15)
    s_nop 0
    v_mfma_f32_16x16x32_bf16 v[12:15], v[220:223], v[8:11], v[12:15]
    v_perm_b32 v4, v59, v59, v28
    v_perm_b32 v5, v59, v59, v29
    v_perm_b32 v6, v59, v59, v30
    v_perm_b32 v7, v59, v59, v31
    s_nop 1
    v_mfma_f32_16x16x32_bf16 v[68:71], v[220:223], v[4:7], v[68:71]
    buffer_load_dwordx4 v[156:159], v64, s[4:7], s32 offen nt
    s_add_u32 s32, s32, 8192
    v_perm_b32 v8, v44, v44, v24
    v_perm_b32 v9, v44, v44, v25
    v_perm_b32 v10, v44, v44, v26
    v_perm_b32 v11, v44, v44, v27
    s_waitcnt vmcnt(15)
    s_nop 0
    v_mfma_f32_16x16x32_bf16 v[12:15], v[224:227], v[8:11], v[12:15]
    v_perm_b32 v4, v60, v60, v24
    v_perm_b32 v5, v60, v60, v25
    v_perm_b32 v6, v60, v60, v26
    v_perm_b32 v7, v60, v60, v27
    s_nop 1
    v_mfma_f32_16x16x32_bf16 v[68:71], v[224:227], v[4:7], v[68:71]
    buffer_load_dwordx4 v[160:163], v64, s[4:7], s32 offen nt
    s_add_u32 s32, s32, 8192
    v_perm_b32 v8, v44, v44, v28
    v_perm_b32 v9, v44, v44, v29
    v_perm_b32 v10, v44, v44, v30
    v_perm_b32 v11, v44, v44, v31
    s_waitcnt vmcnt(15)
    s_nop 0
    v_mfma_f32_16x16x32_bf16 v[12:15], v[228:231], v[8:11], v[12:15]
    v_perm_b32 v4, v60, v60, v28
    v_perm_b32 v5, v60, v60, v29
    v_perm_b32 v6, v60, v60, v30
    v_perm_b32 v7, v60, v60, v31
    s_nop 1
    v_mfma_f32_16x16x32_bf16 v[68:71], v[228:231], v[4:7], v[68:71]
    buffer_load_dwordx4 v[164:167], v64, s[4:7], s32 offen nt
    s_add_u32 s32, s32, 8192
    v_perm_b32 v8, v45, v45, v24
    v_perm_b32 v9, v45, v45, v25
    v_perm_b32 v10, v45, v45, v26
    v_perm_b32 v11, v45, v45, v27
    s_waitcnt vmcnt(15)
    s_nop 0
    v_mfma_f32_16x16x32_bf16 v[12:15], v[232:235], v[8:11], v[12:15]
    v_perm_b32 v4, v61, v61, v24
    v_perm_b32 v5, v61, v61, v25
    v_perm_b32 v6, v61, v61, v26
    v_perm_b32 v7, v61, v61, v27
    s_nop 1
    v_mfma_f32_16x16x32_bf16 v[68:71], v[232:235], v[4:7], v[68:71]
    buffer_load_dwordx4 v[168:171], v64, s[4:7], s32 offen nt
    s_add_u32 s32, s32, 8192
    v_perm_b32 v8, v45, v45, v28
    v_perm_b32 v9, v45, v45, v29
    v_perm_b32 v10, v45, v45, v30
    v_perm_b32 v11, v45, v45, v31
    s_waitcnt vmcnt(15)
    s_nop 0
    v_mfma_f32_16x16x32_bf16 v[12:15], v[236:239], v[8:11], v[12:15]
    v_perm_b32 v4, v61, v61, v28
    v_perm_b32 v5, v61, v61, v29
    v_perm_b32 v6, v61, v61, v30
    v_perm_b32 v7, v61, v61, v31
    s_nop 1
    v_mfma_f32_16x16x32_bf16 v[68:71], v[236:239], v[4:7], v[68:71]
    buffer_load_dwordx4 v[172:175], v64, s[4:7], s32 offen nt
    s_add_u32 s32, s32, 8192
    v_perm_b32 v8, v46, v46, v24
    v_perm_b32 v9, v46, v46, v25
    v_perm_b32 v10, v46, v46, v26
    v_perm_b32 v11, v46, v46, v27
    s_waitcnt vmcnt(15)
    s_nop 0
    v_mfma_f32_16x16x32_bf16 v[12:15], v[240:243], v[8:11], v[12:15]
    v_perm_b32 v4, v62, v62, v24
    v_perm_b32 v5, v62, v62, v25
    v_perm_b32 v6, v62, v62, v26
    v_perm_b32 v7, v62, v62, v27
    s_nop 1
    v_mfma_f32_16x16x32_bf16 v[68:71], v[240:243], v[4:7], v[68:71]
    buffer_load_dwordx4 v[176:179], v64, s[4:7], s32 offen nt
    s_add_u32 s32, s32, 8192
    v_perm_b32 v8, v46, v46, v28
    v_perm_b32 v9, v46, v46, v29
    v_perm_b32 v10, v46, v46, v30
    v_perm_b32 v11, v46, v46, v31
    s_waitcnt vmcnt(15)
    s_nop 0
    v_mfma_f32_16x16x32_bf16 v[12:15], v[244:247], v[8:11], v[12:15]
    v_perm_b32 v4, v62, v62, v28
    v_perm_b32 v5, v62, v62, v29
    v_perm_b32 v6, v62, v62, v30
    v_perm_b32 v7, v62, v62, v31
    s_nop 1
    v_mfma_f32_16x16x32_bf16 v[68:71], v[244:247], v[4:7], v[68:71]
    buffer_load_dwordx4 v[180:183], v64, s[4:7], s32 offen nt
    s_add_u32 s32, s32, 8192
    v_perm_b32 v8, v47, v47, v24
    v_perm_b32 v9, v47, v47, v25
    v_perm_b32 v10, v47, v47, v26
    v_perm_b32 v11, v47, v47, v27
    s_waitcnt vmcnt(15)
    s_nop 0
    v_mfma_f32_16x16x32_bf16 v[12:15], v[248:251], v[8:11], v[12:15]
    v_perm_b32 v4, v63, v63, v24
    v_perm_b32 v5, v63, v63, v25
    v_perm_b32 v6, v63, v63, v26
    v_perm_b32 v7, v63, v63, v27
    s_nop 1
    v_mfma_f32_16x16x32_bf16 v[68:71], v[248:251], v[4:7], v[68:71]
    buffer_load_dwordx4 v[184:187], v64, s[4:7], s32 offen nt
    s_add_u32 s32, s32, 8192
    v_perm_b32 v8, v47, v47, v28
    v_perm_b32 v9, v47, v47, v29
    v_perm_b32 v10, v47, v47, v30
    v_perm_b32 v11, v47, v47, v31
    s_waitcnt vmcnt(15)
    s_nop 0
    v_mfma_f32_16x16x32_bf16 v[12:15], v[252:255], v[8:11], v[12:15]
    v_perm_b32 v4, v63, v63, v28
    v_perm_b32 v5, v63, v63, v29
    v_perm_b32 v6, v63, v63, v30
    v_perm_b32 v7, v63, v63, v31
    s_nop 1
    v_mfma_f32_16x16x32_bf16 v[68:71], v[252:255], v[4:7], v[68:71]
    buffer_load_dwordx4 v[188:191], v64, s[4:7], s32 offen nt
    s_add_u32 s32, s32, 8192
    v_lshrrev_b32 v3, 4, v0
    v_lshlrev_b32 v3, 7, v3
    v_and_b32 v4, 7, v0
    v_lshl_add_u32 v3, v4, 2, v3
    v_bfe_u32 v4, v0, 3, 1
    v_lshl_add_u32 v3, v4, 9, v3
    s_lshl_b32 s24, s3, 11
    s_add_u32 s24, s24, 135168
    v_add_u32 v3, s24, v3
    ds_write_b32 v3, v12 offset:0
    ds_write_b32 v3, v13 offset:32
    ds_write_b32 v3, v14 offset:64
    ds_write_b32 v3, v15 offset:96
    ds_write_b32 v3, v68 offset:1024
    ds_write_b32 v3, v69 offset:1056
    ds_write_b32 v3, v70 offset:1088
    ds_write_b32 v3, v71 offset:1120
    s_waitcnt lgkmcnt(0)
    s_barrier
    ds_read_b128 v[72:75], v65 offset:0
    ds_read_b128 v[76:79], v65 offset:16
    ds_read_b128 v[80:83], v65 offset:2048
    ds_read_b128 v[84:87], v65 offset:2064
    ds_read_b128 v[88:91], v65 offset:4096
    ds_read_b128 v[92:95], v65 offset:4112
    ds_read_b128 v[96:99], v65 offset:6144
    ds_read_b128 v[100:103], v65 offset:6160
    s_waitcnt lgkmcnt(4)
    v_add_f32 v72, v72, v80
    v_add_f32 v73, v73, v81
    v_add_f32 v74, v74, v82
    v_add_f32 v75, v75, v83
    v_add_f32 v76, v76, v84
    v_add_f32 v77, v77, v85
    v_add_f32 v78, v78, v86
    v_add_f32 v79, v79, v87
    s_waitcnt lgkmcnt(2)
    v_add_f32 v72, v72, v88
    v_add_f32 v73, v73, v89
    v_add_f32 v74, v74, v90
    v_add_f32 v75, v75, v91
    v_add_f32 v76, v76, v92
    v_add_f32 v77, v77, v93
    v_add_f32 v78, v78, v94
    v_add_f32 v79, v79, v95
    s_waitcnt lgkmcnt(0)
    v_add_f32 v72, v72, v96
    v_add_f32 v73, v73, v97
    v_add_f32 v74, v74, v98
    v_add_f32 v75, v75, v99
    v_add_f32 v76, v76, v100
    v_add_f32 v77, v77, v101
    v_add_f32 v78, v78, v102
    v_add_f32 v79, v79, v103
    v_cvt_pk_bf16_f32 v8, v72, v73
    v_cvt_pk_bf16_f32 v9, v74, v75
    v_cvt_pk_bf16_f32 v10, v76, v77
    v_cvt_pk_bf16_f32 v11, v78, v79
    s_cmp_ge_u32 s74, 32
    s_cbranch_scc1 L_C
L_A2:
    buffer_load_dwordx4 v[192:195], v64, s[4:7], s32 offen nt
    s_add_u32 s32, s32, 8192
    s_waitcnt vmcnt(16)
    v_mfma_f32_16x16x32_bf16 v[68:71], v[128:131], v[8:11], 0
    s_nop 7
    v_add_f32_dpp v72, v69, v68 quad_perm:[1,1,1,1] row_mask:0xf bank_mask:0xf
    s_nop 1
    v_add_f32_dpp v72, v70, v72 quad_perm:[2,2,2,2] row_mask:0xf bank_mask:0xf
    s_nop 1
    v_add_f32_dpp v72, v71, v72 quad_perm:[3,3,3,3] row_mask:0xf bank_mask:0xf
    buffer_load_dwordx4 v[196:199], v64, s[4:7], s32 offen nt
    s_add_u32 s32, s32, 8192
    s_waitcnt vmcnt(16)
    v_mfma_f32_16x16x32_bf16 v[12:15], v[132:135], v[8:11], 0
    s_nop 7
    v_add_f32_dpp v73, v13, v12 quad_perm:[1,1,1,1] row_mask:0xf bank_mask:0xf
    s_nop 1
    v_add_f32_dpp v73, v14, v73 quad_perm:[2,2,2,2] row_mask:0xf bank_mask:0xf
    s_nop 1
    v_add_f32_dpp v73, v15, v73 quad_perm:[3,3,3,3] row_mask:0xf bank_mask:0xf
    buffer_load_dwordx4 v[200:203], v64, s[4:7], s32 offen nt
    s_add_u32 s32, s32, 8192
    s_waitcnt vmcnt(16)
    v_mfma_f32_16x16x32_bf16 v[68:71], v[136:139], v[8:11], 0
    s_nop 7
    v_add_f32_dpp v74, v69, v68 quad_perm:[1,1,1,1] row_mask:0xf bank_mask:0xf
    s_nop 1
    v_add_f32_dpp v74, v70, v74 quad_perm:[2,2,2,2] row_mask:0xf bank_mask:0xf
    s_nop 1
    v_add_f32_dpp v74, v71, v74 quad_perm:[3,3,3,3] row_mask:0xf bank_mask:0xf
    buffer_load_dwordx4 v[204:207], v64, s[4:7], s32 offen nt
    s_add_u32 s32, s32, 8192
    s_waitcnt vmcnt(16)
    v_mfma_f32_16x16x32_bf16 v[12:15], v[140:143], v[8:11], 0
    s_nop 7
    v_add_f32_dpp v75, v13, v12 quad_perm:[1,1,1,1] row_mask:0xf bank_mask:0xf
    s_nop 1
    v_add_f32_dpp v75, v14, v75 quad_perm:[2,2,2,2] row_mask:0xf bank_mask:0xf
    s_nop 1
    v_add_f32_dpp v75, v15, v75 quad_perm:[3,3,3,3] row_mask:0xf bank_mask:0xf
    buffer_load_dwordx4 v[208:211], v64, s[4:7], s32 offen nt
    s_add_u32 s32, s32, 8192
    s_waitcnt vmcnt(16)
    v_mfma_f32_16x16x32_bf16 v[68:71], v[144:147], v[8:11], 0
    s_nop 7
    v_add_f32_dpp v76, v69, v68 quad_perm:[1,1,1,1] row_mask:0xf bank_mask:0xf
    s_nop 1
    v_add_f32_dpp v76, v70, v76 quad_perm:[2,2,2,2] row_mask:0xf bank_mask:0xf
    s_nop 1
    v_add_f32_dpp v76, v71, v76 quad_perm:[3,3,3,3] row_mask:0xf bank_mask:0xf
    buffer_load_dwordx4 v[212:215], v64, s[4:7], s32 offen nt
    s_add_u32 s32, s32, 8192
    s_waitcnt vmcnt(16)
    v_mfma_f32_16x16x32_bf16 v[12:15], v[148:151], v[8:11], 0
    s_nop 7
    v_add_f32_dpp v77, v13, v12 quad_perm:[1,1,1,1] row_mask:0xf bank_mask:0xf
    s_nop 1
    v_add_f32_dpp v77, v14, v77 quad_perm:[2,2,2,2] row_mask:0xf bank_mask:0xf
    s_nop 1
    v_add_f32_dpp v77, v15, v77 quad_perm:[3,3,3,3] row_mask:0xf bank_mask:0xf
    buffer_load_dwordx4 v[216:219], v64, s[4:7], s32 offen nt
    s_add_u32 s32, s32, 8192
    s_waitcnt vmcnt(16)
    v_mfma_f32_16x16x32_bf16 v[68:71], v[152:155], v[8:11], 0
    s_nop 7
    v_add_f32_dpp v78, v69, v68 quad_perm:[1,1,1,1] row_mask:0xf bank_mask:0xf
    s_nop 1
    v_add_f32_dpp v78, v70, v78 quad_perm:[2,2,2,2] row_mask:0xf bank_mask:0xf
    s_nop 1
    v_add_f32_dpp v78, v71, v78 quad_perm:[3,3,3,3] row_mask:0xf bank_mask:0xf
    buffer_load_dwordx4 v[220:223], v64, s[4:7], s32 offen nt
    s_add_u32 s32, s32, 8192
    s_waitcnt vmcnt(16)
    v_mfma_f32_16x16x32_bf16 v[12:15], v[156:159], v[8:11], 0
    s_nop 7
    v_add_f32_dpp v79, v13, v12 quad_perm:[1,1,1,1] row_mask:0xf bank_mask:0xf
    s_nop 1
    v_add_f32_dpp v79, v14, v79 quad_perm:[2,2,2,2] row_mask:0xf bank_mask:0xf
    s_nop 1
    v_add_f32_dpp v79, v15, v79 quad_perm:[3,3,3,3] row_mask:0xf bank_mask:0xf
    buffer_load_dwordx4 v[224:227], v64, s[4:7], s32 offen nt
    s_add_u32 s32, s32, 8192
    s_waitcnt vmcnt(16)
    v_mfma_f32_16x16x32_bf16 v[68:71], v[160:163], v[8:11], 0
    s_nop 7
    v_add_f32_dpp v3, v68, v69 quad_perm:[0,0,0,0] row_mask:0xf bank_mask:0xf
    s_nop 1
    v_add_f32_dpp v3, v70, v3 quad_perm:[2,2,2,2] row_mask:0xf bank_mask:0xf
    s_nop 1
    v_add_f32_dpp v3, v71, v3 quad_perm:[3,3,3,3] row_mask:0xf bank_mask:0xf
    v_cndmask_b32 v72, v72, v3, s[64:65]
    buffer_load_dwordx4 v[228:231], v64, s[4:7], s32 offen nt
    s_add_u32 s32, s32, 8192
    s_waitcnt vmcnt(16)
    v_mfma_f32_16x16x32_bf16 v[12:15], v[164:167], v[8:11], 0
    s_nop 7
    v_add_f32_dpp v3, v12, v13 quad_perm:[0,0,0,0] row_mask:0xf bank_mask:0xf
    s_nop 1
    v_add_f32_dpp v3, v14, v3 quad_perm:[2,2,2,2] row_mask:0xf bank_mask:0xf
    s_nop 1
    v_add_f32_dpp v3, v15, v3 quad_perm:[3,3,3,3] row_mask:0xf bank_mask:0xf
    v_cndmask_b32 v73, v73, v3, s[64:65]
    buffer_load_dwordx4 v[232:235], v64, s[4:7], s32 offen nt
    s_add_u32 s32, s32, 8192
    s_waitcnt vmcnt(16)
    v_mfma_f32_16x16x32_bf16 v[68:71], v[168:171], v[8:11], 0
    s_nop 7
    v_add_f32_dpp v3, v68, v69 quad_perm:[0,0,0,0] row_mask:0xf bank_mask:0xf
    s_nop 1
    v_add_f32_dpp v3, v70, v3 quad_perm:[2,2,2,2] row_mask:0xf bank_mask:0xf
    s_nop 1
    v_add_f32_dpp v3, v71, v3 quad_perm:[3,3,3,3] row_mask:0xf bank_mask:0xf
    v_cndmask_b32 v74, v74, v3, s[64:65]
    buffer_load_dwordx4 v[236:239], v64, s[4:7], s32 offen nt
    s_add_u32 s32, s32, 8192
    s_waitcnt vmcnt(16)
    v_mfma_f32_16x16x32_bf16 v[12:15], v[172:175], v[8:11], 0
    s_nop 7
    v_add_f32_dpp v3, v12, v13 quad_perm:[0,0,0,0] row_mask:0xf bank_mask:0xf
    s_nop 1
    v_add_f32_dpp v3, v14, v3 quad_perm:[2,2,2,2] row_mask:0xf bank_mask:0xf
    s_nop 1
    v_add_f32_dpp v3, v15, v3 quad_perm:[3,3,3,3] row_mask:0xf bank_mask:0xf
    v_cndmask_b32 v75, v75, v3, s[64:65]
    buffer_load_dwordx4 v[240:243], v64, s[4:7], s32 offen nt
    s_add_u32 s32, s32, 8192
    s_waitcnt vmcnt(16)
    v_mfma_f32_16x16x32_bf16 v[68:71], v[176:179], v[8:11], 0
    s_nop 7
    v_add_f32_dpp v3, v68, v69 quad_perm:[0,0,0,0] row_mask:0xf bank_mask:0xf
    s_nop 1
    v_add_f32_dpp v3, v70, v3 quad_perm:[2,2,2,2] row_mask:0xf bank_mask:0xf
    s_nop 1
    v_add_f32_dpp v3, v71, v3 quad_perm:[3,3,3,3] row_mask:0xf bank_mask:0xf
    v_cndmask_b32 v76, v76, v3, s[64:65]
    buffer_load_dwordx4 v[244:247], v64, s[4:7], s32 offen nt
    s_add_u32 s32, s32, 8192
    s_waitcnt vmcnt(16)
    v_mfma_f32_16x16x32_bf16 v[12:15], v[180:183], v[8:11], 0
    s_nop 7
    v_add_f32_dpp v3, v12, v13 quad_perm:[0,0,0,0] row_mask:0xf bank_mask:0xf
    s_nop 1
    v_add_f32_dpp v3, v14, v3 quad_perm:[2,2,2,2] row_mask:0xf bank_mask:0xf
    s_nop 1
    v_add_f32_dpp v3, v15, v3 quad_perm:[3,3,3,3] row_mask:0xf bank_mask:0xf
    v_cndmask_b32 v77, v77, v3, s[64:65]
    buffer_load_dwordx4 v[248:251], v64, s[4:7], s32 offen nt
    s_add_u32 s32, s32, 8192
    s_waitcnt vmcnt(16)
    v_mfma_f32_16x16x32_bf16 v[68:71], v[184:187], v[8:11], 0
    s_nop 7
    v_add_f32_dpp v3, v68, v69 quad_perm:[0,0,0,0] row_mask:0xf bank_mask:0xf
    s_nop 1
    v_add_f32_dpp v3, v70, v3 quad_perm:[2,2,2,2] row_mask:0xf bank_mask:0xf
    s_nop 1
    v_add_f32_dpp v3, v71, v3 quad_perm:[3,3,3,3] row_mask:0xf bank_mask:0xf
    v_cndmask_b32 v78, v78, v3, s[64:65]
    buffer_load_dwordx4 v[252:255], v64, s[4:7], s32 offen nt
    s_add_u32 s32, s32, 8192
    s_waitcnt vmcnt(16)
    v_mfma_f32_16x16x32_bf16 v[12:15], v[188:191], v[8:11], 0
    s_nop 7
    v_add_f32_dpp v3, v12, v13 quad_perm:[0,0,0,0] row_mask:0xf bank_mask:0xf
    s_nop 1
    v_add_f32_dpp v3, v14, v3 quad_perm:[2,2,2,2] row_mask:0xf bank_mask:0xf
    s_nop 1
    v_add_f32_dpp v3, v15, v3 quad_perm:[3,3,3,3] row_mask:0xf bank_mask:0xf
    v_cndmask_b32 v79, v79, v3, s[64:65]
    s_waitcnt vmcnt(15)
    v_mfma_f32_16x16x32_bf16 v[68:71], v[192:195], v[8:11], 0
    s_nop 7
    v_add_f32_dpp v3, v68, v70 quad_perm:[0,0,0,0] row_mask:0xf bank_mask:0xf
    s_nop 1
    v_add_f32_dpp v3, v69, v3 quad_perm:[1,1,1,1] row_mask:0xf bank_mask:0xf
    s_nop 1
    v_add_f32_dpp v3, v71, v3 quad_perm:[3,3,3,3] row_mask:0xf bank_mask:0xf
    v_cndmask_b32 v72, v72, v3, s[66:67]
    s_waitcnt vmcnt(14)
    v_mfma_f32_16x16x32_bf16 v[12:15], v[196:199], v[8:11], 0
    s_nop 7
    v_add_f32_dpp v3, v12, v14 quad_perm:[0,0,0,0] row_mask:0xf bank_mask:0xf
    s_nop 1
    v_add_f32_dpp v3, v13, v3 quad_perm:[1,1,1,1] row_mask:0xf bank_mask:0xf
    s_nop 1
    v_add_f32_dpp v3, v15, v3 quad_perm:[3,3,3,3] row_mask:0xf bank_mask:0xf
    v_cndmask_b32 v73, v73, v3, s[66:67]
    s_waitcnt vmcnt(13)
    v_mfma_f32_16x16x32_bf16 v[68:71], v[200:203], v[8:11], 0
    s_nop 7
    v_add_f32_dpp v3, v68, v70 quad_perm:[0,0,0,0] row_mask:0xf bank_mask:0xf
    s_nop 1
    v_add_f32_dpp v3, v69, v3 quad_perm:[1,1,1,1] row_mask:0xf bank_mask:0xf
    s_nop 1
    v_add_f32_dpp v3, v71, v3 quad_perm:[3,3,3,3] row_mask:0xf bank_mask:0xf
    v_cndmask_b32 v74, v74, v3, s[66:67]
    s_waitcnt vmcnt(12)
    v_mfma_f32_16x16x32_bf16 v[12:15], v[204:207], v[8:11], 0
    s_nop 7
    v_add_f32_dpp v3, v12, v14 quad_perm:[0,0,0,0] row_mask:0xf bank_mask:0xf
    s_nop 1
    v_add_f32_dpp v3, v13, v3 quad_perm:[1,1,1,1] row_mask:0xf bank_mask:0xf
    s_nop 1
    v_add_f32_dpp v3, v15, v3 quad_perm:[3,3,3,3] row_mask:0xf bank_mask:0xf
    v_cndmask_b32 v75, v75, v3, s[66:67]
    s_waitcnt vmcnt(11)
    v_mfma_f32_16x16x32_bf16 v[68:71], v[208:211], v[8:11], 0
    s_nop 7
    v_add_f32_dpp v3, v68, v70 quad_perm:[0,0,0,0] row_mask:0xf bank_mask:0xf
    s_nop 1
    v_add_f32_dpp v3, v69, v3 quad_perm:[1,1,1,1] row_mask:0xf bank_mask:0xf
    s_nop 1
    v_add_f32_dpp v3, v71, v3 quad_perm:[3,3,3,3] row_mask:0xf bank_mask:0xf
    v_cndmask_b32 v76, v76, v3, s[66:67]
    s_waitcnt vmcnt(10)
    v_mfma_f32_16x16x32_bf16 v[12:15], v[212:215], v[8:11], 0
    s_nop 7
    v_add_f32_dpp v3, v12, v14 quad_perm:[0,0,0,0] row_mask:0xf bank_mask:0xf
    s_nop 1
    v_add_f32_dpp v3, v13, v3 quad_perm:[1,1,1,1] row_mask:0xf bank_mask:0xf
    s_nop 1
    v_add_f32_dpp v3, v15, v3 quad_perm:[3,3,3,3] row_mask:0xf bank_mask:0xf
    v_cndmask_b32 v77, v77, v3, s[66:67]
    s_waitcnt vmcnt(9)
    v_mfma_f32_16x16x32_bf16 v[68:71], v[216:219], v[8:11], 0
    s_nop 7
    v_add_f32_dpp v3, v68, v70 quad_perm:[0,0,0,0] row_mask:0xf bank_mask:0xf
    s_nop 1
    v_add_f32_dpp v3, v69, v3 quad_perm:[1,1,1,1] row_mask:0xf bank_mask:0xf
    s_nop 1
    v_add_f32_dpp v3, v71, v3 quad_perm:[3,3,3,3] row_mask:0xf bank_mask:0xf
    v_cndmask_b32 v78, v78, v3, s[66:67]
    s_waitcnt vmcnt(8)
    v_mfma_f32_16x16x32_bf16 v[12:15], v[220:223], v[8:11], 0
    s_nop 7
    v_add_f32_dpp v3, v12, v14 quad_perm:[0,0,0,0] row_mask:0xf bank_mask:0xf
    s_nop 1
    v_add_f32_dpp v3, v13, v3 quad_perm:[1,1,1,1] row_mask:0xf bank_mask:0xf
    s_nop 1
    v_add_f32_dpp v3, v15, v3 quad_perm:[3,3,3,3] row_mask:0xf bank_mask:0xf
    v_cndmask_b32 v79, v79, v3, s[66:67]
    s_waitcnt vmcnt(7)
    v_mfma_f32_16x16x32_bf16 v[68:71], v[224:227], v[8:11], 0
    s_nop 7
    v_add_f32_dpp v3, v68, v71 quad_perm:[0,0,0,0] row_mask:0xf bank_mask:0xf
    s_nop 1
    v_add_f32_dpp v3, v69, v3 quad_perm:[1,1,1,1] row_mask:0xf bank_mask:0xf
    s_nop 1
    v_add_f32_dpp v3, v70, v3 quad_perm:[2,2,2,2] row_mask:0xf bank_mask:0xf
    v_cndmask_b32 v72, v72, v3, s[68:69]
    s_waitcnt vmcnt(6)
    v_mfma_f32_16x16x32_bf16 v[12:15], v[228:231], v[8:11], 0
    s_nop 7
    v_add_f32_dpp v3, v12, v15 quad_perm:[0,0,0,0] row_mask:0xf bank_mask:0xf
    s_nop 1
    v_add_f32_dpp v3, v13, v3 quad_perm:[1,1,1,1] row_mask:0xf bank_mask:0xf
    s_nop 1
    v_add_f32_dpp v3, v14, v3 quad_perm:[2,2,2,2] row_mask:0xf bank_mask:0xf
    v_cndmask_b32 v73, v73, v3, s[68:69]
    s_waitcnt vmcnt(5)
    v_mfma_f32_16x16x32_bf16 v[68:71], v[232:235], v[8:11], 0
    s_nop 7
    v_add_f32_dpp v3, v68, v71 quad_perm:[0,0,0,0] row_mask:0xf bank_mask:0xf
    s_nop 1
    v_add_f32_dpp v3, v69, v3 quad_perm:[1,1,1,1] row_mask:0xf bank_mask:0xf
    s_nop 1
    v_add_f32_dpp v3, v70, v3 quad_perm:[2,2,2,2] row_mask:0xf bank_mask:0xf
    v_cndmask_b32 v74, v74, v3, s[68:69]
    s_waitcnt vmcnt(4)
    v_mfma_f32_16x16x32_bf16 v[12:15], v[236:239], v[8:11], 0
    s_nop 7
    v_add_f32_dpp v3, v12, v15 quad_perm:[0,0,0,0] row_mask:0xf bank_mask:0xf
    s_nop 1
    v_add_f32_dpp v3, v13, v3 quad_perm:[1,1,1,1] row_mask:0xf bank_mask:0xf
    s_nop 1
    v_add_f32_dpp v3, v14, v3 quad_perm:[2,2,2,2] row_mask:0xf bank_mask:0xf
    v_cndmask_b32 v75, v75, v3, s[68:69]
    s_waitcnt vmcnt(3)
    v_mfma_f32_16x16x32_bf16 v[68:71], v[240:243], v[8:11], 0
    s_nop 7
    v_add_f32_dpp v3, v68, v71 quad_perm:[0,0,0,0] row_mask:0xf bank_mask:0xf
    s_nop 1
    v_add_f32_dpp v3, v69, v3 quad_perm:[1,1,1,1] row_mask:0xf bank_mask:0xf
    s_nop 1
    v_add_f32_dpp v3, v70, v3 quad_perm:[2,2,2,2] row_mask:0xf bank_mask:0xf
    v_cndmask_b32 v76, v76, v3, s[68:69]
    s_waitcnt vmcnt(2)
    v_mfma_f32_16x16x32_bf16 v[12:15], v[244:247], v[8:11], 0
    s_nop 7
    v_add_f32_dpp v3, v12, v15 quad_perm:[0,0,0,0] row_mask:0xf bank_mask:0xf
    s_nop 1
    v_add_f32_dpp v3, v13, v3 quad_perm:[1,1,1,1] row_mask:0xf bank_mask:0xf
    s_nop 1
    v_add_f32_dpp v3, v14, v3 quad_perm:[2,2,2,2] row_mask:0xf bank_mask:0xf
    v_cndmask_b32 v77, v77, v3, s[68:69]
    s_waitcnt vmcnt(1)
    v_mfma_f32_16x16x32_bf16 v[68:71], v[248:251], v[8:11], 0
    s_nop 7
    v_add_f32_dpp v3, v68, v71 quad_perm:[0,0,0,0] row_mask:0xf bank_mask:0xf
    s_nop 1
    v_add_f32_dpp v3, v69, v3 quad_perm:[1,1,1,1] row_mask:0xf bank_mask:0xf
    s_nop 1
    v_add_f32_dpp v3, v70, v3 quad_perm:[2,2,2,2] row_mask:0xf bank_mask:0xf
    v_cndmask_b32 v78, v78, v3, s[68:69]
    s_waitcnt vmcnt(0)
    v_mfma_f32_16x16x32_bf16 v[12:15], v[252:255], v[8:11], 0
    s_nop 7
    v_add_f32_dpp v3, v12, v15 quad_perm:[0,0,0,0] row_mask:0xf bank_mask:0xf
    s_nop 1
    v_add_f32_dpp v3, v13, v3 quad_perm:[1,1,1,1] row_mask:0xf bank_mask:0xf
    s_nop 1
    v_add_f32_dpp v3, v14, v3 quad_perm:[2,2,2,2] row_mask:0xf bank_mask:0xf
    v_cndmask_b32 v79, v79, v3, s[68:69]
    s_mov_b32 s71, 0x3e0293ee
    v_mul_f32 v72, s71, v72
    v_mul_f32 v73, s71, v73
    v_mul_f32 v74, s71, v74
    v_mul_f32 v75, s71, v75
    v_mul_f32 v76, s71, v76
    v_mul_f32 v77, s71, v77
    v_mul_f32 v78, s71, v78
    v_mul_f32 v79, s71, v79
    v_cvt_pk_bf16_f32 v4, v72, v73
    v_cvt_pk_bf16_f32 v5, v74, v75
    v_cvt_pk_bf16_f32 v6, v76, v77
    v_cvt_pk_bf16_f32 v7, v78, v79
    s_lshl_b32 s24, s26, 10
    s_lshl_b32 s25, s3, 8
    s_add_u32 s24, s24, s25
    s_add_u32 s24, s24, 0x0
    buffer_store_dwordx4 v[4:7], v66, s[12:15], s24 offen sc1
    s_waitcnt vmcnt(0)
    s_barrier
    s_cmp_lg_u32 s3, 0
    s_cbranch_scc1 L_sig5
    s_mov_b64 exec, 1
    v_mov_b32 v3, 1
    buffer_atomic_add v3, off, s[16:19], 0 offset:0 sc0
    s_waitcnt vmcnt(0)
    v_readfirstlane_b32 s24, v3
    s_mov_b64 exec, -1
    s_cmp_lg_u32 s24, 63
    s_cbranch_scc1 L_sig5
    v_lshlrev_b32 v4, 7, v0
    v_mov_b32 v3, 1
    s_mov_b32 s24, 0x170000
    buffer_store_dword v3, v4, s[12:15], s24 offen offset:0 sc1
L_sig5:
    s_mov_b32 s4, s44
    s_mov_b32 s5, s45
    s_mov_b32 s6, 0x400000
    s_mov_b32 s7, 0x20000
    s_mov_b32 s8, s46
    s_mov_b32 s9, s47
    s_mov_b32 s10, 0x400000
    s_mov_b32 s11, 0x20000
    s_lshl_b32 s33, s26, 17
    s_lshl_b32 s24, s3, 15
    s_add_u32 s33, s33, s24
    s_mul_i32 s34, s3, 33792
    s_mov_b32 s70, 0
L_woA:
    s_and_b32 s24, s70, 3
    s_lshl_b32 s24, s24, 1
    s_lshr_b32 s25, s70, 2
    s_or_b32 s24, s24, s25
    s_lshl_b32 s24, s24, 10
    s_add_u32 s24, s24, s33
    s_mul_i32 s25, s70, 4224
    s_add_u32 m0, s25, s34
    s_waitcnt vmcnt(24)
    buffer_load_dwordx4 v2, s[8:11], s24 offen nt lds
    s_add_u32 m0, m0, 1056
    s_add_u32 s24, s24, 8192
    s_waitcnt vmcnt(24)
    buffer_load_dwordx4 v2, s[8:11], s24 offen nt lds
    s_add_u32 m0, m0, 1056
    s_add_u32 s24, s24, 8192
    s_waitcnt vmcnt(24)
    buffer_load_dwordx4 v2, s[8:11], s24 offen nt lds
    s_add_u32 m0, m0, 1056
    s_add_u32 s24, s24, 8192
    s_waitcnt vmcnt(24)
    buffer_load_dwordx4 v2, s[8:11], s24 offen nt lds
    s_add_u32 s70, s70, 1
    s_cmp_lt_u32 s70, 8
    s_cbranch_scc1 L_woA
    s_mov_b32 s32, s35
    buffer_load_dwordx4 v[128:131], v18, s[4:7], s32 offen nt
    s_add_u32 s32, s32, 8192
    buffer_load_dwordx4 v[132:135], v18, s[4:7], s32 offen nt
    s_add_u32 s32, s32, 8192
    buffer_load_dwordx4 v[136:139], v18, s[4:7], s32 offen nt
    s_add_u32 s32, s32, 8192
    buffer_load_dwordx4 v[140:143], v18, s[4:7], s32 offen nt
    s_add_u32 s32, s32, 8192
    buffer_load_dwordx4 v[144:147], v18, s[4:7], s32 offen nt
    s_add_u32 s32, s32, 8192
    buffer_load_dwordx4 v[148:151], v18, s[4:7], s32 offen nt
    s_add_u32 s32, s32, 8192
    buffer_load_dwordx4 v[152:155], v18, s[4:7], s32 offen nt
    s_add_u32 s32, s32, 8192
    buffer_load_dwordx4 v[156:159], v18, s[4:7], s32 offen nt
    s_add_u32 s32, s32, 8192
    buffer_load_dwordx4 v[160:163], v18, s[4:7], s32 offen nt
    s_add_u32 s32, s32, 8192
    buffer_load_dwordx4 v[164:167], v18, s[4:7], s32 offen nt
    s_add_u32 s32, s32, 8192
    buffer_load_dwordx4 v[168:171], v18, s[4:7], s32 offen nt
    s_add_u32 s32, s32, 8192
    buffer_load_dwordx4 v[172:175], v18, s[4:7], s32 offen nt
    s_add_u32 s32, s32, 8192
    buffer_load_dwordx4 v[176:179], v18, s[4:7], s32 offen nt
    s_add_u32 s32, s32, 8192
    buffer_load_dwordx4 v[180:183], v18, s[4:7], s32 offen nt
    s_add_u32 s32, s32, 8192
    buffer_load_dwordx4 v[184:187], v18, s[4:7], s32 offen nt
    s_add_u32 s32, s32, 8192
    buffer_load_dwordx4 v[188:191], v18, s[4:7], s32 offen nt
    s_add_u32 s32, s32, 8192
    buffer_load_dwordx4 v[192:195], v18, s[4:7], s32 offen nt
    s_add_u32 s32, s32, 8192
    buffer_load_dwordx4 v[196:199], v18, s[4:7], s32 offen nt
    s_add_u32 s32, s32, 8192
    buffer_load_dwordx4 v[200:203], v18, s[4:7], s32 offen nt
    s_add_u32 s32, s32, 8192
    buffer_load_dwordx4 v[204:207], v18, s[4:7], s32 offen nt
    s_add_u32 s32, s32, 8192
    buffer_load_dwordx4 v[208:211], v18, s[4:7], s32 offen nt
    s_add_u32 s32, s32, 8192
    buffer_load_dwordx4 v[212:215], v18, s[4:7], s32 offen nt
    s_add_u32 s32, s32, 8192
    buffer_load_dwordx4 v[216:219], v18, s[4:7], s32 offen nt
    s_add_u32 s32, s32, 8192
    buffer_load_dwordx4 v[220:223], v18, s[4:7], s32 offen nt
    s_add_u32 s32, s32, 8192
    buffer_load_dwordx4 v[224:227], v18, s[4:7], s32 offen nt
    s_add_u32 s32, s32, 8192
    buffer_load_dwordx4 v[228:231], v18, s[4:7], s32 offen nt
    s_add_u32 s32, s32, 8192
    buffer_load_dwordx4 v[232:235], v18, s[4:7], s32 offen nt
    s_add_u32 s32, s32, 8192
    buffer_load_dwordx4 v[236:239], v18, s[4:7], s32 offen nt
    s_add_u32 s32, s32, 8192
    buffer_load_dwordx4 v[240:243], v18, s[4:7], s32 offen nt
    s_add_u32 s32, s32, 8192
    buffer_load_dwordx4 v[244:247], v18, s[4:7], s32 offen nt
    s_add_u32 s32, s32, 8192
    buffer_load_dwordx4 v[248:251], v18, s[4:7], s32 offen nt
    s_add_u32 s32, s32, 8192
    buffer_load_dwordx4 v[252:255], v18, s[4:7], s32 offen nt
    s_add_u32 s32, s32, 8192
    s_waitcnt vmcnt(32)
    s_barrier
    v_lshrrev_b32 v3, 2, v0
    v_mul_u32_u24 v3, 1056, v3
    v_and_b32 v4, 3, v0
    v_lshl_add_u32 v3, v4, 3, v3
    s_mul_i32 s24, s3, 256
    s_add_u32 s24, s24, 0
    v_add_u32 v3, s24, v3
    v_add_u32 v4, 67584, v3
    ds_read_b64_tr_b16 a[0:1], v3 offset:0
    ds_read_b64_tr_b16 a[2:3], v3 offset:16896
    ds_read_b64_tr_b16 a[4:5], v3 offset:33792
    ds_read_b64_tr_b16 a[6:7], v3 offset:50688
    ds_read_b64_tr_b16 a[8:9], v4 offset:0
    ds_read_b64_tr_b16 a[10:11], v4 offset:16896
    ds_read_b64_tr_b16 a[12:13], v4 offset:33792
    ds_read_b64_tr_b16 a[14:15], v4 offset:50688
    ds_read_b64_tr_b16 a[16:17], v3 offset:32
    ds_read_b64_tr_b16 a[18:19], v3 offset:16928
    ds_read_b64_tr_b16 a[20:21], v3 offset:33824
    ds_read_b64_tr_b16 a[22:23], v3 offset:50720
    ds_read_b64_tr_b16 a[24:25], v4 offset:32
    ds_read_b64_tr_b16 a[26:27], v4 offset:16928
    ds_read_b64_tr_b16 a[28:29], v4 offset:33824
    ds_read_b64_tr_b16 a[30:31], v4 offset:50720
    ds_read_b64_tr_b16 a[32:33], v3 offset:64
    ds_read_b64_tr_b16 a[34:35], v3 offset:16960
    ds_read_b64_tr_b16 a[36:37], v3 offset:33856
    ds_read_b64_tr_b16 a[38:39], v3 offset:50752
    ds_read_b64_tr_b16 a[40:41], v4 offset:64
    ds_read_b64_tr_b16 a[42:43], v4 offset:16960
    ds_read_b64_tr_b16 a[44:45], v4 offset:33856
    ds_read_b64_tr_b16 a[46:47], v4 offset:50752
    ds_read_b64_tr_b16 a[48:49], v3 offset:96
    ds_read_b64_tr_b16 a[50:51], v3 offset:16992
    ds_read_b64_tr_b16 a[52:53], v3 offset:33888
    ds_read_b64_tr_b16 a[54:55], v3 offset:50784
    ds_read_b64_tr_b16 a[56:57], v4 offset:96
    ds_read_b64_tr_b16 a[58:59], v4 offset:16992
    ds_read_b64_tr_b16 a[60:61], v4 offset:33888
    ds_read_b64_tr_b16 a[62:63], v4 offset:50784
    ds_read_b64_tr_b16 a[64:65], v3 offset:128
    ds_read_b64_tr_b16 a[66:67], v3 offset:17024
    ds_read_b64_tr_b16 a[68:69], v3 offset:33920
    ds_read_b64_tr_b16 a[70:71], v3 offset:50816
    ds_read_b64_tr_b16 a[72:73], v4 offset:128
    ds_read_b64_tr_b16 a[74:75], v4 offset:17024
    ds_read_b64_tr_b16 a[76:77], v4 offset:33920
    ds_read_b64_tr_b16 a[78:79], v4 offset:50816
    ds_read_b64_tr_b16 a[80:81], v3 offset:160
    ds_read_b64_tr_b16 a[82:83], v3 offset:17056
    ds_read_b64_tr_b16 a[84:85], v3 offset:33952
    ds_read_b64_tr_b16 a[86:87], v3 offset:50848
    ds_read_b64_tr_b16 a[88:89], v4 offset:160
    ds_read_b64_tr_b16 a[90:91], v4 offset:17056
    ds_read_b64_tr_b16 a[92:93], v4 offset:33952
    ds_read_b64_tr_b16 a[94:95], v4 offset:50848
    ds_read_b64_tr_b16 a[96:97], v3 offset:192
    ds_read_b64_tr_b16 a[98:99], v3 offset:17088
    ds_read_b64_tr_b16 a[100:101], v3 offset:33984
    ds_read_b64_tr_b16 a[102:103], v3 offset:50880
    ds_read_b64_tr_b16 a[104:105], v4 offset:192
    ds_read_b64_tr_b16 a[106:107], v4 offset:17088
    ds_read_b64_tr_b16 a[108:109], v4 offset:33984
    ds_read_b64_tr_b16 a[110:111], v4 offset:50880
    ds_read_b64_tr_b16 a[112:113], v3 offset:224
    ds_read_b64_tr_b16 a[114:115], v3 offset:17120
    ds_read_b64_tr_b16 a[116:117], v3 offset:34016
    ds_read_b64_tr_b16 a[118:119], v3 offset:50912
    ds_read_b64_tr_b16 a[120:121], v4 offset:224
    ds_read_b64_tr_b16 a[122:123], v4 offset:17120
    ds_read_b64_tr_b16 a[124:125], v4 offset:34016
    ds_read_b64_tr_b16 a[126:127], v4 offset:50912
    s_waitcnt lgkmcnt(0)
    s_barrier
    s_mov_b32 s8, s56
    s_mov_b32 s9, s57
    s_mov_b32 s10, 0x400000
    s_mov_b32 s11, 0x20000
    s_lshl_b32 s33, s26, 17
    s_lshl_b32 s24, s3, 15
    s_add_u32 s33, s33, s24
    s_add_u32 s33, s33, 0
    s_mul_i32 s34, s3, 17408
    s_add_u32 s34, s34, 0
    s_mov_b32 exec_hi, 0
    s_mov_b32 s70, 0
L_woW:
    s_and_b32 s24, s70, 1
    s_lshl_b32 s24, s24, 4
    s_and_b32 s25, s70, 4
    s_lshl_b32 s25, s25, 1
    s_or_b32 s24, s24, s25
    s_bfe_u32 s25, s70, 0x10001
    s_or_b32 s24, s24, s25
    s_lshl_b32 s24, s24, 10
    s_add_u32 s24, s24, s33
    s_mul_i32 s25, s70, 2176
    s_add_u32 m0, s25, s34
    s_waitcnt vmcnt(24)
    buffer_load_dwordx4 v2, s[8:11], s24 offen nt lds
    s_add_u32 m0, m0, 544
    s_add_u32 s24, s24, 2048
    s_waitcnt vmcnt(24)
    buffer_load_dwordx4 v2, s[8:11], s24 offen nt lds
    s_add_u32 m0, m0, 544
    s_add_u32 s24, s24, 2048
    s_waitcnt vmcnt(24)
    buffer_load_dwordx4 v2, s[8:11], s24 offen nt lds
    s_add_u32 m0, m0, 544
    s_add_u32 s24, s24, 2048
    s_waitcnt vmcnt(24)
    buffer_load_dwordx4 v2, s[8:11], s24 offen nt lds
    s_add_u32 s70, s70, 1
    s_cmp_lt_u32 s70, 8
    s_cbranch_scc1 L_woW
    s_mov_b64 exec, -1
    s_waitcnt vmcnt(0)
    s_barrier
    v_lshrrev_b32 v3, 2, v0
    v_mul_u32_u24 v3, 544, v3
    v_and_b32 v4, 3, v0
    v_lshl_add_u32 v3, v4, 3, v3
    s_mul_i32 s24, s3, 128
    s_add_u32 s24, s24, 0
    v_add_u32 v3, s24, v3
    v_add_u32 v4, 34816, v3
    ds_read_b64_tr_b16 a[128:129], v3 offset:0
    ds_read_b64_tr_b16 a[130:131], v3 offset:8704
    ds_read_b64_tr_b16 a[132:133], v3 offset:17408
    ds_read_b64_tr_b16 a[134:135], v3 offset:26112
    ds_read_b64_tr_b16 a[136:137], v4 offset:0
    ds_read_b64_tr_b16 a[138:139], v4 offset:8704
    ds_read_b64_tr_b16 a[140:141], v4 offset:17408
    ds_read_b64_tr_b16 a[142:143], v4 offset:26112
    ds_read_b64_tr_b16 a[144:145], v3 offset:32
    ds_read_b64_tr_b16 a[146:147], v3 offset:8736
    ds_read_b64_tr_b16 a[148:149], v3 offset:17440
    ds_read_b64_tr_b16 a[150:151], v3 offset:26144
    ds_read_b64_tr_b16 a[152:153], v4 offset:32
    ds_read_b64_tr_b16 a[154:155], v4 offset:8736
    ds_read_b64_tr_b16 a[156:157], v4 offset:17440
    ds_read_b64_tr_b16 a[158:159], v4 offset:26144
    ds_read_b64_tr_b16 a[160:161], v3 offset:64
    ds_read_b64_tr_b16 a[162:163], v3 offset:8768
    ds_read_b64_tr_b16 a[164:165], v3 offset:17472
    ds_read_b64_tr_b16 a[166:167], v3 offset:26176
    ds_read_b64_tr_b16 a[168:169], v4 offset:64
    ds_read_b64_tr_b16 a[170:171], v4 offset:8768
    ds_read_b64_tr_b16 a[172:173], v4 offset:17472
    ds_read_b64_tr_b16 a[174:175], v4 offset:26176
    ds_read_b64_tr_b16 a[176:177], v3 offset:96
    ds_read_b64_tr_b16 a[178:179], v3 offset:8800
    ds_read_b64_tr_b16 a[180:181], v3 offset:17504
    ds_read_b64_tr_b16 a[182:183], v3 offset:26208
    ds_read_b64_tr_b16 a[184:185], v4 offset:96
    ds_read_b64_tr_b16 a[186:187], v4 offset:8800
    ds_read_b64_tr_b16 a[188:189], v4 offset:17504
    ds_read_b64_tr_b16 a[190:191], v4 offset:26208
    s_waitcnt lgkmcnt(0)
    s_cmp_lg_u32 s3, 0
    s_cbranch_scc1 L_awx6
    s_mov_b32 s24, 262144
    s_mov_b64 exec, 1
L_aw7:
    buffer_load_dword v1, off, s[12:15], s73 offset:0 sc1
    s_waitcnt vmcnt(0)
    v_readfirstlane_b32 s25, v1
    s_nop 0
    s_cmp_eq_u32 s25, 1
    s_cbranch_scc1 L_awx6
    s_sleep 4
    s_sub_u32 s24, s24, 1
    s_cmp_lg_u32 s24, 0
    s_cbranch_scc1 L_aw7
L_awx6:
    s_mov_b64 exec, -1
    s_barrier
    s_cmp_lg_u32 s3, 0
    s_cbranch_scc1 L_xi8
    s_getreg_b32 s25, hwreg(HW_REG_XCC_ID, 0, 4)
    s_lshl_b32 s24, s26, 7
    s_add_u32 s24, s24, 0x1b4000
    s_mov_b64 exec, 1
    v_mov_b32 v3, s25
    buffer_store_dword v3, off, s[12:15], s24 offset:0 sc1
    s_mov_b64 exec, -1
L_xi8:
    s_cmp_lg_u32 s3, 0
    s_cbranch_scc1 L_awx9
    s_mov_b32 s24, 262144
    s_mov_b64 exec, 1
L_aw10:
    buffer_load_dword v1, off, s[12:15], s73 offset:4 sc1
    s_waitcnt vmcnt(0)
    v_readfirstlane_b32 s25, v1
    s_nop 0
    s_cmp_eq_u32 s25, 1
    s_cbranch_scc1 L_awx9
    s_sleep 4
    s_sub_u32 s24, s24, 1
    s_cmp_lg_u32 s24, 0
    s_cbranch_scc1 L_aw10
L_awx9:
    s_mov_b64 exec, -1
    s_barrier
    s_lshl_b32 s24, s26, 2
    s_add_u32 s24, s24, s3
    s_lshl_b32 s25, s24, 6
    s_add_u32 s25, s25, 0x120000
    v_and_b32 v3, 7, v0
    v_lshlrev_b32 v3, 3, v3
    buffer_load_dwordx2 v[4:5], v3, s[12:15], s25 offen sc1
    s_lshl_b32 s24, s24, 13
    s_add_u32 s24, s24, 0x20000
    buffer_load_dwordx4 v[72:75], v2, s[12:15], s24 offen offset:0 sc1
    buffer_load_dwordx4 v[76:79], v2, s[12:15], s24 offen offset:1024 sc1
    buffer_load_dwordx4 v[80:83], v2, s[12:15], s24 offen offset:2048 sc1
    buffer_load_dwordx4 v[84:87], v2, s[12:15], s24 offen offset:3072 sc1
    s_add_u32 s24, s24, 4096
    buffer_load_dwordx4 v[88:91], v2, s[12:15], s24 offen offset:0 sc1
    buffer_load_dwordx4 v[92:95], v2, s[12:15], s24 offen offset:1024 sc1
    buffer_load_dwordx4 v[96:99], v2, s[12:15], s24 offen offset:2048 sc1
    buffer_load_dwordx4 v[100:103], v2, s[12:15], s24 offen offset:3072 sc1
    s_waitcnt vmcnt(8)
    v_mov_b32 v6, v4
    s_nop 1
    v_max_f32_dpp v6, v6, v6 row_ror:4 row_mask:0xf bank_mask:0xf
    s_nop 1
    v_max_f32_dpp v6, v6, v6 row_ror:2 row_mask:0xf bank_mask:0xf
    s_nop 1
    v_max_f32_dpp v6, v6, v6 row_ror:1 row_mask:0xf bank_mask:0xf
    v_sub_f32 v4, v4, v6
    v_exp_f32 v4, v4
    s_nop 0
    v_mul_f32 v5, v4, v5
    s_nop 1
    v_add_f32_dpp v5, v5, v5 row_ror:4 row_mask:0xf bank_mask:0xf
    s_nop 1
    v_add_f32_dpp v5, v5, v5 row_ror:2 row_mask:0xf bank_mask:0xf
    s_nop 1
    v_add_f32_dpp v5, v5, v5 row_ror:1 row_mask:0xf bank_mask:0xf
    v_rcp_f32 v5, v5
    s_nop 0
    v_mul_f32 v4, v4, v5
    s_nop 0
    v_readlane_b32 s24, v4, 0
    s_waitcnt vmcnt(7)
    v_lshlrev_b32 v5, 16, v72
    v_and_b32 v6, 0xffff0000, v72
    v_mul_f32 v104, s24, v5
    v_mul_f32 v105, s24, v6
    v_lshlrev_b32 v5, 16, v73
    v_and_b32 v6, 0xffff0000, v73
    v_mul_f32 v106, s24, v5
    v_mul_f32 v107, s24, v6
    v_lshlrev_b32 v5, 16, v74
    v_and_b32 v6, 0xffff0000, v74
    v_mul_f32 v108, s24, v5
    v_mul_f32 v109, s24, v6
    v_lshlrev_b32 v5, 16, v75
    v_and_b32 v6, 0xffff0000, v75
    v_mul_f32 v110, s24, v5
    v_mul_f32 v111, s24, v6
    v_readlane_b32 s24, v4, 1
    s_waitcnt vmcnt(6)
    v_lshlrev_b32 v5, 16, v76
    v_and_b32 v6, 0xffff0000, v76
    v_fmac_f32 v104, s24, v5
    v_fmac_f32 v105, s24, v6
    v_lshlrev_b32 v5, 16, v77
    v_and_b32 v6, 0xffff0000, v77
    v_fmac_f32 v106, s24, v5
    v_fmac_f32 v107, s24, v6
    v_lshlrev_b32 v5, 16, v78
    v_and_b32 v6, 0xffff0000, v78
    v_fmac_f32 v108, s24, v5
    v_fmac_f32 v109, s24, v6
    v_lshlrev_b32 v5, 16, v79
    v_and_b32 v6, 0xffff0000, v79
    v_fmac_f32 v110, s24, v5
    v_fmac_f32 v111, s24, v6
    v_readlane_b32 s24, v4, 2
    s_waitcnt vmcnt(5)
    v_lshlrev_b32 v5, 16, v80
    v_and_b32 v6, 0xffff0000, v80
    v_fmac_f32 v104, s24, v5
    v_fmac_f32 v105, s24, v6
    v_lshlrev_b32 v5, 16, v81
    v_and_b32 v6, 0xffff0000, v81
    v_fmac_f32 v106, s24, v5
    v_fmac_f32 v107, s24, v6
    v_lshlrev_b32 v5, 16, v82
    v_and_b32 v6, 0xffff0000, v82
    v_fmac_f32 v108, s24, v5
    v_fmac_f32 v109, s24, v6
    v_lshlrev_b32 v5, 16, v83
    v_and_b32 v6, 0xffff0000, v83
    v_fmac_f32 v110, s24, v5
    v_fmac_f32 v111, s24, v6
    v_readlane_b32 s24, v4, 3
    s_waitcnt vmcnt(4)
    v_lshlrev_b32 v5, 16, v84
    v_and_b32 v6, 0xffff0000, v84
    v_fmac_f32 v104, s24, v5
    v_fmac_f32 v105, s24, v6
    v_lshlrev_b32 v5, 16, v85
    v_and_b32 v6, 0xffff0000, v85
    v_fmac_f32 v106, s24, v5
    v_fmac_f32 v107, s24, v6
    v_lshlrev_b32 v5, 16, v86
    v_and_b32 v6, 0xffff0000, v86
    v_fmac_f32 v108, s24, v5
    v_fmac_f32 v109, s24, v6
    v_lshlrev_b32 v5, 16, v87
    v_and_b32 v6, 0xffff0000, v87
    v_fmac_f32 v110, s24, v5
    v_fmac_f32 v111, s24, v6
    v_readlane_b32 s24, v4, 4
    s_waitcnt vmcnt(3)
    v_lshlrev_b32 v5, 16, v88
    v_and_b32 v6, 0xffff0000, v88
    v_fmac_f32 v104, s24, v5
    v_fmac_f32 v105, s24, v6
    v_lshlrev_b32 v5, 16, v89
    v_and_b32 v6, 0xffff0000, v89
    v_fmac_f32 v106, s24, v5
    v_fmac_f32 v107, s24, v6
    v_lshlrev_b32 v5, 16, v90
    v_and_b32 v6, 0xffff0000, v90
    v_fmac_f32 v108, s24, v5
    v_fmac_f32 v109, s24, v6
    v_lshlrev_b32 v5, 16, v91
    v_and_b32 v6, 0xffff0000, v91
    v_fmac_f32 v110, s24, v5
    v_fmac_f32 v111, s24, v6
    v_readlane_b32 s24, v4, 5
    s_waitcnt vmcnt(2)
    v_lshlrev_b32 v5, 16, v92
    v_and_b32 v6, 0xffff0000, v92
    v_fmac_f32 v104, s24, v5
    v_fmac_f32 v105, s24, v6
    v_lshlrev_b32 v5, 16, v93
    v_and_b32 v6, 0xffff0000, v93
    v_fmac_f32 v106, s24, v5
    v_fmac_f32 v107, s24, v6
    v_lshlrev_b32 v5, 16, v94
    v_and_b32 v6, 0xffff0000, v94
    v_fmac_f32 v108, s24, v5
    v_fmac_f32 v109, s24, v6
    v_lshlrev_b32 v5, 16, v95
    v_and_b32 v6, 0xffff0000, v95
    v_fmac_f32 v110, s24, v5
    v_fmac_f32 v111, s24, v6
    v_readlane_b32 s24, v4, 6
    s_waitcnt vmcnt(1)
    v_lshlrev_b32 v5, 16, v96
    v_and_b32 v6, 0xffff0000, v96
    v_fmac_f32 v104, s24, v5
    v_fmac_f32 v105, s24, v6
    v_lshlrev_b32 v5, 16, v97
    v_and_b32 v6, 0xffff0000, v97
    v_fmac_f32 v106, s24, v5
    v_fmac_f32 v107, s24, v6
    v_lshlrev_b32 v5, 16, v98
    v_and_b32 v6, 0xffff0000, v98
    v_fmac_f32 v108, s24, v5
    v_fmac_f32 v109, s24, v6
    v_lshlrev_b32 v5, 16, v99
    v_and_b32 v6, 0xffff0000, v99
    v_fmac_f32 v110, s24, v5
    v_fmac_f32 v111, s24, v6
    v_readlane_b32 s24, v4, 7
    s_waitcnt vmcnt(0)
    v_lshlrev_b32 v5, 16, v100
    v_and_b32 v6, 0xffff0000, v100
    v_fmac_f32 v104, s24, v5
    v_fmac_f32 v105, s24, v6
    v_lshlrev_b32 v5, 16, v101
    v_and_b32 v6, 0xffff0000, v101
    v_fmac_f32 v106, s24, v5
    v_fmac_f32 v107, s24, v6
    v_lshlrev_b32 v5, 16, v102
    v_and_b32 v6, 0xffff0000, v102
    v_fmac_f32 v108, s24, v5
    v_fmac_f32 v109, s24, v6
    v_lshlrev_b32 v5, 16, v103
    v_and_b32 v6, 0xffff0000, v103
    v_fmac_f32 v110, s24, v5
    v_fmac_f32 v111, s24, v6
    v_cvt_pk_bf16_f32 v4, v104, v105
    v_cvt_pk_bf16_f32 v5, v106, v107
    v_cvt_pk_bf16_f32 v6, v108, v109
    v_cvt_pk_bf16_f32 v7, v110, v111
    s_lshl_b32 s24, s3, 10
    s_add_u32 s24, s24, 145408
    v_add_u32 v3, s24, v2
    ds_write_b128 v3, v[4:7]
    s_lshl_b32 s24, s3, 8
    s_add_u32 s24, s24, 145408
    v_add_u32 v3, s24, v19
    s_waitcnt lgkmcnt(0)
    s_barrier
    ds_read_b128 v[32:35], v3 offset:0
    ds_read_b128 v[36:39], v3 offset:16
    ds_read_b128 v[40:43], v3 offset:32
    ds_read_b128 v[44:47], v3 offset:48
    ds_read_b128 v[48:51], v3 offset:2048
    ds_read_b128 v[52:55], v3 offset:2064
    ds_read_b128 v[56:59], v3 offset:2080
    ds_read_b128 v[60:63], v3 offset:2096
    s_waitcnt lgkmcnt(0)
    v_perm_b32 v8, v32, v32, v24
    v_perm_b32 v9, v32, v32, v25
    v_perm_b32 v10, v32, v32, v26
    v_perm_b32 v11, v32, v32, v27
    s_nop 1
    v_mfma_f32_16x16x32_bf16 v[12:15], v[128:131], v[8:11], 0
    v_perm_b32 v4, v48, v48, v24
    v_perm_b32 v5, v48, v48, v25
    v_perm_b32 v6, v48, v48, v26
    v_perm_b32 v7, v48, v48, v27
    s_nop 1
    v_mfma_f32_16x16x32_bf16 v[68:71], v[128:131], v[4:7], 0
    v_perm_b32 v8, v32, v32, v28
    v_perm_b32 v9, v32, v32, v29
    v_perm_b32 v10, v32, v32, v30
    v_perm_b32 v11, v32, v32, v31
    s_nop 1
    v_mfma_f32_16x16x32_bf16 v[12:15], v[132:135], v[8:11], v[12:15]
    v_perm_b32 v4, v48, v48, v28
    v_perm_b32 v5, v48, v48, v29
    v_perm_b32 v6, v48, v48, v30
    v_perm_b32 v7, v48, v48, v31
    s_nop 1
    v_mfma_f32_16x16x32_bf16 v[68:71], v[132:135], v[4:7], v[68:71]
    v_perm_b32 v8, v33, v33, v24
    v_perm_b32 v9, v33, v33, v25
    v_perm_b32 v10, v33, v33, v26
    v_perm_b32 v11, v33, v33, v27
    s_nop 1
    v_mfma_f32_16x16x32_bf16 v[12:15], v[136:139], v[8:11], v[12:15]
    v_perm_b32 v4, v49, v49, v24
    v_perm_b32 v5, v49, v49, v25
    v_perm_b32 v6, v49, v49, v26
    v_perm_b32 v7, v49, v49, v27
    s_nop 1
    v_mfma_f32_16x16x32_bf16 v[68:71], v[136:139], v[4:7], v[68:71]
    v_perm_b32 v8, v33, v33, v28
    v_perm_b32 v9, v33, v33, v29
    v_perm_b32 v10, v33, v33, v30
    v_perm_b32 v11, v33, v33, v31
    s_nop 1
    v_mfma_f32_16x16x32_bf16 v[12:15], v[140:143], v[8:11], v[12:15]
    v_perm_b32 v4, v49, v49, v28
    v_perm_b32 v5, v49, v49, v29
    v_perm_b32 v6, v49, v49, v30
    v_perm_b32 v7, v49, v49, v31
    s_nop 1
    v_mfma_f32_16x16x32_bf16 v[68:71], v[140:143], v[4:7], v[68:71]
    v_perm_b32 v8, v34, v34, v24
    v_perm_b32 v9, v34, v34, v25
    v_perm_b32 v10, v34, v34, v26
    v_perm_b32 v11, v34, v34, v27
    s_nop 1
    v_mfma_f32_16x16x32_bf16 v[12:15], v[144:147], v[8:11], v[12:15]
    v_perm_b32 v4, v50, v50, v24
    v_perm_b32 v5, v50, v50, v25
    v_perm_b32 v6, v50, v50, v26
    v_perm_b32 v7, v50, v50, v27
    s_nop 1
    v_mfma_f32_16x16x32_bf16 v[68:71], v[144:147], v[4:7], v[68:71]
    v_perm_b32 v8, v34, v34, v28
    v_perm_b32 v9, v34, v34, v29
    v_perm_b32 v10, v34, v34, v30
    v_perm_b32 v11, v34, v34, v31
    s_nop 1
    v_mfma_f32_16x16x32_bf16 v[12:15], v[148:151], v[8:11], v[12:15]
    v_perm_b32 v4, v50, v50, v28
    v_perm_b32 v5, v50, v50, v29
    v_perm_b32 v6, v50, v50, v30
    v_perm_b32 v7, v50, v50, v31
    s_nop 1
    v_mfma_f32_16x16x32_bf16 v[68:71], v[148:151], v[4:7], v[68:71]
    v_perm_b32 v8, v35, v35, v24
    v_perm_b32 v9, v35, v35, v25
    v_perm_b32 v10, v35, v35, v26
    v_perm_b32 v11, v35, v35, v27
    s_nop 1
    v_mfma_f32_16x16x32_bf16 v[12:15], v[152:155], v[8:11], v[12:15]
    v_perm_b32 v4, v51, v51, v24
    v_perm_b32 v5, v51, v51, v25
    v_perm_b32 v6, v51, v51, v26
    v_perm_b32 v7, v51, v51, v27
    s_nop 1
    v_mfma_f32_16x16x32_bf16 v[68:71], v[152:155], v[4:7], v[68:71]
    v_perm_b32 v8, v35, v35, v28
    v_perm_b32 v9, v35, v35, v29
    v_perm_b32 v10, v35, v35, v30
    v_perm_b32 v11, v35, v35, v31
    s_nop 1
    v_mfma_f32_16x16x32_bf16 v[12:15], v[156:159], v[8:11], v[12:15]
    v_perm_b32 v4, v51, v51, v28
    v_perm_b32 v5, v51, v51, v29
    v_perm_b32 v6, v51, v51, v30
    v_perm_b32 v7, v51, v51, v31
    s_nop 1
    v_mfma_f32_16x16x32_bf16 v[68:71], v[156:159], v[4:7], v[68:71]
    v_perm_b32 v8, v36, v36, v24
    v_perm_b32 v9, v36, v36, v25
    v_perm_b32 v10, v36, v36, v26
    v_perm_b32 v11, v36, v36, v27
    s_nop 1
    v_mfma_f32_16x16x32_bf16 v[12:15], v[160:163], v[8:11], v[12:15]
    v_perm_b32 v4, v52, v52, v24
    v_perm_b32 v5, v52, v52, v25
    v_perm_b32 v6, v52, v52, v26
    v_perm_b32 v7, v52, v52, v27
    s_nop 1
    v_mfma_f32_16x16x32_bf16 v[68:71], v[160:163], v[4:7], v[68:71]
    v_perm_b32 v8, v36, v36, v28
    v_perm_b32 v9, v36, v36, v29
    v_perm_b32 v10, v36, v36, v30
    v_perm_b32 v11, v36, v36, v31
    s_nop 1
    v_mfma_f32_16x16x32_bf16 v[12:15], v[164:167], v[8:11], v[12:15]
    v_perm_b32 v4, v52, v52, v28
    v_perm_b32 v5, v52, v52, v29
    v_perm_b32 v6, v52, v52, v30
    v_perm_b32 v7, v52, v52, v31
    s_nop 1
    v_mfma_f32_16x16x32_bf16 v[68:71], v[164:167], v[4:7], v[68:71]
    v_perm_b32 v8, v37, v37, v24
    v_perm_b32 v9, v37, v37, v25
    v_perm_b32 v10, v37, v37, v26
    v_perm_b32 v11, v37, v37, v27
    s_nop 1
    v_mfma_f32_16x16x32_bf16 v[12:15], v[168:171], v[8:11], v[12:15]
    v_perm_b32 v4, v53, v53, v24
    v_perm_b32 v5, v53, v53, v25
    v_perm_b32 v6, v53, v53, v26
    v_perm_b32 v7, v53, v53, v27
    s_nop 1
    v_mfma_f32_16x16x32_bf16 v[68:71], v[168:171], v[4:7], v[68:71]
    v_perm_b32 v8, v37, v37, v28
    v_perm_b32 v9, v37, v37, v29
    v_perm_b32 v10, v37, v37, v30
    v_perm_b32 v11, v37, v37, v31
    s_nop 1
    v_mfma_f32_16x16x32_bf16 v[12:15], v[172:175], v[8:11], v[12:15]
    v_perm_b32 v4, v53, v53, v28
    v_perm_b32 v5, v53, v53, v29
    v_perm_b32 v6, v53, v53, v30
    v_perm_b32 v7, v53, v53, v31
    s_nop 1
    v_mfma_f32_16x16x32_bf16 v[68:71], v[172:175], v[4:7], v[68:71]
    v_perm_b32 v8, v38, v38, v24
    v_perm_b32 v9, v38, v38, v25
    v_perm_b32 v10, v38, v38, v26
    v_perm_b32 v11, v38, v38, v27
    s_nop 1
    v_mfma_f32_16x16x32_bf16 v[12:15], v[176:179], v[8:11], v[12:15]
    v_perm_b32 v4, v54, v54, v24
    v_perm_b32 v5, v54, v54, v25
    v_perm_b32 v6, v54, v54, v26
    v_perm_b32 v7, v54, v54, v27
    s_nop 1
    v_mfma_f32_16x16x32_bf16 v[68:71], v[176:179], v[4:7], v[68:71]
    v_perm_b32 v8, v38, v38, v28
    v_perm_b32 v9, v38, v38, v29
    v_perm_b32 v10, v38, v38, v30
    v_perm_b32 v11, v38, v38, v31
    s_nop 1
    v_mfma_f32_16x16x32_bf16 v[12:15], v[180:183], v[8:11], v[12:15]
    v_perm_b32 v4, v54, v54, v28
    v_perm_b32 v5, v54, v54, v29
    v_perm_b32 v6, v54, v54, v30
    v_perm_b32 v7, v54, v54, v31
    s_nop 1
    v_mfma_f32_16x16x32_bf16 v[68:71], v[180:183], v[4:7], v[68:71]
    v_perm_b32 v8, v39, v39, v24
    v_perm_b32 v9, v39, v39, v25
    v_perm_b32 v10, v39, v39, v26
    v_perm_b32 v11, v39, v39, v27
    s_nop 1
    v_mfma_f32_16x16x32_bf16 v[12:15], v[184:187], v[8:11], v[12:15]
    v_perm_b32 v4, v55, v55, v24
    v_perm_b32 v5, v55, v55, v25
    v_perm_b32 v6, v55, v55, v26
    v_perm_b32 v7, v55, v55, v27
    s_nop 1
    v_mfma_f32_16x16x32_bf16 v[68:71], v[184:187], v[4:7], v[68:71]
    v_perm_b32 v8, v39, v39, v28
    v_perm_b32 v9, v39, v39, v29
    v_perm_b32 v10, v39, v39, v30
    v_perm_b32 v11, v39, v39, v31
    s_nop 1
    v_mfma_f32_16x16x32_bf16 v[12:15], v[188:191], v[8:11], v[12:15]
    v_perm_b32 v4, v55, v55, v28
    v_perm_b32 v5, v55, v55, v29
    v_perm_b32 v6, v55, v55, v30
    v_perm_b32 v7, v55, v55, v31
    s_nop 1
    v_mfma_f32_16x16x32_bf16 v[68:71], v[188:191], v[4:7], v[68:71]
    v_perm_b32 v8, v40, v40, v24
    v_perm_b32 v9, v40, v40, v25
    v_perm_b32 v10, v40, v40, v26
    v_perm_b32 v11, v40, v40, v27
    s_nop 1
    v_mfma_f32_16x16x32_bf16 v[12:15], v[192:195], v[8:11], v[12:15]
    v_perm_b32 v4, v56, v56, v24
    v_perm_b32 v5, v56, v56, v25
    v_perm_b32 v6, v56, v56, v26
    v_perm_b32 v7, v56, v56, v27
    s_nop 1
    v_mfma_f32_16x16x32_bf16 v[68:71], v[192:195], v[4:7], v[68:71]
    v_perm_b32 v8, v40, v40, v28
    v_perm_b32 v9, v40, v40, v29
    v_perm_b32 v10, v40, v40, v30
    v_perm_b32 v11, v40, v40, v31
    s_nop 1
    v_mfma_f32_16x16x32_bf16 v[12:15], v[196:199], v[8:11], v[12:15]
    v_perm_b32 v4, v56, v56, v28
    v_perm_b32 v5, v56, v56, v29
    v_perm_b32 v6, v56, v56, v30
    v_perm_b32 v7, v56, v56, v31
    s_nop 1
    v_mfma_f32_16x16x32_bf16 v[68:71], v[196:199], v[4:7], v[68:71]
    v_perm_b32 v8, v41, v41, v24
    v_perm_b32 v9, v41, v41, v25
    v_perm_b32 v10, v41, v41, v26
    v_perm_b32 v11, v41, v41, v27
    s_nop 1
    v_mfma_f32_16x16x32_bf16 v[12:15], v[200:203], v[8:11], v[12:15]
    v_perm_b32 v4, v57, v57, v24
    v_perm_b32 v5, v57, v57, v25
    v_perm_b32 v6, v57, v57, v26
    v_perm_b32 v7, v57, v57, v27
    s_nop 1
    v_mfma_f32_16x16x32_bf16 v[68:71], v[200:203], v[4:7], v[68:71]
    v_perm_b32 v8, v41, v41, v28
    v_perm_b32 v9, v41, v41, v29
    v_perm_b32 v10, v41, v41, v30
    v_perm_b32 v11, v41, v41, v31
    s_nop 1
    v_mfma_f32_16x16x32_bf16 v[12:15], v[204:207], v[8:11], v[12:15]
    v_perm_b32 v4, v57, v57, v28
    v_perm_b32 v5, v57, v57, v29
    v_perm_b32 v6, v57, v57, v30
    v_perm_b32 v7, v57, v57, v31
    s_nop 1
    v_mfma_f32_16x16x32_bf16 v[68:71], v[204:207], v[4:7], v[68:71]
    v_perm_b32 v8, v42, v42, v24
    v_perm_b32 v9, v42, v42, v25
    v_perm_b32 v10, v42, v42, v26
    v_perm_b32 v11, v42, v42, v27
    s_nop 1
    v_mfma_f32_16x16x32_bf16 v[12:15], v[208:211], v[8:11], v[12:15]
    v_perm_b32 v4, v58, v58, v24
    v_perm_b32 v5, v58, v58, v25
    v_perm_b32 v6, v58, v58, v26
    v_perm_b32 v7, v58, v58, v27
    s_nop 1
    v_mfma_f32_16x16x32_bf16 v[68:71], v[208:211], v[4:7], v[68:71]
    v_perm_b32 v8, v42, v42, v28
    v_perm_b32 v9, v42, v42, v29
    v_perm_b32 v10, v42, v42, v30
    v_perm_b32 v11, v42, v42, v31
    s_nop 1
    v_mfma_f32_16x16x32_bf16 v[12:15], v[212:215], v[8:11], v[12:15]
    v_perm_b32 v4, v58, v58, v28
    v_perm_b32 v5, v58, v58, v29
    v_perm_b32 v6, v58, v58, v30
    v_perm_b32 v7, v58, v58, v31
    s_nop 1
    v_mfma_f32_16x16x32_bf16 v[68:71], v[212:215], v[4:7], v[68:71]
    v_perm_b32 v8, v43, v43, v24
    v_perm_b32 v9, v43, v43, v25
    v_perm_b32 v10, v43, v43, v26
    v_perm_b32 v11, v43, v43, v27
    s_nop 1
    v_mfma_f32_16x16x32_bf16 v[12:15], v[216:219], v[8:11], v[12:15]
    v_perm_b32 v4, v59, v59, v24
    v_perm_b32 v5, v59, v59, v25
    v_perm_b32 v6, v59, v59, v26
    v_perm_b32 v7, v59, v59, v27
    s_nop 1
    v_mfma_f32_16x16x32_bf16 v[68:71], v[216:219], v[4:7], v[68:71]
    v_perm_b32 v8, v43, v43, v28
    v_perm_b32 v9, v43, v43, v29
    v_perm_b32 v10, v43, v43, v30
    v_perm_b32 v11, v43, v43, v31
    s_nop 1
    v_mfma_f32_16x16x32_bf16 v[12:15], v[220:223], v[8:11], v[12:15]
    v_perm_b32 v4, v59, v59, v28
    v_perm_b32 v5, v59, v59, v29
    v_perm_b32 v6, v59, v59, v30
    v_perm_b32 v7, v59, v59, v31
    s_nop 1
    v_mfma_f32_16x16x32_bf16 v[68:71], v[220:223], v[4:7], v[68:71]
    v_perm_b32 v8, v44, v44, v24
    v_perm_b32 v9, v44, v44, v25
    v_perm_b32 v10, v44, v44, v26
    v_perm_b32 v11, v44, v44, v27
    s_nop 1
    v_mfma_f32_16x16x32_bf16 v[12:15], v[224:227], v[8:11], v[12:15]
    v_perm_b32 v4, v60, v60, v24
    v_perm_b32 v5, v60, v60, v25
    v_perm_b32 v6, v60, v60, v26
    v_perm_b32 v7, v60, v60, v27
    s_nop 1
    v_mfma_f32_16x16x32_bf16 v[68:71], v[224:227], v[4:7], v[68:71]
    v_perm_b32 v8, v44, v44, v28
    v_perm_b32 v9, v44, v44, v29
    v_perm_b32 v10, v44, v44, v30
    v_perm_b32 v11, v44, v44, v31
    s_nop 1
    v_mfma_f32_16x16x32_bf16 v[12:15], v[228:231], v[8:11], v[12:15]
    v_perm_b32 v4, v60, v60, v28
    v_perm_b32 v5, v60, v60, v29
    v_perm_b32 v6, v60, v60, v30
    v_perm_b32 v7, v60, v60, v31
    s_nop 1
    v_mfma_f32_16x16x32_bf16 v[68:71], v[228:231], v[4:7], v[68:71]
    v_perm_b32 v8, v45, v45, v24
    v_perm_b32 v9, v45, v45, v25
    v_perm_b32 v10, v45, v45, v26
    v_perm_b32 v11, v45, v45, v27
    s_nop 1
    v_mfma_f32_16x16x32_bf16 v[12:15], v[232:235], v[8:11], v[12:15]
    v_perm_b32 v4, v61, v61, v24
    v_perm_b32 v5, v61, v61, v25
    v_perm_b32 v6, v61, v61, v26
    v_perm_b32 v7, v61, v61, v27
    s_nop 1
    v_mfma_f32_16x16x32_bf16 v[68:71], v[232:235], v[4:7], v[68:71]
    v_perm_b32 v8, v45, v45, v28
    v_perm_b32 v9, v45, v45, v29
    v_perm_b32 v10, v45, v45, v30
    v_perm_b32 v11, v45, v45, v31
    s_nop 1
    v_mfma_f32_16x16x32_bf16 v[12:15], v[236:239], v[8:11], v[12:15]
    v_perm_b32 v4, v61, v61, v28
    v_perm_b32 v5, v61, v61, v29
    v_perm_b32 v6, v61, v61, v30
    v_perm_b32 v7, v61, v61, v31
    s_nop 1
    v_mfma_f32_16x16x32_bf16 v[68:71], v[236:239], v[4:7], v[68:71]
    v_perm_b32 v8, v46, v46, v24
    v_perm_b32 v9, v46, v46, v25
    v_perm_b32 v10, v46, v46, v26
    v_perm_b32 v11, v46, v46, v27
    s_nop 1
    v_mfma_f32_16x16x32_bf16 v[12:15], v[240:243], v[8:11], v[12:15]
    v_perm_b32 v4, v62, v62, v24
    v_perm_b32 v5, v62, v62, v25
    v_perm_b32 v6, v62, v62, v26
    v_perm_b32 v7, v62, v62, v27
    s_nop 1
    v_mfma_f32_16x16x32_bf16 v[68:71], v[240:243], v[4:7], v[68:71]
    v_perm_b32 v8, v46, v46, v28
    v_perm_b32 v9, v46, v46, v29
    v_perm_b32 v10, v46, v46, v30
    v_perm_b32 v11, v46, v46, v31
    s_nop 1
    v_mfma_f32_16x16x32_bf16 v[12:15], v[244:247], v[8:11], v[12:15]
    v_perm_b32 v4, v62, v62, v28
    v_perm_b32 v5, v62, v62, v29
    v_perm_b32 v6, v62, v62, v30
    v_perm_b32 v7, v62, v62, v31
    s_nop 1
    v_mfma_f32_16x16x32_bf16 v[68:71], v[244:247], v[4:7], v[68:71]
    v_perm_b32 v8, v47, v47, v24
    v_perm_b32 v9, v47, v47, v25
    v_perm_b32 v10, v47, v47, v26
    v_perm_b32 v11, v47, v47, v27
    s_nop 1
    v_mfma_f32_16x16x32_bf16 v[12:15], v[248:251], v[8:11], v[12:15]
    v_perm_b32 v4, v63, v63, v24
    v_perm_b32 v5, v63, v63, v25
    v_perm_b32 v6, v63, v63, v26
    v_perm_b32 v7, v63, v63, v27
    s_nop 1
    v_mfma_f32_16x16x32_bf16 v[68:71], v[248:251], v[4:7], v[68:71]
    v_perm_b32 v8, v47, v47, v28
    v_perm_b32 v9, v47, v47, v29
    v_perm_b32 v10, v47, v47, v30
    v_perm_b32 v11, v47, v47, v31
    s_nop 1
    v_mfma_f32_16x16x32_bf16 v[12:15], v[252:255], v[8:11], v[12:15]
    v_perm_b32 v4, v63, v63, v28
    v_perm_b32 v5, v63, v63, v29
    v_perm_b32 v6, v63, v63, v30
    v_perm_b32 v7, v63, v63, v31
    s_nop 1
    v_mfma_f32_16x16x32_bf16 v[68:71], v[252:255], v[4:7], v[68:71]
    v_lshrrev_b32 v3, 4, v0
    v_lshlrev_b32 v3, 7, v3
    v_and_b32 v4, 7, v0
    v_lshl_add_u32 v3, v4, 4, v3
    v_bfe_u32 v4, v0, 3, 1
    v_lshl_add_u32 v3, v4, 9, v3
    s_lshl_b32 s24, s3, 11
    s_add_u32 s24, s24, 135168
    v_add_u32 v3, s24, v3
    ds_write_b128 v3, v[12:15]
    ds_write_b128 v3, v[68:71] offset:1024
    s_waitcnt lgkmcnt(0)
    s_barrier
    v_and_b32 v5, 31, v0
    s_lshl_b32 s24, s3, 9
    s_add_u32 s24, s24, 135168
    v_lshl_add_u32 v3, v5, 4, s24
    ds_read_b128 v[72:75], v3 offset:0
    ds_read_b128 v[76:79], v3 offset:2048
    ds_read_b128 v[80:83], v3 offset:4096
    ds_read_b128 v[84:87], v3 offset:6144
    s_lshl_b32 s24, s3, 8
    s_add_u32 s24, s24, 143360
    v_lshl_add_u32 v5, v5, 3, s24
    s_waitcnt lgkmcnt(0)
    v_add_f32 v72, v72, v76
    v_add_f32 v73, v73, v77
    v_add_f32 v74, v74, v78
    v_add_f32 v75, v75, v79
    v_add_f32 v72, v72, v80
    v_add_f32 v73, v73, v81
    v_add_f32 v74, v74, v82
    v_add_f32 v75, v75, v83
    v_add_f32 v72, v72, v84
    v_add_f32 v73, v73, v85
    v_add_f32 v74, v74, v86
    v_add_f32 v75, v75, v87
    v_cvt_pk_bf16_f32 v6, v72, v73
    v_cvt_pk_bf16_f32 v7, v74, v75
    ds_write_b64 v5, v[6:7]
    v_lshrrev_b32 v3, 4, v0
    v_and_b32 v4, 3, v0
    v_lshlrev_b32 v5, 8, v4
    v_lshl_add_u32 v5, v3, 4, v5
    v_add_u32 v5, 143360, v5
    s_waitcnt lgkmcnt(0)
    s_barrier
    ds_read_b128 v[32:35], v5 offset:0
    ds_read_b128 v[36:39], v5 offset:64
    ds_read_b128 v[40:43], v5 offset:128
    ds_read_b128 v[44:47], v5 offset:192
    s_waitcnt lgkmcnt(3)
    v_mfma_f32_16x16x32_bf16 v[72:75], v[32:35], a[0:3], 0
    s_waitcnt lgkmcnt(2)
    v_mfma_f32_16x16x32_bf16 v[72:75], v[36:39], a[4:7], v[72:75]
    s_waitcnt lgkmcnt(1)
    v_mfma_f32_16x16x32_bf16 v[72:75], v[40:43], a[8:11], v[72:75]
    s_waitcnt lgkmcnt(0)
    v_mfma_f32_16x16x32_bf16 v[72:75], v[44:47], a[12:15], v[72:75]
    v_mfma_f32_16x16x32_bf16 v[76:79], v[32:35], a[16:19], 0
    v_mfma_f32_16x16x32_bf16 v[76:79], v[36:39], a[20:23], v[76:79]
    v_mfma_f32_16x16x32_bf16 v[76:79], v[40:43], a[24:27], v[76:79]
    v_mfma_f32_16x16x32_bf16 v[76:79], v[44:47], a[28:31], v[76:79]
    v_mfma_f32_16x16x32_bf16 v[80:83], v[32:35], a[32:35], 0
    v_mfma_f32_16x16x32_bf16 v[80:83], v[36:39], a[36:39], v[80:83]
    v_mfma_f32_16x16x32_bf16 v[80:83], v[40:43], a[40:43], v[80:83]
    v_mfma_f32_16x16x32_bf16 v[80:83], v[44:47], a[44:47], v[80:83]
    v_mov_b32_dpp v4, v72 quad_perm:[0,1,2,3] row_mask:0x1 bank_mask:0xf
    v_mov_b32_dpp v5, v73 quad_perm:[0,1,2,3] row_mask:0x1 bank_mask:0xf
    v_mov_b32_dpp v6, v74 quad_perm:[0,1,2,3] row_mask:0x1 bank_mask:0xf
    v_mov_b32_dpp v7, v75 quad_perm:[0,1,2,3] row_mask:0x1 bank_mask:0xf
    v_mfma_f32_16x16x32_bf16 v[84:87], v[32:35], a[48:51], 0
    v_mfma_f32_16x16x32_bf16 v[84:87], v[36:39], a[52:55], v[84:87]
    v_mfma_f32_16x16x32_bf16 v[84:87], v[40:43], a[56:59], v[84:87]
    v_mfma_f32_16x16x32_bf16 v[84:87], v[44:47], a[60:63], v[84:87]
    v_mov_b32_dpp v4, v76 quad_perm:[0,1,2,3] row_mask:0x2 bank_mask:0xf
    v_mov_b32_dpp v5, v77 quad_perm:[0,1,2,3] row_mask:0x2 bank_mask:0xf
    v_mov_b32_dpp v6, v78 quad_perm:[0,1,2,3] row_mask:0x2 bank_mask:0xf
    v_mov_b32_dpp v7, v79 quad_perm:[0,1,2,3] row_mask:0x2 bank_mask:0xf
    v_mfma_f32_16x16x32_bf16 v[88:91], v[32:35], a[64:67], 0
    v_mfma_f32_16x16x32_bf16 v[88:91], v[36:39], a[68:71], v[88:91]
    v_mfma_f32_16x16x32_bf16 v[88:91], v[40:43], a[72:75], v[88:91]
    v_mfma_f32_16x16x32_bf16 v[88:91], v[44:47], a[76:79], v[88:91]
    v_mov_b32_dpp v4, v80 quad_perm:[0,1,2,3] row_mask:0x4 bank_mask:0xf
    v_mov_b32_dpp v5, v81 quad_perm:[0,1,2,3] row_mask:0x4 bank_mask:0xf
    v_mov_b32_dpp v6, v82 quad_perm:[0,1,2,3] row_mask:0x4 bank_mask:0xf
    v_mov_b32_dpp v7, v83 quad_perm:[0,1,2,3] row_mask:0x4 bank_mask:0xf
    v_mfma_f32_16x16x32_bf16 v[92:95], v[32:35], a[80:83], 0
    v_mfma_f32_16x16x32_bf16 v[92:95], v[36:39], a[84:87], v[92:95]
    v_mfma_f32_16x16x32_bf16 v[92:95], v[40:43], a[88:91], v[92:95]
    v_mfma_f32_16x16x32_bf16 v[92:95], v[44:47], a[92:95], v[92:95]
    v_mov_b32_dpp v4, v84 quad_perm:[0,1,2,3] row_mask:0x8 bank_mask:0xf
    v_mov_b32_dpp v5, v85 quad_perm:[0,1,2,3] row_mask:0x8 bank_mask:0xf
    v_mov_b32_dpp v6, v86 quad_perm:[0,1,2,3] row_mask:0x8 bank_mask:0xf
    v_mov_b32_dpp v7, v87 quad_perm:[0,1,2,3] row_mask:0x8 bank_mask:0xf
    v_mfma_f32_16x16x32_bf16 v[96:99], v[32:35], a[96:99], 0
    v_mfma_f32_16x16x32_bf16 v[96:99], v[36:39], a[100:103], v[96:99]
    v_mfma_f32_16x16x32_bf16 v[96:99], v[40:43], a[104:107], v[96:99]
    v_mfma_f32_16x16x32_bf16 v[96:99], v[44:47], a[108:111], v[96:99]
    v_mov_b32_dpp v8, v88 quad_perm:[0,1,2,3] row_mask:0x1 bank_mask:0xf
    v_mov_b32_dpp v9, v89 quad_perm:[0,1,2,3] row_mask:0x1 bank_mask:0xf
    v_mov_b32_dpp v10, v90 quad_perm:[0,1,2,3] row_mask:0x1 bank_mask:0xf
    v_mov_b32_dpp v11, v91 quad_perm:[0,1,2,3] row_mask:0x1 bank_mask:0xf
    v_mfma_f32_16x16x32_bf16 v[100:103], v[32:35], a[112:115], 0
    v_mfma_f32_16x16x32_bf16 v[100:103], v[36:39], a[116:119], v[100:103]
    v_mfma_f32_16x16x32_bf16 v[100:103], v[40:43], a[120:123], v[100:103]
    v_mfma_f32_16x16x32_bf16 v[100:103], v[44:47], a[124:127], v[100:103]
    v_mov_b32_dpp v8, v92 quad_perm:[0,1,2,3] row_mask:0x2 bank_mask:0xf
    v_mov_b32_dpp v9, v93 quad_perm:[0,1,2,3] row_mask:0x2 bank_mask:0xf
    v_mov_b32_dpp v10, v94 quad_perm:[0,1,2,3] row_mask:0x2 bank_mask:0xf
    v_mov_b32_dpp v11, v95 quad_perm:[0,1,2,3] row_mask:0x2 bank_mask:0xf
    v_mov_b32_dpp v8, v96 quad_perm:[0,1,2,3] row_mask:0x4 bank_mask:0xf
    v_mov_b32_dpp v9, v97 quad_perm:[0,1,2,3] row_mask:0x4 bank_mask:0xf
    v_mov_b32_dpp v10, v98 quad_perm:[0,1,2,3] row_mask:0x4 bank_mask:0xf
    v_mov_b32_dpp v11, v99 quad_perm:[0,1,2,3] row_mask:0x4 bank_mask:0xf
    v_mov_b32_dpp v8, v100 quad_perm:[0,1,2,3] row_mask:0x8 bank_mask:0xf
    v_mov_b32_dpp v9, v101 quad_perm:[0,1,2,3] row_mask:0x8 bank_mask:0xf
    v_mov_b32_dpp v10, v102 quad_perm:[0,1,2,3] row_mask:0x8 bank_mask:0xf
    v_mov_b32_dpp v11, v103 quad_perm:[0,1,2,3] row_mask:0x8 bank_mask:0xf
    s_lshl_b32 s24, s26, 13
    s_lshl_b32 s25, s3, 11
    s_add_u32 s24, s24, s25
    s_add_u32 s24, s24, 0x124000
    buffer_store_dwordx4 v[4:7], v2, s[12:15], s24 offen sc1
    buffer_store_dwordx4 v[8:11], v2, s[12:15], s24 offen offset:1024 sc1
    s_waitcnt vmcnt(0)
    s_barrier
    s_cmp_lg_u32 s3, 0
    s_cbranch_scc1 L_sig11
    s_mov_b64 exec, 1
    v_mov_b32 v3, 1
    buffer_atomic_add v3, off, s[16:19], 0 offset:8 sc0
    s_waitcnt vmcnt(0)
    v_readfirstlane_b32 s24, v3
    s_mov_b64 exec, -1
    s_cmp_lg_u32 s24, 31
    s_cbranch_scc1 L_sig11
    v_lshlrev_b32 v4, 7, v0
    v_mov_b32 v3, 1
    s_mov_b32 s24, 0x170000
    buffer_store_dword v3, v4, s[12:15], s24 offen offset:8 sc1
L_sig11:
L_R:
    s_mov_b32 s20, s58
    s_mov_b32 s21, s59
    s_mov_b32 s22, 0x2000
    s_mov_b32 s23, 0x20000
    v_and_b32 v3, 1, v0
    v_lshlrev_b32 v3, 4, v3
    v_mov_b32 v4, 0xffff
    v_lshlrev_b32 v4, v3, v4
    v_bfe_u32 v3, v0, 1, 2
    v_cmp_eq_u32 vcc, 0, v3
    s_nop 1
    v_cndmask_b32 v20, 0, v4, vcc
    v_cmp_eq_u32 vcc, 1, v3
    s_nop 1
    v_cndmask_b32 v21, 0, v4, vcc
    v_cmp_eq_u32 vcc, 2, v3
    s_nop 1
    v_cndmask_b32 v22, 0, v4, vcc
    v_cmp_eq_u32 vcc, 3, v3
    s_nop 1
    v_cndmask_b32 v23, 0, v4, vcc
    v_lshrrev_b32 v3, 4, v0
    v_and_b32 v4, 7, v0
    v_lshl_add_u32 v5, v3, 3, v4
    v_lshlrev_b32 v27, 4, v5
    v_add_u32 v27, 144384, v27
    s_lshl_b32 s24, s3, 2
    v_add_u32 v26, s24, v27
    s_lshl_b32 s24, s3, 8
    s_add_u32 s24, s24, 143360
    v_lshl_add_u32 v24, v5, 3, s24
    v_lshlrev_b32 v28, 11, v3
    v_lshl_add_u32 v28, v4, 1, v28
    s_lshl_b32 s24, s74, 4
    v_add_u32 v28, s24, v28
    v_lshrrev_b32 v5, 3, v0
    s_lshl_b32 s24, s3, 3
    v_add_u32 v5, s24, v5
    v_lshlrev_b32 v5, 13, v5
    v_lshl_add_u32 v30, v4, 4, v5
    v_and_b32 v5, 3, v0
    v_lshlrev_b32 v25, 8, v5
    v_lshl_add_u32 v25, v3, 4, v25
    v_add_u32 v25, 143360, v25
    v_and_b32 v29, 0x1ff, v2
    v_min_u32 v6, 5, v4
    v_lshlrev_b32 v31, 4, v6
    s_lshl_b32 s33, s26, 2
    s_add_u32 s33, s33, s3
    s_lshl_b32 s29, s33, 7
    s_add_u32 s29, s29, 0x1b0000
    s_mov_b32 s24, 262144
    s_branch L_pd12_in
L_pd12:
    s_sleep 16
L_pd12_in:
    buffer_load_dwordx2 v[8:9], v31, s[12:15], s29 offen sc1
    s_waitcnt vmcnt(0)
    v_max_u32 v3, v8, v9
    v_cmp_eq_u32 vcc, -1, v3
    s_sub_u32 s24, s24, 1
    s_cmp_eq_u32 s24, 0
    s_cbranch_scc1 L_pd12_x
    s_and_b64 exec, exec, vcc
    s_cbranch_scc1 L_pd12
L_pd12_x:
    s_mov_b64 exec, -1
    v_mov_b32 v6, v8
    s_nop 1
    v_max_f32_dpp v6, v6, v6 quad_perm:[1,0,3,2] row_mask:0xf bank_mask:0xf
    s_nop 1
    v_max_f32_dpp v6, v6, v6 quad_perm:[2,3,0,1] row_mask:0xf bank_mask:0xf
    s_nop 1
    v_max_f32_dpp v6, v6, v6 row_half_mirror row_mask:0xf bank_mask:0xf
    v_sub_f32 v8, v8, v6
    v_exp_f32 v8, v8
    v_cmp_gt_u32 vcc, 6, v4
    s_nop 1
    v_cndmask_b32 v8, 0, v8, vcc
    v_mul_f32 v9, v8, v9
    s_nop 1
    v_add_f32_dpp v9, v9, v9 quad_perm:[1,0,3,2] row_mask:0xf bank_mask:0xf
    s_nop 1
    v_add_f32_dpp v9, v9, v9 quad_perm:[2,3,0,1] row_mask:0xf bank_mask:0xf
    s_nop 1
    v_add_f32_dpp v9, v9, v9 row_half_mirror row_mask:0xf bank_mask:0xf
    v_rcp_f32 v9, v9
    s_nop 0
    v_mul_f32 v8, v8, v9
    v_cvt_pk_bf16_f32 v8, v8, v8
    v_lshrrev_b32 v5, 4, v0
    v_lshlrev_b32 v5, 2, v5
    ds_bpermute_b32 v6, v5, v8
    ds_bpermute_b32 v7, v5, v8 offset:16
    s_waitcnt lgkmcnt(0)
    v_and_b32 v32, v6, v20
    v_and_b32 v33, v6, v21
    v_and_b32 v34, v6, v22
    v_and_b32 v35, v6, v23
    v_and_b32 v36, v7, v20
    v_and_b32 v37, v7, v21
    v_and_b32 v38, v7, v22
    v_and_b32 v39, v7, v23
    s_cmp_lg_u32 s3, 0
    s_cbranch_scc1 L_awx13
    s_mov_b32 s24, 262144
    s_mov_b64 exec, 1
L_aw14:
    buffer_load_dword v1, off, s[12:15], s73 offset:8 sc1
    s_waitcnt vmcnt(0)
    v_readfirstlane_b32 s25, v1
    s_nop 0
    s_cmp_eq_u32 s25, 1
    s_cbranch_scc1 L_awx13
    s_sleep 4
    s_sub_u32 s24, s24, 1
    s_cmp_lg_u32 s24, 0
    s_cbranch_scc1 L_aw14
L_awx13:
    s_mov_b64 exec, -1
    s_barrier
    s_lshl_b32 s30, s74, 7
    s_add_u32 s24, s30, 0x124000
    buffer_load_dwordx4 v[4:7], v30, s[12:15], s24 offen sc1
    s_waitcnt vmcnt(0)
    v_permlane32_swap_b32 v4, v6
    v_permlane32_swap_b32 v5, v7
    v_add_f32 v4, v4, v6
    v_add_f32 v5, v5, v7
    s_nop 1
    v_permlane16_swap_b32 v4, v5
    v_add_f32 v4, v4, v5
    s_nop 1
    v_add_f32_dpp v4, v4, v4 row_ror:8 row_mask:0xf bank_mask:0xf
    ds_write_b32 v26, v4 offset:0
    s_waitcnt lgkmcnt(0)
    s_barrier
    s_cmp_lg_u32 s3, 0
    s_cbranch_scc1 L_fr15
    ds_read_b128 v[4:7], v27 offset:0
    s_waitcnt lgkmcnt(0)
    v_add_f32 v4, v4, v5
    v_add_f32 v6, v6, v7
    v_add_f32 v4, v4, v6
    v_cvt_pk_bf16_f32 v4, v4, v4
    buffer_store_short v4, v28, s[20:23], 0 offen offset:0
L_fr15:
    s_mul_i32 s29, s33, 1536
    s_add_u32 s29, s29, 0x180000
    s_add_u32 s30, s30, 0x1b8000
    s_lshl_b32 s31, s26, 13
    s_lshr_b32 s24, s74, 5
    s_lshl_b32 s24, s24, 12
    s_add_u32 s31, s31, s24
    s_lshl_b32 s24, s3, 10
    s_add_u32 s31, s31, s24
    s_add_u32 s31, s31, 0x1b8000
    s_mov_b32 s24, 262144
    s_branch L_pd16_in
L_pd16:
L_pd16_in:
    buffer_load_dwordx4 v[40:43], v2, s[12:15], s29 offen sc1
    buffer_load_dwordx4 v[44:47], v29, s[12:15], s29 offen offset:1024 sc1
    s_waitcnt vmcnt(0)
    v_max_u32 v3, v40, v41
    v_max3_u32 v3, v3, v42, v43
    v_max3_u32 v3, v3, v44, v45
    v_max3_u32 v3, v3, v46, v47
    v_cmp_eq_u32 vcc, -1, v3
    s_sub_u32 s24, s24, 1
    s_cmp_eq_u32 s24, 0
    s_cbranch_scc1 L_pd16_x
    s_and_b64 exec, exec, vcc
    s_cbranch_scc1 L_pd16
L_pd16_x:
    s_mov_b64 exec, -1
    v_mfma_f32_16x16x32_bf16 v[12:15], v[40:43], v[32:35], 0
    v_mfma_f32_16x16x32_bf16 v[12:15], v[44:47], v[36:39], v[12:15]
    s_nop 7
    v_cvt_pk_bf16_f32 v4, v12, v13
    v_cvt_pk_bf16_f32 v5, v14, v15
    ds_write_b64 v24, v[4:5]
    s_waitcnt lgkmcnt(0)
    s_barrier
    ds_read_b128 v[48:51], v25 offset:0
    ds_read_b128 v[52:55], v25 offset:64
    ds_read_b128 v[56:59], v25 offset:128
    ds_read_b128 v[60:63], v25 offset:192
    s_waitcnt lgkmcnt(3)
    v_mfma_f32_16x16x32_bf16 v[64:67], v[48:51], a[128:131], 0
    v_mfma_f32_16x16x32_bf16 v[68:71], v[48:51], a[144:147], 0
    v_mfma_f32_16x16x32_bf16 v[72:75], v[48:51], a[160:163], 0
    v_mfma_f32_16x16x32_bf16 v[76:79], v[48:51], a[176:179], 0
    s_waitcnt lgkmcnt(2)
    v_mfma_f32_16x16x32_bf16 v[64:67], v[52:55], a[132:135], v[64:67]
    v_mfma_f32_16x16x32_bf16 v[68:71], v[52:55], a[148:151], v[68:71]
    v_mfma_f32_16x16x32_bf16 v[72:75], v[52:55], a[164:167], v[72:75]
    v_mfma_f32_16x16x32_bf16 v[76:79], v[52:55], a[180:183], v[76:79]
    s_waitcnt lgkmcnt(1)
    v_mfma_f32_16x16x32_bf16 v[64:67], v[56:59], a[136:139], v[64:67]
    v_mfma_f32_16x16x32_bf16 v[68:71], v[56:59], a[152:155], v[68:71]
    v_mfma_f32_16x16x32_bf16 v[72:75], v[56:59], a[168:171], v[72:75]
    v_mfma_f32_16x16x32_bf16 v[76:79], v[56:59], a[184:187], v[76:79]
    s_waitcnt lgkmcnt(0)
    v_mfma_f32_16x16x32_bf16 v[64:67], v[60:63], a[140:143], v[64:67]
    v_mfma_f32_16x16x32_bf16 v[68:71], v[60:63], a[156:159], v[68:71]
    v_mfma_f32_16x16x32_bf16 v[72:75], v[60:63], a[172:175], v[72:75]
    v_mfma_f32_16x16x32_bf16 v[76:79], v[60:63], a[188:191], v[76:79]
    s_nop 4
    v_mov_b32_dpp v8, v64 quad_perm:[0,1,2,3] row_mask:0x1 bank_mask:0xf
    v_mov_b32_dpp v9, v65 quad_perm:[0,1,2,3] row_mask:0x1 bank_mask:0xf
    v_mov_b32_dpp v10, v66 quad_perm:[0,1,2,3] row_mask:0x1 bank_mask:0xf
    v_mov_b32_dpp v11, v67 quad_perm:[0,1,2,3] row_mask:0x1 bank_mask:0xf
    v_mov_b32_dpp v8, v68 quad_perm:[0,1,2,3] row_mask:0x2 bank_mask:0xf
    v_mov_b32_dpp v9, v69 quad_perm:[0,1,2,3] row_mask:0x2 bank_mask:0xf
    v_mov_b32_dpp v10, v70 quad_perm:[0,1,2,3] row_mask:0x2 bank_mask:0xf
    v_mov_b32_dpp v11, v71 quad_perm:[0,1,2,3] row_mask:0x2 bank_mask:0xf
    v_mov_b32_dpp v8, v72 quad_perm:[0,1,2,3] row_mask:0x4 bank_mask:0xf
    v_mov_b32_dpp v9, v73 quad_perm:[0,1,2,3] row_mask:0x4 bank_mask:0xf
    v_mov_b32_dpp v10, v74 quad_perm:[0,1,2,3] row_mask:0x4 bank_mask:0xf
    v_mov_b32_dpp v11, v75 quad_perm:[0,1,2,3] row_mask:0x4 bank_mask:0xf
    v_mov_b32_dpp v8, v76 quad_perm:[0,1,2,3] row_mask:0x8 bank_mask:0xf
    v_mov_b32_dpp v9, v77 quad_perm:[0,1,2,3] row_mask:0x8 bank_mask:0xf
    v_mov_b32_dpp v10, v78 quad_perm:[0,1,2,3] row_mask:0x8 bank_mask:0xf
    v_mov_b32_dpp v11, v79 quad_perm:[0,1,2,3] row_mask:0x8 bank_mask:0xf
    buffer_store_dwordx4 v[8:11], v2, s[12:15], s31 offen sc1
    s_mov_b32 s24, 262144
    s_branch L_pd17_in
L_pd17:
L_pd17_in:
    buffer_load_dwordx4 v[4:7], v30, s[12:15], s30 offen sc1
    s_waitcnt vmcnt(0)
    v_max_u32 v3, v4, v5
    v_max3_u32 v3, v3, v6, v7
    v_cmp_eq_u32 vcc, -1, v3
    s_sub_u32 s24, s24, 1
    s_cmp_eq_u32 s24, 0
    s_cbranch_scc1 L_pd17_x
    s_and_b64 exec, exec, vcc
    s_cbranch_scc1 L_pd17
L_pd17_x:
    s_mov_b64 exec, -1
    v_permlane32_swap_b32 v4, v6
    v_permlane32_swap_b32 v5, v7
    v_add_f32 v4, v4, v6
    v_add_f32 v5, v5, v7
    s_nop 1
    v_permlane16_swap_b32 v4, v5
    v_add_f32 v4, v4, v5
    s_nop 1
    v_add_f32_dpp v4, v4, v4 row_ror:8 row_mask:0xf bank_mask:0xf
    ds_write_b32 v26, v4 offset:512
    s_waitcnt lgkmcnt(0)
    s_barrier
    s_cmp_lg_u32 s3, 0
    s_cbranch_scc1 L_fr18
    ds_read_b128 v[4:7], v27 offset:512
    s_waitcnt lgkmcnt(0)
    v_add_f32 v4, v4, v5
    v_add_f32 v6, v6, v7
    v_add_f32 v4, v4, v6
    v_cvt_pk_bf16_f32 v4, v4, v4
    buffer_store_short v4, v28, s[20:23], 0 offen offset:1024
L_fr18:
L_end:
    s_endpgm
L_C:
    s_cmp_lg_u32 s3, 0
    s_cbranch_scc1 L_C_q
    v_lshrrev_b32 v3, 4, v0
    v_and_b32 v4, 3, v0
    v_lshlrev_b32 v5, 6, v3
    v_lshl_add_u32 v5, v4, 4, v5
    v_bfe_u32 v4, v0, 2, 2
    v_lshl_add_u32 v5, v4, 8, v5
    s_lshl_b32 s24, s26, 10
    s_add_u32 s24, s24, 0x164000
    buffer_store_dwordx4 v[8:11], v5, s[12:15], s24 offen sc1
L_C_q:
    s_waitcnt vmcnt(0)
    s_barrier
    s_cmp_lg_u32 s3, 0
    s_cbranch_scc1 L_sig19
    s_mov_b64 exec, 1
    v_mov_b32 v3, 1
    v_mov_b32 v4, 1
    buffer_atomic_add v4, off, s[16:19], 0 offset:128
    buffer_atomic_add v3, off, s[16:19], 0 offset:0 sc0
    s_waitcnt vmcnt(0)
    v_readfirstlane_b32 s24, v3
    s_mov_b64 exec, -1
    s_cmp_lg_u32 s24, 63
    s_cbranch_scc1 L_sig19
    v_lshlrev_b32 v4, 7, v0
    v_mov_b32 v3, 1
    s_mov_b32 s24, 0x170000
    buffer_store_dword v3, v4, s[12:15], s24 offen offset:0 sc1
L_sig19:
    s_lshl_b32 s30, s72, 19
    s_add_u32 s4, s38, s30
    s_addc_u32 s5, s39, 0
    s_mov_b32 s6, 0x80000
    s_mov_b32 s7, 0x20000
    s_mov_b32 s8, s56
    s_mov_b32 s9, s57
    s_mov_b32 s10, 0x400000
    s_mov_b32 s11, 0x20000
    s_lshl_b32 s33, s26, 17
    s_lshl_b32 s24, s3, 15
    s_add_u32 s33, s33, s24
    s_add_u32 s33, s33, 512
    s_mul_i32 s34, s3, 17408
    s_add_u32 s34, s34, 67584
    s_mov_b32 exec_hi, 0
    s_mov_b32 s70, 0
L_woC:
    s_and_b32 s24, s70, 1
    s_lshl_b32 s24, s24, 4
    s_and_b32 s25, s70, 4
    s_lshl_b32 s25, s25, 1
    s_or_b32 s24, s24, s25
    s_bfe_u32 s25, s70, 0x10001
    s_or_b32 s24, s24, s25
    s_lshl_b32 s24, s24, 10
    s_add_u32 s24, s24, s33
    s_mul_i32 s25, s70, 2176
    s_add_u32 m0, s25, s34
    s_waitcnt vmcnt(24)
    buffer_load_dwordx4 v2, s[8:11], s24 offen nt lds
    s_add_u32 m0, m0, 544
    s_add_u32 s24, s24, 2048
    s_waitcnt vmcnt(24)
    buffer_load_dwordx4 v2, s[8:11], s24 offen nt lds
    s_add_u32 m0, m0, 544
    s_add_u32 s24, s24, 2048
    s_waitcnt vmcnt(24)
    buffer_load_dwordx4 v2, s[8:11], s24 offen nt lds
    s_add_u32 m0, m0, 544
    s_add_u32 s24, s24, 2048
    s_waitcnt vmcnt(24)
    buffer_load_dwordx4 v2, s[8:11], s24 offen nt lds
    s_add_u32 s70, s70, 1
    s_cmp_lt_u32 s70, 8
    s_cbranch_scc1 L_woC
    s_mov_b64 exec, -1
    s_lshl_b32 s32, s3, 13
    s_mul_i32 s34, s3, 8448
    s_mov_b32 s33, 0
    s_add_u32 m0, s33, s34
    s_nop 0
    buffer_load_dwordx4 v2, s[4:7], s32 offen nt lds
    s_add_u32 m0, m0, 1056
    s_add_u32 s32, s32, 1024
    buffer_load_dwordx4 v2, s[4:7], s32 offen nt lds
    s_add_u32 m0, m0, 1056
    s_add_u32 s32, s32, 1024
    buffer_load_dwordx4 v2, s[4:7], s32 offen nt lds
    s_add_u32 m0, m0, 1056
    s_add_u32 s32, s32, 1024
    buffer_load_dwordx4 v2, s[4:7], s32 offen nt lds
    s_add_u32 m0, m0, 1056
    s_add_u32 s32, s32, 1024
    buffer_load_dwordx4 v2, s[4:7], s32 offen nt lds
    s_add_u32 m0, m0, 1056
    s_add_u32 s32, s32, 1024
    buffer_load_dwordx4 v2, s[4:7], s32 offen nt lds
    s_add_u32 m0, m0, 1056
    s_add_u32 s32, s32, 1024
    buffer_load_dwordx4 v2, s[4:7], s32 offen nt lds
    s_add_u32 m0, m0, 1056
    s_add_u32 s32, s32, 1024
    buffer_load_dwordx4 v2, s[4:7], s32 offen nt lds
    s_add_u32 s32, s32, 25600
    s_mov_b32 s33, 33792
    s_add_u32 m0, s33, s34
    s_nop 0
    buffer_load_dwordx4 v2, s[4:7], s32 offen nt lds
    s_add_u32 m0, m0, 1056
    s_add_u32 s32, s32, 1024
    buffer_load_dwordx4 v2, s[4:7], s32 offen nt lds
    s_add_u32 m0, m0, 1056
    s_add_u32 s32, s32, 1024
    buffer_load_dwordx4 v2, s[4:7], s32 offen nt lds
    s_add_u32 m0, m0, 1056
    s_add_u32 s32, s32, 1024
    buffer_load_dwordx4 v2, s[4:7], s32 offen nt lds
    s_add_u32 m0, m0, 1056
    s_add_u32 s32, s32, 1024
    buffer_load_dwordx4 v2, s[4:7], s32 offen nt lds
    s_add_u32 m0, m0, 1056
    s_add_u32 s32, s32, 1024
    buffer_load_dwordx4 v2, s[4:7], s32 offen nt lds
    s_add_u32 m0, m0, 1056
    s_add_u32 s32, s32, 1024
    buffer_load_dwordx4 v2, s[4:7], s32 offen nt lds
    s_add_u32 m0, m0, 1056
    s_add_u32 s32, s32, 1024
    buffer_load_dwordx4 v2, s[4:7], s32 offen nt lds
    s_add_u32 s32, s32, 25600
    s_waitcnt vmcnt(16)
    s_barrier
    v_lshrrev_b32 v3, 2, v0
    v_mul_u32_u24 v3, 544, v3
    v_and_b32 v4, 3, v0
    v_lshl_add_u32 v3, v4, 3, v3
    s_mul_i32 s24, s3, 128
    s_add_u32 s24, s24, 67584
    v_add_u32 v3, s24, v3
    v_add_u32 v4, 34816, v3
    ds_read_b64_tr_b16 a[128:129], v3 offset:0
    ds_read_b64_tr_b16 a[130:131], v3 offset:8704
    ds_read_b64_tr_b16 a[132:133], v3 offset:17408
    ds_read_b64_tr_b16 a[134:135], v3 offset:26112
    ds_read_b64_tr_b16 a[136:137], v4 offset:0
    ds_read_b64_tr_b16 a[138:139], v4 offset:8704
    ds_read_b64_tr_b16 a[140:141], v4 offset:17408
    ds_read_b64_tr_b16 a[142:143], v4 offset:26112
    ds_read_b64_tr_b16 a[144:145], v3 offset:32
    ds_read_b64_tr_b16 a[146:147], v3 offset:8736
    ds_read_b64_tr_b16 a[148:149], v3 offset:17440
    ds_read_b64_tr_b16 a[150:151], v3 offset:26144
    ds_read_b64_tr_b16 a[152:153], v4 offset:32
    ds_read_b64_tr_b16 a[154:155], v4 offset:8736
    ds_read_b64_tr_b16 a[156:157], v4 offset:17440
    ds_read_b64_tr_b16 a[158:159], v4 offset:26144
    ds_read_b64_tr_b16 a[160:161], v3 offset:64
    ds_read_b64_tr_b16 a[162:163], v3 offset:8768
    ds_read_b64_tr_b16 a[164:165], v3 offset:17472
    ds_read_b64_tr_b16 a[166:167], v3 offset:26176
    ds_read_b64_tr_b16 a[168:169], v4 offset:64
    ds_read_b64_tr_b16 a[170:171], v4 offset:8768
    ds_read_b64_tr_b16 a[172:173], v4 offset:17472
    ds_read_b64_tr_b16 a[174:175], v4 offset:26176
    ds_read_b64_tr_b16 a[176:177], v3 offset:96
    ds_read_b64_tr_b16 a[178:179], v3 offset:8800
    ds_read_b64_tr_b16 a[180:181], v3 offset:17504
    ds_read_b64_tr_b16 a[182:183], v3 offset:26208
    ds_read_b64_tr_b16 a[184:185], v4 offset:96
    ds_read_b64_tr_b16 a[186:187], v4 offset:8800
    ds_read_b64_tr_b16 a[188:189], v4 offset:17504
    ds_read_b64_tr_b16 a[190:191], v4 offset:26208
    s_waitcnt lgkmcnt(0)
    s_barrier
    s_mov_b32 s33, 67584
    s_add_u32 m0, s33, s34
    s_nop 0
    buffer_load_dwordx4 v2, s[4:7], s32 offen nt lds
    s_add_u32 m0, m0, 1056
    s_add_u32 s32, s32, 1024
    buffer_load_dwordx4 v2, s[4:7], s32 offen nt lds
    s_add_u32 m0, m0, 1056
    s_add_u32 s32, s32, 1024
    buffer_load_dwordx4 v2, s[4:7], s32 offen nt lds
    s_add_u32 m0, m0, 1056
    s_add_u32 s32, s32, 1024
    buffer_load_dwordx4 v2, s[4:7], s32 offen nt lds
    s_add_u32 m0, m0, 1056
    s_add_u32 s32, s32, 1024
    buffer_load_dwordx4 v2, s[4:7], s32 offen nt lds
    s_add_u32 m0, m0, 1056
    s_add_u32 s32, s32, 1024
    buffer_load_dwordx4 v2, s[4:7], s32 offen nt lds
    s_add_u32 m0, m0, 1056
    s_add_u32 s32, s32, 1024
    buffer_load_dwordx4 v2, s[4:7], s32 offen nt lds
    s_add_u32 m0, m0, 1056
    s_add_u32 s32, s32, 1024
    buffer_load_dwordx4 v2, s[4:7], s32 offen nt lds
    s_add_u32 s32, s32, 25600
    s_lshr_b32 s28, s3, 1
    s_and_b32 s29, s3, 1
    v_and_b32 v3, 15, v0
    v_lshrrev_b32 v4, 4, v0
    v_mul_u32_u24 v19, 1056, v3
    v_lshl_add_u32 v19, v4, 4, v19
    s_mul_i32 s24, s28, 16896
    s_add_u32 s24, s24, 101376
    v_add_u32 v18, s24, v19
    v_lshrrev_b32 v5, 2, v0
    v_mul_u32_u24 v20, 1056, v5
    v_and_b32 v5, 3, v0
    v_lshl_add_u32 v20, v5, 3, v20
    s_lshl_b32 s24, s29, 9
    v_add_u32 v20, s24, v20
    v_mov_b32 v128, 0
    v_mov_b32 v129, 0
    v_mov_b32 v130, 0
    v_mov_b32 v131, 0
    v_mov_b32 v132, 0
    v_mov_b32 v133, 0
    v_mov_b32 v134, 0
    v_mov_b32 v135, 0
    v_mov_b32 v136, 0
    v_mov_b32 v137, 0
    v_mov_b32 v138, 0
    v_mov_b32 v139, 0
    v_mov_b32 v140, 0
    v_mov_b32 v141, 0
    v_mov_b32 v142, 0
    v_mov_b32 v143, 0
    v_mov_b32 v144, 0
    v_mov_b32 v145, 0
    v_mov_b32 v146, 0
    v_mov_b32 v147, 0
    v_mov_b32 v148, 0
    v_mov_b32 v149, 0
    v_mov_b32 v150, 0
    v_mov_b32 v151, 0
    v_mov_b32 v152, 0
    v_mov_b32 v153, 0
    v_mov_b32 v154, 0
    v_mov_b32 v155, 0
    v_mov_b32 v156, 0
    v_mov_b32 v157, 0
    v_mov_b32 v158, 0
    v_mov_b32 v159, 0
    v_mov_b32 v160, 0
    v_mov_b32 v161, 0
    v_mov_b32 v162, 0
    v_mov_b32 v163, 0
    v_mov_b32 v164, 0
    v_mov_b32 v165, 0
    v_mov_b32 v166, 0
    v_mov_b32 v167, 0
    v_mov_b32 v168, 0
    v_mov_b32 v169, 0
    v_mov_b32 v170, 0
    v_mov_b32 v171, 0
    v_mov_b32 v172, 0
    v_mov_b32 v173, 0
    v_mov_b32 v174, 0
    v_mov_b32 v175, 0
    v_mov_b32 v176, 0
    v_mov_b32 v177, 0
    v_mov_b32 v178, 0
    v_mov_b32 v179, 0
    v_mov_b32 v180, 0
    v_mov_b32 v181, 0
    v_mov_b32 v182, 0
    v_mov_b32 v183, 0
    v_mov_b32 v184, 0
    v_mov_b32 v185, 0
    v_mov_b32 v186, 0
    v_mov_b32 v187, 0
    v_mov_b32 v188, 0
    v_mov_b32 v189, 0
    v_mov_b32 v190, 0
    v_mov_b32 v191, 0
    v_mov_b32 v22, 0xff800000
    v_mov_b32 v23, 0
    s_cmp_lg_u32 s3, 0
    s_cbranch_scc1 L_awx20
    s_mov_b32 s24, 262144
    s_mov_b64 exec, 1
L_aw21:
    buffer_load_dword v1, off, s[12:15], s73 offset:0 sc1
    s_waitcnt vmcnt(0)
    v_readfirstlane_b32 s25, v1
    s_nop 0
    s_cmp_eq_u32 s25, 1
    s_cbranch_scc1 L_awx20
    s_sleep 4
    s_sub_u32 s24, s24, 1
    s_cmp_lg_u32 s24, 0
    s_cbranch_scc1 L_aw21
L_awx20:
    s_mov_b64 exec, -1
    s_barrier
    s_lshr_b32 s24, s72, 3
    s_lshl_b32 s24, s24, 15
    s_lshl_b32 s25, s3, 13
    s_add_u32 s24, s24, s25
    s_add_u32 s24, s24, 0x0
    buffer_load_dwordx4 v[32:35], v2, s[12:15], s24 offen offset:0 sc1
    buffer_load_dwordx4 v[36:39], v2, s[12:15], s24 offen offset:1024 sc1
    buffer_load_dwordx4 v[40:43], v2, s[12:15], s24 offen offset:2048 sc1
    buffer_load_dwordx4 v[44:47], v2, s[12:15], s24 offen offset:3072 sc1
    s_add_u32 s24, s24, 4096
    buffer_load_dwordx4 v[48:51], v2, s[12:15], s24 offen offset:0 sc1
    buffer_load_dwordx4 v[52:55], v2, s[12:15], s24 offen offset:1024 sc1
    buffer_load_dwordx4 v[56:59], v2, s[12:15], s24 offen offset:2048 sc1
    buffer_load_dwordx4 v[60:63], v2, s[12:15], s24 offen offset:3072 sc1
    s_add_u32 s24, s34, 101376
    v_add_u32 v3, s24, v2
    s_waitcnt vmcnt(7)
    ds_write_b128 v3, v[32:35] offset:0
    s_waitcnt vmcnt(6)
    ds_write_b128 v3, v[36:39] offset:1056
    s_waitcnt vmcnt(5)
    ds_write_b128 v3, v[40:43] offset:2112
    s_waitcnt vmcnt(4)
    ds_write_b128 v3, v[44:47] offset:3168
    s_waitcnt vmcnt(3)
    ds_write_b128 v3, v[48:51] offset:4224
    s_waitcnt vmcnt(2)
    ds_write_b128 v3, v[52:55] offset:5280
    s_waitcnt vmcnt(1)
    ds_write_b128 v3, v[56:59] offset:6336
    s_waitcnt vmcnt(0)
    ds_write_b128 v3, v[60:63] offset:7392
    s_waitcnt lgkmcnt(0)
    s_barrier
    ds_read_b128 a[0:3], v18 offset:0
    ds_read_b128 a[4:7], v18 offset:64
    ds_read_b128 a[8:11], v18 offset:128
    ds_read_b128 a[12:15], v18 offset:192
    ds_read_b128 a[16:19], v18 offset:256
    ds_read_b128 a[20:23], v18 offset:320
    ds_read_b128 a[24:27], v18 offset:384
    ds_read_b128 a[28:31], v18 offset:448
    ds_read_b128 a[32:35], v18 offset:512
    ds_read_b128 a[36:39], v18 offset:576
    ds_read_b128 a[40:43], v18 offset:640
    ds_read_b128 a[44:47], v18 offset:704
    ds_read_b128 a[48:51], v18 offset:768
    ds_read_b128 a[52:55], v18 offset:832
    ds_read_b128 a[56:59], v18 offset:896
    ds_read_b128 a[60:63], v18 offset:960
    s_cmp_lg_u32 s3, 0
    s_cbranch_scc1 L_xi22
    s_getreg_b32 s25, hwreg(HW_REG_XCC_ID, 0, 4)
    s_lshl_b32 s24, s26, 7
    s_add_u32 s24, s24, 0x1b4000
    s_mov_b64 exec, 1
    v_mov_b32 v3, s25
    buffer_store_dword v3, off, s[12:15], s24 offset:4 sc1
    s_mov_b64 exec, -1
L_xi22:
    s_mov_b32 s27, 0
    s_mov_b32 s33, 101376
    s_mov_b32 s35, 0
    s_waitcnt lgkmcnt(0)
L_CT:
    s_waitcnt vmcnt(16)
    s_barrier
    v_add_u32 v24, s35, v19
    v_add_u32 v25, s35, v20
    ds_read_b128 v[32:35], v24 offset:0
    ds_read_b128 v[36:39], v24 offset:16896
    ds_read_b128 v[40:43], v24 offset:64
    ds_read_b128 v[44:47], v24 offset:16960
    ds_read_b128 v[48:51], v24 offset:128
    ds_read_b128 v[52:55], v24 offset:17024
    ds_read_b128 v[56:59], v24 offset:192
    s_add_u32 m0, s33, s34
    s_nop 0
    buffer_load_dwordx4 v2, s[4:7], s32 offen nt lds
    s_add_u32 m0, m0, 1056
    s_add_u32 s32, s32, 1024
    buffer_load_dwordx4 v2, s[4:7], s32 offen nt lds
    s_add_u32 m0, m0, 1056
    s_add_u32 s32, s32, 1024
    buffer_load_dwordx4 v2, s[4:7], s32 offen nt lds
    s_add_u32 m0, m0, 1056
    s_add_u32 s32, s32, 1024
    buffer_load_dwordx4 v2, s[4:7], s32 offen nt lds
    s_add_u32 m0, m0, 1056
    s_add_u32 s32, s32, 1024
    buffer_load_dwordx4 v2, s[4:7], s32 offen nt lds
    s_add_u32 m0, m0, 1056
    s_add_u32 s32, s32, 1024
    buffer_load_dwordx4 v2, s[4:7], s32 offen nt lds
    s_add_u32 m0, m0, 1056
    s_add_u32 s32, s32, 1024
    buffer_load_dwordx4 v2, s[4:7], s32 offen nt lds
    s_add_u32 m0, m0, 1056
    s_add_u32 s32, s32, 1024
    buffer_load_dwordx4 v2, s[4:7], s32 offen nt lds
    s_add_u32 s32, s32, 25600
    s_mov_b32 s33, s35
    s_add_u32 s35, s35, 33792
    s_cmp_eq_u32 s35, 135168
    s_cselect_b32 s35, 0, s35
    s_waitcnt lgkmcnt(6)
    v_mfma_f32_16x16x32_bf16 v[64:67], v[32:35], a[0:3], 0
    ds_read_b128 v[60:63], v24 offset:17088
    s_waitcnt lgkmcnt(6)
    v_mfma_f32_16x16x32_bf16 v[68:71], v[36:39], a[0:3], 0
    ds_read_b128 v[32:35], v24 offset:256
    s_waitcnt lgkmcnt(6)
    v_mfma_f32_16x16x32_bf16 v[64:67], v[40:43], a[4:7], v[64:67]
    ds_read_b128 v[36:39], v24 offset:17152
    s_waitcnt lgkmcnt(6)
    v_mfma_f32_16x16x32_bf16 v[68:71], v[44:47], a[4:7], v[68:71]
    ds_read_b128 v[40:43], v24 offset:320
    s_waitcnt lgkmcnt(6)
    v_mfma_f32_16x16x32_bf16 v[64:67], v[48:51], a[8:11], v[64:67]
    ds_read_b128 v[44:47], v24 offset:17216
    s_waitcnt lgkmcnt(6)
    v_mfma_f32_16x16x32_bf16 v[68:71], v[52:55], a[8:11], v[68:71]
    ds_read_b128 v[48:51], v24 offset:384
    s_waitcnt lgkmcnt(6)
    v_mfma_f32_16x16x32_bf16 v[64:67], v[56:59], a[12:15], v[64:67]
    ds_read_b128 v[52:55], v24 offset:17280
    s_waitcnt lgkmcnt(6)
    v_mfma_f32_16x16x32_bf16 v[68:71], v[60:63], a[12:15], v[68:71]
    ds_read_b128 v[56:59], v24 offset:448
    s_waitcnt lgkmcnt(6)
    v_mfma_f32_16x16x32_bf16 v[64:67], v[32:35], a[16:19], v[64:67]
    ds_read_b128 v[60:63], v24 offset:17344
    s_waitcnt lgkmcnt(6)
    v_mfma_f32_16x16x32_bf16 v[68:71], v[36:39], a[16:19], v[68:71]
    ds_read_b128 v[32:35], v24 offset:512
    s_waitcnt lgkmcnt(6)
    v_mfma_f32_16x16x32_bf16 v[64:67], v[40:43], a[20:23], v[64:67]
    ds_read_b128 v[36:39], v24 offset:17408
    s_waitcnt lgkmcnt(6)
    v_mfma_f32_16x16x32_bf16 v[68:71], v[44:47], a[20:23], v[68:71]
    ds_read_b128 v[40:43], v24 offset:576
    s_waitcnt lgkmcnt(6)
    v_mfma_f32_16x16x32_bf16 v[64:67], v[48:51], a[24:27], v[64:67]
    ds_read_b128 v[44:47], v24 offset:17472
    s_waitcnt lgkmcnt(6)
    v_mfma_f32_16x16x32_bf16 v[68:71], v[52:55], a[24:27], v[68:71]
    ds_read_b128 v[48:51], v24 offset:640
    s_waitcnt lgkmcnt(6)
    v_mfma_f32_16x16x32_bf16 v[64:67], v[56:59], a[28:31], v[64:67]
    ds_read_b128 v[52:55], v24 offset:17536
    s_waitcnt lgkmcnt(6)
    v_mfma_f32_16x16x32_bf16 v[68:71], v[60:63], a[28:31], v[68:71]
    ds_read_b128 v[56:59], v24 offset:704
    s_waitcnt lgkmcnt(6)
    v_mfma_f32_16x16x32_bf16 v[64:67], v[32:35], a[32:35], v[64:67]
    ds_read_b128 v[60:63], v24 offset:17600
    s_waitcnt lgkmcnt(6)
    v_mfma_f32_16x16x32_bf16 v[68:71], v[36:39], a[32:35], v[68:71]
    ds_read_b128 v[32:35], v24 offset:768
    s_waitcnt lgkmcnt(6)
    v_mfma_f32_16x16x32_bf16 v[64:67], v[40:43], a[36:39], v[64:67]
    ds_read_b128 v[36:39], v24 offset:17664
    s_waitcnt lgkmcnt(6)
    v_mfma_f32_16x16x32_bf16 v[68:71], v[44:47], a[36:39], v[68:71]
    ds_read_b128 v[40:43], v24 offset:832
    s_waitcnt lgkmcnt(6)
    v_mfma_f32_16x16x32_bf16 v[64:67], v[48:51], a[40:43], v[64:67]
    ds_read_b128 v[44:47], v24 offset:17728
    s_waitcnt lgkmcnt(6)
    v_mfma_f32_16x16x32_bf16 v[68:71], v[52:55], a[40:43], v[68:71]
    ds_read_b128 v[48:51], v24 offset:896
    s_waitcnt lgkmcnt(6)
    v_mfma_f32_16x16x32_bf16 v[64:67], v[56:59], a[44:47], v[64:67]
    ds_read_b128 v[52:55], v24 offset:17792
    s_waitcnt lgkmcnt(6)
    v_mfma_f32_16x16x32_bf16 v[68:71], v[60:63], a[44:47], v[68:71]
    ds_read_b128 v[56:59], v24 offset:960
    s_waitcnt lgkmcnt(6)
    v_mfma_f32_16x16x32_bf16 v[64:67], v[32:35], a[48:51], v[64:67]
    ds_read_b128 v[60:63], v24 offset:17856
    s_waitcnt lgkmcnt(6)
    v_mfma_f32_16x16x32_bf16 v[68:71], v[36:39], a[48:51], v[68:71]
    ds_read_b64_tr_b16 v[192:193], v25 offset:0
    s_waitcnt lgkmcnt(6)
    v_mfma_f32_16x16x32_bf16 v[64:67], v[40:43], a[52:55], v[64:67]
    ds_read_b64_tr_b16 v[194:195], v25 offset:16896
    s_waitcnt lgkmcnt(6)
    v_mfma_f32_16x16x32_bf16 v[68:71], v[44:47], a[52:55], v[68:71]
    ds_read_b64_tr_b16 v[196:197], v25 offset:32
    s_waitcnt lgkmcnt(6)
    v_mfma_f32_16x16x32_bf16 v[64:67], v[48:51], a[56:59], v[64:67]
    ds_read_b64_tr_b16 v[198:199], v25 offset:16928
    s_waitcnt lgkmcnt(6)
    v_mfma_f32_16x16x32_bf16 v[68:71], v[52:55], a[56:59], v[68:71]
    ds_read_b64_tr_b16 v[200:201], v25 offset:64
    s_waitcnt lgkmcnt(6)
    v_mfma_f32_16x16x32_bf16 v[64:67], v[56:59], a[60:63], v[64:67]
    ds_read_b64_tr_b16 v[202:203], v25 offset:16960
    s_waitcnt lgkmcnt(6)
    v_mfma_f32_16x16x32_bf16 v[68:71], v[60:63], a[60:63], v[68:71]
    ds_read_b64_tr_b16 v[204:205], v25 offset:96
    ds_read_b64_tr_b16 v[206:207], v25 offset:16992
    ds_read_b64_tr_b16 v[208:209], v25 offset:128
    ds_read_b64_tr_b16 v[210:211], v25 offset:17024
    ds_read_b64_tr_b16 v[212:213], v25 offset:160
    ds_read_b64_tr_b16 v[214:215], v25 offset:17056
    ds_read_b64_tr_b16 v[216:217], v25 offset:192
    ds_read_b64_tr_b16 v[218:219], v25 offset:17088
    v_max3_f32 v3, v64, v65, v22
    v_max3_f32 v3, v3, v66, v67
    v_max3_f32 v3, v3, v68, v69
    v_max3_f32 v3, v3, v70, v71
    v_mov_b32 v4, v3
    ds_read_b64_tr_b16 v[220:221], v25 offset:224
    s_nop 0
    v_permlane32_swap_b32 v3, v4
    ds_read_b64_tr_b16 v[222:223], v25 offset:17120
    v_max_f32 v3, v3, v4
    ds_read_b64_tr_b16 v[224:225], v25 offset:256
    v_mov_b32 v4, v3
    ds_read_b64_tr_b16 v[226:227], v25 offset:17152
    s_nop 0
    v_permlane16_swap_b32 v3, v4
    ds_read_b64_tr_b16 v[228:229], v25 offset:288
    v_max_f32 v3, v3, v4
    ds_read_b64_tr_b16 v[230:231], v25 offset:17184
    v_sub_f32 v4, v22, v3
    ds_read_b64_tr_b16 v[232:233], v25 offset:320
    v_exp_f32 v4, v4
    ds_read_b64_tr_b16 v[234:235], v25 offset:17216
    v_mov_b32 v22, v3
    ds_read_b64_tr_b16 v[236:237], v25 offset:352
    v_sub_f32 v64, v64, v3
    ds_read_b64_tr_b16 v[238:239], v25 offset:17248
    v_sub_f32 v65, v65, v3
    ds_read_b64_tr_b16 v[240:241], v25 offset:384
    v_sub_f32 v66, v66, v3
    ds_read_b64_tr_b16 v[242:243], v25 offset:17280
    v_sub_f32 v67, v67, v3
    ds_read_b64_tr_b16 v[244:245], v25 offset:416
    v_sub_f32 v68, v68, v3
    ds_read_b64_tr_b16 v[246:247], v25 offset:17312
    v_sub_f32 v69, v69, v3
    ds_read_b64_tr_b16 v[248:249], v25 offset:448
    v_sub_f32 v70, v70, v3
    ds_read_b64_tr_b16 v[250:251], v25 offset:17344
    v_sub_f32 v71, v71, v3
    ds_read_b64_tr_b16 v[252:253], v25 offset:480
    v_exp_f32 v64, v64
    ds_read_b64_tr_b16 v[254:255], v25 offset:17376
    v_exp_f32 v65, v65
    v_exp_f32 v66, v66
    v_exp_f32 v67, v67
    v_exp_f32 v68, v68
    v_exp_f32 v69, v69
    v_exp_f32 v70, v70
    v_exp_f32 v71, v71
    v_cvt_pk_bf16_f32 v72, v64, v65
    v_cvt_pk_bf16_f32 v73, v66, v67
    v_cvt_pk_bf16_f32 v74, v68, v69
    v_cvt_pk_bf16_f32 v75, v70, v71
    v_pk_mul_f32 v[128:129], v[128:129], v[4:5] op_sel_hi:[1,0]
    v_pk_mul_f32 v[130:131], v[130:131], v[4:5] op_sel_hi:[1,0]
    v_pk_mul_f32 v[132:133], v[132:133], v[4:5] op_sel_hi:[1,0]
    v_pk_mul_f32 v[134:135], v[134:135], v[4:5] op_sel_hi:[1,0]
    s_waitcnt lgkmcnt(0)
    v_mfma_f32_16x16x32_bf16 v[128:131], v[192:195], v[72:75], v[128:131]
    v_pk_mul_f32 v[136:137], v[136:137], v[4:5] op_sel_hi:[1,0]
    v_pk_mul_f32 v[138:139], v[138:139], v[4:5] op_sel_hi:[1,0]
    v_mfma_f32_16x16x32_bf16 v[132:135], v[196:199], v[72:75], v[132:135]
    v_pk_mul_f32 v[140:141], v[140:141], v[4:5] op_sel_hi:[1,0]
    v_pk_mul_f32 v[142:143], v[142:143], v[4:5] op_sel_hi:[1,0]
    v_mfma_f32_16x16x32_bf16 v[136:139], v[200:203], v[72:75], v[136:139]
    v_pk_mul_f32 v[144:145], v[144:145], v[4:5] op_sel_hi:[1,0]
    v_pk_mul_f32 v[146:147], v[146:147], v[4:5] op_sel_hi:[1,0]
    v_mfma_f32_16x16x32_bf16 v[140:143], v[204:207], v[72:75], v[140:143]
    v_pk_mul_f32 v[148:149], v[148:149], v[4:5] op_sel_hi:[1,0]
    v_pk_mul_f32 v[150:151], v[150:151], v[4:5] op_sel_hi:[1,0]
    v_mfma_f32_16x16x32_bf16 v[144:147], v[208:211], v[72:75], v[144:147]
    v_pk_mul_f32 v[152:153], v[152:153], v[4:5] op_sel_hi:[1,0]
    v_pk_mul_f32 v[154:155], v[154:155], v[4:5] op_sel_hi:[1,0]
    v_mfma_f32_16x16x32_bf16 v[148:151], v[212:215], v[72:75], v[148:151]
    v_pk_mul_f32 v[156:157], v[156:157], v[4:5] op_sel_hi:[1,0]
    v_pk_mul_f32 v[158:159], v[158:159], v[4:5] op_sel_hi:[1,0]
    v_mfma_f32_16x16x32_bf16 v[152:155], v[216:219], v[72:75], v[152:155]
    v_pk_mul_f32 v[160:161], v[160:161], v[4:5] op_sel_hi:[1,0]
    v_pk_mul_f32 v[162:163], v[162:163], v[4:5] op_sel_hi:[1,0]
    v_mfma_f32_16x16x32_bf16 v[156:159], v[220:223], v[72:75], v[156:159]
    v_pk_mul_f32 v[164:165], v[164:165], v[4:5] op_sel_hi:[1,0]
    v_pk_mul_f32 v[166:167], v[166:167], v[4:5] op_sel_hi:[1,0]
    v_mfma_f32_16x16x32_bf16 v[160:163], v[224:227], v[72:75], v[160:163]
    v_pk_mul_f32 v[168:169], v[168:169], v[4:5] op_sel_hi:[1,0]
    v_pk_mul_f32 v[170:171], v[170:171], v[4:5] op_sel_hi:[1,0]
    v_mfma_f32_16x16x32_bf16 v[164:167], v[228:231], v[72:75], v[164:167]
    v_pk_mul_f32 v[172:173], v[172:173], v[4:5] op_sel_hi:[1,0]
    v_pk_mul_f32 v[174:175], v[174:175], v[4:5] op_sel_hi:[1,0]
    v_mfma_f32_16x16x32_bf16 v[168:171], v[232:235], v[72:75], v[168:171]
    v_pk_mul_f32 v[176:177], v[176:177], v[4:5] op_sel_hi:[1,0]
    v_pk_mul_f32 v[178:179], v[178:179], v[4:5] op_sel_hi:[1,0]
    v_mfma_f32_16x16x32_bf16 v[172:175], v[236:239], v[72:75], v[172:175]
    v_pk_mul_f32 v[180:181], v[180:181], v[4:5] op_sel_hi:[1,0]
    v_pk_mul_f32 v[182:183], v[182:183], v[4:5] op_sel_hi:[1,0]
    v_mfma_f32_16x16x32_bf16 v[176:179], v[240:243], v[72:75], v[176:179]
    v_pk_mul_f32 v[184:185], v[184:185], v[4:5] op_sel_hi:[1,0]
    v_pk_mul_f32 v[186:187], v[186:187], v[4:5] op_sel_hi:[1,0]
    v_mfma_f32_16x16x32_bf16 v[180:183], v[244:247], v[72:75], v[180:183]
    v_pk_mul_f32 v[188:189], v[188:189], v[4:5] op_sel_hi:[1,0]
    v_pk_mul_f32 v[190:191], v[190:191], v[4:5] op_sel_hi:[1,0]
    v_mfma_f32_16x16x32_bf16 v[184:187], v[248:251], v[72:75], v[184:187]
    s_nop 0
    v_mfma_f32_16x16x32_bf16 v[188:191], v[252:255], v[72:75], v[188:191]
    v_fma_f32 v23, v23, v4, v64
    v_add_f32 v23, v23, v65
    v_add_f32 v23, v23, v66
    v_add_f32 v23, v23, v67
    v_add_f32 v23, v23, v68
    v_add_f32 v23, v23, v69
    v_add_f32 v23, v23, v70
    v_add_f32 v23, v23, v71
    s_add_u32 s27, s27, 1
    s_cmp_lt_u32 s27, 16
    s_cbranch_scc1 L_CT
    s_waitcnt vmcnt(0)
    s_barrier
    v_mov_b32 v4, v23
    s_nop 1
    v_permlane32_swap_b32 v23, v4
    v_add_f32 v23, v23, v4
    v_mov_b32 v4, v23
    s_nop 1
    v_permlane16_swap_b32 v23, v4
    v_add_f32 v23, v23, v4
    v_and_b32 v3, 15, v0
    v_lshlrev_b32 v5, 8, v3
    s_lshl_b32 s24, s72, 3
    s_lshl_b32 s25, s28, 12
    s_add_u32 s24, s24, s25
    s_add_u32 s24, s24, 0x120000
    s_cmp_lg_u32 s29, 0
    s_cbranch_scc1 L_C_ml
    s_mov_b64 exec, 0xffff
    buffer_store_dwordx2 v[22:23], v5, s[12:15], s24 offen sc1
    s_mov_b64 exec, -1
L_C_ml:
    v_lshrrev_b32 v4, 4, v0
    v_mul_u32_u24 v3, 528, v3
    v_lshl_add_u32 v3, v4, 3, v3
    s_mul_i32 s24, s3, 8448
    v_add_u32 v3, s24, v3
    v_cvt_pk_bf16_f32 v32, v128, v129
    v_cvt_pk_bf16_f32 v33, v130, v131
    ds_write_b64 v3, v[32:33] offset:0
    v_cvt_pk_bf16_f32 v34, v132, v133
    v_cvt_pk_bf16_f32 v35, v134, v135
    ds_write_b64 v3, v[34:35] offset:32
    v_cvt_pk_bf16_f32 v36, v136, v137
    v_cvt_pk_bf16_f32 v37, v138, v139
    ds_write_b64 v3, v[36:37] offset:64
    v_cvt_pk_bf16_f32 v38, v140, v141
    v_cvt_pk_bf16_f32 v39, v142, v143
    ds_write_b64 v3, v[38:39] offset:96
    v_cvt_pk_bf16_f32 v40, v144, v145
    v_cvt_pk_bf16_f32 v41, v146, v147
    ds_write_b64 v3, v[40:41] offset:128
    v_cvt_pk_bf16_f32 v42, v148, v149
    v_cvt_pk_bf16_f32 v43, v150, v151
    ds_write_b64 v3, v[42:43] offset:160
    v_cvt_pk_bf16_f32 v44, v152, v153
    v_cvt_pk_bf16_f32 v45, v154, v155
    ds_write_b64 v3, v[44:45] offset:192
    v_cvt_pk_bf16_f32 v46, v156, v157
    v_cvt_pk_bf16_f32 v47, v158, v159
    ds_write_b64 v3, v[46:47] offset:224
    v_cvt_pk_bf16_f32 v32, v160, v161
    v_cvt_pk_bf16_f32 v33, v162, v163
    ds_write_b64 v3, v[32:33] offset:256
    v_cvt_pk_bf16_f32 v34, v164, v165
    v_cvt_pk_bf16_f32 v35, v166, v167
    ds_write_b64 v3, v[34:35] offset:288
    v_cvt_pk_bf16_f32 v36, v168, v169
    v_cvt_pk_bf16_f32 v37, v170, v171
    ds_write_b64 v3, v[36:37] offset:320
    v_cvt_pk_bf16_f32 v38, v172, v173
    v_cvt_pk_bf16_f32 v39, v174, v175
    ds_write_b64 v3, v[38:39] offset:352
    v_cvt_pk_bf16_f32 v40, v176, v177
    v_cvt_pk_bf16_f32 v41, v178, v179
    ds_write_b64 v3, v[40:41] offset:384
    v_cvt_pk_bf16_f32 v42, v180, v181
    v_cvt_pk_bf16_f32 v43, v182, v183
    ds_write_b64 v3, v[42:43] offset:416
    v_cvt_pk_bf16_f32 v44, v184, v185
    v_cvt_pk_bf16_f32 v45, v186, v187
    ds_write_b64 v3, v[44:45] offset:448
    v_cvt_pk_bf16_f32 v46, v188, v189
    v_cvt_pk_bf16_f32 v47, v190, v191
    ds_write_b64 v3, v[46:47] offset:480
    v_lshrrev_b32 v4, 5, v0
    v_and_b32 v5, 31, v0
    v_mul_u32_u24 v3, 528, v4
    v_lshl_add_u32 v3, v5, 4, v3
    v_add_u32 v3, s24, v3
    v_lshlrev_b32 v4, 15, v4
    v_lshl_add_u32 v4, v5, 4, v4
    s_waitcnt lgkmcnt(0)
    ds_read_b128 v[64:67], v3 offset:0
    ds_read_b128 v[68:71], v3 offset:1056
    ds_read_b128 v[72:75], v3 offset:2112
    ds_read_b128 v[76:79], v3 offset:3168
    ds_read_b128 v[80:83], v3 offset:4224
    ds_read_b128 v[84:87], v3 offset:5280
    ds_read_b128 v[88:91], v3 offset:6336
    ds_read_b128 v[92:95], v3 offset:7392
    s_lshl_b32 s24, s72, 10
    s_lshl_b32 s25, s29, 9
    s_add_u32 s24, s24, s25
    s_lshl_b32 s25, s28, 19
    s_add_u32 s24, s24, s25
    s_add_u32 s24, s24, 0x20000
    s_waitcnt lgkmcnt(7)
    buffer_store_dwordx4 v[64:67], v4, s[12:15], s24 offen sc1
    s_add_u32 s24, s24, 0x10000
    s_waitcnt lgkmcnt(6)
    buffer_store_dwordx4 v[68:71], v4, s[12:15], s24 offen sc1
    s_add_u32 s24, s24, 0x10000
    s_waitcnt lgkmcnt(5)
    buffer_store_dwordx4 v[72:75], v4, s[12:15], s24 offen sc1
    s_add_u32 s24, s24, 0x10000
    s_waitcnt lgkmcnt(4)
    buffer_store_dwordx4 v[76:79], v4, s[12:15], s24 offen sc1
    s_add_u32 s24, s24, 0x10000
    s_waitcnt lgkmcnt(3)
    buffer_store_dwordx4 v[80:83], v4, s[12:15], s24 offen sc1
    s_add_u32 s24, s24, 0x10000
    s_waitcnt lgkmcnt(2)
    buffer_store_dwordx4 v[84:87], v4, s[12:15], s24 offen sc1
    s_add_u32 s24, s24, 0x10000
    s_waitcnt lgkmcnt(1)
    buffer_store_dwordx4 v[88:91], v4, s[12:15], s24 offen sc1
    s_add_u32 s24, s24, 0x10000
    s_waitcnt lgkmcnt(0)
    buffer_store_dwordx4 v[92:95], v4, s[12:15], s24 offen sc1
    s_add_u32 s24, s24, 0x10000
    s_waitcnt vmcnt(0)
    s_barrier
    s_cmp_lg_u32 s3, 0
    s_cbranch_scc1 L_sig23
    s_mov_b64 exec, 1
    v_mov_b32 v3, 1
    buffer_atomic_add v3, off, s[16:19], 0 offset:4 sc0
    s_waitcnt vmcnt(0)
    v_readfirstlane_b32 s24, v3
    s_mov_b64 exec, -1
    s_cmp_lg_u32 s24, 31
    s_cbranch_scc1 L_sig23
    v_lshlrev_b32 v4, 7, v0
    v_mov_b32 v3, 1
    s_mov_b32 s24, 0x170000
    buffer_store_dword v3, v4, s[12:15], s24 offen offset:4 sc1
L_sig23:
    s_branch L_R
L_last:
    s_endpgm
.section .rodata,"a"
.p2align 6
.amdhsa_kernel concat_heads__compressed_kv_cla__mha_block_cached__decode_kernel
  .amdhsa_next_free_vgpr 512
  .amdhsa_next_free_sgpr 102
  .amdhsa_accum_offset 256
  .amdhsa_group_segment_fixed_size 0
  .amdhsa_kernarg_size 112
  .amdhsa_user_sgpr_count 2
  .amdhsa_user_sgpr_kernarg_segment_ptr 1
  .amdhsa_system_sgpr_workgroup_id_x 1
  .amdhsa_float_denorm_mode_32 3
.end_amdhsa_kernel
```

```asm
; @launch grid=(256,1,1) block=(256,1,1) lds=149504
.amdgcn_target "amdgcn-amd-amdhsa--gfx950"
.text
.globl concat_heads__compressed_kv_cla__mha_block_cached__decode_kernel
.p2align 8
.type concat_heads__compressed_kv_cla__mha_block_cached__decode_kernel,@function
concat_heads__compressed_kv_cla__mha_block_cached__decode_kernel:
    s_load_dwordx16 s[36:51], s[0:1], 0
    s_load_dwordx8 s[52:59], s[0:1], 64
    s_load_dwordx4 s[60:63], s[0:1], 96
    s_cmp_ge_u32 s2, 256
    s_cbranch_scc1 L_end
    v_lshrrev_b32 v1, 6, v0
    v_and_b32 v0, 63, v0
    v_readfirstlane_b32 s3, v1
    v_lshlrev_b32 v2, 4, v0
    s_cmp_lt_u32 s2, 64
    s_cbranch_scc1 L_A
L_B:
    s_getpc_b64 s[20:21]
L_pc1:
    s_sub_u32 s20, s20, L_pc1-L_B
    s_subb_u32 s21, s21, 0
    s_mov_b32 s22, L_A-L_B
    s_mov_b32 s23, 0x20000
    v_lshl_add_u32 v3, v0, 2, s3
    v_lshlrev_b32 v3, 7, v3
    buffer_load_dword v17, v3, s[20:23], 0 offen
    s_sub_u32 s24, s2, 64
    s_and_b32 s25, s24, 7
    s_lshr_b32 s24, s24, 3
    s_mul_i32 s26, s24, 43
    s_lshr_b32 s26, s26, 8
    s_mul_i32 s27, s26, 6
    s_sub_u32 s27, s24, s27
    s_lshl_b32 s74, s24, 2
    s_add_u32 s74, s74, s3
    s_mov_b32 s70, 0x5040100
    s_mov_b32 s71, 0xd0c0908
    s_lshl_b32 s25, s25, 3
    s_lshr_b64 s[70:71], s[70:71], s25
    s_lshl_b32 s26, s26, 3
    s_lshr_b32 s26, 0x12100200, s26
    s_or_b32 s26, s26, s70
    s_and_b32 s26, s26, 31
    v_lshrrev_b32 v3, 4, v0
    v_lshlrev_b32 v4, 3, v3
    v_mov_b32 v6, 0x12100200
    v_lshrrev_b32 v4, v4, v6
    v_or_b32 v4, s70, v4
    v_and_b32 v4, 31, v4
    v_and_b32 v6, 0xf0, v2
    v_lshl_add_u32 v24, v4, 8, v6
    v_lshl_add_u32 v25, v4, 17, v6
    s_and_b32 s25, s2, 7
    s_lshl_b32 s25, s25, 10
    v_add_u32 v26, s25, v2
    s_cmp_ge_u32 s27, 3
    s_cselect_b32 s28, 1, 0
    s_mul_i32 s29, s28, 3
    s_sub_u32 s29, s27, s29
    s_lshr_b32 s72, s3, 1
    s_lshl_b32 s24, s28, 1
    s_add_u32 s72, s72, s24
    s_and_b32 s31, s3, 1
    s_lshl_b32 s24, s29, 1
    s_add_u32 s31, s31, s24
    s_lshl_b32 s30, s72, 5
    s_add_u32 s30, s30, s26
    s_lshl_b32 s30, s30, 20
    v_lshrrev_b32 v3, 4, v0
    v_and_b32 v4, 3, v0
    v_lshlrev_b32 v5, 6, v3
    v_lshl_add_u32 v5, v4, 4, v5
    v_bfe_u32 v1, v0, 2, 2
    v_lshl_add_u32 v1, v1, 8, v5
    s_mul_i32 s35, s31, 1024
    s_mov_b32 s32, s35
    s_mov_b32 s6, 0x100000
    s_mov_b32 s7, 0x20000
    s_waitcnt lgkmcnt(0)
    s_add_u32 s4, s50, s30
    s_addc_u32 s5, s51, 0
    s_mov_b32 s8, s54
    s_mov_b32 s9, s55
    s_mov_b32 s10, 0x400000
    s_mov_b32 s11, 0x20000
L_pfb:
    s_lshl_b32 s24, s74, 13
    s_waitcnt vmcnt(6)
    buffer_load_dwordx4 v[28:31], v24, s[8:11], s24 offen
    s_add_u32 s74, s74, 96
    s_cmp_lt_u32 s74, 512
    s_cbranch_scc1 L_pfb
    s_sub_u32 s74, s74, 512
    s_mov_b32 s8, s40
    s_mov_b32 s9, s41
    s_mov_b32 s10, 0x400000
    s_mov_b32 s11, 0x20000
L_pfq:
    s_lshl_b32 s24, s74, 13
    s_waitcnt vmcnt(6)
    buffer_load_dwordx4 v[28:31], v24, s[8:11], s24 offen
    s_add_u32 s74, s74, 96
    s_cmp_lt_u32 s74, 512
    s_cbranch_scc1 L_pfq
    s_sub_u32 s74, s74, 512
    s_mov_b32 s8, s42
    s_mov_b32 s9, s43
    s_mov_b32 s10, 0x400000
    s_mov_b32 s11, 0x20000
L_pfk:
    s_lshl_b32 s24, s74, 13
    s_waitcnt vmcnt(6)
    buffer_load_dwordx4 v[28:31], v24, s[8:11], s24 offen
    s_add_u32 s74, s74, 96
    s_cmp_lt_u32 s74, 512
    s_cbranch_scc1 L_pfk
    s_sub_u32 s74, s74, 512
    s_mov_b32 s8, s56
    s_mov_b32 s9, s57
    s_mov_b32 s10, 0x400000
    s_mov_b32 s11, 0x20000
L_pfo:
    s_lshl_b32 s24, s74, 8
    s_waitcnt vmcnt(6)
    buffer_load_dwordx4 v[28:31], v25, s[8:11], s24 offen
    s_add_u32 s74, s74, 96
    s_cmp_lt_u32 s74, 512
    s_cbranch_scc1 L_pfo
    s_sub_u32 s74, s74, 512
    s_mov_b32 s8, s46
    s_mov_b32 s9, s47
    s_mov_b32 s10, 0x400000
    s_mov_b32 s11, 0x20000
L_pfv:
    s_lshl_b32 s24, s74, 8
    s_waitcnt vmcnt(6)
    buffer_load_dwordx4 v[28:31], v25, s[8:11], s24 offen
    s_add_u32 s74, s74, 96
    s_cmp_lt_u32 s74, 512
    s_cbranch_scc1 L_pfv
    s_sub_u32 s74, s74, 512
    s_mov_b32 s8, s44
    s_mov_b32 s9, s45
    s_mov_b32 s10, 0x400000
    s_mov_b32 s11, 0x20000
L_pfu:
    s_lshl_b32 s24, s74, 13
    s_waitcnt vmcnt(6)
    buffer_load_dwordx4 v[28:31], v24, s[8:11], s24 offen
    s_add_u32 s74, s74, 96
    s_cmp_lt_u32 s74, 512
    s_cbranch_scc1 L_pfu
    s_sub_u32 s74, s74, 512
    s_mov_b32 s8, s38
    s_mov_b32 s9, s39
    s_mov_b32 s10, 0x1000000
    s_mov_b32 s11, 0x20000
L_pfc:
    s_lshl_b32 s24, s74, 13
    s_waitcnt vmcnt(6)
    buffer_load_dwordx4 v[28:31], v26, s[8:11], s24 offen
    s_add_u32 s74, s74, 96
    s_cmp_lt_u32 s74, 2048
    s_cbranch_scc1 L_pfc
    s_sub_u32 s74, s74, 2048
    s_waitcnt vmcnt(15)
    buffer_load_dwordx4 a[0:3], v1, s[4:7], s32 offen offset:0 nt
    s_add_u32 s32, s32, 6144
    s_waitcnt vmcnt(15)
    buffer_load_dwordx4 a[4:7], v1, s[4:7], s32 offen offset:0 nt
    s_add_u32 s32, s32, 6144
    s_waitcnt vmcnt(15)
    buffer_load_dwordx4 a[8:11], v1, s[4:7], s32 offen offset:0 nt
    s_add_u32 s32, s32, 6144
    s_waitcnt vmcnt(15)
    buffer_load_dwordx4 a[12:15], v1, s[4:7], s32 offen offset:0 nt
    s_add_u32 s32, s32, 6144
    s_waitcnt vmcnt(15)
    buffer_load_dwordx4 a[16:19], v1, s[4:7], s32 offen offset:0 nt
    s_add_u32 s32, s32, 6144
    s_waitcnt vmcnt(15)
    buffer_load_dwordx4 a[20:23], v1, s[4:7], s32 offen offset:0 nt
    s_add_u32 s32, s32, 6144
    s_waitcnt vmcnt(15)
    buffer_load_dwordx4 a[24:27], v1, s[4:7], s32 offen offset:0 nt
    s_add_u32 s32, s32, 6144
    s_waitcnt vmcnt(15)
    buffer_load_dwordx4 a[28:31], v1, s[4:7], s32 offen offset:0 nt
    s_add_u32 s32, s32, 6144
    s_waitcnt vmcnt(15)
    buffer_load_dwordx4 a[32:35], v1, s[4:7], s32 offen offset:0 nt
    s_add_u32 s32, s32, 6144
    s_waitcnt vmcnt(15)
    buffer_load_dwordx4 a[36:39], v1, s[4:7], s32 offen offset:0 nt
    s_add_u32 s32, s32, 6144
    s_waitcnt vmcnt(15)
    buffer_load_dwordx4 a[40:43], v1, s[4:7], s32 offen offset:0 nt
    s_add_u32 s32, s32, 6144
    s_waitcnt vmcnt(15)
    buffer_load_dwordx4 a[44:47], v1, s[4:7], s32 offen offset:0 nt
    s_add_u32 s32, s32, 6144
    s_waitcnt vmcnt(15)
    buffer_load_dwordx4 a[48:51], v1, s[4:7], s32 offen offset:0 nt
    s_add_u32 s32, s32, 6144
    s_waitcnt vmcnt(15)
    buffer_load_dwordx4 a[52:55], v1, s[4:7], s32 offen offset:0 nt
    s_add_u32 s32, s32, 6144
    s_waitcnt vmcnt(15)
    buffer_load_dwordx4 a[56:59], v1, s[4:7], s32 offen offset:0 nt
    s_add_u32 s32, s32, 6144
    s_waitcnt vmcnt(15)
    buffer_load_dwordx4 a[60:63], v1, s[4:7], s32 offen offset:0 nt
    s_add_u32 s32, s32, 6144
    s_mov_b32 s12, s62
    s_mov_b32 s13, s63
    s_mov_b32 s14, 0x400000
    s_mov_b32 s15, 0x20000
    s_mov_b32 s16, s60
    s_mov_b32 s17, s61
    s_mov_b32 s18, 0x100
    s_mov_b32 s19, 0x20000
    v_and_b32 v3, 1, v0
    v_lshlrev_b32 v3, 4, v3
    v_mov_b32 v4, 0xffff
    v_lshlrev_b32 v4, v3, v4
    v_bfe_u32 v3, v0, 1, 2
    v_cmp_eq_u32 vcc, 0, v3
    s_nop 1
    v_cndmask_b32 v20, 0, v4, vcc
    v_cmp_eq_u32 vcc, 1, v3
    s_nop 1
    v_cndmask_b32 v21, 0, v4, vcc
    v_cmp_eq_u32 vcc, 2, v3
    s_nop 1
    v_cndmask_b32 v22, 0, v4, vcc
    v_cmp_eq_u32 vcc, 3, v3
    s_nop 1
    v_cndmask_b32 v23, 0, v4, vcc
    s_mov_b32 s64, 0x22222222
    s_mov_b32 s65, 0x22222222
    s_mov_b32 s66, 0x44444444
    s_mov_b32 s67, 0x44444444
    s_mov_b32 s68, 0x88888888
    s_mov_b32 s69, 0x88888888
    v_mov_b32 v32, 0
    v_mov_b32 v33, 0
    v_mov_b32 v34, 0
    v_mov_b32 v35, 0
    v_mov_b32 v36, 0
    v_mov_b32 v37, 0
    v_mov_b32 v38, 0
    v_mov_b32 v39, 0
    v_mov_b32 v40, 0
    v_mov_b32 v41, 0
    v_mov_b32 v42, 0
    v_mov_b32 v43, 0
    v_mov_b32 v44, 0
    v_mov_b32 v45, 0
    v_mov_b32 v46, 0
    v_mov_b32 v47, 0
    s_lshl_b32 s33, s26, 2
    s_add_u32 s33, s33, s72
    s_lshl_b32 s34, s33, 8
    s_add_u32 s34, s34, 0x164000
    s_mov_b64 exec, 1
    buffer_load_dword v61, off, s[16:19], 0 offset:128 sc1
    s_mov_b64 exec, -1
    s_waitcnt vmcnt(15)
    buffer_load_dwordx4 v[64:67], v1, s[4:7], s32 offen offset:0 nt
    s_add_u32 s32, s32, 6144
    s_waitcnt vmcnt(15)
    buffer_load_dwordx4 v[68:71], v1, s[4:7], s32 offen offset:0 nt
    s_add_u32 s32, s32, 6144
    s_waitcnt vmcnt(15)
    buffer_load_dwordx4 v[72:75], v1, s[4:7], s32 offen offset:0 nt
    s_add_u32 s32, s32, 6144
    s_waitcnt vmcnt(15)
    buffer_load_dwordx4 v[76:79], v1, s[4:7], s32 offen offset:0 nt
    s_add_u32 s32, s32, 6144
    s_waitcnt vmcnt(15)
    buffer_load_dwordx4 v[80:83], v1, s[4:7], s32 offen offset:0 nt
    s_add_u32 s32, s32, 6144
    s_waitcnt vmcnt(15)
    buffer_load_dwordx4 v[84:87], v1, s[4:7], s32 offen offset:0 nt
    s_add_u32 s32, s32, 6144
    s_waitcnt vmcnt(15)
    buffer_load_dwordx4 v[88:91], v1, s[4:7], s32 offen offset:0 nt
    s_add_u32 s32, s32, 6144
    s_waitcnt vmcnt(15)
    buffer_load_dwordx4 v[92:95], v1, s[4:7], s32 offen offset:0 nt
    s_add_u32 s32, s32, 6144
    s_waitcnt vmcnt(8)
    v_readfirstlane_b32 s25, v61
    s_nop 0
    s_cmp_ge_u32 s25, 32
    s_cbranch_scc1 L_B_q
    s_mov_b32 s24, 262144
    s_mov_b64 exec, 1
L_aw2:
    buffer_load_dword v61, off, s[16:19], 0 offset:128 sc1
    s_waitcnt vmcnt(0)
    v_readfirstlane_b32 s25, v61
    s_nop 0
    s_cmp_ge_u32 s25, 32
    s_cbranch_scc1 L_B_q
    s_sleep 16
    s_sub_u32 s24, s24, 1
    s_cmp_lg_u32 s24, 0
    s_cbranch_scc1 L_aw2
L_B_q:
    s_mov_b64 exec, -1
    buffer_load_dwordx4 v[8:11], v5, s[12:15], s34 offen sc1
    s_waitcnt vmcnt(15)
    buffer_load_dwordx4 v[96:99], v1, s[4:7], s32 offen offset:0 nt
    s_add_u32 s32, s32, 6144
    s_waitcnt vmcnt(15)
    buffer_load_dwordx4 v[100:103], v1, s[4:7], s32 offen offset:0 nt
    s_add_u32 s32, s32, 6144
    s_waitcnt vmcnt(15)
    buffer_load_dwordx4 v[104:107], v1, s[4:7], s32 offen offset:0 nt
    s_add_u32 s32, s32, 6144
    s_waitcnt vmcnt(15)
    buffer_load_dwordx4 v[108:111], v1, s[4:7], s32 offen offset:0 nt
    s_add_u32 s32, s32, 6144
    s_waitcnt vmcnt(15)
    buffer_load_dwordx4 v[112:115], v1, s[4:7], s32 offen offset:0 nt
    s_add_u32 s32, s32, 6144
    s_waitcnt vmcnt(15)
    buffer_load_dwordx4 v[116:119], v1, s[4:7], s32 offen offset:0 nt
    s_add_u32 s32, s32, 6144
    s_waitcnt vmcnt(15)
    buffer_load_dwordx4 v[120:123], v1, s[4:7], s32 offen offset:0 nt
    s_add_u32 s32, s32, 6144
    s_waitcnt vmcnt(15)
    buffer_load_dwordx4 v[124:127], v1, s[4:7], s32 offen offset:0 nt
    s_add_u32 s32, s32, 6144
    s_waitcnt vmcnt(8)
    v_mov_b32_dpp v32, v8 quad_perm:[0,1,2,3] row_mask:0xf bank_mask:0x1
    v_mov_b32_dpp v33, v9 quad_perm:[0,1,2,3] row_mask:0xf bank_mask:0x1
    v_mov_b32_dpp v34, v10 quad_perm:[0,1,2,3] row_mask:0xf bank_mask:0x1
    v_mov_b32_dpp v35, v11 quad_perm:[0,1,2,3] row_mask:0xf bank_mask:0x1
    v_mov_b32_dpp v36, v8 quad_perm:[0,1,2,3] row_mask:0xf bank_mask:0x2
    v_mov_b32_dpp v37, v9 quad_perm:[0,1,2,3] row_mask:0xf bank_mask:0x2
    v_mov_b32_dpp v38, v10 quad_perm:[0,1,2,3] row_mask:0xf bank_mask:0x2
    v_mov_b32_dpp v39, v11 quad_perm:[0,1,2,3] row_mask:0xf bank_mask:0x2
    v_mov_b32_dpp v40, v8 quad_perm:[0,1,2,3] row_mask:0xf bank_mask:0x4
    v_mov_b32_dpp v41, v9 quad_perm:[0,1,2,3] row_mask:0xf bank_mask:0x4
    v_mov_b32_dpp v42, v10 quad_perm:[0,1,2,3] row_mask:0xf bank_mask:0x4
    v_mov_b32_dpp v43, v11 quad_perm:[0,1,2,3] row_mask:0xf bank_mask:0x4
    v_mov_b32_dpp v44, v8 quad_perm:[0,1,2,3] row_mask:0xf bank_mask:0x8
    v_mov_b32_dpp v45, v9 quad_perm:[0,1,2,3] row_mask:0xf bank_mask:0x8
    v_mov_b32_dpp v46, v10 quad_perm:[0,1,2,3] row_mask:0xf bank_mask:0x8
    v_mov_b32_dpp v47, v11 quad_perm:[0,1,2,3] row_mask:0xf bank_mask:0x8
    s_mov_b32 s27, 1
L_BK:
    s_cmp_lg_u32 s27, 10
    s_cbranch_scc1 L_BK_a
    s_add_u32 s4, s52, s30
    s_addc_u32 s5, s53, 0
    s_mov_b32 s32, s35
    v_mov_b32 v1, v2
L_BK_a:
    s_barrier
    v_mov_b32 v49, v50
    v_mov_b32 v50, v51
    v_mov_b32 v51, v52
    v_mov_b32 v52, v53
    v_mov_b32 v53, v54
    v_mov_b32 v54, v55
    v_mov_b32 v55, v56
    v_mov_b32 v56, v57
    v_mov_b32 v57, v58
    s_waitcnt vmcnt(15)
    v_mfma_f32_16x16x32_bf16 v[12:15], v[64:67], v[32:35], 0
    buffer_load_dwordx4 v[64:67], v1, s[4:7], s32 offen offset:0 nt
    s_add_u32 s32, s32, 6144
    s_waitcnt vmcnt(15)
    v_mfma_f32_16x16x32_bf16 v[12:15], v[68:71], v[36:39], v[12:15]
    buffer_load_dwordx4 v[68:71], v1, s[4:7], s32 offen offset:0 nt
    s_add_u32 s32, s32, 6144
    s_waitcnt vmcnt(15)
    v_mfma_f32_16x16x32_bf16 v[12:15], v[72:75], v[40:43], v[12:15]
    buffer_load_dwordx4 v[72:75], v1, s[4:7], s32 offen offset:0 nt
    s_add_u32 s32, s32, 6144
    s_waitcnt vmcnt(15)
    v_mfma_f32_16x16x32_bf16 v[12:15], v[76:79], v[44:47], v[12:15]
    buffer_load_dwordx4 v[76:79], v1, s[4:7], s32 offen offset:0 nt
    s_add_u32 s32, s32, 6144
    s_nop 5
    v_add_f32_dpp v58, v13, v12 quad_perm:[1,1,1,1] row_mask:0xf bank_mask:0xf
    s_nop 1
    v_add_f32_dpp v58, v14, v58 quad_perm:[2,2,2,2] row_mask:0xf bank_mask:0xf
    s_nop 1
    v_add_f32_dpp v58, v15, v58 quad_perm:[3,3,3,3] row_mask:0xf bank_mask:0xf
    s_waitcnt vmcnt(15)
    v_mfma_f32_16x16x32_bf16 v[16:19], v[80:83], v[32:35], 0
    buffer_load_dwordx4 v[80:83], v1, s[4:7], s32 offen offset:0 nt
    s_add_u32 s32, s32, 6144
    s_waitcnt vmcnt(15)
    v_mfma_f32_16x16x32_bf16 v[16:19], v[84:87], v[36:39], v[16:19]
    buffer_load_dwordx4 v[84:87], v1, s[4:7], s32 offen offset:0 nt
    s_add_u32 s32, s32, 6144
    s_waitcnt vmcnt(15)
    v_mfma_f32_16x16x32_bf16 v[16:19], v[88:91], v[40:43], v[16:19]
    buffer_load_dwordx4 v[88:91], v1, s[4:7], s32 offen offset:0 nt
    s_add_u32 s32, s32, 6144
    s_waitcnt vmcnt(15)
    v_mfma_f32_16x16x32_bf16 v[16:19], v[92:95], v[44:47], v[16:19]
    buffer_load_dwordx4 v[92:95], v1, s[4:7], s32 offen offset:0 nt
    s_add_u32 s32, s32, 6144
    s_nop 5
    v_add_f32_dpp v3, v16, v17 quad_perm:[0,0,0,0] row_mask:0xf bank_mask:0xf
    s_nop 1
    v_add_f32_dpp v3, v18, v3 quad_perm:[2,2,2,2] row_mask:0xf bank_mask:0xf
    s_nop 1
    v_add_f32_dpp v3, v19, v3 quad_perm:[3,3,3,3] row_mask:0xf bank_mask:0xf
    v_cndmask_b32 v58, v58, v3, s[64:65]
    s_waitcnt vmcnt(15)
    v_mfma_f32_16x16x32_bf16 v[12:15], v[96:99], v[32:35], 0
    buffer_load_dwordx4 v[96:99], v1, s[4:7], s32 offen offset:0 nt
    s_add_u32 s32, s32, 6144
    s_waitcnt vmcnt(15)
    v_mfma_f32_16x16x32_bf16 v[12:15], v[100:103], v[36:39], v[12:15]
    buffer_load_dwordx4 v[100:103], v1, s[4:7], s32 offen offset:0 nt
    s_add_u32 s32, s32, 6144
    s_waitcnt vmcnt(15)
    v_mfma_f32_16x16x32_bf16 v[12:15], v[104:107], v[40:43], v[12:15]
    buffer_load_dwordx4 v[104:107], v1, s[4:7], s32 offen offset:0 nt
    s_add_u32 s32, s32, 6144
    s_waitcnt vmcnt(15)
    v_mfma_f32_16x16x32_bf16 v[12:15], v[108:111], v[44:47], v[12:15]
    buffer_load_dwordx4 v[108:111], v1, s[4:7], s32 offen offset:0 nt
    s_add_u32 s32, s32, 6144
    s_nop 5
    v_add_f32_dpp v3, v12, v14 quad_perm:[0,0,0,0] row_mask:0xf bank_mask:0xf
    s_nop 1
    v_add_f32_dpp v3, v13, v3 quad_perm:[1,1,1,1] row_mask:0xf bank_mask:0xf
    s_nop 1
    v_add_f32_dpp v3, v15, v3 quad_perm:[3,3,3,3] row_mask:0xf bank_mask:0xf
    v_cndmask_b32 v58, v58, v3, s[66:67]
    s_waitcnt vmcnt(15)
    v_mfma_f32_16x16x32_bf16 v[16:19], v[112:115], v[32:35], 0
    buffer_load_dwordx4 v[112:115], v1, s[4:7], s32 offen offset:0 nt
    s_add_u32 s32, s32, 6144
    s_waitcnt vmcnt(15)
    v_mfma_f32_16x16x32_bf16 v[16:19], v[116:119], v[36:39], v[16:19]
    buffer_load_dwordx4 v[116:119], v1, s[4:7], s32 offen offset:0 nt
    s_add_u32 s32, s32, 6144
    s_waitcnt vmcnt(15)
    v_mfma_f32_16x16x32_bf16 v[16:19], v[120:123], v[40:43], v[16:19]
    buffer_load_dwordx4 v[120:123], v1, s[4:7], s32 offen offset:0 nt
    s_add_u32 s32, s32, 6144
    s_waitcnt vmcnt(15)
    v_mfma_f32_16x16x32_bf16 v[16:19], v[124:127], v[44:47], v[16:19]
    buffer_load_dwordx4 v[124:127], v1, s[4:7], s32 offen offset:0 nt
    s_add_u32 s32, s32, 6144
    s_nop 5
    v_add_f32_dpp v3, v16, v19 quad_perm:[0,0,0,0] row_mask:0xf bank_mask:0xf
    s_nop 1
    v_add_f32_dpp v3, v17, v3 quad_perm:[1,1,1,1] row_mask:0xf bank_mask:0xf
    s_nop 1
    v_add_f32_dpp v3, v18, v3 quad_perm:[2,2,2,2] row_mask:0xf bank_mask:0xf
    v_cndmask_b32 v58, v58, v3, s[68:69]
    s_cmp_lg_u32 s27, 1
    s_cbranch_scc1 L_BK_b0
    v_mfma_f32_16x16x32_bf16 v[12:15], a[0:3], v[32:35], 0
    v_mfma_f32_16x16x32_bf16 v[12:15], a[4:7], v[36:39], v[12:15]
    v_mfma_f32_16x16x32_bf16 v[12:15], a[8:11], v[40:43], v[12:15]
    v_mfma_f32_16x16x32_bf16 v[12:15], a[12:15], v[44:47], v[12:15]
    s_nop 7
    v_add_f32_dpp v48, v13, v12 quad_perm:[1,1,1,1] row_mask:0xf bank_mask:0xf
    s_nop 1
    v_add_f32_dpp v48, v14, v48 quad_perm:[2,2,2,2] row_mask:0xf bank_mask:0xf
    s_nop 1
    v_add_f32_dpp v48, v15, v48 quad_perm:[3,3,3,3] row_mask:0xf bank_mask:0xf
    v_mfma_f32_16x16x32_bf16 v[16:19], a[16:19], v[32:35], 0
    v_mfma_f32_16x16x32_bf16 v[16:19], a[20:23], v[36:39], v[16:19]
    v_mfma_f32_16x16x32_bf16 v[16:19], a[24:27], v[40:43], v[16:19]
    v_mfma_f32_16x16x32_bf16 v[16:19], a[28:31], v[44:47], v[16:19]
    s_nop 7
    v_add_f32_dpp v3, v16, v17 quad_perm:[0,0,0,0] row_mask:0xf bank_mask:0xf
    s_nop 1
    v_add_f32_dpp v3, v18, v3 quad_perm:[2,2,2,2] row_mask:0xf bank_mask:0xf
    s_nop 1
    v_add_f32_dpp v3, v19, v3 quad_perm:[3,3,3,3] row_mask:0xf bank_mask:0xf
    v_cndmask_b32 v48, v48, v3, s[64:65]
    v_mfma_f32_16x16x32_bf16 v[12:15], a[32:35], v[32:35], 0
    v_mfma_f32_16x16x32_bf16 v[12:15], a[36:39], v[36:39], v[12:15]
    v_mfma_f32_16x16x32_bf16 v[12:15], a[40:43], v[40:43], v[12:15]
    v_mfma_f32_16x16x32_bf16 v[12:15], a[44:47], v[44:47], v[12:15]
    s_nop 7
    v_add_f32_dpp v3, v12, v14 quad_perm:[0,0,0,0] row_mask:0xf bank_mask:0xf
    s_nop 1
    v_add_f32_dpp v3, v13, v3 quad_perm:[1,1,1,1] row_mask:0xf bank_mask:0xf
    s_nop 1
    v_add_f32_dpp v3, v15, v3 quad_perm:[3,3,3,3] row_mask:0xf bank_mask:0xf
    v_cndmask_b32 v48, v48, v3, s[66:67]
    v_mfma_f32_16x16x32_bf16 v[16:19], a[48:51], v[32:35], 0
    v_mfma_f32_16x16x32_bf16 v[16:19], a[52:55], v[36:39], v[16:19]
    v_mfma_f32_16x16x32_bf16 v[16:19], a[56:59], v[40:43], v[16:19]
    v_mfma_f32_16x16x32_bf16 v[16:19], a[60:63], v[44:47], v[16:19]
    s_nop 7
    v_add_f32_dpp v3, v16, v19 quad_perm:[0,0,0,0] row_mask:0xf bank_mask:0xf
    s_nop 1
    v_add_f32_dpp v3, v17, v3 quad_perm:[1,1,1,1] row_mask:0xf bank_mask:0xf
    s_nop 1
    v_add_f32_dpp v3, v18, v3 quad_perm:[2,2,2,2] row_mask:0xf bank_mask:0xf
    v_cndmask_b32 v48, v48, v3, s[68:69]
L_BK_b0:
    s_add_u32 s27, s27, 1
    s_cmp_lt_u32 s27, 11
    s_cbranch_scc1 L_BK
    v_and_b32 v3, 3, v0
    v_bfe_u32 v4, v0, 2, 2
    v_lshl_add_u32 v3, v3, 2, v4
    v_add_u32 v3, 160, v3
    v_lshrrev_b32 v3, 0, v3
    v_mul_u32_u24 v3, 6, v3
    v_add_u32 v3, s31, v3
    v_mov_b32 v4, 0xff800000
    v_cmp_gt_u32 vcc, 1024, v3
    s_nop 1
    v_cndmask_b32 v58, v4, v58, vcc
    v_max3_f32 v3, v48, v49, v50
    v_max3_f32 v3, v3, v51, v52
    v_max3_f32 v3, v3, v53, v54
    v_max3_f32 v3, v3, v55, v56
    v_max3_f32 v3, v3, v57, v58
    s_nop 1
    v_max_f32_dpp v3, v3, v3 row_ror:8 row_mask:0xf bank_mask:0xf
    s_nop 1
    v_max_f32_dpp v3, v3, v3 row_ror:4 row_mask:0xf bank_mask:0xf
    s_nop 1
    v_max_f32_dpp v3, v3, v3 row_ror:2 row_mask:0xf bank_mask:0xf
    s_nop 1
    v_max_f32_dpp v3, v3, v3 row_ror:1 row_mask:0xf bank_mask:0xf
    s_nop 1
    v_max_f32_dpp v3, v3, v3 row_bcast:15 row_mask:0xa bank_mask:0xf
    s_nop 1
    v_max_f32_dpp v3, v3, v3 row_bcast:31 row_mask:0xc bank_mask:0xf
    s_nop 0
    v_readlane_b32 s24, v3, 63
    s_mov_b32 s71, 0x3e0293ee
    v_mov_b32 v6, s71
    v_mul_f32 v6, s24, v6
    v_fma_f32 v48, v48, s71, -v6
    v_fma_f32 v49, v49, s71, -v6
    v_fma_f32 v50, v50, s71, -v6
    v_fma_f32 v51, v51, s71, -v6
    v_fma_f32 v52, v52, s71, -v6
    v_fma_f32 v53, v53, s71, -v6
    v_fma_f32 v54, v54, s71, -v6
    v_fma_f32 v55, v55, s71, -v6
    v_fma_f32 v56, v56, s71, -v6
    v_fma_f32 v57, v57, s71, -v6
    v_fma_f32 v58, v58, s71, -v6
    v_exp_f32 v48, v48
    v_exp_f32 v49, v49
    v_exp_f32 v50, v50
    v_exp_f32 v51, v51
    v_exp_f32 v52, v52
    v_exp_f32 v53, v53
    v_exp_f32 v54, v54
    v_exp_f32 v55, v55
    v_exp_f32 v56, v56
    v_exp_f32 v57, v57
    v_exp_f32 v58, v58
    v_add_f32 v7, v48, v49
    v_add_f32 v7, v7, v50
    v_add_f32 v7, v7, v51
    v_add_f32 v7, v7, v52
    v_add_f32 v7, v7, v53
    v_add_f32 v7, v7, v54
    v_add_f32 v7, v7, v55
    v_add_f32 v7, v7, v56
    v_add_f32 v7, v7, v57
    v_add_f32 v7, v7, v58
    v_cvt_pk_bf16_f32 v48, v48, v48
    v_cvt_pk_bf16_f32 v49, v49, v49
    v_cvt_pk_bf16_f32 v50, v50, v50
    v_cvt_pk_bf16_f32 v51, v51, v51
    v_cvt_pk_bf16_f32 v52, v52, v52
    v_cvt_pk_bf16_f32 v53, v53, v53
    v_cvt_pk_bf16_f32 v54, v54, v54
    v_cvt_pk_bf16_f32 v55, v55, v55
    v_cvt_pk_bf16_f32 v56, v56, v56
    v_cvt_pk_bf16_f32 v57, v57, v57
    v_cvt_pk_bf16_f32 v58, v58, v58
    v_add_f32_dpp v7, v7, v7 row_ror:8 row_mask:0xf bank_mask:0xf
    s_nop 1
    v_add_f32_dpp v7, v7, v7 row_ror:4 row_mask:0xf bank_mask:0xf
    s_nop 1
    v_add_f32_dpp v7, v7, v7 row_ror:2 row_mask:0xf bank_mask:0xf
    s_nop 1
    v_add_f32_dpp v7, v7, v7 row_ror:1 row_mask:0xf bank_mask:0xf
    s_nop 1
    v_add_f32_dpp v7, v7, v7 row_bcast:15 row_mask:0xa bank_mask:0xf
    s_nop 1
    v_add_f32_dpp v7, v7, v7 row_bcast:31 row_mask:0xc bank_mask:0xf
    s_nop 0
    v_readlane_b32 s70, v7, 63
    s_lshl_b32 s25, s33, 3
    s_add_u32 s25, s25, s31
    s_lshl_b32 s25, s25, 4
    s_add_u32 s25, s25, 0x1b0000
    s_mov_b64 exec, 1
    v_mov_b32 v7, s70
    buffer_store_dwordx2 v[6:7], off, s[12:15], s25 sc1
    s_mov_b64 exec, -1
    s_mul_i32 s73, s33, 6
    s_add_u32 s73, s73, s31
    s_lshl_b32 s73, s73, 8
    s_add_u32 s73, s73, 0x180000
    v_lshrrev_b32 v3, 4, v0
    v_lshlrev_b32 v60, 6, v3
    v_and_b32 v4, 7, v0
    v_lshl_add_u32 v60, v4, 3, v60
    v_mov_b32 v12, 0
    v_mov_b32 v13, 0
    v_mov_b32 v14, 0
    v_mov_b32 v15, 0
    s_mov_b32 s27, 0
L_BV:
    s_barrier
    s_cmp_lg_u32 s27, 4
    s_cbranch_scc1 L_BV_x0
    s_lshl_b32 s24, s26, 7
    s_add_u32 s24, s24, 0x1b4000
    s_mov_b64 exec, 1
    buffer_load_dwordx2 v[62:63], off, s[12:15], s24 sc1
    s_mov_b64 exec, -1
L_BV_x0:
    s_cmp_lg_u32 s27, 5
    s_cbranch_scc1 L_BV_x1
    s_getreg_b32 s75, hwreg(HW_REG_XCC_ID, 0, 4)
    v_readfirstlane_b32 s24, v62
    v_readfirstlane_b32 s25, v63
    s_xor_b32 s24, s24, s75
    s_xor_b32 s25, s25, s75
    s_or_b32 s75, s24, s25
L_BV_x1:
    v_and_b32_dpp v8, v48, v20 row_newbcast:0 row_mask:0xf bank_mask:0xf
    v_and_b32_dpp v9, v48, v21 row_newbcast:0 row_mask:0xf bank_mask:0xf
    v_and_b32_dpp v10, v48, v22 row_newbcast:0 row_mask:0xf bank_mask:0xf
    v_and_b32_dpp v11, v48, v23 row_newbcast:0 row_mask:0xf bank_mask:0xf
    s_waitcnt vmcnt(15)
    s_nop 0
    v_mfma_f32_16x16x32_bf16 v[12:15], v[64:67], v[8:11], v[12:15]
    buffer_load_dwordx4 v[64:67], v1, s[4:7], s32 offen offset:0 nt
    s_add_u32 s32, s32, 6144
    v_and_b32_dpp v8, v48, v20 row_newbcast:4 row_mask:0xf bank_mask:0xf
    v_and_b32_dpp v9, v48, v21 row_newbcast:4 row_mask:0xf bank_mask:0xf
    v_and_b32_dpp v10, v48, v22 row_newbcast:4 row_mask:0xf bank_mask:0xf
    v_and_b32_dpp v11, v48, v23 row_newbcast:4 row_mask:0xf bank_mask:0xf
    s_waitcnt vmcnt(15)
    s_nop 0
    v_mfma_f32_16x16x32_bf16 v[12:15], v[68:71], v[8:11], v[12:15]
    buffer_load_dwordx4 v[68:71], v1, s[4:7], s32 offen offset:0 nt
    s_add_u32 s32, s32, 6144
    v_and_b32_dpp v8, v48, v20 row_newbcast:8 row_mask:0xf bank_mask:0xf
    v_and_b32_dpp v9, v48, v21 row_newbcast:8 row_mask:0xf bank_mask:0xf
    v_and_b32_dpp v10, v48, v22 row_newbcast:8 row_mask:0xf bank_mask:0xf
    v_and_b32_dpp v11, v48, v23 row_newbcast:8 row_mask:0xf bank_mask:0xf
    s_waitcnt vmcnt(15)
    s_nop 0
    v_mfma_f32_16x16x32_bf16 v[12:15], v[72:75], v[8:11], v[12:15]
    buffer_load_dwordx4 v[72:75], v1, s[4:7], s32 offen offset:0 nt
    s_add_u32 s32, s32, 6144
    v_and_b32_dpp v8, v48, v20 row_newbcast:12 row_mask:0xf bank_mask:0xf
    v_and_b32_dpp v9, v48, v21 row_newbcast:12 row_mask:0xf bank_mask:0xf
    v_and_b32_dpp v10, v48, v22 row_newbcast:12 row_mask:0xf bank_mask:0xf
    v_and_b32_dpp v11, v48, v23 row_newbcast:12 row_mask:0xf bank_mask:0xf
    s_waitcnt vmcnt(15)
    s_nop 0
    v_mfma_f32_16x16x32_bf16 v[12:15], v[76:79], v[8:11], v[12:15]
    buffer_load_dwordx4 v[76:79], v1, s[4:7], s32 offen offset:0 nt
    s_add_u32 s32, s32, 6144
    v_and_b32_dpp v8, v48, v20 row_newbcast:1 row_mask:0xf bank_mask:0xf
    v_and_b32_dpp v9, v48, v21 row_newbcast:1 row_mask:0xf bank_mask:0xf
    v_and_b32_dpp v10, v48, v22 row_newbcast:1 row_mask:0xf bank_mask:0xf
    v_and_b32_dpp v11, v48, v23 row_newbcast:1 row_mask:0xf bank_mask:0xf
    s_waitcnt vmcnt(15)
    s_nop 0
    v_mfma_f32_16x16x32_bf16 v[12:15], v[80:83], v[8:11], v[12:15]
    buffer_load_dwordx4 v[80:83], v1, s[4:7], s32 offen offset:0 nt
    s_add_u32 s32, s32, 6144
    v_and_b32_dpp v8, v48, v20 row_newbcast:5 row_mask:0xf bank_mask:0xf
    v_and_b32_dpp v9, v48, v21 row_newbcast:5 row_mask:0xf bank_mask:0xf
    v_and_b32_dpp v10, v48, v22 row_newbcast:5 row_mask:0xf bank_mask:0xf
    v_and_b32_dpp v11, v48, v23 row_newbcast:5 row_mask:0xf bank_mask:0xf
    s_waitcnt vmcnt(15)
    s_nop 0
    v_mfma_f32_16x16x32_bf16 v[12:15], v[84:87], v[8:11], v[12:15]
    buffer_load_dwordx4 v[84:87], v1, s[4:7], s32 offen offset:0 nt
    s_add_u32 s32, s32, 6144
    v_and_b32_dpp v8, v48, v20 row_newbcast:9 row_mask:0xf bank_mask:0xf
    v_and_b32_dpp v9, v48, v21 row_newbcast:9 row_mask:0xf bank_mask:0xf
    v_and_b32_dpp v10, v48, v22 row_newbcast:9 row_mask:0xf bank_mask:0xf
    v_and_b32_dpp v11, v48, v23 row_newbcast:9 row_mask:0xf bank_mask:0xf
    s_waitcnt vmcnt(15)
    s_nop 0
    v_mfma_f32_16x16x32_bf16 v[12:15], v[88:91], v[8:11], v[12:15]
    buffer_load_dwordx4 v[88:91], v1, s[4:7], s32 offen offset:0 nt
    s_add_u32 s32, s32, 6144
    v_and_b32_dpp v8, v48, v20 row_newbcast:13 row_mask:0xf bank_mask:0xf
    v_and_b32_dpp v9, v48, v21 row_newbcast:13 row_mask:0xf bank_mask:0xf
    v_and_b32_dpp v10, v48, v22 row_newbcast:13 row_mask:0xf bank_mask:0xf
    v_and_b32_dpp v11, v48, v23 row_newbcast:13 row_mask:0xf bank_mask:0xf
    s_waitcnt vmcnt(15)
    s_nop 0
    v_mfma_f32_16x16x32_bf16 v[12:15], v[92:95], v[8:11], v[12:15]
    buffer_load_dwordx4 v[92:95], v1, s[4:7], s32 offen offset:0 nt
    s_add_u32 s32, s32, 6144
    v_and_b32_dpp v8, v48, v20 row_newbcast:2 row_mask:0xf bank_mask:0xf
    v_and_b32_dpp v9, v48, v21 row_newbcast:2 row_mask:0xf bank_mask:0xf
    v_and_b32_dpp v10, v48, v22 row_newbcast:2 row_mask:0xf bank_mask:0xf
    v_and_b32_dpp v11, v48, v23 row_newbcast:2 row_mask:0xf bank_mask:0xf
    s_waitcnt vmcnt(15)
    s_nop 0
    v_mfma_f32_16x16x32_bf16 v[12:15], v[96:99], v[8:11], v[12:15]
    buffer_load_dwordx4 v[96:99], v1, s[4:7], s32 offen offset:0 nt
    s_add_u32 s32, s32, 6144
    v_and_b32_dpp v8, v48, v20 row_newbcast:6 row_mask:0xf bank_mask:0xf
    v_and_b32_dpp v9, v48, v21 row_newbcast:6 row_mask:0xf bank_mask:0xf
    v_and_b32_dpp v10, v48, v22 row_newbcast:6 row_mask:0xf bank_mask:0xf
    v_and_b32_dpp v11, v48, v23 row_newbcast:6 row_mask:0xf bank_mask:0xf
    s_waitcnt vmcnt(15)
    s_nop 0
    v_mfma_f32_16x16x32_bf16 v[12:15], v[100:103], v[8:11], v[12:15]
    buffer_load_dwordx4 v[100:103], v1, s[4:7], s32 offen offset:0 nt
    s_add_u32 s32, s32, 6144
    v_and_b32_dpp v8, v48, v20 row_newbcast:10 row_mask:0xf bank_mask:0xf
    v_and_b32_dpp v9, v48, v21 row_newbcast:10 row_mask:0xf bank_mask:0xf
    v_and_b32_dpp v10, v48, v22 row_newbcast:10 row_mask:0xf bank_mask:0xf
    v_and_b32_dpp v11, v48, v23 row_newbcast:10 row_mask:0xf bank_mask:0xf
    s_waitcnt vmcnt(15)
    s_nop 0
    v_mfma_f32_16x16x32_bf16 v[12:15], v[104:107], v[8:11], v[12:15]
    buffer_load_dwordx4 v[104:107], v1, s[4:7], s32 offen offset:0 nt
    s_add_u32 s32, s32, 6144
    s_cmp_lg_u32 s27, 10
    s_cbranch_scc1 L_BV_a
    s_mov_b32 exec_lo, 0x00ff00ff
    s_mov_b32 exec_hi, 0x00ff00ff
    s_cmp_eq_u32 s75, 0
    s_nop 0
    v_cvt_pk_bf16_f32 v4, v12, v13
    v_cvt_pk_bf16_f32 v5, v14, v15
    s_cbranch_scc0 L_BV_far
    buffer_store_dwordx2 v[4:5], v60, s[12:15], s73 offen
    s_branch L_BV_done
L_BV_far:
    buffer_store_dwordx2 v[4:5], v60, s[12:15], s73 offen sc1
L_BV_done:
    s_endpgm
L_BV_a:
    v_and_b32_dpp v8, v48, v20 row_newbcast:14 row_mask:0xf bank_mask:0xf
    v_and_b32_dpp v9, v48, v21 row_newbcast:14 row_mask:0xf bank_mask:0xf
    v_and_b32_dpp v10, v48, v22 row_newbcast:14 row_mask:0xf bank_mask:0xf
    v_and_b32_dpp v11, v48, v23 row_newbcast:14 row_mask:0xf bank_mask:0xf
    s_waitcnt vmcnt(15)
    s_nop 0
    v_mfma_f32_16x16x32_bf16 v[12:15], v[108:111], v[8:11], v[12:15]
    buffer_load_dwordx4 v[108:111], v1, s[4:7], s32 offen offset:0 nt
    s_add_u32 s32, s32, 6144
    v_and_b32_dpp v8, v48, v20 row_newbcast:3 row_mask:0xf bank_mask:0xf
    v_and_b32_dpp v9, v48, v21 row_newbcast:3 row_mask:0xf bank_mask:0xf
    v_and_b32_dpp v10, v48, v22 row_newbcast:3 row_mask:0xf bank_mask:0xf
    v_and_b32_dpp v11, v48, v23 row_newbcast:3 row_mask:0xf bank_mask:0xf
    s_waitcnt vmcnt(15)
    s_nop 0
    v_mfma_f32_16x16x32_bf16 v[12:15], v[112:115], v[8:11], v[12:15]
    buffer_load_dwordx4 v[112:115], v1, s[4:7], s32 offen offset:0 nt
    s_add_u32 s32, s32, 6144
    v_and_b32_dpp v8, v48, v20 row_newbcast:7 row_mask:0xf bank_mask:0xf
    v_and_b32_dpp v9, v48, v21 row_newbcast:7 row_mask:0xf bank_mask:0xf
    v_and_b32_dpp v10, v48, v22 row_newbcast:7 row_mask:0xf bank_mask:0xf
    v_and_b32_dpp v11, v48, v23 row_newbcast:7 row_mask:0xf bank_mask:0xf
    s_waitcnt vmcnt(15)
    s_nop 0
    v_mfma_f32_16x16x32_bf16 v[12:15], v[116:119], v[8:11], v[12:15]
    buffer_load_dwordx4 v[116:119], v1, s[4:7], s32 offen offset:0 nt
    s_add_u32 s32, s32, 6144
    v_and_b32_dpp v8, v48, v20 row_newbcast:11 row_mask:0xf bank_mask:0xf
    v_and_b32_dpp v9, v48, v21 row_newbcast:11 row_mask:0xf bank_mask:0xf
    v_and_b32_dpp v10, v48, v22 row_newbcast:11 row_mask:0xf bank_mask:0xf
    v_and_b32_dpp v11, v48, v23 row_newbcast:11 row_mask:0xf bank_mask:0xf
    s_waitcnt vmcnt(15)
    s_nop 0
    v_mfma_f32_16x16x32_bf16 v[12:15], v[120:123], v[8:11], v[12:15]
    buffer_load_dwordx4 v[120:123], v1, s[4:7], s32 offen offset:0 nt
    s_add_u32 s32, s32, 6144
    v_and_b32_dpp v8, v48, v20 row_newbcast:15 row_mask:0xf bank_mask:0xf
    v_and_b32_dpp v9, v48, v21 row_newbcast:15 row_mask:0xf bank_mask:0xf
    v_and_b32_dpp v10, v48, v22 row_newbcast:15 row_mask:0xf bank_mask:0xf
    v_and_b32_dpp v11, v48, v23 row_newbcast:15 row_mask:0xf bank_mask:0xf
    s_waitcnt vmcnt(15)
    s_nop 0
    v_mfma_f32_16x16x32_bf16 v[12:15], v[124:127], v[8:11], v[12:15]
    buffer_load_dwordx4 v[124:127], v1, s[4:7], s32 offen offset:0 nt
    s_add_u32 s32, s32, 6144
    v_mov_b32 v48, v49
    v_mov_b32 v49, v50
    v_mov_b32 v50, v51
    v_mov_b32 v51, v52
    v_mov_b32 v52, v53
    v_mov_b32 v53, v54
    v_mov_b32 v54, v55
    v_mov_b32 v55, v56
    v_mov_b32 v56, v57
    v_mov_b32 v57, v58
    s_add_u32 s27, s27, 1
    s_branch L_BV
L_A:
    s_getpc_b64 s[20:21]
L_pc3:
    s_sub_u32 s20, s20, L_pc3-L_A
    s_subb_u32 s21, s21, 0
    s_mov_b32 s22, L_A2-L_A
    s_mov_b32 s23, 0x20000
    v_lshl_add_u32 v3, v0, 2, s3
    v_lshlrev_b32 v3, 7, v3
    buffer_load_dword v17, v3, s[20:23], 0 offen
    s_mov_b32 s74, s2
    s_and_b32 s72, s2, 31
    s_and_b32 s25, s72, 7
    s_lshr_b32 s26, s72, 3
    s_mov_b32 s70, 0x5040100
    s_mov_b32 s71, 0xd0c0908
    s_lshl_b32 s25, s25, 3
    s_lshr_b64 s[70:71], s[70:71], s25
    s_lshl_b32 s26, s26, 3
    s_lshr_b32 s26, 0x12100200, s26
    s_or_b32 s26, s26, s70
    s_and_b32 s26, s26, 31
    v_lshrrev_b32 v3, 4, v0
    v_and_b32 v4, 15, v0
    v_lshlrev_b32 v18, 18, v3
    v_lshl_add_u32 v18, v4, 4, v18
    v_lshrrev_b32 v6, 3, v4
    v_lshlrev_b32 v6, 10, v6
    v_lshl_add_u32 v19, v3, 6, v6
    v_bfe_u32 v1, v0, 2, 2
    v_lshlrev_b32 v64, 18, v1
    v_lshl_add_u32 v64, v3, 6, v64
    v_and_b32 v4, 3, v0
    v_lshl_add_u32 v64, v4, 4, v64
    v_lshlrev_b32 v65, 9, v1
    v_lshl_add_u32 v65, v3, 7, v65
    v_lshl_add_u32 v65, v4, 5, v65
    v_add_u32 v65, 135168, v65
    v_lshlrev_b32 v66, 15, v1
    v_lshl_add_u32 v66, v3, 6, v66
    v_lshl_add_u32 v66, v4, 4, v66
    v_and_b32 v4, 15, v0
    v_lshlrev_b32 v67, 10, v3
    v_lshl_add_u32 v67, v4, 4, v67
    s_lshl_b32 s35, s3, 20
    s_lshl_b32 s24, s26, 8
    s_add_u32 s35, s35, s24
    s_waitcnt lgkmcnt(0)
    s_cmp_lt_u32 s74, 32
    s_cselect_b64 s[4:5], s[40:41], s[54:55]
    s_mov_b32 s6, 0x400000
    s_mov_b32 s7, 0x20000
    s_cselect_b64 s[20:21], s[36:37], s[48:49]
    s_mov_b32 s22, 4096
    s_mov_b32 s23, 0x20000
    s_cselect_b32 s75, 0x400000, 0
    s_lshl_b32 s24, s3, 8
    s_mov_b32 s32, s35
    buffer_load_dwordx4 v[12:15], v67, s[20:23], s24 offen
    buffer_load_dwordx4 v[128:131], v18, s[4:7], s32 offen
    s_add_u32 s32, s32, 8192
    buffer_load_dwordx4 v[132:135], v18, s[4:7], s32 offen
    s_add_u32 s32, s32, 8192
    buffer_load_dwordx4 v[136:139], v18, s[4:7], s32 offen
    s_add_u32 s32, s32, 8192
    buffer_load_dwordx4 v[140:143], v18, s[4:7], s32 offen
    s_add_u32 s32, s32, 8192
    buffer_load_dwordx4 v[144:147], v18, s[4:7], s32 offen
    s_add_u32 s32, s32, 8192
    buffer_load_dwordx4 v[148:151], v18, s[4:7], s32 offen
    s_add_u32 s32, s32, 8192
    buffer_load_dwordx4 v[152:155], v18, s[4:7], s32 offen
    s_add_u32 s32, s32, 8192
    buffer_load_dwordx4 v[156:159], v18, s[4:7], s32 offen
    s_add_u32 s32, s32, 8192
    buffer_load_dwordx4 v[160:163], v18, s[4:7], s32 offen
    s_add_u32 s32, s32, 8192
    buffer_load_dwordx4 v[164:167], v18, s[4:7], s32 offen
    s_add_u32 s32, s32, 8192
    buffer_load_dwordx4 v[168:171], v18, s[4:7], s32 offen
    s_add_u32 s32, s32, 8192
    buffer_load_dwordx4 v[172:175], v18, s[4:7], s32 offen
    s_add_u32 s32, s32, 8192
    buffer_load_dwordx4 v[176:179], v18, s[4:7], s32 offen
    s_add_u32 s32, s32, 8192
    buffer_load_dwordx4 v[180:183], v18, s[4:7], s32 offen
    s_add_u32 s32, s32, 8192
    buffer_load_dwordx4 v[184:187], v18, s[4:7], s32 offen
    s_add_u32 s32, s32, 8192
    buffer_load_dwordx4 v[188:191], v18, s[4:7], s32 offen
    s_add_u32 s32, s32, 8192
    s_mov_b32 s12, s62
    s_mov_b32 s13, s63
    s_mov_b32 s14, 0x400000
    s_mov_b32 s15, 0x20000
    s_mov_b32 s16, s60
    s_mov_b32 s17, s61
    s_mov_b32 s18, 0x100
    s_mov_b32 s19, 0x20000
    v_and_b32 v3, 1, v0
    v_lshlrev_b32 v3, 4, v3
    v_mov_b32 v4, 0xffff
    v_lshlrev_b32 v4, v3, v4
    v_bfe_u32 v3, v0, 1, 2
    v_cmp_eq_u32 vcc, 0, v3
    s_nop 1
    v_cndmask_b32 v20, 0, v4, vcc
    v_cmp_eq_u32 vcc, 1, v3
    s_nop 1
    v_cndmask_b32 v21, 0, v4, vcc
    v_cmp_eq_u32 vcc, 2, v3
    s_nop 1
    v_cndmask_b32 v22, 0, v4, vcc
    v_cmp_eq_u32 vcc, 3, v3
    s_nop 1
    v_cndmask_b32 v23, 0, v4, vcc
    v_mov_b32 v3, 0x0c0c0c0c
    s_mov_b32 s24, 0x01000100
    s_mov_b32 s25, 0x03020302
    v_bfi_b32 v24, v20, s24, v3
    v_bfi_b32 v28, v20, s25, v3
    v_bfi_b32 v25, v21, s24, v3
    v_bfi_b32 v29, v21, s25, v3
    v_bfi_b32 v26, v22, s24, v3
    v_bfi_b32 v30, v22, s25, v3
    v_bfi_b32 v27, v23, s24, v3
    v_bfi_b32 v31, v23, s25, v3
    s_mov_b32 s64, 0x22222222
    s_mov_b32 s65, 0x22222222
    s_mov_b32 s66, 0x44444444
    s_mov_b32 s67, 0x44444444
    s_mov_b32 s68, 0x88888888
    s_mov_b32 s69, 0x88888888
    s_lshl_b32 s24, s3, 8
    s_add_u32 s24, s24, 145408
    v_add_u32 v3, s24, v67
    v_add_u32 v4, s24, v19
    s_waitcnt vmcnt(16)
    ds_write_b128 v3, v[12:15]
    s_waitcnt lgkmcnt(0)
    ds_read_b128 v[32:35], v4 offset:0
    ds_read_b128 v[36:39], v4 offset:16
    ds_read_b128 v[40:43], v4 offset:32
    ds_read_b128 v[44:47], v4 offset:48
    ds_read_b128 v[48:51], v4 offset:2048
    ds_read_b128 v[52:55], v4 offset:2064
    ds_read_b128 v[56:59], v4 offset:2080
    ds_read_b128 v[60:63], v4 offset:2096
    s_waitcnt lgkmcnt(0)
    v_perm_b32 v8, v32, v32, v24
    v_perm_b32 v9, v32, v32, v25
    v_perm_b32 v10, v32, v32, v26
    v_perm_b32 v11, v32, v32, v27
    s_waitcnt vmcnt(15)
    s_nop 0
    v_mfma_f32_16x16x32_bf16 v[12:15], v[128:131], v[8:11], 0
    v_perm_b32 v4, v48, v48, v24
    v_perm_b32 v5, v48, v48, v25
    v_perm_b32 v6, v48, v48, v26
    v_perm_b32 v7, v48, v48, v27
    s_nop 1
    v_mfma_f32_16x16x32_bf16 v[68:71], v[128:131], v[4:7], 0
    buffer_load_dwordx4 v[192:195], v18, s[4:7], s32 offen nt
    s_add_u32 s32, s32, 8192
    v_perm_b32 v8, v32, v32, v28
    v_perm_b32 v9, v32, v32, v29
    v_perm_b32 v10, v32, v32, v30
    v_perm_b32 v11, v32, v32, v31
    s_waitcnt vmcnt(15)
    s_nop 0
    v_mfma_f32_16x16x32_bf16 v[12:15], v[132:135], v[8:11], v[12:15]
    v_perm_b32 v4, v48, v48, v28
    v_perm_b32 v5, v48, v48, v29
    v_perm_b32 v6, v48, v48, v30
    v_perm_b32 v7, v48, v48, v31
    s_nop 1
    v_mfma_f32_16x16x32_bf16 v[68:71], v[132:135], v[4:7], v[68:71]
    buffer_load_dwordx4 v[196:199], v18, s[4:7], s32 offen nt
    s_add_u32 s32, s32, 8192
    v_perm_b32 v8, v33, v33, v24
    v_perm_b32 v9, v33, v33, v25
    v_perm_b32 v10, v33, v33, v26
    v_perm_b32 v11, v33, v33, v27
    s_waitcnt vmcnt(15)
    s_nop 0
    v_mfma_f32_16x16x32_bf16 v[12:15], v[136:139], v[8:11], v[12:15]
    v_perm_b32 v4, v49, v49, v24
    v_perm_b32 v5, v49, v49, v25
    v_perm_b32 v6, v49, v49, v26
    v_perm_b32 v7, v49, v49, v27
    s_nop 1
    v_mfma_f32_16x16x32_bf16 v[68:71], v[136:139], v[4:7], v[68:71]
    buffer_load_dwordx4 v[200:203], v18, s[4:7], s32 offen nt
    s_add_u32 s32, s32, 8192
    v_perm_b32 v8, v33, v33, v28
    v_perm_b32 v9, v33, v33, v29
    v_perm_b32 v10, v33, v33, v30
    v_perm_b32 v11, v33, v33, v31
    s_waitcnt vmcnt(15)
    s_nop 0
    v_mfma_f32_16x16x32_bf16 v[12:15], v[140:143], v[8:11], v[12:15]
    v_perm_b32 v4, v49, v49, v28
    v_perm_b32 v5, v49, v49, v29
    v_perm_b32 v6, v49, v49, v30
    v_perm_b32 v7, v49, v49, v31
    s_nop 1
    v_mfma_f32_16x16x32_bf16 v[68:71], v[140:143], v[4:7], v[68:71]
    buffer_load_dwordx4 v[204:207], v18, s[4:7], s32 offen nt
    s_add_u32 s32, s32, 8192
    v_perm_b32 v8, v34, v34, v24
    v_perm_b32 v9, v34, v34, v25
    v_perm_b32 v10, v34, v34, v26
    v_perm_b32 v11, v34, v34, v27
    s_waitcnt vmcnt(15)
    s_nop 0
    v_mfma_f32_16x16x32_bf16 v[12:15], v[144:147], v[8:11], v[12:15]
    v_perm_b32 v4, v50, v50, v24
    v_perm_b32 v5, v50, v50, v25
    v_perm_b32 v6, v50, v50, v26
    v_perm_b32 v7, v50, v50, v27
    s_nop 1
    v_mfma_f32_16x16x32_bf16 v[68:71], v[144:147], v[4:7], v[68:71]
    buffer_load_dwordx4 v[208:211], v18, s[4:7], s32 offen nt
    s_add_u32 s32, s32, 8192
    v_perm_b32 v8, v34, v34, v28
    v_perm_b32 v9, v34, v34, v29
    v_perm_b32 v10, v34, v34, v30
    v_perm_b32 v11, v34, v34, v31
    s_waitcnt vmcnt(15)
    s_nop 0
    v_mfma_f32_16x16x32_bf16 v[12:15], v[148:151], v[8:11], v[12:15]
    v_perm_b32 v4, v50, v50, v28
    v_perm_b32 v5, v50, v50, v29
    v_perm_b32 v6, v50, v50, v30
    v_perm_b32 v7, v50, v50, v31
    s_nop 1
    v_mfma_f32_16x16x32_bf16 v[68:71], v[148:151], v[4:7], v[68:71]
    buffer_load_dwordx4 v[212:215], v18, s[4:7], s32 offen nt
    s_add_u32 s32, s32, 8192
    v_perm_b32 v8, v35, v35, v24
    v_perm_b32 v9, v35, v35, v25
    v_perm_b32 v10, v35, v35, v26
    v_perm_b32 v11, v35, v35, v27
    s_waitcnt vmcnt(15)
    s_nop 0
    v_mfma_f32_16x16x32_bf16 v[12:15], v[152:155], v[8:11], v[12:15]
    v_perm_b32 v4, v51, v51, v24
    v_perm_b32 v5, v51, v51, v25
    v_perm_b32 v6, v51, v51, v26
    v_perm_b32 v7, v51, v51, v27
    s_nop 1
    v_mfma_f32_16x16x32_bf16 v[68:71], v[152:155], v[4:7], v[68:71]
    buffer_load_dwordx4 v[216:219], v18, s[4:7], s32 offen nt
    s_add_u32 s32, s32, 8192
    v_perm_b32 v8, v35, v35, v28
    v_perm_b32 v9, v35, v35, v29
    v_perm_b32 v10, v35, v35, v30
    v_perm_b32 v11, v35, v35, v31
    s_waitcnt vmcnt(15)
    s_nop 0
    v_mfma_f32_16x16x32_bf16 v[12:15], v[156:159], v[8:11], v[12:15]
    v_perm_b32 v4, v51, v51, v28
    v_perm_b32 v5, v51, v51, v29
    v_perm_b32 v6, v51, v51, v30
    v_perm_b32 v7, v51, v51, v31
    s_nop 1
    v_mfma_f32_16x16x32_bf16 v[68:71], v[156:159], v[4:7], v[68:71]
    buffer_load_dwordx4 v[220:223], v18, s[4:7], s32 offen nt
    s_add_u32 s32, s32, 8192
    v_perm_b32 v8, v36, v36, v24
    v_perm_b32 v9, v36, v36, v25
    v_perm_b32 v10, v36, v36, v26
    v_perm_b32 v11, v36, v36, v27
    s_waitcnt vmcnt(15)
    s_nop 0
    v_mfma_f32_16x16x32_bf16 v[12:15], v[160:163], v[8:11], v[12:15]
    v_perm_b32 v4, v52, v52, v24
    v_perm_b32 v5, v52, v52, v25
    v_perm_b32 v6, v52, v52, v26
    v_perm_b32 v7, v52, v52, v27
    s_nop 1
    v_mfma_f32_16x16x32_bf16 v[68:71], v[160:163], v[4:7], v[68:71]
    buffer_load_dwordx4 v[224:227], v18, s[4:7], s32 offen nt
    s_add_u32 s32, s32, 8192
    v_perm_b32 v8, v36, v36, v28
    v_perm_b32 v9, v36, v36, v29
    v_perm_b32 v10, v36, v36, v30
    v_perm_b32 v11, v36, v36, v31
    s_waitcnt vmcnt(15)
    s_nop 0
    v_mfma_f32_16x16x32_bf16 v[12:15], v[164:167], v[8:11], v[12:15]
    v_perm_b32 v4, v52, v52, v28
    v_perm_b32 v5, v52, v52, v29
    v_perm_b32 v6, v52, v52, v30
    v_perm_b32 v7, v52, v52, v31
    s_nop 1
    v_mfma_f32_16x16x32_bf16 v[68:71], v[164:167], v[4:7], v[68:71]
    buffer_load_dwordx4 v[228:231], v18, s[4:7], s32 offen nt
    s_add_u32 s32, s32, 8192
    v_perm_b32 v8, v37, v37, v24
    v_perm_b32 v9, v37, v37, v25
    v_perm_b32 v10, v37, v37, v26
    v_perm_b32 v11, v37, v37, v27
    s_waitcnt vmcnt(15)
    s_nop 0
    v_mfma_f32_16x16x32_bf16 v[12:15], v[168:171], v[8:11], v[12:15]
    v_perm_b32 v4, v53, v53, v24
    v_perm_b32 v5, v53, v53, v25
    v_perm_b32 v6, v53, v53, v26
    v_perm_b32 v7, v53, v53, v27
    s_nop 1
    v_mfma_f32_16x16x32_bf16 v[68:71], v[168:171], v[4:7], v[68:71]
    buffer_load_dwordx4 v[232:235], v18, s[4:7], s32 offen nt
    s_add_u32 s32, s32, 8192
    v_perm_b32 v8, v37, v37, v28
    v_perm_b32 v9, v37, v37, v29
    v_perm_b32 v10, v37, v37, v30
    v_perm_b32 v11, v37, v37, v31
    s_waitcnt vmcnt(15)
    s_nop 0
    v_mfma_f32_16x16x32_bf16 v[12:15], v[172:175], v[8:11], v[12:15]
    v_perm_b32 v4, v53, v53, v28
    v_perm_b32 v5, v53, v53, v29
    v_perm_b32 v6, v53, v53, v30
    v_perm_b32 v7, v53, v53, v31
    s_nop 1
    v_mfma_f32_16x16x32_bf16 v[68:71], v[172:175], v[4:7], v[68:71]
    buffer_load_dwordx4 v[236:239], v18, s[4:7], s32 offen nt
    s_add_u32 s32, s32, 8192
    v_perm_b32 v8, v38, v38, v24
    v_perm_b32 v9, v38, v38, v25
    v_perm_b32 v10, v38, v38, v26
    v_perm_b32 v11, v38, v38, v27
    s_waitcnt vmcnt(15)
    s_nop 0
    v_mfma_f32_16x16x32_bf16 v[12:15], v[176:179], v[8:11], v[12:15]
    v_perm_b32 v4, v54, v54, v24
    v_perm_b32 v5, v54, v54, v25
    v_perm_b32 v6, v54, v54, v26
    v_perm_b32 v7, v54, v54, v27
    s_nop 1
    v_mfma_f32_16x16x32_bf16 v[68:71], v[176:179], v[4:7], v[68:71]
    buffer_load_dwordx4 v[240:243], v18, s[4:7], s32 offen nt
    s_add_u32 s32, s32, 8192
    v_perm_b32 v8, v38, v38, v28
    v_perm_b32 v9, v38, v38, v29
    v_perm_b32 v10, v38, v38, v30
    v_perm_b32 v11, v38, v38, v31
    s_waitcnt vmcnt(15)
    s_nop 0
    v_mfma_f32_16x16x32_bf16 v[12:15], v[180:183], v[8:11], v[12:15]
    v_perm_b32 v4, v54, v54, v28
    v_perm_b32 v5, v54, v54, v29
    v_perm_b32 v6, v54, v54, v30
    v_perm_b32 v7, v54, v54, v31
    s_nop 1
    v_mfma_f32_16x16x32_bf16 v[68:71], v[180:183], v[4:7], v[68:71]
    buffer_load_dwordx4 v[244:247], v18, s[4:7], s32 offen nt
    s_add_u32 s32, s32, 8192
    v_perm_b32 v8, v39, v39, v24
    v_perm_b32 v9, v39, v39, v25
    v_perm_b32 v10, v39, v39, v26
    v_perm_b32 v11, v39, v39, v27
    s_waitcnt vmcnt(15)
    s_nop 0
    v_mfma_f32_16x16x32_bf16 v[12:15], v[184:187], v[8:11], v[12:15]
    v_perm_b32 v4, v55, v55, v24
    v_perm_b32 v5, v55, v55, v25
    v_perm_b32 v6, v55, v55, v26
    v_perm_b32 v7, v55, v55, v27
    s_nop 1
    v_mfma_f32_16x16x32_bf16 v[68:71], v[184:187], v[4:7], v[68:71]
    buffer_load_dwordx4 v[248:251], v18, s[4:7], s32 offen nt
    s_add_u32 s32, s32, 8192
    v_perm_b32 v8, v39, v39, v28
    v_perm_b32 v9, v39, v39, v29
    v_perm_b32 v10, v39, v39, v30
    v_perm_b32 v11, v39, v39, v31
    s_waitcnt vmcnt(15)
    s_nop 0
    v_mfma_f32_16x16x32_bf16 v[12:15], v[188:191], v[8:11], v[12:15]
    v_perm_b32 v4, v55, v55, v28
    v_perm_b32 v5, v55, v55, v29
    v_perm_b32 v6, v55, v55, v30
    v_perm_b32 v7, v55, v55, v31
    s_nop 1
    v_mfma_f32_16x16x32_bf16 v[68:71], v[188:191], v[4:7], v[68:71]
    buffer_load_dwordx4 v[252:255], v18, s[4:7], s32 offen nt
    s_add_u32 s32, s32, 8192
    v_perm_b32 v8, v40, v40, v24
    v_perm_b32 v9, v40, v40, v25
    v_perm_b32 v10, v40, v40, v26
    v_perm_b32 v11, v40, v40, v27
    s_waitcnt vmcnt(15)
    s_nop 0
    v_mfma_f32_16x16x32_bf16 v[12:15], v[192:195], v[8:11], v[12:15]
    v_perm_b32 v4, v56, v56, v24
    v_perm_b32 v5, v56, v56, v25
    v_perm_b32 v6, v56, v56, v26
    v_perm_b32 v7, v56, v56, v27
    s_nop 1
    v_mfma_f32_16x16x32_bf16 v[68:71], v[192:195], v[4:7], v[68:71]
    v_mov_b32 v76, -1
    v_mov_b32 v77, -1
    v_mov_b32 v78, -1
    v_mov_b32 v79, -1
    s_lshl_b32 s73, s74, 7
    s_add_u32 s73, s73, 0x170000
    s_cmp_lg_u32 s3, 0
    s_cbranch_scc1 L_A_nofl
    s_mov_b64 exec, 1
    buffer_store_dwordx4 v[76:79], off, s[12:15], s73 sc1
    s_mov_b64 exec, -1
L_A_nofl:
    s_cmp_lt_u32 s74, 32
    s_cbranch_scc1 L_A_noclr
    s_lshl_b32 s24, s72, 2
    s_add_u32 s24, s24, s3
    s_lshl_b32 s24, s24, 12
    s_add_u32 s24, s24, 0x180000
    s_cmp_ge_u32 s24, 0x1f8000
    s_cbranch_scc1 L_A_noclr
    buffer_store_dwordx4 v[76:79], v2, s[12:15], s24 offen offset:0 sc1
    buffer_store_dwordx4 v[76:79], v2, s[12:15], s24 offen offset:1024 sc1
    buffer_store_dwordx4 v[76:79], v2, s[12:15], s24 offen offset:2048 sc1
    buffer_store_dwordx4 v[76:79], v2, s[12:15], s24 offen offset:3072 sc1
L_A_noclr:
    s_getpc_b64 s[20:21]
L_pc4:
    s_add_u32 s20, s20, L_A2-L_pc4
    s_addc_u32 s21, s21, 0
    s_mov_b32 s22, L_last-L_A2
    s_mov_b32 s23, 0x20000
    v_lshl_add_u32 v3, v0, 2, s3
    v_lshlrev_b32 v3, 7, v3
    buffer_load_dword v17, v3, s[20:23], 0 offen
    s_mov_b32 s4, s42
    s_mov_b32 s5, s43
    s_mov_b32 s6, s75
    s_mov_b32 s32, s35
    buffer_load_dwordx4 v[128:131], v64, s[4:7], s32 offen nt
    s_add_u32 s32, s32, 8192
    v_perm_b32 v8, v40, v40, v28
    v_perm_b32 v9, v40, v40, v29
    v_perm_b32 v10, v40, v40, v30
    v_perm_b32 v11, v40, v40, v31
    s_waitcnt vmcnt(15)
    s_nop 0
    v_mfma_f32_16x16x32_bf16 v[12:15], v[196:199], v[8:11], v[12:15]
    v_perm_b32 v4, v56, v56, v28
    v_perm_b32 v5, v56, v56, v29
    v_perm_b32 v6, v56, v56, v30
    v_perm_b32 v7, v56, v56, v31
    s_nop 1
    v_mfma_f32_16x16x32_bf16 v[68:71], v[196:199], v[4:7], v[68:71]
    buffer_load_dwordx4 v[132:135], v64, s[4:7], s32 offen nt
    s_add_u32 s32, s32, 8192
    v_perm_b32 v8, v41, v41, v24
    v_perm_b32 v9, v41, v41, v25
    v_perm_b32 v10, v41, v41, v26
    v_perm_b32 v11, v41, v41, v27
    s_waitcnt vmcnt(15)
    s_nop 0
    v_mfma_f32_16x16x32_bf16 v[12:15], v[200:203], v[8:11], v[12:15]
    v_perm_b32 v4, v57, v57, v24
    v_perm_b32 v5, v57, v57, v25
    v_perm_b32 v6, v57, v57, v26
    v_perm_b32 v7, v57, v57, v27
    s_nop 1
    v_mfma_f32_16x16x32_bf16 v[68:71], v[200:203], v[4:7], v[68:71]
    buffer_load_dwordx4 v[136:139], v64, s[4:7], s32 offen nt
    s_add_u32 s32, s32, 8192
    v_perm_b32 v8, v41, v41, v28
    v_perm_b32 v9, v41, v41, v29
    v_perm_b32 v10, v41, v41, v30
    v_perm_b32 v11, v41, v41, v31
    s_waitcnt vmcnt(15)
    s_nop 0
    v_mfma_f32_16x16x32_bf16 v[12:15], v[204:207], v[8:11], v[12:15]
    v_perm_b32 v4, v57, v57, v28
    v_perm_b32 v5, v57, v57, v29
    v_perm_b32 v6, v57, v57, v30
    v_perm_b32 v7, v57, v57, v31
    s_nop 1
    v_mfma_f32_16x16x32_bf16 v[68:71], v[204:207], v[4:7], v[68:71]
    buffer_load_dwordx4 v[140:143], v64, s[4:7], s32 offen nt
    s_add_u32 s32, s32, 8192
    v_perm_b32 v8, v42, v42, v24
    v_perm_b32 v9, v42, v42, v25
    v_perm_b32 v10, v42, v42, v26
    v_perm_b32 v11, v42, v42, v27
    s_waitcnt vmcnt(15)
    s_nop 0
    v_mfma_f32_16x16x32_bf16 v[12:15], v[208:211], v[8:11], v[12:15]
    v_perm_b32 v4, v58, v58, v24
    v_perm_b32 v5, v58, v58, v25
    v_perm_b32 v6, v58, v58, v26
    v_perm_b32 v7, v58, v58, v27
    s_nop 1
    v_mfma_f32_16x16x32_bf16 v[68:71], v[208:211], v[4:7], v[68:71]
    buffer_load_dwordx4 v[144:147], v64, s[4:7], s32 offen nt
    s_add_u32 s32, s32, 8192
    v_perm_b32 v8, v42, v42, v28
    v_perm_b32 v9, v42, v42, v29
    v_perm_b32 v10, v42, v42, v30
    v_perm_b32 v11, v42, v42, v31
    s_waitcnt vmcnt(15)
    s_nop 0
    v_mfma_f32_16x16x32_bf16 v[12:15], v[212:215], v[8:11], v[12:15]
    v_perm_b32 v4, v58, v58, v28
    v_perm_b32 v5, v58, v58, v29
    v_perm_b32 v6, v58, v58, v30
    v_perm_b32 v7, v58, v58, v31
    s_nop 1
    v_mfma_f32_16x16x32_bf16 v[68:71], v[212:215], v[4:7], v[68:71]
    buffer_load_dwordx4 v[148:151], v64, s[4:7], s32 offen nt
    s_add_u32 s32, s32, 8192
    v_perm_b32 v8, v43, v43, v24
    v_perm_b32 v9, v43, v43, v25
    v_perm_b32 v10, v43, v43, v26
    v_perm_b32 v11, v43, v43, v27
    s_waitcnt vmcnt(15)
    s_nop 0
    v_mfma_f32_16x16x32_bf16 v[12:15], v[216:219], v[8:11], v[12:15]
    v_perm_b32 v4, v59, v59, v24
    v_perm_b32 v5, v59, v59, v25
    v_perm_b32 v6, v59, v59, v26
    v_perm_b32 v7, v59, v59, v27
    s_nop 1
    v_mfma_f32_16x16x32_bf16 v[68:71], v[216:219], v[4:7], v[68:71]
    buffer_load_dwordx4 v[152:155], v64, s[4:7], s32 offen nt
    s_add_u32 s32, s32, 8192
    v_perm_b32 v8, v43, v43, v28
    v_perm_b32 v9, v43, v43, v29
    v_perm_b32 v10, v43, v43, v30
    v_perm_b32 v11, v43, v43, v31
    s_waitcnt vmcnt(15)
    s_nop 0
    v_mfma_f32_16x16x32_bf16 v[12:15], v[220:223], v[8:11], v[12:15]
    v_perm_b32 v4, v59, v59, v28
    v_perm_b32 v5, v59, v59, v29
    v_perm_b32 v6, v59, v59, v30
    v_perm_b32 v7, v59, v59, v31
    s_nop 1
    v_mfma_f32_16x16x32_bf16 v[68:71], v[220:223], v[4:7], v[68:71]
    buffer_load_dwordx4 v[156:159], v64, s[4:7], s32 offen nt
    s_add_u32 s32, s32, 8192
    v_perm_b32 v8, v44, v44, v24
    v_perm_b32 v9, v44, v44, v25
    v_perm_b32 v10, v44, v44, v26
    v_perm_b32 v11, v44, v44, v27
    s_waitcnt vmcnt(15)
    s_nop 0
    v_mfma_f32_16x16x32_bf16 v[12:15], v[224:227], v[8:11], v[12:15]
    v_perm_b32 v4, v60, v60, v24
    v_perm_b32 v5, v60, v60, v25
    v_perm_b32 v6, v60, v60, v26
    v_perm_b32 v7, v60, v60, v27
    s_nop 1
    v_mfma_f32_16x16x32_bf16 v[68:71], v[224:227], v[4:7], v[68:71]
    buffer_load_dwordx4 v[160:163], v64, s[4:7], s32 offen nt
    s_add_u32 s32, s32, 8192
    v_perm_b32 v8, v44, v44, v28
    v_perm_b32 v9, v44, v44, v29
    v_perm_b32 v10, v44, v44, v30
    v_perm_b32 v11, v44, v44, v31
    s_waitcnt vmcnt(15)
    s_nop 0
    v_mfma_f32_16x16x32_bf16 v[12:15], v[228:231], v[8:11], v[12:15]
    v_perm_b32 v4, v60, v60, v28
    v_perm_b32 v5, v60, v60, v29
    v_perm_b32 v6, v60, v60, v30
    v_perm_b32 v7, v60, v60, v31
    s_nop 1
    v_mfma_f32_16x16x32_bf16 v[68:71], v[228:231], v[4:7], v[68:71]
    buffer_load_dwordx4 v[164:167], v64, s[4:7], s32 offen nt
    s_add_u32 s32, s32, 8192
    v_perm_b32 v8, v45, v45, v24
    v_perm_b32 v9, v45, v45, v25
    v_perm_b32 v10, v45, v45, v26
    v_perm_b32 v11, v45, v45, v27
    s_waitcnt vmcnt(15)
    s_nop 0
    v_mfma_f32_16x16x32_bf16 v[12:15], v[232:235], v[8:11], v[12:15]
    v_perm_b32 v4, v61, v61, v24
    v_perm_b32 v5, v61, v61, v25
    v_perm_b32 v6, v61, v61, v26
    v_perm_b32 v7, v61, v61, v27
    s_nop 1
    v_mfma_f32_16x16x32_bf16 v[68:71], v[232:235], v[4:7], v[68:71]
    buffer_load_dwordx4 v[168:171], v64, s[4:7], s32 offen nt
    s_add_u32 s32, s32, 8192
    v_perm_b32 v8, v45, v45, v28
    v_perm_b32 v9, v45, v45, v29
    v_perm_b32 v10, v45, v45, v30
    v_perm_b32 v11, v45, v45, v31
    s_waitcnt vmcnt(15)
    s_nop 0
    v_mfma_f32_16x16x32_bf16 v[12:15], v[236:239], v[8:11], v[12:15]
    v_perm_b32 v4, v61, v61, v28
    v_perm_b32 v5, v61, v61, v29
    v_perm_b32 v6, v61, v61, v30
    v_perm_b32 v7, v61, v61, v31
    s_nop 1
    v_mfma_f32_16x16x32_bf16 v[68:71], v[236:239], v[4:7], v[68:71]
    buffer_load_dwordx4 v[172:175], v64, s[4:7], s32 offen nt
    s_add_u32 s32, s32, 8192
    v_perm_b32 v8, v46, v46, v24
    v_perm_b32 v9, v46, v46, v25
    v_perm_b32 v10, v46, v46, v26
    v_perm_b32 v11, v46, v46, v27
    s_waitcnt vmcnt(15)
    s_nop 0
    v_mfma_f32_16x16x32_bf16 v[12:15], v[240:243], v[8:11], v[12:15]
    v_perm_b32 v4, v62, v62, v24
    v_perm_b32 v5, v62, v62, v25
    v_perm_b32 v6, v62, v62, v26
    v_perm_b32 v7, v62, v62, v27
    s_nop 1
    v_mfma_f32_16x16x32_bf16 v[68:71], v[240:243], v[4:7], v[68:71]
    buffer_load_dwordx4 v[176:179], v64, s[4:7], s32 offen nt
    s_add_u32 s32, s32, 8192
    v_perm_b32 v8, v46, v46, v28
    v_perm_b32 v9, v46, v46, v29
    v_perm_b32 v10, v46, v46, v30
    v_perm_b32 v11, v46, v46, v31
    s_waitcnt vmcnt(15)
    s_nop 0
    v_mfma_f32_16x16x32_bf16 v[12:15], v[244:247], v[8:11], v[12:15]
    v_perm_b32 v4, v62, v62, v28
    v_perm_b32 v5, v62, v62, v29
    v_perm_b32 v6, v62, v62, v30
    v_perm_b32 v7, v62, v62, v31
    s_nop 1
    v_mfma_f32_16x16x32_bf16 v[68:71], v[244:247], v[4:7], v[68:71]
    buffer_load_dwordx4 v[180:183], v64, s[4:7], s32 offen nt
    s_add_u32 s32, s32, 8192
    v_perm_b32 v8, v47, v47, v24
    v_perm_b32 v9, v47, v47, v25
    v_perm_b32 v10, v47, v47, v26
    v_perm_b32 v11, v47, v47, v27
    s_waitcnt vmcnt(15)
    s_nop 0
    v_mfma_f32_16x16x32_bf16 v[12:15], v[248:251], v[8:11], v[12:15]
    v_perm_b32 v4, v63, v63, v24
    v_perm_b32 v5, v63, v63, v25
    v_perm_b32 v6, v63, v63, v26
    v_perm_b32 v7, v63, v63, v27
    s_nop 1
    v_mfma_f32_16x16x32_bf16 v[68:71], v[248:251], v[4:7], v[68:71]
    buffer_load_dwordx4 v[184:187], v64, s[4:7], s32 offen nt
    s_add_u32 s32, s32, 8192
    v_perm_b32 v8, v47, v47, v28
    v_perm_b32 v9, v47, v47, v29
    v_perm_b32 v10, v47, v47, v30
    v_perm_b32 v11, v47, v47, v31
    s_waitcnt vmcnt(15)
    s_nop 0
    v_mfma_f32_16x16x32_bf16 v[12:15], v[252:255], v[8:11], v[12:15]
    v_perm_b32 v4, v63, v63, v28
    v_perm_b32 v5, v63, v63, v29
    v_perm_b32 v6, v63, v63, v30
    v_perm_b32 v7, v63, v63, v31
    s_nop 1
    v_mfma_f32_16x16x32_bf16 v[68:71], v[252:255], v[4:7], v[68:71]
    buffer_load_dwordx4 v[188:191], v64, s[4:7], s32 offen nt
    s_add_u32 s32, s32, 8192
    v_lshrrev_b32 v3, 4, v0
    v_lshlrev_b32 v3, 7, v3
    v_and_b32 v4, 7, v0
    v_lshl_add_u32 v3, v4, 2, v3
    v_bfe_u32 v4, v0, 3, 1
    v_lshl_add_u32 v3, v4, 9, v3
    s_lshl_b32 s24, s3, 11
    s_add_u32 s24, s24, 135168
    v_add_u32 v3, s24, v3
    ds_write_b32 v3, v12 offset:0
    ds_write_b32 v3, v13 offset:32
    ds_write_b32 v3, v14 offset:64
    ds_write_b32 v3, v15 offset:96
    ds_write_b32 v3, v68 offset:1024
    ds_write_b32 v3, v69 offset:1056
    ds_write_b32 v3, v70 offset:1088
    ds_write_b32 v3, v71 offset:1120
    s_waitcnt lgkmcnt(0)
    s_barrier
    ds_read_b128 v[72:75], v65 offset:0
    ds_read_b128 v[76:79], v65 offset:16
    ds_read_b128 v[80:83], v65 offset:2048
    ds_read_b128 v[84:87], v65 offset:2064
    ds_read_b128 v[88:91], v65 offset:4096
    ds_read_b128 v[92:95], v65 offset:4112
    ds_read_b128 v[96:99], v65 offset:6144
    ds_read_b128 v[100:103], v65 offset:6160
    s_waitcnt lgkmcnt(4)
    v_add_f32 v72, v72, v80
    v_add_f32 v73, v73, v81
    v_add_f32 v74, v74, v82
    v_add_f32 v75, v75, v83
    v_add_f32 v76, v76, v84
    v_add_f32 v77, v77, v85
    v_add_f32 v78, v78, v86
    v_add_f32 v79, v79, v87
    s_waitcnt lgkmcnt(2)
    v_add_f32 v72, v72, v88
    v_add_f32 v73, v73, v89
    v_add_f32 v74, v74, v90
    v_add_f32 v75, v75, v91
    v_add_f32 v76, v76, v92
    v_add_f32 v77, v77, v93
    v_add_f32 v78, v78, v94
    v_add_f32 v79, v79, v95
    s_waitcnt lgkmcnt(0)
    v_add_f32 v72, v72, v96
    v_add_f32 v73, v73, v97
    v_add_f32 v74, v74, v98
    v_add_f32 v75, v75, v99
    v_add_f32 v76, v76, v100
    v_add_f32 v77, v77, v101
    v_add_f32 v78, v78, v102
    v_add_f32 v79, v79, v103
    v_cvt_pk_bf16_f32 v8, v72, v73
    v_cvt_pk_bf16_f32 v9, v74, v75
    v_cvt_pk_bf16_f32 v10, v76, v77
    v_cvt_pk_bf16_f32 v11, v78, v79
    s_cmp_ge_u32 s74, 32
    s_cbranch_scc1 L_C
L_A2:
    buffer_load_dwordx4 v[192:195], v64, s[4:7], s32 offen nt
    s_add_u32 s32, s32, 8192
    s_waitcnt vmcnt(16)
    v_mfma_f32_16x16x32_bf16 v[68:71], v[128:131], v[8:11], 0
    s_nop 7
    v_add_f32_dpp v72, v69, v68 quad_perm:[1,1,1,1] row_mask:0xf bank_mask:0xf
    s_nop 1
    v_add_f32_dpp v72, v70, v72 quad_perm:[2,2,2,2] row_mask:0xf bank_mask:0xf
    s_nop 1
    v_add_f32_dpp v72, v71, v72 quad_perm:[3,3,3,3] row_mask:0xf bank_mask:0xf
    buffer_load_dwordx4 v[196:199], v64, s[4:7], s32 offen nt
    s_add_u32 s32, s32, 8192
    s_waitcnt vmcnt(16)
    v_mfma_f32_16x16x32_bf16 v[12:15], v[132:135], v[8:11], 0
    s_nop 7
    v_add_f32_dpp v73, v13, v12 quad_perm:[1,1,1,1] row_mask:0xf bank_mask:0xf
    s_nop 1
    v_add_f32_dpp v73, v14, v73 quad_perm:[2,2,2,2] row_mask:0xf bank_mask:0xf
    s_nop 1
    v_add_f32_dpp v73, v15, v73 quad_perm:[3,3,3,3] row_mask:0xf bank_mask:0xf
    buffer_load_dwordx4 v[200:203], v64, s[4:7], s32 offen nt
    s_add_u32 s32, s32, 8192
    s_waitcnt vmcnt(16)
    v_mfma_f32_16x16x32_bf16 v[68:71], v[136:139], v[8:11], 0
    s_nop 7
    v_add_f32_dpp v74, v69, v68 quad_perm:[1,1,1,1] row_mask:0xf bank_mask:0xf
    s_nop 1
    v_add_f32_dpp v74, v70, v74 quad_perm:[2,2,2,2] row_mask:0xf bank_mask:0xf
    s_nop 1
    v_add_f32_dpp v74, v71, v74 quad_perm:[3,3,3,3] row_mask:0xf bank_mask:0xf
    buffer_load_dwordx4 v[204:207], v64, s[4:7], s32 offen nt
    s_add_u32 s32, s32, 8192
    s_waitcnt vmcnt(16)
    v_mfma_f32_16x16x32_bf16 v[12:15], v[140:143], v[8:11], 0
    s_nop 7
    v_add_f32_dpp v75, v13, v12 quad_perm:[1,1,1,1] row_mask:0xf bank_mask:0xf
    s_nop 1
    v_add_f32_dpp v75, v14, v75 quad_perm:[2,2,2,2] row_mask:0xf bank_mask:0xf
    s_nop 1
    v_add_f32_dpp v75, v15, v75 quad_perm:[3,3,3,3] row_mask:0xf bank_mask:0xf
    buffer_load_dwordx4 v[208:211], v64, s[4:7], s32 offen nt
    s_add_u32 s32, s32, 8192
    s_waitcnt vmcnt(16)
    v_mfma_f32_16x16x32_bf16 v[68:71], v[144:147], v[8:11], 0
    s_nop 7
    v_add_f32_dpp v76, v69, v68 quad_perm:[1,1,1,1] row_mask:0xf bank_mask:0xf
    s_nop 1
    v_add_f32_dpp v76, v70, v76 quad_perm:[2,2,2,2] row_mask:0xf bank_mask:0xf
    s_nop 1
    v_add_f32_dpp v76, v71, v76 quad_perm:[3,3,3,3] row_mask:0xf bank_mask:0xf
    buffer_load_dwordx4 v[212:215], v64, s[4:7], s32 offen nt
    s_add_u32 s32, s32, 8192
    s_waitcnt vmcnt(16)
    v_mfma_f32_16x16x32_bf16 v[12:15], v[148:151], v[8:11], 0
    s_nop 7
    v_add_f32_dpp v77, v13, v12 quad_perm:[1,1,1,1] row_mask:0xf bank_mask:0xf
    s_nop 1
    v_add_f32_dpp v77, v14, v77 quad_perm:[2,2,2,2] row_mask:0xf bank_mask:0xf
    s_nop 1
    v_add_f32_dpp v77, v15, v77 quad_perm:[3,3,3,3] row_mask:0xf bank_mask:0xf
    buffer_load_dwordx4 v[216:219], v64, s[4:7], s32 offen nt
    s_add_u32 s32, s32, 8192
    s_waitcnt vmcnt(16)
    v_mfma_f32_16x16x32_bf16 v[68:71], v[152:155], v[8:11], 0
    s_nop 7
    v_add_f32_dpp v78, v69, v68 quad_perm:[1,1,1,1] row_mask:0xf bank_mask:0xf
    s_nop 1
    v_add_f32_dpp v78, v70, v78 quad_perm:[2,2,2,2] row_mask:0xf bank_mask:0xf
    s_nop 1
    v_add_f32_dpp v78, v71, v78 quad_perm:[3,3,3,3] row_mask:0xf bank_mask:0xf
    buffer_load_dwordx4 v[220:223], v64, s[4:7], s32 offen nt
    s_add_u32 s32, s32, 8192
    s_waitcnt vmcnt(16)
    v_mfma_f32_16x16x32_bf16 v[12:15], v[156:159], v[8:11], 0
    s_nop 7
    v_add_f32_dpp v79, v13, v12 quad_perm:[1,1,1,1] row_mask:0xf bank_mask:0xf
    s_nop 1
    v_add_f32_dpp v79, v14, v79 quad_perm:[2,2,2,2] row_mask:0xf bank_mask:0xf
    s_nop 1
    v_add_f32_dpp v79, v15, v79 quad_perm:[3,3,3,3] row_mask:0xf bank_mask:0xf
    buffer_load_dwordx4 v[224:227], v64, s[4:7], s32 offen nt
    s_add_u32 s32, s32, 8192
    s_waitcnt vmcnt(16)
    v_mfma_f32_16x16x32_bf16 v[68:71], v[160:163], v[8:11], 0
    s_nop 7
    v_add_f32_dpp v3, v68, v69 quad_perm:[0,0,0,0] row_mask:0xf bank_mask:0xf
    s_nop 1
    v_add_f32_dpp v3, v70, v3 quad_perm:[2,2,2,2] row_mask:0xf bank_mask:0xf
    s_nop 1
    v_add_f32_dpp v3, v71, v3 quad_perm:[3,3,3,3] row_mask:0xf bank_mask:0xf
    v_cndmask_b32 v72, v72, v3, s[64:65]
    buffer_load_dwordx4 v[228:231], v64, s[4:7], s32 offen nt
    s_add_u32 s32, s32, 8192
    s_waitcnt vmcnt(16)
    v_mfma_f32_16x16x32_bf16 v[12:15], v[164:167], v[8:11], 0
    s_nop 7
    v_add_f32_dpp v3, v12, v13 quad_perm:[0,0,0,0] row_mask:0xf bank_mask:0xf
    s_nop 1
    v_add_f32_dpp v3, v14, v3 quad_perm:[2,2,2,2] row_mask:0xf bank_mask:0xf
    s_nop 1
    v_add_f32_dpp v3, v15, v3 quad_perm:[3,3,3,3] row_mask:0xf bank_mask:0xf
    v_cndmask_b32 v73, v73, v3, s[64:65]
    buffer_load_dwordx4 v[232:235], v64, s[4:7], s32 offen nt
    s_add_u32 s32, s32, 8192
    s_waitcnt vmcnt(16)
    v_mfma_f32_16x16x32_bf16 v[68:71], v[168:171], v[8:11], 0
    s_nop 7
    v_add_f32_dpp v3, v68, v69 quad_perm:[0,0,0,0] row_mask:0xf bank_mask:0xf
    s_nop 1
    v_add_f32_dpp v3, v70, v3 quad_perm:[2,2,2,2] row_mask:0xf bank_mask:0xf
    s_nop 1
    v_add_f32_dpp v3, v71, v3 quad_perm:[3,3,3,3] row_mask:0xf bank_mask:0xf
    v_cndmask_b32 v74, v74, v3, s[64:65]
    buffer_load_dwordx4 v[236:239], v64, s[4:7], s32 offen nt
    s_add_u32 s32, s32, 8192
    s_waitcnt vmcnt(16)
    v_mfma_f32_16x16x32_bf16 v[12:15], v[172:175], v[8:11], 0
    s_nop 7
    v_add_f32_dpp v3, v12, v13 quad_perm:[0,0,0,0] row_mask:0xf bank_mask:0xf
    s_nop 1
    v_add_f32_dpp v3, v14, v3 quad_perm:[2,2,2,2] row_mask:0xf bank_mask:0xf
    s_nop 1
    v_add_f32_dpp v3, v15, v3 quad_perm:[3,3,3,3] row_mask:0xf bank_mask:0xf
    v_cndmask_b32 v75, v75, v3, s[64:65]
    buffer_load_dwordx4 v[240:243], v64, s[4:7], s32 offen nt
    s_add_u32 s32, s32, 8192
    s_waitcnt vmcnt(16)
    v_mfma_f32_16x16x32_bf16 v[68:71], v[176:179], v[8:11], 0
    s_nop 7
    v_add_f32_dpp v3, v68, v69 quad_perm:[0,0,0,0] row_mask:0xf bank_mask:0xf
    s_nop 1
    v_add_f32_dpp v3, v70, v3 quad_perm:[2,2,2,2] row_mask:0xf bank_mask:0xf
    s_nop 1
    v_add_f32_dpp v3, v71, v3 quad_perm:[3,3,3,3] row_mask:0xf bank_mask:0xf
    v_cndmask_b32 v76, v76, v3, s[64:65]
    buffer_load_dwordx4 v[244:247], v64, s[4:7], s32 offen nt
    s_add_u32 s32, s32, 8192
    s_waitcnt vmcnt(16)
    v_mfma_f32_16x16x32_bf16 v[12:15], v[180:183], v[8:11], 0
    s_nop 7
    v_add_f32_dpp v3, v12, v13 quad_perm:[0,0,0,0] row_mask:0xf bank_mask:0xf
    s_nop 1
    v_add_f32_dpp v3, v14, v3 quad_perm:[2,2,2,2] row_mask:0xf bank_mask:0xf
    s_nop 1
    v_add_f32_dpp v3, v15, v3 quad_perm:[3,3,3,3] row_mask:0xf bank_mask:0xf
    v_cndmask_b32 v77, v77, v3, s[64:65]
    buffer_load_dwordx4 v[248:251], v64, s[4:7], s32 offen nt
    s_add_u32 s32, s32, 8192
    s_waitcnt vmcnt(16)
    v_mfma_f32_16x16x32_bf16 v[68:71], v[184:187], v[8:11], 0
    s_nop 7
    v_add_f32_dpp v3, v68, v69 quad_perm:[0,0,0,0] row_mask:0xf bank_mask:0xf
    s_nop 1
    v_add_f32_dpp v3, v70, v3 quad_perm:[2,2,2,2] row_mask:0xf bank_mask:0xf
    s_nop 1
    v_add_f32_dpp v3, v71, v3 quad_perm:[3,3,3,3] row_mask:0xf bank_mask:0xf
    v_cndmask_b32 v78, v78, v3, s[64:65]
    buffer_load_dwordx4 v[252:255], v64, s[4:7], s32 offen nt
    s_add_u32 s32, s32, 8192
    s_waitcnt vmcnt(16)
    v_mfma_f32_16x16x32_bf16 v[12:15], v[188:191], v[8:11], 0
    s_nop 7
    v_add_f32_dpp v3, v12, v13 quad_perm:[0,0,0,0] row_mask:0xf bank_mask:0xf
    s_nop 1
    v_add_f32_dpp v3, v14, v3 quad_perm:[2,2,2,2] row_mask:0xf bank_mask:0xf
    s_nop 1
    v_add_f32_dpp v3, v15, v3 quad_perm:[3,3,3,3] row_mask:0xf bank_mask:0xf
    v_cndmask_b32 v79, v79, v3, s[64:65]
    s_waitcnt vmcnt(15)
    v_mfma_f32_16x16x32_bf16 v[68:71], v[192:195], v[8:11], 0
    s_nop 7
    v_add_f32_dpp v3, v68, v70 quad_perm:[0,0,0,0] row_mask:0xf bank_mask:0xf
    s_nop 1
    v_add_f32_dpp v3, v69, v3 quad_perm:[1,1,1,1] row_mask:0xf bank_mask:0xf
    s_nop 1
    v_add_f32_dpp v3, v71, v3 quad_perm:[3,3,3,3] row_mask:0xf bank_mask:0xf
    v_cndmask_b32 v72, v72, v3, s[66:67]
    s_waitcnt vmcnt(14)
    v_mfma_f32_16x16x32_bf16 v[12:15], v[196:199], v[8:11], 0
    s_nop 7
    v_add_f32_dpp v3, v12, v14 quad_perm:[0,0,0,0] row_mask:0xf bank_mask:0xf
    s_nop 1
    v_add_f32_dpp v3, v13, v3 quad_perm:[1,1,1,1] row_mask:0xf bank_mask:0xf
    s_nop 1
    v_add_f32_dpp v3, v15, v3 quad_perm:[3,3,3,3] row_mask:0xf bank_mask:0xf
    v_cndmask_b32 v73, v73, v3, s[66:67]
    s_waitcnt vmcnt(13)
    v_mfma_f32_16x16x32_bf16 v[68:71], v[200:203], v[8:11], 0
    s_nop 7
    v_add_f32_dpp v3, v68, v70 quad_perm:[0,0,0,0] row_mask:0xf bank_mask:0xf
    s_nop 1
    v_add_f32_dpp v3, v69, v3 quad_perm:[1,1,1,1] row_mask:0xf bank_mask:0xf
    s_nop 1
    v_add_f32_dpp v3, v71, v3 quad_perm:[3,3,3,3] row_mask:0xf bank_mask:0xf
    v_cndmask_b32 v74, v74, v3, s[66:67]
    s_waitcnt vmcnt(12)
    v_mfma_f32_16x16x32_bf16 v[12:15], v[204:207], v[8:11], 0
    s_nop 7
    v_add_f32_dpp v3, v12, v14 quad_perm:[0,0,0,0] row_mask:0xf bank_mask:0xf
    s_nop 1
    v_add_f32_dpp v3, v13, v3 quad_perm:[1,1,1,1] row_mask:0xf bank_mask:0xf
    s_nop 1
    v_add_f32_dpp v3, v15, v3 quad_perm:[3,3,3,3] row_mask:0xf bank_mask:0xf
    v_cndmask_b32 v75, v75, v3, s[66:67]
    s_waitcnt vmcnt(11)
    v_mfma_f32_16x16x32_bf16 v[68:71], v[208:211], v[8:11], 0
    s_nop 7
    v_add_f32_dpp v3, v68, v70 quad_perm:[0,0,0,0] row_mask:0xf bank_mask:0xf
    s_nop 1
    v_add_f32_dpp v3, v69, v3 quad_perm:[1,1,1,1] row_mask:0xf bank_mask:0xf
    s_nop 1
    v_add_f32_dpp v3, v71, v3 quad_perm:[3,3,3,3] row_mask:0xf bank_mask:0xf
    v_cndmask_b32 v76, v76, v3, s[66:67]
    s_waitcnt vmcnt(10)
    v_mfma_f32_16x16x32_bf16 v[12:15], v[212:215], v[8:11], 0
    s_nop 7
    v_add_f32_dpp v3, v12, v14 quad_perm:[0,0,0,0] row_mask:0xf bank_mask:0xf
    s_nop 1
    v_add_f32_dpp v3, v13, v3 quad_perm:[1,1,1,1] row_mask:0xf bank_mask:0xf
    s_nop 1
    v_add_f32_dpp v3, v15, v3 quad_perm:[3,3,3,3] row_mask:0xf bank_mask:0xf
    v_cndmask_b32 v77, v77, v3, s[66:67]
    s_waitcnt vmcnt(9)
    v_mfma_f32_16x16x32_bf16 v[68:71], v[216:219], v[8:11], 0
    s_nop 7
    v_add_f32_dpp v3, v68, v70 quad_perm:[0,0,0,0] row_mask:0xf bank_mask:0xf
    s_nop 1
    v_add_f32_dpp v3, v69, v3 quad_perm:[1,1,1,1] row_mask:0xf bank_mask:0xf
    s_nop 1
    v_add_f32_dpp v3, v71, v3 quad_perm:[3,3,3,3] row_mask:0xf bank_mask:0xf
    v_cndmask_b32 v78, v78, v3, s[66:67]
    s_waitcnt vmcnt(8)
    v_mfma_f32_16x16x32_bf16 v[12:15], v[220:223], v[8:11], 0
    s_nop 7
    v_add_f32_dpp v3, v12, v14 quad_perm:[0,0,0,0] row_mask:0xf bank_mask:0xf
    s_nop 1
    v_add_f32_dpp v3, v13, v3 quad_perm:[1,1,1,1] row_mask:0xf bank_mask:0xf
    s_nop 1
    v_add_f32_dpp v3, v15, v3 quad_perm:[3,3,3,3] row_mask:0xf bank_mask:0xf
    v_cndmask_b32 v79, v79, v3, s[66:67]
    s_waitcnt vmcnt(7)
    v_mfma_f32_16x16x32_bf16 v[68:71], v[224:227], v[8:11], 0
    s_nop 7
    v_add_f32_dpp v3, v68, v71 quad_perm:[0,0,0,0] row_mask:0xf bank_mask:0xf
    s_nop 1
    v_add_f32_dpp v3, v69, v3 quad_perm:[1,1,1,1] row_mask:0xf bank_mask:0xf
    s_nop 1
    v_add_f32_dpp v3, v70, v3 quad_perm:[2,2,2,2] row_mask:0xf bank_mask:0xf
    v_cndmask_b32 v72, v72, v3, s[68:69]
    s_waitcnt vmcnt(6)
    v_mfma_f32_16x16x32_bf16 v[12:15], v[228:231], v[8:11], 0
    s_nop 7
    v_add_f32_dpp v3, v12, v15 quad_perm:[0,0,0,0] row_mask:0xf bank_mask:0xf
    s_nop 1
    v_add_f32_dpp v3, v13, v3 quad_perm:[1,1,1,1] row_mask:0xf bank_mask:0xf
    s_nop 1
    v_add_f32_dpp v3, v14, v3 quad_perm:[2,2,2,2] row_mask:0xf bank_mask:0xf
    v_cndmask_b32 v73, v73, v3, s[68:69]
    s_waitcnt vmcnt(5)
    v_mfma_f32_16x16x32_bf16 v[68:71], v[232:235], v[8:11], 0
    s_nop 7
    v_add_f32_dpp v3, v68, v71 quad_perm:[0,0,0,0] row_mask:0xf bank_mask:0xf
    s_nop 1
    v_add_f32_dpp v3, v69, v3 quad_perm:[1,1,1,1] row_mask:0xf bank_mask:0xf
    s_nop 1
    v_add_f32_dpp v3, v70, v3 quad_perm:[2,2,2,2] row_mask:0xf bank_mask:0xf
    v_cndmask_b32 v74, v74, v3, s[68:69]
    s_waitcnt vmcnt(4)
    v_mfma_f32_16x16x32_bf16 v[12:15], v[236:239], v[8:11], 0
    s_nop 7
    v_add_f32_dpp v3, v12, v15 quad_perm:[0,0,0,0] row_mask:0xf bank_mask:0xf
    s_nop 1
    v_add_f32_dpp v3, v13, v3 quad_perm:[1,1,1,1] row_mask:0xf bank_mask:0xf
    s_nop 1
    v_add_f32_dpp v3, v14, v3 quad_perm:[2,2,2,2] row_mask:0xf bank_mask:0xf
    v_cndmask_b32 v75, v75, v3, s[68:69]
    s_waitcnt vmcnt(3)
    v_mfma_f32_16x16x32_bf16 v[68:71], v[240:243], v[8:11], 0
    s_nop 7
    v_add_f32_dpp v3, v68, v71 quad_perm:[0,0,0,0] row_mask:0xf bank_mask:0xf
    s_nop 1
    v_add_f32_dpp v3, v69, v3 quad_perm:[1,1,1,1] row_mask:0xf bank_mask:0xf
    s_nop 1
    v_add_f32_dpp v3, v70, v3 quad_perm:[2,2,2,2] row_mask:0xf bank_mask:0xf
    v_cndmask_b32 v76, v76, v3, s[68:69]
    s_waitcnt vmcnt(2)
    v_mfma_f32_16x16x32_bf16 v[12:15], v[244:247], v[8:11], 0
    s_nop 7
    v_add_f32_dpp v3, v12, v15 quad_perm:[0,0,0,0] row_mask:0xf bank_mask:0xf
    s_nop 1
    v_add_f32_dpp v3, v13, v3 quad_perm:[1,1,1,1] row_mask:0xf bank_mask:0xf
    s_nop 1
    v_add_f32_dpp v3, v14, v3 quad_perm:[2,2,2,2] row_mask:0xf bank_mask:0xf
    v_cndmask_b32 v77, v77, v3, s[68:69]
    s_waitcnt vmcnt(1)
    v_mfma_f32_16x16x32_bf16 v[68:71], v[248:251], v[8:11], 0
    s_nop 7
    v_add_f32_dpp v3, v68, v71 quad_perm:[0,0,0,0] row_mask:0xf bank_mask:0xf
    s_nop 1
    v_add_f32_dpp v3, v69, v3 quad_perm:[1,1,1,1] row_mask:0xf bank_mask:0xf
    s_nop 1
    v_add_f32_dpp v3, v70, v3 quad_perm:[2,2,2,2] row_mask:0xf bank_mask:0xf
    v_cndmask_b32 v78, v78, v3, s[68:69]
    s_waitcnt vmcnt(0)
    v_mfma_f32_16x16x32_bf16 v[12:15], v[252:255], v[8:11], 0
    s_nop 7
    v_add_f32_dpp v3, v12, v15 quad_perm:[0,0,0,0] row_mask:0xf bank_mask:0xf
    s_nop 1
    v_add_f32_dpp v3, v13, v3 quad_perm:[1,1,1,1] row_mask:0xf bank_mask:0xf
    s_nop 1
    v_add_f32_dpp v3, v14, v3 quad_perm:[2,2,2,2] row_mask:0xf bank_mask:0xf
    v_cndmask_b32 v79, v79, v3, s[68:69]
    s_mov_b32 s71, 0x3e0293ee
    v_mul_f32 v72, s71, v72
    v_mul_f32 v73, s71, v73
    v_mul_f32 v74, s71, v74
    v_mul_f32 v75, s71, v75
    v_mul_f32 v76, s71, v76
    v_mul_f32 v77, s71, v77
    v_mul_f32 v78, s71, v78
    v_mul_f32 v79, s71, v79
    v_cvt_pk_bf16_f32 v4, v72, v73
    v_cvt_pk_bf16_f32 v5, v74, v75
    v_cvt_pk_bf16_f32 v6, v76, v77
    v_cvt_pk_bf16_f32 v7, v78, v79
    s_lshl_b32 s24, s26, 10
    s_lshl_b32 s25, s3, 8
    s_add_u32 s24, s24, s25
    s_add_u32 s24, s24, 0x0
    buffer_store_dwordx4 v[4:7], v66, s[12:15], s24 offen sc1
    s_waitcnt vmcnt(0)
    s_barrier
    s_cmp_lg_u32 s3, 0
    s_cbranch_scc1 L_sig5
    s_mov_b64 exec, 1
    v_mov_b32 v3, 1
    buffer_atomic_add v3, off, s[16:19], 0 offset:0 sc0
    s_waitcnt vmcnt(0)
    v_readfirstlane_b32 s24, v3
    s_mov_b64 exec, -1
    s_and_b32 s24, s24, 63
    s_cmp_lg_u32 s24, 63
    s_cbranch_scc1 L_sig5
    v_lshlrev_b32 v4, 7, v0
    v_mov_b32 v3, 1
    s_mov_b32 s24, 0x170000
    buffer_store_dword v3, v4, s[12:15], s24 offen offset:0 sc1
L_sig5:
    s_mov_b32 s4, s44
    s_mov_b32 s5, s45
    s_mov_b32 s6, 0x400000
    s_mov_b32 s7, 0x20000
    s_mov_b32 s8, s46
    s_mov_b32 s9, s47
    s_mov_b32 s10, 0x400000
    s_mov_b32 s11, 0x20000
    s_lshl_b32 s33, s26, 17
    s_lshl_b32 s24, s3, 15
    s_add_u32 s33, s33, s24
    s_mul_i32 s34, s3, 33792
    s_mov_b32 s70, 0
L_woA:
    s_and_b32 s24, s70, 3
    s_lshl_b32 s24, s24, 1
    s_lshr_b32 s25, s70, 2
    s_or_b32 s24, s24, s25
    s_lshl_b32 s24, s24, 10
    s_add_u32 s24, s24, s33
    s_mul_i32 s25, s70, 4224
    s_add_u32 m0, s25, s34
    s_waitcnt vmcnt(24)
    buffer_load_dwordx4 v2, s[8:11], s24 offen nt lds
    s_add_u32 m0, m0, 1056
    s_add_u32 s24, s24, 8192
    s_waitcnt vmcnt(24)
    buffer_load_dwordx4 v2, s[8:11], s24 offen nt lds
    s_add_u32 m0, m0, 1056
    s_add_u32 s24, s24, 8192
    s_waitcnt vmcnt(24)
    buffer_load_dwordx4 v2, s[8:11], s24 offen nt lds
    s_add_u32 m0, m0, 1056
    s_add_u32 s24, s24, 8192
    s_waitcnt vmcnt(24)
    buffer_load_dwordx4 v2, s[8:11], s24 offen nt lds
    s_add_u32 s70, s70, 1
    s_cmp_lt_u32 s70, 8
    s_cbranch_scc1 L_woA
    s_mov_b32 s32, s35
    buffer_load_dwordx4 v[128:131], v18, s[4:7], s32 offen nt
    s_add_u32 s32, s32, 8192
    buffer_load_dwordx4 v[132:135], v18, s[4:7], s32 offen nt
    s_add_u32 s32, s32, 8192
    buffer_load_dwordx4 v[136:139], v18, s[4:7], s32 offen nt
    s_add_u32 s32, s32, 8192
    buffer_load_dwordx4 v[140:143], v18, s[4:7], s32 offen nt
    s_add_u32 s32, s32, 8192
    buffer_load_dwordx4 v[144:147], v18, s[4:7], s32 offen nt
    s_add_u32 s32, s32, 8192
    buffer_load_dwordx4 v[148:151], v18, s[4:7], s32 offen nt
    s_add_u32 s32, s32, 8192
    buffer_load_dwordx4 v[152:155], v18, s[4:7], s32 offen nt
    s_add_u32 s32, s32, 8192
    buffer_load_dwordx4 v[156:159], v18, s[4:7], s32 offen nt
    s_add_u32 s32, s32, 8192
    buffer_load_dwordx4 v[160:163], v18, s[4:7], s32 offen nt
    s_add_u32 s32, s32, 8192
    buffer_load_dwordx4 v[164:167], v18, s[4:7], s32 offen nt
    s_add_u32 s32, s32, 8192
    buffer_load_dwordx4 v[168:171], v18, s[4:7], s32 offen nt
    s_add_u32 s32, s32, 8192
    buffer_load_dwordx4 v[172:175], v18, s[4:7], s32 offen nt
    s_add_u32 s32, s32, 8192
    buffer_load_dwordx4 v[176:179], v18, s[4:7], s32 offen nt
    s_add_u32 s32, s32, 8192
    buffer_load_dwordx4 v[180:183], v18, s[4:7], s32 offen nt
    s_add_u32 s32, s32, 8192
    buffer_load_dwordx4 v[184:187], v18, s[4:7], s32 offen nt
    s_add_u32 s32, s32, 8192
    buffer_load_dwordx4 v[188:191], v18, s[4:7], s32 offen nt
    s_add_u32 s32, s32, 8192
    buffer_load_dwordx4 v[192:195], v18, s[4:7], s32 offen nt
    s_add_u32 s32, s32, 8192
    buffer_load_dwordx4 v[196:199], v18, s[4:7], s32 offen nt
    s_add_u32 s32, s32, 8192
    buffer_load_dwordx4 v[200:203], v18, s[4:7], s32 offen nt
    s_add_u32 s32, s32, 8192
    buffer_load_dwordx4 v[204:207], v18, s[4:7], s32 offen nt
    s_add_u32 s32, s32, 8192
    buffer_load_dwordx4 v[208:211], v18, s[4:7], s32 offen nt
    s_add_u32 s32, s32, 8192
    buffer_load_dwordx4 v[212:215], v18, s[4:7], s32 offen nt
    s_add_u32 s32, s32, 8192
    buffer_load_dwordx4 v[216:219], v18, s[4:7], s32 offen nt
    s_add_u32 s32, s32, 8192
    buffer_load_dwordx4 v[220:223], v18, s[4:7], s32 offen nt
    s_add_u32 s32, s32, 8192
    buffer_load_dwordx4 v[224:227], v18, s[4:7], s32 offen nt
    s_add_u32 s32, s32, 8192
    buffer_load_dwordx4 v[228:231], v18, s[4:7], s32 offen nt
    s_add_u32 s32, s32, 8192
    buffer_load_dwordx4 v[232:235], v18, s[4:7], s32 offen nt
    s_add_u32 s32, s32, 8192
    buffer_load_dwordx4 v[236:239], v18, s[4:7], s32 offen nt
    s_add_u32 s32, s32, 8192
    buffer_load_dwordx4 v[240:243], v18, s[4:7], s32 offen nt
    s_add_u32 s32, s32, 8192
    buffer_load_dwordx4 v[244:247], v18, s[4:7], s32 offen nt
    s_add_u32 s32, s32, 8192
    buffer_load_dwordx4 v[248:251], v18, s[4:7], s32 offen nt
    s_add_u32 s32, s32, 8192
    buffer_load_dwordx4 v[252:255], v18, s[4:7], s32 offen nt
    s_add_u32 s32, s32, 8192
    s_waitcnt vmcnt(32)
    s_barrier
    v_lshrrev_b32 v3, 2, v0
    v_mul_u32_u24 v3, 1056, v3
    v_and_b32 v4, 3, v0
    v_lshl_add_u32 v3, v4, 3, v3
    s_mul_i32 s24, s3, 256
    s_add_u32 s24, s24, 0
    v_add_u32 v3, s24, v3
    v_add_u32 v4, 67584, v3
    ds_read_b64_tr_b16 a[0:1], v3 offset:0
    ds_read_b64_tr_b16 a[2:3], v3 offset:16896
    ds_read_b64_tr_b16 a[4:5], v3 offset:33792
    ds_read_b64_tr_b16 a[6:7], v3 offset:50688
    ds_read_b64_tr_b16 a[8:9], v4 offset:0
    ds_read_b64_tr_b16 a[10:11], v4 offset:16896
    ds_read_b64_tr_b16 a[12:13], v4 offset:33792
    ds_read_b64_tr_b16 a[14:15], v4 offset:50688
    ds_read_b64_tr_b16 a[16:17], v3 offset:32
    ds_read_b64_tr_b16 a[18:19], v3 offset:16928
    ds_read_b64_tr_b16 a[20:21], v3 offset:33824
    ds_read_b64_tr_b16 a[22:23], v3 offset:50720
    ds_read_b64_tr_b16 a[24:25], v4 offset:32
    ds_read_b64_tr_b16 a[26:27], v4 offset:16928
    ds_read_b64_tr_b16 a[28:29], v4 offset:33824
    ds_read_b64_tr_b16 a[30:31], v4 offset:50720
    ds_read_b64_tr_b16 a[32:33], v3 offset:64
    ds_read_b64_tr_b16 a[34:35], v3 offset:16960
    ds_read_b64_tr_b16 a[36:37], v3 offset:33856
    ds_read_b64_tr_b16 a[38:39], v3 offset:50752
    ds_read_b64_tr_b16 a[40:41], v4 offset:64
    ds_read_b64_tr_b16 a[42:43], v4 offset:16960
    ds_read_b64_tr_b16 a[44:45], v4 offset:33856
    ds_read_b64_tr_b16 a[46:47], v4 offset:50752
    ds_read_b64_tr_b16 a[48:49], v3 offset:96
    ds_read_b64_tr_b16 a[50:51], v3 offset:16992
    ds_read_b64_tr_b16 a[52:53], v3 offset:33888
    ds_read_b64_tr_b16 a[54:55], v3 offset:50784
    ds_read_b64_tr_b16 a[56:57], v4 offset:96
    ds_read_b64_tr_b16 a[58:59], v4 offset:16992
    ds_read_b64_tr_b16 a[60:61], v4 offset:33888
    ds_read_b64_tr_b16 a[62:63], v4 offset:50784
    ds_read_b64_tr_b16 a[64:65], v3 offset:128
    ds_read_b64_tr_b16 a[66:67], v3 offset:17024
    ds_read_b64_tr_b16 a[68:69], v3 offset:33920
    ds_read_b64_tr_b16 a[70:71], v3 offset:50816
    ds_read_b64_tr_b16 a[72:73], v4 offset:128
    ds_read_b64_tr_b16 a[74:75], v4 offset:17024
    ds_read_b64_tr_b16 a[76:77], v4 offset:33920
    ds_read_b64_tr_b16 a[78:79], v4 offset:50816
    ds_read_b64_tr_b16 a[80:81], v3 offset:160
    ds_read_b64_tr_b16 a[82:83], v3 offset:17056
    ds_read_b64_tr_b16 a[84:85], v3 offset:33952
    ds_read_b64_tr_b16 a[86:87], v3 offset:50848
    ds_read_b64_tr_b16 a[88:89], v4 offset:160
    ds_read_b64_tr_b16 a[90:91], v4 offset:17056
    ds_read_b64_tr_b16 a[92:93], v4 offset:33952
    ds_read_b64_tr_b16 a[94:95], v4 offset:50848
    ds_read_b64_tr_b16 a[96:97], v3 offset:192
    ds_read_b64_tr_b16 a[98:99], v3 offset:17088
    ds_read_b64_tr_b16 a[100:101], v3 offset:33984
    ds_read_b64_tr_b16 a[102:103], v3 offset:50880
    ds_read_b64_tr_b16 a[104:105], v4 offset:192
    ds_read_b64_tr_b16 a[106:107], v4 offset:17088
    ds_read_b64_tr_b16 a[108:109], v4 offset:33984
    ds_read_b64_tr_b16 a[110:111], v4 offset:50880
    ds_read_b64_tr_b16 a[112:113], v3 offset:224
    ds_read_b64_tr_b16 a[114:115], v3 offset:17120
    ds_read_b64_tr_b16 a[116:117], v3 offset:34016
    ds_read_b64_tr_b16 a[118:119], v3 offset:50912
    ds_read_b64_tr_b16 a[120:121], v4 offset:224
    ds_read_b64_tr_b16 a[122:123], v4 offset:17120
    ds_read_b64_tr_b16 a[124:125], v4 offset:34016
    ds_read_b64_tr_b16 a[126:127], v4 offset:50912
    s_waitcnt lgkmcnt(0)
    s_barrier
    s_mov_b32 s8, s56
    s_mov_b32 s9, s57
    s_mov_b32 s10, 0x400000
    s_mov_b32 s11, 0x20000
    s_lshl_b32 s33, s26, 17
    s_lshl_b32 s24, s3, 15
    s_add_u32 s33, s33, s24
    s_add_u32 s33, s33, 0
    s_mul_i32 s34, s3, 17408
    s_add_u32 s34, s34, 0
    s_mov_b32 exec_hi, 0
    s_mov_b32 s70, 0
L_woW:
    s_and_b32 s24, s70, 1
    s_lshl_b32 s24, s24, 4
    s_and_b32 s25, s70, 4
    s_lshl_b32 s25, s25, 1
    s_or_b32 s24, s24, s25
    s_bfe_u32 s25, s70, 0x10001
    s_or_b32 s24, s24, s25
    s_lshl_b32 s24, s24, 10
    s_add_u32 s24, s24, s33
    s_mul_i32 s25, s70, 2176
    s_add_u32 m0, s25, s34
    s_waitcnt vmcnt(24)
    buffer_load_dwordx4 v2, s[8:11], s24 offen nt lds
    s_add_u32 m0, m0, 544
    s_add_u32 s24, s24, 2048
    s_waitcnt vmcnt(24)
    buffer_load_dwordx4 v2, s[8:11], s24 offen nt lds
    s_add_u32 m0, m0, 544
    s_add_u32 s24, s24, 2048
    s_waitcnt vmcnt(24)
    buffer_load_dwordx4 v2, s[8:11], s24 offen nt lds
    s_add_u32 m0, m0, 544
    s_add_u32 s24, s24, 2048
    s_waitcnt vmcnt(24)
    buffer_load_dwordx4 v2, s[8:11], s24 offen nt lds
    s_add_u32 s70, s70, 1
    s_cmp_lt_u32 s70, 8
    s_cbranch_scc1 L_woW
    s_mov_b64 exec, -1
    s_waitcnt vmcnt(0)
    s_barrier
    v_lshrrev_b32 v3, 2, v0
    v_mul_u32_u24 v3, 544, v3
    v_and_b32 v4, 3, v0
    v_lshl_add_u32 v3, v4, 3, v3
    s_mul_i32 s24, s3, 128
    s_add_u32 s24, s24, 0
    v_add_u32 v3, s24, v3
    v_add_u32 v4, 34816, v3
    ds_read_b64_tr_b16 a[128:129], v3 offset:0
    ds_read_b64_tr_b16 a[130:131], v3 offset:8704
    ds_read_b64_tr_b16 a[132:133], v3 offset:17408
    ds_read_b64_tr_b16 a[134:135], v3 offset:26112
    ds_read_b64_tr_b16 a[136:137], v4 offset:0
    ds_read_b64_tr_b16 a[138:139], v4 offset:8704
    ds_read_b64_tr_b16 a[140:141], v4 offset:17408
    ds_read_b64_tr_b16 a[142:143], v4 offset:26112
    ds_read_b64_tr_b16 a[144:145], v3 offset:32
    ds_read_b64_tr_b16 a[146:147], v3 offset:8736
    ds_read_b64_tr_b16 a[148:149], v3 offset:17440
    ds_read_b64_tr_b16 a[150:151], v3 offset:26144
    ds_read_b64_tr_b16 a[152:153], v4 offset:32
    ds_read_b64_tr_b16 a[154:155], v4 offset:8736
    ds_read_b64_tr_b16 a[156:157], v4 offset:17440
    ds_read_b64_tr_b16 a[158:159], v4 offset:26144
    ds_read_b64_tr_b16 a[160:161], v3 offset:64
    ds_read_b64_tr_b16 a[162:163], v3 offset:8768
    ds_read_b64_tr_b16 a[164:165], v3 offset:17472
    ds_read_b64_tr_b16 a[166:167], v3 offset:26176
    ds_read_b64_tr_b16 a[168:169], v4 offset:64
    ds_read_b64_tr_b16 a[170:171], v4 offset:8768
    ds_read_b64_tr_b16 a[172:173], v4 offset:17472
    ds_read_b64_tr_b16 a[174:175], v4 offset:26176
    ds_read_b64_tr_b16 a[176:177], v3 offset:96
    ds_read_b64_tr_b16 a[178:179], v3 offset:8800
    ds_read_b64_tr_b16 a[180:181], v3 offset:17504
    ds_read_b64_tr_b16 a[182:183], v3 offset:26208
    ds_read_b64_tr_b16 a[184:185], v4 offset:96
    ds_read_b64_tr_b16 a[186:187], v4 offset:8800
    ds_read_b64_tr_b16 a[188:189], v4 offset:17504
    ds_read_b64_tr_b16 a[190:191], v4 offset:26208
    s_waitcnt lgkmcnt(0)
    s_cmp_lg_u32 s3, 0
    s_cbranch_scc1 L_awx6
    s_mov_b32 s24, 262144
    s_mov_b64 exec, 1
L_aw7:
    buffer_load_dword v1, off, s[12:15], s73 offset:0 sc1
    s_waitcnt vmcnt(0)
    v_readfirstlane_b32 s25, v1
    s_nop 0
    s_cmp_eq_u32 s25, 1
    s_cbranch_scc1 L_awx6
    s_sleep 4
    s_sub_u32 s24, s24, 1
    s_cmp_lg_u32 s24, 0
    s_cbranch_scc1 L_aw7
L_awx6:
    s_mov_b64 exec, -1
    s_barrier
    s_cmp_lg_u32 s3, 0
    s_cbranch_scc1 L_xi8
    s_getreg_b32 s25, hwreg(HW_REG_XCC_ID, 0, 4)
    s_lshl_b32 s24, s26, 7
    s_add_u32 s24, s24, 0x1b4000
    s_mov_b64 exec, 1
    v_mov_b32 v3, s25
    buffer_store_dword v3, off, s[12:15], s24 offset:0 sc1
    s_mov_b64 exec, -1
L_xi8:
    s_cmp_lg_u32 s3, 0
    s_cbranch_scc1 L_awx9
    s_mov_b32 s24, 262144
    s_mov_b64 exec, 1
L_aw10:
    buffer_load_dword v1, off, s[12:15], s73 offset:4 sc1
    s_waitcnt vmcnt(0)
    v_readfirstlane_b32 s25, v1
    s_nop 0
    s_cmp_eq_u32 s25, 1
    s_cbranch_scc1 L_awx9
    s_sleep 4
    s_sub_u32 s24, s24, 1
    s_cmp_lg_u32 s24, 0
    s_cbranch_scc1 L_aw10
L_awx9:
    s_mov_b64 exec, -1
    s_barrier
    s_lshl_b32 s24, s26, 2
    s_add_u32 s24, s24, s3
    s_lshl_b32 s25, s24, 6
    s_add_u32 s25, s25, 0x120000
    v_and_b32 v3, 7, v0
    v_lshlrev_b32 v3, 3, v3
    buffer_load_dwordx2 v[4:5], v3, s[12:15], s25 offen sc1
    s_lshl_b32 s24, s24, 13
    s_add_u32 s24, s24, 0x20000
    buffer_load_dwordx4 v[72:75], v2, s[12:15], s24 offen offset:0 sc1
    buffer_load_dwordx4 v[76:79], v2, s[12:15], s24 offen offset:1024 sc1
    buffer_load_dwordx4 v[80:83], v2, s[12:15], s24 offen offset:2048 sc1
    buffer_load_dwordx4 v[84:87], v2, s[12:15], s24 offen offset:3072 sc1
    s_add_u32 s24, s24, 4096
    buffer_load_dwordx4 v[88:91], v2, s[12:15], s24 offen offset:0 sc1
    buffer_load_dwordx4 v[92:95], v2, s[12:15], s24 offen offset:1024 sc1
    buffer_load_dwordx4 v[96:99], v2, s[12:15], s24 offen offset:2048 sc1
    buffer_load_dwordx4 v[100:103], v2, s[12:15], s24 offen offset:3072 sc1
    s_waitcnt vmcnt(8)
    v_mov_b32 v6, v4
    s_nop 1
    v_max_f32_dpp v6, v6, v6 row_ror:4 row_mask:0xf bank_mask:0xf
    s_nop 1
    v_max_f32_dpp v6, v6, v6 row_ror:2 row_mask:0xf bank_mask:0xf
    s_nop 1
    v_max_f32_dpp v6, v6, v6 row_ror:1 row_mask:0xf bank_mask:0xf
    v_sub_f32 v4, v4, v6
    v_exp_f32 v4, v4
    s_nop 0
    v_mul_f32 v5, v4, v5
    s_nop 1
    v_add_f32_dpp v5, v5, v5 row_ror:4 row_mask:0xf bank_mask:0xf
    s_nop 1
    v_add_f32_dpp v5, v5, v5 row_ror:2 row_mask:0xf bank_mask:0xf
    s_nop 1
    v_add_f32_dpp v5, v5, v5 row_ror:1 row_mask:0xf bank_mask:0xf
    v_rcp_f32 v5, v5
    s_nop 0
    v_mul_f32 v4, v4, v5
    s_nop 0
    v_readlane_b32 s24, v4, 0
    s_waitcnt vmcnt(7)
    v_lshlrev_b32 v5, 16, v72
    v_and_b32 v6, 0xffff0000, v72
    v_mul_f32 v104, s24, v5
    v_mul_f32 v105, s24, v6
    v_lshlrev_b32 v5, 16, v73
    v_and_b32 v6, 0xffff0000, v73
    v_mul_f32 v106, s24, v5
    v_mul_f32 v107, s24, v6
    v_lshlrev_b32 v5, 16, v74
    v_and_b32 v6, 0xffff0000, v74
    v_mul_f32 v108, s24, v5
    v_mul_f32 v109, s24, v6
    v_lshlrev_b32 v5, 16, v75
    v_and_b32 v6, 0xffff0000, v75
    v_mul_f32 v110, s24, v5
    v_mul_f32 v111, s24, v6
    v_readlane_b32 s24, v4, 1
    s_waitcnt vmcnt(6)
    v_lshlrev_b32 v5, 16, v76
    v_and_b32 v6, 0xffff0000, v76
    v_fmac_f32 v104, s24, v5
    v_fmac_f32 v105, s24, v6
    v_lshlrev_b32 v5, 16, v77
    v_and_b32 v6, 0xffff0000, v77
    v_fmac_f32 v106, s24, v5
    v_fmac_f32 v107, s24, v6
    v_lshlrev_b32 v5, 16, v78
    v_and_b32 v6, 0xffff0000, v78
    v_fmac_f32 v108, s24, v5
    v_fmac_f32 v109, s24, v6
    v_lshlrev_b32 v5, 16, v79
    v_and_b32 v6, 0xffff0000, v79
    v_fmac_f32 v110, s24, v5
    v_fmac_f32 v111, s24, v6
    v_readlane_b32 s24, v4, 2
    s_waitcnt vmcnt(5)
    v_lshlrev_b32 v5, 16, v80
    v_and_b32 v6, 0xffff0000, v80
    v_fmac_f32 v104, s24, v5
    v_fmac_f32 v105, s24, v6
    v_lshlrev_b32 v5, 16, v81
    v_and_b32 v6, 0xffff0000, v81
    v_fmac_f32 v106, s24, v5
    v_fmac_f32 v107, s24, v6
    v_lshlrev_b32 v5, 16, v82
    v_and_b32 v6, 0xffff0000, v82
    v_fmac_f32 v108, s24, v5
    v_fmac_f32 v109, s24, v6
    v_lshlrev_b32 v5, 16, v83
    v_and_b32 v6, 0xffff0000, v83
    v_fmac_f32 v110, s24, v5
    v_fmac_f32 v111, s24, v6
    v_readlane_b32 s24, v4, 3
    s_waitcnt vmcnt(4)
    v_lshlrev_b32 v5, 16, v84
    v_and_b32 v6, 0xffff0000, v84
    v_fmac_f32 v104, s24, v5
    v_fmac_f32 v105, s24, v6
    v_lshlrev_b32 v5, 16, v85
    v_and_b32 v6, 0xffff0000, v85
    v_fmac_f32 v106, s24, v5
    v_fmac_f32 v107, s24, v6
    v_lshlrev_b32 v5, 16, v86
    v_and_b32 v6, 0xffff0000, v86
    v_fmac_f32 v108, s24, v5
    v_fmac_f32 v109, s24, v6
    v_lshlrev_b32 v5, 16, v87
    v_and_b32 v6, 0xffff0000, v87
    v_fmac_f32 v110, s24, v5
    v_fmac_f32 v111, s24, v6
    v_readlane_b32 s24, v4, 4
    s_waitcnt vmcnt(3)
    v_lshlrev_b32 v5, 16, v88
    v_and_b32 v6, 0xffff0000, v88
    v_fmac_f32 v104, s24, v5
    v_fmac_f32 v105, s24, v6
    v_lshlrev_b32 v5, 16, v89
    v_and_b32 v6, 0xffff0000, v89
    v_fmac_f32 v106, s24, v5
    v_fmac_f32 v107, s24, v6
    v_lshlrev_b32 v5, 16, v90
    v_and_b32 v6, 0xffff0000, v90
    v_fmac_f32 v108, s24, v5
    v_fmac_f32 v109, s24, v6
    v_lshlrev_b32 v5, 16, v91
    v_and_b32 v6, 0xffff0000, v91
    v_fmac_f32 v110, s24, v5
    v_fmac_f32 v111, s24, v6
    v_readlane_b32 s24, v4, 5
    s_waitcnt vmcnt(2)
    v_lshlrev_b32 v5, 16, v92
    v_and_b32 v6, 0xffff0000, v92
    v_fmac_f32 v104, s24, v5
    v_fmac_f32 v105, s24, v6
    v_lshlrev_b32 v5, 16, v93
    v_and_b32 v6, 0xffff0000, v93
    v_fmac_f32 v106, s24, v5
    v_fmac_f32 v107, s24, v6
    v_lshlrev_b32 v5, 16, v94
    v_and_b32 v6, 0xffff0000, v94
    v_fmac_f32 v108, s24, v5
    v_fmac_f32 v109, s24, v6
    v_lshlrev_b32 v5, 16, v95
    v_and_b32 v6, 0xffff0000, v95
    v_fmac_f32 v110, s24, v5
    v_fmac_f32 v111, s24, v6
    v_readlane_b32 s24, v4, 6
    s_waitcnt vmcnt(1)
    v_lshlrev_b32 v5, 16, v96
    v_and_b32 v6, 0xffff0000, v96
    v_fmac_f32 v104, s24, v5
    v_fmac_f32 v105, s24, v6
    v_lshlrev_b32 v5, 16, v97
    v_and_b32 v6, 0xffff0000, v97
    v_fmac_f32 v106, s24, v5
    v_fmac_f32 v107, s24, v6
    v_lshlrev_b32 v5, 16, v98
    v_and_b32 v6, 0xffff0000, v98
    v_fmac_f32 v108, s24, v5
    v_fmac_f32 v109, s24, v6
    v_lshlrev_b32 v5, 16, v99
    v_and_b32 v6, 0xffff0000, v99
    v_fmac_f32 v110, s24, v5
    v_fmac_f32 v111, s24, v6
    v_readlane_b32 s24, v4, 7
    s_waitcnt vmcnt(0)
    v_lshlrev_b32 v5, 16, v100
    v_and_b32 v6, 0xffff0000, v100
    v_fmac_f32 v104, s24, v5
    v_fmac_f32 v105, s24, v6
    v_lshlrev_b32 v5, 16, v101
    v_and_b32 v6, 0xffff0000, v101
    v_fmac_f32 v106, s24, v5
    v_fmac_f32 v107, s24, v6
    v_lshlrev_b32 v5, 16, v102
    v_and_b32 v6, 0xffff0000, v102
    v_fmac_f32 v108, s24, v5
    v_fmac_f32 v109, s24, v6
    v_lshlrev_b32 v5, 16, v103
    v_and_b32 v6, 0xffff0000, v103
    v_fmac_f32 v110, s24, v5
    v_fmac_f32 v111, s24, v6
    v_cvt_pk_bf16_f32 v4, v104, v105
    v_cvt_pk_bf16_f32 v5, v106, v107
    v_cvt_pk_bf16_f32 v6, v108, v109
    v_cvt_pk_bf16_f32 v7, v110, v111
    s_lshl_b32 s24, s3, 10
    s_add_u32 s24, s24, 145408
    v_add_u32 v3, s24, v2
    ds_write_b128 v3, v[4:7]
    s_lshl_b32 s24, s3, 8
    s_add_u32 s24, s24, 145408
    v_add_u32 v3, s24, v19
    s_waitcnt lgkmcnt(0)
    s_barrier
    ds_read_b128 v[32:35], v3 offset:0
    ds_read_b128 v[36:39], v3 offset:16
    ds_read_b128 v[40:43], v3 offset:32
    ds_read_b128 v[44:47], v3 offset:48
    ds_read_b128 v[48:51], v3 offset:2048
    ds_read_b128 v[52:55], v3 offset:2064
    ds_read_b128 v[56:59], v3 offset:2080
    ds_read_b128 v[60:63], v3 offset:2096
    s_waitcnt lgkmcnt(0)
    v_perm_b32 v8, v32, v32, v24
    v_perm_b32 v9, v32, v32, v25
    v_perm_b32 v10, v32, v32, v26
    v_perm_b32 v11, v32, v32, v27
    s_nop 1
    v_mfma_f32_16x16x32_bf16 v[12:15], v[128:131], v[8:11], 0
    v_perm_b32 v4, v48, v48, v24
    v_perm_b32 v5, v48, v48, v25
    v_perm_b32 v6, v48, v48, v26
    v_perm_b32 v7, v48, v48, v27
    s_nop 1
    v_mfma_f32_16x16x32_bf16 v[68:71], v[128:131], v[4:7], 0
    v_perm_b32 v8, v32, v32, v28
    v_perm_b32 v9, v32, v32, v29
    v_perm_b32 v10, v32, v32, v30
    v_perm_b32 v11, v32, v32, v31
    s_nop 1
    v_mfma_f32_16x16x32_bf16 v[12:15], v[132:135], v[8:11], v[12:15]
    v_perm_b32 v4, v48, v48, v28
    v_perm_b32 v5, v48, v48, v29
    v_perm_b32 v6, v48, v48, v30
    v_perm_b32 v7, v48, v48, v31
    s_nop 1
    v_mfma_f32_16x16x32_bf16 v[68:71], v[132:135], v[4:7], v[68:71]
    v_perm_b32 v8, v33, v33, v24
    v_perm_b32 v9, v33, v33, v25
    v_perm_b32 v10, v33, v33, v26
    v_perm_b32 v11, v33, v33, v27
    s_nop 1
    v_mfma_f32_16x16x32_bf16 v[12:15], v[136:139], v[8:11], v[12:15]
    v_perm_b32 v4, v49, v49, v24
    v_perm_b32 v5, v49, v49, v25
    v_perm_b32 v6, v49, v49, v26
    v_perm_b32 v7, v49, v49, v27
    s_nop 1
    v_mfma_f32_16x16x32_bf16 v[68:71], v[136:139], v[4:7], v[68:71]
    v_perm_b32 v8, v33, v33, v28
    v_perm_b32 v9, v33, v33, v29
    v_perm_b32 v10, v33, v33, v30
    v_perm_b32 v11, v33, v33, v31
    s_nop 1
    v_mfma_f32_16x16x32_bf16 v[12:15], v[140:143], v[8:11], v[12:15]
    v_perm_b32 v4, v49, v49, v28
    v_perm_b32 v5, v49, v49, v29
    v_perm_b32 v6, v49, v49, v30
    v_perm_b32 v7, v49, v49, v31
    s_nop 1
    v_mfma_f32_16x16x32_bf16 v[68:71], v[140:143], v[4:7], v[68:71]
    v_perm_b32 v8, v34, v34, v24
    v_perm_b32 v9, v34, v34, v25
    v_perm_b32 v10, v34, v34, v26
    v_perm_b32 v11, v34, v34, v27
    s_nop 1
    v_mfma_f32_16x16x32_bf16 v[12:15], v[144:147], v[8:11], v[12:15]
    v_perm_b32 v4, v50, v50, v24
    v_perm_b32 v5, v50, v50, v25
    v_perm_b32 v6, v50, v50, v26
    v_perm_b32 v7, v50, v50, v27
    s_nop 1
    v_mfma_f32_16x16x32_bf16 v[68:71], v[144:147], v[4:7], v[68:71]
    v_perm_b32 v8, v34, v34, v28
    v_perm_b32 v9, v34, v34, v29
    v_perm_b32 v10, v34, v34, v30
    v_perm_b32 v11, v34, v34, v31
    s_nop 1
    v_mfma_f32_16x16x32_bf16 v[12:15], v[148:151], v[8:11], v[12:15]
    v_perm_b32 v4, v50, v50, v28
    v_perm_b32 v5, v50, v50, v29
    v_perm_b32 v6, v50, v50, v30
    v_perm_b32 v7, v50, v50, v31
    s_nop 1
    v_mfma_f32_16x16x32_bf16 v[68:71], v[148:151], v[4:7], v[68:71]
    v_perm_b32 v8, v35, v35, v24
    v_perm_b32 v9, v35, v35, v25
    v_perm_b32 v10, v35, v35, v26
    v_perm_b32 v11, v35, v35, v27
    s_nop 1
    v_mfma_f32_16x16x32_bf16 v[12:15], v[152:155], v[8:11], v[12:15]
    v_perm_b32 v4, v51, v51, v24
    v_perm_b32 v5, v51, v51, v25
    v_perm_b32 v6, v51, v51, v26
    v_perm_b32 v7, v51, v51, v27
    s_nop 1
    v_mfma_f32_16x16x32_bf16 v[68:71], v[152:155], v[4:7], v[68:71]
    v_perm_b32 v8, v35, v35, v28
    v_perm_b32 v9, v35, v35, v29
    v_perm_b32 v10, v35, v35, v30
    v_perm_b32 v11, v35, v35, v31
    s_nop 1
    v_mfma_f32_16x16x32_bf16 v[12:15], v[156:159], v[8:11], v[12:15]
    v_perm_b32 v4, v51, v51, v28
    v_perm_b32 v5, v51, v51, v29
    v_perm_b32 v6, v51, v51, v30
    v_perm_b32 v7, v51, v51, v31
    s_nop 1
    v_mfma_f32_16x16x32_bf16 v[68:71], v[156:159], v[4:7], v[68:71]
    v_perm_b32 v8, v36, v36, v24
    v_perm_b32 v9, v36, v36, v25
    v_perm_b32 v10, v36, v36, v26
    v_perm_b32 v11, v36, v36, v27
    s_nop 1
    v_mfma_f32_16x16x32_bf16 v[12:15], v[160:163], v[8:11], v[12:15]
    v_perm_b32 v4, v52, v52, v24
    v_perm_b32 v5, v52, v52, v25
    v_perm_b32 v6, v52, v52, v26
    v_perm_b32 v7, v52, v52, v27
    s_nop 1
    v_mfma_f32_16x16x32_bf16 v[68:71], v[160:163], v[4:7], v[68:71]
    v_perm_b32 v8, v36, v36, v28
    v_perm_b32 v9, v36, v36, v29
    v_perm_b32 v10, v36, v36, v30
    v_perm_b32 v11, v36, v36, v31
    s_nop 1
    v_mfma_f32_16x16x32_bf16 v[12:15], v[164:167], v[8:11], v[12:15]
    v_perm_b32 v4, v52, v52, v28
    v_perm_b32 v5, v52, v52, v29
    v_perm_b32 v6, v52, v52, v30
    v_perm_b32 v7, v52, v52, v31
    s_nop 1
    v_mfma_f32_16x16x32_bf16 v[68:71], v[164:167], v[4:7], v[68:71]
    v_perm_b32 v8, v37, v37, v24
    v_perm_b32 v9, v37, v37, v25
    v_perm_b32 v10, v37, v37, v26
    v_perm_b32 v11, v37, v37, v27
    s_nop 1
    v_mfma_f32_16x16x32_bf16 v[12:15], v[168:171], v[8:11], v[12:15]
    v_perm_b32 v4, v53, v53, v24
    v_perm_b32 v5, v53, v53, v25
    v_perm_b32 v6, v53, v53, v26
    v_perm_b32 v7, v53, v53, v27
    s_nop 1
    v_mfma_f32_16x16x32_bf16 v[68:71], v[168:171], v[4:7], v[68:71]
    v_perm_b32 v8, v37, v37, v28
    v_perm_b32 v9, v37, v37, v29
    v_perm_b32 v10, v37, v37, v30
    v_perm_b32 v11, v37, v37, v31
    s_nop 1
    v_mfma_f32_16x16x32_bf16 v[12:15], v[172:175], v[8:11], v[12:15]
    v_perm_b32 v4, v53, v53, v28
    v_perm_b32 v5, v53, v53, v29
    v_perm_b32 v6, v53, v53, v30
    v_perm_b32 v7, v53, v53, v31
    s_nop 1
    v_mfma_f32_16x16x32_bf16 v[68:71], v[172:175], v[4:7], v[68:71]
    v_perm_b32 v8, v38, v38, v24
    v_perm_b32 v9, v38, v38, v25
    v_perm_b32 v10, v38, v38, v26
    v_perm_b32 v11, v38, v38, v27
    s_nop 1
    v_mfma_f32_16x16x32_bf16 v[12:15], v[176:179], v[8:11], v[12:15]
    v_perm_b32 v4, v54, v54, v24
    v_perm_b32 v5, v54, v54, v25
    v_perm_b32 v6, v54, v54, v26
    v_perm_b32 v7, v54, v54, v27
    s_nop 1
    v_mfma_f32_16x16x32_bf16 v[68:71], v[176:179], v[4:7], v[68:71]
    v_perm_b32 v8, v38, v38, v28
    v_perm_b32 v9, v38, v38, v29
    v_perm_b32 v10, v38, v38, v30
    v_perm_b32 v11, v38, v38, v31
    s_nop 1
    v_mfma_f32_16x16x32_bf16 v[12:15], v[180:183], v[8:11], v[12:15]
    v_perm_b32 v4, v54, v54, v28
    v_perm_b32 v5, v54, v54, v29
    v_perm_b32 v6, v54, v54, v30
    v_perm_b32 v7, v54, v54, v31
    s_nop 1
    v_mfma_f32_16x16x32_bf16 v[68:71], v[180:183], v[4:7], v[68:71]
    v_perm_b32 v8, v39, v39, v24
    v_perm_b32 v9, v39, v39, v25
    v_perm_b32 v10, v39, v39, v26
    v_perm_b32 v11, v39, v39, v27
    s_nop 1
    v_mfma_f32_16x16x32_bf16 v[12:15], v[184:187], v[8:11], v[12:15]
    v_perm_b32 v4, v55, v55, v24
    v_perm_b32 v5, v55, v55, v25
    v_perm_b32 v6, v55, v55, v26
    v_perm_b32 v7, v55, v55, v27
    s_nop 1
    v_mfma_f32_16x16x32_bf16 v[68:71], v[184:187], v[4:7], v[68:71]
    v_perm_b32 v8, v39, v39, v28
    v_perm_b32 v9, v39, v39, v29
    v_perm_b32 v10, v39, v39, v30
    v_perm_b32 v11, v39, v39, v31
    s_nop 1
    v_mfma_f32_16x16x32_bf16 v[12:15], v[188:191], v[8:11], v[12:15]
    v_perm_b32 v4, v55, v55, v28
    v_perm_b32 v5, v55, v55, v29
    v_perm_b32 v6, v55, v55, v30
    v_perm_b32 v7, v55, v55, v31
    s_nop 1
    v_mfma_f32_16x16x32_bf16 v[68:71], v[188:191], v[4:7], v[68:71]
    v_perm_b32 v8, v40, v40, v24
    v_perm_b32 v9, v40, v40, v25
    v_perm_b32 v10, v40, v40, v26
    v_perm_b32 v11, v40, v40, v27
    s_nop 1
    v_mfma_f32_16x16x32_bf16 v[12:15], v[192:195], v[8:11], v[12:15]
    v_perm_b32 v4, v56, v56, v24
    v_perm_b32 v5, v56, v56, v25
    v_perm_b32 v6, v56, v56, v26
    v_perm_b32 v7, v56, v56, v27
    s_nop 1
    v_mfma_f32_16x16x32_bf16 v[68:71], v[192:195], v[4:7], v[68:71]
    v_perm_b32 v8, v40, v40, v28
    v_perm_b32 v9, v40, v40, v29
    v_perm_b32 v10, v40, v40, v30
    v_perm_b32 v11, v40, v40, v31
    s_nop 1
    v_mfma_f32_16x16x32_bf16 v[12:15], v[196:199], v[8:11], v[12:15]
    v_perm_b32 v4, v56, v56, v28
    v_perm_b32 v5, v56, v56, v29
    v_perm_b32 v6, v56, v56, v30
    v_perm_b32 v7, v56, v56, v31
    s_nop 1
    v_mfma_f32_16x16x32_bf16 v[68:71], v[196:199], v[4:7], v[68:71]
    v_perm_b32 v8, v41, v41, v24
    v_perm_b32 v9, v41, v41, v25
    v_perm_b32 v10, v41, v41, v26
    v_perm_b32 v11, v41, v41, v27
    s_nop 1
    v_mfma_f32_16x16x32_bf16 v[12:15], v[200:203], v[8:11], v[12:15]
    v_perm_b32 v4, v57, v57, v24
    v_perm_b32 v5, v57, v57, v25
    v_perm_b32 v6, v57, v57, v26
    v_perm_b32 v7, v57, v57, v27
    s_nop 1
    v_mfma_f32_16x16x32_bf16 v[68:71], v[200:203], v[4:7], v[68:71]
    v_perm_b32 v8, v41, v41, v28
    v_perm_b32 v9, v41, v41, v29
    v_perm_b32 v10, v41, v41, v30
    v_perm_b32 v11, v41, v41, v31
    s_nop 1
    v_mfma_f32_16x16x32_bf16 v[12:15], v[204:207], v[8:11], v[12:15]
    v_perm_b32 v4, v57, v57, v28
    v_perm_b32 v5, v57, v57, v29
    v_perm_b32 v6, v57, v57, v30
    v_perm_b32 v7, v57, v57, v31
    s_nop 1
    v_mfma_f32_16x16x32_bf16 v[68:71], v[204:207], v[4:7], v[68:71]
    v_perm_b32 v8, v42, v42, v24
    v_perm_b32 v9, v42, v42, v25
    v_perm_b32 v10, v42, v42, v26
    v_perm_b32 v11, v42, v42, v27
    s_nop 1
    v_mfma_f32_16x16x32_bf16 v[12:15], v[208:211], v[8:11], v[12:15]
    v_perm_b32 v4, v58, v58, v24
    v_perm_b32 v5, v58, v58, v25
    v_perm_b32 v6, v58, v58, v26
    v_perm_b32 v7, v58, v58, v27
    s_nop 1
    v_mfma_f32_16x16x32_bf16 v[68:71], v[208:211], v[4:7], v[68:71]
    v_perm_b32 v8, v42, v42, v28
    v_perm_b32 v9, v42, v42, v29
    v_perm_b32 v10, v42, v42, v30
    v_perm_b32 v11, v42, v42, v31
    s_nop 1
    v_mfma_f32_16x16x32_bf16 v[12:15], v[212:215], v[8:11], v[12:15]
    v_perm_b32 v4, v58, v58, v28
    v_perm_b32 v5, v58, v58, v29
    v_perm_b32 v6, v58, v58, v30
    v_perm_b32 v7, v58, v58, v31
    s_nop 1
    v_mfma_f32_16x16x32_bf16 v[68:71], v[212:215], v[4:7], v[68:71]
    v_perm_b32 v8, v43, v43, v24
    v_perm_b32 v9, v43, v43, v25
    v_perm_b32 v10, v43, v43, v26
    v_perm_b32 v11, v43, v43, v27
    s_nop 1
    v_mfma_f32_16x16x32_bf16 v[12:15], v[216:219], v[8:11], v[12:15]
    v_perm_b32 v4, v59, v59, v24
    v_perm_b32 v5, v59, v59, v25
    v_perm_b32 v6, v59, v59, v26
    v_perm_b32 v7, v59, v59, v27
    s_nop 1
    v_mfma_f32_16x16x32_bf16 v[68:71], v[216:219], v[4:7], v[68:71]
    v_perm_b32 v8, v43, v43, v28
    v_perm_b32 v9, v43, v43, v29
    v_perm_b32 v10, v43, v43, v30
    v_perm_b32 v11, v43, v43, v31
    s_nop 1
    v_mfma_f32_16x16x32_bf16 v[12:15], v[220:223], v[8:11], v[12:15]
    v_perm_b32 v4, v59, v59, v28
    v_perm_b32 v5, v59, v59, v29
    v_perm_b32 v6, v59, v59, v30
    v_perm_b32 v7, v59, v59, v31
    s_nop 1
    v_mfma_f32_16x16x32_bf16 v[68:71], v[220:223], v[4:7], v[68:71]
    v_perm_b32 v8, v44, v44, v24
    v_perm_b32 v9, v44, v44, v25
    v_perm_b32 v10, v44, v44, v26
    v_perm_b32 v11, v44, v44, v27
    s_nop 1
    v_mfma_f32_16x16x32_bf16 v[12:15], v[224:227], v[8:11], v[12:15]
    v_perm_b32 v4, v60, v60, v24
    v_perm_b32 v5, v60, v60, v25
    v_perm_b32 v6, v60, v60, v26
    v_perm_b32 v7, v60, v60, v27
    s_nop 1
    v_mfma_f32_16x16x32_bf16 v[68:71], v[224:227], v[4:7], v[68:71]
    v_perm_b32 v8, v44, v44, v28
    v_perm_b32 v9, v44, v44, v29
    v_perm_b32 v10, v44, v44, v30
    v_perm_b32 v11, v44, v44, v31
    s_nop 1
    v_mfma_f32_16x16x32_bf16 v[12:15], v[228:231], v[8:11], v[12:15]
    v_perm_b32 v4, v60, v60, v28
    v_perm_b32 v5, v60, v60, v29
    v_perm_b32 v6, v60, v60, v30
    v_perm_b32 v7, v60, v60, v31
    s_nop 1
    v_mfma_f32_16x16x32_bf16 v[68:71], v[228:231], v[4:7], v[68:71]
    v_perm_b32 v8, v45, v45, v24
    v_perm_b32 v9, v45, v45, v25
    v_perm_b32 v10, v45, v45, v26
    v_perm_b32 v11, v45, v45, v27
    s_nop 1
    v_mfma_f32_16x16x32_bf16 v[12:15], v[232:235], v[8:11], v[12:15]
    v_perm_b32 v4, v61, v61, v24
    v_perm_b32 v5, v61, v61, v25
    v_perm_b32 v6, v61, v61, v26
    v_perm_b32 v7, v61, v61, v27
    s_nop 1
    v_mfma_f32_16x16x32_bf16 v[68:71], v[232:235], v[4:7], v[68:71]
    v_perm_b32 v8, v45, v45, v28
    v_perm_b32 v9, v45, v45, v29
    v_perm_b32 v10, v45, v45, v30
    v_perm_b32 v11, v45, v45, v31
    s_nop 1
    v_mfma_f32_16x16x32_bf16 v[12:15], v[236:239], v[8:11], v[12:15]
    v_perm_b32 v4, v61, v61, v28
    v_perm_b32 v5, v61, v61, v29
    v_perm_b32 v6, v61, v61, v30
    v_perm_b32 v7, v61, v61, v31
    s_nop 1
    v_mfma_f32_16x16x32_bf16 v[68:71], v[236:239], v[4:7], v[68:71]
    v_perm_b32 v8, v46, v46, v24
    v_perm_b32 v9, v46, v46, v25
    v_perm_b32 v10, v46, v46, v26
    v_perm_b32 v11, v46, v46, v27
    s_nop 1
    v_mfma_f32_16x16x32_bf16 v[12:15], v[240:243], v[8:11], v[12:15]
    v_perm_b32 v4, v62, v62, v24
    v_perm_b32 v5, v62, v62, v25
    v_perm_b32 v6, v62, v62, v26
    v_perm_b32 v7, v62, v62, v27
    s_nop 1
    v_mfma_f32_16x16x32_bf16 v[68:71], v[240:243], v[4:7], v[68:71]
    v_perm_b32 v8, v46, v46, v28
    v_perm_b32 v9, v46, v46, v29
    v_perm_b32 v10, v46, v46, v30
    v_perm_b32 v11, v46, v46, v31
    s_nop 1
    v_mfma_f32_16x16x32_bf16 v[12:15], v[244:247], v[8:11], v[12:15]
    v_perm_b32 v4, v62, v62, v28
    v_perm_b32 v5, v62, v62, v29
    v_perm_b32 v6, v62, v62, v30
    v_perm_b32 v7, v62, v62, v31
    s_nop 1
    v_mfma_f32_16x16x32_bf16 v[68:71], v[244:247], v[4:7], v[68:71]
    v_perm_b32 v8, v47, v47, v24
    v_perm_b32 v9, v47, v47, v25
    v_perm_b32 v10, v47, v47, v26
    v_perm_b32 v11, v47, v47, v27
    s_nop 1
    v_mfma_f32_16x16x32_bf16 v[12:15], v[248:251], v[8:11], v[12:15]
    v_perm_b32 v4, v63, v63, v24
    v_perm_b32 v5, v63, v63, v25
    v_perm_b32 v6, v63, v63, v26
    v_perm_b32 v7, v63, v63, v27
    s_nop 1
    v_mfma_f32_16x16x32_bf16 v[68:71], v[248:251], v[4:7], v[68:71]
    v_perm_b32 v8, v47, v47, v28
    v_perm_b32 v9, v47, v47, v29
    v_perm_b32 v10, v47, v47, v30
    v_perm_b32 v11, v47, v47, v31
    s_nop 1
    v_mfma_f32_16x16x32_bf16 v[12:15], v[252:255], v[8:11], v[12:15]
    v_perm_b32 v4, v63, v63, v28
    v_perm_b32 v5, v63, v63, v29
    v_perm_b32 v6, v63, v63, v30
    v_perm_b32 v7, v63, v63, v31
    s_nop 1
    v_mfma_f32_16x16x32_bf16 v[68:71], v[252:255], v[4:7], v[68:71]
    v_lshrrev_b32 v3, 4, v0
    v_lshlrev_b32 v3, 7, v3
    v_and_b32 v4, 7, v0
    v_lshl_add_u32 v3, v4, 4, v3
    v_bfe_u32 v4, v0, 3, 1
    v_lshl_add_u32 v3, v4, 9, v3
    s_lshl_b32 s24, s3, 11
    s_add_u32 s24, s24, 135168
    v_add_u32 v3, s24, v3
    ds_write_b128 v3, v[12:15]
    ds_write_b128 v3, v[68:71] offset:1024
    s_waitcnt lgkmcnt(0)
    s_barrier
    v_and_b32 v5, 31, v0
    s_lshl_b32 s24, s3, 9
    s_add_u32 s24, s24, 135168
    v_lshl_add_u32 v3, v5, 4, s24
    ds_read_b128 v[72:75], v3 offset:0
    ds_read_b128 v[76:79], v3 offset:2048
    ds_read_b128 v[80:83], v3 offset:4096
    ds_read_b128 v[84:87], v3 offset:6144
    s_lshl_b32 s24, s3, 8
    s_add_u32 s24, s24, 143360
    v_lshl_add_u32 v5, v5, 3, s24
    s_waitcnt lgkmcnt(0)
    v_add_f32 v72, v72, v76
    v_add_f32 v73, v73, v77
    v_add_f32 v74, v74, v78
    v_add_f32 v75, v75, v79
    v_add_f32 v72, v72, v80
    v_add_f32 v73, v73, v81
    v_add_f32 v74, v74, v82
    v_add_f32 v75, v75, v83
    v_add_f32 v72, v72, v84
    v_add_f32 v73, v73, v85
    v_add_f32 v74, v74, v86
    v_add_f32 v75, v75, v87
    v_cvt_pk_bf16_f32 v6, v72, v73
    v_cvt_pk_bf16_f32 v7, v74, v75
    ds_write_b64 v5, v[6:7]
    v_lshrrev_b32 v3, 4, v0
    v_and_b32 v4, 3, v0
    v_lshlrev_b32 v5, 8, v4
    v_lshl_add_u32 v5, v3, 4, v5
    v_add_u32 v5, 143360, v5
    s_waitcnt lgkmcnt(0)
    s_barrier
    ds_read_b128 v[32:35], v5 offset:0
    ds_read_b128 v[36:39], v5 offset:64
    ds_read_b128 v[40:43], v5 offset:128
    ds_read_b128 v[44:47], v5 offset:192
    s_waitcnt lgkmcnt(3)
    v_mfma_f32_16x16x32_bf16 v[72:75], v[32:35], a[0:3], 0
    s_waitcnt lgkmcnt(2)
    v_mfma_f32_16x16x32_bf16 v[72:75], v[36:39], a[4:7], v[72:75]
    s_waitcnt lgkmcnt(1)
    v_mfma_f32_16x16x32_bf16 v[72:75], v[40:43], a[8:11], v[72:75]
    s_waitcnt lgkmcnt(0)
    v_mfma_f32_16x16x32_bf16 v[72:75], v[44:47], a[12:15], v[72:75]
    v_mfma_f32_16x16x32_bf16 v[76:79], v[32:35], a[16:19], 0
    v_mfma_f32_16x16x32_bf16 v[76:79], v[36:39], a[20:23], v[76:79]
    v_mfma_f32_16x16x32_bf16 v[76:79], v[40:43], a[24:27], v[76:79]
    v_mfma_f32_16x16x32_bf16 v[76:79], v[44:47], a[28:31], v[76:79]
    v_mfma_f32_16x16x32_bf16 v[80:83], v[32:35], a[32:35], 0
    v_mfma_f32_16x16x32_bf16 v[80:83], v[36:39], a[36:39], v[80:83]
    v_mfma_f32_16x16x32_bf16 v[80:83], v[40:43], a[40:43], v[80:83]
    v_mfma_f32_16x16x32_bf16 v[80:83], v[44:47], a[44:47], v[80:83]
    v_mov_b32_dpp v4, v72 quad_perm:[0,1,2,3] row_mask:0x1 bank_mask:0xf
    v_mov_b32_dpp v5, v73 quad_perm:[0,1,2,3] row_mask:0x1 bank_mask:0xf
    v_mov_b32_dpp v6, v74 quad_perm:[0,1,2,3] row_mask:0x1 bank_mask:0xf
    v_mov_b32_dpp v7, v75 quad_perm:[0,1,2,3] row_mask:0x1 bank_mask:0xf
    v_mfma_f32_16x16x32_bf16 v[84:87], v[32:35], a[48:51], 0
    v_mfma_f32_16x16x32_bf16 v[84:87], v[36:39], a[52:55], v[84:87]
    v_mfma_f32_16x16x32_bf16 v[84:87], v[40:43], a[56:59], v[84:87]
    v_mfma_f32_16x16x32_bf16 v[84:87], v[44:47], a[60:63], v[84:87]
    v_mov_b32_dpp v4, v76 quad_perm:[0,1,2,3] row_mask:0x2 bank_mask:0xf
    v_mov_b32_dpp v5, v77 quad_perm:[0,1,2,3] row_mask:0x2 bank_mask:0xf
    v_mov_b32_dpp v6, v78 quad_perm:[0,1,2,3] row_mask:0x2 bank_mask:0xf
    v_mov_b32_dpp v7, v79 quad_perm:[0,1,2,3] row_mask:0x2 bank_mask:0xf
    v_mfma_f32_16x16x32_bf16 v[88:91], v[32:35], a[64:67], 0
    v_mfma_f32_16x16x32_bf16 v[88:91], v[36:39], a[68:71], v[88:91]
    v_mfma_f32_16x16x32_bf16 v[88:91], v[40:43], a[72:75], v[88:91]
    v_mfma_f32_16x16x32_bf16 v[88:91], v[44:47], a[76:79], v[88:91]
    v_mov_b32_dpp v4, v80 quad_perm:[0,1,2,3] row_mask:0x4 bank_mask:0xf
    v_mov_b32_dpp v5, v81 quad_perm:[0,1,2,3] row_mask:0x4 bank_mask:0xf
    v_mov_b32_dpp v6, v82 quad_perm:[0,1,2,3] row_mask:0x4 bank_mask:0xf
    v_mov_b32_dpp v7, v83 quad_perm:[0,1,2,3] row_mask:0x4 bank_mask:0xf
    v_mfma_f32_16x16x32_bf16 v[92:95], v[32:35], a[80:83], 0
    v_mfma_f32_16x16x32_bf16 v[92:95], v[36:39], a[84:87], v[92:95]
    v_mfma_f32_16x16x32_bf16 v[92:95], v[40:43], a[88:91], v[92:95]
    v_mfma_f32_16x16x32_bf16 v[92:95], v[44:47], a[92:95], v[92:95]
    v_mov_b32_dpp v4, v84 quad_perm:[0,1,2,3] row_mask:0x8 bank_mask:0xf
    v_mov_b32_dpp v5, v85 quad_perm:[0,1,2,3] row_mask:0x8 bank_mask:0xf
    v_mov_b32_dpp v6, v86 quad_perm:[0,1,2,3] row_mask:0x8 bank_mask:0xf
    v_mov_b32_dpp v7, v87 quad_perm:[0,1,2,3] row_mask:0x8 bank_mask:0xf
    v_mfma_f32_16x16x32_bf16 v[96:99], v[32:35], a[96:99], 0
    v_mfma_f32_16x16x32_bf16 v[96:99], v[36:39], a[100:103], v[96:99]
    v_mfma_f32_16x16x32_bf16 v[96:99], v[40:43], a[104:107], v[96:99]
    v_mfma_f32_16x16x32_bf16 v[96:99], v[44:47], a[108:111], v[96:99]
    v_mov_b32_dpp v8, v88 quad_perm:[0,1,2,3] row_mask:0x1 bank_mask:0xf
    v_mov_b32_dpp v9, v89 quad_perm:[0,1,2,3] row_mask:0x1 bank_mask:0xf
    v_mov_b32_dpp v10, v90 quad_perm:[0,1,2,3] row_mask:0x1 bank_mask:0xf
    v_mov_b32_dpp v11, v91 quad_perm:[0,1,2,3] row_mask:0x1 bank_mask:0xf
    v_mfma_f32_16x16x32_bf16 v[100:103], v[32:35], a[112:115], 0
    v_mfma_f32_16x16x32_bf16 v[100:103], v[36:39], a[116:119], v[100:103]
    v_mfma_f32_16x16x32_bf16 v[100:103], v[40:43], a[120:123], v[100:103]
    v_mfma_f32_16x16x32_bf16 v[100:103], v[44:47], a[124:127], v[100:103]
    v_mov_b32_dpp v8, v92 quad_perm:[0,1,2,3] row_mask:0x2 bank_mask:0xf
    v_mov_b32_dpp v9, v93 quad_perm:[0,1,2,3] row_mask:0x2 bank_mask:0xf
    v_mov_b32_dpp v10, v94 quad_perm:[0,1,2,3] row_mask:0x2 bank_mask:0xf
    v_mov_b32_dpp v11, v95 quad_perm:[0,1,2,3] row_mask:0x2 bank_mask:0xf
    v_mov_b32_dpp v8, v96 quad_perm:[0,1,2,3] row_mask:0x4 bank_mask:0xf
    v_mov_b32_dpp v9, v97 quad_perm:[0,1,2,3] row_mask:0x4 bank_mask:0xf
    v_mov_b32_dpp v10, v98 quad_perm:[0,1,2,3] row_mask:0x4 bank_mask:0xf
    v_mov_b32_dpp v11, v99 quad_perm:[0,1,2,3] row_mask:0x4 bank_mask:0xf
    v_mov_b32_dpp v8, v100 quad_perm:[0,1,2,3] row_mask:0x8 bank_mask:0xf
    v_mov_b32_dpp v9, v101 quad_perm:[0,1,2,3] row_mask:0x8 bank_mask:0xf
    v_mov_b32_dpp v10, v102 quad_perm:[0,1,2,3] row_mask:0x8 bank_mask:0xf
    v_mov_b32_dpp v11, v103 quad_perm:[0,1,2,3] row_mask:0x8 bank_mask:0xf
    s_lshl_b32 s24, s26, 13
    s_lshl_b32 s25, s3, 11
    s_add_u32 s24, s24, s25
    s_add_u32 s24, s24, 0x124000
    buffer_store_dwordx4 v[4:7], v2, s[12:15], s24 offen sc1
    buffer_store_dwordx4 v[8:11], v2, s[12:15], s24 offen offset:1024 sc1
    s_waitcnt vmcnt(0)
    s_barrier
    s_cmp_lg_u32 s3, 0
    s_cbranch_scc1 L_sig11
    s_mov_b64 exec, 1
    v_mov_b32 v3, 1
    buffer_atomic_add v3, off, s[16:19], 0 offset:8 sc0
    s_waitcnt vmcnt(0)
    v_readfirstlane_b32 s24, v3
    s_mov_b64 exec, -1
    s_and_b32 s24, s24, 31
    s_cmp_lg_u32 s24, 31
    s_cbranch_scc1 L_sig11
    v_lshlrev_b32 v4, 7, v0
    v_mov_b32 v3, 1
    s_mov_b32 s24, 0x170000
    buffer_store_dword v3, v4, s[12:15], s24 offen offset:8 sc1
L_sig11:
L_R:
    s_mov_b32 s20, s58
    s_mov_b32 s21, s59
    s_mov_b32 s22, 0x2000
    s_mov_b32 s23, 0x20000
    v_and_b32 v3, 1, v0
    v_lshlrev_b32 v3, 4, v3
    v_mov_b32 v4, 0xffff
    v_lshlrev_b32 v4, v3, v4
    v_bfe_u32 v3, v0, 1, 2
    v_cmp_eq_u32 vcc, 0, v3
    s_nop 1
    v_cndmask_b32 v20, 0, v4, vcc
    v_cmp_eq_u32 vcc, 1, v3
    s_nop 1
    v_cndmask_b32 v21, 0, v4, vcc
    v_cmp_eq_u32 vcc, 2, v3
    s_nop 1
    v_cndmask_b32 v22, 0, v4, vcc
    v_cmp_eq_u32 vcc, 3, v3
    s_nop 1
    v_cndmask_b32 v23, 0, v4, vcc
    v_lshrrev_b32 v3, 4, v0
    v_and_b32 v4, 7, v0
    v_lshl_add_u32 v5, v3, 3, v4
    v_lshlrev_b32 v27, 4, v5
    v_add_u32 v27, 144384, v27
    s_lshl_b32 s24, s3, 2
    v_add_u32 v26, s24, v27
    s_lshl_b32 s24, s3, 8
    s_add_u32 s24, s24, 143360
    v_lshl_add_u32 v24, v5, 3, s24
    v_lshlrev_b32 v28, 11, v3
    v_lshl_add_u32 v28, v4, 1, v28
    s_lshl_b32 s24, s74, 4
    v_add_u32 v28, s24, v28
    v_lshrrev_b32 v5, 3, v0
    s_lshl_b32 s24, s3, 3
    v_add_u32 v5, s24, v5
    v_lshlrev_b32 v5, 13, v5
    v_lshl_add_u32 v30, v4, 4, v5
    v_and_b32 v5, 3, v0
    v_lshlrev_b32 v25, 8, v5
    v_lshl_add_u32 v25, v3, 4, v25
    v_add_u32 v25, 143360, v25
    v_and_b32 v29, 0x1ff, v2
    v_min_u32 v6, 5, v4
    v_lshlrev_b32 v31, 4, v6
    s_cmp_lg_u32 s3, 0
    s_cbranch_scc1 L_awx12
    s_mov_b32 s24, 262144
    s_mov_b64 exec, 1
L_aw13:
    buffer_load_dword v1, off, s[12:15], s73 offset:8 sc1
    s_waitcnt vmcnt(0)
    v_readfirstlane_b32 s25, v1
    s_nop 0
    s_cmp_eq_u32 s25, 1
    s_cbranch_scc1 L_awx12
    s_sleep 4
    s_sub_u32 s24, s24, 1
    s_cmp_lg_u32 s24, 0
    s_cbranch_scc1 L_aw13
L_awx12:
    s_mov_b64 exec, -1
    s_barrier
    s_lshl_b32 s30, s74, 7
    s_add_u32 s24, s30, 0x124000
    buffer_load_dwordx4 v[4:7], v30, s[12:15], s24 offen sc1
    s_waitcnt vmcnt(0)
    v_permlane32_swap_b32 v4, v6
    v_permlane32_swap_b32 v5, v7
    v_add_f32 v4, v4, v6
    v_add_f32 v5, v5, v7
    s_nop 1
    v_permlane16_swap_b32 v4, v5
    v_add_f32 v4, v4, v5
    s_nop 1
    v_add_f32_dpp v4, v4, v4 row_ror:8 row_mask:0xf bank_mask:0xf
    ds_write_b32 v26, v4 offset:0
    s_waitcnt lgkmcnt(0)
    s_barrier
    s_cmp_lg_u32 s3, 0
    s_cbranch_scc1 L_fr14
    ds_read_b128 v[4:7], v27 offset:0
    s_waitcnt lgkmcnt(0)
    v_add_f32 v4, v4, v5
    v_add_f32 v6, v6, v7
    v_add_f32 v4, v4, v6
    v_cvt_pk_bf16_f32 v4, v4, v4
    buffer_store_short v4, v28, s[20:23], 0 offen offset:0
L_fr14:
    s_lshl_b32 s33, s26, 2
    s_add_u32 s33, s33, s3
    s_lshl_b32 s29, s33, 7
    s_add_u32 s29, s29, 0x1b0000
    s_mov_b32 s24, 262144
    s_branch L_pd15_in
L_pd15:
    s_sleep 64
L_pd15_in:
    buffer_load_dwordx2 v[8:9], v31, s[12:15], s29 offen sc1
    s_waitcnt vmcnt(0)
    v_max_u32 v3, v8, v9
    v_cmp_eq_u32 vcc, -1, v3
    s_sub_u32 s24, s24, 1
    s_cmp_eq_u32 s24, 0
    s_cbranch_scc1 L_pd15_x
    s_and_b64 exec, exec, vcc
    s_cbranch_scc1 L_pd15
L_pd15_x:
    s_mov_b64 exec, -1
    v_mov_b32 v6, v8
    s_nop 1
    v_max_f32_dpp v6, v6, v6 quad_perm:[1,0,3,2] row_mask:0xf bank_mask:0xf
    s_nop 1
    v_max_f32_dpp v6, v6, v6 quad_perm:[2,3,0,1] row_mask:0xf bank_mask:0xf
    s_nop 1
    v_max_f32_dpp v6, v6, v6 row_half_mirror row_mask:0xf bank_mask:0xf
    v_sub_f32 v8, v8, v6
    v_exp_f32 v8, v8
    v_and_b32 v4, 7, v0
    v_cmp_gt_u32 vcc, 6, v4
    s_nop 1
    v_cndmask_b32 v8, 0, v8, vcc
    v_mul_f32 v9, v8, v9
    s_nop 1
    v_add_f32_dpp v9, v9, v9 quad_perm:[1,0,3,2] row_mask:0xf bank_mask:0xf
    s_nop 1
    v_add_f32_dpp v9, v9, v9 quad_perm:[2,3,0,1] row_mask:0xf bank_mask:0xf
    s_nop 1
    v_add_f32_dpp v9, v9, v9 row_half_mirror row_mask:0xf bank_mask:0xf
    v_rcp_f32 v9, v9
    s_nop 0
    v_mul_f32 v8, v8, v9
    v_cvt_pk_bf16_f32 v8, v8, v8
    v_lshrrev_b32 v5, 4, v0
    v_lshlrev_b32 v5, 2, v5
    ds_bpermute_b32 v6, v5, v8
    ds_bpermute_b32 v7, v5, v8 offset:16
    s_waitcnt lgkmcnt(0)
    v_and_b32 v32, v6, v20
    v_and_b32 v33, v6, v21
    v_and_b32 v34, v6, v22
    v_and_b32 v35, v6, v23
    v_and_b32 v36, v7, v20
    v_and_b32 v37, v7, v21
    v_and_b32 v38, v7, v22
    v_and_b32 v39, v7, v23
    s_mul_i32 s29, s33, 1536
    s_add_u32 s29, s29, 0x180000
    s_add_u32 s30, s30, 0x1b8000
    s_lshl_b32 s31, s26, 13
    s_lshr_b32 s24, s74, 5
    s_lshl_b32 s24, s24, 12
    s_add_u32 s31, s31, s24
    s_lshl_b32 s24, s3, 10
    s_add_u32 s31, s31, s24
    s_add_u32 s31, s31, 0x1b8000
    s_mov_b32 s24, 262144
    s_branch L_pd16_in
L_pd16:
L_pd16_in:
    buffer_load_dwordx4 v[40:43], v2, s[12:15], s29 offen sc1
    buffer_load_dwordx4 v[44:47], v29, s[12:15], s29 offen offset:1024 sc1
    s_waitcnt vmcnt(0)
    v_max_u32 v3, v40, v41
    v_max3_u32 v3, v3, v42, v43
    v_max3_u32 v3, v3, v44, v45
    v_max3_u32 v3, v3, v46, v47
    v_cmp_eq_u32 vcc, -1, v3
    s_sub_u32 s24, s24, 1
    s_cmp_eq_u32 s24, 0
    s_cbranch_scc1 L_pd16_x
    s_and_b64 exec, exec, vcc
    s_cbranch_scc1 L_pd16
L_pd16_x:
    s_mov_b64 exec, -1
    v_mfma_f32_16x16x32_bf16 v[12:15], v[40:43], v[32:35], 0
    v_mfma_f32_16x16x32_bf16 v[12:15], v[44:47], v[36:39], v[12:15]
    s_nop 7
    v_cvt_pk_bf16_f32 v4, v12, v13
    v_cvt_pk_bf16_f32 v5, v14, v15
    ds_write_b64 v24, v[4:5]
    s_waitcnt lgkmcnt(0)
    s_barrier
    ds_read_b128 v[48:51], v25 offset:0
    ds_read_b128 v[52:55], v25 offset:64
    ds_read_b128 v[56:59], v25 offset:128
    ds_read_b128 v[60:63], v25 offset:192
    s_waitcnt lgkmcnt(3)
    v_mfma_f32_16x16x32_bf16 v[64:67], v[48:51], a[128:131], 0
    v_mfma_f32_16x16x32_bf16 v[68:71], v[48:51], a[144:147], 0
    v_mfma_f32_16x16x32_bf16 v[72:75], v[48:51], a[160:163], 0
    v_mfma_f32_16x16x32_bf16 v[76:79], v[48:51], a[176:179], 0
    s_waitcnt lgkmcnt(2)
    v_mfma_f32_16x16x32_bf16 v[64:67], v[52:55], a[132:135], v[64:67]
    v_mfma_f32_16x16x32_bf16 v[68:71], v[52:55], a[148:151], v[68:71]
    v_mfma_f32_16x16x32_bf16 v[72:75], v[52:55], a[164:167], v[72:75]
    v_mfma_f32_16x16x32_bf16 v[76:79], v[52:55], a[180:183], v[76:79]
    s_waitcnt lgkmcnt(1)
    v_mfma_f32_16x16x32_bf16 v[64:67], v[56:59], a[136:139], v[64:67]
    v_mfma_f32_16x16x32_bf16 v[68:71], v[56:59], a[152:155], v[68:71]
    v_mfma_f32_16x16x32_bf16 v[72:75], v[56:59], a[168:171], v[72:75]
    v_mfma_f32_16x16x32_bf16 v[76:79], v[56:59], a[184:187], v[76:79]
    s_waitcnt lgkmcnt(0)
    v_mfma_f32_16x16x32_bf16 v[64:67], v[60:63], a[140:143], v[64:67]
    v_mfma_f32_16x16x32_bf16 v[68:71], v[60:63], a[156:159], v[68:71]
    v_mfma_f32_16x16x32_bf16 v[72:75], v[60:63], a[172:175], v[72:75]
    v_mfma_f32_16x16x32_bf16 v[76:79], v[60:63], a[188:191], v[76:79]
    s_nop 4
    v_mov_b32_dpp v8, v64 quad_perm:[0,1,2,3] row_mask:0x1 bank_mask:0xf
    v_mov_b32_dpp v9, v65 quad_perm:[0,1,2,3] row_mask:0x1 bank_mask:0xf
    v_mov_b32_dpp v10, v66 quad_perm:[0,1,2,3] row_mask:0x1 bank_mask:0xf
    v_mov_b32_dpp v11, v67 quad_perm:[0,1,2,3] row_mask:0x1 bank_mask:0xf
    v_mov_b32_dpp v8, v68 quad_perm:[0,1,2,3] row_mask:0x2 bank_mask:0xf
    v_mov_b32_dpp v9, v69 quad_perm:[0,1,2,3] row_mask:0x2 bank_mask:0xf
    v_mov_b32_dpp v10, v70 quad_perm:[0,1,2,3] row_mask:0x2 bank_mask:0xf
    v_mov_b32_dpp v11, v71 quad_perm:[0,1,2,3] row_mask:0x2 bank_mask:0xf
    v_mov_b32_dpp v8, v72 quad_perm:[0,1,2,3] row_mask:0x4 bank_mask:0xf
    v_mov_b32_dpp v9, v73 quad_perm:[0,1,2,3] row_mask:0x4 bank_mask:0xf
    v_mov_b32_dpp v10, v74 quad_perm:[0,1,2,3] row_mask:0x4 bank_mask:0xf
    v_mov_b32_dpp v11, v75 quad_perm:[0,1,2,3] row_mask:0x4 bank_mask:0xf
    v_mov_b32_dpp v8, v76 quad_perm:[0,1,2,3] row_mask:0x8 bank_mask:0xf
    v_mov_b32_dpp v9, v77 quad_perm:[0,1,2,3] row_mask:0x8 bank_mask:0xf
    v_mov_b32_dpp v10, v78 quad_perm:[0,1,2,3] row_mask:0x8 bank_mask:0xf
    v_mov_b32_dpp v11, v79 quad_perm:[0,1,2,3] row_mask:0x8 bank_mask:0xf
    buffer_store_dwordx4 v[8:11], v2, s[12:15], s31 offen sc1
    s_mov_b32 s24, 262144
    s_branch L_pd17_in
L_pd17:
L_pd17_in:
    buffer_load_dwordx4 v[4:7], v30, s[12:15], s30 offen sc1
    s_waitcnt vmcnt(0)
    v_max_u32 v3, v4, v5
    v_max3_u32 v3, v3, v6, v7
    v_cmp_eq_u32 vcc, -1, v3
    s_sub_u32 s24, s24, 1
    s_cmp_eq_u32 s24, 0
    s_cbranch_scc1 L_pd17_x
    s_and_b64 exec, exec, vcc
    s_cbranch_scc1 L_pd17
L_pd17_x:
    s_mov_b64 exec, -1
    v_permlane32_swap_b32 v4, v6
    v_permlane32_swap_b32 v5, v7
    v_add_f32 v4, v4, v6
    v_add_f32 v5, v5, v7
    s_nop 1
    v_permlane16_swap_b32 v4, v5
    v_add_f32 v4, v4, v5
    s_nop 1
    v_add_f32_dpp v4, v4, v4 row_ror:8 row_mask:0xf bank_mask:0xf
    ds_write_b32 v26, v4 offset:512
    s_waitcnt lgkmcnt(0)
    s_barrier
    s_cmp_lg_u32 s3, 0
    s_cbranch_scc1 L_fr18
    ds_read_b128 v[4:7], v27 offset:512
    s_waitcnt lgkmcnt(0)
    v_add_f32 v4, v4, v5
    v_add_f32 v6, v6, v7
    v_add_f32 v4, v4, v6
    v_cvt_pk_bf16_f32 v4, v4, v4
    buffer_store_short v4, v28, s[20:23], 0 offen offset:1024
L_fr18:
L_end:
    s_endpgm
L_C:
    s_cmp_lg_u32 s3, 0
    s_cbranch_scc1 L_C_q
    v_lshrrev_b32 v3, 4, v0
    v_and_b32 v4, 3, v0
    v_lshlrev_b32 v5, 6, v3
    v_lshl_add_u32 v5, v4, 4, v5
    v_bfe_u32 v4, v0, 2, 2
    v_lshl_add_u32 v5, v4, 8, v5
    s_lshl_b32 s24, s26, 10
    s_add_u32 s24, s24, 0x164000
    buffer_store_dwordx4 v[8:11], v5, s[12:15], s24 offen sc1
L_C_q:
    s_waitcnt vmcnt(0)
    s_barrier
    s_cmp_lg_u32 s3, 0
    s_cbranch_scc1 L_sig19
    s_mov_b64 exec, 1
    v_mov_b32 v3, 1
    v_mov_b32 v4, 1
    buffer_atomic_add v4, off, s[16:19], 0 offset:128
    buffer_atomic_add v3, off, s[16:19], 0 offset:0 sc0
    s_waitcnt vmcnt(0)
    v_readfirstlane_b32 s24, v3
    s_mov_b64 exec, -1
    s_and_b32 s24, s24, 63
    s_cmp_lg_u32 s24, 63
    s_cbranch_scc1 L_sig19
    v_lshlrev_b32 v4, 7, v0
    v_mov_b32 v3, 1
    s_mov_b32 s24, 0x170000
    buffer_store_dword v3, v4, s[12:15], s24 offen offset:0 sc1
L_sig19:
    s_lshr_b32 s30, s72, 3
    s_lshl_b32 s30, s30, 22
    s_add_u32 s4, s38, s30
    s_addc_u32 s5, s39, 0
    s_mov_b32 s6, 0x400000
    s_mov_b32 s7, 0x20000
    s_mov_b32 s8, s56
    s_mov_b32 s9, s57
    s_mov_b32 s10, 0x400000
    s_mov_b32 s11, 0x20000
    s_lshl_b32 s33, s26, 17
    s_lshl_b32 s24, s3, 15
    s_add_u32 s33, s33, s24
    s_add_u32 s33, s33, 512
    s_mul_i32 s34, s3, 17408
    s_add_u32 s34, s34, 67584
    s_mov_b32 exec_hi, 0
    s_mov_b32 s70, 0
L_woC:
    s_and_b32 s24, s70, 1
    s_lshl_b32 s24, s24, 4
    s_and_b32 s25, s70, 4
    s_lshl_b32 s25, s25, 1
    s_or_b32 s24, s24, s25
    s_bfe_u32 s25, s70, 0x10001
    s_or_b32 s24, s24, s25
    s_lshl_b32 s24, s24, 10
    s_add_u32 s24, s24, s33
    s_mul_i32 s25, s70, 2176
    s_add_u32 m0, s25, s34
    s_waitcnt vmcnt(24)
    buffer_load_dwordx4 v2, s[8:11], s24 offen nt lds
    s_add_u32 m0, m0, 544
    s_add_u32 s24, s24, 2048
    s_waitcnt vmcnt(24)
    buffer_load_dwordx4 v2, s[8:11], s24 offen nt lds
    s_add_u32 m0, m0, 544
    s_add_u32 s24, s24, 2048
    s_waitcnt vmcnt(24)
    buffer_load_dwordx4 v2, s[8:11], s24 offen nt lds
    s_add_u32 m0, m0, 544
    s_add_u32 s24, s24, 2048
    s_waitcnt vmcnt(24)
    buffer_load_dwordx4 v2, s[8:11], s24 offen nt lds
    s_add_u32 s70, s70, 1
    s_cmp_lt_u32 s70, 8
    s_cbranch_scc1 L_woC
    s_mov_b64 exec, -1
    s_lshl_b32 s32, s3, 16
    s_and_b32 s24, s72, 7
    s_lshl_b32 s24, s24, 10
    s_add_u32 s32, s32, s24
    s_mul_i32 s34, s3, 8448
    s_mov_b32 s33, 0
    s_add_u32 m0, s33, s34
    s_nop 0
    buffer_load_dwordx4 v2, s[4:7], s32 offen  lds
    s_add_u32 m0, m0, 1056
    s_add_u32 s32, s32, 8192
    buffer_load_dwordx4 v2, s[4:7], s32 offen  lds
    s_add_u32 m0, m0, 1056
    s_add_u32 s32, s32, 8192
    buffer_load_dwordx4 v2, s[4:7], s32 offen  lds
    s_add_u32 m0, m0, 1056
    s_add_u32 s32, s32, 8192
    buffer_load_dwordx4 v2, s[4:7], s32 offen  lds
    s_add_u32 m0, m0, 1056
    s_add_u32 s32, s32, 8192
    buffer_load_dwordx4 v2, s[4:7], s32 offen  lds
    s_add_u32 m0, m0, 1056
    s_add_u32 s32, s32, 8192
    buffer_load_dwordx4 v2, s[4:7], s32 offen  lds
    s_add_u32 m0, m0, 1056
    s_add_u32 s32, s32, 8192
    buffer_load_dwordx4 v2, s[4:7], s32 offen  lds
    s_add_u32 m0, m0, 1056
    s_add_u32 s32, s32, 8192
    buffer_load_dwordx4 v2, s[4:7], s32 offen  lds
    s_add_u32 s32, s32, 204800
    s_mov_b32 s33, 33792
    s_add_u32 m0, s33, s34
    s_nop 0
    buffer_load_dwordx4 v2, s[4:7], s32 offen  lds
    s_add_u32 m0, m0, 1056
    s_add_u32 s32, s32, 8192
    buffer_load_dwordx4 v2, s[4:7], s32 offen  lds
    s_add_u32 m0, m0, 1056
    s_add_u32 s32, s32, 8192
    buffer_load_dwordx4 v2, s[4:7], s32 offen  lds
    s_add_u32 m0, m0, 1056
    s_add_u32 s32, s32, 8192
    buffer_load_dwordx4 v2, s[4:7], s32 offen  lds
    s_add_u32 m0, m0, 1056
    s_add_u32 s32, s32, 8192
    buffer_load_dwordx4 v2, s[4:7], s32 offen  lds
    s_add_u32 m0, m0, 1056
    s_add_u32 s32, s32, 8192
    buffer_load_dwordx4 v2, s[4:7], s32 offen  lds
    s_add_u32 m0, m0, 1056
    s_add_u32 s32, s32, 8192
    buffer_load_dwordx4 v2, s[4:7], s32 offen  lds
    s_add_u32 m0, m0, 1056
    s_add_u32 s32, s32, 8192
    buffer_load_dwordx4 v2, s[4:7], s32 offen  lds
    s_add_u32 s32, s32, 204800
    s_waitcnt vmcnt(16)
    s_barrier
    v_lshrrev_b32 v3, 2, v0
    v_mul_u32_u24 v3, 544, v3
    v_and_b32 v4, 3, v0
    v_lshl_add_u32 v3, v4, 3, v3
    s_mul_i32 s24, s3, 128
    s_add_u32 s24, s24, 67584
    v_add_u32 v3, s24, v3
    v_add_u32 v4, 34816, v3
    ds_read_b64_tr_b16 a[128:129], v3 offset:0
    ds_read_b64_tr_b16 a[130:131], v3 offset:8704
    ds_read_b64_tr_b16 a[132:133], v3 offset:17408
    ds_read_b64_tr_b16 a[134:135], v3 offset:26112
    ds_read_b64_tr_b16 a[136:137], v4 offset:0
    ds_read_b64_tr_b16 a[138:139], v4 offset:8704
    ds_read_b64_tr_b16 a[140:141], v4 offset:17408
    ds_read_b64_tr_b16 a[142:143], v4 offset:26112
    ds_read_b64_tr_b16 a[144:145], v3 offset:32
    ds_read_b64_tr_b16 a[146:147], v3 offset:8736
    ds_read_b64_tr_b16 a[148:149], v3 offset:17440
    ds_read_b64_tr_b16 a[150:151], v3 offset:26144
    ds_read_b64_tr_b16 a[152:153], v4 offset:32
    ds_read_b64_tr_b16 a[154:155], v4 offset:8736
    ds_read_b64_tr_b16 a[156:157], v4 offset:17440
    ds_read_b64_tr_b16 a[158:159], v4 offset:26144
    ds_read_b64_tr_b16 a[160:161], v3 offset:64
    ds_read_b64_tr_b16 a[162:163], v3 offset:8768
    ds_read_b64_tr_b16 a[164:165], v3 offset:17472
    ds_read_b64_tr_b16 a[166:167], v3 offset:26176
    ds_read_b64_tr_b16 a[168:169], v4 offset:64
    ds_read_b64_tr_b16 a[170:171], v4 offset:8768
    ds_read_b64_tr_b16 a[172:173], v4 offset:17472
    ds_read_b64_tr_b16 a[174:175], v4 offset:26176
    ds_read_b64_tr_b16 a[176:177], v3 offset:96
    ds_read_b64_tr_b16 a[178:179], v3 offset:8800
    ds_read_b64_tr_b16 a[180:181], v3 offset:17504
    ds_read_b64_tr_b16 a[182:183], v3 offset:26208
    ds_read_b64_tr_b16 a[184:185], v4 offset:96
    ds_read_b64_tr_b16 a[186:187], v4 offset:8800
    ds_read_b64_tr_b16 a[188:189], v4 offset:17504
    ds_read_b64_tr_b16 a[190:191], v4 offset:26208
    s_waitcnt lgkmcnt(0)
    s_barrier
    s_mov_b32 s33, 67584
    s_add_u32 m0, s33, s34
    s_nop 0
    buffer_load_dwordx4 v2, s[4:7], s32 offen  lds
    s_add_u32 m0, m0, 1056
    s_add_u32 s32, s32, 8192
    buffer_load_dwordx4 v2, s[4:7], s32 offen  lds
    s_add_u32 m0, m0, 1056
    s_add_u32 s32, s32, 8192
    buffer_load_dwordx4 v2, s[4:7], s32 offen  lds
    s_add_u32 m0, m0, 1056
    s_add_u32 s32, s32, 8192
    buffer_load_dwordx4 v2, s[4:7], s32 offen  lds
    s_add_u32 m0, m0, 1056
    s_add_u32 s32, s32, 8192
    buffer_load_dwordx4 v2, s[4:7], s32 offen  lds
    s_add_u32 m0, m0, 1056
    s_add_u32 s32, s32, 8192
    buffer_load_dwordx4 v2, s[4:7], s32 offen  lds
    s_add_u32 m0, m0, 1056
    s_add_u32 s32, s32, 8192
    buffer_load_dwordx4 v2, s[4:7], s32 offen  lds
    s_add_u32 m0, m0, 1056
    s_add_u32 s32, s32, 8192
    buffer_load_dwordx4 v2, s[4:7], s32 offen  lds
    s_add_u32 s32, s32, 204800
    s_lshr_b32 s28, s3, 1
    s_and_b32 s29, s3, 1
    v_and_b32 v3, 15, v0
    v_lshrrev_b32 v4, 4, v0
    v_mul_u32_u24 v19, 1056, v3
    v_lshl_add_u32 v19, v4, 4, v19
    s_mul_i32 s24, s28, 16896
    s_add_u32 s24, s24, 101376
    v_add_u32 v18, s24, v19
    v_lshrrev_b32 v5, 2, v0
    v_mul_u32_u24 v20, 1056, v5
    v_and_b32 v5, 3, v0
    v_lshl_add_u32 v20, v5, 3, v20
    s_lshl_b32 s24, s29, 9
    v_add_u32 v20, s24, v20
    v_mov_b32 v128, 0
    v_mov_b32 v129, 0
    v_mov_b32 v130, 0
    v_mov_b32 v131, 0
    v_mov_b32 v132, 0
    v_mov_b32 v133, 0
    v_mov_b32 v134, 0
    v_mov_b32 v135, 0
    v_mov_b32 v136, 0
    v_mov_b32 v137, 0
    v_mov_b32 v138, 0
    v_mov_b32 v139, 0
    v_mov_b32 v140, 0
    v_mov_b32 v141, 0
    v_mov_b32 v142, 0
    v_mov_b32 v143, 0
    v_mov_b32 v144, 0
    v_mov_b32 v145, 0
    v_mov_b32 v146, 0
    v_mov_b32 v147, 0
    v_mov_b32 v148, 0
    v_mov_b32 v149, 0
    v_mov_b32 v150, 0
    v_mov_b32 v151, 0
    v_mov_b32 v152, 0
    v_mov_b32 v153, 0
    v_mov_b32 v154, 0
    v_mov_b32 v155, 0
    v_mov_b32 v156, 0
    v_mov_b32 v157, 0
    v_mov_b32 v158, 0
    v_mov_b32 v159, 0
    v_mov_b32 v160, 0
    v_mov_b32 v161, 0
    v_mov_b32 v162, 0
    v_mov_b32 v163, 0
    v_mov_b32 v164, 0
    v_mov_b32 v165, 0
    v_mov_b32 v166, 0
    v_mov_b32 v167, 0
    v_mov_b32 v168, 0
    v_mov_b32 v169, 0
    v_mov_b32 v170, 0
    v_mov_b32 v171, 0
    v_mov_b32 v172, 0
    v_mov_b32 v173, 0
    v_mov_b32 v174, 0
    v_mov_b32 v175, 0
    v_mov_b32 v176, 0
    v_mov_b32 v177, 0
    v_mov_b32 v178, 0
    v_mov_b32 v179, 0
    v_mov_b32 v180, 0
    v_mov_b32 v181, 0
    v_mov_b32 v182, 0
    v_mov_b32 v183, 0
    v_mov_b32 v184, 0
    v_mov_b32 v185, 0
    v_mov_b32 v186, 0
    v_mov_b32 v187, 0
    v_mov_b32 v188, 0
    v_mov_b32 v189, 0
    v_mov_b32 v190, 0
    v_mov_b32 v191, 0
    v_mov_b32 v22, 0xff800000
    v_mov_b32 v23, 0
    s_cmp_lg_u32 s3, 0
    s_cbranch_scc1 L_awx20
    s_mov_b32 s24, 262144
    s_mov_b64 exec, 1
L_aw21:
    buffer_load_dword v1, off, s[12:15], s73 offset:0 sc1
    s_waitcnt vmcnt(0)
    v_readfirstlane_b32 s25, v1
    s_nop 0
    s_cmp_eq_u32 s25, 1
    s_cbranch_scc1 L_awx20
    s_sleep 4
    s_sub_u32 s24, s24, 1
    s_cmp_lg_u32 s24, 0
    s_cbranch_scc1 L_aw21
L_awx20:
    s_mov_b64 exec, -1
    s_barrier
    s_lshr_b32 s24, s72, 3
    s_lshl_b32 s24, s24, 15
    s_lshl_b32 s25, s3, 13
    s_add_u32 s24, s24, s25
    s_add_u32 s24, s24, 0x0
    buffer_load_dwordx4 v[32:35], v2, s[12:15], s24 offen offset:0 sc1
    buffer_load_dwordx4 v[36:39], v2, s[12:15], s24 offen offset:1024 sc1
    buffer_load_dwordx4 v[40:43], v2, s[12:15], s24 offen offset:2048 sc1
    buffer_load_dwordx4 v[44:47], v2, s[12:15], s24 offen offset:3072 sc1
    s_add_u32 s24, s24, 4096
    buffer_load_dwordx4 v[48:51], v2, s[12:15], s24 offen offset:0 sc1
    buffer_load_dwordx4 v[52:55], v2, s[12:15], s24 offen offset:1024 sc1
    buffer_load_dwordx4 v[56:59], v2, s[12:15], s24 offen offset:2048 sc1
    buffer_load_dwordx4 v[60:63], v2, s[12:15], s24 offen offset:3072 sc1
    s_add_u32 s24, s34, 101376
    v_add_u32 v3, s24, v2
    s_waitcnt vmcnt(7)
    ds_write_b128 v3, v[32:35] offset:0
    s_waitcnt vmcnt(6)
    ds_write_b128 v3, v[36:39] offset:1056
    s_waitcnt vmcnt(5)
    ds_write_b128 v3, v[40:43] offset:2112
    s_waitcnt vmcnt(4)
    ds_write_b128 v3, v[44:47] offset:3168
    s_waitcnt vmcnt(3)
    ds_write_b128 v3, v[48:51] offset:4224
    s_waitcnt vmcnt(2)
    ds_write_b128 v3, v[52:55] offset:5280
    s_waitcnt vmcnt(1)
    ds_write_b128 v3, v[56:59] offset:6336
    s_waitcnt vmcnt(0)
    ds_write_b128 v3, v[60:63] offset:7392
    s_waitcnt lgkmcnt(0)
    s_barrier
    ds_read_b128 a[0:3], v18 offset:0
    ds_read_b128 a[4:7], v18 offset:64
    ds_read_b128 a[8:11], v18 offset:128
    ds_read_b128 a[12:15], v18 offset:192
    ds_read_b128 a[16:19], v18 offset:256
    ds_read_b128 a[20:23], v18 offset:320
    ds_read_b128 a[24:27], v18 offset:384
    ds_read_b128 a[28:31], v18 offset:448
    ds_read_b128 a[32:35], v18 offset:512
    ds_read_b128 a[36:39], v18 offset:576
    ds_read_b128 a[40:43], v18 offset:640
    ds_read_b128 a[44:47], v18 offset:704
    ds_read_b128 a[48:51], v18 offset:768
    ds_read_b128 a[52:55], v18 offset:832
    ds_read_b128 a[56:59], v18 offset:896
    ds_read_b128 a[60:63], v18 offset:960
    s_cmp_lg_u32 s3, 0
    s_cbranch_scc1 L_xi22
    s_getreg_b32 s25, hwreg(HW_REG_XCC_ID, 0, 4)
    s_lshl_b32 s24, s26, 7
    s_add_u32 s24, s24, 0x1b4000
    s_mov_b64 exec, 1
    v_mov_b32 v3, s25
    buffer_store_dword v3, off, s[12:15], s24 offset:4 sc1
    s_mov_b64 exec, -1
L_xi22:
    s_mov_b32 s27, 0
    s_mov_b32 s33, 101376
    s_mov_b32 s35, 0
    s_waitcnt lgkmcnt(0)
L_CT:
    s_waitcnt vmcnt(16)
    s_barrier
    v_add_u32 v24, s35, v19
    v_add_u32 v25, s35, v20
    ds_read_b128 v[32:35], v24 offset:0
    ds_read_b128 v[36:39], v24 offset:16896
    ds_read_b128 v[40:43], v24 offset:64
    ds_read_b128 v[44:47], v24 offset:16960
    ds_read_b128 v[48:51], v24 offset:128
    ds_read_b128 v[52:55], v24 offset:17024
    ds_read_b128 v[56:59], v24 offset:192
    s_add_u32 m0, s33, s34
    s_nop 0
    buffer_load_dwordx4 v2, s[4:7], s32 offen nt lds
    s_add_u32 m0, m0, 1056
    s_add_u32 s32, s32, 8192
    buffer_load_dwordx4 v2, s[4:7], s32 offen nt lds
    s_add_u32 m0, m0, 1056
    s_add_u32 s32, s32, 8192
    buffer_load_dwordx4 v2, s[4:7], s32 offen nt lds
    s_add_u32 m0, m0, 1056
    s_add_u32 s32, s32, 8192
    buffer_load_dwordx4 v2, s[4:7], s32 offen nt lds
    s_add_u32 m0, m0, 1056
    s_add_u32 s32, s32, 8192
    buffer_load_dwordx4 v2, s[4:7], s32 offen nt lds
    s_add_u32 m0, m0, 1056
    s_add_u32 s32, s32, 8192
    buffer_load_dwordx4 v2, s[4:7], s32 offen nt lds
    s_add_u32 m0, m0, 1056
    s_add_u32 s32, s32, 8192
    buffer_load_dwordx4 v2, s[4:7], s32 offen nt lds
    s_add_u32 m0, m0, 1056
    s_add_u32 s32, s32, 8192
    buffer_load_dwordx4 v2, s[4:7], s32 offen nt lds
    s_add_u32 s32, s32, 204800
    s_mov_b32 s33, s35
    s_add_u32 s35, s35, 33792
    s_cmp_eq_u32 s35, 135168
    s_cselect_b32 s35, 0, s35
    s_waitcnt lgkmcnt(6)
    v_mfma_f32_16x16x32_bf16 v[64:67], v[32:35], a[0:3], 0
    ds_read_b128 v[60:63], v24 offset:17088
    s_waitcnt lgkmcnt(6)
    v_mfma_f32_16x16x32_bf16 v[68:71], v[36:39], a[0:3], 0
    ds_read_b128 v[32:35], v24 offset:256
    s_waitcnt lgkmcnt(6)
    v_mfma_f32_16x16x32_bf16 v[64:67], v[40:43], a[4:7], v[64:67]
    ds_read_b128 v[36:39], v24 offset:17152
    s_waitcnt lgkmcnt(6)
    v_mfma_f32_16x16x32_bf16 v[68:71], v[44:47], a[4:7], v[68:71]
    ds_read_b128 v[40:43], v24 offset:320
    s_waitcnt lgkmcnt(6)
    v_mfma_f32_16x16x32_bf16 v[64:67], v[48:51], a[8:11], v[64:67]
    ds_read_b128 v[44:47], v24 offset:17216
    s_waitcnt lgkmcnt(6)
    v_mfma_f32_16x16x32_bf16 v[68:71], v[52:55], a[8:11], v[68:71]
    ds_read_b128 v[48:51], v24 offset:384
    s_waitcnt lgkmcnt(6)
    v_mfma_f32_16x16x32_bf16 v[64:67], v[56:59], a[12:15], v[64:67]
    ds_read_b128 v[52:55], v24 offset:17280
    s_waitcnt lgkmcnt(6)
    v_mfma_f32_16x16x32_bf16 v[68:71], v[60:63], a[12:15], v[68:71]
    ds_read_b128 v[56:59], v24 offset:448
    s_waitcnt lgkmcnt(6)
    v_mfma_f32_16x16x32_bf16 v[64:67], v[32:35], a[16:19], v[64:67]
    ds_read_b128 v[60:63], v24 offset:17344
    s_waitcnt lgkmcnt(6)
    v_mfma_f32_16x16x32_bf16 v[68:71], v[36:39], a[16:19], v[68:71]
    ds_read_b128 v[32:35], v24 offset:512
    s_waitcnt lgkmcnt(6)
    v_mfma_f32_16x16x32_bf16 v[64:67], v[40:43], a[20:23], v[64:67]
    ds_read_b128 v[36:39], v24 offset:17408
    s_waitcnt lgkmcnt(6)
    v_mfma_f32_16x16x32_bf16 v[68:71], v[44:47], a[20:23], v[68:71]
    ds_read_b128 v[40:43], v24 offset:576
    s_waitcnt lgkmcnt(6)
    v_mfma_f32_16x16x32_bf16 v[64:67], v[48:51], a[24:27], v[64:67]
    ds_read_b128 v[44:47], v24 offset:17472
    s_waitcnt lgkmcnt(6)
    v_mfma_f32_16x16x32_bf16 v[68:71], v[52:55], a[24:27], v[68:71]
    ds_read_b128 v[48:51], v24 offset:640
    s_waitcnt lgkmcnt(6)
    v_mfma_f32_16x16x32_bf16 v[64:67], v[56:59], a[28:31], v[64:67]
    ds_read_b128 v[52:55], v24 offset:17536
    s_waitcnt lgkmcnt(6)
    v_mfma_f32_16x16x32_bf16 v[68:71], v[60:63], a[28:31], v[68:71]
    ds_read_b128 v[56:59], v24 offset:704
    s_waitcnt lgkmcnt(6)
    v_mfma_f32_16x16x32_bf16 v[64:67], v[32:35], a[32:35], v[64:67]
    ds_read_b128 v[60:63], v24 offset:17600
    s_waitcnt lgkmcnt(6)
    v_mfma_f32_16x16x32_bf16 v[68:71], v[36:39], a[32:35], v[68:71]
    ds_read_b128 v[32:35], v24 offset:768
    s_waitcnt lgkmcnt(6)
    v_mfma_f32_16x16x32_bf16 v[64:67], v[40:43], a[36:39], v[64:67]
    ds_read_b128 v[36:39], v24 offset:17664
    s_waitcnt lgkmcnt(6)
    v_mfma_f32_16x16x32_bf16 v[68:71], v[44:47], a[36:39], v[68:71]
    ds_read_b128 v[40:43], v24 offset:832
    s_waitcnt lgkmcnt(6)
    v_mfma_f32_16x16x32_bf16 v[64:67], v[48:51], a[40:43], v[64:67]
    ds_read_b128 v[44:47], v24 offset:17728
    s_waitcnt lgkmcnt(6)
    v_mfma_f32_16x16x32_bf16 v[68:71], v[52:55], a[40:43], v[68:71]
    ds_read_b128 v[48:51], v24 offset:896
    s_waitcnt lgkmcnt(6)
    v_mfma_f32_16x16x32_bf16 v[64:67], v[56:59], a[44:47], v[64:67]
    ds_read_b128 v[52:55], v24 offset:17792
    s_waitcnt lgkmcnt(6)
    v_mfma_f32_16x16x32_bf16 v[68:71], v[60:63], a[44:47], v[68:71]
    ds_read_b128 v[56:59], v24 offset:960
    s_waitcnt lgkmcnt(6)
    v_mfma_f32_16x16x32_bf16 v[64:67], v[32:35], a[48:51], v[64:67]
    ds_read_b128 v[60:63], v24 offset:17856
    s_waitcnt lgkmcnt(6)
    v_mfma_f32_16x16x32_bf16 v[68:71], v[36:39], a[48:51], v[68:71]
    ds_read_b64_tr_b16 v[192:193], v25 offset:0
    s_waitcnt lgkmcnt(6)
    v_mfma_f32_16x16x32_bf16 v[64:67], v[40:43], a[52:55], v[64:67]
    ds_read_b64_tr_b16 v[194:195], v25 offset:16896
    s_waitcnt lgkmcnt(6)
    v_mfma_f32_16x16x32_bf16 v[68:71], v[44:47], a[52:55], v[68:71]
    ds_read_b64_tr_b16 v[196:197], v25 offset:32
    s_waitcnt lgkmcnt(6)
    v_mfma_f32_16x16x32_bf16 v[64:67], v[48:51], a[56:59], v[64:67]
    ds_read_b64_tr_b16 v[198:199], v25 offset:16928
    s_waitcnt lgkmcnt(6)
    v_mfma_f32_16x16x32_bf16 v[68:71], v[52:55], a[56:59], v[68:71]
    ds_read_b64_tr_b16 v[200:201], v25 offset:64
    s_waitcnt lgkmcnt(6)
    v_mfma_f32_16x16x32_bf16 v[64:67], v[56:59], a[60:63], v[64:67]
    ds_read_b64_tr_b16 v[202:203], v25 offset:16960
    s_waitcnt lgkmcnt(6)
    v_mfma_f32_16x16x32_bf16 v[68:71], v[60:63], a[60:63], v[68:71]
    ds_read_b64_tr_b16 v[204:205], v25 offset:96
    ds_read_b64_tr_b16 v[206:207], v25 offset:16992
    ds_read_b64_tr_b16 v[208:209], v25 offset:128
    ds_read_b64_tr_b16 v[210:211], v25 offset:17024
    ds_read_b64_tr_b16 v[212:213], v25 offset:160
    ds_read_b64_tr_b16 v[214:215], v25 offset:17056
    ds_read_b64_tr_b16 v[216:217], v25 offset:192
    ds_read_b64_tr_b16 v[218:219], v25 offset:17088
    v_max3_f32 v3, v64, v65, v22
    v_max3_f32 v3, v3, v66, v67
    v_max3_f32 v3, v3, v68, v69
    v_max3_f32 v3, v3, v70, v71
    v_mov_b32 v4, v3
    ds_read_b64_tr_b16 v[220:221], v25 offset:224
    s_nop 0
    v_permlane32_swap_b32 v3, v4
    ds_read_b64_tr_b16 v[222:223], v25 offset:17120
    v_max_f32 v3, v3, v4
    ds_read_b64_tr_b16 v[224:225], v25 offset:256
    v_mov_b32 v4, v3
    ds_read_b64_tr_b16 v[226:227], v25 offset:17152
    s_nop 0
    v_permlane16_swap_b32 v3, v4
    ds_read_b64_tr_b16 v[228:229], v25 offset:288
    v_max_f32 v3, v3, v4
    ds_read_b64_tr_b16 v[230:231], v25 offset:17184
    v_sub_f32 v4, v22, v3
    ds_read_b64_tr_b16 v[232:233], v25 offset:320
    v_exp_f32 v4, v4
    ds_read_b64_tr_b16 v[234:235], v25 offset:17216
    v_mov_b32 v22, v3
    ds_read_b64_tr_b16 v[236:237], v25 offset:352
    v_sub_f32 v64, v64, v3
    ds_read_b64_tr_b16 v[238:239], v25 offset:17248
    v_sub_f32 v65, v65, v3
    ds_read_b64_tr_b16 v[240:241], v25 offset:384
    v_sub_f32 v66, v66, v3
    ds_read_b64_tr_b16 v[242:243], v25 offset:17280
    v_sub_f32 v67, v67, v3
    ds_read_b64_tr_b16 v[244:245], v25 offset:416
    v_sub_f32 v68, v68, v3
    ds_read_b64_tr_b16 v[246:247], v25 offset:17312
    v_sub_f32 v69, v69, v3
    ds_read_b64_tr_b16 v[248:249], v25 offset:448
    v_sub_f32 v70, v70, v3
    ds_read_b64_tr_b16 v[250:251], v25 offset:17344
    v_sub_f32 v71, v71, v3
    ds_read_b64_tr_b16 v[252:253], v25 offset:480
    v_exp_f32 v64, v64
    ds_read_b64_tr_b16 v[254:255], v25 offset:17376
    v_exp_f32 v65, v65
    v_exp_f32 v66, v66
    v_exp_f32 v67, v67
    v_exp_f32 v68, v68
    v_exp_f32 v69, v69
    v_exp_f32 v70, v70
    v_exp_f32 v71, v71
    v_cvt_pk_bf16_f32 v72, v64, v65
    v_cvt_pk_bf16_f32 v73, v66, v67
    v_cvt_pk_bf16_f32 v74, v68, v69
    v_cvt_pk_bf16_f32 v75, v70, v71
    v_pk_mul_f32 v[128:129], v[128:129], v[4:5] op_sel_hi:[1,0]
    v_pk_mul_f32 v[130:131], v[130:131], v[4:5] op_sel_hi:[1,0]
    v_pk_mul_f32 v[132:133], v[132:133], v[4:5] op_sel_hi:[1,0]
    v_pk_mul_f32 v[134:135], v[134:135], v[4:5] op_sel_hi:[1,0]
    s_waitcnt lgkmcnt(0)
    v_mfma_f32_16x16x32_bf16 v[128:131], v[192:195], v[72:75], v[128:131]
    v_pk_mul_f32 v[136:137], v[136:137], v[4:5] op_sel_hi:[1,0]
    v_pk_mul_f32 v[138:139], v[138:139], v[4:5] op_sel_hi:[1,0]
    v_mfma_f32_16x16x32_bf16 v[132:135], v[196:199], v[72:75], v[132:135]
    v_pk_mul_f32 v[140:141], v[140:141], v[4:5] op_sel_hi:[1,0]
    v_pk_mul_f32 v[142:143], v[142:143], v[4:5] op_sel_hi:[1,0]
    v_mfma_f32_16x16x32_bf16 v[136:139], v[200:203], v[72:75], v[136:139]
    v_pk_mul_f32 v[144:145], v[144:145], v[4:5] op_sel_hi:[1,0]
    v_pk_mul_f32 v[146:147], v[146:147], v[4:5] op_sel_hi:[1,0]
    v_mfma_f32_16x16x32_bf16 v[140:143], v[204:207], v[72:75], v[140:143]
    v_pk_mul_f32 v[148:149], v[148:149], v[4:5] op_sel_hi:[1,0]
    v_pk_mul_f32 v[150:151], v[150:151], v[4:5] op_sel_hi:[1,0]
    v_mfma_f32_16x16x32_bf16 v[144:147], v[208:211], v[72:75], v[144:147]
    v_pk_mul_f32 v[152:153], v[152:153], v[4:5] op_sel_hi:[1,0]
    v_pk_mul_f32 v[154:155], v[154:155], v[4:5] op_sel_hi:[1,0]
    v_mfma_f32_16x16x32_bf16 v[148:151], v[212:215], v[72:75], v[148:151]
    v_pk_mul_f32 v[156:157], v[156:157], v[4:5] op_sel_hi:[1,0]
    v_pk_mul_f32 v[158:159], v[158:159], v[4:5] op_sel_hi:[1,0]
    v_mfma_f32_16x16x32_bf16 v[152:155], v[216:219], v[72:75], v[152:155]
    v_pk_mul_f32 v[160:161], v[160:161], v[4:5] op_sel_hi:[1,0]
    v_pk_mul_f32 v[162:163], v[162:163], v[4:5] op_sel_hi:[1,0]
    v_mfma_f32_16x16x32_bf16 v[156:159], v[220:223], v[72:75], v[156:159]
    v_pk_mul_f32 v[164:165], v[164:165], v[4:5] op_sel_hi:[1,0]
    v_pk_mul_f32 v[166:167], v[166:167], v[4:5] op_sel_hi:[1,0]
    v_mfma_f32_16x16x32_bf16 v[160:163], v[224:227], v[72:75], v[160:163]
    v_pk_mul_f32 v[168:169], v[168:169], v[4:5] op_sel_hi:[1,0]
    v_pk_mul_f32 v[170:171], v[170:171], v[4:5] op_sel_hi:[1,0]
    v_mfma_f32_16x16x32_bf16 v[164:167], v[228:231], v[72:75], v[164:167]
    v_pk_mul_f32 v[172:173], v[172:173], v[4:5] op_sel_hi:[1,0]
    v_pk_mul_f32 v[174:175], v[174:175], v[4:5] op_sel_hi:[1,0]
    v_mfma_f32_16x16x32_bf16 v[168:171], v[232:235], v[72:75], v[168:171]
    v_pk_mul_f32 v[176:177], v[176:177], v[4:5] op_sel_hi:[1,0]
    v_pk_mul_f32 v[178:179], v[178:179], v[4:5] op_sel_hi:[1,0]
    v_mfma_f32_16x16x32_bf16 v[172:175], v[236:239], v[72:75], v[172:175]
    v_pk_mul_f32 v[180:181], v[180:181], v[4:5] op_sel_hi:[1,0]
    v_pk_mul_f32 v[182:183], v[182:183], v[4:5] op_sel_hi:[1,0]
    v_mfma_f32_16x16x32_bf16 v[176:179], v[240:243], v[72:75], v[176:179]
    v_pk_mul_f32 v[184:185], v[184:185], v[4:5] op_sel_hi:[1,0]
    v_pk_mul_f32 v[186:187], v[186:187], v[4:5] op_sel_hi:[1,0]
    v_mfma_f32_16x16x32_bf16 v[180:183], v[244:247], v[72:75], v[180:183]
    v_pk_mul_f32 v[188:189], v[188:189], v[4:5] op_sel_hi:[1,0]
    v_pk_mul_f32 v[190:191], v[190:191], v[4:5] op_sel_hi:[1,0]
    v_mfma_f32_16x16x32_bf16 v[184:187], v[248:251], v[72:75], v[184:187]
    s_nop 0
    v_mfma_f32_16x16x32_bf16 v[188:191], v[252:255], v[72:75], v[188:191]
    v_fma_f32 v23, v23, v4, v64
    v_add_f32 v23, v23, v65
    v_add_f32 v23, v23, v66
    v_add_f32 v23, v23, v67
    v_add_f32 v23, v23, v68
    v_add_f32 v23, v23, v69
    v_add_f32 v23, v23, v70
    v_add_f32 v23, v23, v71
    s_add_u32 s27, s27, 1
    s_cmp_lt_u32 s27, 16
    s_cbranch_scc1 L_CT
    s_waitcnt vmcnt(0)
    s_barrier
    v_mov_b32 v4, v23
    s_nop 1
    v_permlane32_swap_b32 v23, v4
    v_add_f32 v23, v23, v4
    v_mov_b32 v4, v23
    s_nop 1
    v_permlane16_swap_b32 v23, v4
    v_add_f32 v23, v23, v4
    v_and_b32 v3, 15, v0
    v_lshlrev_b32 v5, 8, v3
    s_lshl_b32 s24, s72, 3
    s_lshl_b32 s25, s28, 12
    s_add_u32 s24, s24, s25
    s_add_u32 s24, s24, 0x120000
    s_cmp_lg_u32 s29, 0
    s_cbranch_scc1 L_C_ml
    s_mov_b64 exec, 0xffff
    buffer_store_dwordx2 v[22:23], v5, s[12:15], s24 offen sc1
    s_mov_b64 exec, -1
L_C_ml:
    v_lshrrev_b32 v4, 4, v0
    v_mul_u32_u24 v3, 528, v3
    v_lshl_add_u32 v3, v4, 3, v3
    s_mul_i32 s24, s3, 8448
    v_add_u32 v3, s24, v3
    v_cvt_pk_bf16_f32 v32, v128, v129
    v_cvt_pk_bf16_f32 v33, v130, v131
    ds_write_b64 v3, v[32:33] offset:0
    v_cvt_pk_bf16_f32 v34, v132, v133
    v_cvt_pk_bf16_f32 v35, v134, v135
    ds_write_b64 v3, v[34:35] offset:32
    v_cvt_pk_bf16_f32 v36, v136, v137
    v_cvt_pk_bf16_f32 v37, v138, v139
    ds_write_b64 v3, v[36:37] offset:64
    v_cvt_pk_bf16_f32 v38, v140, v141
    v_cvt_pk_bf16_f32 v39, v142, v143
    ds_write_b64 v3, v[38:39] offset:96
    v_cvt_pk_bf16_f32 v40, v144, v145
    v_cvt_pk_bf16_f32 v41, v146, v147
    ds_write_b64 v3, v[40:41] offset:128
    v_cvt_pk_bf16_f32 v42, v148, v149
    v_cvt_pk_bf16_f32 v43, v150, v151
    ds_write_b64 v3, v[42:43] offset:160
    v_cvt_pk_bf16_f32 v44, v152, v153
    v_cvt_pk_bf16_f32 v45, v154, v155
    ds_write_b64 v3, v[44:45] offset:192
    v_cvt_pk_bf16_f32 v46, v156, v157
    v_cvt_pk_bf16_f32 v47, v158, v159
    ds_write_b64 v3, v[46:47] offset:224
    v_cvt_pk_bf16_f32 v32, v160, v161
    v_cvt_pk_bf16_f32 v33, v162, v163
    ds_write_b64 v3, v[32:33] offset:256
    v_cvt_pk_bf16_f32 v34, v164, v165
    v_cvt_pk_bf16_f32 v35, v166, v167
    ds_write_b64 v3, v[34:35] offset:288
    v_cvt_pk_bf16_f32 v36, v168, v169
    v_cvt_pk_bf16_f32 v37, v170, v171
    ds_write_b64 v3, v[36:37] offset:320
    v_cvt_pk_bf16_f32 v38, v172, v173
    v_cvt_pk_bf16_f32 v39, v174, v175
    ds_write_b64 v3, v[38:39] offset:352
    v_cvt_pk_bf16_f32 v40, v176, v177
    v_cvt_pk_bf16_f32 v41, v178, v179
    ds_write_b64 v3, v[40:41] offset:384
    v_cvt_pk_bf16_f32 v42, v180, v181
    v_cvt_pk_bf16_f32 v43, v182, v183
    ds_write_b64 v3, v[42:43] offset:416
    v_cvt_pk_bf16_f32 v44, v184, v185
    v_cvt_pk_bf16_f32 v45, v186, v187
    ds_write_b64 v3, v[44:45] offset:448
    v_cvt_pk_bf16_f32 v46, v188, v189
    v_cvt_pk_bf16_f32 v47, v190, v191
    ds_write_b64 v3, v[46:47] offset:480
    v_lshrrev_b32 v4, 5, v0
    v_and_b32 v5, 31, v0
    v_mul_u32_u24 v3, 528, v4
    v_lshl_add_u32 v3, v5, 4, v3
    v_add_u32 v3, s24, v3
    v_lshlrev_b32 v4, 15, v4
    v_lshl_add_u32 v4, v5, 4, v4
    s_waitcnt lgkmcnt(0)
    ds_read_b128 v[64:67], v3 offset:0
    ds_read_b128 v[68:71], v3 offset:1056
    ds_read_b128 v[72:75], v3 offset:2112
    ds_read_b128 v[76:79], v3 offset:3168
    ds_read_b128 v[80:83], v3 offset:4224
    ds_read_b128 v[84:87], v3 offset:5280
    ds_read_b128 v[88:91], v3 offset:6336
    ds_read_b128 v[92:95], v3 offset:7392
    s_lshl_b32 s24, s72, 10
    s_lshl_b32 s25, s29, 9
    s_add_u32 s24, s24, s25
    s_lshl_b32 s25, s28, 19
    s_add_u32 s24, s24, s25
    s_add_u32 s24, s24, 0x20000
    s_waitcnt lgkmcnt(7)
    buffer_store_dwordx4 v[64:67], v4, s[12:15], s24 offen sc1
    s_add_u32 s24, s24, 0x10000
    s_waitcnt lgkmcnt(6)
    buffer_store_dwordx4 v[68:71], v4, s[12:15], s24 offen sc1
    s_add_u32 s24, s24, 0x10000
    s_waitcnt lgkmcnt(5)
    buffer_store_dwordx4 v[72:75], v4, s[12:15], s24 offen sc1
    s_add_u32 s24, s24, 0x10000
    s_waitcnt lgkmcnt(4)
    buffer_store_dwordx4 v[76:79], v4, s[12:15], s24 offen sc1
    s_add_u32 s24, s24, 0x10000
    s_waitcnt lgkmcnt(3)
    buffer_store_dwordx4 v[80:83], v4, s[12:15], s24 offen sc1
    s_add_u32 s24, s24, 0x10000
    s_waitcnt lgkmcnt(2)
    buffer_store_dwordx4 v[84:87], v4, s[12:15], s24 offen sc1
    s_add_u32 s24, s24, 0x10000
    s_waitcnt lgkmcnt(1)
    buffer_store_dwordx4 v[88:91], v4, s[12:15], s24 offen sc1
    s_add_u32 s24, s24, 0x10000
    s_waitcnt lgkmcnt(0)
    buffer_store_dwordx4 v[92:95], v4, s[12:15], s24 offen sc1
    s_add_u32 s24, s24, 0x10000
    s_waitcnt vmcnt(0)
    s_barrier
    s_cmp_lg_u32 s3, 0
    s_cbranch_scc1 L_sig23
    s_mov_b64 exec, 1
    v_mov_b32 v3, 1
    buffer_atomic_add v3, off, s[16:19], 0 offset:4 sc0
    s_waitcnt vmcnt(0)
    v_readfirstlane_b32 s24, v3
    s_mov_b64 exec, -1
    s_and_b32 s24, s24, 31
    s_cmp_lg_u32 s24, 31
    s_cbranch_scc1 L_sig23
    v_lshlrev_b32 v4, 7, v0
    v_mov_b32 v3, 1
    s_mov_b32 s24, 0x170000
    buffer_store_dword v3, v4, s[12:15], s24 offen offset:4 sc1
L_sig23:
    s_branch L_R
L_last:
    s_endpgm
.section .rodata,"a"
.p2align 6
.amdhsa_kernel concat_heads__compressed_kv_cla__mha_block_cached__decode_kernel
  .amdhsa_next_free_vgpr 512
  .amdhsa_next_free_sgpr 102
  .amdhsa_accum_offset 256
  .amdhsa_group_segment_fixed_size 0
  .amdhsa_kernarg_size 112
  .amdhsa_user_sgpr_count 2
  .amdhsa_user_sgpr_kernarg_segment_ptr 1
  .amdhsa_system_sgpr_workgroup_id_x 1
  .amdhsa_float_denorm_mode_32 3
.end_amdhsa_kernel
```

```asm
; @launch grid=(256,1,1) block=(256,1,1) lds=149504
.amdgcn_target "amdgcn-amd-amdhsa--gfx950"
.text
.globl concat_heads__compressed_kv_cla__mha_block_cached__decode_kernel
.p2align 8
.type concat_heads__compressed_kv_cla__mha_block_cached__decode_kernel,@function
concat_heads__compressed_kv_cla__mha_block_cached__decode_kernel:
    s_load_dwordx16 s[36:51], s[0:1], 0
    s_load_dwordx8 s[52:59], s[0:1], 64
    s_load_dwordx4 s[60:63], s[0:1], 96
    s_cmp_ge_u32 s2, 256
    s_cbranch_scc1 L_end
    v_lshrrev_b32 v1, 6, v0
    v_and_b32 v0, 63, v0
    v_readfirstlane_b32 s3, v1
    v_lshlrev_b32 v2, 4, v0
    s_cmp_lt_u32 s2, 64
    s_cbranch_scc1 L_A
L_B:
    s_getpc_b64 s[20:21]
L_pc1:
    s_sub_u32 s20, s20, L_pc1-L_B
    s_subb_u32 s21, s21, 0
    s_mov_b32 s22, L_A-L_B
    s_mov_b32 s23, 0x20000
    v_lshl_add_u32 v3, v0, 2, s3
    v_lshlrev_b32 v3, 7, v3
    buffer_load_dword v17, v3, s[20:23], 0 offen
    s_sub_u32 s24, s2, 64
    s_and_b32 s25, s24, 7
    s_lshr_b32 s24, s24, 3
    s_mul_i32 s26, s24, 43
    s_lshr_b32 s26, s26, 8
    s_mul_i32 s27, s26, 6
    s_sub_u32 s27, s24, s27
    s_lshl_b32 s74, s24, 2
    s_add_u32 s74, s74, s3
    s_mov_b32 s70, 0x5040100
    s_mov_b32 s71, 0xd0c0908
    s_lshl_b32 s25, s25, 3
    s_lshr_b64 s[70:71], s[70:71], s25
    s_lshl_b32 s26, s26, 3
    s_lshr_b32 s26, 0x12100200, s26
    s_or_b32 s26, s26, s70
    s_and_b32 s26, s26, 31
    v_lshrrev_b32 v3, 4, v0
    v_lshlrev_b32 v4, 3, v3
    v_mov_b32 v6, 0x12100200
    v_lshrrev_b32 v4, v4, v6
    v_or_b32 v4, s70, v4
    v_and_b32 v4, 31, v4
    v_and_b32 v6, 0xf0, v2
    v_lshl_add_u32 v24, v4, 8, v6
    v_lshl_add_u32 v25, v4, 17, v6
    s_and_b32 s25, s2, 7
    s_lshl_b32 s25, s25, 10
    v_add_u32 v26, s25, v2
    s_cmp_ge_u32 s27, 3
    s_cselect_b32 s28, 1, 0
    s_mul_i32 s29, s28, 3
    s_sub_u32 s29, s27, s29
    s_lshr_b32 s72, s3, 1
    s_lshl_b32 s24, s28, 1
    s_add_u32 s72, s72, s24
    s_and_b32 s31, s3, 1
    s_lshl_b32 s24, s29, 1
    s_add_u32 s31, s31, s24
    s_lshl_b32 s30, s72, 5
    s_add_u32 s30, s30, s26
    s_lshl_b32 s30, s30, 20
    v_lshrrev_b32 v3, 4, v0
    v_and_b32 v4, 3, v0
    v_lshlrev_b32 v5, 6, v3
    v_lshl_add_u32 v5, v4, 4, v5
    v_bfe_u32 v1, v0, 2, 2
    v_lshl_add_u32 v1, v1, 8, v5
    s_mul_i32 s35, s31, 1024
    s_mov_b32 s32, s35
    s_mov_b32 s6, 0x100000
    s_mov_b32 s7, 0x20000
    s_waitcnt lgkmcnt(0)
    s_add_u32 s4, s50, s30
    s_addc_u32 s5, s51, 0
    s_mov_b32 s8, s54
    s_mov_b32 s9, s55
    s_mov_b32 s10, 0x400000
    s_mov_b32 s11, 0x20000
L_pfb:
    s_lshl_b32 s24, s74, 13
    s_waitcnt vmcnt(6)
    buffer_load_dwordx4 v[28:31], v24, s[8:11], s24 offen
    s_add_u32 s74, s74, 96
    s_cmp_lt_u32 s74, 512
    s_cbranch_scc1 L_pfb
L_pgb:
    s_sub_u32 s74, s74, 512
    s_mov_b32 s8, s40
    s_mov_b32 s9, s41
    s_mov_b32 s10, 0x400000
    s_mov_b32 s11, 0x20000
L_pfq:
    s_lshl_b32 s24, s74, 13
    s_waitcnt vmcnt(6)
    buffer_load_dwordx4 v[28:31], v24, s[8:11], s24 offen
    s_add_u32 s74, s74, 96
    s_cmp_lt_u32 s74, 512
    s_cbranch_scc1 L_pfq
L_pgq:
    s_sub_u32 s74, s74, 512
    s_mov_b32 s8, s42
    s_mov_b32 s9, s43
    s_mov_b32 s10, 0x400000
    s_mov_b32 s11, 0x20000
L_pfk:
    s_lshl_b32 s24, s74, 13
    s_waitcnt vmcnt(6)
    buffer_load_dwordx4 v[28:31], v24, s[8:11], s24 offen
    s_add_u32 s74, s74, 96
    s_cmp_lt_u32 s74, 512
    s_cbranch_scc1 L_pfk
L_pgk:
    s_sub_u32 s74, s74, 512
    s_mov_b32 s8, s56
    s_mov_b32 s9, s57
    s_mov_b32 s10, 0x400000
    s_mov_b32 s11, 0x20000
L_pfo:
    s_lshl_b32 s24, s74, 8
    s_waitcnt vmcnt(6)
    buffer_load_dwordx4 v[28:31], v25, s[8:11], s24 offen
    s_add_u32 s74, s74, 96
    s_cmp_lt_u32 s74, 512
    s_cbranch_scc1 L_pfo
L_pgo:
    s_sub_u32 s74, s74, 512
    s_mov_b32 s8, s44
    s_mov_b32 s9, s45
    s_mov_b32 s10, 0x400000
    s_mov_b32 s11, 0x20000
L_pfu:
    s_lshl_b32 s24, s74, 13
    s_waitcnt vmcnt(6)
    buffer_load_dwordx4 v[28:31], v24, s[8:11], s24 offen
    s_add_u32 s74, s74, 96
    s_cmp_lt_u32 s74, 512
    s_cbranch_scc1 L_pfu
L_pgu:
    s_sub_u32 s74, s74, 512
    s_mov_b32 s8, s46
    s_mov_b32 s9, s47
    s_mov_b32 s10, 0x400000
    s_mov_b32 s11, 0x20000
L_pfv:
    s_lshl_b32 s24, s74, 8
    s_waitcnt vmcnt(6)
    buffer_load_dwordx4 v[28:31], v25, s[8:11], s24 offen
    s_add_u32 s74, s74, 96
    s_cmp_lt_u32 s74, 512
    s_cbranch_scc1 L_pfv
L_pgv:
    s_sub_u32 s74, s74, 512
    s_mov_b32 s8, s38
    s_mov_b32 s9, s39
    s_mov_b32 s10, 0x1000000
    s_mov_b32 s11, 0x20000
L_pfc:
    s_lshl_b32 s24, s74, 13
    s_waitcnt vmcnt(6)
    buffer_load_dwordx4 v[28:31], v26, s[8:11], s24 offen
    s_add_u32 s74, s74, 96
    s_cmp_lt_u32 s74, 2048
    s_cbranch_scc1 L_pfc
L_pgc:
    s_sub_u32 s74, s74, 2048
    s_waitcnt vmcnt(15)
    buffer_load_dwordx4 a[0:3], v1, s[4:7], s32 offen offset:0 nt
    s_add_u32 s32, s32, 6144
    s_waitcnt vmcnt(15)
    buffer_load_dwordx4 a[4:7], v1, s[4:7], s32 offen offset:0 nt
    s_add_u32 s32, s32, 6144
    s_waitcnt vmcnt(15)
    buffer_load_dwordx4 a[8:11], v1, s[4:7], s32 offen offset:0 nt
    s_add_u32 s32, s32, 6144
    s_waitcnt vmcnt(15)
    buffer_load_dwordx4 a[12:15], v1, s[4:7], s32 offen offset:0 nt
    s_add_u32 s32, s32, 6144
    s_waitcnt vmcnt(15)
    buffer_load_dwordx4 a[16:19], v1, s[4:7], s32 offen offset:0 nt
    s_add_u32 s32, s32, 6144
    s_waitcnt vmcnt(15)
    buffer_load_dwordx4 a[20:23], v1, s[4:7], s32 offen offset:0 nt
    s_add_u32 s32, s32, 6144
    s_waitcnt vmcnt(15)
    buffer_load_dwordx4 a[24:27], v1, s[4:7], s32 offen offset:0 nt
    s_add_u32 s32, s32, 6144
    s_waitcnt vmcnt(15)
    buffer_load_dwordx4 a[28:31], v1, s[4:7], s32 offen offset:0 nt
    s_add_u32 s32, s32, 6144
    s_waitcnt vmcnt(15)
    buffer_load_dwordx4 a[32:35], v1, s[4:7], s32 offen offset:0 nt
    s_add_u32 s32, s32, 6144
    s_waitcnt vmcnt(15)
    buffer_load_dwordx4 a[36:39], v1, s[4:7], s32 offen offset:0 nt
    s_add_u32 s32, s32, 6144
    s_waitcnt vmcnt(15)
    buffer_load_dwordx4 a[40:43], v1, s[4:7], s32 offen offset:0 nt
    s_add_u32 s32, s32, 6144
    s_waitcnt vmcnt(15)
    buffer_load_dwordx4 a[44:47], v1, s[4:7], s32 offen offset:0 nt
    s_add_u32 s32, s32, 6144
    s_waitcnt vmcnt(15)
    buffer_load_dwordx4 a[48:51], v1, s[4:7], s32 offen offset:0 nt
    s_add_u32 s32, s32, 6144
    s_waitcnt vmcnt(15)
    buffer_load_dwordx4 a[52:55], v1, s[4:7], s32 offen offset:0 nt
    s_add_u32 s32, s32, 6144
    s_waitcnt vmcnt(15)
    buffer_load_dwordx4 a[56:59], v1, s[4:7], s32 offen offset:0 nt
    s_add_u32 s32, s32, 6144
    s_waitcnt vmcnt(15)
    buffer_load_dwordx4 a[60:63], v1, s[4:7], s32 offen offset:0 nt
    s_add_u32 s32, s32, 6144
    s_mov_b32 s12, s62
    s_mov_b32 s13, s63
    s_mov_b32 s14, 0x400000
    s_mov_b32 s15, 0x20000
    s_mov_b32 s16, s60
    s_mov_b32 s17, s61
    s_mov_b32 s18, 0x100
    s_mov_b32 s19, 0x20000
    v_and_b32 v3, 1, v0
    v_lshlrev_b32 v3, 4, v3
    v_mov_b32 v4, 0xffff
    v_lshlrev_b32 v4, v3, v4
    v_bfe_u32 v3, v0, 1, 2
    v_cmp_eq_u32 vcc, 0, v3
    s_nop 1
    v_cndmask_b32 v20, 0, v4, vcc
    v_cmp_eq_u32 vcc, 1, v3
    s_nop 1
    v_cndmask_b32 v21, 0, v4, vcc
    v_cmp_eq_u32 vcc, 2, v3
    s_nop 1
    v_cndmask_b32 v22, 0, v4, vcc
    v_cmp_eq_u32 vcc, 3, v3
    s_nop 1
    v_cndmask_b32 v23, 0, v4, vcc
    s_mov_b32 s64, 0x22222222
    s_mov_b32 s65, 0x22222222
    s_mov_b32 s66, 0x44444444
    s_mov_b32 s67, 0x44444444
    s_mov_b32 s68, 0x88888888
    s_mov_b32 s69, 0x88888888
    v_mov_b32 v32, 0
    v_mov_b32 v33, 0
    v_mov_b32 v34, 0
    v_mov_b32 v35, 0
    v_mov_b32 v36, 0
    v_mov_b32 v37, 0
    v_mov_b32 v38, 0
    v_mov_b32 v39, 0
    v_mov_b32 v40, 0
    v_mov_b32 v41, 0
    v_mov_b32 v42, 0
    v_mov_b32 v43, 0
    v_mov_b32 v44, 0
    v_mov_b32 v45, 0
    v_mov_b32 v46, 0
    v_mov_b32 v47, 0
    s_lshl_b32 s33, s26, 2
    s_add_u32 s33, s33, s72
    s_lshl_b32 s34, s33, 8
    s_add_u32 s34, s34, 0x164000
    s_mov_b64 exec, 1
    buffer_load_dword v61, off, s[16:19], 0 offset:128 sc1
    s_mov_b64 exec, -1
    s_waitcnt vmcnt(15)
    buffer_load_dwordx4 v[64:67], v1, s[4:7], s32 offen offset:0 nt
    s_add_u32 s32, s32, 6144
    s_waitcnt vmcnt(15)
    buffer_load_dwordx4 v[68:71], v1, s[4:7], s32 offen offset:0 nt
    s_add_u32 s32, s32, 6144
    s_waitcnt vmcnt(15)
    buffer_load_dwordx4 v[72:75], v1, s[4:7], s32 offen offset:0 nt
    s_add_u32 s32, s32, 6144
    s_waitcnt vmcnt(15)
    buffer_load_dwordx4 v[76:79], v1, s[4:7], s32 offen offset:0 nt
    s_add_u32 s32, s32, 6144
    s_waitcnt vmcnt(15)
    buffer_load_dwordx4 v[80:83], v1, s[4:7], s32 offen offset:0 nt
    s_add_u32 s32, s32, 6144
    s_waitcnt vmcnt(15)
    buffer_load_dwordx4 v[84:87], v1, s[4:7], s32 offen offset:0 nt
    s_add_u32 s32, s32, 6144
    s_waitcnt vmcnt(15)
    buffer_load_dwordx4 v[88:91], v1, s[4:7], s32 offen offset:0 nt
    s_add_u32 s32, s32, 6144
    s_waitcnt vmcnt(15)
    buffer_load_dwordx4 v[92:95], v1, s[4:7], s32 offen offset:0 nt
    s_add_u32 s32, s32, 6144
    s_waitcnt vmcnt(8)
    v_readfirstlane_b32 s25, v61
    s_nop 0
    s_cmp_ge_u32 s25, 32
    s_cbranch_scc1 L_B_q
    s_mov_b32 s24, 262144
    s_mov_b64 exec, 1
L_aw2:
    buffer_load_dword v61, off, s[16:19], 0 offset:128 sc1
    s_waitcnt vmcnt(0)
    v_readfirstlane_b32 s25, v61
    s_nop 0
    s_cmp_ge_u32 s25, 32
    s_cbranch_scc1 L_B_q
    s_sleep 16
    s_sub_u32 s24, s24, 1
    s_cmp_lg_u32 s24, 0
    s_cbranch_scc1 L_aw2
L_B_q:
    s_mov_b64 exec, -1
    buffer_load_dwordx4 v[8:11], v5, s[12:15], s34 offen sc1
    s_waitcnt vmcnt(15)
    buffer_load_dwordx4 v[96:99], v1, s[4:7], s32 offen offset:0 nt
    s_add_u32 s32, s32, 6144
    s_waitcnt vmcnt(15)
    buffer_load_dwordx4 v[100:103], v1, s[4:7], s32 offen offset:0 nt
    s_add_u32 s32, s32, 6144
    s_waitcnt vmcnt(15)
    buffer_load_dwordx4 v[104:107], v1, s[4:7], s32 offen offset:0 nt
    s_add_u32 s32, s32, 6144
    s_waitcnt vmcnt(15)
    buffer_load_dwordx4 v[108:111], v1, s[4:7], s32 offen offset:0 nt
    s_add_u32 s32, s32, 6144
    s_waitcnt vmcnt(15)
    buffer_load_dwordx4 v[112:115], v1, s[4:7], s32 offen offset:0 nt
    s_add_u32 s32, s32, 6144
    s_waitcnt vmcnt(15)
    buffer_load_dwordx4 v[116:119], v1, s[4:7], s32 offen offset:0 nt
    s_add_u32 s32, s32, 6144
    s_waitcnt vmcnt(15)
    buffer_load_dwordx4 v[120:123], v1, s[4:7], s32 offen offset:0 nt
    s_add_u32 s32, s32, 6144
    s_waitcnt vmcnt(15)
    buffer_load_dwordx4 v[124:127], v1, s[4:7], s32 offen offset:0 nt
    s_add_u32 s32, s32, 6144
    s_waitcnt vmcnt(8)
    v_mov_b32_dpp v32, v8 quad_perm:[0,1,2,3] row_mask:0xf bank_mask:0x1
    v_mov_b32_dpp v33, v9 quad_perm:[0,1,2,3] row_mask:0xf bank_mask:0x1
    v_mov_b32_dpp v34, v10 quad_perm:[0,1,2,3] row_mask:0xf bank_mask:0x1
    v_mov_b32_dpp v35, v11 quad_perm:[0,1,2,3] row_mask:0xf bank_mask:0x1
    v_mov_b32_dpp v36, v8 quad_perm:[0,1,2,3] row_mask:0xf bank_mask:0x2
    v_mov_b32_dpp v37, v9 quad_perm:[0,1,2,3] row_mask:0xf bank_mask:0x2
    v_mov_b32_dpp v38, v10 quad_perm:[0,1,2,3] row_mask:0xf bank_mask:0x2
    v_mov_b32_dpp v39, v11 quad_perm:[0,1,2,3] row_mask:0xf bank_mask:0x2
    v_mov_b32_dpp v40, v8 quad_perm:[0,1,2,3] row_mask:0xf bank_mask:0x4
    v_mov_b32_dpp v41, v9 quad_perm:[0,1,2,3] row_mask:0xf bank_mask:0x4
    v_mov_b32_dpp v42, v10 quad_perm:[0,1,2,3] row_mask:0xf bank_mask:0x4
    v_mov_b32_dpp v43, v11 quad_perm:[0,1,2,3] row_mask:0xf bank_mask:0x4
    v_mov_b32_dpp v44, v8 quad_perm:[0,1,2,3] row_mask:0xf bank_mask:0x8
    v_mov_b32_dpp v45, v9 quad_perm:[0,1,2,3] row_mask:0xf bank_mask:0x8
    v_mov_b32_dpp v46, v10 quad_perm:[0,1,2,3] row_mask:0xf bank_mask:0x8
    v_mov_b32_dpp v47, v11 quad_perm:[0,1,2,3] row_mask:0xf bank_mask:0x8
    s_mov_b32 s27, 1
L_BK:
    s_cmp_lg_u32 s27, 10
    s_cbranch_scc1 L_BK_a
    s_add_u32 s4, s52, s30
    s_addc_u32 s5, s53, 0
    s_mov_b32 s32, s35
    v_mov_b32 v1, v2
L_BK_a:
    s_barrier
    s_cmp_lg_u32 s27, 8
    s_cbranch_scc1 L_BV_x0
    s_lshl_b32 s24, s26, 7
    s_add_u32 s24, s24, 0x1b6000
    s_mov_b64 exec, 1
    buffer_load_dwordx2 v[62:63], off, s[12:15], s24 sc1
    s_mov_b64 exec, -1
L_BV_x0:
    s_cmp_lg_u32 s27, 9
    s_cbranch_scc1 L_BV_x1
    s_getreg_b32 s75, hwreg(HW_REG_XCC_ID, 0, 4)
    v_readfirstlane_b32 s24, v62
    v_readfirstlane_b32 s25, v63
    s_xor_b32 s24, s24, s75
    s_xor_b32 s25, s25, s75
    s_or_b32 s75, s24, s25
L_BV_x1:
    v_mov_b32 v49, v50
    v_mov_b32 v50, v51
    v_mov_b32 v51, v52
    v_mov_b32 v52, v53
    v_mov_b32 v53, v54
    v_mov_b32 v54, v55
    v_mov_b32 v55, v56
    v_mov_b32 v56, v57
    v_mov_b32 v57, v58
    s_waitcnt vmcnt(15)
    v_mfma_f32_16x16x32_bf16 v[12:15], v[64:67], v[32:35], 0
    buffer_load_dwordx4 v[64:67], v1, s[4:7], s32 offen offset:0 nt
    s_add_u32 s32, s32, 6144
    s_waitcnt vmcnt(15)
    v_mfma_f32_16x16x32_bf16 v[12:15], v[68:71], v[36:39], v[12:15]
    buffer_load_dwordx4 v[68:71], v1, s[4:7], s32 offen offset:0 nt
    s_add_u32 s32, s32, 6144
    s_waitcnt vmcnt(15)
    v_mfma_f32_16x16x32_bf16 v[12:15], v[72:75], v[40:43], v[12:15]
    buffer_load_dwordx4 v[72:75], v1, s[4:7], s32 offen offset:0 nt
    s_add_u32 s32, s32, 6144
    s_waitcnt vmcnt(15)
    v_mfma_f32_16x16x32_bf16 v[12:15], v[76:79], v[44:47], v[12:15]
    buffer_load_dwordx4 v[76:79], v1, s[4:7], s32 offen offset:0 nt
    s_add_u32 s32, s32, 6144
    s_nop 5
    v_add_f32_dpp v58, v13, v12 quad_perm:[1,1,1,1] row_mask:0xf bank_mask:0xf
    s_nop 1
    v_add_f32_dpp v58, v14, v58 quad_perm:[2,2,2,2] row_mask:0xf bank_mask:0xf
    s_nop 1
    v_add_f32_dpp v58, v15, v58 quad_perm:[3,3,3,3] row_mask:0xf bank_mask:0xf
    s_waitcnt vmcnt(15)
    v_mfma_f32_16x16x32_bf16 v[16:19], v[80:83], v[32:35], 0
    buffer_load_dwordx4 v[80:83], v1, s[4:7], s32 offen offset:0 nt
    s_add_u32 s32, s32, 6144
    s_waitcnt vmcnt(15)
    v_mfma_f32_16x16x32_bf16 v[16:19], v[84:87], v[36:39], v[16:19]
    buffer_load_dwordx4 v[84:87], v1, s[4:7], s32 offen offset:0 nt
    s_add_u32 s32, s32, 6144
    s_waitcnt vmcnt(15)
    v_mfma_f32_16x16x32_bf16 v[16:19], v[88:91], v[40:43], v[16:19]
    buffer_load_dwordx4 v[88:91], v1, s[4:7], s32 offen offset:0 nt
    s_add_u32 s32, s32, 6144
    s_waitcnt vmcnt(15)
    v_mfma_f32_16x16x32_bf16 v[16:19], v[92:95], v[44:47], v[16:19]
    buffer_load_dwordx4 v[92:95], v1, s[4:7], s32 offen offset:0 nt
    s_add_u32 s32, s32, 6144
    s_nop 5
    v_add_f32_dpp v3, v16, v17 quad_perm:[0,0,0,0] row_mask:0xf bank_mask:0xf
    s_nop 1
    v_add_f32_dpp v3, v18, v3 quad_perm:[2,2,2,2] row_mask:0xf bank_mask:0xf
    s_nop 1
    v_add_f32_dpp v3, v19, v3 quad_perm:[3,3,3,3] row_mask:0xf bank_mask:0xf
    v_cndmask_b32 v58, v58, v3, s[64:65]
    s_waitcnt vmcnt(15)
    v_mfma_f32_16x16x32_bf16 v[12:15], v[96:99], v[32:35], 0
    buffer_load_dwordx4 v[96:99], v1, s[4:7], s32 offen offset:0 nt
    s_add_u32 s32, s32, 6144
    s_waitcnt vmcnt(15)
    v_mfma_f32_16x16x32_bf16 v[12:15], v[100:103], v[36:39], v[12:15]
    buffer_load_dwordx4 v[100:103], v1, s[4:7], s32 offen offset:0 nt
    s_add_u32 s32, s32, 6144
    s_waitcnt vmcnt(15)
    v_mfma_f32_16x16x32_bf16 v[12:15], v[104:107], v[40:43], v[12:15]
    buffer_load_dwordx4 v[104:107], v1, s[4:7], s32 offen offset:0 nt
    s_add_u32 s32, s32, 6144
    s_waitcnt vmcnt(15)
    v_mfma_f32_16x16x32_bf16 v[12:15], v[108:111], v[44:47], v[12:15]
    buffer_load_dwordx4 v[108:111], v1, s[4:7], s32 offen offset:0 nt
    s_add_u32 s32, s32, 6144
    s_nop 5
    v_add_f32_dpp v3, v12, v14 quad_perm:[0,0,0,0] row_mask:0xf bank_mask:0xf
    s_nop 1
    v_add_f32_dpp v3, v13, v3 quad_perm:[1,1,1,1] row_mask:0xf bank_mask:0xf
    s_nop 1
    v_add_f32_dpp v3, v15, v3 quad_perm:[3,3,3,3] row_mask:0xf bank_mask:0xf
    v_cndmask_b32 v58, v58, v3, s[66:67]
    s_waitcnt vmcnt(15)
    v_mfma_f32_16x16x32_bf16 v[16:19], v[112:115], v[32:35], 0
    buffer_load_dwordx4 v[112:115], v1, s[4:7], s32 offen offset:0 nt
    s_add_u32 s32, s32, 6144
    s_waitcnt vmcnt(15)
    v_mfma_f32_16x16x32_bf16 v[16:19], v[116:119], v[36:39], v[16:19]
    buffer_load_dwordx4 v[116:119], v1, s[4:7], s32 offen offset:0 nt
    s_add_u32 s32, s32, 6144
    s_waitcnt vmcnt(15)
    v_mfma_f32_16x16x32_bf16 v[16:19], v[120:123], v[40:43], v[16:19]
    buffer_load_dwordx4 v[120:123], v1, s[4:7], s32 offen offset:0 nt
    s_add_u32 s32, s32, 6144
    s_waitcnt vmcnt(15)
    v_mfma_f32_16x16x32_bf16 v[16:19], v[124:127], v[44:47], v[16:19]
    buffer_load_dwordx4 v[124:127], v1, s[4:7], s32 offen offset:0 nt
    s_add_u32 s32, s32, 6144
    s_nop 5
    v_add_f32_dpp v3, v16, v19 quad_perm:[0,0,0,0] row_mask:0xf bank_mask:0xf
    s_nop 1
    v_add_f32_dpp v3, v17, v3 quad_perm:[1,1,1,1] row_mask:0xf bank_mask:0xf
    s_nop 1
    v_add_f32_dpp v3, v18, v3 quad_perm:[2,2,2,2] row_mask:0xf bank_mask:0xf
    v_cndmask_b32 v58, v58, v3, s[68:69]
    s_cmp_lg_u32 s27, 1
    s_cbranch_scc1 L_BK_b0
    v_mfma_f32_16x16x32_bf16 v[12:15], a[0:3], v[32:35], 0
    v_mfma_f32_16x16x32_bf16 v[12:15], a[4:7], v[36:39], v[12:15]
    v_mfma_f32_16x16x32_bf16 v[12:15], a[8:11], v[40:43], v[12:15]
    v_mfma_f32_16x16x32_bf16 v[12:15], a[12:15], v[44:47], v[12:15]
    s_nop 7
    v_add_f32_dpp v48, v13, v12 quad_perm:[1,1,1,1] row_mask:0xf bank_mask:0xf
    s_nop 1
    v_add_f32_dpp v48, v14, v48 quad_perm:[2,2,2,2] row_mask:0xf bank_mask:0xf
    s_nop 1
    v_add_f32_dpp v48, v15, v48 quad_perm:[3,3,3,3] row_mask:0xf bank_mask:0xf
    v_mfma_f32_16x16x32_bf16 v[16:19], a[16:19], v[32:35], 0
    v_mfma_f32_16x16x32_bf16 v[16:19], a[20:23], v[36:39], v[16:19]
    v_mfma_f32_16x16x32_bf16 v[16:19], a[24:27], v[40:43], v[16:19]
    v_mfma_f32_16x16x32_bf16 v[16:19], a[28:31], v[44:47], v[16:19]
    s_nop 7
    v_add_f32_dpp v3, v16, v17 quad_perm:[0,0,0,0] row_mask:0xf bank_mask:0xf
    s_nop 1
    v_add_f32_dpp v3, v18, v3 quad_perm:[2,2,2,2] row_mask:0xf bank_mask:0xf
    s_nop 1
    v_add_f32_dpp v3, v19, v3 quad_perm:[3,3,3,3] row_mask:0xf bank_mask:0xf
    v_cndmask_b32 v48, v48, v3, s[64:65]
    v_mfma_f32_16x16x32_bf16 v[12:15], a[32:35], v[32:35], 0
    v_mfma_f32_16x16x32_bf16 v[12:15], a[36:39], v[36:39], v[12:15]
    v_mfma_f32_16x16x32_bf16 v[12:15], a[40:43], v[40:43], v[12:15]
    v_mfma_f32_16x16x32_bf16 v[12:15], a[44:47], v[44:47], v[12:15]
    s_nop 7
    v_add_f32_dpp v3, v12, v14 quad_perm:[0,0,0,0] row_mask:0xf bank_mask:0xf
    s_nop 1
    v_add_f32_dpp v3, v13, v3 quad_perm:[1,1,1,1] row_mask:0xf bank_mask:0xf
    s_nop 1
    v_add_f32_dpp v3, v15, v3 quad_perm:[3,3,3,3] row_mask:0xf bank_mask:0xf
    v_cndmask_b32 v48, v48, v3, s[66:67]
    v_mfma_f32_16x16x32_bf16 v[16:19], a[48:51], v[32:35], 0
    v_mfma_f32_16x16x32_bf16 v[16:19], a[52:55], v[36:39], v[16:19]
    v_mfma_f32_16x16x32_bf16 v[16:19], a[56:59], v[40:43], v[16:19]
    v_mfma_f32_16x16x32_bf16 v[16:19], a[60:63], v[44:47], v[16:19]
    s_nop 7
    v_add_f32_dpp v3, v16, v19 quad_perm:[0,0,0,0] row_mask:0xf bank_mask:0xf
    s_nop 1
    v_add_f32_dpp v3, v17, v3 quad_perm:[1,1,1,1] row_mask:0xf bank_mask:0xf
    s_nop 1
    v_add_f32_dpp v3, v18, v3 quad_perm:[2,2,2,2] row_mask:0xf bank_mask:0xf
    v_cndmask_b32 v48, v48, v3, s[68:69]
L_BK_b0:
    s_add_u32 s27, s27, 1
    s_cmp_lt_u32 s27, 11
    s_cbranch_scc1 L_BK
    v_and_b32 v3, 3, v0
    v_bfe_u32 v4, v0, 2, 2
    v_lshl_add_u32 v3, v3, 2, v4
    v_add_u32 v3, 160, v3
    v_lshrrev_b32 v3, 0, v3
    v_mul_u32_u24 v3, 6, v3
    v_add_u32 v3, s31, v3
    v_mov_b32 v4, 0xff800000
    v_cmp_gt_u32 vcc, 1024, v3
    s_nop 1
    v_cndmask_b32 v58, v4, v58, vcc
    v_max3_f32 v3, v48, v49, v50
    v_max3_f32 v3, v3, v51, v52
    v_max3_f32 v3, v3, v53, v54
    v_max3_f32 v3, v3, v55, v56
    v_max3_f32 v3, v3, v57, v58
    s_nop 1
    v_max_f32_dpp v3, v3, v3 row_ror:8 row_mask:0xf bank_mask:0xf
    s_nop 1
    v_max_f32_dpp v3, v3, v3 row_ror:4 row_mask:0xf bank_mask:0xf
    s_nop 1
    v_max_f32_dpp v3, v3, v3 row_ror:2 row_mask:0xf bank_mask:0xf
    s_nop 1
    v_max_f32_dpp v3, v3, v3 row_ror:1 row_mask:0xf bank_mask:0xf
    s_nop 1
    v_max_f32_dpp v3, v3, v3 row_bcast:15 row_mask:0xa bank_mask:0xf
    s_nop 1
    v_max_f32_dpp v3, v3, v3 row_bcast:31 row_mask:0xc bank_mask:0xf
    s_nop 0
    v_readlane_b32 s24, v3, 63
    s_mov_b32 s71, 0x3e0293ee
    v_mov_b32 v6, s71
    v_mul_f32 v6, s24, v6
    v_fma_f32 v48, v48, s71, -v6
    v_fma_f32 v49, v49, s71, -v6
    v_fma_f32 v50, v50, s71, -v6
    v_fma_f32 v51, v51, s71, -v6
    v_fma_f32 v52, v52, s71, -v6
    v_fma_f32 v53, v53, s71, -v6
    v_fma_f32 v54, v54, s71, -v6
    v_fma_f32 v55, v55, s71, -v6
    v_fma_f32 v56, v56, s71, -v6
    v_fma_f32 v57, v57, s71, -v6
    v_fma_f32 v58, v58, s71, -v6
    v_exp_f32 v48, v48
    v_exp_f32 v49, v49
    v_exp_f32 v50, v50
    v_exp_f32 v51, v51
    v_exp_f32 v52, v52
    v_exp_f32 v53, v53
    v_exp_f32 v54, v54
    v_exp_f32 v55, v55
    v_exp_f32 v56, v56
    v_exp_f32 v57, v57
    v_exp_f32 v58, v58
    v_add_f32 v7, v48, v49
    v_add_f32 v7, v7, v50
    v_add_f32 v7, v7, v51
    v_add_f32 v7, v7, v52
    v_add_f32 v7, v7, v53
    v_add_f32 v7, v7, v54
    v_add_f32 v7, v7, v55
    v_add_f32 v7, v7, v56
    v_add_f32 v7, v7, v57
    v_add_f32 v7, v7, v58
    v_cvt_pk_bf16_f32 v48, v48, v48
    v_cvt_pk_bf16_f32 v49, v49, v49
    v_cvt_pk_bf16_f32 v50, v50, v50
    v_cvt_pk_bf16_f32 v51, v51, v51
    v_cvt_pk_bf16_f32 v52, v52, v52
    v_cvt_pk_bf16_f32 v53, v53, v53
    v_cvt_pk_bf16_f32 v54, v54, v54
    v_cvt_pk_bf16_f32 v55, v55, v55
    v_cvt_pk_bf16_f32 v56, v56, v56
    v_cvt_pk_bf16_f32 v57, v57, v57
    v_cvt_pk_bf16_f32 v58, v58, v58
    v_add_f32_dpp v7, v7, v7 row_ror:8 row_mask:0xf bank_mask:0xf
    s_nop 1
    v_add_f32_dpp v7, v7, v7 row_ror:4 row_mask:0xf bank_mask:0xf
    s_nop 1
    v_add_f32_dpp v7, v7, v7 row_ror:2 row_mask:0xf bank_mask:0xf
    s_nop 1
    v_add_f32_dpp v7, v7, v7 row_ror:1 row_mask:0xf bank_mask:0xf
    s_nop 1
    v_add_f32_dpp v7, v7, v7 row_bcast:15 row_mask:0xa bank_mask:0xf
    s_nop 1
    v_add_f32_dpp v7, v7, v7 row_bcast:31 row_mask:0xc bank_mask:0xf
    s_nop 0
    v_readlane_b32 s70, v7, 63
    s_lshl_b32 s34, s2, 7
    s_add_u32 s34, s34, 0x1ae000
    s_lshl_b32 s25, s3, 4
    s_add_u32 s25, s25, s34
    s_mov_b64 exec, 1
    v_mov_b32 v7, s70
    s_cmp_eq_u32 s75, 0
    s_cbranch_scc0 L_B_mlf
    buffer_store_dwordx2 v[6:7], off, s[12:15], s25
    s_branch L_B_mld
L_B_mlf:
    buffer_store_dwordx2 v[6:7], off, s[12:15], s25 sc1
L_B_mld:
    s_mov_b64 exec, -1
    s_mul_i32 s73, s33, 6
    s_add_u32 s73, s73, s31
    s_lshl_b32 s73, s73, 8
    s_add_u32 s73, s73, 0x180000
    v_lshrrev_b32 v3, 4, v0
    v_lshlrev_b32 v60, 6, v3
    v_and_b32 v4, 7, v0
    v_lshl_add_u32 v60, v4, 3, v60
    v_mov_b32 v12, 0
    v_mov_b32 v13, 0
    v_mov_b32 v14, 0
    v_mov_b32 v15, 0
    s_mov_b32 s27, 0
L_BV:
    s_barrier
    s_cmp_ge_u32 s27, 3
    s_cselect_b32 s71, s3, 4
    s_cmp_lg_u32 s71, 0
    s_cbranch_scc1 L_BV_p0
    s_lshl_b32 s24, s27, 2
    s_add_u32 s24, s24, 0
    s_mov_b64 exec, 1
    v_mov_b32 v63, s24
    s_cmp_eq_u32 s75, 0
    s_cbranch_scc0 L_BV_q0
    buffer_store_dword v63, off, s[12:15], s34 offset:64
    s_branch L_BV_r0
L_BV_q0:
    buffer_store_dword v63, off, s[12:15], s34 offset:64 sc1
L_BV_r0:
    s_mov_b64 exec, -1
L_BV_p0:
    v_and_b32_dpp v8, v48, v20 row_newbcast:0 row_mask:0xf bank_mask:0xf
    v_and_b32_dpp v9, v48, v21 row_newbcast:0 row_mask:0xf bank_mask:0xf
    v_and_b32_dpp v10, v48, v22 row_newbcast:0 row_mask:0xf bank_mask:0xf
    v_and_b32_dpp v11, v48, v23 row_newbcast:0 row_mask:0xf bank_mask:0xf
    s_waitcnt vmcnt(15)
    s_nop 0
    v_mfma_f32_16x16x32_bf16 v[12:15], v[64:67], v[8:11], v[12:15]
    buffer_load_dwordx4 v[64:67], v1, s[4:7], s32 offen offset:0 nt
    s_add_u32 s32, s32, 6144
    v_and_b32_dpp v8, v48, v20 row_newbcast:4 row_mask:0xf bank_mask:0xf
    v_and_b32_dpp v9, v48, v21 row_newbcast:4 row_mask:0xf bank_mask:0xf
    v_and_b32_dpp v10, v48, v22 row_newbcast:4 row_mask:0xf bank_mask:0xf
    v_and_b32_dpp v11, v48, v23 row_newbcast:4 row_mask:0xf bank_mask:0xf
    s_waitcnt vmcnt(15)
    s_nop 0
    v_mfma_f32_16x16x32_bf16 v[12:15], v[68:71], v[8:11], v[12:15]
    buffer_load_dwordx4 v[68:71], v1, s[4:7], s32 offen offset:0 nt
    s_add_u32 s32, s32, 6144
    v_and_b32_dpp v8, v48, v20 row_newbcast:8 row_mask:0xf bank_mask:0xf
    v_and_b32_dpp v9, v48, v21 row_newbcast:8 row_mask:0xf bank_mask:0xf
    v_and_b32_dpp v10, v48, v22 row_newbcast:8 row_mask:0xf bank_mask:0xf
    v_and_b32_dpp v11, v48, v23 row_newbcast:8 row_mask:0xf bank_mask:0xf
    s_waitcnt vmcnt(15)
    s_nop 0
    v_mfma_f32_16x16x32_bf16 v[12:15], v[72:75], v[8:11], v[12:15]
    buffer_load_dwordx4 v[72:75], v1, s[4:7], s32 offen offset:0 nt
    s_add_u32 s32, s32, 6144
    v_and_b32_dpp v8, v48, v20 row_newbcast:12 row_mask:0xf bank_mask:0xf
    v_and_b32_dpp v9, v48, v21 row_newbcast:12 row_mask:0xf bank_mask:0xf
    v_and_b32_dpp v10, v48, v22 row_newbcast:12 row_mask:0xf bank_mask:0xf
    v_and_b32_dpp v11, v48, v23 row_newbcast:12 row_mask:0xf bank_mask:0xf
    s_waitcnt vmcnt(15)
    s_nop 0
    v_mfma_f32_16x16x32_bf16 v[12:15], v[76:79], v[8:11], v[12:15]
    buffer_load_dwordx4 v[76:79], v1, s[4:7], s32 offen offset:0 nt
    s_add_u32 s32, s32, 6144
    s_cmp_lg_u32 s71, 1
    s_cbranch_scc1 L_BV_p1
    s_lshl_b32 s24, s27, 2
    s_add_u32 s24, s24, 1
    s_mov_b64 exec, 1
    v_mov_b32 v63, s24
    s_cmp_eq_u32 s75, 0
    s_cbranch_scc0 L_BV_q1
    buffer_store_dword v63, off, s[12:15], s34 offset:64
    s_branch L_BV_r1
L_BV_q1:
    buffer_store_dword v63, off, s[12:15], s34 offset:64 sc1
L_BV_r1:
    s_mov_b64 exec, -1
L_BV_p1:
    v_and_b32_dpp v8, v48, v20 row_newbcast:1 row_mask:0xf bank_mask:0xf
    v_and_b32_dpp v9, v48, v21 row_newbcast:1 row_mask:0xf bank_mask:0xf
    v_and_b32_dpp v10, v48, v22 row_newbcast:1 row_mask:0xf bank_mask:0xf
    v_and_b32_dpp v11, v48, v23 row_newbcast:1 row_mask:0xf bank_mask:0xf
    s_waitcnt vmcnt(15)
    s_nop 0
    v_mfma_f32_16x16x32_bf16 v[12:15], v[80:83], v[8:11], v[12:15]
    buffer_load_dwordx4 v[80:83], v1, s[4:7], s32 offen offset:0 nt
    s_add_u32 s32, s32, 6144
    v_and_b32_dpp v8, v48, v20 row_newbcast:5 row_mask:0xf bank_mask:0xf
    v_and_b32_dpp v9, v48, v21 row_newbcast:5 row_mask:0xf bank_mask:0xf
    v_and_b32_dpp v10, v48, v22 row_newbcast:5 row_mask:0xf bank_mask:0xf
    v_and_b32_dpp v11, v48, v23 row_newbcast:5 row_mask:0xf bank_mask:0xf
    s_waitcnt vmcnt(15)
    s_nop 0
    v_mfma_f32_16x16x32_bf16 v[12:15], v[84:87], v[8:11], v[12:15]
    buffer_load_dwordx4 v[84:87], v1, s[4:7], s32 offen offset:0 nt
    s_add_u32 s32, s32, 6144
    v_and_b32_dpp v8, v48, v20 row_newbcast:9 row_mask:0xf bank_mask:0xf
    v_and_b32_dpp v9, v48, v21 row_newbcast:9 row_mask:0xf bank_mask:0xf
    v_and_b32_dpp v10, v48, v22 row_newbcast:9 row_mask:0xf bank_mask:0xf
    v_and_b32_dpp v11, v48, v23 row_newbcast:9 row_mask:0xf bank_mask:0xf
    s_waitcnt vmcnt(15)
    s_nop 0
    v_mfma_f32_16x16x32_bf16 v[12:15], v[88:91], v[8:11], v[12:15]
    buffer_load_dwordx4 v[88:91], v1, s[4:7], s32 offen offset:0 nt
    s_add_u32 s32, s32, 6144
    v_and_b32_dpp v8, v48, v20 row_newbcast:13 row_mask:0xf bank_mask:0xf
    v_and_b32_dpp v9, v48, v21 row_newbcast:13 row_mask:0xf bank_mask:0xf
    v_and_b32_dpp v10, v48, v22 row_newbcast:13 row_mask:0xf bank_mask:0xf
    v_and_b32_dpp v11, v48, v23 row_newbcast:13 row_mask:0xf bank_mask:0xf
    s_waitcnt vmcnt(15)
    s_nop 0
    v_mfma_f32_16x16x32_bf16 v[12:15], v[92:95], v[8:11], v[12:15]
    buffer_load_dwordx4 v[92:95], v1, s[4:7], s32 offen offset:0 nt
    s_add_u32 s32, s32, 6144
    s_cmp_lg_u32 s71, 2
    s_cbranch_scc1 L_BV_p2
    s_lshl_b32 s24, s27, 2
    s_add_u32 s24, s24, 2
    s_mov_b64 exec, 1
    v_mov_b32 v63, s24
    s_cmp_eq_u32 s75, 0
    s_cbranch_scc0 L_BV_q2
    buffer_store_dword v63, off, s[12:15], s34 offset:64
    s_branch L_BV_r2
L_BV_q2:
    buffer_store_dword v63, off, s[12:15], s34 offset:64 sc1
L_BV_r2:
    s_mov_b64 exec, -1
L_BV_p2:
    v_and_b32_dpp v8, v48, v20 row_newbcast:2 row_mask:0xf bank_mask:0xf
    v_and_b32_dpp v9, v48, v21 row_newbcast:2 row_mask:0xf bank_mask:0xf
    v_and_b32_dpp v10, v48, v22 row_newbcast:2 row_mask:0xf bank_mask:0xf
    v_and_b32_dpp v11, v48, v23 row_newbcast:2 row_mask:0xf bank_mask:0xf
    s_waitcnt vmcnt(15)
    s_nop 0
    v_mfma_f32_16x16x32_bf16 v[12:15], v[96:99], v[8:11], v[12:15]
    buffer_load_dwordx4 v[96:99], v1, s[4:7], s32 offen offset:0 nt
    s_add_u32 s32, s32, 6144
    v_and_b32_dpp v8, v48, v20 row_newbcast:6 row_mask:0xf bank_mask:0xf
    v_and_b32_dpp v9, v48, v21 row_newbcast:6 row_mask:0xf bank_mask:0xf
    v_and_b32_dpp v10, v48, v22 row_newbcast:6 row_mask:0xf bank_mask:0xf
    v_and_b32_dpp v11, v48, v23 row_newbcast:6 row_mask:0xf bank_mask:0xf
    s_waitcnt vmcnt(15)
    s_nop 0
    v_mfma_f32_16x16x32_bf16 v[12:15], v[100:103], v[8:11], v[12:15]
    buffer_load_dwordx4 v[100:103], v1, s[4:7], s32 offen offset:0 nt
    s_add_u32 s32, s32, 6144
    v_and_b32_dpp v8, v48, v20 row_newbcast:10 row_mask:0xf bank_mask:0xf
    v_and_b32_dpp v9, v48, v21 row_newbcast:10 row_mask:0xf bank_mask:0xf
    v_and_b32_dpp v10, v48, v22 row_newbcast:10 row_mask:0xf bank_mask:0xf
    v_and_b32_dpp v11, v48, v23 row_newbcast:10 row_mask:0xf bank_mask:0xf
    s_waitcnt vmcnt(15)
    s_nop 0
    v_mfma_f32_16x16x32_bf16 v[12:15], v[104:107], v[8:11], v[12:15]
    buffer_load_dwordx4 v[104:107], v1, s[4:7], s32 offen offset:0 nt
    s_add_u32 s32, s32, 6144
    s_cmp_lg_u32 s27, 10
    s_cbranch_scc1 L_BV_a
    s_mov_b32 exec_lo, 0x00ff00ff
    s_mov_b32 exec_hi, 0x00ff00ff
    s_cmp_eq_u32 s75, 0
    s_nop 0
    v_cvt_pk_bf16_f32 v4, v12, v13
    v_cvt_pk_bf16_f32 v5, v14, v15
    s_cbranch_scc0 L_BV_far
    buffer_store_dwordx2 v[4:5], v60, s[12:15], s73 offen
    s_branch L_BV_done
L_BV_far:
    buffer_store_dwordx2 v[4:5], v60, s[12:15], s73 offen sc1
L_BV_done:
    s_endpgm
L_BV_a:
    v_and_b32_dpp v8, v48, v20 row_newbcast:14 row_mask:0xf bank_mask:0xf
    v_and_b32_dpp v9, v48, v21 row_newbcast:14 row_mask:0xf bank_mask:0xf
    v_and_b32_dpp v10, v48, v22 row_newbcast:14 row_mask:0xf bank_mask:0xf
    v_and_b32_dpp v11, v48, v23 row_newbcast:14 row_mask:0xf bank_mask:0xf
    s_waitcnt vmcnt(15)
    s_nop 0
    v_mfma_f32_16x16x32_bf16 v[12:15], v[108:111], v[8:11], v[12:15]
    buffer_load_dwordx4 v[108:111], v1, s[4:7], s32 offen offset:0 nt
    s_add_u32 s32, s32, 6144
    s_cmp_lg_u32 s71, 3
    s_cbranch_scc1 L_BV_p3
    s_lshl_b32 s24, s27, 2
    s_add_u32 s24, s24, 3
    s_mov_b64 exec, 1
    v_mov_b32 v63, s24
    s_cmp_eq_u32 s75, 0
    s_cbranch_scc0 L_BV_q3
    buffer_store_dword v63, off, s[12:15], s34 offset:64
    s_branch L_BV_r3
L_BV_q3:
    buffer_store_dword v63, off, s[12:15], s34 offset:64 sc1
L_BV_r3:
    s_mov_b64 exec, -1
L_BV_p3:
    v_and_b32_dpp v8, v48, v20 row_newbcast:3 row_mask:0xf bank_mask:0xf
    v_and_b32_dpp v9, v48, v21 row_newbcast:3 row_mask:0xf bank_mask:0xf
    v_and_b32_dpp v10, v48, v22 row_newbcast:3 row_mask:0xf bank_mask:0xf
    v_and_b32_dpp v11, v48, v23 row_newbcast:3 row_mask:0xf bank_mask:0xf
    s_waitcnt vmcnt(15)
    s_nop 0
    v_mfma_f32_16x16x32_bf16 v[12:15], v[112:115], v[8:11], v[12:15]
    buffer_load_dwordx4 v[112:115], v1, s[4:7], s32 offen offset:0 nt
    s_add_u32 s32, s32, 6144
    v_and_b32_dpp v8, v48, v20 row_newbcast:7 row_mask:0xf bank_mask:0xf
    v_and_b32_dpp v9, v48, v21 row_newbcast:7 row_mask:0xf bank_mask:0xf
    v_and_b32_dpp v10, v48, v22 row_newbcast:7 row_mask:0xf bank_mask:0xf
    v_and_b32_dpp v11, v48, v23 row_newbcast:7 row_mask:0xf bank_mask:0xf
    s_waitcnt vmcnt(15)
    s_nop 0
    v_mfma_f32_16x16x32_bf16 v[12:15], v[116:119], v[8:11], v[12:15]
    buffer_load_dwordx4 v[116:119], v1, s[4:7], s32 offen offset:0 nt
    s_add_u32 s32, s32, 6144
    v_and_b32_dpp v8, v48, v20 row_newbcast:11 row_mask:0xf bank_mask:0xf
    v_and_b32_dpp v9, v48, v21 row_newbcast:11 row_mask:0xf bank_mask:0xf
    v_and_b32_dpp v10, v48, v22 row_newbcast:11 row_mask:0xf bank_mask:0xf
    v_and_b32_dpp v11, v48, v23 row_newbcast:11 row_mask:0xf bank_mask:0xf
    s_waitcnt vmcnt(15)
    s_nop 0
    v_mfma_f32_16x16x32_bf16 v[12:15], v[120:123], v[8:11], v[12:15]
    buffer_load_dwordx4 v[120:123], v1, s[4:7], s32 offen offset:0 nt
    s_add_u32 s32, s32, 6144
    v_and_b32_dpp v8, v48, v20 row_newbcast:15 row_mask:0xf bank_mask:0xf
    v_and_b32_dpp v9, v48, v21 row_newbcast:15 row_mask:0xf bank_mask:0xf
    v_and_b32_dpp v10, v48, v22 row_newbcast:15 row_mask:0xf bank_mask:0xf
    v_and_b32_dpp v11, v48, v23 row_newbcast:15 row_mask:0xf bank_mask:0xf
    s_waitcnt vmcnt(15)
    s_nop 0
    v_mfma_f32_16x16x32_bf16 v[12:15], v[124:127], v[8:11], v[12:15]
    buffer_load_dwordx4 v[124:127], v1, s[4:7], s32 offen offset:0 nt
    s_add_u32 s32, s32, 6144
    v_mov_b32 v48, v49
    v_mov_b32 v49, v50
    v_mov_b32 v50, v51
    v_mov_b32 v51, v52
    v_mov_b32 v52, v53
    v_mov_b32 v53, v54
    v_mov_b32 v54, v55
    v_mov_b32 v55, v56
    v_mov_b32 v56, v57
    v_mov_b32 v57, v58
    s_add_u32 s27, s27, 1
    s_branch L_BV
L_A:
    s_getpc_b64 s[20:21]
L_pc3:
    s_sub_u32 s20, s20, L_pc3-L_A
    s_subb_u32 s21, s21, 0
    s_mov_b32 s22, L_A2-L_A
    s_mov_b32 s23, 0x20000
    v_lshl_add_u32 v3, v0, 2, s3
    v_lshlrev_b32 v3, 7, v3
    buffer_load_dword v17, v3, s[20:23], 0 offen
    s_mov_b32 s74, s2
    s_and_b32 s72, s2, 31
    s_and_b32 s25, s72, 7
    s_lshr_b32 s26, s72, 3
    s_mov_b32 s70, 0x5040100
    s_mov_b32 s71, 0xd0c0908
    s_lshl_b32 s25, s25, 3
    s_lshr_b64 s[70:71], s[70:71], s25
    s_lshl_b32 s26, s26, 3
    s_lshr_b32 s26, 0x12100200, s26
    s_or_b32 s26, s26, s70
    s_and_b32 s26, s26, 31
    v_lshrrev_b32 v3, 4, v0
    v_and_b32 v4, 15, v0
    v_lshlrev_b32 v18, 18, v3
    v_lshl_add_u32 v18, v4, 4, v18
    v_lshrrev_b32 v6, 3, v4
    v_lshlrev_b32 v6, 10, v6
    v_lshl_add_u32 v19, v3, 6, v6
    v_bfe_u32 v1, v0, 2, 2
    v_lshlrev_b32 v64, 18, v1
    v_lshl_add_u32 v64, v3, 6, v64
    v_and_b32 v4, 3, v0
    v_lshl_add_u32 v64, v4, 4, v64
    v_lshlrev_b32 v65, 9, v1
    v_lshl_add_u32 v65, v3, 7, v65
    v_lshl_add_u32 v65, v4, 5, v65
    v_add_u32 v65, 135168, v65
    v_lshlrev_b32 v66, 15, v1
    v_lshl_add_u32 v66, v3, 6, v66
    v_lshl_add_u32 v66, v4, 4, v66
    v_and_b32 v4, 15, v0
    v_lshlrev_b32 v67, 10, v3
    v_lshl_add_u32 v67, v4, 4, v67
    s_lshl_b32 s35, s3, 20
    s_lshl_b32 s24, s26, 8
    s_add_u32 s35, s35, s24
    s_waitcnt lgkmcnt(0)
    s_cmp_lt_u32 s74, 32
    s_cselect_b64 s[4:5], s[40:41], s[54:55]
    s_mov_b32 s6, 0x400000
    s_mov_b32 s7, 0x20000
    s_cselect_b64 s[20:21], s[36:37], s[48:49]
    s_mov_b32 s22, 4096
    s_mov_b32 s23, 0x20000
    s_cselect_b32 s75, 0x400000, 0
    s_lshl_b32 s24, s3, 8
    s_mov_b32 s32, s35
    buffer_load_dwordx4 v[12:15], v67, s[20:23], s24 offen
    buffer_load_dwordx4 v[128:131], v18, s[4:7], s32 offen
    s_add_u32 s32, s32, 8192
    buffer_load_dwordx4 v[132:135], v18, s[4:7], s32 offen
    s_add_u32 s32, s32, 8192
    buffer_load_dwordx4 v[136:139], v18, s[4:7], s32 offen
    s_add_u32 s32, s32, 8192
    buffer_load_dwordx4 v[140:143], v18, s[4:7], s32 offen
    s_add_u32 s32, s32, 8192
    buffer_load_dwordx4 v[144:147], v18, s[4:7], s32 offen
    s_add_u32 s32, s32, 8192
    buffer_load_dwordx4 v[148:151], v18, s[4:7], s32 offen
    s_add_u32 s32, s32, 8192
    buffer_load_dwordx4 v[152:155], v18, s[4:7], s32 offen
    s_add_u32 s32, s32, 8192
    buffer_load_dwordx4 v[156:159], v18, s[4:7], s32 offen
    s_add_u32 s32, s32, 8192
    buffer_load_dwordx4 v[160:163], v18, s[4:7], s32 offen
    s_add_u32 s32, s32, 8192
    buffer_load_dwordx4 v[164:167], v18, s[4:7], s32 offen
    s_add_u32 s32, s32, 8192
    buffer_load_dwordx4 v[168:171], v18, s[4:7], s32 offen
    s_add_u32 s32, s32, 8192
    buffer_load_dwordx4 v[172:175], v18, s[4:7], s32 offen
    s_add_u32 s32, s32, 8192
    buffer_load_dwordx4 v[176:179], v18, s[4:7], s32 offen
    s_add_u32 s32, s32, 8192
    buffer_load_dwordx4 v[180:183], v18, s[4:7], s32 offen
    s_add_u32 s32, s32, 8192
    buffer_load_dwordx4 v[184:187], v18, s[4:7], s32 offen
    s_add_u32 s32, s32, 8192
    buffer_load_dwordx4 v[188:191], v18, s[4:7], s32 offen
    s_add_u32 s32, s32, 8192
    s_mov_b32 s12, s62
    s_mov_b32 s13, s63
    s_mov_b32 s14, 0x400000
    s_mov_b32 s15, 0x20000
    s_mov_b32 s16, s60
    s_mov_b32 s17, s61
    s_mov_b32 s18, 0x100
    s_mov_b32 s19, 0x20000
    v_and_b32 v3, 1, v0
    v_lshlrev_b32 v3, 4, v3
    v_mov_b32 v4, 0xffff
    v_lshlrev_b32 v4, v3, v4
    v_bfe_u32 v3, v0, 1, 2
    v_cmp_eq_u32 vcc, 0, v3
    s_nop 1
    v_cndmask_b32 v20, 0, v4, vcc
    v_cmp_eq_u32 vcc, 1, v3
    s_nop 1
    v_cndmask_b32 v21, 0, v4, vcc
    v_cmp_eq_u32 vcc, 2, v3
    s_nop 1
    v_cndmask_b32 v22, 0, v4, vcc
    v_cmp_eq_u32 vcc, 3, v3
    s_nop 1
    v_cndmask_b32 v23, 0, v4, vcc
    v_mov_b32 v3, 0x0c0c0c0c
    s_mov_b32 s24, 0x01000100
    s_mov_b32 s25, 0x03020302
    v_bfi_b32 v24, v20, s24, v3
    v_bfi_b32 v28, v20, s25, v3
    v_bfi_b32 v25, v21, s24, v3
    v_bfi_b32 v29, v21, s25, v3
    v_bfi_b32 v26, v22, s24, v3
    v_bfi_b32 v30, v22, s25, v3
    v_bfi_b32 v27, v23, s24, v3
    v_bfi_b32 v31, v23, s25, v3
    s_mov_b32 s64, 0x22222222
    s_mov_b32 s65, 0x22222222
    s_mov_b32 s66, 0x44444444
    s_mov_b32 s67, 0x44444444
    s_mov_b32 s68, 0x88888888
    s_mov_b32 s69, 0x88888888
    s_lshl_b32 s24, s3, 8
    s_add_u32 s24, s24, 145408
    v_add_u32 v3, s24, v67
    v_add_u32 v4, s24, v19
    s_waitcnt vmcnt(16)
    ds_write_b128 v3, v[12:15]
    s_waitcnt lgkmcnt(0)
    ds_read_b128 v[32:35], v4 offset:0
    ds_read_b128 v[36:39], v4 offset:16
    ds_read_b128 v[40:43], v4 offset:32
    ds_read_b128 v[44:47], v4 offset:48
    ds_read_b128 v[48:51], v4 offset:2048
    ds_read_b128 v[52:55], v4 offset:2064
    ds_read_b128 v[56:59], v4 offset:2080
    ds_read_b128 v[60:63], v4 offset:2096
    s_waitcnt lgkmcnt(0)
    v_mov_b32 v76, -1
    v_mov_b32 v77, -1
    v_mov_b32 v78, -1
    v_mov_b32 v79, -1
    s_lshl_b32 s71, s72, 2
    s_add_u32 s71, s71, s3
    s_lshl_b32 s71, s71, 12
    s_add_u32 s71, s71, 0x180000
    s_cmp_ge_u32 s71, 0x1f7000
    s_cselect_b32 s71, 0x400000, s71
    s_cmp_lt_u32 s74, 32
    s_cselect_b32 s71, 0x400000, s71
    v_perm_b32 v8, v32, v32, v24
    v_perm_b32 v9, v32, v32, v25
    v_perm_b32 v10, v32, v32, v26
    v_perm_b32 v11, v32, v32, v27
    v_perm_b32 v4, v48, v48, v24
    v_perm_b32 v5, v48, v48, v25
    v_perm_b32 v6, v48, v48, v26
    v_perm_b32 v7, v48, v48, v27
    s_waitcnt vmcnt(15)
    v_mfma_f32_16x16x32_bf16 v[12:15], v[128:131], v[8:11], 0
    v_mfma_f32_16x16x32_bf16 v[68:71], v[128:131], v[4:7], 0
    buffer_load_dwordx4 v[192:195], v18, s[4:7], s32 offen nt
    s_add_u32 s32, s32, 8192
    v_perm_b32 v8, v32, v32, v28
    v_perm_b32 v9, v32, v32, v29
    v_perm_b32 v10, v32, v32, v30
    v_perm_b32 v11, v32, v32, v31
    v_perm_b32 v4, v48, v48, v28
    v_perm_b32 v5, v48, v48, v29
    v_perm_b32 v6, v48, v48, v30
    v_perm_b32 v7, v48, v48, v31
    s_waitcnt vmcnt(15)
    v_mfma_f32_16x16x32_bf16 v[12:15], v[132:135], v[8:11], v[12:15]
    v_mfma_f32_16x16x32_bf16 v[68:71], v[132:135], v[4:7], v[68:71]
    buffer_load_dwordx4 v[196:199], v18, s[4:7], s32 offen nt
    s_add_u32 s32, s32, 8192
    v_perm_b32 v8, v33, v33, v24
    v_perm_b32 v9, v33, v33, v25
    v_perm_b32 v10, v33, v33, v26
    v_perm_b32 v11, v33, v33, v27
    v_perm_b32 v4, v49, v49, v24
    v_perm_b32 v5, v49, v49, v25
    v_perm_b32 v6, v49, v49, v26
    v_perm_b32 v7, v49, v49, v27
    s_waitcnt vmcnt(15)
    v_mfma_f32_16x16x32_bf16 v[12:15], v[136:139], v[8:11], v[12:15]
    v_mfma_f32_16x16x32_bf16 v[68:71], v[136:139], v[4:7], v[68:71]
    buffer_load_dwordx4 v[200:203], v18, s[4:7], s32 offen nt
    s_add_u32 s32, s32, 8192
    v_perm_b32 v8, v33, v33, v28
    v_perm_b32 v9, v33, v33, v29
    v_perm_b32 v10, v33, v33, v30
    v_perm_b32 v11, v33, v33, v31
    v_perm_b32 v4, v49, v49, v28
    v_perm_b32 v5, v49, v49, v29
    v_perm_b32 v6, v49, v49, v30
    v_perm_b32 v7, v49, v49, v31
    s_waitcnt vmcnt(15)
    v_mfma_f32_16x16x32_bf16 v[12:15], v[140:143], v[8:11], v[12:15]
    v_mfma_f32_16x16x32_bf16 v[68:71], v[140:143], v[4:7], v[68:71]
    buffer_load_dwordx4 v[204:207], v18, s[4:7], s32 offen nt
    s_add_u32 s32, s32, 8192
    v_perm_b32 v8, v34, v34, v24
    v_perm_b32 v9, v34, v34, v25
    v_perm_b32 v10, v34, v34, v26
    v_perm_b32 v11, v34, v34, v27
    v_perm_b32 v4, v50, v50, v24
    v_perm_b32 v5, v50, v50, v25
    v_perm_b32 v6, v50, v50, v26
    v_perm_b32 v7, v50, v50, v27
    s_waitcnt vmcnt(15)
    v_mfma_f32_16x16x32_bf16 v[12:15], v[144:147], v[8:11], v[12:15]
    v_mfma_f32_16x16x32_bf16 v[68:71], v[144:147], v[4:7], v[68:71]
    buffer_load_dwordx4 v[208:211], v18, s[4:7], s32 offen nt
    s_add_u32 s32, s32, 8192
    v_perm_b32 v8, v34, v34, v28
    v_perm_b32 v9, v34, v34, v29
    v_perm_b32 v10, v34, v34, v30
    v_perm_b32 v11, v34, v34, v31
    v_perm_b32 v4, v50, v50, v28
    v_perm_b32 v5, v50, v50, v29
    v_perm_b32 v6, v50, v50, v30
    v_perm_b32 v7, v50, v50, v31
    s_waitcnt vmcnt(15)
    v_mfma_f32_16x16x32_bf16 v[12:15], v[148:151], v[8:11], v[12:15]
    v_mfma_f32_16x16x32_bf16 v[68:71], v[148:151], v[4:7], v[68:71]
    buffer_load_dwordx4 v[212:215], v18, s[4:7], s32 offen nt
    s_add_u32 s32, s32, 8192
    v_perm_b32 v8, v35, v35, v24
    v_perm_b32 v9, v35, v35, v25
    v_perm_b32 v10, v35, v35, v26
    v_perm_b32 v11, v35, v35, v27
    v_perm_b32 v4, v51, v51, v24
    v_perm_b32 v5, v51, v51, v25
    v_perm_b32 v6, v51, v51, v26
    v_perm_b32 v7, v51, v51, v27
    s_waitcnt vmcnt(15)
    v_mfma_f32_16x16x32_bf16 v[12:15], v[152:155], v[8:11], v[12:15]
    v_mfma_f32_16x16x32_bf16 v[68:71], v[152:155], v[4:7], v[68:71]
    buffer_load_dwordx4 v[216:219], v18, s[4:7], s32 offen nt
    s_add_u32 s32, s32, 8192
    v_perm_b32 v8, v35, v35, v28
    v_perm_b32 v9, v35, v35, v29
    v_perm_b32 v10, v35, v35, v30
    v_perm_b32 v11, v35, v35, v31
    v_perm_b32 v4, v51, v51, v28
    v_perm_b32 v5, v51, v51, v29
    v_perm_b32 v6, v51, v51, v30
    v_perm_b32 v7, v51, v51, v31
    s_waitcnt vmcnt(15)
    v_mfma_f32_16x16x32_bf16 v[12:15], v[156:159], v[8:11], v[12:15]
    v_mfma_f32_16x16x32_bf16 v[68:71], v[156:159], v[4:7], v[68:71]
    buffer_load_dwordx4 v[220:223], v18, s[4:7], s32 offen nt
    s_add_u32 s32, s32, 8192
    v_perm_b32 v8, v36, v36, v24
    v_perm_b32 v9, v36, v36, v25
    v_perm_b32 v10, v36, v36, v26
    v_perm_b32 v11, v36, v36, v27
    v_perm_b32 v4, v52, v52, v24
    v_perm_b32 v5, v52, v52, v25
    v_perm_b32 v6, v52, v52, v26
    v_perm_b32 v7, v52, v52, v27
    s_waitcnt vmcnt(15)
    v_mfma_f32_16x16x32_bf16 v[12:15], v[160:163], v[8:11], v[12:15]
    v_mfma_f32_16x16x32_bf16 v[68:71], v[160:163], v[4:7], v[68:71]
    buffer_load_dwordx4 v[224:227], v18, s[4:7], s32 offen nt
    s_add_u32 s32, s32, 8192
    v_perm_b32 v8, v36, v36, v28
    v_perm_b32 v9, v36, v36, v29
    v_perm_b32 v10, v36, v36, v30
    v_perm_b32 v11, v36, v36, v31
    v_perm_b32 v4, v52, v52, v28
    v_perm_b32 v5, v52, v52, v29
    v_perm_b32 v6, v52, v52, v30
    v_perm_b32 v7, v52, v52, v31
    s_waitcnt vmcnt(15)
    v_mfma_f32_16x16x32_bf16 v[12:15], v[164:167], v[8:11], v[12:15]
    v_mfma_f32_16x16x32_bf16 v[68:71], v[164:167], v[4:7], v[68:71]
    buffer_load_dwordx4 v[228:231], v18, s[4:7], s32 offen nt
    s_add_u32 s32, s32, 8192
    v_perm_b32 v8, v37, v37, v24
    v_perm_b32 v9, v37, v37, v25
    v_perm_b32 v10, v37, v37, v26
    v_perm_b32 v11, v37, v37, v27
    v_perm_b32 v4, v53, v53, v24
    v_perm_b32 v5, v53, v53, v25
    v_perm_b32 v6, v53, v53, v26
    v_perm_b32 v7, v53, v53, v27
    s_waitcnt vmcnt(15)
    v_mfma_f32_16x16x32_bf16 v[12:15], v[168:171], v[8:11], v[12:15]
    v_mfma_f32_16x16x32_bf16 v[68:71], v[168:171], v[4:7], v[68:71]
    buffer_load_dwordx4 v[232:235], v18, s[4:7], s32 offen nt
    s_add_u32 s32, s32, 8192
    v_perm_b32 v8, v37, v37, v28
    v_perm_b32 v9, v37, v37, v29
    v_perm_b32 v10, v37, v37, v30
    v_perm_b32 v11, v37, v37, v31
    v_perm_b32 v4, v53, v53, v28
    v_perm_b32 v5, v53, v53, v29
    v_perm_b32 v6, v53, v53, v30
    v_perm_b32 v7, v53, v53, v31
    s_waitcnt vmcnt(15)
    v_mfma_f32_16x16x32_bf16 v[12:15], v[172:175], v[8:11], v[12:15]
    v_mfma_f32_16x16x32_bf16 v[68:71], v[172:175], v[4:7], v[68:71]
    buffer_load_dwordx4 v[236:239], v18, s[4:7], s32 offen nt
    s_add_u32 s32, s32, 8192
    v_perm_b32 v8, v38, v38, v24
    v_perm_b32 v9, v38, v38, v25
    v_perm_b32 v10, v38, v38, v26
    v_perm_b32 v11, v38, v38, v27
    v_perm_b32 v4, v54, v54, v24
    v_perm_b32 v5, v54, v54, v25
    v_perm_b32 v6, v54, v54, v26
    v_perm_b32 v7, v54, v54, v27
    s_waitcnt vmcnt(15)
    v_mfma_f32_16x16x32_bf16 v[12:15], v[176:179], v[8:11], v[12:15]
    v_mfma_f32_16x16x32_bf16 v[68:71], v[176:179], v[4:7], v[68:71]
    buffer_load_dwordx4 v[240:243], v18, s[4:7], s32 offen nt
    s_add_u32 s32, s32, 8192
    v_perm_b32 v8, v38, v38, v28
    v_perm_b32 v9, v38, v38, v29
    v_perm_b32 v10, v38, v38, v30
    v_perm_b32 v11, v38, v38, v31
    v_perm_b32 v4, v54, v54, v28
    v_perm_b32 v5, v54, v54, v29
    v_perm_b32 v6, v54, v54, v30
    v_perm_b32 v7, v54, v54, v31
    s_waitcnt vmcnt(15)
    v_mfma_f32_16x16x32_bf16 v[12:15], v[180:183], v[8:11], v[12:15]
    v_mfma_f32_16x16x32_bf16 v[68:71], v[180:183], v[4:7], v[68:71]
    buffer_load_dwordx4 v[244:247], v18, s[4:7], s32 offen nt
    s_add_u32 s32, s32, 8192
    v_perm_b32 v8, v39, v39, v24
    v_perm_b32 v9, v39, v39, v25
    v_perm_b32 v10, v39, v39, v26
    v_perm_b32 v11, v39, v39, v27
    v_perm_b32 v4, v55, v55, v24
    v_perm_b32 v5, v55, v55, v25
    v_perm_b32 v6, v55, v55, v26
    v_perm_b32 v7, v55, v55, v27
    s_waitcnt vmcnt(15)
    v_mfma_f32_16x16x32_bf16 v[12:15], v[184:187], v[8:11], v[12:15]
    v_mfma_f32_16x16x32_bf16 v[68:71], v[184:187], v[4:7], v[68:71]
    buffer_load_dwordx4 v[248:251], v18, s[4:7], s32 offen nt
    s_add_u32 s32, s32, 8192
    v_perm_b32 v8, v39, v39, v28
    v_perm_b32 v9, v39, v39, v29
    v_perm_b32 v10, v39, v39, v30
    v_perm_b32 v11, v39, v39, v31
    v_perm_b32 v4, v55, v55, v28
    v_perm_b32 v5, v55, v55, v29
    v_perm_b32 v6, v55, v55, v30
    v_perm_b32 v7, v55, v55, v31
    s_waitcnt vmcnt(15)
    v_mfma_f32_16x16x32_bf16 v[12:15], v[188:191], v[8:11], v[12:15]
    v_mfma_f32_16x16x32_bf16 v[68:71], v[188:191], v[4:7], v[68:71]
    buffer_load_dwordx4 v[252:255], v18, s[4:7], s32 offen nt
    s_add_u32 s32, s32, 8192
    v_perm_b32 v8, v40, v40, v24
    v_perm_b32 v9, v40, v40, v25
    v_perm_b32 v10, v40, v40, v26
    v_perm_b32 v11, v40, v40, v27
    v_perm_b32 v4, v56, v56, v24
    v_perm_b32 v5, v56, v56, v25
    v_perm_b32 v6, v56, v56, v26
    v_perm_b32 v7, v56, v56, v27
    s_waitcnt vmcnt(15)
    v_mfma_f32_16x16x32_bf16 v[12:15], v[192:195], v[8:11], v[12:15]
    v_mfma_f32_16x16x32_bf16 v[68:71], v[192:195], v[4:7], v[68:71]
    s_lshl_b32 s73, s74, 7
    s_add_u32 s73, s73, 0x170000
    s_cmp_lg_u32 s3, 0
    s_cbranch_scc1 L_A_nofl
    s_mov_b64 exec, 1
    buffer_store_dwordx4 v[76:79], off, s[12:15], s73 sc1
    s_mov_b64 exec, -1
L_A_nofl:
    buffer_store_dwordx4 v[76:79], v2, s[12:15], s71 offen offset:0 sc1
    buffer_store_dwordx4 v[76:79], v2, s[12:15], s71 offen offset:1024 sc1
    buffer_store_dwordx4 v[76:79], v2, s[12:15], s71 offen offset:2048 sc1
    buffer_store_dwordx4 v[76:79], v2, s[12:15], s71 offen offset:3072 sc1
    s_getpc_b64 s[20:21]
L_pc4:
    s_add_u32 s20, s20, L_A2-L_pc4
    s_addc_u32 s21, s21, 0
    s_mov_b32 s22, L_last-L_A2
    s_mov_b32 s23, 0x20000
    v_lshl_add_u32 v3, v0, 2, s3
    v_lshlrev_b32 v3, 7, v3
    buffer_load_dword v17, v3, s[20:23], 0 offen
    s_mov_b32 s4, s42
    s_mov_b32 s5, s43
    s_mov_b32 s6, s75
    s_mov_b32 s32, s35
    buffer_load_dwordx4 v[128:131], v64, s[4:7], s32 offen nt
    s_add_u32 s32, s32, 8192
    v_perm_b32 v8, v40, v40, v28
    v_perm_b32 v9, v40, v40, v29
    v_perm_b32 v10, v40, v40, v30
    v_perm_b32 v11, v40, v40, v31
    v_perm_b32 v4, v56, v56, v28
    v_perm_b32 v5, v56, v56, v29
    v_perm_b32 v6, v56, v56, v30
    v_perm_b32 v7, v56, v56, v31
    s_waitcnt vmcnt(15)
    v_mfma_f32_16x16x32_bf16 v[12:15], v[196:199], v[8:11], v[12:15]
    v_mfma_f32_16x16x32_bf16 v[68:71], v[196:199], v[4:7], v[68:71]
    buffer_load_dwordx4 v[132:135], v64, s[4:7], s32 offen nt
    s_add_u32 s32, s32, 8192
    v_perm_b32 v8, v41, v41, v24
    v_perm_b32 v9, v41, v41, v25
    v_perm_b32 v10, v41, v41, v26
    v_perm_b32 v11, v41, v41, v27
    v_perm_b32 v4, v57, v57, v24
    v_perm_b32 v5, v57, v57, v25
    v_perm_b32 v6, v57, v57, v26
    v_perm_b32 v7, v57, v57, v27
    s_waitcnt vmcnt(15)
    v_mfma_f32_16x16x32_bf16 v[12:15], v[200:203], v[8:11], v[12:15]
    v_mfma_f32_16x16x32_bf16 v[68:71], v[200:203], v[4:7], v[68:71]
    buffer_load_dwordx4 v[136:139], v64, s[4:7], s32 offen nt
    s_add_u32 s32, s32, 8192
    v_perm_b32 v8, v41, v41, v28
    v_perm_b32 v9, v41, v41, v29
    v_perm_b32 v10, v41, v41, v30
    v_perm_b32 v11, v41, v41, v31
    v_perm_b32 v4, v57, v57, v28
    v_perm_b32 v5, v57, v57, v29
    v_perm_b32 v6, v57, v57, v30
    v_perm_b32 v7, v57, v57, v31
    s_waitcnt vmcnt(15)
    v_mfma_f32_16x16x32_bf16 v[12:15], v[204:207], v[8:11], v[12:15]
    v_mfma_f32_16x16x32_bf16 v[68:71], v[204:207], v[4:7], v[68:71]
    buffer_load_dwordx4 v[140:143], v64, s[4:7], s32 offen nt
    s_add_u32 s32, s32, 8192
    v_perm_b32 v8, v42, v42, v24
    v_perm_b32 v9, v42, v42, v25
    v_perm_b32 v10, v42, v42, v26
    v_perm_b32 v11, v42, v42, v27
    v_perm_b32 v4, v58, v58, v24
    v_perm_b32 v5, v58, v58, v25
    v_perm_b32 v6, v58, v58, v26
    v_perm_b32 v7, v58, v58, v27
    s_waitcnt vmcnt(15)
    v_mfma_f32_16x16x32_bf16 v[12:15], v[208:211], v[8:11], v[12:15]
    v_mfma_f32_16x16x32_bf16 v[68:71], v[208:211], v[4:7], v[68:71]
    buffer_load_dwordx4 v[144:147], v64, s[4:7], s32 offen nt
    s_add_u32 s32, s32, 8192
    v_perm_b32 v8, v42, v42, v28
    v_perm_b32 v9, v42, v42, v29
    v_perm_b32 v10, v42, v42, v30
    v_perm_b32 v11, v42, v42, v31
    v_perm_b32 v4, v58, v58, v28
    v_perm_b32 v5, v58, v58, v29
    v_perm_b32 v6, v58, v58, v30
    v_perm_b32 v7, v58, v58, v31
    s_waitcnt vmcnt(15)
    v_mfma_f32_16x16x32_bf16 v[12:15], v[212:215], v[8:11], v[12:15]
    v_mfma_f32_16x16x32_bf16 v[68:71], v[212:215], v[4:7], v[68:71]
    buffer_load_dwordx4 v[148:151], v64, s[4:7], s32 offen nt
    s_add_u32 s32, s32, 8192
    v_perm_b32 v8, v43, v43, v24
    v_perm_b32 v9, v43, v43, v25
    v_perm_b32 v10, v43, v43, v26
    v_perm_b32 v11, v43, v43, v27
    v_perm_b32 v4, v59, v59, v24
    v_perm_b32 v5, v59, v59, v25
    v_perm_b32 v6, v59, v59, v26
    v_perm_b32 v7, v59, v59, v27
    s_waitcnt vmcnt(15)
    v_mfma_f32_16x16x32_bf16 v[12:15], v[216:219], v[8:11], v[12:15]
    v_mfma_f32_16x16x32_bf16 v[68:71], v[216:219], v[4:7], v[68:71]
    buffer_load_dwordx4 v[152:155], v64, s[4:7], s32 offen nt
    s_add_u32 s32, s32, 8192
    v_perm_b32 v8, v43, v43, v28
    v_perm_b32 v9, v43, v43, v29
    v_perm_b32 v10, v43, v43, v30
    v_perm_b32 v11, v43, v43, v31
    v_perm_b32 v4, v59, v59, v28
    v_perm_b32 v5, v59, v59, v29
    v_perm_b32 v6, v59, v59, v30
    v_perm_b32 v7, v59, v59, v31
    s_waitcnt vmcnt(15)
    v_mfma_f32_16x16x32_bf16 v[12:15], v[220:223], v[8:11], v[12:15]
    v_mfma_f32_16x16x32_bf16 v[68:71], v[220:223], v[4:7], v[68:71]
    buffer_load_dwordx4 v[156:159], v64, s[4:7], s32 offen nt
    s_add_u32 s32, s32, 8192
    v_perm_b32 v8, v44, v44, v24
    v_perm_b32 v9, v44, v44, v25
    v_perm_b32 v10, v44, v44, v26
    v_perm_b32 v11, v44, v44, v27
    v_perm_b32 v4, v60, v60, v24
    v_perm_b32 v5, v60, v60, v25
    v_perm_b32 v6, v60, v60, v26
    v_perm_b32 v7, v60, v60, v27
    s_waitcnt vmcnt(15)
    v_mfma_f32_16x16x32_bf16 v[12:15], v[224:227], v[8:11], v[12:15]
    v_mfma_f32_16x16x32_bf16 v[68:71], v[224:227], v[4:7], v[68:71]
    buffer_load_dwordx4 v[160:163], v64, s[4:7], s32 offen nt
    s_add_u32 s32, s32, 8192
    v_perm_b32 v8, v44, v44, v28
    v_perm_b32 v9, v44, v44, v29
    v_perm_b32 v10, v44, v44, v30
    v_perm_b32 v11, v44, v44, v31
    v_perm_b32 v4, v60, v60, v28
    v_perm_b32 v5, v60, v60, v29
    v_perm_b32 v6, v60, v60, v30
    v_perm_b32 v7, v60, v60, v31
    s_waitcnt vmcnt(15)
    v_mfma_f32_16x16x32_bf16 v[12:15], v[228:231], v[8:11], v[12:15]
    v_mfma_f32_16x16x32_bf16 v[68:71], v[228:231], v[4:7], v[68:71]
    buffer_load_dwordx4 v[164:167], v64, s[4:7], s32 offen nt
    s_add_u32 s32, s32, 8192
    v_perm_b32 v8, v45, v45, v24
    v_perm_b32 v9, v45, v45, v25
    v_perm_b32 v10, v45, v45, v26
    v_perm_b32 v11, v45, v45, v27
    v_perm_b32 v4, v61, v61, v24
    v_perm_b32 v5, v61, v61, v25
    v_perm_b32 v6, v61, v61, v26
    v_perm_b32 v7, v61, v61, v27
    s_waitcnt vmcnt(15)
    v_mfma_f32_16x16x32_bf16 v[12:15], v[232:235], v[8:11], v[12:15]
    v_mfma_f32_16x16x32_bf16 v[68:71], v[232:235], v[4:7], v[68:71]
    buffer_load_dwordx4 v[168:171], v64, s[4:7], s32 offen nt
    s_add_u32 s32, s32, 8192
    v_perm_b32 v8, v45, v45, v28
    v_perm_b32 v9, v45, v45, v29
    v_perm_b32 v10, v45, v45, v30
    v_perm_b32 v11, v45, v45, v31
    v_perm_b32 v4, v61, v61, v28
    v_perm_b32 v5, v61, v61, v29
    v_perm_b32 v6, v61, v61, v30
    v_perm_b32 v7, v61, v61, v31
    s_waitcnt vmcnt(15)
    v_mfma_f32_16x16x32_bf16 v[12:15], v[236:239], v[8:11], v[12:15]
    v_mfma_f32_16x16x32_bf16 v[68:71], v[236:239], v[4:7], v[68:71]
    buffer_load_dwordx4 v[172:175], v64, s[4:7], s32 offen nt
    s_add_u32 s32, s32, 8192
    v_perm_b32 v8, v46, v46, v24
    v_perm_b32 v9, v46, v46, v25
    v_perm_b32 v10, v46, v46, v26
    v_perm_b32 v11, v46, v46, v27
    v_perm_b32 v4, v62, v62, v24
    v_perm_b32 v5, v62, v62, v25
    v_perm_b32 v6, v62, v62, v26
    v_perm_b32 v7, v62, v62, v27
    s_waitcnt vmcnt(15)
    v_mfma_f32_16x16x32_bf16 v[12:15], v[240:243], v[8:11], v[12:15]
    v_mfma_f32_16x16x32_bf16 v[68:71], v[240:243], v[4:7], v[68:71]
    buffer_load_dwordx4 v[176:179], v64, s[4:7], s32 offen nt
    s_add_u32 s32, s32, 8192
    v_perm_b32 v8, v46, v46, v28
    v_perm_b32 v9, v46, v46, v29
    v_perm_b32 v10, v46, v46, v30
    v_perm_b32 v11, v46, v46, v31
    v_perm_b32 v4, v62, v62, v28
    v_perm_b32 v5, v62, v62, v29
    v_perm_b32 v6, v62, v62, v30
    v_perm_b32 v7, v62, v62, v31
    s_waitcnt vmcnt(15)
    v_mfma_f32_16x16x32_bf16 v[12:15], v[244:247], v[8:11], v[12:15]
    v_mfma_f32_16x16x32_bf16 v[68:71], v[244:247], v[4:7], v[68:71]
    buffer_load_dwordx4 v[180:183], v64, s[4:7], s32 offen nt
    s_add_u32 s32, s32, 8192
    v_perm_b32 v8, v47, v47, v24
    v_perm_b32 v9, v47, v47, v25
    v_perm_b32 v10, v47, v47, v26
    v_perm_b32 v11, v47, v47, v27
    v_perm_b32 v4, v63, v63, v24
    v_perm_b32 v5, v63, v63, v25
    v_perm_b32 v6, v63, v63, v26
    v_perm_b32 v7, v63, v63, v27
    s_waitcnt vmcnt(15)
    v_mfma_f32_16x16x32_bf16 v[12:15], v[248:251], v[8:11], v[12:15]
    v_mfma_f32_16x16x32_bf16 v[68:71], v[248:251], v[4:7], v[68:71]
    buffer_load_dwordx4 v[184:187], v64, s[4:7], s32 offen nt
    s_add_u32 s32, s32, 8192
    v_perm_b32 v8, v47, v47, v28
    v_perm_b32 v9, v47, v47, v29
    v_perm_b32 v10, v47, v47, v30
    v_perm_b32 v11, v47, v47, v31
    v_perm_b32 v4, v63, v63, v28
    v_perm_b32 v5, v63, v63, v29
    v_perm_b32 v6, v63, v63, v30
    v_perm_b32 v7, v63, v63, v31
    s_waitcnt vmcnt(15)
    v_mfma_f32_16x16x32_bf16 v[12:15], v[252:255], v[8:11], v[12:15]
    v_mfma_f32_16x16x32_bf16 v[68:71], v[252:255], v[4:7], v[68:71]
    buffer_load_dwordx4 v[188:191], v64, s[4:7], s32 offen nt
    s_add_u32 s32, s32, 8192
    v_lshrrev_b32 v3, 4, v0
    v_lshlrev_b32 v3, 7, v3
    v_and_b32 v4, 7, v0
    v_lshl_add_u32 v3, v4, 2, v3
    v_bfe_u32 v4, v0, 3, 1
    v_lshl_add_u32 v3, v4, 9, v3
    s_lshl_b32 s24, s3, 11
    s_add_u32 s24, s24, 135168
    v_add_u32 v3, s24, v3
    ds_write_b32 v3, v12 offset:0
    ds_write_b32 v3, v13 offset:32
    ds_write_b32 v3, v14 offset:64
    ds_write_b32 v3, v15 offset:96
    ds_write_b32 v3, v68 offset:1024
    ds_write_b32 v3, v69 offset:1056
    ds_write_b32 v3, v70 offset:1088
    ds_write_b32 v3, v71 offset:1120
    s_waitcnt lgkmcnt(0)
    s_barrier
    ds_read_b128 v[72:75], v65 offset:0
    ds_read_b128 v[76:79], v65 offset:16
    ds_read_b128 v[80:83], v65 offset:2048
    ds_read_b128 v[84:87], v65 offset:2064
    ds_read_b128 v[88:91], v65 offset:4096
    ds_read_b128 v[92:95], v65 offset:4112
    ds_read_b128 v[96:99], v65 offset:6144
    ds_read_b128 v[100:103], v65 offset:6160
    s_waitcnt lgkmcnt(4)
    v_add_f32 v72, v72, v80
    v_add_f32 v73, v73, v81
    v_add_f32 v74, v74, v82
    v_add_f32 v75, v75, v83
    v_add_f32 v76, v76, v84
    v_add_f32 v77, v77, v85
    v_add_f32 v78, v78, v86
    v_add_f32 v79, v79, v87
    s_waitcnt lgkmcnt(2)
    v_add_f32 v72, v72, v88
    v_add_f32 v73, v73, v89
    v_add_f32 v74, v74, v90
    v_add_f32 v75, v75, v91
    v_add_f32 v76, v76, v92
    v_add_f32 v77, v77, v93
    v_add_f32 v78, v78, v94
    v_add_f32 v79, v79, v95
    s_waitcnt lgkmcnt(0)
    v_add_f32 v72, v72, v96
    v_add_f32 v73, v73, v97
    v_add_f32 v74, v74, v98
    v_add_f32 v75, v75, v99
    v_add_f32 v76, v76, v100
    v_add_f32 v77, v77, v101
    v_add_f32 v78, v78, v102
    v_add_f32 v79, v79, v103
    v_cvt_pk_bf16_f32 v8, v72, v73
    v_cvt_pk_bf16_f32 v9, v74, v75
    v_cvt_pk_bf16_f32 v10, v76, v77
    v_cvt_pk_bf16_f32 v11, v78, v79
    s_cmp_ge_u32 s74, 32
    s_cbranch_scc1 L_C
L_A2:
    buffer_load_dwordx4 v[192:195], v64, s[4:7], s32 offen nt
    s_add_u32 s32, s32, 8192
    buffer_load_dwordx4 v[196:199], v64, s[4:7], s32 offen nt
    s_add_u32 s32, s32, 8192
    buffer_load_dwordx4 v[200:203], v64, s[4:7], s32 offen nt
    s_add_u32 s32, s32, 8192
    buffer_load_dwordx4 v[204:207], v64, s[4:7], s32 offen nt
    s_add_u32 s32, s32, 8192
    buffer_load_dwordx4 v[208:211], v64, s[4:7], s32 offen nt
    s_add_u32 s32, s32, 8192
    buffer_load_dwordx4 v[212:215], v64, s[4:7], s32 offen nt
    s_add_u32 s32, s32, 8192
    buffer_load_dwordx4 v[216:219], v64, s[4:7], s32 offen nt
    s_add_u32 s32, s32, 8192
    buffer_load_dwordx4 v[220:223], v64, s[4:7], s32 offen nt
    s_add_u32 s32, s32, 8192
    buffer_load_dwordx4 v[224:227], v64, s[4:7], s32 offen nt
    s_add_u32 s32, s32, 8192
    buffer_load_dwordx4 v[228:231], v64, s[4:7], s32 offen nt
    s_add_u32 s32, s32, 8192
    buffer_load_dwordx4 v[232:235], v64, s[4:7], s32 offen nt
    s_add_u32 s32, s32, 8192
    buffer_load_dwordx4 v[236:239], v64, s[4:7], s32 offen nt
    s_add_u32 s32, s32, 8192
    buffer_load_dwordx4 v[240:243], v64, s[4:7], s32 offen nt
    s_add_u32 s32, s32, 8192
    buffer_load_dwordx4 v[244:247], v64, s[4:7], s32 offen nt
    s_add_u32 s32, s32, 8192
    buffer_load_dwordx4 v[248:251], v64, s[4:7], s32 offen nt
    s_add_u32 s32, s32, 8192
    buffer_load_dwordx4 v[252:255], v64, s[4:7], s32 offen nt
    s_add_u32 s32, s32, 8192
    s_waitcnt vmcnt(31)
    v_mfma_f32_16x16x32_bf16 v[80:83], v[128:131], v[8:11], 0
    s_waitcnt vmcnt(30)
    v_mfma_f32_16x16x32_bf16 v[84:87], v[132:135], v[8:11], 0
    s_waitcnt vmcnt(29)
    v_mfma_f32_16x16x32_bf16 v[88:91], v[136:139], v[8:11], 0
    s_waitcnt vmcnt(28)
    v_mfma_f32_16x16x32_bf16 v[92:95], v[140:143], v[8:11], 0
    s_waitcnt vmcnt(27)
    v_mfma_f32_16x16x32_bf16 v[96:99], v[144:147], v[8:11], 0
    s_waitcnt vmcnt(26)
    v_mfma_f32_16x16x32_bf16 v[100:103], v[148:151], v[8:11], 0
    s_waitcnt vmcnt(25)
    v_mfma_f32_16x16x32_bf16 v[104:107], v[152:155], v[8:11], 0
    s_waitcnt vmcnt(24)
    v_mfma_f32_16x16x32_bf16 v[108:111], v[156:159], v[8:11], 0
    v_add_f32_dpp v72, v81, v80 quad_perm:[1,1,1,1] row_mask:0xf bank_mask:0xf
    v_add_f32_dpp v73, v85, v84 quad_perm:[1,1,1,1] row_mask:0xf bank_mask:0xf
    v_add_f32_dpp v74, v89, v88 quad_perm:[1,1,1,1] row_mask:0xf bank_mask:0xf
    v_add_f32_dpp v75, v93, v92 quad_perm:[1,1,1,1] row_mask:0xf bank_mask:0xf
    v_add_f32_dpp v76, v97, v96 quad_perm:[1,1,1,1] row_mask:0xf bank_mask:0xf
    v_add_f32_dpp v77, v101, v100 quad_perm:[1,1,1,1] row_mask:0xf bank_mask:0xf
    v_add_f32_dpp v78, v105, v104 quad_perm:[1,1,1,1] row_mask:0xf bank_mask:0xf
    s_nop 0
    v_add_f32_dpp v79, v109, v108 quad_perm:[1,1,1,1] row_mask:0xf bank_mask:0xf
    v_add_f32_dpp v72, v82, v72 quad_perm:[2,2,2,2] row_mask:0xf bank_mask:0xf
    v_add_f32_dpp v73, v86, v73 quad_perm:[2,2,2,2] row_mask:0xf bank_mask:0xf
    v_add_f32_dpp v74, v90, v74 quad_perm:[2,2,2,2] row_mask:0xf bank_mask:0xf
    v_add_f32_dpp v75, v94, v75 quad_perm:[2,2,2,2] row_mask:0xf bank_mask:0xf
    v_add_f32_dpp v76, v98, v76 quad_perm:[2,2,2,2] row_mask:0xf bank_mask:0xf
    v_add_f32_dpp v77, v102, v77 quad_perm:[2,2,2,2] row_mask:0xf bank_mask:0xf
    v_add_f32_dpp v78, v106, v78 quad_perm:[2,2,2,2] row_mask:0xf bank_mask:0xf
    v_add_f32_dpp v79, v110, v79 quad_perm:[2,2,2,2] row_mask:0xf bank_mask:0xf
    v_add_f32_dpp v72, v83, v72 quad_perm:[3,3,3,3] row_mask:0xf bank_mask:0xf
    v_add_f32_dpp v73, v87, v73 quad_perm:[3,3,3,3] row_mask:0xf bank_mask:0xf
    v_add_f32_dpp v74, v91, v74 quad_perm:[3,3,3,3] row_mask:0xf bank_mask:0xf
    v_add_f32_dpp v75, v95, v75 quad_perm:[3,3,3,3] row_mask:0xf bank_mask:0xf
    v_add_f32_dpp v76, v99, v76 quad_perm:[3,3,3,3] row_mask:0xf bank_mask:0xf
    v_add_f32_dpp v77, v103, v77 quad_perm:[3,3,3,3] row_mask:0xf bank_mask:0xf
    v_add_f32_dpp v78, v107, v78 quad_perm:[3,3,3,3] row_mask:0xf bank_mask:0xf
    v_add_f32_dpp v79, v111, v79 quad_perm:[3,3,3,3] row_mask:0xf bank_mask:0xf
    s_waitcnt vmcnt(23)
    v_mfma_f32_16x16x32_bf16 v[80:83], v[160:163], v[8:11], 0
    s_waitcnt vmcnt(22)
    v_mfma_f32_16x16x32_bf16 v[84:87], v[164:167], v[8:11], 0
    s_waitcnt vmcnt(21)
    v_mfma_f32_16x16x32_bf16 v[88:91], v[168:171], v[8:11], 0
    s_waitcnt vmcnt(20)
    v_mfma_f32_16x16x32_bf16 v[92:95], v[172:175], v[8:11], 0
    s_waitcnt vmcnt(19)
    v_mfma_f32_16x16x32_bf16 v[96:99], v[176:179], v[8:11], 0
    s_waitcnt vmcnt(18)
    v_mfma_f32_16x16x32_bf16 v[100:103], v[180:183], v[8:11], 0
    s_waitcnt vmcnt(17)
    v_mfma_f32_16x16x32_bf16 v[104:107], v[184:187], v[8:11], 0
    s_waitcnt vmcnt(16)
    v_mfma_f32_16x16x32_bf16 v[108:111], v[188:191], v[8:11], 0
    v_add_f32_dpp v112, v80, v81 quad_perm:[0,0,0,0] row_mask:0xf bank_mask:0xf
    v_add_f32_dpp v113, v84, v85 quad_perm:[0,0,0,0] row_mask:0xf bank_mask:0xf
    v_add_f32_dpp v114, v88, v89 quad_perm:[0,0,0,0] row_mask:0xf bank_mask:0xf
    v_add_f32_dpp v115, v92, v93 quad_perm:[0,0,0,0] row_mask:0xf bank_mask:0xf
    v_add_f32_dpp v116, v96, v97 quad_perm:[0,0,0,0] row_mask:0xf bank_mask:0xf
    v_add_f32_dpp v117, v100, v101 quad_perm:[0,0,0,0] row_mask:0xf bank_mask:0xf
    v_add_f32_dpp v118, v104, v105 quad_perm:[0,0,0,0] row_mask:0xf bank_mask:0xf
    s_nop 0
    v_add_f32_dpp v119, v108, v109 quad_perm:[0,0,0,0] row_mask:0xf bank_mask:0xf
    v_add_f32_dpp v112, v82, v112 quad_perm:[2,2,2,2] row_mask:0xf bank_mask:0xf
    v_add_f32_dpp v113, v86, v113 quad_perm:[2,2,2,2] row_mask:0xf bank_mask:0xf
    v_add_f32_dpp v114, v90, v114 quad_perm:[2,2,2,2] row_mask:0xf bank_mask:0xf
    v_add_f32_dpp v115, v94, v115 quad_perm:[2,2,2,2] row_mask:0xf bank_mask:0xf
    v_add_f32_dpp v116, v98, v116 quad_perm:[2,2,2,2] row_mask:0xf bank_mask:0xf
    v_add_f32_dpp v117, v102, v117 quad_perm:[2,2,2,2] row_mask:0xf bank_mask:0xf
    v_add_f32_dpp v118, v106, v118 quad_perm:[2,2,2,2] row_mask:0xf bank_mask:0xf
    v_add_f32_dpp v119, v110, v119 quad_perm:[2,2,2,2] row_mask:0xf bank_mask:0xf
    v_add_f32_dpp v112, v83, v112 quad_perm:[3,3,3,3] row_mask:0xf bank_mask:0xf
    v_add_f32_dpp v113, v87, v113 quad_perm:[3,3,3,3] row_mask:0xf bank_mask:0xf
    v_add_f32_dpp v114, v91, v114 quad_perm:[3,3,3,3] row_mask:0xf bank_mask:0xf
    v_add_f32_dpp v115, v95, v115 quad_perm:[3,3,3,3] row_mask:0xf bank_mask:0xf
    v_add_f32_dpp v116, v99, v116 quad_perm:[3,3,3,3] row_mask:0xf bank_mask:0xf
    v_add_f32_dpp v117, v103, v117 quad_perm:[3,3,3,3] row_mask:0xf bank_mask:0xf
    v_add_f32_dpp v118, v107, v118 quad_perm:[3,3,3,3] row_mask:0xf bank_mask:0xf
    v_add_f32_dpp v119, v111, v119 quad_perm:[3,3,3,3] row_mask:0xf bank_mask:0xf
    v_cndmask_b32 v72, v72, v112, s[64:65]
    v_cndmask_b32 v73, v73, v113, s[64:65]
    v_cndmask_b32 v74, v74, v114, s[64:65]
    v_cndmask_b32 v75, v75, v115, s[64:65]
    v_cndmask_b32 v76, v76, v116, s[64:65]
    v_cndmask_b32 v77, v77, v117, s[64:65]
    v_cndmask_b32 v78, v78, v118, s[64:65]
    v_cndmask_b32 v79, v79, v119, s[64:65]
    s_waitcnt vmcnt(15)
    v_mfma_f32_16x16x32_bf16 v[80:83], v[192:195], v[8:11], 0
    s_waitcnt vmcnt(14)
    v_mfma_f32_16x16x32_bf16 v[84:87], v[196:199], v[8:11], 0
    s_waitcnt vmcnt(13)
    v_mfma_f32_16x16x32_bf16 v[88:91], v[200:203], v[8:11], 0
    s_waitcnt vmcnt(12)
    v_mfma_f32_16x16x32_bf16 v[92:95], v[204:207], v[8:11], 0
    s_waitcnt vmcnt(11)
    v_mfma_f32_16x16x32_bf16 v[96:99], v[208:211], v[8:11], 0
    s_waitcnt vmcnt(10)
    v_mfma_f32_16x16x32_bf16 v[100:103], v[212:215], v[8:11], 0
    s_waitcnt vmcnt(9)
    v_mfma_f32_16x16x32_bf16 v[104:107], v[216:219], v[8:11], 0
    s_waitcnt vmcnt(8)
    v_mfma_f32_16x16x32_bf16 v[108:111], v[220:223], v[8:11], 0
    v_add_f32_dpp v112, v80, v82 quad_perm:[0,0,0,0] row_mask:0xf bank_mask:0xf
    v_add_f32_dpp v113, v84, v86 quad_perm:[0,0,0,0] row_mask:0xf bank_mask:0xf
    v_add_f32_dpp v114, v88, v90 quad_perm:[0,0,0,0] row_mask:0xf bank_mask:0xf
    v_add_f32_dpp v115, v92, v94 quad_perm:[0,0,0,0] row_mask:0xf bank_mask:0xf
    v_add_f32_dpp v116, v96, v98 quad_perm:[0,0,0,0] row_mask:0xf bank_mask:0xf
    v_add_f32_dpp v117, v100, v102 quad_perm:[0,0,0,0] row_mask:0xf bank_mask:0xf
    v_add_f32_dpp v118, v104, v106 quad_perm:[0,0,0,0] row_mask:0xf bank_mask:0xf
    s_nop 0
    v_add_f32_dpp v119, v108, v110 quad_perm:[0,0,0,0] row_mask:0xf bank_mask:0xf
    v_add_f32_dpp v112, v81, v112 quad_perm:[1,1,1,1] row_mask:0xf bank_mask:0xf
    v_add_f32_dpp v113, v85, v113 quad_perm:[1,1,1,1] row_mask:0xf bank_mask:0xf
    v_add_f32_dpp v114, v89, v114 quad_perm:[1,1,1,1] row_mask:0xf bank_mask:0xf
    v_add_f32_dpp v115, v93, v115 quad_perm:[1,1,1,1] row_mask:0xf bank_mask:0xf
    v_add_f32_dpp v116, v97, v116 quad_perm:[1,1,1,1] row_mask:0xf bank_mask:0xf
    v_add_f32_dpp v117, v101, v117 quad_perm:[1,1,1,1] row_mask:0xf bank_mask:0xf
    v_add_f32_dpp v118, v105, v118 quad_perm:[1,1,1,1] row_mask:0xf bank_mask:0xf
    v_add_f32_dpp v119, v109, v119 quad_perm:[1,1,1,1] row_mask:0xf bank_mask:0xf
    v_add_f32_dpp v112, v83, v112 quad_perm:[3,3,3,3] row_mask:0xf bank_mask:0xf
    v_add_f32_dpp v113, v87, v113 quad_perm:[3,3,3,3] row_mask:0xf bank_mask:0xf
    v_add_f32_dpp v114, v91, v114 quad_perm:[3,3,3,3] row_mask:0xf bank_mask:0xf
    v_add_f32_dpp v115, v95, v115 quad_perm:[3,3,3,3] row_mask:0xf bank_mask:0xf
    v_add_f32_dpp v116, v99, v116 quad_perm:[3,3,3,3] row_mask:0xf bank_mask:0xf
    v_add_f32_dpp v117, v103, v117 quad_perm:[3,3,3,3] row_mask:0xf bank_mask:0xf
    v_add_f32_dpp v118, v107, v118 quad_perm:[3,3,3,3] row_mask:0xf bank_mask:0xf
    v_add_f32_dpp v119, v111, v119 quad_perm:[3,3,3,3] row_mask:0xf bank_mask:0xf
    v_cndmask_b32 v72, v72, v112, s[66:67]
    v_cndmask_b32 v73, v73, v113, s[66:67]
    v_cndmask_b32 v74, v74, v114, s[66:67]
    v_cndmask_b32 v75, v75, v115, s[66:67]
    v_cndmask_b32 v76, v76, v116, s[66:67]
    v_cndmask_b32 v77, v77, v117, s[66:67]
    v_cndmask_b32 v78, v78, v118, s[66:67]
    v_cndmask_b32 v79, v79, v119, s[66:67]
    s_waitcnt vmcnt(7)
    v_mfma_f32_16x16x32_bf16 v[80:83], v[224:227], v[8:11], 0
    s_waitcnt vmcnt(6)
    v_mfma_f32_16x16x32_bf16 v[84:87], v[228:231], v[8:11], 0
    s_waitcnt vmcnt(5)
    v_mfma_f32_16x16x32_bf16 v[88:91], v[232:235], v[8:11], 0
    s_waitcnt vmcnt(4)
    v_mfma_f32_16x16x32_bf16 v[92:95], v[236:239], v[8:11], 0
    s_waitcnt vmcnt(3)
    v_mfma_f32_16x16x32_bf16 v[96:99], v[240:243], v[8:11], 0
    s_waitcnt vmcnt(2)
    v_mfma_f32_16x16x32_bf16 v[100:103], v[244:247], v[8:11], 0
    s_waitcnt vmcnt(1)
    v_mfma_f32_16x16x32_bf16 v[104:107], v[248:251], v[8:11], 0
    s_waitcnt vmcnt(0)
    v_mfma_f32_16x16x32_bf16 v[108:111], v[252:255], v[8:11], 0
    v_add_f32_dpp v112, v80, v83 quad_perm:[0,0,0,0] row_mask:0xf bank_mask:0xf
    v_add_f32_dpp v113, v84, v87 quad_perm:[0,0,0,0] row_mask:0xf bank_mask:0xf
    v_add_f32_dpp v114, v88, v91 quad_perm:[0,0,0,0] row_mask:0xf bank_mask:0xf
    v_add_f32_dpp v115, v92, v95 quad_perm:[0,0,0,0] row_mask:0xf bank_mask:0xf
    v_add_f32_dpp v116, v96, v99 quad_perm:[0,0,0,0] row_mask:0xf bank_mask:0xf
    v_add_f32_dpp v117, v100, v103 quad_perm:[0,0,0,0] row_mask:0xf bank_mask:0xf
    v_add_f32_dpp v118, v104, v107 quad_perm:[0,0,0,0] row_mask:0xf bank_mask:0xf
    s_nop 0
    v_add_f32_dpp v119, v108, v111 quad_perm:[0,0,0,0] row_mask:0xf bank_mask:0xf
    v_add_f32_dpp v112, v81, v112 quad_perm:[1,1,1,1] row_mask:0xf bank_mask:0xf
    v_add_f32_dpp v113, v85, v113 quad_perm:[1,1,1,1] row_mask:0xf bank_mask:0xf
    v_add_f32_dpp v114, v89, v114 quad_perm:[1,1,1,1] row_mask:0xf bank_mask:0xf
    v_add_f32_dpp v115, v93, v115 quad_perm:[1,1,1,1] row_mask:0xf bank_mask:0xf
    v_add_f32_dpp v116, v97, v116 quad_perm:[1,1,1,1] row_mask:0xf bank_mask:0xf
    v_add_f32_dpp v117, v101, v117 quad_perm:[1,1,1,1] row_mask:0xf bank_mask:0xf
    v_add_f32_dpp v118, v105, v118 quad_perm:[1,1,1,1] row_mask:0xf bank_mask:0xf
    v_add_f32_dpp v119, v109, v119 quad_perm:[1,1,1,1] row_mask:0xf bank_mask:0xf
    v_add_f32_dpp v112, v82, v112 quad_perm:[2,2,2,2] row_mask:0xf bank_mask:0xf
    v_add_f32_dpp v113, v86, v113 quad_perm:[2,2,2,2] row_mask:0xf bank_mask:0xf
    v_add_f32_dpp v114, v90, v114 quad_perm:[2,2,2,2] row_mask:0xf bank_mask:0xf
    v_add_f32_dpp v115, v94, v115 quad_perm:[2,2,2,2] row_mask:0xf bank_mask:0xf
    v_add_f32_dpp v116, v98, v116 quad_perm:[2,2,2,2] row_mask:0xf bank_mask:0xf
    v_add_f32_dpp v117, v102, v117 quad_perm:[2,2,2,2] row_mask:0xf bank_mask:0xf
    v_add_f32_dpp v118, v106, v118 quad_perm:[2,2,2,2] row_mask:0xf bank_mask:0xf
    v_add_f32_dpp v119, v110, v119 quad_perm:[2,2,2,2] row_mask:0xf bank_mask:0xf
    v_cndmask_b32 v72, v72, v112, s[68:69]
    v_cndmask_b32 v73, v73, v113, s[68:69]
    v_cndmask_b32 v74, v74, v114, s[68:69]
    v_cndmask_b32 v75, v75, v115, s[68:69]
    v_cndmask_b32 v76, v76, v116, s[68:69]
    v_cndmask_b32 v77, v77, v117, s[68:69]
    v_cndmask_b32 v78, v78, v118, s[68:69]
    v_cndmask_b32 v79, v79, v119, s[68:69]
    s_mov_b32 s71, 0x3e0293ee
    v_mul_f32 v72, s71, v72
    v_mul_f32 v73, s71, v73
    v_mul_f32 v74, s71, v74
    v_mul_f32 v75, s71, v75
    v_mul_f32 v76, s71, v76
    v_mul_f32 v77, s71, v77
    v_mul_f32 v78, s71, v78
    v_mul_f32 v79, s71, v79
    v_cvt_pk_bf16_f32 v4, v72, v73
    v_cvt_pk_bf16_f32 v5, v74, v75
    v_cvt_pk_bf16_f32 v6, v76, v77
    v_cvt_pk_bf16_f32 v7, v78, v79
    s_lshl_b32 s24, s26, 10
    s_lshl_b32 s25, s3, 8
    s_add_u32 s24, s24, s25
    s_add_u32 s24, s24, 0x0
    buffer_store_dwordx4 v[4:7], v66, s[12:15], s24 offen sc1
    s_mov_b32 s8, s56
    s_mov_b32 s9, s57
    s_mov_b32 s10, 0x400000
    s_mov_b32 s11, 0x20000
    s_lshl_b32 s33, s26, 17
    s_lshl_b32 s24, s3, 15
    s_add_u32 s33, s33, s24
    s_add_u32 s33, s33, 0
    s_mul_i32 s34, s3, 17408
    s_add_u32 s34, s34, 0
    s_mov_b32 exec_hi, 0
    s_mov_b32 s70, 0
L_woW:
    s_and_b32 s24, s70, 1
    s_lshl_b32 s24, s24, 4
    s_and_b32 s25, s70, 4
    s_lshl_b32 s25, s25, 1
    s_or_b32 s24, s24, s25
    s_bfe_u32 s25, s70, 0x10001
    s_or_b32 s24, s24, s25
    s_lshl_b32 s24, s24, 10
    s_add_u32 s24, s24, s33
    s_mul_i32 s25, s70, 2176
    s_add_u32 m0, s25, s34
    s_waitcnt vmcnt(24)
    buffer_load_dwordx4 v2, s[8:11], s24 offen nt lds
    s_add_u32 m0, m0, 544
    s_add_u32 s24, s24, 2048
    s_waitcnt vmcnt(24)
    buffer_load_dwordx4 v2, s[8:11], s24 offen nt lds
    s_add_u32 m0, m0, 544
    s_add_u32 s24, s24, 2048
    s_waitcnt vmcnt(24)
    buffer_load_dwordx4 v2, s[8:11], s24 offen nt lds
    s_add_u32 m0, m0, 544
    s_add_u32 s24, s24, 2048
    s_waitcnt vmcnt(24)
    buffer_load_dwordx4 v2, s[8:11], s24 offen nt lds
    s_add_u32 s70, s70, 1
    s_cmp_lt_u32 s70, 8
    s_cbranch_scc1 L_woW
    s_mov_b64 exec, -1
    s_waitcnt vmcnt(0)
    s_barrier
    s_cmp_lg_u32 s3, 0
    s_cbranch_scc1 L_sig5
    s_mov_b64 exec, 1
    v_mov_b32 v3, 1
    buffer_atomic_add v3, off, s[16:19], 0 offset:0 sc0
    s_waitcnt vmcnt(0)
    v_readfirstlane_b32 s24, v3
    s_mov_b64 exec, -1
    s_and_b32 s24, s24, 63
    s_cmp_lg_u32 s24, 63
    s_cbranch_scc1 L_sig5
    v_lshlrev_b32 v4, 7, v0
    v_mov_b32 v3, 1
    s_mov_b32 s24, 0x170000
    buffer_store_dword v3, v4, s[12:15], s24 offen offset:0 sc1
L_sig5:
    v_lshrrev_b32 v3, 2, v0
    v_mul_u32_u24 v3, 544, v3
    v_and_b32 v4, 3, v0
    v_lshl_add_u32 v3, v4, 3, v3
    s_mul_i32 s24, s3, 128
    s_add_u32 s24, s24, 0
    v_add_u32 v3, s24, v3
    v_add_u32 v4, 34816, v3
    ds_read_b64_tr_b16 a[128:129], v3 offset:0
    ds_read_b64_tr_b16 a[130:131], v3 offset:8704
    ds_read_b64_tr_b16 a[132:133], v3 offset:17408
    ds_read_b64_tr_b16 a[134:135], v3 offset:26112
    ds_read_b64_tr_b16 a[136:137], v4 offset:0
    ds_read_b64_tr_b16 a[138:139], v4 offset:8704
    ds_read_b64_tr_b16 a[140:141], v4 offset:17408
    ds_read_b64_tr_b16 a[142:143], v4 offset:26112
    ds_read_b64_tr_b16 a[144:145], v3 offset:32
    ds_read_b64_tr_b16 a[146:147], v3 offset:8736
    ds_read_b64_tr_b16 a[148:149], v3 offset:17440
    ds_read_b64_tr_b16 a[150:151], v3 offset:26144
    ds_read_b64_tr_b16 a[152:153], v4 offset:32
    ds_read_b64_tr_b16 a[154:155], v4 offset:8736
    ds_read_b64_tr_b16 a[156:157], v4 offset:17440
    ds_read_b64_tr_b16 a[158:159], v4 offset:26144
    ds_read_b64_tr_b16 a[160:161], v3 offset:64
    ds_read_b64_tr_b16 a[162:163], v3 offset:8768
    ds_read_b64_tr_b16 a[164:165], v3 offset:17472
    ds_read_b64_tr_b16 a[166:167], v3 offset:26176
    ds_read_b64_tr_b16 a[168:169], v4 offset:64
    ds_read_b64_tr_b16 a[170:171], v4 offset:8768
    ds_read_b64_tr_b16 a[172:173], v4 offset:17472
    ds_read_b64_tr_b16 a[174:175], v4 offset:26176
    ds_read_b64_tr_b16 a[176:177], v3 offset:96
    ds_read_b64_tr_b16 a[178:179], v3 offset:8800
    ds_read_b64_tr_b16 a[180:181], v3 offset:17504
    ds_read_b64_tr_b16 a[182:183], v3 offset:26208
    ds_read_b64_tr_b16 a[184:185], v4 offset:96
    ds_read_b64_tr_b16 a[186:187], v4 offset:8800
    ds_read_b64_tr_b16 a[188:189], v4 offset:17504
    ds_read_b64_tr_b16 a[190:191], v4 offset:26208
    s_mov_b32 s4, s44
    s_mov_b32 s5, s45
    s_mov_b32 s6, 0x400000
    s_mov_b32 s7, 0x20000
    s_mov_b32 s8, s46
    s_mov_b32 s9, s47
    s_mov_b32 s10, 0x400000
    s_mov_b32 s11, 0x20000
    s_mov_b32 s32, s35
    buffer_load_dwordx4 v[128:131], v18, s[4:7], s32 offen nt
    s_add_u32 s32, s32, 8192
    buffer_load_dwordx4 v[132:135], v18, s[4:7], s32 offen nt
    s_add_u32 s32, s32, 8192
    buffer_load_dwordx4 v[136:139], v18, s[4:7], s32 offen nt
    s_add_u32 s32, s32, 8192
    buffer_load_dwordx4 v[140:143], v18, s[4:7], s32 offen nt
    s_add_u32 s32, s32, 8192
    buffer_load_dwordx4 v[144:147], v18, s[4:7], s32 offen nt
    s_add_u32 s32, s32, 8192
    buffer_load_dwordx4 v[148:151], v18, s[4:7], s32 offen nt
    s_add_u32 s32, s32, 8192
    buffer_load_dwordx4 v[152:155], v18, s[4:7], s32 offen nt
    s_add_u32 s32, s32, 8192
    buffer_load_dwordx4 v[156:159], v18, s[4:7], s32 offen nt
    s_add_u32 s32, s32, 8192
    buffer_load_dwordx4 v[160:163], v18, s[4:7], s32 offen nt
    s_add_u32 s32, s32, 8192
    buffer_load_dwordx4 v[164:167], v18, s[4:7], s32 offen nt
    s_add_u32 s32, s32, 8192
    buffer_load_dwordx4 v[168:171], v18, s[4:7], s32 offen nt
    s_add_u32 s32, s32, 8192
    buffer_load_dwordx4 v[172:175], v18, s[4:7], s32 offen nt
    s_add_u32 s32, s32, 8192
    buffer_load_dwordx4 v[176:179], v18, s[4:7], s32 offen nt
    s_add_u32 s32, s32, 8192
    buffer_load_dwordx4 v[180:183], v18, s[4:7], s32 offen nt
    s_add_u32 s32, s32, 8192
    buffer_load_dwordx4 v[184:187], v18, s[4:7], s32 offen nt
    s_add_u32 s32, s32, 8192
    buffer_load_dwordx4 v[188:191], v18, s[4:7], s32 offen nt
    s_add_u32 s32, s32, 8192
    buffer_load_dwordx4 v[192:195], v18, s[4:7], s32 offen nt
    s_add_u32 s32, s32, 8192
    buffer_load_dwordx4 v[196:199], v18, s[4:7], s32 offen nt
    s_add_u32 s32, s32, 8192
    buffer_load_dwordx4 v[200:203], v18, s[4:7], s32 offen nt
    s_add_u32 s32, s32, 8192
    buffer_load_dwordx4 v[204:207], v18, s[4:7], s32 offen nt
    s_add_u32 s32, s32, 8192
    buffer_load_dwordx4 v[208:211], v18, s[4:7], s32 offen nt
    s_add_u32 s32, s32, 8192
    buffer_load_dwordx4 v[212:215], v18, s[4:7], s32 offen nt
    s_add_u32 s32, s32, 8192
    buffer_load_dwordx4 v[216:219], v18, s[4:7], s32 offen nt
    s_add_u32 s32, s32, 8192
    buffer_load_dwordx4 v[220:223], v18, s[4:7], s32 offen nt
    s_add_u32 s32, s32, 8192
    buffer_load_dwordx4 v[224:227], v18, s[4:7], s32 offen nt
    s_add_u32 s32, s32, 8192
    buffer_load_dwordx4 v[228:231], v18, s[4:7], s32 offen nt
    s_add_u32 s32, s32, 8192
    buffer_load_dwordx4 v[232:235], v18, s[4:7], s32 offen nt
    s_add_u32 s32, s32, 8192
    buffer_load_dwordx4 v[236:239], v18, s[4:7], s32 offen nt
    s_add_u32 s32, s32, 8192
    buffer_load_dwordx4 v[240:243], v18, s[4:7], s32 offen nt
    s_add_u32 s32, s32, 8192
    buffer_load_dwordx4 v[244:247], v18, s[4:7], s32 offen nt
    s_add_u32 s32, s32, 8192
    buffer_load_dwordx4 v[248:251], v18, s[4:7], s32 offen nt
    s_add_u32 s32, s32, 8192
    buffer_load_dwordx4 v[252:255], v18, s[4:7], s32 offen nt
    s_add_u32 s32, s32, 8192
    s_lshl_b32 s33, s26, 17
    s_lshl_b32 s24, s3, 15
    s_add_u32 s33, s33, s24
    s_mul_i32 s34, s3, 33792
    s_waitcnt lgkmcnt(0)
    s_barrier
    s_mov_b32 s70, 0
L_woA:
    s_and_b32 s24, s70, 3
    s_lshl_b32 s24, s24, 1
    s_lshr_b32 s25, s70, 2
    s_or_b32 s24, s24, s25
    s_lshl_b32 s24, s24, 10
    s_add_u32 s24, s24, s33
    s_mul_i32 s25, s70, 4224
    s_add_u32 m0, s25, s34
    s_waitcnt vmcnt(24)
    buffer_load_dwordx4 v2, s[8:11], s24 offen nt lds
    s_add_u32 m0, m0, 1056
    s_add_u32 s24, s24, 8192
    s_waitcnt vmcnt(24)
    buffer_load_dwordx4 v2, s[8:11], s24 offen nt lds
    s_add_u32 m0, m0, 1056
    s_add_u32 s24, s24, 8192
    s_waitcnt vmcnt(24)
    buffer_load_dwordx4 v2, s[8:11], s24 offen nt lds
    s_add_u32 m0, m0, 1056
    s_add_u32 s24, s24, 8192
    s_waitcnt vmcnt(24)
    buffer_load_dwordx4 v2, s[8:11], s24 offen nt lds
    s_add_u32 s70, s70, 1
    s_cmp_lt_u32 s70, 8
    s_cbranch_scc1 L_woA
    s_waitcnt vmcnt(0)
    s_barrier
    v_lshrrev_b32 v3, 2, v0
    v_mul_u32_u24 v3, 1056, v3
    v_and_b32 v4, 3, v0
    v_lshl_add_u32 v3, v4, 3, v3
    s_mul_i32 s24, s3, 256
    s_add_u32 s24, s24, 0
    v_add_u32 v3, s24, v3
    v_add_u32 v4, 67584, v3
    ds_read_b64_tr_b16 a[0:1], v3 offset:0
    ds_read_b64_tr_b16 a[2:3], v3 offset:16896
    ds_read_b64_tr_b16 a[4:5], v3 offset:33792
    ds_read_b64_tr_b16 a[6:7], v3 offset:50688
    ds_read_b64_tr_b16 a[8:9], v4 offset:0
    ds_read_b64_tr_b16 a[10:11], v4 offset:16896
    ds_read_b64_tr_b16 a[12:13], v4 offset:33792
    ds_read_b64_tr_b16 a[14:15], v4 offset:50688
    ds_read_b64_tr_b16 a[16:17], v3 offset:32
    ds_read_b64_tr_b16 a[18:19], v3 offset:16928
    ds_read_b64_tr_b16 a[20:21], v3 offset:33824
    ds_read_b64_tr_b16 a[22:23], v3 offset:50720
    ds_read_b64_tr_b16 a[24:25], v4 offset:32
    ds_read_b64_tr_b16 a[26:27], v4 offset:16928
    ds_read_b64_tr_b16 a[28:29], v4 offset:33824
    ds_read_b64_tr_b16 a[30:31], v4 offset:50720
    ds_read_b64_tr_b16 a[32:33], v3 offset:64
    ds_read_b64_tr_b16 a[34:35], v3 offset:16960
    ds_read_b64_tr_b16 a[36:37], v3 offset:33856
    ds_read_b64_tr_b16 a[38:39], v3 offset:50752
    ds_read_b64_tr_b16 a[40:41], v4 offset:64
    ds_read_b64_tr_b16 a[42:43], v4 offset:16960
    ds_read_b64_tr_b16 a[44:45], v4 offset:33856
    ds_read_b64_tr_b16 a[46:47], v4 offset:50752
    ds_read_b64_tr_b16 a[48:49], v3 offset:96
    ds_read_b64_tr_b16 a[50:51], v3 offset:16992
    ds_read_b64_tr_b16 a[52:53], v3 offset:33888
    ds_read_b64_tr_b16 a[54:55], v3 offset:50784
    ds_read_b64_tr_b16 a[56:57], v4 offset:96
    ds_read_b64_tr_b16 a[58:59], v4 offset:16992
    ds_read_b64_tr_b16 a[60:61], v4 offset:33888
    ds_read_b64_tr_b16 a[62:63], v4 offset:50784
    ds_read_b64_tr_b16 a[64:65], v3 offset:128
    ds_read_b64_tr_b16 a[66:67], v3 offset:17024
    ds_read_b64_tr_b16 a[68:69], v3 offset:33920
    ds_read_b64_tr_b16 a[70:71], v3 offset:50816
    ds_read_b64_tr_b16 a[72:73], v4 offset:128
    ds_read_b64_tr_b16 a[74:75], v4 offset:17024
    ds_read_b64_tr_b16 a[76:77], v4 offset:33920
    ds_read_b64_tr_b16 a[78:79], v4 offset:50816
    ds_read_b64_tr_b16 a[80:81], v3 offset:160
    ds_read_b64_tr_b16 a[82:83], v3 offset:17056
    ds_read_b64_tr_b16 a[84:85], v3 offset:33952
    ds_read_b64_tr_b16 a[86:87], v3 offset:50848
    ds_read_b64_tr_b16 a[88:89], v4 offset:160
    ds_read_b64_tr_b16 a[90:91], v4 offset:17056
    ds_read_b64_tr_b16 a[92:93], v4 offset:33952
    ds_read_b64_tr_b16 a[94:95], v4 offset:50848
    ds_read_b64_tr_b16 a[96:97], v3 offset:192
    ds_read_b64_tr_b16 a[98:99], v3 offset:17088
    ds_read_b64_tr_b16 a[100:101], v3 offset:33984
    ds_read_b64_tr_b16 a[102:103], v3 offset:50880
    ds_read_b64_tr_b16 a[104:105], v4 offset:192
    ds_read_b64_tr_b16 a[106:107], v4 offset:17088
    ds_read_b64_tr_b16 a[108:109], v4 offset:33984
    ds_read_b64_tr_b16 a[110:111], v4 offset:50880
    ds_read_b64_tr_b16 a[112:113], v3 offset:224
    ds_read_b64_tr_b16 a[114:115], v3 offset:17120
    ds_read_b64_tr_b16 a[116:117], v3 offset:34016
    ds_read_b64_tr_b16 a[118:119], v3 offset:50912
    ds_read_b64_tr_b16 a[120:121], v4 offset:224
    ds_read_b64_tr_b16 a[122:123], v4 offset:17120
    ds_read_b64_tr_b16 a[124:125], v4 offset:34016
    ds_read_b64_tr_b16 a[126:127], v4 offset:50912
    s_waitcnt lgkmcnt(0)
    s_cmp_lg_u32 s3, 0
    s_cbranch_scc1 L_awx6
    s_mov_b32 s24, 262144
    s_mov_b64 exec, 1
L_aw7:
    buffer_load_dword v1, off, s[12:15], s73 offset:0 sc1
    s_waitcnt vmcnt(0)
    v_readfirstlane_b32 s25, v1
    s_nop 0
    s_cmp_eq_u32 s25, 1
    s_cbranch_scc1 L_awx6
    s_sleep 4
    s_sub_u32 s24, s24, 1
    s_cmp_lg_u32 s24, 0
    s_cbranch_scc1 L_aw7
L_awx6:
    s_mov_b64 exec, -1
    s_barrier
    s_cmp_lg_u32 s3, 0
    s_cbranch_scc1 L_xi8
    s_getreg_b32 s25, hwreg(HW_REG_XCC_ID, 0, 4)
    s_lshl_b32 s24, s26, 7
    s_add_u32 s24, s24, 0x1b6000
    s_mov_b64 exec, 1
    v_mov_b32 v3, s25
    buffer_store_dword v3, off, s[12:15], s24 offset:0 sc1
    s_mov_b64 exec, -1
L_xi8:
    s_cmp_lg_u32 s3, 0
    s_cbranch_scc1 L_awx9
    s_mov_b32 s24, 262144
    s_mov_b64 exec, 1
L_aw10:
    buffer_load_dword v1, off, s[12:15], s73 offset:4 sc1
    s_waitcnt vmcnt(0)
    v_readfirstlane_b32 s25, v1
    s_nop 0
    s_cmp_eq_u32 s25, 1
    s_cbranch_scc1 L_awx9
    s_sleep 4
    s_sub_u32 s24, s24, 1
    s_cmp_lg_u32 s24, 0
    s_cbranch_scc1 L_aw10
L_awx9:
    s_mov_b64 exec, -1
    s_barrier
    s_lshl_b32 s24, s3, 11
    s_lshl_b32 s25, s26, 3
    s_add_u32 s25, s25, s24
    s_add_u32 s25, s25, 0x120000
    s_lshl_b32 s24, s26, 2
    s_add_u32 s24, s24, s3
    v_and_b32 v3, 7, v0
    v_lshlrev_b32 v3, 8, v3
    buffer_load_dwordx2 v[4:5], v3, s[12:15], s25 offen sc1
    s_lshl_b32 s24, s24, 13
    s_add_u32 s24, s24, 0x20000
    buffer_load_dwordx4 v[72:75], v2, s[12:15], s24 offen offset:0 sc1
    buffer_load_dwordx4 v[76:79], v2, s[12:15], s24 offen offset:1024 sc1
    buffer_load_dwordx4 v[80:83], v2, s[12:15], s24 offen offset:2048 sc1
    buffer_load_dwordx4 v[84:87], v2, s[12:15], s24 offen offset:3072 sc1
    s_add_u32 s24, s24, 4096
    buffer_load_dwordx4 v[88:91], v2, s[12:15], s24 offen offset:0 sc1
    buffer_load_dwordx4 v[92:95], v2, s[12:15], s24 offen offset:1024 sc1
    buffer_load_dwordx4 v[96:99], v2, s[12:15], s24 offen offset:2048 sc1
    buffer_load_dwordx4 v[100:103], v2, s[12:15], s24 offen offset:3072 sc1
    s_waitcnt vmcnt(8)
    v_mov_b32 v6, v4
    s_nop 1
    v_max_f32_dpp v6, v6, v6 row_ror:4 row_mask:0xf bank_mask:0xf
    s_nop 1
    v_max_f32_dpp v6, v6, v6 row_ror:2 row_mask:0xf bank_mask:0xf
    s_nop 1
    v_max_f32_dpp v6, v6, v6 row_ror:1 row_mask:0xf bank_mask:0xf
    v_sub_f32 v4, v4, v6
    v_exp_f32 v4, v4
    s_nop 0
    v_mul_f32 v5, v4, v5
    s_nop 1
    v_add_f32_dpp v5, v5, v5 row_ror:4 row_mask:0xf bank_mask:0xf
    s_nop 1
    v_add_f32_dpp v5, v5, v5 row_ror:2 row_mask:0xf bank_mask:0xf
    s_nop 1
    v_add_f32_dpp v5, v5, v5 row_ror:1 row_mask:0xf bank_mask:0xf
    v_rcp_f32 v5, v5
    s_nop 0
    v_mul_f32 v4, v4, v5
    s_nop 0
    v_readlane_b32 s24, v4, 0
    s_waitcnt vmcnt(7)
    v_lshlrev_b32 v5, 16, v72
    v_and_b32 v6, 0xffff0000, v72
    v_mul_f32 v104, s24, v5
    v_mul_f32 v105, s24, v6
    v_lshlrev_b32 v5, 16, v73
    v_and_b32 v6, 0xffff0000, v73
    v_mul_f32 v106, s24, v5
    v_mul_f32 v107, s24, v6
    v_lshlrev_b32 v5, 16, v74
    v_and_b32 v6, 0xffff0000, v74
    v_mul_f32 v108, s24, v5
    v_mul_f32 v109, s24, v6
    v_lshlrev_b32 v5, 16, v75
    v_and_b32 v6, 0xffff0000, v75
    v_mul_f32 v110, s24, v5
    v_mul_f32 v111, s24, v6
    v_readlane_b32 s24, v4, 1
    s_waitcnt vmcnt(6)
    v_lshlrev_b32 v5, 16, v76
    v_and_b32 v6, 0xffff0000, v76
    v_fmac_f32 v104, s24, v5
    v_fmac_f32 v105, s24, v6
    v_lshlrev_b32 v5, 16, v77
    v_and_b32 v6, 0xffff0000, v77
    v_fmac_f32 v106, s24, v5
    v_fmac_f32 v107, s24, v6
    v_lshlrev_b32 v5, 16, v78
    v_and_b32 v6, 0xffff0000, v78
    v_fmac_f32 v108, s24, v5
    v_fmac_f32 v109, s24, v6
    v_lshlrev_b32 v5, 16, v79
    v_and_b32 v6, 0xffff0000, v79
    v_fmac_f32 v110, s24, v5
    v_fmac_f32 v111, s24, v6
    v_readlane_b32 s24, v4, 2
    s_waitcnt vmcnt(5)
    v_lshlrev_b32 v5, 16, v80
    v_and_b32 v6, 0xffff0000, v80
    v_fmac_f32 v104, s24, v5
    v_fmac_f32 v105, s24, v6
    v_lshlrev_b32 v5, 16, v81
    v_and_b32 v6, 0xffff0000, v81
    v_fmac_f32 v106, s24, v5
    v_fmac_f32 v107, s24, v6
    v_lshlrev_b32 v5, 16, v82
    v_and_b32 v6, 0xffff0000, v82
    v_fmac_f32 v108, s24, v5
    v_fmac_f32 v109, s24, v6
    v_lshlrev_b32 v5, 16, v83
    v_and_b32 v6, 0xffff0000, v83
    v_fmac_f32 v110, s24, v5
    v_fmac_f32 v111, s24, v6
    v_readlane_b32 s24, v4, 3
    s_waitcnt vmcnt(4)
    v_lshlrev_b32 v5, 16, v84
    v_and_b32 v6, 0xffff0000, v84
    v_fmac_f32 v104, s24, v5
    v_fmac_f32 v105, s24, v6
    v_lshlrev_b32 v5, 16, v85
    v_and_b32 v6, 0xffff0000, v85
    v_fmac_f32 v106, s24, v5
    v_fmac_f32 v107, s24, v6
    v_lshlrev_b32 v5, 16, v86
    v_and_b32 v6, 0xffff0000, v86
    v_fmac_f32 v108, s24, v5
    v_fmac_f32 v109, s24, v6
    v_lshlrev_b32 v5, 16, v87
    v_and_b32 v6, 0xffff0000, v87
    v_fmac_f32 v110, s24, v5
    v_fmac_f32 v111, s24, v6
    v_readlane_b32 s24, v4, 4
    s_waitcnt vmcnt(3)
    v_lshlrev_b32 v5, 16, v88
    v_and_b32 v6, 0xffff0000, v88
    v_fmac_f32 v104, s24, v5
    v_fmac_f32 v105, s24, v6
    v_lshlrev_b32 v5, 16, v89
    v_and_b32 v6, 0xffff0000, v89
    v_fmac_f32 v106, s24, v5
    v_fmac_f32 v107, s24, v6
    v_lshlrev_b32 v5, 16, v90
    v_and_b32 v6, 0xffff0000, v90
    v_fmac_f32 v108, s24, v5
    v_fmac_f32 v109, s24, v6
    v_lshlrev_b32 v5, 16, v91
    v_and_b32 v6, 0xffff0000, v91
    v_fmac_f32 v110, s24, v5
    v_fmac_f32 v111, s24, v6
    v_readlane_b32 s24, v4, 5
    s_waitcnt vmcnt(2)
    v_lshlrev_b32 v5, 16, v92
    v_and_b32 v6, 0xffff0000, v92
    v_fmac_f32 v104, s24, v5
    v_fmac_f32 v105, s24, v6
    v_lshlrev_b32 v5, 16, v93
    v_and_b32 v6, 0xffff0000, v93
    v_fmac_f32 v106, s24, v5
    v_fmac_f32 v107, s24, v6
    v_lshlrev_b32 v5, 16, v94
    v_and_b32 v6, 0xffff0000, v94
    v_fmac_f32 v108, s24, v5
    v_fmac_f32 v109, s24, v6
    v_lshlrev_b32 v5, 16, v95
    v_and_b32 v6, 0xffff0000, v95
    v_fmac_f32 v110, s24, v5
    v_fmac_f32 v111, s24, v6
    v_readlane_b32 s24, v4, 6
    s_waitcnt vmcnt(1)
    v_lshlrev_b32 v5, 16, v96
    v_and_b32 v6, 0xffff0000, v96
    v_fmac_f32 v104, s24, v5
    v_fmac_f32 v105, s24, v6
    v_lshlrev_b32 v5, 16, v97
    v_and_b32 v6, 0xffff0000, v97
    v_fmac_f32 v106, s24, v5
    v_fmac_f32 v107, s24, v6
    v_lshlrev_b32 v5, 16, v98
    v_and_b32 v6, 0xffff0000, v98
    v_fmac_f32 v108, s24, v5
    v_fmac_f32 v109, s24, v6
    v_lshlrev_b32 v5, 16, v99
    v_and_b32 v6, 0xffff0000, v99
    v_fmac_f32 v110, s24, v5
    v_fmac_f32 v111, s24, v6
    v_readlane_b32 s24, v4, 7
    s_waitcnt vmcnt(0)
    v_lshlrev_b32 v5, 16, v100
    v_and_b32 v6, 0xffff0000, v100
    v_fmac_f32 v104, s24, v5
    v_fmac_f32 v105, s24, v6
    v_lshlrev_b32 v5, 16, v101
    v_and_b32 v6, 0xffff0000, v101
    v_fmac_f32 v106, s24, v5
    v_fmac_f32 v107, s24, v6
    v_lshlrev_b32 v5, 16, v102
    v_and_b32 v6, 0xffff0000, v102
    v_fmac_f32 v108, s24, v5
    v_fmac_f32 v109, s24, v6
    v_lshlrev_b32 v5, 16, v103
    v_and_b32 v6, 0xffff0000, v103
    v_fmac_f32 v110, s24, v5
    v_fmac_f32 v111, s24, v6
    v_cvt_pk_bf16_f32 v4, v104, v105
    v_cvt_pk_bf16_f32 v5, v106, v107
    v_cvt_pk_bf16_f32 v6, v108, v109
    v_cvt_pk_bf16_f32 v7, v110, v111
    s_lshl_b32 s24, s3, 10
    s_add_u32 s24, s24, 145408
    v_add_u32 v3, s24, v2
    ds_write_b128 v3, v[4:7]
    s_lshl_b32 s24, s3, 8
    s_add_u32 s24, s24, 145408
    v_add_u32 v3, s24, v19
    s_waitcnt lgkmcnt(0)
    s_barrier
    ds_read_b128 v[32:35], v3 offset:0
    ds_read_b128 v[36:39], v3 offset:16
    ds_read_b128 v[40:43], v3 offset:32
    ds_read_b128 v[44:47], v3 offset:48
    ds_read_b128 v[48:51], v3 offset:2048
    ds_read_b128 v[52:55], v3 offset:2064
    ds_read_b128 v[56:59], v3 offset:2080
    ds_read_b128 v[60:63], v3 offset:2096
    s_waitcnt lgkmcnt(0)
    v_perm_b32 v8, v32, v32, v24
    v_perm_b32 v9, v32, v32, v25
    v_perm_b32 v10, v32, v32, v26
    v_perm_b32 v11, v32, v32, v27
    v_perm_b32 v4, v48, v48, v24
    v_perm_b32 v5, v48, v48, v25
    v_perm_b32 v6, v48, v48, v26
    v_perm_b32 v7, v48, v48, v27
    v_mfma_f32_16x16x32_bf16 v[12:15], v[128:131], v[8:11], 0
    s_nop 0
    v_mfma_f32_16x16x32_bf16 v[68:71], v[128:131], v[4:7], 0
    v_perm_b32 v8, v32, v32, v28
    v_perm_b32 v9, v32, v32, v29
    v_perm_b32 v10, v32, v32, v30
    v_perm_b32 v11, v32, v32, v31
    v_perm_b32 v4, v48, v48, v28
    v_perm_b32 v5, v48, v48, v29
    v_perm_b32 v6, v48, v48, v30
    v_perm_b32 v7, v48, v48, v31
    v_mfma_f32_16x16x32_bf16 v[12:15], v[132:135], v[8:11], v[12:15]
    s_nop 0
    v_mfma_f32_16x16x32_bf16 v[68:71], v[132:135], v[4:7], v[68:71]
    v_perm_b32 v8, v33, v33, v24
    v_perm_b32 v9, v33, v33, v25
    v_perm_b32 v10, v33, v33, v26
    v_perm_b32 v11, v33, v33, v27
    v_perm_b32 v4, v49, v49, v24
    v_perm_b32 v5, v49, v49, v25
    v_perm_b32 v6, v49, v49, v26
    v_perm_b32 v7, v49, v49, v27
    v_mfma_f32_16x16x32_bf16 v[12:15], v[136:139], v[8:11], v[12:15]
    s_nop 0
    v_mfma_f32_16x16x32_bf16 v[68:71], v[136:139], v[4:7], v[68:71]
    v_perm_b32 v8, v33, v33, v28
    v_perm_b32 v9, v33, v33, v29
    v_perm_b32 v10, v33, v33, v30
    v_perm_b32 v11, v33, v33, v31
    v_perm_b32 v4, v49, v49, v28
    v_perm_b32 v5, v49, v49, v29
    v_perm_b32 v6, v49, v49, v30
    v_perm_b32 v7, v49, v49, v31
    v_mfma_f32_16x16x32_bf16 v[12:15], v[140:143], v[8:11], v[12:15]
    s_nop 0
    v_mfma_f32_16x16x32_bf16 v[68:71], v[140:143], v[4:7], v[68:71]
    v_perm_b32 v8, v34, v34, v24
    v_perm_b32 v9, v34, v34, v25
    v_perm_b32 v10, v34, v34, v26
    v_perm_b32 v11, v34, v34, v27
    v_perm_b32 v4, v50, v50, v24
    v_perm_b32 v5, v50, v50, v25
    v_perm_b32 v6, v50, v50, v26
    v_perm_b32 v7, v50, v50, v27
    v_mfma_f32_16x16x32_bf16 v[12:15], v[144:147], v[8:11], v[12:15]
    s_nop 0
    v_mfma_f32_16x16x32_bf16 v[68:71], v[144:147], v[4:7], v[68:71]
    v_perm_b32 v8, v34, v34, v28
    v_perm_b32 v9, v34, v34, v29
    v_perm_b32 v10, v34, v34, v30
    v_perm_b32 v11, v34, v34, v31
    v_perm_b32 v4, v50, v50, v28
    v_perm_b32 v5, v50, v50, v29
    v_perm_b32 v6, v50, v50, v30
    v_perm_b32 v7, v50, v50, v31
    v_mfma_f32_16x16x32_bf16 v[12:15], v[148:151], v[8:11], v[12:15]
    s_nop 0
    v_mfma_f32_16x16x32_bf16 v[68:71], v[148:151], v[4:7], v[68:71]
    v_perm_b32 v8, v35, v35, v24
    v_perm_b32 v9, v35, v35, v25
    v_perm_b32 v10, v35, v35, v26
    v_perm_b32 v11, v35, v35, v27
    v_perm_b32 v4, v51, v51, v24
    v_perm_b32 v5, v51, v51, v25
    v_perm_b32 v6, v51, v51, v26
    v_perm_b32 v7, v51, v51, v27
    v_mfma_f32_16x16x32_bf16 v[12:15], v[152:155], v[8:11], v[12:15]
    s_nop 0
    v_mfma_f32_16x16x32_bf16 v[68:71], v[152:155], v[4:7], v[68:71]
    v_perm_b32 v8, v35, v35, v28
    v_perm_b32 v9, v35, v35, v29
    v_perm_b32 v10, v35, v35, v30
    v_perm_b32 v11, v35, v35, v31
    v_perm_b32 v4, v51, v51, v28
    v_perm_b32 v5, v51, v51, v29
    v_perm_b32 v6, v51, v51, v30
    v_perm_b32 v7, v51, v51, v31
    v_mfma_f32_16x16x32_bf16 v[12:15], v[156:159], v[8:11], v[12:15]
    s_nop 0
    v_mfma_f32_16x16x32_bf16 v[68:71], v[156:159], v[4:7], v[68:71]
    v_perm_b32 v8, v36, v36, v24
    v_perm_b32 v9, v36, v36, v25
    v_perm_b32 v10, v36, v36, v26
    v_perm_b32 v11, v36, v36, v27
    v_perm_b32 v4, v52, v52, v24
    v_perm_b32 v5, v52, v52, v25
    v_perm_b32 v6, v52, v52, v26
    v_perm_b32 v7, v52, v52, v27
    v_mfma_f32_16x16x32_bf16 v[12:15], v[160:163], v[8:11], v[12:15]
    s_nop 0
    v_mfma_f32_16x16x32_bf16 v[68:71], v[160:163], v[4:7], v[68:71]
    v_perm_b32 v8, v36, v36, v28
    v_perm_b32 v9, v36, v36, v29
    v_perm_b32 v10, v36, v36, v30
    v_perm_b32 v11, v36, v36, v31
    v_perm_b32 v4, v52, v52, v28
    v_perm_b32 v5, v52, v52, v29
    v_perm_b32 v6, v52, v52, v30
    v_perm_b32 v7, v52, v52, v31
    v_mfma_f32_16x16x32_bf16 v[12:15], v[164:167], v[8:11], v[12:15]
    s_nop 0
    v_mfma_f32_16x16x32_bf16 v[68:71], v[164:167], v[4:7], v[68:71]
    v_perm_b32 v8, v37, v37, v24
    v_perm_b32 v9, v37, v37, v25
    v_perm_b32 v10, v37, v37, v26
    v_perm_b32 v11, v37, v37, v27
    v_perm_b32 v4, v53, v53, v24
    v_perm_b32 v5, v53, v53, v25
    v_perm_b32 v6, v53, v53, v26
    v_perm_b32 v7, v53, v53, v27
    v_mfma_f32_16x16x32_bf16 v[12:15], v[168:171], v[8:11], v[12:15]
    s_nop 0
    v_mfma_f32_16x16x32_bf16 v[68:71], v[168:171], v[4:7], v[68:71]
    v_perm_b32 v8, v37, v37, v28
    v_perm_b32 v9, v37, v37, v29
    v_perm_b32 v10, v37, v37, v30
    v_perm_b32 v11, v37, v37, v31
    v_perm_b32 v4, v53, v53, v28
    v_perm_b32 v5, v53, v53, v29
    v_perm_b32 v6, v53, v53, v30
    v_perm_b32 v7, v53, v53, v31
    v_mfma_f32_16x16x32_bf16 v[12:15], v[172:175], v[8:11], v[12:15]
    s_nop 0
    v_mfma_f32_16x16x32_bf16 v[68:71], v[172:175], v[4:7], v[68:71]
    v_perm_b32 v8, v38, v38, v24
    v_perm_b32 v9, v38, v38, v25
    v_perm_b32 v10, v38, v38, v26
    v_perm_b32 v11, v38, v38, v27
    v_perm_b32 v4, v54, v54, v24
    v_perm_b32 v5, v54, v54, v25
    v_perm_b32 v6, v54, v54, v26
    v_perm_b32 v7, v54, v54, v27
    v_mfma_f32_16x16x32_bf16 v[12:15], v[176:179], v[8:11], v[12:15]
    s_nop 0
    v_mfma_f32_16x16x32_bf16 v[68:71], v[176:179], v[4:7], v[68:71]
    v_perm_b32 v8, v38, v38, v28
    v_perm_b32 v9, v38, v38, v29
    v_perm_b32 v10, v38, v38, v30
    v_perm_b32 v11, v38, v38, v31
    v_perm_b32 v4, v54, v54, v28
    v_perm_b32 v5, v54, v54, v29
    v_perm_b32 v6, v54, v54, v30
    v_perm_b32 v7, v54, v54, v31
    v_mfma_f32_16x16x32_bf16 v[12:15], v[180:183], v[8:11], v[12:15]
    s_nop 0
    v_mfma_f32_16x16x32_bf16 v[68:71], v[180:183], v[4:7], v[68:71]
    v_perm_b32 v8, v39, v39, v24
    v_perm_b32 v9, v39, v39, v25
    v_perm_b32 v10, v39, v39, v26
    v_perm_b32 v11, v39, v39, v27
    v_perm_b32 v4, v55, v55, v24
    v_perm_b32 v5, v55, v55, v25
    v_perm_b32 v6, v55, v55, v26
    v_perm_b32 v7, v55, v55, v27
    v_mfma_f32_16x16x32_bf16 v[12:15], v[184:187], v[8:11], v[12:15]
    s_nop 0
    v_mfma_f32_16x16x32_bf16 v[68:71], v[184:187], v[4:7], v[68:71]
    v_perm_b32 v8, v39, v39, v28
    v_perm_b32 v9, v39, v39, v29
    v_perm_b32 v10, v39, v39, v30
    v_perm_b32 v11, v39, v39, v31
    v_perm_b32 v4, v55, v55, v28
    v_perm_b32 v5, v55, v55, v29
    v_perm_b32 v6, v55, v55, v30
    v_perm_b32 v7, v55, v55, v31
    v_mfma_f32_16x16x32_bf16 v[12:15], v[188:191], v[8:11], v[12:15]
    s_nop 0
    v_mfma_f32_16x16x32_bf16 v[68:71], v[188:191], v[4:7], v[68:71]
    v_perm_b32 v8, v40, v40, v24
    v_perm_b32 v9, v40, v40, v25
    v_perm_b32 v10, v40, v40, v26
    v_perm_b32 v11, v40, v40, v27
    v_perm_b32 v4, v56, v56, v24
    v_perm_b32 v5, v56, v56, v25
    v_perm_b32 v6, v56, v56, v26
    v_perm_b32 v7, v56, v56, v27
    v_mfma_f32_16x16x32_bf16 v[12:15], v[192:195], v[8:11], v[12:15]
    s_nop 0
    v_mfma_f32_16x16x32_bf16 v[68:71], v[192:195], v[4:7], v[68:71]
    v_perm_b32 v8, v40, v40, v28
    v_perm_b32 v9, v40, v40, v29
    v_perm_b32 v10, v40, v40, v30
    v_perm_b32 v11, v40, v40, v31
    v_perm_b32 v4, v56, v56, v28
    v_perm_b32 v5, v56, v56, v29
    v_perm_b32 v6, v56, v56, v30
    v_perm_b32 v7, v56, v56, v31
    v_mfma_f32_16x16x32_bf16 v[12:15], v[196:199], v[8:11], v[12:15]
    s_nop 0
    v_mfma_f32_16x16x32_bf16 v[68:71], v[196:199], v[4:7], v[68:71]
    v_perm_b32 v8, v41, v41, v24
    v_perm_b32 v9, v41, v41, v25
    v_perm_b32 v10, v41, v41, v26
    v_perm_b32 v11, v41, v41, v27
    v_perm_b32 v4, v57, v57, v24
    v_perm_b32 v5, v57, v57, v25
    v_perm_b32 v6, v57, v57, v26
    v_perm_b32 v7, v57, v57, v27
    v_mfma_f32_16x16x32_bf16 v[12:15], v[200:203], v[8:11], v[12:15]
    s_nop 0
    v_mfma_f32_16x16x32_bf16 v[68:71], v[200:203], v[4:7], v[68:71]
    v_perm_b32 v8, v41, v41, v28
    v_perm_b32 v9, v41, v41, v29
    v_perm_b32 v10, v41, v41, v30
    v_perm_b32 v11, v41, v41, v31
    v_perm_b32 v4, v57, v57, v28
    v_perm_b32 v5, v57, v57, v29
    v_perm_b32 v6, v57, v57, v30
    v_perm_b32 v7, v57, v57, v31
    v_mfma_f32_16x16x32_bf16 v[12:15], v[204:207], v[8:11], v[12:15]
    s_nop 0
    v_mfma_f32_16x16x32_bf16 v[68:71], v[204:207], v[4:7], v[68:71]
    v_perm_b32 v8, v42, v42, v24
    v_perm_b32 v9, v42, v42, v25
    v_perm_b32 v10, v42, v42, v26
    v_perm_b32 v11, v42, v42, v27
    v_perm_b32 v4, v58, v58, v24
    v_perm_b32 v5, v58, v58, v25
    v_perm_b32 v6, v58, v58, v26
    v_perm_b32 v7, v58, v58, v27
    v_mfma_f32_16x16x32_bf16 v[12:15], v[208:211], v[8:11], v[12:15]
    s_nop 0
    v_mfma_f32_16x16x32_bf16 v[68:71], v[208:211], v[4:7], v[68:71]
    v_perm_b32 v8, v42, v42, v28
    v_perm_b32 v9, v42, v42, v29
    v_perm_b32 v10, v42, v42, v30
    v_perm_b32 v11, v42, v42, v31
    v_perm_b32 v4, v58, v58, v28
    v_perm_b32 v5, v58, v58, v29
    v_perm_b32 v6, v58, v58, v30
    v_perm_b32 v7, v58, v58, v31
    v_mfma_f32_16x16x32_bf16 v[12:15], v[212:215], v[8:11], v[12:15]
    s_nop 0
    v_mfma_f32_16x16x32_bf16 v[68:71], v[212:215], v[4:7], v[68:71]
    v_perm_b32 v8, v43, v43, v24
    v_perm_b32 v9, v43, v43, v25
    v_perm_b32 v10, v43, v43, v26
    v_perm_b32 v11, v43, v43, v27
    v_perm_b32 v4, v59, v59, v24
    v_perm_b32 v5, v59, v59, v25
    v_perm_b32 v6, v59, v59, v26
    v_perm_b32 v7, v59, v59, v27
    v_mfma_f32_16x16x32_bf16 v[12:15], v[216:219], v[8:11], v[12:15]
    s_nop 0
    v_mfma_f32_16x16x32_bf16 v[68:71], v[216:219], v[4:7], v[68:71]
    v_perm_b32 v8, v43, v43, v28
    v_perm_b32 v9, v43, v43, v29
    v_perm_b32 v10, v43, v43, v30
    v_perm_b32 v11, v43, v43, v31
    v_perm_b32 v4, v59, v59, v28
    v_perm_b32 v5, v59, v59, v29
    v_perm_b32 v6, v59, v59, v30
    v_perm_b32 v7, v59, v59, v31
    v_mfma_f32_16x16x32_bf16 v[12:15], v[220:223], v[8:11], v[12:15]
    s_nop 0
    v_mfma_f32_16x16x32_bf16 v[68:71], v[220:223], v[4:7], v[68:71]
    v_perm_b32 v8, v44, v44, v24
    v_perm_b32 v9, v44, v44, v25
    v_perm_b32 v10, v44, v44, v26
    v_perm_b32 v11, v44, v44, v27
    v_perm_b32 v4, v60, v60, v24
    v_perm_b32 v5, v60, v60, v25
    v_perm_b32 v6, v60, v60, v26
    v_perm_b32 v7, v60, v60, v27
    v_mfma_f32_16x16x32_bf16 v[12:15], v[224:227], v[8:11], v[12:15]
    s_nop 0
    v_mfma_f32_16x16x32_bf16 v[68:71], v[224:227], v[4:7], v[68:71]
    v_perm_b32 v8, v44, v44, v28
    v_perm_b32 v9, v44, v44, v29
    v_perm_b32 v10, v44, v44, v30
    v_perm_b32 v11, v44, v44, v31
    v_perm_b32 v4, v60, v60, v28
    v_perm_b32 v5, v60, v60, v29
    v_perm_b32 v6, v60, v60, v30
    v_perm_b32 v7, v60, v60, v31
    v_mfma_f32_16x16x32_bf16 v[12:15], v[228:231], v[8:11], v[12:15]
    s_nop 0
    v_mfma_f32_16x16x32_bf16 v[68:71], v[228:231], v[4:7], v[68:71]
    v_perm_b32 v8, v45, v45, v24
    v_perm_b32 v9, v45, v45, v25
    v_perm_b32 v10, v45, v45, v26
    v_perm_b32 v11, v45, v45, v27
    v_perm_b32 v4, v61, v61, v24
    v_perm_b32 v5, v61, v61, v25
    v_perm_b32 v6, v61, v61, v26
    v_perm_b32 v7, v61, v61, v27
    v_mfma_f32_16x16x32_bf16 v[12:15], v[232:235], v[8:11], v[12:15]
    s_nop 0
    v_mfma_f32_16x16x32_bf16 v[68:71], v[232:235], v[4:7], v[68:71]
    v_perm_b32 v8, v45, v45, v28
    v_perm_b32 v9, v45, v45, v29
    v_perm_b32 v10, v45, v45, v30
    v_perm_b32 v11, v45, v45, v31
    v_perm_b32 v4, v61, v61, v28
    v_perm_b32 v5, v61, v61, v29
    v_perm_b32 v6, v61, v61, v30
    v_perm_b32 v7, v61, v61, v31
    v_mfma_f32_16x16x32_bf16 v[12:15], v[236:239], v[8:11], v[12:15]
    s_nop 0
    v_mfma_f32_16x16x32_bf16 v[68:71], v[236:239], v[4:7], v[68:71]
    v_perm_b32 v8, v46, v46, v24
    v_perm_b32 v9, v46, v46, v25
    v_perm_b32 v10, v46, v46, v26
    v_perm_b32 v11, v46, v46, v27
    v_perm_b32 v4, v62, v62, v24
    v_perm_b32 v5, v62, v62, v25
    v_perm_b32 v6, v62, v62, v26
    v_perm_b32 v7, v62, v62, v27
    v_mfma_f32_16x16x32_bf16 v[12:15], v[240:243], v[8:11], v[12:15]
    s_nop 0
    v_mfma_f32_16x16x32_bf16 v[68:71], v[240:243], v[4:7], v[68:71]
    v_perm_b32 v8, v46, v46, v28
    v_perm_b32 v9, v46, v46, v29
    v_perm_b32 v10, v46, v46, v30
    v_perm_b32 v11, v46, v46, v31
    v_perm_b32 v4, v62, v62, v28
    v_perm_b32 v5, v62, v62, v29
    v_perm_b32 v6, v62, v62, v30
    v_perm_b32 v7, v62, v62, v31
    v_mfma_f32_16x16x32_bf16 v[12:15], v[244:247], v[8:11], v[12:15]
    s_nop 0
    v_mfma_f32_16x16x32_bf16 v[68:71], v[244:247], v[4:7], v[68:71]
    v_perm_b32 v8, v47, v47, v24
    v_perm_b32 v9, v47, v47, v25
    v_perm_b32 v10, v47, v47, v26
    v_perm_b32 v11, v47, v47, v27
    v_perm_b32 v4, v63, v63, v24
    v_perm_b32 v5, v63, v63, v25
    v_perm_b32 v6, v63, v63, v26
    v_perm_b32 v7, v63, v63, v27
    v_mfma_f32_16x16x32_bf16 v[12:15], v[248:251], v[8:11], v[12:15]
    s_nop 0
    v_mfma_f32_16x16x32_bf16 v[68:71], v[248:251], v[4:7], v[68:71]
    v_perm_b32 v8, v47, v47, v28
    v_perm_b32 v9, v47, v47, v29
    v_perm_b32 v10, v47, v47, v30
    v_perm_b32 v11, v47, v47, v31
    v_perm_b32 v4, v63, v63, v28
    v_perm_b32 v5, v63, v63, v29
    v_perm_b32 v6, v63, v63, v30
    v_perm_b32 v7, v63, v63, v31
    v_mfma_f32_16x16x32_bf16 v[12:15], v[252:255], v[8:11], v[12:15]
    s_nop 0
    v_mfma_f32_16x16x32_bf16 v[68:71], v[252:255], v[4:7], v[68:71]
    v_lshrrev_b32 v3, 4, v0
    v_lshlrev_b32 v3, 7, v3
    v_and_b32 v4, 7, v0
    v_lshl_add_u32 v3, v4, 4, v3
    v_bfe_u32 v4, v0, 3, 1
    v_lshl_add_u32 v3, v4, 9, v3
    s_lshl_b32 s24, s3, 11
    s_add_u32 s24, s24, 135168
    v_add_u32 v3, s24, v3
    ds_write_b128 v3, v[12:15]
    ds_write_b128 v3, v[68:71] offset:1024
    s_waitcnt lgkmcnt(0)
    s_barrier
    v_and_b32 v5, 31, v0
    s_lshl_b32 s24, s3, 9
    s_add_u32 s24, s24, 135168
    v_lshl_add_u32 v3, v5, 4, s24
    ds_read_b128 v[72:75], v3 offset:0
    ds_read_b128 v[76:79], v3 offset:2048
    ds_read_b128 v[80:83], v3 offset:4096
    ds_read_b128 v[84:87], v3 offset:6144
    s_lshl_b32 s24, s3, 8
    s_add_u32 s24, s24, 143360
    v_lshl_add_u32 v5, v5, 3, s24
    s_waitcnt lgkmcnt(0)
    v_add_f32 v72, v72, v76
    v_add_f32 v73, v73, v77
    v_add_f32 v74, v74, v78
    v_add_f32 v75, v75, v79
    v_add_f32 v72, v72, v80
    v_add_f32 v73, v73, v81
    v_add_f32 v74, v74, v82
    v_add_f32 v75, v75, v83
    v_add_f32 v72, v72, v84
    v_add_f32 v73, v73, v85
    v_add_f32 v74, v74, v86
    v_add_f32 v75, v75, v87
    v_cvt_pk_bf16_f32 v6, v72, v73
    v_cvt_pk_bf16_f32 v7, v74, v75
    ds_write_b64 v5, v[6:7]
    v_lshrrev_b32 v3, 4, v0
    v_and_b32 v4, 3, v0
    v_lshlrev_b32 v5, 8, v4
    v_lshl_add_u32 v5, v3, 4, v5
    v_add_u32 v5, 143360, v5
    s_waitcnt lgkmcnt(0)
    s_barrier
    ds_read_b128 v[32:35], v5 offset:0
    ds_read_b128 v[36:39], v5 offset:64
    ds_read_b128 v[40:43], v5 offset:128
    ds_read_b128 v[44:47], v5 offset:192
    s_waitcnt lgkmcnt(3)
    v_mfma_f32_16x16x32_bf16 v[72:75], v[32:35], a[0:3], 0
    s_waitcnt lgkmcnt(2)
    v_mfma_f32_16x16x32_bf16 v[72:75], v[36:39], a[4:7], v[72:75]
    s_waitcnt lgkmcnt(1)
    v_mfma_f32_16x16x32_bf16 v[72:75], v[40:43], a[8:11], v[72:75]
    s_waitcnt lgkmcnt(0)
    v_mfma_f32_16x16x32_bf16 v[72:75], v[44:47], a[12:15], v[72:75]
    v_mfma_f32_16x16x32_bf16 v[76:79], v[32:35], a[16:19], 0
    v_mfma_f32_16x16x32_bf16 v[76:79], v[36:39], a[20:23], v[76:79]
    v_mfma_f32_16x16x32_bf16 v[76:79], v[40:43], a[24:27], v[76:79]
    v_mfma_f32_16x16x32_bf16 v[76:79], v[44:47], a[28:31], v[76:79]
    v_mfma_f32_16x16x32_bf16 v[80:83], v[32:35], a[32:35], 0
    v_mfma_f32_16x16x32_bf16 v[80:83], v[36:39], a[36:39], v[80:83]
    v_mfma_f32_16x16x32_bf16 v[80:83], v[40:43], a[40:43], v[80:83]
    v_mfma_f32_16x16x32_bf16 v[80:83], v[44:47], a[44:47], v[80:83]
    v_mov_b32_dpp v4, v72 quad_perm:[0,1,2,3] row_mask:0x1 bank_mask:0xf
    v_mov_b32_dpp v5, v73 quad_perm:[0,1,2,3] row_mask:0x1 bank_mask:0xf
    v_mov_b32_dpp v6, v74 quad_perm:[0,1,2,3] row_mask:0x1 bank_mask:0xf
    v_mov_b32_dpp v7, v75 quad_perm:[0,1,2,3] row_mask:0x1 bank_mask:0xf
    v_mfma_f32_16x16x32_bf16 v[84:87], v[32:35], a[48:51], 0
    v_mfma_f32_16x16x32_bf16 v[84:87], v[36:39], a[52:55], v[84:87]
    v_mfma_f32_16x16x32_bf16 v[84:87], v[40:43], a[56:59], v[84:87]
    v_mfma_f32_16x16x32_bf16 v[84:87], v[44:47], a[60:63], v[84:87]
    v_mov_b32_dpp v4, v76 quad_perm:[0,1,2,3] row_mask:0x2 bank_mask:0xf
    v_mov_b32_dpp v5, v77 quad_perm:[0,1,2,3] row_mask:0x2 bank_mask:0xf
    v_mov_b32_dpp v6, v78 quad_perm:[0,1,2,3] row_mask:0x2 bank_mask:0xf
    v_mov_b32_dpp v7, v79 quad_perm:[0,1,2,3] row_mask:0x2 bank_mask:0xf
    v_mfma_f32_16x16x32_bf16 v[88:91], v[32:35], a[64:67], 0
    v_mfma_f32_16x16x32_bf16 v[88:91], v[36:39], a[68:71], v[88:91]
    v_mfma_f32_16x16x32_bf16 v[88:91], v[40:43], a[72:75], v[88:91]
    v_mfma_f32_16x16x32_bf16 v[88:91], v[44:47], a[76:79], v[88:91]
    v_mov_b32_dpp v4, v80 quad_perm:[0,1,2,3] row_mask:0x4 bank_mask:0xf
    v_mov_b32_dpp v5, v81 quad_perm:[0,1,2,3] row_mask:0x4 bank_mask:0xf
    v_mov_b32_dpp v6, v82 quad_perm:[0,1,2,3] row_mask:0x4 bank_mask:0xf
    v_mov_b32_dpp v7, v83 quad_perm:[0,1,2,3] row_mask:0x4 bank_mask:0xf
    v_mfma_f32_16x16x32_bf16 v[92:95], v[32:35], a[80:83], 0
    v_mfma_f32_16x16x32_bf16 v[92:95], v[36:39], a[84:87], v[92:95]
    v_mfma_f32_16x16x32_bf16 v[92:95], v[40:43], a[88:91], v[92:95]
    v_mfma_f32_16x16x32_bf16 v[92:95], v[44:47], a[92:95], v[92:95]
    v_mov_b32_dpp v4, v84 quad_perm:[0,1,2,3] row_mask:0x8 bank_mask:0xf
    v_mov_b32_dpp v5, v85 quad_perm:[0,1,2,3] row_mask:0x8 bank_mask:0xf
    v_mov_b32_dpp v6, v86 quad_perm:[0,1,2,3] row_mask:0x8 bank_mask:0xf
    v_mov_b32_dpp v7, v87 quad_perm:[0,1,2,3] row_mask:0x8 bank_mask:0xf
    v_mfma_f32_16x16x32_bf16 v[96:99], v[32:35], a[96:99], 0
    v_mfma_f32_16x16x32_bf16 v[96:99], v[36:39], a[100:103], v[96:99]
    v_mfma_f32_16x16x32_bf16 v[96:99], v[40:43], a[104:107], v[96:99]
    v_mfma_f32_16x16x32_bf16 v[96:99], v[44:47], a[108:111], v[96:99]
    v_mov_b32_dpp v8, v88 quad_perm:[0,1,2,3] row_mask:0x1 bank_mask:0xf
    v_mov_b32_dpp v9, v89 quad_perm:[0,1,2,3] row_mask:0x1 bank_mask:0xf
    v_mov_b32_dpp v10, v90 quad_perm:[0,1,2,3] row_mask:0x1 bank_mask:0xf
    v_mov_b32_dpp v11, v91 quad_perm:[0,1,2,3] row_mask:0x1 bank_mask:0xf
    v_mfma_f32_16x16x32_bf16 v[100:103], v[32:35], a[112:115], 0
    v_mfma_f32_16x16x32_bf16 v[100:103], v[36:39], a[116:119], v[100:103]
    v_mfma_f32_16x16x32_bf16 v[100:103], v[40:43], a[120:123], v[100:103]
    v_mfma_f32_16x16x32_bf16 v[100:103], v[44:47], a[124:127], v[100:103]
    v_mov_b32_dpp v8, v92 quad_perm:[0,1,2,3] row_mask:0x2 bank_mask:0xf
    v_mov_b32_dpp v9, v93 quad_perm:[0,1,2,3] row_mask:0x2 bank_mask:0xf
    v_mov_b32_dpp v10, v94 quad_perm:[0,1,2,3] row_mask:0x2 bank_mask:0xf
    v_mov_b32_dpp v11, v95 quad_perm:[0,1,2,3] row_mask:0x2 bank_mask:0xf
    v_mov_b32_dpp v8, v96 quad_perm:[0,1,2,3] row_mask:0x4 bank_mask:0xf
    v_mov_b32_dpp v9, v97 quad_perm:[0,1,2,3] row_mask:0x4 bank_mask:0xf
    v_mov_b32_dpp v10, v98 quad_perm:[0,1,2,3] row_mask:0x4 bank_mask:0xf
    v_mov_b32_dpp v11, v99 quad_perm:[0,1,2,3] row_mask:0x4 bank_mask:0xf
    v_mov_b32_dpp v8, v100 quad_perm:[0,1,2,3] row_mask:0x8 bank_mask:0xf
    v_mov_b32_dpp v9, v101 quad_perm:[0,1,2,3] row_mask:0x8 bank_mask:0xf
    v_mov_b32_dpp v10, v102 quad_perm:[0,1,2,3] row_mask:0x8 bank_mask:0xf
    v_mov_b32_dpp v11, v103 quad_perm:[0,1,2,3] row_mask:0x8 bank_mask:0xf
    s_lshl_b32 s24, s26, 13
    s_lshl_b32 s25, s3, 11
    s_add_u32 s24, s24, s25
    s_add_u32 s24, s24, 0x124000
    buffer_store_dwordx4 v[4:7], v2, s[12:15], s24 offen sc1
    buffer_store_dwordx4 v[8:11], v2, s[12:15], s24 offen offset:1024 sc1
    s_waitcnt vmcnt(0)
    s_barrier
    s_cmp_lg_u32 s3, 0
    s_cbranch_scc1 L_sig11
    s_mov_b64 exec, 1
    v_mov_b32 v3, 1
    buffer_atomic_add v3, off, s[16:19], 0 offset:8 sc0
    s_waitcnt vmcnt(0)
    v_readfirstlane_b32 s24, v3
    s_mov_b64 exec, -1
    s_and_b32 s24, s24, 31
    s_cmp_lg_u32 s24, 31
    s_cbranch_scc1 L_sig11
    v_lshlrev_b32 v4, 7, v0
    v_mov_b32 v3, 1
    s_mov_b32 s24, 0x170000
    buffer_store_dword v3, v4, s[12:15], s24 offen offset:8 sc1
L_sig11:
L_R:
    s_mov_b32 s20, s58
    s_mov_b32 s21, s59
    s_mov_b32 s22, 0x2000
    s_mov_b32 s23, 0x20000
    v_and_b32 v3, 1, v0
    v_lshlrev_b32 v3, 4, v3
    v_mov_b32 v4, 0xffff
    v_lshlrev_b32 v4, v3, v4
    v_bfe_u32 v3, v0, 1, 2
    v_cmp_eq_u32 vcc, 0, v3
    s_nop 1
    v_cndmask_b32 v20, 0, v4, vcc
    v_cmp_eq_u32 vcc, 1, v3
    s_nop 1
    v_cndmask_b32 v21, 0, v4, vcc
    v_cmp_eq_u32 vcc, 2, v3
    s_nop 1
    v_cndmask_b32 v22, 0, v4, vcc
    v_cmp_eq_u32 vcc, 3, v3
    s_nop 1
    v_cndmask_b32 v23, 0, v4, vcc
    v_lshrrev_b32 v3, 4, v0
    v_and_b32 v4, 7, v0
    v_lshl_add_u32 v5, v3, 3, v4
    v_lshlrev_b32 v27, 4, v5
    v_add_u32 v27, 144384, v27
    s_lshl_b32 s24, s3, 2
    v_add_u32 v26, s24, v27
    s_lshl_b32 s24, s3, 8
    s_add_u32 s24, s24, 143360
    v_lshl_add_u32 v24, v5, 3, s24
    s_and_b32 s30, s74, 7
    s_lshl_b32 s30, s30, 3
    s_lshr_b32 s24, s74, 3
    s_or_b32 s30, s30, s24
    v_lshlrev_b32 v28, 11, v3
    v_lshl_add_u32 v28, v4, 1, v28
    s_lshl_b32 s24, s30, 4
    v_add_u32 v28, s24, v28
    v_lshrrev_b32 v5, 3, v0
    s_lshl_b32 s24, s3, 3
    v_add_u32 v5, s24, v5
    v_lshlrev_b32 v5, 13, v5
    v_lshl_add_u32 v30, v4, 4, v5
    v_and_b32 v5, 3, v0
    v_lshlrev_b32 v25, 8, v5
    v_lshl_add_u32 v25, v3, 4, v25
    v_add_u32 v25, 143360, v25
    v_and_b32 v29, 0x1ff, v2
    v_min_u32 v6, 5, v4
    v_lshrrev_b32 v5, 1, v6
    v_lshlrev_b32 v31, 10, v5
    v_and_b32 v6, 1, v6
    v_lshl_add_u32 v31, v6, 4, v31
    s_cmp_lg_u32 s3, 0
    s_cbranch_scc1 L_awx12
    s_mov_b32 s24, 262144
    s_mov_b64 exec, 1
L_aw13:
    buffer_load_dword v1, off, s[12:15], s73 offset:8 sc1
    s_waitcnt vmcnt(0)
    v_readfirstlane_b32 s25, v1
    s_nop 0
    s_cmp_eq_u32 s25, 1
    s_cbranch_scc1 L_awx12
    s_sleep 4
    s_sub_u32 s24, s24, 1
    s_cmp_lg_u32 s24, 0
    s_cbranch_scc1 L_aw13
L_awx12:
    s_mov_b64 exec, -1
    s_barrier
    s_lshl_b32 s30, s30, 7
    s_add_u32 s24, s30, 0x124000
    buffer_load_dwordx4 v[4:7], v30, s[12:15], s24 offen sc1
    s_waitcnt vmcnt(0)
    v_permlane32_swap_b32 v4, v6
    v_permlane32_swap_b32 v5, v7
    v_add_f32 v4, v4, v6
    v_add_f32 v5, v5, v7
    s_nop 1
    v_permlane16_swap_b32 v4, v5
    v_add_f32 v4, v4, v5
    s_nop 1
    v_add_f32_dpp v4, v4, v4 row_ror:8 row_mask:0xf bank_mask:0xf
    ds_write_b32 v26, v4 offset:0
    s_waitcnt lgkmcnt(0)
    s_barrier
    s_cmp_lg_u32 s3, 0
    s_cbranch_scc1 L_fr14
    ds_read_b128 v[4:7], v27 offset:0
    s_waitcnt lgkmcnt(0)
    v_add_f32 v4, v4, v5
    v_add_f32 v6, v6, v7
    v_add_f32 v4, v4, v6
    v_cvt_pk_bf16_f32 v4, v4, v4
    buffer_store_short v4, v28, s[20:23], 0 offen offset:0
L_fr14:
    s_lshl_b32 s33, s26, 2
    s_add_u32 s33, s33, s3
    s_and_b32 s35, s72, 7
    s_lshl_b32 s35, s35, 7
    s_add_u32 s35, s35, 0x1b0000
    s_lshr_b32 s34, s72, 3
    s_mul_i32 s34, s34, 6
    s_lshr_b32 s24, s3, 1
    s_mul_i32 s24, s24, 3
    s_add_u32 s24, s24, s34
    s_lshl_b32 s29, s24, 10
    s_add_u32 s29, s29, s35
    s_and_b32 s24, s3, 1
    s_lshl_b32 s24, s24, 5
    s_add_u32 s29, s29, s24
    s_mov_b32 s24, 262144
    s_branch L_pd15_in
L_pd15:
    s_sleep 64
L_pd15_in:
    buffer_load_dwordx2 v[8:9], v31, s[12:15], s29 offen sc1
    s_waitcnt vmcnt(0)
    v_max_u32 v3, v8, v9
    v_cmp_eq_u32 vcc, -1, v3
    s_sub_u32 s24, s24, 1
    s_cmp_eq_u32 s24, 0
    s_cbranch_scc1 L_pd15_x
    s_and_b64 exec, exec, vcc
    s_cbranch_scc1 L_pd15
L_pd15_x:
    s_mov_b64 exec, -1
    v_mov_b32 v6, v8
    s_nop 1
    v_max_f32_dpp v6, v6, v6 quad_perm:[1,0,3,2] row_mask:0xf bank_mask:0xf
    s_nop 1
    v_max_f32_dpp v6, v6, v6 quad_perm:[2,3,0,1] row_mask:0xf bank_mask:0xf
    s_nop 1
    v_max_f32_dpp v6, v6, v6 row_half_mirror row_mask:0xf bank_mask:0xf
    v_sub_f32 v8, v8, v6
    v_exp_f32 v8, v8
    v_and_b32 v4, 7, v0
    v_cmp_gt_u32 vcc, 6, v4
    s_nop 1
    v_cndmask_b32 v8, 0, v8, vcc
    v_mul_f32 v9, v8, v9
    s_nop 1
    v_add_f32_dpp v9, v9, v9 quad_perm:[1,0,3,2] row_mask:0xf bank_mask:0xf
    s_nop 1
    v_add_f32_dpp v9, v9, v9 quad_perm:[2,3,0,1] row_mask:0xf bank_mask:0xf
    s_nop 1
    v_add_f32_dpp v9, v9, v9 row_half_mirror row_mask:0xf bank_mask:0xf
    v_rcp_f32 v9, v9
    s_nop 0
    v_mul_f32 v8, v8, v9
    v_cvt_pk_bf16_f32 v8, v8, v8
    v_lshrrev_b32 v5, 4, v0
    v_lshlrev_b32 v5, 2, v5
    ds_bpermute_b32 v6, v5, v8
    ds_bpermute_b32 v7, v5, v8 offset:16
    s_waitcnt lgkmcnt(0)
    v_and_b32 v32, v6, v20
    v_and_b32 v33, v6, v21
    v_and_b32 v34, v6, v22
    v_and_b32 v35, v6, v23
    v_and_b32 v36, v7, v20
    v_and_b32 v37, v7, v21
    v_and_b32 v38, v7, v22
    v_and_b32 v39, v7, v23
    s_mul_i32 s29, s33, 1536
    s_add_u32 s29, s29, 0x180000
    s_add_u32 s30, s30, 0x1b7000
    s_lshl_b32 s31, s26, 13
    s_lshr_b32 s24, s74, 5
    s_lshl_b32 s24, s24, 12
    s_add_u32 s31, s31, s24
    s_lshl_b32 s24, s3, 10
    s_add_u32 s31, s31, s24
    s_add_u32 s31, s31, 0x1b7000
    s_cmp_lg_u32 s3, 0
    s_cbranch_scc1 L_H_x
    s_lshr_b32 s24, s74, 5
    s_mul_i32 s25, s24, 3
    s_add_u32 s34, s34, s25
    s_lshl_b32 s24, s24, 6
    s_add_u32 s24, s24, s26
    s_lshl_b32 s24, s24, 20
    s_add_u32 s4, s52, s24
    s_addc_u32 s5, s53, 0
    s_mov_b32 s6, 0x100000
    s_mov_b32 s7, 0x20000
    s_add_u32 s8, s4, 0x2000000
    s_addc_u32 s9, s5, 0
    s_mov_b32 s10, s6
    s_mov_b32 s11, 0x20000
    v_lshrrev_b32 v3, 4, v0
    v_mul_u32_u24 v16, 6144, v3
    v_and_b32 v3, 15, v0
    v_lshl_add_u32 v16, v3, 7, v16
    v_lshlrev_b32 v17, 10, v0
    v_mov_b32 v18, 0
    s_mov_b32 s64, 0
    s_mov_b32 s65, 0
    s_mov_b32 s66, 0
    s_mov_b32 s67, 0
    s_mov_b32 s68, 0
    s_mov_b32 s69, 0
    s_mov_b32 s27, 43
    s_mov_b32 s28, 43
    s_mov_b32 s32, 43
    s_mov_b32 s75, 262144
L_H:
    s_sub_u32 s75, s75, 1
    s_cmp_eq_u32 s75, 0
    s_cbranch_scc1 L_H_x
    s_mov_b32 exec_lo, 0xffffff
    s_mov_b32 exec_hi, s64
    buffer_load_dword v18, v17, s[12:15], s35 offen offset:64 sc1
    s_mov_b64 exec, -1
    s_waitcnt vmcnt(0)
    v_max_i32 v19, 0, v18
    s_nop 1
    v_add_u32_dpp v3, v19, v19 row_ror:8 row_mask:0xf bank_mask:0xf
    s_nop 1
    v_add_u32_dpp v3, v3, v3 row_ror:4 row_mask:0xf bank_mask:0xf
    s_nop 1
    v_add_u32_dpp v3, v3, v3 row_ror:2 row_mask:0xf bank_mask:0xf
    s_nop 1
    v_add_u32_dpp v3, v3, v3 row_ror:1 row_mask:0xf bank_mask:0xf
    s_nop 0
    v_readlane_b32 s70, v3, 0
    v_readlane_b32 s24, v3, 16
    s_nop 0
    s_add_u32 s70, s70, s24
    s_mov_b32 s71, 0
    s_add_u32 s24, s34, 0
    v_readlane_b32 s24, v19, s24
    s_nop 0
    s_add_u32 s25, s24, 8
    s_cmp_gt_u32 s25, s27
    s_cbranch_scc1 L_H_n0
    s_mov_b32 s71, 1
    s_sub_u32 s25, 43, s27
    s_mul_i32 s25, s25, 17
    s_mul_i32 s24, s24, 24
    s_add_u32 s24, s24, s25
    s_add_u32 s24, s24, 30
    s_cmp_ge_i32 s24, s70
    s_cbranch_scc1 L_H_n0
    s_sub_u32 s27, s27, 2
    s_mul_i32 s24, s27, 24576
    s_add_u32 s24, s24, 0
    buffer_load_dword v5, v16, s[4:7], s24 offen
    buffer_load_dword v5, v16, s[8:11], s24 offen
    s_add_u32 s24, s24, 24576
    buffer_load_dword v5, v16, s[4:7], s24 offen
    buffer_load_dword v5, v16, s[8:11], s24 offen
    s_branch L_H
L_H_n0:
    s_add_u32 s24, s34, 1
    v_readlane_b32 s24, v19, s24
    s_nop 0
    s_add_u32 s25, s24, 8
    s_cmp_gt_u32 s25, s28
    s_cbranch_scc1 L_H_n1
    s_mov_b32 s71, 1
    s_sub_u32 s25, 43, s28
    s_mul_i32 s25, s25, 17
    s_mul_i32 s24, s24, 24
    s_add_u32 s24, s24, s25
    s_add_u32 s24, s24, 30
    s_cmp_ge_i32 s24, s70
    s_cbranch_scc1 L_H_n1
    s_sub_u32 s28, s28, 2
    s_mul_i32 s24, s28, 24576
    s_add_u32 s24, s24, 2048
    buffer_load_dword v5, v16, s[4:7], s24 offen
    buffer_load_dword v5, v16, s[8:11], s24 offen
    s_add_u32 s24, s24, 24576
    buffer_load_dword v5, v16, s[4:7], s24 offen
    buffer_load_dword v5, v16, s[8:11], s24 offen
    s_branch L_H
L_H_n1:
    s_add_u32 s24, s34, 2
    v_readlane_b32 s24, v19, s24
    s_nop 0
    s_add_u32 s25, s24, 8
    s_cmp_gt_u32 s25, s32
    s_cbranch_scc1 L_H_n2
    s_mov_b32 s71, 1
    s_sub_u32 s25, 43, s32
    s_mul_i32 s25, s25, 17
    s_mul_i32 s24, s24, 24
    s_add_u32 s24, s24, s25
    s_add_u32 s24, s24, 30
    s_cmp_ge_i32 s24, s70
    s_cbranch_scc1 L_H_n2
    s_sub_u32 s32, s32, 2
    s_mul_i32 s24, s32, 24576
    s_add_u32 s24, s24, 4096
    buffer_load_dword v5, v16, s[4:7], s24 offen
    buffer_load_dword v5, v16, s[8:11], s24 offen
    s_add_u32 s24, s24, 24576
    buffer_load_dword v5, v16, s[4:7], s24 offen
    buffer_load_dword v5, v16, s[8:11], s24 offen
    s_branch L_H
L_H_n2:
    s_sleep 4
    s_cmp_lg_u32 s71, 0
    s_cbranch_scc1 L_H
L_H_x:
    s_mov_b32 s24, 262144
    s_branch L_pd16_in
L_pd16:
L_pd16_in:
    buffer_load_dwordx4 v[40:43], v2, s[12:15], s29 offen sc1
    buffer_load_dwordx4 v[44:47], v29, s[12:15], s29 offen offset:1024 sc1
    s_waitcnt vmcnt(0)
    v_max_u32 v3, v40, v41
    v_max3_u32 v3, v3, v42, v43
    v_max3_u32 v3, v3, v44, v45
    v_max3_u32 v3, v3, v46, v47
    v_cmp_eq_u32 vcc, -1, v3
    s_sub_u32 s24, s24, 1
    s_cmp_eq_u32 s24, 0
    s_cbranch_scc1 L_pd16_x
    s_and_b64 exec, exec, vcc
    s_cbranch_scc1 L_pd16
L_pd16_x:
    s_mov_b64 exec, -1
    v_mfma_f32_16x16x32_bf16 v[12:15], v[40:43], v[32:35], 0
    v_mfma_f32_16x16x32_bf16 v[12:15], v[44:47], v[36:39], v[12:15]
    s_nop 7
    v_cvt_pk_bf16_f32 v4, v12, v13
    v_cvt_pk_bf16_f32 v5, v14, v15
    ds_write_b64 v24, v[4:5]
    s_waitcnt lgkmcnt(0)
    s_barrier
    ds_read_b128 v[48:51], v25 offset:0
    ds_read_b128 v[52:55], v25 offset:64
    ds_read_b128 v[56:59], v25 offset:128
    ds_read_b128 v[60:63], v25 offset:192
    s_waitcnt lgkmcnt(3)
    v_mfma_f32_16x16x32_bf16 v[64:67], v[48:51], a[128:131], 0
    v_mfma_f32_16x16x32_bf16 v[68:71], v[48:51], a[144:147], 0
    v_mfma_f32_16x16x32_bf16 v[72:75], v[48:51], a[160:163], 0
    v_mfma_f32_16x16x32_bf16 v[76:79], v[48:51], a[176:179], 0
    s_waitcnt lgkmcnt(2)
    v_mfma_f32_16x16x32_bf16 v[64:67], v[52:55], a[132:135], v[64:67]
    v_mfma_f32_16x16x32_bf16 v[68:71], v[52:55], a[148:151], v[68:71]
    v_mfma_f32_16x16x32_bf16 v[72:75], v[52:55], a[164:167], v[72:75]
    v_mfma_f32_16x16x32_bf16 v[76:79], v[52:55], a[180:183], v[76:79]
    s_waitcnt lgkmcnt(1)
    v_mfma_f32_16x16x32_bf16 v[64:67], v[56:59], a[136:139], v[64:67]
    v_mfma_f32_16x16x32_bf16 v[68:71], v[56:59], a[152:155], v[68:71]
    v_mfma_f32_16x16x32_bf16 v[72:75], v[56:59], a[168:171], v[72:75]
    v_mfma_f32_16x16x32_bf16 v[76:79], v[56:59], a[184:187], v[76:79]
    s_waitcnt lgkmcnt(0)
    v_mfma_f32_16x16x32_bf16 v[64:67], v[60:63], a[140:143], v[64:67]
    v_mfma_f32_16x16x32_bf16 v[68:71], v[60:63], a[156:159], v[68:71]
    v_mfma_f32_16x16x32_bf16 v[72:75], v[60:63], a[172:175], v[72:75]
    v_mfma_f32_16x16x32_bf16 v[76:79], v[60:63], a[188:191], v[76:79]
    s_nop 4
    v_mov_b32_dpp v8, v64 quad_perm:[0,1,2,3] row_mask:0x1 bank_mask:0xf
    v_mov_b32_dpp v9, v65 quad_perm:[0,1,2,3] row_mask:0x1 bank_mask:0xf
    v_mov_b32_dpp v10, v66 quad_perm:[0,1,2,3] row_mask:0x1 bank_mask:0xf
    v_mov_b32_dpp v11, v67 quad_perm:[0,1,2,3] row_mask:0x1 bank_mask:0xf
    v_mov_b32_dpp v8, v68 quad_perm:[0,1,2,3] row_mask:0x2 bank_mask:0xf
    v_mov_b32_dpp v9, v69 quad_perm:[0,1,2,3] row_mask:0x2 bank_mask:0xf
    v_mov_b32_dpp v10, v70 quad_perm:[0,1,2,3] row_mask:0x2 bank_mask:0xf
    v_mov_b32_dpp v11, v71 quad_perm:[0,1,2,3] row_mask:0x2 bank_mask:0xf
    v_mov_b32_dpp v8, v72 quad_perm:[0,1,2,3] row_mask:0x4 bank_mask:0xf
    v_mov_b32_dpp v9, v73 quad_perm:[0,1,2,3] row_mask:0x4 bank_mask:0xf
    v_mov_b32_dpp v10, v74 quad_perm:[0,1,2,3] row_mask:0x4 bank_mask:0xf
    v_mov_b32_dpp v11, v75 quad_perm:[0,1,2,3] row_mask:0x4 bank_mask:0xf
    v_mov_b32_dpp v8, v76 quad_perm:[0,1,2,3] row_mask:0x8 bank_mask:0xf
    v_mov_b32_dpp v9, v77 quad_perm:[0,1,2,3] row_mask:0x8 bank_mask:0xf
    v_mov_b32_dpp v10, v78 quad_perm:[0,1,2,3] row_mask:0x8 bank_mask:0xf
    v_mov_b32_dpp v11, v79 quad_perm:[0,1,2,3] row_mask:0x8 bank_mask:0xf
    buffer_store_dwordx4 v[8:11], v2, s[12:15], s31 offen sc1
    s_mov_b32 s24, 262144
    s_branch L_pd17_in
L_pd17:
L_pd17_in:
    buffer_load_dwordx4 v[4:7], v30, s[12:15], s30 offen sc1
    s_waitcnt vmcnt(0)
    v_max_u32 v3, v4, v5
    v_max3_u32 v3, v3, v6, v7
    v_cmp_eq_u32 vcc, -1, v3
    s_sub_u32 s24, s24, 1
    s_cmp_eq_u32 s24, 0
    s_cbranch_scc1 L_pd17_x
    s_and_b64 exec, exec, vcc
    s_cbranch_scc1 L_pd17
L_pd17_x:
    s_mov_b64 exec, -1
    v_permlane32_swap_b32 v4, v6
    v_permlane32_swap_b32 v5, v7
    v_add_f32 v4, v4, v6
    v_add_f32 v5, v5, v7
    s_nop 1
    v_permlane16_swap_b32 v4, v5
    v_add_f32 v4, v4, v5
    s_nop 1
    v_add_f32_dpp v4, v4, v4 row_ror:8 row_mask:0xf bank_mask:0xf
    ds_write_b32 v26, v4 offset:512
    s_waitcnt lgkmcnt(0)
    s_barrier
    s_cmp_lg_u32 s3, 0
    s_cbranch_scc1 L_fr18
    ds_read_b128 v[4:7], v27 offset:512
    s_waitcnt lgkmcnt(0)
    v_add_f32 v4, v4, v5
    v_add_f32 v6, v6, v7
    v_add_f32 v4, v4, v6
    v_cvt_pk_bf16_f32 v4, v4, v4
    buffer_store_short v4, v28, s[20:23], 0 offen offset:1024
L_fr18:
L_end:
    s_endpgm
L_C:
    s_cmp_lg_u32 s3, 0
    s_cbranch_scc1 L_C_q
    v_lshrrev_b32 v3, 4, v0
    v_and_b32 v4, 3, v0
    v_lshlrev_b32 v5, 6, v3
    v_lshl_add_u32 v5, v4, 4, v5
    v_bfe_u32 v4, v0, 2, 2
    v_lshl_add_u32 v5, v4, 8, v5
    s_lshl_b32 s24, s26, 10
    s_add_u32 s24, s24, 0x164000
    buffer_store_dwordx4 v[8:11], v5, s[12:15], s24 offen sc1
L_C_q:
    s_mov_b32 s8, s56
    s_mov_b32 s9, s57
    s_mov_b32 s10, 0x400000
    s_mov_b32 s11, 0x20000
    s_lshl_b32 s33, s26, 17
    s_lshl_b32 s24, s3, 15
    s_add_u32 s33, s33, s24
    s_add_u32 s33, s33, 512
    s_mul_i32 s34, s3, 17408
    s_add_u32 s34, s34, 0
    s_mov_b32 exec_hi, 0
    s_mov_b32 s70, 0
L_woC:
    s_and_b32 s24, s70, 1
    s_lshl_b32 s24, s24, 4
    s_and_b32 s25, s70, 4
    s_lshl_b32 s25, s25, 1
    s_or_b32 s24, s24, s25
    s_bfe_u32 s25, s70, 0x10001
    s_or_b32 s24, s24, s25
    s_lshl_b32 s24, s24, 10
    s_add_u32 s24, s24, s33
    s_mul_i32 s25, s70, 2176
    s_add_u32 m0, s25, s34
    s_waitcnt vmcnt(24)
    buffer_load_dwordx4 v2, s[8:11], s24 offen nt lds
    s_add_u32 m0, m0, 544
    s_add_u32 s24, s24, 2048
    s_waitcnt vmcnt(24)
    buffer_load_dwordx4 v2, s[8:11], s24 offen nt lds
    s_add_u32 m0, m0, 544
    s_add_u32 s24, s24, 2048
    s_waitcnt vmcnt(24)
    buffer_load_dwordx4 v2, s[8:11], s24 offen nt lds
    s_add_u32 m0, m0, 544
    s_add_u32 s24, s24, 2048
    s_waitcnt vmcnt(24)
    buffer_load_dwordx4 v2, s[8:11], s24 offen nt lds
    s_add_u32 s70, s70, 1
    s_cmp_lt_u32 s70, 8
    s_cbranch_scc1 L_woC
    s_mov_b64 exec, -1
    s_waitcnt vmcnt(0)
    s_barrier
    s_cmp_lg_u32 s3, 0
    s_cbranch_scc1 L_sig19
    s_mov_b64 exec, 1
    v_mov_b32 v3, 1
    v_mov_b32 v4, 1
    buffer_atomic_add v4, off, s[16:19], 0 offset:128
    buffer_atomic_add v3, off, s[16:19], 0 offset:0 sc0
    s_waitcnt vmcnt(0)
    v_readfirstlane_b32 s24, v3
    s_mov_b64 exec, -1
    s_and_b32 s24, s24, 63
    s_cmp_lg_u32 s24, 63
    s_cbranch_scc1 L_sig19
    v_lshlrev_b32 v4, 7, v0
    v_mov_b32 v3, 1
    s_mov_b32 s24, 0x170000
    buffer_store_dword v3, v4, s[12:15], s24 offen offset:0 sc1
L_sig19:
    v_lshrrev_b32 v3, 2, v0
    v_mul_u32_u24 v3, 544, v3
    v_and_b32 v4, 3, v0
    v_lshl_add_u32 v3, v4, 3, v3
    s_mul_i32 s24, s3, 128
    s_add_u32 s24, s24, 0
    v_add_u32 v3, s24, v3
    v_add_u32 v4, 34816, v3
    ds_read_b64_tr_b16 a[128:129], v3 offset:0
    ds_read_b64_tr_b16 a[130:131], v3 offset:8704
    ds_read_b64_tr_b16 a[132:133], v3 offset:17408
    ds_read_b64_tr_b16 a[134:135], v3 offset:26112
    ds_read_b64_tr_b16 a[136:137], v4 offset:0
    ds_read_b64_tr_b16 a[138:139], v4 offset:8704
    ds_read_b64_tr_b16 a[140:141], v4 offset:17408
    ds_read_b64_tr_b16 a[142:143], v4 offset:26112
    ds_read_b64_tr_b16 a[144:145], v3 offset:32
    ds_read_b64_tr_b16 a[146:147], v3 offset:8736
    ds_read_b64_tr_b16 a[148:149], v3 offset:17440
    ds_read_b64_tr_b16 a[150:151], v3 offset:26144
    ds_read_b64_tr_b16 a[152:153], v4 offset:32
    ds_read_b64_tr_b16 a[154:155], v4 offset:8736
    ds_read_b64_tr_b16 a[156:157], v4 offset:17440
    ds_read_b64_tr_b16 a[158:159], v4 offset:26144
    ds_read_b64_tr_b16 a[160:161], v3 offset:64
    ds_read_b64_tr_b16 a[162:163], v3 offset:8768
    ds_read_b64_tr_b16 a[164:165], v3 offset:17472
    ds_read_b64_tr_b16 a[166:167], v3 offset:26176
    ds_read_b64_tr_b16 a[168:169], v4 offset:64
    ds_read_b64_tr_b16 a[170:171], v4 offset:8768
    ds_read_b64_tr_b16 a[172:173], v4 offset:17472
    ds_read_b64_tr_b16 a[174:175], v4 offset:26176
    ds_read_b64_tr_b16 a[176:177], v3 offset:96
    ds_read_b64_tr_b16 a[178:179], v3 offset:8800
    ds_read_b64_tr_b16 a[180:181], v3 offset:17504
    ds_read_b64_tr_b16 a[182:183], v3 offset:26208
    ds_read_b64_tr_b16 a[184:185], v4 offset:96
    ds_read_b64_tr_b16 a[186:187], v4 offset:8800
    ds_read_b64_tr_b16 a[188:189], v4 offset:17504
    ds_read_b64_tr_b16 a[190:191], v4 offset:26208
    s_lshr_b32 s30, s72, 3
    s_lshl_b32 s30, s30, 22
    s_add_u32 s4, s38, s30
    s_addc_u32 s5, s39, 0
    s_mov_b32 s6, 0x400000
    s_mov_b32 s7, 0x20000
    s_lshl_b32 s32, s3, 16
    s_and_b32 s24, s72, 7
    s_lshl_b32 s24, s24, 10
    s_add_u32 s32, s32, s24
    s_mul_i32 s34, s3, 8448
    s_waitcnt lgkmcnt(0)
    s_barrier
    s_mov_b32 s33, 0
    s_add_u32 m0, s33, s34
    s_nop 0
    buffer_load_dwordx4 v2, s[4:7], s32 offen  lds
    s_add_u32 m0, m0, 1056
    s_add_u32 s32, s32, 8192
    buffer_load_dwordx4 v2, s[4:7], s32 offen  lds
    s_add_u32 m0, m0, 1056
    s_add_u32 s32, s32, 8192
    buffer_load_dwordx4 v2, s[4:7], s32 offen  lds
    s_add_u32 m0, m0, 1056
    s_add_u32 s32, s32, 8192
    buffer_load_dwordx4 v2, s[4:7], s32 offen  lds
    s_add_u32 m0, m0, 1056
    s_add_u32 s32, s32, 8192
    buffer_load_dwordx4 v2, s[4:7], s32 offen  lds
    s_add_u32 m0, m0, 1056
    s_add_u32 s32, s32, 8192
    buffer_load_dwordx4 v2, s[4:7], s32 offen  lds
    s_add_u32 m0, m0, 1056
    s_add_u32 s32, s32, 8192
    buffer_load_dwordx4 v2, s[4:7], s32 offen  lds
    s_add_u32 m0, m0, 1056
    s_add_u32 s32, s32, 8192
    buffer_load_dwordx4 v2, s[4:7], s32 offen  lds
    s_add_u32 s32, s32, 204800
    s_mov_b32 s33, 33792
    s_add_u32 m0, s33, s34
    s_nop 0
    buffer_load_dwordx4 v2, s[4:7], s32 offen  lds
    s_add_u32 m0, m0, 1056
    s_add_u32 s32, s32, 8192
    buffer_load_dwordx4 v2, s[4:7], s32 offen  lds
    s_add_u32 m0, m0, 1056
    s_add_u32 s32, s32, 8192
    buffer_load_dwordx4 v2, s[4:7], s32 offen  lds
    s_add_u32 m0, m0, 1056
    s_add_u32 s32, s32, 8192
    buffer_load_dwordx4 v2, s[4:7], s32 offen  lds
    s_add_u32 m0, m0, 1056
    s_add_u32 s32, s32, 8192
    buffer_load_dwordx4 v2, s[4:7], s32 offen  lds
    s_add_u32 m0, m0, 1056
    s_add_u32 s32, s32, 8192
    buffer_load_dwordx4 v2, s[4:7], s32 offen  lds
    s_add_u32 m0, m0, 1056
    s_add_u32 s32, s32, 8192
    buffer_load_dwordx4 v2, s[4:7], s32 offen  lds
    s_add_u32 m0, m0, 1056
    s_add_u32 s32, s32, 8192
    buffer_load_dwordx4 v2, s[4:7], s32 offen  lds
    s_add_u32 s32, s32, 204800
    s_mov_b32 s33, 67584
    s_add_u32 m0, s33, s34
    s_nop 0
    buffer_load_dwordx4 v2, s[4:7], s32 offen  lds
    s_add_u32 m0, m0, 1056
    s_add_u32 s32, s32, 8192
    buffer_load_dwordx4 v2, s[4:7], s32 offen  lds
    s_add_u32 m0, m0, 1056
    s_add_u32 s32, s32, 8192
    buffer_load_dwordx4 v2, s[4:7], s32 offen  lds
    s_add_u32 m0, m0, 1056
    s_add_u32 s32, s32, 8192
    buffer_load_dwordx4 v2, s[4:7], s32 offen  lds
    s_add_u32 m0, m0, 1056
    s_add_u32 s32, s32, 8192
    buffer_load_dwordx4 v2, s[4:7], s32 offen  lds
    s_add_u32 m0, m0, 1056
    s_add_u32 s32, s32, 8192
    buffer_load_dwordx4 v2, s[4:7], s32 offen  lds
    s_add_u32 m0, m0, 1056
    s_add_u32 s32, s32, 8192
    buffer_load_dwordx4 v2, s[4:7], s32 offen  lds
    s_add_u32 m0, m0, 1056
    s_add_u32 s32, s32, 8192
    buffer_load_dwordx4 v2, s[4:7], s32 offen  lds
    s_add_u32 s32, s32, 204800
    s_lshr_b32 s28, s3, 1
    s_and_b32 s29, s3, 1
    v_and_b32 v3, 15, v0
    v_lshrrev_b32 v4, 4, v0
    v_mul_u32_u24 v19, 1056, v3
    v_lshl_add_u32 v19, v4, 4, v19
    s_mul_i32 s24, s28, 16896
    s_add_u32 s24, s24, 101376
    v_add_u32 v18, s24, v19
    v_lshrrev_b32 v5, 2, v0
    v_mul_u32_u24 v20, 1056, v5
    v_and_b32 v5, 3, v0
    v_lshl_add_u32 v20, v5, 3, v20
    s_lshl_b32 s24, s29, 9
    v_add_u32 v20, s24, v20
    v_mov_b32 v128, 0
    v_mov_b32 v129, 0
    v_mov_b32 v130, 0
    v_mov_b32 v131, 0
    v_mov_b32 v132, 0
    v_mov_b32 v133, 0
    v_mov_b32 v134, 0
    v_mov_b32 v135, 0
    v_mov_b32 v136, 0
    v_mov_b32 v137, 0
    v_mov_b32 v138, 0
    v_mov_b32 v139, 0
    v_mov_b32 v140, 0
    v_mov_b32 v141, 0
    v_mov_b32 v142, 0
    v_mov_b32 v143, 0
    v_mov_b32 v144, 0
    v_mov_b32 v145, 0
    v_mov_b32 v146, 0
    v_mov_b32 v147, 0
    v_mov_b32 v148, 0
    v_mov_b32 v149, 0
    v_mov_b32 v150, 0
    v_mov_b32 v151, 0
    v_mov_b32 v152, 0
    v_mov_b32 v153, 0
    v_mov_b32 v154, 0
    v_mov_b32 v155, 0
    v_mov_b32 v156, 0
    v_mov_b32 v157, 0
    v_mov_b32 v158, 0
    v_mov_b32 v159, 0
    v_mov_b32 v160, 0
    v_mov_b32 v161, 0
    v_mov_b32 v162, 0
    v_mov_b32 v163, 0
    v_mov_b32 v164, 0
    v_mov_b32 v165, 0
    v_mov_b32 v166, 0
    v_mov_b32 v167, 0
    v_mov_b32 v168, 0
    v_mov_b32 v169, 0
    v_mov_b32 v170, 0
    v_mov_b32 v171, 0
    v_mov_b32 v172, 0
    v_mov_b32 v173, 0
    v_mov_b32 v174, 0
    v_mov_b32 v175, 0
    v_mov_b32 v176, 0
    v_mov_b32 v177, 0
    v_mov_b32 v178, 0
    v_mov_b32 v179, 0
    v_mov_b32 v180, 0
    v_mov_b32 v181, 0
    v_mov_b32 v182, 0
    v_mov_b32 v183, 0
    v_mov_b32 v184, 0
    v_mov_b32 v185, 0
    v_mov_b32 v186, 0
    v_mov_b32 v187, 0
    v_mov_b32 v188, 0
    v_mov_b32 v189, 0
    v_mov_b32 v190, 0
    v_mov_b32 v191, 0
    v_mov_b32 v22, 0xff800000
    v_mov_b32 v23, 0
    s_cmp_lg_u32 s3, 0
    s_cbranch_scc1 L_awx20
    s_mov_b32 s24, 262144
    s_mov_b64 exec, 1
L_aw21:
    buffer_load_dword v1, off, s[12:15], s73 offset:0 sc1
    s_waitcnt vmcnt(0)
    v_readfirstlane_b32 s25, v1
    s_nop 0
    s_cmp_eq_u32 s25, 1
    s_cbranch_scc1 L_awx20
    s_sleep 4
    s_sub_u32 s24, s24, 1
    s_cmp_lg_u32 s24, 0
    s_cbranch_scc1 L_aw21
L_awx20:
    s_mov_b64 exec, -1
    s_barrier
    s_lshr_b32 s24, s72, 3
    s_lshl_b32 s24, s24, 15
    s_lshl_b32 s25, s3, 13
    s_add_u32 s24, s24, s25
    s_add_u32 s24, s24, 0x0
    buffer_load_dwordx4 v[32:35], v2, s[12:15], s24 offen offset:0 sc1
    buffer_load_dwordx4 v[36:39], v2, s[12:15], s24 offen offset:1024 sc1
    buffer_load_dwordx4 v[40:43], v2, s[12:15], s24 offen offset:2048 sc1
    buffer_load_dwordx4 v[44:47], v2, s[12:15], s24 offen offset:3072 sc1
    s_add_u32 s24, s24, 4096
    buffer_load_dwordx4 v[48:51], v2, s[12:15], s24 offen offset:0 sc1
    buffer_load_dwordx4 v[52:55], v2, s[12:15], s24 offen offset:1024 sc1
    buffer_load_dwordx4 v[56:59], v2, s[12:15], s24 offen offset:2048 sc1
    buffer_load_dwordx4 v[60:63], v2, s[12:15], s24 offen offset:3072 sc1
    s_add_u32 s24, s34, 101376
    v_add_u32 v3, s24, v2
    s_waitcnt vmcnt(7)
    ds_write_b128 v3, v[32:35] offset:0
    s_waitcnt vmcnt(6)
    ds_write_b128 v3, v[36:39] offset:1056
    s_waitcnt vmcnt(5)
    ds_write_b128 v3, v[40:43] offset:2112
    s_waitcnt vmcnt(4)
    ds_write_b128 v3, v[44:47] offset:3168
    s_waitcnt vmcnt(3)
    ds_write_b128 v3, v[48:51] offset:4224
    s_waitcnt vmcnt(2)
    ds_write_b128 v3, v[52:55] offset:5280
    s_waitcnt vmcnt(1)
    ds_write_b128 v3, v[56:59] offset:6336
    s_waitcnt vmcnt(0)
    ds_write_b128 v3, v[60:63] offset:7392
    s_waitcnt lgkmcnt(0)
    s_barrier
    ds_read_b128 a[0:3], v18 offset:0
    ds_read_b128 a[4:7], v18 offset:64
    ds_read_b128 a[8:11], v18 offset:128
    ds_read_b128 a[12:15], v18 offset:192
    ds_read_b128 a[16:19], v18 offset:256
    ds_read_b128 a[20:23], v18 offset:320
    ds_read_b128 a[24:27], v18 offset:384
    ds_read_b128 a[28:31], v18 offset:448
    ds_read_b128 a[32:35], v18 offset:512
    ds_read_b128 a[36:39], v18 offset:576
    ds_read_b128 a[40:43], v18 offset:640
    ds_read_b128 a[44:47], v18 offset:704
    ds_read_b128 a[48:51], v18 offset:768
    ds_read_b128 a[52:55], v18 offset:832
    ds_read_b128 a[56:59], v18 offset:896
    ds_read_b128 a[60:63], v18 offset:960
    s_cmp_lg_u32 s3, 0
    s_cbranch_scc1 L_xi22
    s_getreg_b32 s25, hwreg(HW_REG_XCC_ID, 0, 4)
    s_lshl_b32 s24, s26, 7
    s_add_u32 s24, s24, 0x1b6000
    s_mov_b64 exec, 1
    v_mov_b32 v3, s25
    buffer_store_dword v3, off, s[12:15], s24 offset:4 sc1
    s_mov_b64 exec, -1
L_xi22:
    s_mov_b32 s27, 0
    s_mov_b32 s33, 101376
    s_mov_b32 s35, 0
    s_waitcnt lgkmcnt(0)
L_CT:
    s_waitcnt vmcnt(16)
    s_barrier
    v_add_u32 v24, s35, v19
    v_add_u32 v25, s35, v20
    ds_read_b128 v[32:35], v24 offset:0
    ds_read_b128 v[36:39], v24 offset:16896
    ds_read_b128 v[40:43], v24 offset:64
    ds_read_b128 v[44:47], v24 offset:16960
    ds_read_b128 v[48:51], v24 offset:128
    ds_read_b128 v[52:55], v24 offset:17024
    ds_read_b128 v[56:59], v24 offset:192
    s_add_u32 m0, s33, s34
    s_nop 0
    buffer_load_dwordx4 v2, s[4:7], s32 offen nt lds
    s_add_u32 m0, m0, 1056
    s_add_u32 s32, s32, 8192
    buffer_load_dwordx4 v2, s[4:7], s32 offen nt lds
    s_add_u32 m0, m0, 1056
    s_add_u32 s32, s32, 8192
    buffer_load_dwordx4 v2, s[4:7], s32 offen nt lds
    s_add_u32 m0, m0, 1056
    s_add_u32 s32, s32, 8192
    buffer_load_dwordx4 v2, s[4:7], s32 offen nt lds
    s_add_u32 m0, m0, 1056
    s_add_u32 s32, s32, 8192
    buffer_load_dwordx4 v2, s[4:7], s32 offen nt lds
    s_add_u32 m0, m0, 1056
    s_add_u32 s32, s32, 8192
    buffer_load_dwordx4 v2, s[4:7], s32 offen nt lds
    s_add_u32 m0, m0, 1056
    s_add_u32 s32, s32, 8192
    buffer_load_dwordx4 v2, s[4:7], s32 offen nt lds
    s_add_u32 m0, m0, 1056
    s_add_u32 s32, s32, 8192
    buffer_load_dwordx4 v2, s[4:7], s32 offen nt lds
    s_add_u32 s32, s32, 204800
    s_mov_b32 s33, s35
    s_add_u32 s35, s35, 33792
    s_cmp_eq_u32 s35, 135168
    s_cselect_b32 s35, 0, s35
    s_waitcnt lgkmcnt(6)
    v_mfma_f32_16x16x32_bf16 v[64:67], v[32:35], a[0:3], 0
    ds_read_b128 v[60:63], v24 offset:17088
    s_waitcnt lgkmcnt(6)
    v_mfma_f32_16x16x32_bf16 v[68:71], v[36:39], a[0:3], 0
    ds_read_b128 v[32:35], v24 offset:256
    s_waitcnt lgkmcnt(6)
    v_mfma_f32_16x16x32_bf16 v[64:67], v[40:43], a[4:7], v[64:67]
    ds_read_b128 v[36:39], v24 offset:17152
    s_waitcnt lgkmcnt(6)
    v_mfma_f32_16x16x32_bf16 v[68:71], v[44:47], a[4:7], v[68:71]
    ds_read_b128 v[40:43], v24 offset:320
    s_waitcnt lgkmcnt(6)
    v_mfma_f32_16x16x32_bf16 v[64:67], v[48:51], a[8:11], v[64:67]
    ds_read_b128 v[44:47], v24 offset:17216
    s_waitcnt lgkmcnt(6)
    v_mfma_f32_16x16x32_bf16 v[68:71], v[52:55], a[8:11], v[68:71]
    ds_read_b128 v[48:51], v24 offset:384
    s_waitcnt lgkmcnt(6)
    v_mfma_f32_16x16x32_bf16 v[64:67], v[56:59], a[12:15], v[64:67]
    ds_read_b128 v[52:55], v24 offset:17280
    s_waitcnt lgkmcnt(6)
    v_mfma_f32_16x16x32_bf16 v[68:71], v[60:63], a[12:15], v[68:71]
    ds_read_b128 v[56:59], v24 offset:448
    s_waitcnt lgkmcnt(6)
    v_mfma_f32_16x16x32_bf16 v[64:67], v[32:35], a[16:19], v[64:67]
    ds_read_b128 v[60:63], v24 offset:17344
    s_waitcnt lgkmcnt(6)
    v_mfma_f32_16x16x32_bf16 v[68:71], v[36:39], a[16:19], v[68:71]
    ds_read_b128 v[32:35], v24 offset:512
    s_waitcnt lgkmcnt(6)
    v_mfma_f32_16x16x32_bf16 v[64:67], v[40:43], a[20:23], v[64:67]
    ds_read_b128 v[36:39], v24 offset:17408
    s_waitcnt lgkmcnt(6)
    v_mfma_f32_16x16x32_bf16 v[68:71], v[44:47], a[20:23], v[68:71]
    ds_read_b128 v[40:43], v24 offset:576
    s_waitcnt lgkmcnt(6)
    v_mfma_f32_16x16x32_bf16 v[64:67], v[48:51], a[24:27], v[64:67]
    ds_read_b128 v[44:47], v24 offset:17472
    s_waitcnt lgkmcnt(6)
    v_mfma_f32_16x16x32_bf16 v[68:71], v[52:55], a[24:27], v[68:71]
    ds_read_b128 v[48:51], v24 offset:640
    s_waitcnt lgkmcnt(6)
    v_mfma_f32_16x16x32_bf16 v[64:67], v[56:59], a[28:31], v[64:67]
    ds_read_b128 v[52:55], v24 offset:17536
    s_waitcnt lgkmcnt(6)
    v_mfma_f32_16x16x32_bf16 v[68:71], v[60:63], a[28:31], v[68:71]
    ds_read_b128 v[56:59], v24 offset:704
    s_waitcnt lgkmcnt(6)
    v_mfma_f32_16x16x32_bf16 v[64:67], v[32:35], a[32:35], v[64:67]
    ds_read_b128 v[60:63], v24 offset:17600
    s_waitcnt lgkmcnt(6)
    v_mfma_f32_16x16x32_bf16 v[68:71], v[36:39], a[32:35], v[68:71]
    ds_read_b128 v[32:35], v24 offset:768
    s_waitcnt lgkmcnt(6)
    v_mfma_f32_16x16x32_bf16 v[64:67], v[40:43], a[36:39], v[64:67]
    ds_read_b128 v[36:39], v24 offset:17664
    s_waitcnt lgkmcnt(6)
    v_mfma_f32_16x16x32_bf16 v[68:71], v[44:47], a[36:39], v[68:71]
    ds_read_b128 v[40:43], v24 offset:832
    s_waitcnt lgkmcnt(6)
    v_mfma_f32_16x16x32_bf16 v[64:67], v[48:51], a[40:43], v[64:67]
    ds_read_b128 v[44:47], v24 offset:17728
    s_waitcnt lgkmcnt(6)
    v_mfma_f32_16x16x32_bf16 v[68:71], v[52:55], a[40:43], v[68:71]
    ds_read_b128 v[48:51], v24 offset:896
    s_waitcnt lgkmcnt(6)
    v_mfma_f32_16x16x32_bf16 v[64:67], v[56:59], a[44:47], v[64:67]
    ds_read_b128 v[52:55], v24 offset:17792
    s_waitcnt lgkmcnt(6)
    v_mfma_f32_16x16x32_bf16 v[68:71], v[60:63], a[44:47], v[68:71]
    ds_read_b128 v[56:59], v24 offset:960
    s_waitcnt lgkmcnt(6)
    v_mfma_f32_16x16x32_bf16 v[64:67], v[32:35], a[48:51], v[64:67]
    ds_read_b128 v[60:63], v24 offset:17856
    s_waitcnt lgkmcnt(6)
    v_mfma_f32_16x16x32_bf16 v[68:71], v[36:39], a[48:51], v[68:71]
    ds_read_b64_tr_b16 v[192:193], v25 offset:0
    s_waitcnt lgkmcnt(6)
    v_mfma_f32_16x16x32_bf16 v[64:67], v[40:43], a[52:55], v[64:67]
    ds_read_b64_tr_b16 v[194:195], v25 offset:16896
    s_waitcnt lgkmcnt(6)
    v_mfma_f32_16x16x32_bf16 v[68:71], v[44:47], a[52:55], v[68:71]
    ds_read_b64_tr_b16 v[196:197], v25 offset:32
    s_waitcnt lgkmcnt(6)
    v_mfma_f32_16x16x32_bf16 v[64:67], v[48:51], a[56:59], v[64:67]
    ds_read_b64_tr_b16 v[198:199], v25 offset:16928
    s_waitcnt lgkmcnt(6)
    v_mfma_f32_16x16x32_bf16 v[68:71], v[52:55], a[56:59], v[68:71]
    ds_read_b64_tr_b16 v[200:201], v25 offset:64
    s_waitcnt lgkmcnt(6)
    v_mfma_f32_16x16x32_bf16 v[64:67], v[56:59], a[60:63], v[64:67]
    ds_read_b64_tr_b16 v[202:203], v25 offset:16960
    s_waitcnt lgkmcnt(6)
    v_mfma_f32_16x16x32_bf16 v[68:71], v[60:63], a[60:63], v[68:71]
    ds_read_b64_tr_b16 v[204:205], v25 offset:96
    ds_read_b64_tr_b16 v[206:207], v25 offset:16992
    ds_read_b64_tr_b16 v[208:209], v25 offset:128
    ds_read_b64_tr_b16 v[210:211], v25 offset:17024
    ds_read_b64_tr_b16 v[212:213], v25 offset:160
    ds_read_b64_tr_b16 v[214:215], v25 offset:17056
    ds_read_b64_tr_b16 v[216:217], v25 offset:192
    ds_read_b64_tr_b16 v[218:219], v25 offset:17088
    v_max3_f32 v3, v64, v65, v22
    v_max3_f32 v3, v3, v66, v67
    v_max3_f32 v3, v3, v68, v69
    v_max3_f32 v3, v3, v70, v71
    v_mov_b32 v4, v3
    ds_read_b64_tr_b16 v[220:221], v25 offset:224
    s_nop 0
    v_permlane32_swap_b32 v3, v4
    ds_read_b64_tr_b16 v[222:223], v25 offset:17120
    v_max_f32 v3, v3, v4
    ds_read_b64_tr_b16 v[224:225], v25 offset:256
    v_mov_b32 v4, v3
    ds_read_b64_tr_b16 v[226:227], v25 offset:17152
    s_nop 0
    v_permlane16_swap_b32 v3, v4
    ds_read_b64_tr_b16 v[228:229], v25 offset:288
    v_max_f32 v3, v3, v4
    ds_read_b64_tr_b16 v[230:231], v25 offset:17184
    v_sub_f32 v4, v22, v3
    ds_read_b64_tr_b16 v[232:233], v25 offset:320
    v_exp_f32 v4, v4
    ds_read_b64_tr_b16 v[234:235], v25 offset:17216
    v_mov_b32 v22, v3
    ds_read_b64_tr_b16 v[236:237], v25 offset:352
    v_sub_f32 v64, v64, v3
    ds_read_b64_tr_b16 v[238:239], v25 offset:17248
    v_sub_f32 v65, v65, v3
    ds_read_b64_tr_b16 v[240:241], v25 offset:384
    v_sub_f32 v66, v66, v3
    ds_read_b64_tr_b16 v[242:243], v25 offset:17280
    v_sub_f32 v67, v67, v3
    ds_read_b64_tr_b16 v[244:245], v25 offset:416
    v_sub_f32 v68, v68, v3
    ds_read_b64_tr_b16 v[246:247], v25 offset:17312
    v_sub_f32 v69, v69, v3
    ds_read_b64_tr_b16 v[248:249], v25 offset:448
    v_sub_f32 v70, v70, v3
    ds_read_b64_tr_b16 v[250:251], v25 offset:17344
    v_sub_f32 v71, v71, v3
    ds_read_b64_tr_b16 v[252:253], v25 offset:480
    v_exp_f32 v64, v64
    ds_read_b64_tr_b16 v[254:255], v25 offset:17376
    v_exp_f32 v65, v65
    v_exp_f32 v66, v66
    v_exp_f32 v67, v67
    v_exp_f32 v68, v68
    v_exp_f32 v69, v69
    v_exp_f32 v70, v70
    v_exp_f32 v71, v71
    v_cvt_pk_bf16_f32 v72, v64, v65
    v_cvt_pk_bf16_f32 v73, v66, v67
    v_cvt_pk_bf16_f32 v74, v68, v69
    v_cvt_pk_bf16_f32 v75, v70, v71
    v_pk_mul_f32 v[128:129], v[128:129], v[4:5] op_sel_hi:[1,0]
    v_pk_mul_f32 v[130:131], v[130:131], v[4:5] op_sel_hi:[1,0]
    v_pk_mul_f32 v[132:133], v[132:133], v[4:5] op_sel_hi:[1,0]
    v_pk_mul_f32 v[134:135], v[134:135], v[4:5] op_sel_hi:[1,0]
    s_waitcnt lgkmcnt(0)
    v_mfma_f32_16x16x32_bf16 v[128:131], v[192:195], v[72:75], v[128:131]
    v_pk_mul_f32 v[136:137], v[136:137], v[4:5] op_sel_hi:[1,0]
    v_pk_mul_f32 v[138:139], v[138:139], v[4:5] op_sel_hi:[1,0]
    v_mfma_f32_16x16x32_bf16 v[132:135], v[196:199], v[72:75], v[132:135]
    v_pk_mul_f32 v[140:141], v[140:141], v[4:5] op_sel_hi:[1,0]
    v_pk_mul_f32 v[142:143], v[142:143], v[4:5] op_sel_hi:[1,0]
    v_mfma_f32_16x16x32_bf16 v[136:139], v[200:203], v[72:75], v[136:139]
    v_pk_mul_f32 v[144:145], v[144:145], v[4:5] op_sel_hi:[1,0]
    v_pk_mul_f32 v[146:147], v[146:147], v[4:5] op_sel_hi:[1,0]
    v_mfma_f32_16x16x32_bf16 v[140:143], v[204:207], v[72:75], v[140:143]
    v_pk_mul_f32 v[148:149], v[148:149], v[4:5] op_sel_hi:[1,0]
    v_pk_mul_f32 v[150:151], v[150:151], v[4:5] op_sel_hi:[1,0]
    v_mfma_f32_16x16x32_bf16 v[144:147], v[208:211], v[72:75], v[144:147]
    v_pk_mul_f32 v[152:153], v[152:153], v[4:5] op_sel_hi:[1,0]
    v_pk_mul_f32 v[154:155], v[154:155], v[4:5] op_sel_hi:[1,0]
    v_mfma_f32_16x16x32_bf16 v[148:151], v[212:215], v[72:75], v[148:151]
    v_pk_mul_f32 v[156:157], v[156:157], v[4:5] op_sel_hi:[1,0]
    v_pk_mul_f32 v[158:159], v[158:159], v[4:5] op_sel_hi:[1,0]
    v_mfma_f32_16x16x32_bf16 v[152:155], v[216:219], v[72:75], v[152:155]
    v_pk_mul_f32 v[160:161], v[160:161], v[4:5] op_sel_hi:[1,0]
    v_pk_mul_f32 v[162:163], v[162:163], v[4:5] op_sel_hi:[1,0]
    v_mfma_f32_16x16x32_bf16 v[156:159], v[220:223], v[72:75], v[156:159]
    v_pk_mul_f32 v[164:165], v[164:165], v[4:5] op_sel_hi:[1,0]
    v_pk_mul_f32 v[166:167], v[166:167], v[4:5] op_sel_hi:[1,0]
    v_mfma_f32_16x16x32_bf16 v[160:163], v[224:227], v[72:75], v[160:163]
    v_pk_mul_f32 v[168:169], v[168:169], v[4:5] op_sel_hi:[1,0]
    v_pk_mul_f32 v[170:171], v[170:171], v[4:5] op_sel_hi:[1,0]
    v_mfma_f32_16x16x32_bf16 v[164:167], v[228:231], v[72:75], v[164:167]
    v_pk_mul_f32 v[172:173], v[172:173], v[4:5] op_sel_hi:[1,0]
    v_pk_mul_f32 v[174:175], v[174:175], v[4:5] op_sel_hi:[1,0]
    v_mfma_f32_16x16x32_bf16 v[168:171], v[232:235], v[72:75], v[168:171]
    v_pk_mul_f32 v[176:177], v[176:177], v[4:5] op_sel_hi:[1,0]
    v_pk_mul_f32 v[178:179], v[178:179], v[4:5] op_sel_hi:[1,0]
    v_mfma_f32_16x16x32_bf16 v[172:175], v[236:239], v[72:75], v[172:175]
    v_pk_mul_f32 v[180:181], v[180:181], v[4:5] op_sel_hi:[1,0]
    v_pk_mul_f32 v[182:183], v[182:183], v[4:5] op_sel_hi:[1,0]
    v_mfma_f32_16x16x32_bf16 v[176:179], v[240:243], v[72:75], v[176:179]
    v_pk_mul_f32 v[184:185], v[184:185], v[4:5] op_sel_hi:[1,0]
    v_pk_mul_f32 v[186:187], v[186:187], v[4:5] op_sel_hi:[1,0]
    v_mfma_f32_16x16x32_bf16 v[180:183], v[244:247], v[72:75], v[180:183]
    v_pk_mul_f32 v[188:189], v[188:189], v[4:5] op_sel_hi:[1,0]
    v_pk_mul_f32 v[190:191], v[190:191], v[4:5] op_sel_hi:[1,0]
    v_mfma_f32_16x16x32_bf16 v[184:187], v[248:251], v[72:75], v[184:187]
    s_nop 0
    v_mfma_f32_16x16x32_bf16 v[188:191], v[252:255], v[72:75], v[188:191]
    v_fma_f32 v23, v23, v4, v64
    v_add_f32 v23, v23, v65
    v_add_f32 v23, v23, v66
    v_add_f32 v23, v23, v67
    v_add_f32 v23, v23, v68
    v_add_f32 v23, v23, v69
    v_add_f32 v23, v23, v70
    v_add_f32 v23, v23, v71
    s_add_u32 s27, s27, 1
    s_cmp_lt_u32 s27, 16
    s_cbranch_scc1 L_CT
    s_waitcnt vmcnt(0)
    s_barrier
    v_mov_b32 v4, v23
    s_nop 1
    v_permlane32_swap_b32 v23, v4
    v_add_f32 v23, v23, v4
    v_mov_b32 v4, v23
    s_nop 1
    v_permlane16_swap_b32 v23, v4
    v_add_f32 v23, v23, v4
    v_and_b32 v3, 15, v0
    v_lshlrev_b32 v5, 3, v3
    s_lshl_b32 s24, s72, 8
    s_lshl_b32 s25, s28, 7
    s_add_u32 s24, s24, s25
    s_add_u32 s24, s24, 0x120000
    s_cmp_lg_u32 s29, 0
    s_cbranch_scc1 L_C_ml
    s_mov_b64 exec, 0xffff
    buffer_store_dwordx2 v[22:23], v5, s[12:15], s24 offen sc1
    s_mov_b64 exec, -1
L_C_ml:
    v_lshrrev_b32 v4, 4, v0
    v_mul_u32_u24 v3, 528, v3
    v_lshl_add_u32 v3, v4, 3, v3
    s_mul_i32 s24, s3, 8448
    v_add_u32 v3, s24, v3
    v_cvt_pk_bf16_f32 v32, v128, v129
    v_cvt_pk_bf16_f32 v33, v130, v131
    ds_write_b64 v3, v[32:33] offset:0
    v_cvt_pk_bf16_f32 v34, v132, v133
    v_cvt_pk_bf16_f32 v35, v134, v135
    ds_write_b64 v3, v[34:35] offset:32
    v_cvt_pk_bf16_f32 v36, v136, v137
    v_cvt_pk_bf16_f32 v37, v138, v139
    ds_write_b64 v3, v[36:37] offset:64
    v_cvt_pk_bf16_f32 v38, v140, v141
    v_cvt_pk_bf16_f32 v39, v142, v143
    ds_write_b64 v3, v[38:39] offset:96
    v_cvt_pk_bf16_f32 v40, v144, v145
    v_cvt_pk_bf16_f32 v41, v146, v147
    ds_write_b64 v3, v[40:41] offset:128
    v_cvt_pk_bf16_f32 v42, v148, v149
    v_cvt_pk_bf16_f32 v43, v150, v151
    ds_write_b64 v3, v[42:43] offset:160
    v_cvt_pk_bf16_f32 v44, v152, v153
    v_cvt_pk_bf16_f32 v45, v154, v155
    ds_write_b64 v3, v[44:45] offset:192
    v_cvt_pk_bf16_f32 v46, v156, v157
    v_cvt_pk_bf16_f32 v47, v158, v159
    ds_write_b64 v3, v[46:47] offset:224
    v_cvt_pk_bf16_f32 v32, v160, v161
    v_cvt_pk_bf16_f32 v33, v162, v163
    ds_write_b64 v3, v[32:33] offset:256
    v_cvt_pk_bf16_f32 v34, v164, v165
    v_cvt_pk_bf16_f32 v35, v166, v167
    ds_write_b64 v3, v[34:35] offset:288
    v_cvt_pk_bf16_f32 v36, v168, v169
    v_cvt_pk_bf16_f32 v37, v170, v171
    ds_write_b64 v3, v[36:37] offset:320
    v_cvt_pk_bf16_f32 v38, v172, v173
    v_cvt_pk_bf16_f32 v39, v174, v175
    ds_write_b64 v3, v[38:39] offset:352
    v_cvt_pk_bf16_f32 v40, v176, v177
    v_cvt_pk_bf16_f32 v41, v178, v179
    ds_write_b64 v3, v[40:41] offset:384
    v_cvt_pk_bf16_f32 v42, v180, v181
    v_cvt_pk_bf16_f32 v43, v182, v183
    ds_write_b64 v3, v[42:43] offset:416
    v_cvt_pk_bf16_f32 v44, v184, v185
    v_cvt_pk_bf16_f32 v45, v186, v187
    ds_write_b64 v3, v[44:45] offset:448
    v_cvt_pk_bf16_f32 v46, v188, v189
    v_cvt_pk_bf16_f32 v47, v190, v191
    ds_write_b64 v3, v[46:47] offset:480
    v_lshrrev_b32 v4, 5, v0
    v_and_b32 v5, 31, v0
    v_mul_u32_u24 v3, 528, v4
    v_lshl_add_u32 v3, v5, 4, v3
    v_add_u32 v3, s24, v3
    v_lshlrev_b32 v4, 15, v4
    v_lshl_add_u32 v4, v5, 4, v4
    s_waitcnt lgkmcnt(0)
    ds_read_b128 v[64:67], v3 offset:0
    ds_read_b128 v[68:71], v3 offset:1056
    ds_read_b128 v[72:75], v3 offset:2112
    ds_read_b128 v[76:79], v3 offset:3168
    ds_read_b128 v[80:83], v3 offset:4224
    ds_read_b128 v[84:87], v3 offset:5280
    ds_read_b128 v[88:91], v3 offset:6336
    ds_read_b128 v[92:95], v3 offset:7392
    s_lshl_b32 s24, s72, 10
    s_lshl_b32 s25, s29, 9
    s_add_u32 s24, s24, s25
    s_lshl_b32 s25, s28, 19
    s_add_u32 s24, s24, s25
    s_add_u32 s24, s24, 0x20000
    s_waitcnt lgkmcnt(7)
    buffer_store_dwordx4 v[64:67], v4, s[12:15], s24 offen sc1
    s_add_u32 s24, s24, 0x10000
    s_waitcnt lgkmcnt(6)
    buffer_store_dwordx4 v[68:71], v4, s[12:15], s24 offen sc1
    s_add_u32 s24, s24, 0x10000
    s_waitcnt lgkmcnt(5)
    buffer_store_dwordx4 v[72:75], v4, s[12:15], s24 offen sc1
    s_add_u32 s24, s24, 0x10000
    s_waitcnt lgkmcnt(4)
    buffer_store_dwordx4 v[76:79], v4, s[12:15], s24 offen sc1
    s_add_u32 s24, s24, 0x10000
    s_waitcnt lgkmcnt(3)
    buffer_store_dwordx4 v[80:83], v4, s[12:15], s24 offen sc1
    s_add_u32 s24, s24, 0x10000
    s_waitcnt lgkmcnt(2)
    buffer_store_dwordx4 v[84:87], v4, s[12:15], s24 offen sc1
    s_add_u32 s24, s24, 0x10000
    s_waitcnt lgkmcnt(1)
    buffer_store_dwordx4 v[88:91], v4, s[12:15], s24 offen sc1
    s_add_u32 s24, s24, 0x10000
    s_waitcnt lgkmcnt(0)
    buffer_store_dwordx4 v[92:95], v4, s[12:15], s24 offen sc1
    s_add_u32 s24, s24, 0x10000
    s_waitcnt vmcnt(0)
    s_barrier
    s_cmp_lg_u32 s3, 0
    s_cbranch_scc1 L_sig23
    s_mov_b64 exec, 1
    v_mov_b32 v3, 1
    buffer_atomic_add v3, off, s[16:19], 0 offset:4 sc0
    s_waitcnt vmcnt(0)
    v_readfirstlane_b32 s24, v3
    s_mov_b64 exec, -1
    s_and_b32 s24, s24, 31
    s_cmp_lg_u32 s24, 31
    s_cbranch_scc1 L_sig23
    v_lshlrev_b32 v4, 7, v0
    v_mov_b32 v3, 1
    s_mov_b32 s24, 0x170000
    buffer_store_dword v3, v4, s[12:15], s24 offen offset:4 sc1
L_sig23:
    s_branch L_R
L_last:
    s_endpgm
.section .rodata,"a"
.p2align 6
.amdhsa_kernel concat_heads__compressed_kv_cla__mha_block_cached__decode_kernel
  .amdhsa_next_free_vgpr 512
  .amdhsa_next_free_sgpr 102
  .amdhsa_accum_offset 256
  .amdhsa_group_segment_fixed_size 0
  .amdhsa_kernarg_size 112
  .amdhsa_user_sgpr_count 2
  .amdhsa_user_sgpr_kernarg_segment_ptr 1
  .amdhsa_system_sgpr_workgroup_id_x 1
  .amdhsa_float_denorm_mode_32 3
.end_amdhsa_kernel
```

```asm
; @launch grid=(256,1,1) block=(256,1,1) lds=149504
.amdgcn_target "amdgcn-amd-amdhsa--gfx950"
.text
.globl concat_heads__compressed_kv_cla__mha_block_cached__decode_kernel
.p2align 8
.type concat_heads__compressed_kv_cla__mha_block_cached__decode_kernel,@function
concat_heads__compressed_kv_cla__mha_block_cached__decode_kernel:
    s_load_dwordx16 s[36:51], s[0:1], 0
    s_load_dwordx8 s[52:59], s[0:1], 64
    s_load_dwordx4 s[60:63], s[0:1], 96
    s_cmp_ge_u32 s2, 256
    s_cbranch_scc1 L_end
    v_lshrrev_b32 v1, 6, v0
    v_and_b32 v0, 63, v0
    v_readfirstlane_b32 s3, v1
    v_lshlrev_b32 v2, 4, v0
    s_cmp_lt_u32 s2, 64
    s_cbranch_scc1 L_A
L_B:
    s_getpc_b64 s[20:21]
L_pc1:
    s_sub_u32 s20, s20, L_pc1-L_B
    s_subb_u32 s21, s21, 0
    s_mov_b32 s22, L_A-L_B
    s_mov_b32 s23, 0x20000
    v_lshl_add_u32 v3, v0, 2, s3
    v_lshlrev_b32 v3, 7, v3
    buffer_load_dword v17, v3, s[20:23], 0 offen
    s_sub_u32 s24, s2, 64
    s_and_b32 s25, s24, 7
    s_lshr_b32 s24, s24, 3
    s_mul_i32 s26, s24, 43
    s_lshr_b32 s26, s26, 8
    s_mul_i32 s27, s26, 6
    s_sub_u32 s27, s24, s27
    s_lshl_b32 s74, s24, 2
    s_add_u32 s74, s74, s3
    s_mov_b32 s70, 0x5040100
    s_mov_b32 s71, 0xd0c0908
    s_lshl_b32 s25, s25, 3
    s_lshr_b64 s[70:71], s[70:71], s25
    s_lshl_b32 s26, s26, 3
    s_lshr_b32 s26, 0x12100200, s26
    s_or_b32 s26, s26, s70
    s_and_b32 s26, s26, 31
    v_lshrrev_b32 v3, 4, v0
    v_lshlrev_b32 v4, 3, v3
    v_mov_b32 v6, 0x12100200
    v_lshrrev_b32 v4, v4, v6
    v_or_b32 v4, s70, v4
    v_and_b32 v4, 31, v4
    v_and_b32 v6, 0xf0, v2
    v_lshl_add_u32 v24, v4, 8, v6
    v_lshl_add_u32 v25, v4, 17, v6
    s_and_b32 s25, s2, 3
    s_lshl_b32 s25, s25, 10
    v_add_u32 v26, s25, v2
    s_bfe_u32 s25, s2, 0x10002
    s_lshl_b32 s25, s25, 23
    v_add_u32 v26, s25, v26
    s_cmp_ge_u32 s27, 3
    s_cselect_b32 s28, 1, 0
    s_mul_i32 s29, s28, 3
    s_sub_u32 s29, s27, s29
    s_lshr_b32 s72, s3, 1
    s_lshl_b32 s24, s28, 1
    s_add_u32 s72, s72, s24
    s_and_b32 s31, s3, 1
    s_lshl_b32 s24, s29, 1
    s_add_u32 s31, s31, s24
    s_lshl_b32 s30, s72, 5
    s_add_u32 s30, s30, s26
    s_lshl_b32 s30, s30, 20
    v_lshrrev_b32 v3, 4, v0
    v_and_b32 v4, 3, v0
    v_lshlrev_b32 v5, 6, v3
    v_lshl_add_u32 v5, v4, 4, v5
    v_bfe_u32 v1, v0, 2, 2
    v_lshl_add_u32 v1, v1, 8, v5
    s_mul_i32 s35, s31, 1024
    s_mov_b32 s32, s35
    s_mov_b32 s6, 0x100000
    s_mov_b32 s7, 0x20000
    s_waitcnt lgkmcnt(0)
    s_add_u32 s4, s50, s30
    s_addc_u32 s5, s51, 0
    s_mov_b32 s8, s54
    s_mov_b32 s9, s55
    s_mov_b32 s10, 0x400000
    s_mov_b32 s11, 0x20000
L_pfb:
    s_lshl_b32 s24, s74, 13
    s_waitcnt vmcnt(6)
    buffer_load_dwordx4 v[28:31], v24, s[8:11], s24 offen
    s_add_u32 s74, s74, 96
    s_cmp_lt_u32 s74, 512
    s_cbranch_scc1 L_pfb
L_pgb:
    s_sub_u32 s74, s74, 512
    s_mov_b32 s8, s40
    s_mov_b32 s9, s41
    s_mov_b32 s10, 0x400000
    s_mov_b32 s11, 0x20000
L_pfq:
    s_lshl_b32 s24, s74, 13
    s_waitcnt vmcnt(6)
    buffer_load_dwordx4 v[28:31], v24, s[8:11], s24 offen
    s_add_u32 s74, s74, 96
    s_cmp_lt_u32 s74, 512
    s_cbranch_scc1 L_pfq
L_pgq:
    s_sub_u32 s74, s74, 512
    s_mov_b32 s8, s42
    s_mov_b32 s9, s43
    s_mov_b32 s10, 0x400000
    s_mov_b32 s11, 0x20000
L_pfk:
    s_lshl_b32 s24, s74, 13
    s_waitcnt vmcnt(6)
    buffer_load_dwordx4 v[28:31], v24, s[8:11], s24 offen
    s_add_u32 s74, s74, 96
    s_cmp_lt_u32 s74, 512
    s_cbranch_scc1 L_pfk
L_pgk:
    s_sub_u32 s74, s74, 512
    s_mov_b32 s8, s56
    s_mov_b32 s9, s57
    s_mov_b32 s10, 0x400000
    s_mov_b32 s11, 0x20000
L_pfo:
    s_lshl_b32 s24, s74, 8
    s_waitcnt vmcnt(6)
    buffer_load_dwordx4 v[28:31], v25, s[8:11], s24 offen
    s_add_u32 s74, s74, 96
    s_cmp_lt_u32 s74, 512
    s_cbranch_scc1 L_pfo
L_pgo:
    s_sub_u32 s74, s74, 512
    s_mov_b32 s8, s44
    s_mov_b32 s9, s45
    s_mov_b32 s10, 0x400000
    s_mov_b32 s11, 0x20000
L_pfu:
    s_lshl_b32 s24, s74, 13
    s_waitcnt vmcnt(6)
    buffer_load_dwordx4 v[28:31], v24, s[8:11], s24 offen
    s_add_u32 s74, s74, 96
    s_cmp_lt_u32 s74, 512
    s_cbranch_scc1 L_pfu
L_pgu:
    s_sub_u32 s74, s74, 512
    s_mov_b32 s8, s46
    s_mov_b32 s9, s47
    s_mov_b32 s10, 0x400000
    s_mov_b32 s11, 0x20000
L_pfv:
    s_lshl_b32 s24, s74, 8
    s_waitcnt vmcnt(6)
    buffer_load_dwordx4 v[28:31], v25, s[8:11], s24 offen
    s_add_u32 s74, s74, 96
    s_cmp_lt_u32 s74, 512
    s_cbranch_scc1 L_pfv
L_pgv:
    s_sub_u32 s74, s74, 512
    s_mov_b32 s8, s38
    s_mov_b32 s9, s39
    s_mov_b32 s10, 0x1000000
    s_mov_b32 s11, 0x20000
L_pfc:
    s_lshl_b32 s24, s74, 12
    s_waitcnt vmcnt(6)
    buffer_load_dwordx4 v[28:31], v26, s[8:11], s24 offen
    s_add_u32 s74, s74, 96
    s_cmp_lt_u32 s74, 2048
    s_cbranch_scc1 L_pfc
L_pgc:
    s_sub_u32 s74, s74, 2048
    s_waitcnt vmcnt(15)
    buffer_load_dwordx4 a[0:3], v1, s[4:7], s32 offen offset:0 nt
    s_add_u32 s32, s32, 6144
    s_waitcnt vmcnt(15)
    buffer_load_dwordx4 a[4:7], v1, s[4:7], s32 offen offset:0 nt
    s_add_u32 s32, s32, 6144
    s_waitcnt vmcnt(15)
    buffer_load_dwordx4 a[8:11], v1, s[4:7], s32 offen offset:0 nt
    s_add_u32 s32, s32, 6144
    s_waitcnt vmcnt(15)
    buffer_load_dwordx4 a[12:15], v1, s[4:7], s32 offen offset:0 nt
    s_add_u32 s32, s32, 6144
    s_waitcnt vmcnt(15)
    buffer_load_dwordx4 a[16:19], v1, s[4:7], s32 offen offset:0 nt
    s_add_u32 s32, s32, 6144
    s_waitcnt vmcnt(15)
    buffer_load_dwordx4 a[20:23], v1, s[4:7], s32 offen offset:0 nt
    s_add_u32 s32, s32, 6144
    s_waitcnt vmcnt(15)
    buffer_load_dwordx4 a[24:27], v1, s[4:7], s32 offen offset:0 nt
    s_add_u32 s32, s32, 6144
    s_waitcnt vmcnt(15)
    buffer_load_dwordx4 a[28:31], v1, s[4:7], s32 offen offset:0 nt
    s_add_u32 s32, s32, 6144
    s_waitcnt vmcnt(15)
    buffer_load_dwordx4 a[32:35], v1, s[4:7], s32 offen offset:0 nt
    s_add_u32 s32, s32, 6144
    s_waitcnt vmcnt(15)
    buffer_load_dwordx4 a[36:39], v1, s[4:7], s32 offen offset:0 nt
    s_add_u32 s32, s32, 6144
    s_waitcnt vmcnt(15)
    buffer_load_dwordx4 a[40:43], v1, s[4:7], s32 offen offset:0 nt
    s_add_u32 s32, s32, 6144
    s_waitcnt vmcnt(15)
    buffer_load_dwordx4 a[44:47], v1, s[4:7], s32 offen offset:0 nt
    s_add_u32 s32, s32, 6144
    s_waitcnt vmcnt(15)
    buffer_load_dwordx4 a[48:51], v1, s[4:7], s32 offen offset:0 nt
    s_add_u32 s32, s32, 6144
    s_waitcnt vmcnt(15)
    buffer_load_dwordx4 a[52:55], v1, s[4:7], s32 offen offset:0 nt
    s_add_u32 s32, s32, 6144
    s_waitcnt vmcnt(15)
    buffer_load_dwordx4 a[56:59], v1, s[4:7], s32 offen offset:0 nt
    s_add_u32 s32, s32, 6144
    s_waitcnt vmcnt(15)
    buffer_load_dwordx4 a[60:63], v1, s[4:7], s32 offen offset:0 nt
    s_add_u32 s32, s32, 6144
    s_mov_b32 s12, s62
    s_mov_b32 s13, s63
    s_mov_b32 s14, 0x400000
    s_mov_b32 s15, 0x20000
    s_mov_b32 s16, s60
    s_mov_b32 s17, s61
    s_mov_b32 s18, 0x100
    s_mov_b32 s19, 0x20000
    v_and_b32 v3, 1, v0
    v_lshlrev_b32 v3, 4, v3
    v_mov_b32 v4, 0xffff
    v_lshlrev_b32 v4, v3, v4
    v_bfe_u32 v3, v0, 1, 2
    v_cmp_eq_u32 vcc, 0, v3
    s_nop 1
    v_cndmask_b32 v20, 0, v4, vcc
    v_cmp_eq_u32 vcc, 1, v3
    s_nop 1
    v_cndmask_b32 v21, 0, v4, vcc
    v_cmp_eq_u32 vcc, 2, v3
    s_nop 1
    v_cndmask_b32 v22, 0, v4, vcc
    v_cmp_eq_u32 vcc, 3, v3
    s_nop 1
    v_cndmask_b32 v23, 0, v4, vcc
    s_mov_b32 s64, 0x22222222
    s_mov_b32 s65, 0x22222222
    s_mov_b32 s66, 0x44444444
    s_mov_b32 s67, 0x44444444
    s_mov_b32 s68, 0x88888888
    s_mov_b32 s69, 0x88888888
    v_mov_b32 v32, 0
    v_mov_b32 v33, 0
    v_mov_b32 v34, 0
    v_mov_b32 v35, 0
    v_mov_b32 v36, 0
    v_mov_b32 v37, 0
    v_mov_b32 v38, 0
    v_mov_b32 v39, 0
    v_mov_b32 v40, 0
    v_mov_b32 v41, 0
    v_mov_b32 v42, 0
    v_mov_b32 v43, 0
    v_mov_b32 v44, 0
    v_mov_b32 v45, 0
    v_mov_b32 v46, 0
    v_mov_b32 v47, 0
    s_lshl_b32 s33, s26, 2
    s_add_u32 s33, s33, s72
    s_lshl_b32 s34, s33, 8
    s_add_u32 s34, s34, 0x164000
    s_mul_i32 s73, s33, 6
    s_add_u32 s73, s73, s31
    s_lshl_b32 s73, s73, 8
    s_add_u32 s73, s73, 0x180000
    s_mov_b64 exec, 1
    buffer_load_dword v61, off, s[16:19], 0 offset:128 sc1
    s_mov_b64 exec, -1
    s_waitcnt vmcnt(15)
    buffer_load_dwordx4 v[64:67], v1, s[4:7], s32 offen offset:0 nt
    s_add_u32 s32, s32, 6144
    s_waitcnt vmcnt(15)
    buffer_load_dwordx4 v[68:71], v1, s[4:7], s32 offen offset:0 nt
    s_add_u32 s32, s32, 6144
    s_waitcnt vmcnt(15)
    buffer_load_dwordx4 v[72:75], v1, s[4:7], s32 offen offset:0 nt
    s_add_u32 s32, s32, 6144
    s_waitcnt vmcnt(15)
    buffer_load_dwordx4 v[76:79], v1, s[4:7], s32 offen offset:0 nt
    s_add_u32 s32, s32, 6144
    s_waitcnt vmcnt(15)
    buffer_load_dwordx4 v[80:83], v1, s[4:7], s32 offen offset:0 nt
    s_add_u32 s32, s32, 6144
    s_waitcnt vmcnt(15)
    buffer_load_dwordx4 v[84:87], v1, s[4:7], s32 offen offset:0 nt
    s_add_u32 s32, s32, 6144
    s_waitcnt vmcnt(15)
    buffer_load_dwordx4 v[88:91], v1, s[4:7], s32 offen offset:0 nt
    s_add_u32 s32, s32, 6144
    s_waitcnt vmcnt(15)
    buffer_load_dwordx4 v[92:95], v1, s[4:7], s32 offen offset:0 nt
    s_add_u32 s32, s32, 6144
    s_waitcnt vmcnt(8)
    v_readfirstlane_b32 s25, v61
    s_nop 0
    s_cmp_ge_u32 s25, 32
    s_cbranch_scc1 L_B_q
    s_mov_b32 s24, 262144
    s_mov_b64 exec, 1
L_aw2:
    buffer_load_dword v61, off, s[16:19], 0 offset:128 sc1
    s_waitcnt vmcnt(0)
    v_readfirstlane_b32 s25, v61
    s_nop 0
    s_cmp_ge_u32 s25, 32
    s_cbranch_scc1 L_B_q
    s_sleep 16
    s_sub_u32 s24, s24, 1
    s_cmp_lg_u32 s24, 0
    s_cbranch_scc1 L_aw2
L_B_q:
    s_mov_b64 exec, -1
    buffer_load_dwordx4 v[8:11], v5, s[12:15], s34 offen sc1
    s_waitcnt vmcnt(15)
    buffer_load_dwordx4 v[96:99], v1, s[4:7], s32 offen offset:0 nt
    s_add_u32 s32, s32, 6144
    s_waitcnt vmcnt(15)
    buffer_load_dwordx4 v[100:103], v1, s[4:7], s32 offen offset:0 nt
    s_add_u32 s32, s32, 6144
    s_waitcnt vmcnt(15)
    buffer_load_dwordx4 v[104:107], v1, s[4:7], s32 offen offset:0 nt
    s_add_u32 s32, s32, 6144
    s_waitcnt vmcnt(15)
    buffer_load_dwordx4 v[108:111], v1, s[4:7], s32 offen offset:0 nt
    s_add_u32 s32, s32, 6144
    s_waitcnt vmcnt(15)
    buffer_load_dwordx4 v[112:115], v1, s[4:7], s32 offen offset:0 nt
    s_add_u32 s32, s32, 6144
    s_waitcnt vmcnt(15)
    buffer_load_dwordx4 v[116:119], v1, s[4:7], s32 offen offset:0 nt
    s_add_u32 s32, s32, 6144
    s_waitcnt vmcnt(15)
    buffer_load_dwordx4 v[120:123], v1, s[4:7], s32 offen offset:0 nt
    s_add_u32 s32, s32, 6144
    s_waitcnt vmcnt(15)
    buffer_load_dwordx4 v[124:127], v1, s[4:7], s32 offen offset:0 nt
    s_add_u32 s32, s32, 6144
    s_waitcnt vmcnt(8)
    v_mov_b32_dpp v32, v8 quad_perm:[0,1,2,3] row_mask:0xf bank_mask:0x1
    v_mov_b32_dpp v33, v9 quad_perm:[0,1,2,3] row_mask:0xf bank_mask:0x1
    v_mov_b32_dpp v34, v10 quad_perm:[0,1,2,3] row_mask:0xf bank_mask:0x1
    v_mov_b32_dpp v35, v11 quad_perm:[0,1,2,3] row_mask:0xf bank_mask:0x1
    v_mov_b32_dpp v36, v8 quad_perm:[0,1,2,3] row_mask:0xf bank_mask:0x2
    v_mov_b32_dpp v37, v9 quad_perm:[0,1,2,3] row_mask:0xf bank_mask:0x2
    v_mov_b32_dpp v38, v10 quad_perm:[0,1,2,3] row_mask:0xf bank_mask:0x2
    v_mov_b32_dpp v39, v11 quad_perm:[0,1,2,3] row_mask:0xf bank_mask:0x2
    v_mov_b32_dpp v40, v8 quad_perm:[0,1,2,3] row_mask:0xf bank_mask:0x4
    v_mov_b32_dpp v41, v9 quad_perm:[0,1,2,3] row_mask:0xf bank_mask:0x4
    v_mov_b32_dpp v42, v10 quad_perm:[0,1,2,3] row_mask:0xf bank_mask:0x4
    v_mov_b32_dpp v43, v11 quad_perm:[0,1,2,3] row_mask:0xf bank_mask:0x4
    v_mov_b32_dpp v44, v8 quad_perm:[0,1,2,3] row_mask:0xf bank_mask:0x8
    v_mov_b32_dpp v45, v9 quad_perm:[0,1,2,3] row_mask:0xf bank_mask:0x8
    v_mov_b32_dpp v46, v10 quad_perm:[0,1,2,3] row_mask:0xf bank_mask:0x8
    v_mov_b32_dpp v47, v11 quad_perm:[0,1,2,3] row_mask:0xf bank_mask:0x8
    s_mov_b32 s27, 1
L_BK:
    s_cmp_lg_u32 s27, 10
    s_cbranch_scc1 L_BK_a
    s_add_u32 s4, s52, s30
    s_addc_u32 s5, s53, 0
    s_mov_b32 s32, s35
    v_mov_b32 v1, v2
L_BK_a:
    s_barrier
    s_cmp_lg_u32 s27, 8
    s_cbranch_scc1 L_BV_x0
    s_lshl_b32 s24, s26, 7
    s_add_u32 s24, s24, 0x1b6000
    s_mov_b64 exec, 1
    buffer_load_dwordx2 v[62:63], off, s[12:15], s24 sc1
    s_mov_b64 exec, -1
L_BV_x0:
    s_cmp_lg_u32 s27, 9
    s_cbranch_scc1 L_BV_x1
    s_getreg_b32 s75, hwreg(HW_REG_XCC_ID, 0, 4)
    v_readfirstlane_b32 s24, v62
    v_readfirstlane_b32 s25, v63
    s_xor_b32 s24, s24, s75
    s_xor_b32 s25, s25, s75
    s_or_b32 s75, s24, s25
L_BV_x1:
    v_mov_b32 v49, v50
    v_mov_b32 v50, v51
    v_mov_b32 v51, v52
    v_mov_b32 v52, v53
    v_mov_b32 v53, v54
    v_mov_b32 v54, v55
    v_mov_b32 v55, v56
    v_mov_b32 v56, v57
    v_mov_b32 v57, v58
    s_waitcnt vmcnt(15)
    v_mfma_f32_16x16x32_bf16 v[12:15], v[64:67], v[32:35], 0
    buffer_load_dwordx4 v[64:67], v1, s[4:7], s32 offen offset:0 nt
    s_add_u32 s32, s32, 6144
    s_waitcnt vmcnt(15)
    v_mfma_f32_16x16x32_bf16 v[12:15], v[68:71], v[36:39], v[12:15]
    buffer_load_dwordx4 v[68:71], v1, s[4:7], s32 offen offset:0 nt
    s_add_u32 s32, s32, 6144
    s_waitcnt vmcnt(15)
    v_mfma_f32_16x16x32_bf16 v[12:15], v[72:75], v[40:43], v[12:15]
    buffer_load_dwordx4 v[72:75], v1, s[4:7], s32 offen offset:0 nt
    s_add_u32 s32, s32, 6144
    s_waitcnt vmcnt(15)
    v_mfma_f32_16x16x32_bf16 v[12:15], v[76:79], v[44:47], v[12:15]
    buffer_load_dwordx4 v[76:79], v1, s[4:7], s32 offen offset:0 nt
    s_add_u32 s32, s32, 6144
    s_nop 5
    v_add_f32_dpp v58, v13, v12 quad_perm:[1,1,1,1] row_mask:0xf bank_mask:0xf
    s_nop 1
    v_add_f32_dpp v58, v14, v58 quad_perm:[2,2,2,2] row_mask:0xf bank_mask:0xf
    s_nop 1
    v_add_f32_dpp v58, v15, v58 quad_perm:[3,3,3,3] row_mask:0xf bank_mask:0xf
    s_waitcnt vmcnt(15)
    v_mfma_f32_16x16x32_bf16 v[16:19], v[80:83], v[32:35], 0
    buffer_load_dwordx4 v[80:83], v1, s[4:7], s32 offen offset:0 nt
    s_add_u32 s32, s32, 6144
    s_waitcnt vmcnt(15)
    v_mfma_f32_16x16x32_bf16 v[16:19], v[84:87], v[36:39], v[16:19]
    buffer_load_dwordx4 v[84:87], v1, s[4:7], s32 offen offset:0 nt
    s_add_u32 s32, s32, 6144
    s_waitcnt vmcnt(15)
    v_mfma_f32_16x16x32_bf16 v[16:19], v[88:91], v[40:43], v[16:19]
    buffer_load_dwordx4 v[88:91], v1, s[4:7], s32 offen offset:0 nt
    s_add_u32 s32, s32, 6144
    s_waitcnt vmcnt(15)
    v_mfma_f32_16x16x32_bf16 v[16:19], v[92:95], v[44:47], v[16:19]
    buffer_load_dwordx4 v[92:95], v1, s[4:7], s32 offen offset:0 nt
    s_add_u32 s32, s32, 6144
    s_nop 5
    v_add_f32_dpp v3, v16, v17 quad_perm:[0,0,0,0] row_mask:0xf bank_mask:0xf
    s_nop 1
    v_add_f32_dpp v3, v18, v3 quad_perm:[2,2,2,2] row_mask:0xf bank_mask:0xf
    s_nop 1
    v_add_f32_dpp v3, v19, v3 quad_perm:[3,3,3,3] row_mask:0xf bank_mask:0xf
    v_cndmask_b32 v58, v58, v3, s[64:65]
    s_waitcnt vmcnt(15)
    v_mfma_f32_16x16x32_bf16 v[12:15], v[96:99], v[32:35], 0
    buffer_load_dwordx4 v[96:99], v1, s[4:7], s32 offen offset:0 nt
    s_add_u32 s32, s32, 6144
    s_waitcnt vmcnt(15)
    v_mfma_f32_16x16x32_bf16 v[12:15], v[100:103], v[36:39], v[12:15]
    buffer_load_dwordx4 v[100:103], v1, s[4:7], s32 offen offset:0 nt
    s_add_u32 s32, s32, 6144
    s_waitcnt vmcnt(15)
    v_mfma_f32_16x16x32_bf16 v[12:15], v[104:107], v[40:43], v[12:15]
    buffer_load_dwordx4 v[104:107], v1, s[4:7], s32 offen offset:0 nt
    s_add_u32 s32, s32, 6144
    s_waitcnt vmcnt(15)
    v_mfma_f32_16x16x32_bf16 v[12:15], v[108:111], v[44:47], v[12:15]
    buffer_load_dwordx4 v[108:111], v1, s[4:7], s32 offen offset:0 nt
    s_add_u32 s32, s32, 6144
    s_nop 5
    v_add_f32_dpp v3, v12, v14 quad_perm:[0,0,0,0] row_mask:0xf bank_mask:0xf
    s_nop 1
    v_add_f32_dpp v3, v13, v3 quad_perm:[1,1,1,1] row_mask:0xf bank_mask:0xf
    s_nop 1
    v_add_f32_dpp v3, v15, v3 quad_perm:[3,3,3,3] row_mask:0xf bank_mask:0xf
    v_cndmask_b32 v58, v58, v3, s[66:67]
    s_waitcnt vmcnt(15)
    v_mfma_f32_16x16x32_bf16 v[16:19], v[112:115], v[32:35], 0
    buffer_load_dwordx4 v[112:115], v1, s[4:7], s32 offen offset:0 nt
    s_add_u32 s32, s32, 6144
    s_waitcnt vmcnt(15)
    v_mfma_f32_16x16x32_bf16 v[16:19], v[116:119], v[36:39], v[16:19]
    buffer_load_dwordx4 v[116:119], v1, s[4:7], s32 offen offset:0 nt
    s_add_u32 s32, s32, 6144
    s_waitcnt vmcnt(15)
    v_mfma_f32_16x16x32_bf16 v[16:19], v[120:123], v[40:43], v[16:19]
    buffer_load_dwordx4 v[120:123], v1, s[4:7], s32 offen offset:0 nt
    s_add_u32 s32, s32, 6144
    s_waitcnt vmcnt(15)
    v_mfma_f32_16x16x32_bf16 v[16:19], v[124:127], v[44:47], v[16:19]
    buffer_load_dwordx4 v[124:127], v1, s[4:7], s32 offen offset:0 nt
    s_add_u32 s32, s32, 6144
    s_nop 5
    v_add_f32_dpp v3, v16, v19 quad_perm:[0,0,0,0] row_mask:0xf bank_mask:0xf
    s_nop 1
    v_add_f32_dpp v3, v17, v3 quad_perm:[1,1,1,1] row_mask:0xf bank_mask:0xf
    s_nop 1
    v_add_f32_dpp v3, v18, v3 quad_perm:[2,2,2,2] row_mask:0xf bank_mask:0xf
    v_cndmask_b32 v58, v58, v3, s[68:69]
    s_cmp_lg_u32 s27, 1
    s_cbranch_scc1 L_BK_b0
    v_mfma_f32_16x16x32_bf16 v[12:15], a[0:3], v[32:35], 0
    v_mfma_f32_16x16x32_bf16 v[12:15], a[4:7], v[36:39], v[12:15]
    v_mfma_f32_16x16x32_bf16 v[12:15], a[8:11], v[40:43], v[12:15]
    v_mfma_f32_16x16x32_bf16 v[12:15], a[12:15], v[44:47], v[12:15]
    s_nop 7
    v_add_f32_dpp v48, v13, v12 quad_perm:[1,1,1,1] row_mask:0xf bank_mask:0xf
    s_nop 1
    v_add_f32_dpp v48, v14, v48 quad_perm:[2,2,2,2] row_mask:0xf bank_mask:0xf
    s_nop 1
    v_add_f32_dpp v48, v15, v48 quad_perm:[3,3,3,3] row_mask:0xf bank_mask:0xf
    v_mfma_f32_16x16x32_bf16 v[16:19], a[16:19], v[32:35], 0
    v_mfma_f32_16x16x32_bf16 v[16:19], a[20:23], v[36:39], v[16:19]
    v_mfma_f32_16x16x32_bf16 v[16:19], a[24:27], v[40:43], v[16:19]
    v_mfma_f32_16x16x32_bf16 v[16:19], a[28:31], v[44:47], v[16:19]
    s_nop 7
    v_add_f32_dpp v3, v16, v17 quad_perm:[0,0,0,0] row_mask:0xf bank_mask:0xf
    s_nop 1
    v_add_f32_dpp v3, v18, v3 quad_perm:[2,2,2,2] row_mask:0xf bank_mask:0xf
    s_nop 1
    v_add_f32_dpp v3, v19, v3 quad_perm:[3,3,3,3] row_mask:0xf bank_mask:0xf
    v_cndmask_b32 v48, v48, v3, s[64:65]
    v_mfma_f32_16x16x32_bf16 v[12:15], a[32:35], v[32:35], 0
    v_mfma_f32_16x16x32_bf16 v[12:15], a[36:39], v[36:39], v[12:15]
    v_mfma_f32_16x16x32_bf16 v[12:15], a[40:43], v[40:43], v[12:15]
    v_mfma_f32_16x16x32_bf16 v[12:15], a[44:47], v[44:47], v[12:15]
    s_nop 7
    v_add_f32_dpp v3, v12, v14 quad_perm:[0,0,0,0] row_mask:0xf bank_mask:0xf
    s_nop 1
    v_add_f32_dpp v3, v13, v3 quad_perm:[1,1,1,1] row_mask:0xf bank_mask:0xf
    s_nop 1
    v_add_f32_dpp v3, v15, v3 quad_perm:[3,3,3,3] row_mask:0xf bank_mask:0xf
    v_cndmask_b32 v48, v48, v3, s[66:67]
    v_mfma_f32_16x16x32_bf16 v[16:19], a[48:51], v[32:35], 0
    v_mfma_f32_16x16x32_bf16 v[16:19], a[52:55], v[36:39], v[16:19]
    v_mfma_f32_16x16x32_bf16 v[16:19], a[56:59], v[40:43], v[16:19]
    v_mfma_f32_16x16x32_bf16 v[16:19], a[60:63], v[44:47], v[16:19]
    s_nop 7
    v_add_f32_dpp v3, v16, v19 quad_perm:[0,0,0,0] row_mask:0xf bank_mask:0xf
    s_nop 1
    v_add_f32_dpp v3, v17, v3 quad_perm:[1,1,1,1] row_mask:0xf bank_mask:0xf
    s_nop 1
    v_add_f32_dpp v3, v18, v3 quad_perm:[2,2,2,2] row_mask:0xf bank_mask:0xf
    v_cndmask_b32 v48, v48, v3, s[68:69]
L_BK_b0:
    s_add_u32 s27, s27, 1
    s_cmp_lt_u32 s27, 11
    s_cbranch_scc1 L_BK
    v_and_b32 v3, 3, v0
    v_bfe_u32 v4, v0, 2, 2
    v_lshl_add_u32 v3, v3, 2, v4
    v_add_u32 v3, 160, v3
    v_lshrrev_b32 v3, 0, v3
    v_mul_u32_u24 v3, 6, v3
    v_add_u32 v3, s31, v3
    v_mov_b32 v4, 0xff800000
    v_cmp_gt_u32 vcc, 1024, v3
    s_nop 1
    v_cndmask_b32 v58, v4, v58, vcc
    v_max3_f32 v3, v48, v49, v50
    v_max3_f32 v3, v3, v51, v52
    v_max3_f32 v3, v3, v53, v54
    v_max3_f32 v3, v3, v55, v56
    v_max3_f32 v3, v3, v57, v58
    s_nop 1
    v_max_f32_dpp v3, v3, v3 row_ror:8 row_mask:0xf bank_mask:0xf
    s_nop 1
    v_max_f32_dpp v3, v3, v3 row_ror:4 row_mask:0xf bank_mask:0xf
    s_nop 1
    v_max_f32_dpp v3, v3, v3 row_ror:2 row_mask:0xf bank_mask:0xf
    s_nop 1
    v_max_f32_dpp v3, v3, v3 row_ror:1 row_mask:0xf bank_mask:0xf
    s_nop 1
    v_max_f32_dpp v3, v3, v3 row_bcast:15 row_mask:0xa bank_mask:0xf
    s_nop 1
    v_max_f32_dpp v3, v3, v3 row_bcast:31 row_mask:0xc bank_mask:0xf
    s_nop 0
    v_readlane_b32 s24, v3, 63
    s_mov_b32 s71, 0x3e0293ee
    v_mov_b32 v6, s71
    v_mul_f32 v6, s24, v6
    v_fma_f32 v48, v48, s71, -v6
    v_fma_f32 v49, v49, s71, -v6
    v_fma_f32 v50, v50, s71, -v6
    v_fma_f32 v51, v51, s71, -v6
    v_fma_f32 v52, v52, s71, -v6
    v_fma_f32 v53, v53, s71, -v6
    v_fma_f32 v54, v54, s71, -v6
    v_fma_f32 v55, v55, s71, -v6
    v_fma_f32 v56, v56, s71, -v6
    v_fma_f32 v57, v57, s71, -v6
    v_fma_f32 v58, v58, s71, -v6
    v_exp_f32 v48, v48
    v_exp_f32 v49, v49
    v_exp_f32 v50, v50
    v_exp_f32 v51, v51
    v_exp_f32 v52, v52
    v_exp_f32 v53, v53
    v_exp_f32 v54, v54
    v_exp_f32 v55, v55
    v_exp_f32 v56, v56
    v_exp_f32 v57, v57
    v_exp_f32 v58, v58
    v_add_f32 v7, v48, v49
    v_add_f32 v7, v7, v50
    v_add_f32 v7, v7, v51
    v_add_f32 v7, v7, v52
    v_add_f32 v7, v7, v53
    v_add_f32 v7, v7, v54
    v_add_f32 v7, v7, v55
    v_add_f32 v7, v7, v56
    v_add_f32 v7, v7, v57
    v_add_f32 v7, v7, v58
    v_cvt_pk_bf16_f32 v48, v48, v48
    v_cvt_pk_bf16_f32 v49, v49, v49
    v_cvt_pk_bf16_f32 v50, v50, v50
    v_cvt_pk_bf16_f32 v51, v51, v51
    v_cvt_pk_bf16_f32 v52, v52, v52
    v_cvt_pk_bf16_f32 v53, v53, v53
    v_cvt_pk_bf16_f32 v54, v54, v54
    v_cvt_pk_bf16_f32 v55, v55, v55
    v_cvt_pk_bf16_f32 v56, v56, v56
    v_cvt_pk_bf16_f32 v57, v57, v57
    v_cvt_pk_bf16_f32 v58, v58, v58
    v_add_f32_dpp v7, v7, v7 row_ror:8 row_mask:0xf bank_mask:0xf
    s_nop 1
    v_add_f32_dpp v7, v7, v7 row_ror:4 row_mask:0xf bank_mask:0xf
    s_nop 1
    v_add_f32_dpp v7, v7, v7 row_ror:2 row_mask:0xf bank_mask:0xf
    s_nop 1
    v_add_f32_dpp v7, v7, v7 row_ror:1 row_mask:0xf bank_mask:0xf
    s_nop 1
    v_add_f32_dpp v7, v7, v7 row_bcast:15 row_mask:0xa bank_mask:0xf
    s_nop 1
    v_add_f32_dpp v7, v7, v7 row_bcast:31 row_mask:0xc bank_mask:0xf
    s_nop 0
    v_readlane_b32 s70, v7, 63
    s_lshl_b32 s34, s2, 7
    s_add_u32 s34, s34, 0x1ae000
    s_lshl_b32 s25, s3, 4
    s_add_u32 s25, s25, s34
    s_mov_b64 exec, 1
    v_mov_b32 v7, s70
    s_cmp_eq_u32 s75, 0
    s_cbranch_scc0 L_B_mlf
    buffer_store_dwordx2 v[6:7], off, s[12:15], s25
    s_branch L_B_mld
L_B_mlf:
    buffer_store_dwordx2 v[6:7], off, s[12:15], s25 sc1
L_B_mld:
    s_mov_b64 exec, -1
    v_lshrrev_b32 v3, 4, v0
    v_lshlrev_b32 v60, 6, v3
    v_and_b32 v4, 7, v0
    v_lshl_add_u32 v60, v4, 3, v60
    v_mov_b32 v12, 0
    v_mov_b32 v13, 0
    v_mov_b32 v14, 0
    v_mov_b32 v15, 0
    s_mov_b32 s27, 0
L_BV:
    s_barrier
    s_cmp_ge_u32 s27, 1
    s_cselect_b32 s71, s3, 4
    s_cmp_lg_u32 s71, 0
    s_cbranch_scc1 L_BV_p0
    s_lshl_b32 s24, s27, 2
    s_add_u32 s24, s24, 0
    s_mov_b64 exec, 1
    v_mov_b32 v63, s24
    s_cmp_eq_u32 s75, 0
    s_cbranch_scc0 L_BV_q0
    buffer_store_dword v63, off, s[12:15], s34 offset:64
    s_branch L_BV_r0
L_BV_q0:
    buffer_store_dword v63, off, s[12:15], s34 offset:64 sc1
L_BV_r0:
    s_mov_b64 exec, -1
L_BV_p0:
    v_and_b32_dpp v8, v48, v20 row_newbcast:0 row_mask:0xf bank_mask:0xf
    v_and_b32_dpp v9, v48, v21 row_newbcast:0 row_mask:0xf bank_mask:0xf
    v_and_b32_dpp v10, v48, v22 row_newbcast:0 row_mask:0xf bank_mask:0xf
    v_and_b32_dpp v11, v48, v23 row_newbcast:0 row_mask:0xf bank_mask:0xf
    s_waitcnt vmcnt(15)
    s_nop 0
    v_mfma_f32_16x16x32_bf16 v[12:15], v[64:67], v[8:11], v[12:15]
    buffer_load_dwordx4 v[64:67], v1, s[4:7], s32 offen offset:0 nt
    s_add_u32 s32, s32, 6144
    v_and_b32_dpp v8, v48, v20 row_newbcast:4 row_mask:0xf bank_mask:0xf
    v_and_b32_dpp v9, v48, v21 row_newbcast:4 row_mask:0xf bank_mask:0xf
    v_and_b32_dpp v10, v48, v22 row_newbcast:4 row_mask:0xf bank_mask:0xf
    v_and_b32_dpp v11, v48, v23 row_newbcast:4 row_mask:0xf bank_mask:0xf
    s_waitcnt vmcnt(15)
    s_nop 0
    v_mfma_f32_16x16x32_bf16 v[12:15], v[68:71], v[8:11], v[12:15]
    buffer_load_dwordx4 v[68:71], v1, s[4:7], s32 offen offset:0 nt
    s_add_u32 s32, s32, 6144
    v_and_b32_dpp v8, v48, v20 row_newbcast:8 row_mask:0xf bank_mask:0xf
    v_and_b32_dpp v9, v48, v21 row_newbcast:8 row_mask:0xf bank_mask:0xf
    v_and_b32_dpp v10, v48, v22 row_newbcast:8 row_mask:0xf bank_mask:0xf
    v_and_b32_dpp v11, v48, v23 row_newbcast:8 row_mask:0xf bank_mask:0xf
    s_waitcnt vmcnt(15)
    s_nop 0
    v_mfma_f32_16x16x32_bf16 v[12:15], v[72:75], v[8:11], v[12:15]
    buffer_load_dwordx4 v[72:75], v1, s[4:7], s32 offen offset:0 nt
    s_add_u32 s32, s32, 6144
    v_and_b32_dpp v8, v48, v20 row_newbcast:12 row_mask:0xf bank_mask:0xf
    v_and_b32_dpp v9, v48, v21 row_newbcast:12 row_mask:0xf bank_mask:0xf
    v_and_b32_dpp v10, v48, v22 row_newbcast:12 row_mask:0xf bank_mask:0xf
    v_and_b32_dpp v11, v48, v23 row_newbcast:12 row_mask:0xf bank_mask:0xf
    s_waitcnt vmcnt(15)
    s_nop 0
    v_mfma_f32_16x16x32_bf16 v[12:15], v[76:79], v[8:11], v[12:15]
    buffer_load_dwordx4 v[76:79], v1, s[4:7], s32 offen offset:0 nt
    s_add_u32 s32, s32, 6144
    s_cmp_lg_u32 s71, 1
    s_cbranch_scc1 L_BV_p1
    s_lshl_b32 s24, s27, 2
    s_add_u32 s24, s24, 1
    s_mov_b64 exec, 1
    v_mov_b32 v63, s24
    s_cmp_eq_u32 s75, 0
    s_cbranch_scc0 L_BV_q1
    buffer_store_dword v63, off, s[12:15], s34 offset:64
    s_branch L_BV_r1
L_BV_q1:
    buffer_store_dword v63, off, s[12:15], s34 offset:64 sc1
L_BV_r1:
    s_mov_b64 exec, -1
L_BV_p1:
    v_and_b32_dpp v8, v48, v20 row_newbcast:1 row_mask:0xf bank_mask:0xf
    v_and_b32_dpp v9, v48, v21 row_newbcast:1 row_mask:0xf bank_mask:0xf
    v_and_b32_dpp v10, v48, v22 row_newbcast:1 row_mask:0xf bank_mask:0xf
    v_and_b32_dpp v11, v48, v23 row_newbcast:1 row_mask:0xf bank_mask:0xf
    s_waitcnt vmcnt(15)
    s_nop 0
    v_mfma_f32_16x16x32_bf16 v[12:15], v[80:83], v[8:11], v[12:15]
    buffer_load_dwordx4 v[80:83], v1, s[4:7], s32 offen offset:0 nt
    s_add_u32 s32, s32, 6144
    v_and_b32_dpp v8, v48, v20 row_newbcast:5 row_mask:0xf bank_mask:0xf
    v_and_b32_dpp v9, v48, v21 row_newbcast:5 row_mask:0xf bank_mask:0xf
    v_and_b32_dpp v10, v48, v22 row_newbcast:5 row_mask:0xf bank_mask:0xf
    v_and_b32_dpp v11, v48, v23 row_newbcast:5 row_mask:0xf bank_mask:0xf
    s_waitcnt vmcnt(15)
    s_nop 0
    v_mfma_f32_16x16x32_bf16 v[12:15], v[84:87], v[8:11], v[12:15]
    buffer_load_dwordx4 v[84:87], v1, s[4:7], s32 offen offset:0 nt
    s_add_u32 s32, s32, 6144
    v_and_b32_dpp v8, v48, v20 row_newbcast:9 row_mask:0xf bank_mask:0xf
    v_and_b32_dpp v9, v48, v21 row_newbcast:9 row_mask:0xf bank_mask:0xf
    v_and_b32_dpp v10, v48, v22 row_newbcast:9 row_mask:0xf bank_mask:0xf
    v_and_b32_dpp v11, v48, v23 row_newbcast:9 row_mask:0xf bank_mask:0xf
    s_waitcnt vmcnt(15)
    s_nop 0
    v_mfma_f32_16x16x32_bf16 v[12:15], v[88:91], v[8:11], v[12:15]
    buffer_load_dwordx4 v[88:91], v1, s[4:7], s32 offen offset:0 nt
    s_add_u32 s32, s32, 6144
    v_and_b32_dpp v8, v48, v20 row_newbcast:13 row_mask:0xf bank_mask:0xf
    v_and_b32_dpp v9, v48, v21 row_newbcast:13 row_mask:0xf bank_mask:0xf
    v_and_b32_dpp v10, v48, v22 row_newbcast:13 row_mask:0xf bank_mask:0xf
    v_and_b32_dpp v11, v48, v23 row_newbcast:13 row_mask:0xf bank_mask:0xf
    s_waitcnt vmcnt(15)
    s_nop 0
    v_mfma_f32_16x16x32_bf16 v[12:15], v[92:95], v[8:11], v[12:15]
    buffer_load_dwordx4 v[92:95], v1, s[4:7], s32 offen offset:0 nt
    s_add_u32 s32, s32, 6144
    s_cmp_lg_u32 s71, 2
    s_cbranch_scc1 L_BV_p2
    s_lshl_b32 s24, s27, 2
    s_add_u32 s24, s24, 2
    s_mov_b64 exec, 1
    v_mov_b32 v63, s24
    s_cmp_eq_u32 s75, 0
    s_cbranch_scc0 L_BV_q2
    buffer_store_dword v63, off, s[12:15], s34 offset:64
    s_branch L_BV_r2
L_BV_q2:
    buffer_store_dword v63, off, s[12:15], s34 offset:64 sc1
L_BV_r2:
    s_mov_b64 exec, -1
L_BV_p2:
    v_and_b32_dpp v8, v48, v20 row_newbcast:2 row_mask:0xf bank_mask:0xf
    v_and_b32_dpp v9, v48, v21 row_newbcast:2 row_mask:0xf bank_mask:0xf
    v_and_b32_dpp v10, v48, v22 row_newbcast:2 row_mask:0xf bank_mask:0xf
    v_and_b32_dpp v11, v48, v23 row_newbcast:2 row_mask:0xf bank_mask:0xf
    s_waitcnt vmcnt(15)
    s_nop 0
    v_mfma_f32_16x16x32_bf16 v[12:15], v[96:99], v[8:11], v[12:15]
    buffer_load_dwordx4 v[96:99], v1, s[4:7], s32 offen offset:0 nt
    s_add_u32 s32, s32, 6144
    v_and_b32_dpp v8, v48, v20 row_newbcast:6 row_mask:0xf bank_mask:0xf
    v_and_b32_dpp v9, v48, v21 row_newbcast:6 row_mask:0xf bank_mask:0xf
    v_and_b32_dpp v10, v48, v22 row_newbcast:6 row_mask:0xf bank_mask:0xf
    v_and_b32_dpp v11, v48, v23 row_newbcast:6 row_mask:0xf bank_mask:0xf
    s_waitcnt vmcnt(15)
    s_nop 0
    v_mfma_f32_16x16x32_bf16 v[12:15], v[100:103], v[8:11], v[12:15]
    buffer_load_dwordx4 v[100:103], v1, s[4:7], s32 offen offset:0 nt
    s_add_u32 s32, s32, 6144
    v_and_b32_dpp v8, v48, v20 row_newbcast:10 row_mask:0xf bank_mask:0xf
    v_and_b32_dpp v9, v48, v21 row_newbcast:10 row_mask:0xf bank_mask:0xf
    v_and_b32_dpp v10, v48, v22 row_newbcast:10 row_mask:0xf bank_mask:0xf
    v_and_b32_dpp v11, v48, v23 row_newbcast:10 row_mask:0xf bank_mask:0xf
    s_waitcnt vmcnt(15)
    s_nop 0
    v_mfma_f32_16x16x32_bf16 v[12:15], v[104:107], v[8:11], v[12:15]
    buffer_load_dwordx4 v[104:107], v1, s[4:7], s32 offen offset:0 nt
    s_add_u32 s32, s32, 6144
    s_cmp_lg_u32 s27, 10
    s_cbranch_scc1 L_BV_a
    s_mov_b32 exec_lo, 0x00ff00ff
    s_mov_b32 exec_hi, 0x00ff00ff
    s_cmp_eq_u32 s75, 0
    s_nop 0
    v_cvt_pk_bf16_f32 v4, v12, v13
    v_cvt_pk_bf16_f32 v5, v14, v15
    s_cbranch_scc0 L_BV_far
    buffer_store_dwordx2 v[4:5], v60, s[12:15], s73 offen
    s_branch L_BV_done
L_BV_far:
    buffer_store_dwordx2 v[4:5], v60, s[12:15], s73 offen sc1
L_BV_done:
    s_endpgm
L_BV_a:
    v_and_b32_dpp v8, v48, v20 row_newbcast:14 row_mask:0xf bank_mask:0xf
    v_and_b32_dpp v9, v48, v21 row_newbcast:14 row_mask:0xf bank_mask:0xf
    v_and_b32_dpp v10, v48, v22 row_newbcast:14 row_mask:0xf bank_mask:0xf
    v_and_b32_dpp v11, v48, v23 row_newbcast:14 row_mask:0xf bank_mask:0xf
    s_waitcnt vmcnt(15)
    s_nop 0
    v_mfma_f32_16x16x32_bf16 v[12:15], v[108:111], v[8:11], v[12:15]
    buffer_load_dwordx4 v[108:111], v1, s[4:7], s32 offen offset:0 nt
    s_add_u32 s32, s32, 6144
    s_cmp_lg_u32 s71, 3
    s_cbranch_scc1 L_BV_p3
    s_lshl_b32 s24, s27, 2
    s_add_u32 s24, s24, 3
    s_mov_b64 exec, 1
    v_mov_b32 v63, s24
    s_cmp_eq_u32 s75, 0
    s_cbranch_scc0 L_BV_q3
    buffer_store_dword v63, off, s[12:15], s34 offset:64
    s_branch L_BV_r3
L_BV_q3:
    buffer_store_dword v63, off, s[12:15], s34 offset:64 sc1
L_BV_r3:
    s_mov_b64 exec, -1
L_BV_p3:
    v_and_b32_dpp v8, v48, v20 row_newbcast:3 row_mask:0xf bank_mask:0xf
    v_and_b32_dpp v9, v48, v21 row_newbcast:3 row_mask:0xf bank_mask:0xf
    v_and_b32_dpp v10, v48, v22 row_newbcast:3 row_mask:0xf bank_mask:0xf
    v_and_b32_dpp v11, v48, v23 row_newbcast:3 row_mask:0xf bank_mask:0xf
    s_waitcnt vmcnt(15)
    s_nop 0
    v_mfma_f32_16x16x32_bf16 v[12:15], v[112:115], v[8:11], v[12:15]
    buffer_load_dwordx4 v[112:115], v1, s[4:7], s32 offen offset:0 nt
    s_add_u32 s32, s32, 6144
    v_and_b32_dpp v8, v48, v20 row_newbcast:7 row_mask:0xf bank_mask:0xf
    v_and_b32_dpp v9, v48, v21 row_newbcast:7 row_mask:0xf bank_mask:0xf
    v_and_b32_dpp v10, v48, v22 row_newbcast:7 row_mask:0xf bank_mask:0xf
    v_and_b32_dpp v11, v48, v23 row_newbcast:7 row_mask:0xf bank_mask:0xf
    s_waitcnt vmcnt(15)
    s_nop 0
    v_mfma_f32_16x16x32_bf16 v[12:15], v[116:119], v[8:11], v[12:15]
    buffer_load_dwordx4 v[116:119], v1, s[4:7], s32 offen offset:0 nt
    s_add_u32 s32, s32, 6144
    v_and_b32_dpp v8, v48, v20 row_newbcast:11 row_mask:0xf bank_mask:0xf
    v_and_b32_dpp v9, v48, v21 row_newbcast:11 row_mask:0xf bank_mask:0xf
    v_and_b32_dpp v10, v48, v22 row_newbcast:11 row_mask:0xf bank_mask:0xf
    v_and_b32_dpp v11, v48, v23 row_newbcast:11 row_mask:0xf bank_mask:0xf
    s_waitcnt vmcnt(15)
    s_nop 0
    v_mfma_f32_16x16x32_bf16 v[12:15], v[120:123], v[8:11], v[12:15]
    buffer_load_dwordx4 v[120:123], v1, s[4:7], s32 offen offset:0 nt
    s_add_u32 s32, s32, 6144
    v_and_b32_dpp v8, v48, v20 row_newbcast:15 row_mask:0xf bank_mask:0xf
    v_and_b32_dpp v9, v48, v21 row_newbcast:15 row_mask:0xf bank_mask:0xf
    v_and_b32_dpp v10, v48, v22 row_newbcast:15 row_mask:0xf bank_mask:0xf
    v_and_b32_dpp v11, v48, v23 row_newbcast:15 row_mask:0xf bank_mask:0xf
    s_waitcnt vmcnt(15)
    s_nop 0
    v_mfma_f32_16x16x32_bf16 v[12:15], v[124:127], v[8:11], v[12:15]
    buffer_load_dwordx4 v[124:127], v1, s[4:7], s32 offen offset:0 nt
    s_add_u32 s32, s32, 6144
    v_mov_b32 v48, v49
    v_mov_b32 v49, v50
    v_mov_b32 v50, v51
    v_mov_b32 v51, v52
    v_mov_b32 v52, v53
    v_mov_b32 v53, v54
    v_mov_b32 v54, v55
    v_mov_b32 v55, v56
    v_mov_b32 v56, v57
    v_mov_b32 v57, v58
    s_add_u32 s27, s27, 1
    s_branch L_BV
L_A:
    s_getpc_b64 s[20:21]
L_pc3:
    s_sub_u32 s20, s20, L_pc3-L_A
    s_subb_u32 s21, s21, 0
    s_mov_b32 s22, L_A2-L_A
    s_mov_b32 s23, 0x20000
    v_lshl_add_u32 v3, v0, 2, s3
    v_lshlrev_b32 v3, 7, v3
    buffer_load_dword v17, v3, s[20:23], 0 offen
    s_mov_b32 s74, s2
    s_and_b32 s72, s2, 31
    s_and_b32 s25, s72, 7
    s_lshr_b32 s26, s72, 3
    s_mov_b32 s70, 0x5040100
    s_mov_b32 s71, 0xd0c0908
    s_lshl_b32 s25, s25, 3
    s_lshr_b64 s[70:71], s[70:71], s25
    s_lshl_b32 s26, s26, 3
    s_lshr_b32 s26, 0x12100200, s26
    s_or_b32 s26, s26, s70
    s_and_b32 s26, s26, 31
    v_lshrrev_b32 v3, 4, v0
    v_and_b32 v4, 15, v0
    v_lshlrev_b32 v18, 18, v3
    v_lshl_add_u32 v18, v4, 4, v18
    v_lshrrev_b32 v6, 3, v4
    v_lshlrev_b32 v6, 10, v6
    v_lshl_add_u32 v19, v3, 6, v6
    v_bfe_u32 v1, v0, 2, 2
    v_lshlrev_b32 v64, 18, v1
    v_lshl_add_u32 v64, v3, 6, v64
    v_and_b32 v4, 3, v0
    v_lshl_add_u32 v64, v4, 4, v64
    v_lshlrev_b32 v65, 9, v1
    v_lshl_add_u32 v65, v3, 7, v65
    v_lshl_add_u32 v65, v4, 5, v65
    v_add_u32 v65, 135168, v65
    v_lshlrev_b32 v66, 15, v1
    v_lshl_add_u32 v66, v3, 6, v66
    v_lshl_add_u32 v66, v4, 4, v66
    v_and_b32 v4, 15, v0
    v_lshlrev_b32 v67, 10, v3
    v_lshl_add_u32 v67, v4, 4, v67
    s_lshl_b32 s35, s3, 20
    s_lshl_b32 s24, s26, 8
    s_add_u32 s35, s35, s24
    s_waitcnt lgkmcnt(0)
    s_cmp_lt_u32 s74, 32
    s_cselect_b64 s[4:5], s[40:41], s[54:55]
    s_mov_b32 s6, 0x400000
    s_mov_b32 s7, 0x20000
    s_cselect_b64 s[20:21], s[36:37], s[48:49]
    s_mov_b32 s22, 4096
    s_mov_b32 s23, 0x20000
    s_cselect_b32 s75, 0x400000, 0
    s_lshl_b32 s24, s3, 8
    s_mov_b32 s32, s35
    buffer_load_dwordx4 v[12:15], v67, s[20:23], s24 offen
    buffer_load_dwordx4 v[128:131], v18, s[4:7], s32 offen
    s_add_u32 s32, s32, 8192
    buffer_load_dwordx4 v[132:135], v18, s[4:7], s32 offen
    s_add_u32 s32, s32, 8192
    buffer_load_dwordx4 v[136:139], v18, s[4:7], s32 offen
    s_add_u32 s32, s32, 8192
    buffer_load_dwordx4 v[140:143], v18, s[4:7], s32 offen
    s_add_u32 s32, s32, 8192
    buffer_load_dwordx4 v[144:147], v18, s[4:7], s32 offen
    s_add_u32 s32, s32, 8192
    buffer_load_dwordx4 v[148:151], v18, s[4:7], s32 offen
    s_add_u32 s32, s32, 8192
    buffer_load_dwordx4 v[152:155], v18, s[4:7], s32 offen
    s_add_u32 s32, s32, 8192
    buffer_load_dwordx4 v[156:159], v18, s[4:7], s32 offen
    s_add_u32 s32, s32, 8192
    buffer_load_dwordx4 v[160:163], v18, s[4:7], s32 offen
    s_add_u32 s32, s32, 8192
    buffer_load_dwordx4 v[164:167], v18, s[4:7], s32 offen
    s_add_u32 s32, s32, 8192
    buffer_load_dwordx4 v[168:171], v18, s[4:7], s32 offen
    s_add_u32 s32, s32, 8192
    buffer_load_dwordx4 v[172:175], v18, s[4:7], s32 offen
    s_add_u32 s32, s32, 8192
    buffer_load_dwordx4 v[176:179], v18, s[4:7], s32 offen
    s_add_u32 s32, s32, 8192
    buffer_load_dwordx4 v[180:183], v18, s[4:7], s32 offen
    s_add_u32 s32, s32, 8192
    buffer_load_dwordx4 v[184:187], v18, s[4:7], s32 offen
    s_add_u32 s32, s32, 8192
    buffer_load_dwordx4 v[188:191], v18, s[4:7], s32 offen
    s_add_u32 s32, s32, 8192
    s_mov_b32 s12, s62
    s_mov_b32 s13, s63
    s_mov_b32 s14, 0x400000
    s_mov_b32 s15, 0x20000
    s_mov_b32 s16, s60
    s_mov_b32 s17, s61
    s_mov_b32 s18, 0x100
    s_mov_b32 s19, 0x20000
    v_and_b32 v3, 1, v0
    v_lshlrev_b32 v3, 4, v3
    v_mov_b32 v4, 0xffff
    v_lshlrev_b32 v4, v3, v4
    v_bfe_u32 v3, v0, 1, 2
    v_cmp_eq_u32 vcc, 0, v3
    s_nop 1
    v_cndmask_b32 v20, 0, v4, vcc
    v_cmp_eq_u32 vcc, 1, v3
    s_nop 1
    v_cndmask_b32 v21, 0, v4, vcc
    v_cmp_eq_u32 vcc, 2, v3
    s_nop 1
    v_cndmask_b32 v22, 0, v4, vcc
    v_cmp_eq_u32 vcc, 3, v3
    s_nop 1
    v_cndmask_b32 v23, 0, v4, vcc
    v_mov_b32 v3, 0x0c0c0c0c
    s_mov_b32 s24, 0x01000100
    s_mov_b32 s25, 0x03020302
    v_bfi_b32 v24, v20, s24, v3
    v_bfi_b32 v28, v20, s25, v3
    v_bfi_b32 v25, v21, s24, v3
    v_bfi_b32 v29, v21, s25, v3
    v_bfi_b32 v26, v22, s24, v3
    v_bfi_b32 v30, v22, s25, v3
    v_bfi_b32 v27, v23, s24, v3
    v_bfi_b32 v31, v23, s25, v3
    s_mov_b32 s64, 0x22222222
    s_mov_b32 s65, 0x22222222
    s_mov_b32 s66, 0x44444444
    s_mov_b32 s67, 0x44444444
    s_mov_b32 s68, 0x88888888
    s_mov_b32 s69, 0x88888888
    s_lshl_b32 s24, s3, 8
    s_add_u32 s24, s24, 145408
    v_add_u32 v3, s24, v67
    v_add_u32 v4, s24, v19
    s_waitcnt vmcnt(16)
    ds_write_b128 v3, v[12:15]
    s_waitcnt lgkmcnt(0)
    ds_read_b128 v[32:35], v4 offset:0
    ds_read_b128 v[36:39], v4 offset:16
    ds_read_b128 v[40:43], v4 offset:32
    ds_read_b128 v[44:47], v4 offset:48
    ds_read_b128 v[48:51], v4 offset:2048
    ds_read_b128 v[52:55], v4 offset:2064
    ds_read_b128 v[56:59], v4 offset:2080
    ds_read_b128 v[60:63], v4 offset:2096
    s_waitcnt lgkmcnt(0)
    v_mov_b32 v76, -1
    v_mov_b32 v77, -1
    v_mov_b32 v78, -1
    v_mov_b32 v79, -1
    s_lshl_b32 s71, s72, 2
    s_add_u32 s71, s71, s3
    s_lshl_b32 s71, s71, 10
    s_add_u32 s71, s71, 0x180000
    s_cmp_lt_u32 s74, 32
    s_cselect_b32 s71, 0x400000, s71
    v_perm_b32 v8, v32, v32, v24
    v_perm_b32 v9, v32, v32, v25
    v_perm_b32 v10, v32, v32, v26
    v_perm_b32 v11, v32, v32, v27
    v_perm_b32 v4, v48, v48, v24
    v_perm_b32 v5, v48, v48, v25
    v_perm_b32 v6, v48, v48, v26
    v_perm_b32 v7, v48, v48, v27
    s_waitcnt vmcnt(15)
    v_mfma_f32_16x16x32_bf16 v[12:15], v[128:131], v[8:11], 0
    v_mfma_f32_16x16x32_bf16 v[68:71], v[128:131], v[4:7], 0
    buffer_load_dwordx4 v[192:195], v18, s[4:7], s32 offen nt
    s_add_u32 s32, s32, 8192
    v_perm_b32 v8, v32, v32, v28
    v_perm_b32 v9, v32, v32, v29
    v_perm_b32 v10, v32, v32, v30
    v_perm_b32 v11, v32, v32, v31
    v_perm_b32 v4, v48, v48, v28
    v_perm_b32 v5, v48, v48, v29
    v_perm_b32 v6, v48, v48, v30
    v_perm_b32 v7, v48, v48, v31
    s_waitcnt vmcnt(15)
    v_mfma_f32_16x16x32_bf16 v[12:15], v[132:135], v[8:11], v[12:15]
    v_mfma_f32_16x16x32_bf16 v[68:71], v[132:135], v[4:7], v[68:71]
    buffer_load_dwordx4 v[196:199], v18, s[4:7], s32 offen nt
    s_add_u32 s32, s32, 8192
    v_perm_b32 v8, v33, v33, v24
    v_perm_b32 v9, v33, v33, v25
    v_perm_b32 v10, v33, v33, v26
    v_perm_b32 v11, v33, v33, v27
    v_perm_b32 v4, v49, v49, v24
    v_perm_b32 v5, v49, v49, v25
    v_perm_b32 v6, v49, v49, v26
    v_perm_b32 v7, v49, v49, v27
    s_waitcnt vmcnt(15)
    v_mfma_f32_16x16x32_bf16 v[12:15], v[136:139], v[8:11], v[12:15]
    v_mfma_f32_16x16x32_bf16 v[68:71], v[136:139], v[4:7], v[68:71]
    buffer_load_dwordx4 v[200:203], v18, s[4:7], s32 offen nt
    s_add_u32 s32, s32, 8192
    v_perm_b32 v8, v33, v33, v28
    v_perm_b32 v9, v33, v33, v29
    v_perm_b32 v10, v33, v33, v30
    v_perm_b32 v11, v33, v33, v31
    v_perm_b32 v4, v49, v49, v28
    v_perm_b32 v5, v49, v49, v29
    v_perm_b32 v6, v49, v49, v30
    v_perm_b32 v7, v49, v49, v31
    s_waitcnt vmcnt(15)
    v_mfma_f32_16x16x32_bf16 v[12:15], v[140:143], v[8:11], v[12:15]
    v_mfma_f32_16x16x32_bf16 v[68:71], v[140:143], v[4:7], v[68:71]
    buffer_load_dwordx4 v[204:207], v18, s[4:7], s32 offen nt
    s_add_u32 s32, s32, 8192
    v_perm_b32 v8, v34, v34, v24
    v_perm_b32 v9, v34, v34, v25
    v_perm_b32 v10, v34, v34, v26
    v_perm_b32 v11, v34, v34, v27
    v_perm_b32 v4, v50, v50, v24
    v_perm_b32 v5, v50, v50, v25
    v_perm_b32 v6, v50, v50, v26
    v_perm_b32 v7, v50, v50, v27
    s_waitcnt vmcnt(15)
    v_mfma_f32_16x16x32_bf16 v[12:15], v[144:147], v[8:11], v[12:15]
    v_mfma_f32_16x16x32_bf16 v[68:71], v[144:147], v[4:7], v[68:71]
    buffer_load_dwordx4 v[208:211], v18, s[4:7], s32 offen nt
    s_add_u32 s32, s32, 8192
    v_perm_b32 v8, v34, v34, v28
    v_perm_b32 v9, v34, v34, v29
    v_perm_b32 v10, v34, v34, v30
    v_perm_b32 v11, v34, v34, v31
    v_perm_b32 v4, v50, v50, v28
    v_perm_b32 v5, v50, v50, v29
    v_perm_b32 v6, v50, v50, v30
    v_perm_b32 v7, v50, v50, v31
    s_waitcnt vmcnt(15)
    v_mfma_f32_16x16x32_bf16 v[12:15], v[148:151], v[8:11], v[12:15]
    v_mfma_f32_16x16x32_bf16 v[68:71], v[148:151], v[4:7], v[68:71]
    buffer_load_dwordx4 v[212:215], v18, s[4:7], s32 offen nt
    s_add_u32 s32, s32, 8192
    v_perm_b32 v8, v35, v35, v24
    v_perm_b32 v9, v35, v35, v25
    v_perm_b32 v10, v35, v35, v26
    v_perm_b32 v11, v35, v35, v27
    v_perm_b32 v4, v51, v51, v24
    v_perm_b32 v5, v51, v51, v25
    v_perm_b32 v6, v51, v51, v26
    v_perm_b32 v7, v51, v51, v27
    s_waitcnt vmcnt(15)
    v_mfma_f32_16x16x32_bf16 v[12:15], v[152:155], v[8:11], v[12:15]
    v_mfma_f32_16x16x32_bf16 v[68:71], v[152:155], v[4:7], v[68:71]
    buffer_load_dwordx4 v[216:219], v18, s[4:7], s32 offen nt
    s_add_u32 s32, s32, 8192
    v_perm_b32 v8, v35, v35, v28
    v_perm_b32 v9, v35, v35, v29
    v_perm_b32 v10, v35, v35, v30
    v_perm_b32 v11, v35, v35, v31
    v_perm_b32 v4, v51, v51, v28
    v_perm_b32 v5, v51, v51, v29
    v_perm_b32 v6, v51, v51, v30
    v_perm_b32 v7, v51, v51, v31
    s_waitcnt vmcnt(15)
    v_mfma_f32_16x16x32_bf16 v[12:15], v[156:159], v[8:11], v[12:15]
    v_mfma_f32_16x16x32_bf16 v[68:71], v[156:159], v[4:7], v[68:71]
    buffer_load_dwordx4 v[220:223], v18, s[4:7], s32 offen nt
    s_add_u32 s32, s32, 8192
    v_perm_b32 v8, v36, v36, v24
    v_perm_b32 v9, v36, v36, v25
    v_perm_b32 v10, v36, v36, v26
    v_perm_b32 v11, v36, v36, v27
    v_perm_b32 v4, v52, v52, v24
    v_perm_b32 v5, v52, v52, v25
    v_perm_b32 v6, v52, v52, v26
    v_perm_b32 v7, v52, v52, v27
    s_waitcnt vmcnt(15)
    v_mfma_f32_16x16x32_bf16 v[12:15], v[160:163], v[8:11], v[12:15]
    v_mfma_f32_16x16x32_bf16 v[68:71], v[160:163], v[4:7], v[68:71]
    buffer_load_dwordx4 v[224:227], v18, s[4:7], s32 offen nt
    s_add_u32 s32, s32, 8192
    v_perm_b32 v8, v36, v36, v28
    v_perm_b32 v9, v36, v36, v29
    v_perm_b32 v10, v36, v36, v30
    v_perm_b32 v11, v36, v36, v31
    v_perm_b32 v4, v52, v52, v28
    v_perm_b32 v5, v52, v52, v29
    v_perm_b32 v6, v52, v52, v30
    v_perm_b32 v7, v52, v52, v31
    s_waitcnt vmcnt(15)
    v_mfma_f32_16x16x32_bf16 v[12:15], v[164:167], v[8:11], v[12:15]
    v_mfma_f32_16x16x32_bf16 v[68:71], v[164:167], v[4:7], v[68:71]
    buffer_load_dwordx4 v[228:231], v18, s[4:7], s32 offen nt
    s_add_u32 s32, s32, 8192
    v_perm_b32 v8, v37, v37, v24
    v_perm_b32 v9, v37, v37, v25
    v_perm_b32 v10, v37, v37, v26
    v_perm_b32 v11, v37, v37, v27
    v_perm_b32 v4, v53, v53, v24
    v_perm_b32 v5, v53, v53, v25
    v_perm_b32 v6, v53, v53, v26
    v_perm_b32 v7, v53, v53, v27
    s_waitcnt vmcnt(15)
    v_mfma_f32_16x16x32_bf16 v[12:15], v[168:171], v[8:11], v[12:15]
    v_mfma_f32_16x16x32_bf16 v[68:71], v[168:171], v[4:7], v[68:71]
    buffer_load_dwordx4 v[232:235], v18, s[4:7], s32 offen nt
    s_add_u32 s32, s32, 8192
    v_perm_b32 v8, v37, v37, v28
    v_perm_b32 v9, v37, v37, v29
    v_perm_b32 v10, v37, v37, v30
    v_perm_b32 v11, v37, v37, v31
    v_perm_b32 v4, v53, v53, v28
    v_perm_b32 v5, v53, v53, v29
    v_perm_b32 v6, v53, v53, v30
    v_perm_b32 v7, v53, v53, v31
    s_waitcnt vmcnt(15)
    v_mfma_f32_16x16x32_bf16 v[12:15], v[172:175], v[8:11], v[12:15]
    v_mfma_f32_16x16x32_bf16 v[68:71], v[172:175], v[4:7], v[68:71]
    buffer_load_dwordx4 v[236:239], v18, s[4:7], s32 offen nt
    s_add_u32 s32, s32, 8192
    v_perm_b32 v8, v38, v38, v24
    v_perm_b32 v9, v38, v38, v25
    v_perm_b32 v10, v38, v38, v26
    v_perm_b32 v11, v38, v38, v27
    v_perm_b32 v4, v54, v54, v24
    v_perm_b32 v5, v54, v54, v25
    v_perm_b32 v6, v54, v54, v26
    v_perm_b32 v7, v54, v54, v27
    s_waitcnt vmcnt(15)
    v_mfma_f32_16x16x32_bf16 v[12:15], v[176:179], v[8:11], v[12:15]
    v_mfma_f32_16x16x32_bf16 v[68:71], v[176:179], v[4:7], v[68:71]
    buffer_load_dwordx4 v[240:243], v18, s[4:7], s32 offen nt
    s_add_u32 s32, s32, 8192
    v_perm_b32 v8, v38, v38, v28
    v_perm_b32 v9, v38, v38, v29
    v_perm_b32 v10, v38, v38, v30
    v_perm_b32 v11, v38, v38, v31
    v_perm_b32 v4, v54, v54, v28
    v_perm_b32 v5, v54, v54, v29
    v_perm_b32 v6, v54, v54, v30
    v_perm_b32 v7, v54, v54, v31
    s_waitcnt vmcnt(15)
    v_mfma_f32_16x16x32_bf16 v[12:15], v[180:183], v[8:11], v[12:15]
    v_mfma_f32_16x16x32_bf16 v[68:71], v[180:183], v[4:7], v[68:71]
    buffer_load_dwordx4 v[244:247], v18, s[4:7], s32 offen nt
    s_add_u32 s32, s32, 8192
    v_perm_b32 v8, v39, v39, v24
    v_perm_b32 v9, v39, v39, v25
    v_perm_b32 v10, v39, v39, v26
    v_perm_b32 v11, v39, v39, v27
    v_perm_b32 v4, v55, v55, v24
    v_perm_b32 v5, v55, v55, v25
    v_perm_b32 v6, v55, v55, v26
    v_perm_b32 v7, v55, v55, v27
    s_waitcnt vmcnt(15)
    v_mfma_f32_16x16x32_bf16 v[12:15], v[184:187], v[8:11], v[12:15]
    v_mfma_f32_16x16x32_bf16 v[68:71], v[184:187], v[4:7], v[68:71]
    buffer_load_dwordx4 v[248:251], v18, s[4:7], s32 offen nt
    s_add_u32 s32, s32, 8192
    v_perm_b32 v8, v39, v39, v28
    v_perm_b32 v9, v39, v39, v29
    v_perm_b32 v10, v39, v39, v30
    v_perm_b32 v11, v39, v39, v31
    v_perm_b32 v4, v55, v55, v28
    v_perm_b32 v5, v55, v55, v29
    v_perm_b32 v6, v55, v55, v30
    v_perm_b32 v7, v55, v55, v31
    s_waitcnt vmcnt(15)
    v_mfma_f32_16x16x32_bf16 v[12:15], v[188:191], v[8:11], v[12:15]
    v_mfma_f32_16x16x32_bf16 v[68:71], v[188:191], v[4:7], v[68:71]
    buffer_load_dwordx4 v[252:255], v18, s[4:7], s32 offen nt
    s_add_u32 s32, s32, 8192
    v_perm_b32 v8, v40, v40, v24
    v_perm_b32 v9, v40, v40, v25
    v_perm_b32 v10, v40, v40, v26
    v_perm_b32 v11, v40, v40, v27
    v_perm_b32 v4, v56, v56, v24
    v_perm_b32 v5, v56, v56, v25
    v_perm_b32 v6, v56, v56, v26
    v_perm_b32 v7, v56, v56, v27
    s_waitcnt vmcnt(15)
    v_mfma_f32_16x16x32_bf16 v[12:15], v[192:195], v[8:11], v[12:15]
    v_mfma_f32_16x16x32_bf16 v[68:71], v[192:195], v[4:7], v[68:71]
    s_lshl_b32 s73, s74, 7
    s_add_u32 s73, s73, 0x170000
    s_cmp_lg_u32 s3, 0
    s_cbranch_scc1 L_A_nofl
    s_mov_b64 exec, 1
    buffer_store_dwordx4 v[76:79], off, s[12:15], s73 sc1
    s_mov_b64 exec, -1
L_A_nofl:
    s_cmp_ge_u32 s71, 0x1d7000
    s_cselect_b32 s71, 0x400000, s71
    buffer_store_dwordx4 v[76:79], v2, s[12:15], s71 offen sc1
    s_add_u32 s71, s71, 0x20000
    s_cmp_ge_u32 s71, 0x1d7000
    s_cselect_b32 s71, 0x400000, s71
    buffer_store_dwordx4 v[76:79], v2, s[12:15], s71 offen sc1
    s_add_u32 s71, s71, 0x20000
    s_cmp_ge_u32 s71, 0x1d7000
    s_cselect_b32 s71, 0x400000, s71
    buffer_store_dwordx4 v[76:79], v2, s[12:15], s71 offen sc1
    s_add_u32 s71, s71, 0x20000
    s_getpc_b64 s[20:21]
L_pc4:
    s_add_u32 s20, s20, L_A2-L_pc4
    s_addc_u32 s21, s21, 0
    s_mov_b32 s22, L_last-L_A2
    s_mov_b32 s23, 0x20000
    v_lshl_add_u32 v3, v0, 2, s3
    v_lshlrev_b32 v3, 7, v3
    buffer_load_dword v17, v3, s[20:23], 0 offen
    s_mov_b32 s4, s42
    s_mov_b32 s5, s43
    s_mov_b32 s6, s75
    s_mov_b32 s32, s35
    buffer_load_dwordx4 v[128:131], v64, s[4:7], s32 offen nt
    s_add_u32 s32, s32, 8192
    v_perm_b32 v8, v40, v40, v28
    v_perm_b32 v9, v40, v40, v29
    v_perm_b32 v10, v40, v40, v30
    v_perm_b32 v11, v40, v40, v31
    v_perm_b32 v4, v56, v56, v28
    v_perm_b32 v5, v56, v56, v29
    v_perm_b32 v6, v56, v56, v30
    v_perm_b32 v7, v56, v56, v31
    s_waitcnt vmcnt(15)
    v_mfma_f32_16x16x32_bf16 v[12:15], v[196:199], v[8:11], v[12:15]
    v_mfma_f32_16x16x32_bf16 v[68:71], v[196:199], v[4:7], v[68:71]
    buffer_load_dwordx4 v[132:135], v64, s[4:7], s32 offen nt
    s_add_u32 s32, s32, 8192
    v_perm_b32 v8, v41, v41, v24
    v_perm_b32 v9, v41, v41, v25
    v_perm_b32 v10, v41, v41, v26
    v_perm_b32 v11, v41, v41, v27
    v_perm_b32 v4, v57, v57, v24
    v_perm_b32 v5, v57, v57, v25
    v_perm_b32 v6, v57, v57, v26
    v_perm_b32 v7, v57, v57, v27
    s_waitcnt vmcnt(15)
    v_mfma_f32_16x16x32_bf16 v[12:15], v[200:203], v[8:11], v[12:15]
    v_mfma_f32_16x16x32_bf16 v[68:71], v[200:203], v[4:7], v[68:71]
    buffer_load_dwordx4 v[136:139], v64, s[4:7], s32 offen nt
    s_add_u32 s32, s32, 8192
    v_perm_b32 v8, v41, v41, v28
    v_perm_b32 v9, v41, v41, v29
    v_perm_b32 v10, v41, v41, v30
    v_perm_b32 v11, v41, v41, v31
    v_perm_b32 v4, v57, v57, v28
    v_perm_b32 v5, v57, v57, v29
    v_perm_b32 v6, v57, v57, v30
    v_perm_b32 v7, v57, v57, v31
    s_waitcnt vmcnt(15)
    v_mfma_f32_16x16x32_bf16 v[12:15], v[204:207], v[8:11], v[12:15]
    v_mfma_f32_16x16x32_bf16 v[68:71], v[204:207], v[4:7], v[68:71]
    buffer_load_dwordx4 v[140:143], v64, s[4:7], s32 offen nt
    s_add_u32 s32, s32, 8192
    v_perm_b32 v8, v42, v42, v24
    v_perm_b32 v9, v42, v42, v25
    v_perm_b32 v10, v42, v42, v26
    v_perm_b32 v11, v42, v42, v27
    v_perm_b32 v4, v58, v58, v24
    v_perm_b32 v5, v58, v58, v25
    v_perm_b32 v6, v58, v58, v26
    v_perm_b32 v7, v58, v58, v27
    s_waitcnt vmcnt(15)
    v_mfma_f32_16x16x32_bf16 v[12:15], v[208:211], v[8:11], v[12:15]
    v_mfma_f32_16x16x32_bf16 v[68:71], v[208:211], v[4:7], v[68:71]
    buffer_load_dwordx4 v[144:147], v64, s[4:7], s32 offen nt
    s_add_u32 s32, s32, 8192
    v_perm_b32 v8, v42, v42, v28
    v_perm_b32 v9, v42, v42, v29
    v_perm_b32 v10, v42, v42, v30
    v_perm_b32 v11, v42, v42, v31
    v_perm_b32 v4, v58, v58, v28
    v_perm_b32 v5, v58, v58, v29
    v_perm_b32 v6, v58, v58, v30
    v_perm_b32 v7, v58, v58, v31
    s_waitcnt vmcnt(15)
    v_mfma_f32_16x16x32_bf16 v[12:15], v[212:215], v[8:11], v[12:15]
    v_mfma_f32_16x16x32_bf16 v[68:71], v[212:215], v[4:7], v[68:71]
    buffer_load_dwordx4 v[148:151], v64, s[4:7], s32 offen nt
    s_add_u32 s32, s32, 8192
    v_perm_b32 v8, v43, v43, v24
    v_perm_b32 v9, v43, v43, v25
    v_perm_b32 v10, v43, v43, v26
    v_perm_b32 v11, v43, v43, v27
    v_perm_b32 v4, v59, v59, v24
    v_perm_b32 v5, v59, v59, v25
    v_perm_b32 v6, v59, v59, v26
    v_perm_b32 v7, v59, v59, v27
    s_waitcnt vmcnt(15)
    v_mfma_f32_16x16x32_bf16 v[12:15], v[216:219], v[8:11], v[12:15]
    v_mfma_f32_16x16x32_bf16 v[68:71], v[216:219], v[4:7], v[68:71]
    buffer_load_dwordx4 v[152:155], v64, s[4:7], s32 offen nt
    s_add_u32 s32, s32, 8192
    v_perm_b32 v8, v43, v43, v28
    v_perm_b32 v9, v43, v43, v29
    v_perm_b32 v10, v43, v43, v30
    v_perm_b32 v11, v43, v43, v31
    v_perm_b32 v4, v59, v59, v28
    v_perm_b32 v5, v59, v59, v29
    v_perm_b32 v6, v59, v59, v30
    v_perm_b32 v7, v59, v59, v31
    s_waitcnt vmcnt(15)
    v_mfma_f32_16x16x32_bf16 v[12:15], v[220:223], v[8:11], v[12:15]
    v_mfma_f32_16x16x32_bf16 v[68:71], v[220:223], v[4:7], v[68:71]
    buffer_load_dwordx4 v[156:159], v64, s[4:7], s32 offen nt
    s_add_u32 s32, s32, 8192
    v_perm_b32 v8, v44, v44, v24
    v_perm_b32 v9, v44, v44, v25
    v_perm_b32 v10, v44, v44, v26
    v_perm_b32 v11, v44, v44, v27
    v_perm_b32 v4, v60, v60, v24
    v_perm_b32 v5, v60, v60, v25
    v_perm_b32 v6, v60, v60, v26
    v_perm_b32 v7, v60, v60, v27
    s_waitcnt vmcnt(15)
    v_mfma_f32_16x16x32_bf16 v[12:15], v[224:227], v[8:11], v[12:15]
    v_mfma_f32_16x16x32_bf16 v[68:71], v[224:227], v[4:7], v[68:71]
    buffer_load_dwordx4 v[160:163], v64, s[4:7], s32 offen nt
    s_add_u32 s32, s32, 8192
    v_perm_b32 v8, v44, v44, v28
    v_perm_b32 v9, v44, v44, v29
    v_perm_b32 v10, v44, v44, v30
    v_perm_b32 v11, v44, v44, v31
    v_perm_b32 v4, v60, v60, v28
    v_perm_b32 v5, v60, v60, v29
    v_perm_b32 v6, v60, v60, v30
    v_perm_b32 v7, v60, v60, v31
    s_waitcnt vmcnt(15)
    v_mfma_f32_16x16x32_bf16 v[12:15], v[228:231], v[8:11], v[12:15]
    v_mfma_f32_16x16x32_bf16 v[68:71], v[228:231], v[4:7], v[68:71]
    buffer_load_dwordx4 v[164:167], v64, s[4:7], s32 offen nt
    s_add_u32 s32, s32, 8192
    v_perm_b32 v8, v45, v45, v24
    v_perm_b32 v9, v45, v45, v25
    v_perm_b32 v10, v45, v45, v26
    v_perm_b32 v11, v45, v45, v27
    v_perm_b32 v4, v61, v61, v24
    v_perm_b32 v5, v61, v61, v25
    v_perm_b32 v6, v61, v61, v26
    v_perm_b32 v7, v61, v61, v27
    s_waitcnt vmcnt(15)
    v_mfma_f32_16x16x32_bf16 v[12:15], v[232:235], v[8:11], v[12:15]
    v_mfma_f32_16x16x32_bf16 v[68:71], v[232:235], v[4:7], v[68:71]
    buffer_load_dwordx4 v[168:171], v64, s[4:7], s32 offen nt
    s_add_u32 s32, s32, 8192
    v_perm_b32 v8, v45, v45, v28
    v_perm_b32 v9, v45, v45, v29
    v_perm_b32 v10, v45, v45, v30
    v_perm_b32 v11, v45, v45, v31
    v_perm_b32 v4, v61, v61, v28
    v_perm_b32 v5, v61, v61, v29
    v_perm_b32 v6, v61, v61, v30
    v_perm_b32 v7, v61, v61, v31
    s_waitcnt vmcnt(15)
    v_mfma_f32_16x16x32_bf16 v[12:15], v[236:239], v[8:11], v[12:15]
    v_mfma_f32_16x16x32_bf16 v[68:71], v[236:239], v[4:7], v[68:71]
    buffer_load_dwordx4 v[172:175], v64, s[4:7], s32 offen nt
    s_add_u32 s32, s32, 8192
    v_perm_b32 v8, v46, v46, v24
    v_perm_b32 v9, v46, v46, v25
    v_perm_b32 v10, v46, v46, v26
    v_perm_b32 v11, v46, v46, v27
    v_perm_b32 v4, v62, v62, v24
    v_perm_b32 v5, v62, v62, v25
    v_perm_b32 v6, v62, v62, v26
    v_perm_b32 v7, v62, v62, v27
    s_waitcnt vmcnt(15)
    v_mfma_f32_16x16x32_bf16 v[12:15], v[240:243], v[8:11], v[12:15]
    v_mfma_f32_16x16x32_bf16 v[68:71], v[240:243], v[4:7], v[68:71]
    buffer_load_dwordx4 v[176:179], v64, s[4:7], s32 offen nt
    s_add_u32 s32, s32, 8192
    v_perm_b32 v8, v46, v46, v28
    v_perm_b32 v9, v46, v46, v29
    v_perm_b32 v10, v46, v46, v30
    v_perm_b32 v11, v46, v46, v31
    v_perm_b32 v4, v62, v62, v28
    v_perm_b32 v5, v62, v62, v29
    v_perm_b32 v6, v62, v62, v30
    v_perm_b32 v7, v62, v62, v31
    s_waitcnt vmcnt(15)
    v_mfma_f32_16x16x32_bf16 v[12:15], v[244:247], v[8:11], v[12:15]
    v_mfma_f32_16x16x32_bf16 v[68:71], v[244:247], v[4:7], v[68:71]
    buffer_load_dwordx4 v[180:183], v64, s[4:7], s32 offen nt
    s_add_u32 s32, s32, 8192
    v_perm_b32 v8, v47, v47, v24
    v_perm_b32 v9, v47, v47, v25
    v_perm_b32 v10, v47, v47, v26
    v_perm_b32 v11, v47, v47, v27
    v_perm_b32 v4, v63, v63, v24
    v_perm_b32 v5, v63, v63, v25
    v_perm_b32 v6, v63, v63, v26
    v_perm_b32 v7, v63, v63, v27
    s_waitcnt vmcnt(15)
    v_mfma_f32_16x16x32_bf16 v[12:15], v[248:251], v[8:11], v[12:15]
    v_mfma_f32_16x16x32_bf16 v[68:71], v[248:251], v[4:7], v[68:71]
    buffer_load_dwordx4 v[184:187], v64, s[4:7], s32 offen nt
    s_add_u32 s32, s32, 8192
    v_perm_b32 v8, v47, v47, v28
    v_perm_b32 v9, v47, v47, v29
    v_perm_b32 v10, v47, v47, v30
    v_perm_b32 v11, v47, v47, v31
    v_perm_b32 v4, v63, v63, v28
    v_perm_b32 v5, v63, v63, v29
    v_perm_b32 v6, v63, v63, v30
    v_perm_b32 v7, v63, v63, v31
    s_waitcnt vmcnt(15)
    v_mfma_f32_16x16x32_bf16 v[12:15], v[252:255], v[8:11], v[12:15]
    v_mfma_f32_16x16x32_bf16 v[68:71], v[252:255], v[4:7], v[68:71]
    buffer_load_dwordx4 v[188:191], v64, s[4:7], s32 offen nt
    s_add_u32 s32, s32, 8192
    v_lshrrev_b32 v3, 4, v0
    v_lshlrev_b32 v3, 7, v3
    v_and_b32 v4, 7, v0
    v_lshl_add_u32 v3, v4, 2, v3
    v_bfe_u32 v4, v0, 3, 1
    v_lshl_add_u32 v3, v4, 9, v3
    s_lshl_b32 s24, s3, 11
    s_add_u32 s24, s24, 135168
    v_add_u32 v3, s24, v3
    ds_write_b32 v3, v12 offset:0
    ds_write_b32 v3, v13 offset:32
    ds_write_b32 v3, v14 offset:64
    ds_write_b32 v3, v15 offset:96
    ds_write_b32 v3, v68 offset:1024
    ds_write_b32 v3, v69 offset:1056
    ds_write_b32 v3, v70 offset:1088
    ds_write_b32 v3, v71 offset:1120
    s_waitcnt lgkmcnt(0)
    s_barrier
    ds_read_b128 v[72:75], v65 offset:0
    ds_read_b128 v[76:79], v65 offset:16
    ds_read_b128 v[80:83], v65 offset:2048
    ds_read_b128 v[84:87], v65 offset:2064
    ds_read_b128 v[88:91], v65 offset:4096
    ds_read_b128 v[92:95], v65 offset:4112
    ds_read_b128 v[96:99], v65 offset:6144
    ds_read_b128 v[100:103], v65 offset:6160
    s_waitcnt lgkmcnt(4)
    v_add_f32 v72, v72, v80
    v_add_f32 v73, v73, v81
    v_add_f32 v74, v74, v82
    v_add_f32 v75, v75, v83
    v_add_f32 v76, v76, v84
    v_add_f32 v77, v77, v85
    v_add_f32 v78, v78, v86
    v_add_f32 v79, v79, v87
    s_waitcnt lgkmcnt(2)
    v_add_f32 v72, v72, v88
    v_add_f32 v73, v73, v89
    v_add_f32 v74, v74, v90
    v_add_f32 v75, v75, v91
    v_add_f32 v76, v76, v92
    v_add_f32 v77, v77, v93
    v_add_f32 v78, v78, v94
    v_add_f32 v79, v79, v95
    s_waitcnt lgkmcnt(0)
    v_add_f32 v72, v72, v96
    v_add_f32 v73, v73, v97
    v_add_f32 v74, v74, v98
    v_add_f32 v75, v75, v99
    v_add_f32 v76, v76, v100
    v_add_f32 v77, v77, v101
    v_add_f32 v78, v78, v102
    v_add_f32 v79, v79, v103
    v_cvt_pk_bf16_f32 v8, v72, v73
    v_cvt_pk_bf16_f32 v9, v74, v75
    v_cvt_pk_bf16_f32 v10, v76, v77
    v_cvt_pk_bf16_f32 v11, v78, v79
    s_cmp_ge_u32 s74, 32
    s_cbranch_scc1 L_C
L_A2:
    buffer_load_dwordx4 v[192:195], v64, s[4:7], s32 offen nt
    s_add_u32 s32, s32, 8192
    buffer_load_dwordx4 v[196:199], v64, s[4:7], s32 offen nt
    s_add_u32 s32, s32, 8192
    buffer_load_dwordx4 v[200:203], v64, s[4:7], s32 offen nt
    s_add_u32 s32, s32, 8192
    buffer_load_dwordx4 v[204:207], v64, s[4:7], s32 offen nt
    s_add_u32 s32, s32, 8192
    buffer_load_dwordx4 v[208:211], v64, s[4:7], s32 offen nt
    s_add_u32 s32, s32, 8192
    buffer_load_dwordx4 v[212:215], v64, s[4:7], s32 offen nt
    s_add_u32 s32, s32, 8192
    buffer_load_dwordx4 v[216:219], v64, s[4:7], s32 offen nt
    s_add_u32 s32, s32, 8192
    buffer_load_dwordx4 v[220:223], v64, s[4:7], s32 offen nt
    s_add_u32 s32, s32, 8192
    buffer_load_dwordx4 v[224:227], v64, s[4:7], s32 offen nt
    s_add_u32 s32, s32, 8192
    buffer_load_dwordx4 v[228:231], v64, s[4:7], s32 offen nt
    s_add_u32 s32, s32, 8192
    buffer_load_dwordx4 v[232:235], v64, s[4:7], s32 offen nt
    s_add_u32 s32, s32, 8192
    buffer_load_dwordx4 v[236:239], v64, s[4:7], s32 offen nt
    s_add_u32 s32, s32, 8192
    buffer_load_dwordx4 v[240:243], v64, s[4:7], s32 offen nt
    s_add_u32 s32, s32, 8192
    buffer_load_dwordx4 v[244:247], v64, s[4:7], s32 offen nt
    s_add_u32 s32, s32, 8192
    buffer_load_dwordx4 v[248:251], v64, s[4:7], s32 offen nt
    s_add_u32 s32, s32, 8192
    buffer_load_dwordx4 v[252:255], v64, s[4:7], s32 offen nt
    s_add_u32 s32, s32, 8192
    s_waitcnt vmcnt(31)
    v_mfma_f32_16x16x32_bf16 v[80:83], v[128:131], v[8:11], 0
    s_waitcnt vmcnt(30)
    v_mfma_f32_16x16x32_bf16 v[84:87], v[132:135], v[8:11], 0
    s_waitcnt vmcnt(29)
    v_mfma_f32_16x16x32_bf16 v[88:91], v[136:139], v[8:11], 0
    s_waitcnt vmcnt(28)
    v_mfma_f32_16x16x32_bf16 v[92:95], v[140:143], v[8:11], 0
    s_waitcnt vmcnt(27)
    v_mfma_f32_16x16x32_bf16 v[96:99], v[144:147], v[8:11], 0
    s_waitcnt vmcnt(26)
    v_mfma_f32_16x16x32_bf16 v[100:103], v[148:151], v[8:11], 0
    s_waitcnt vmcnt(25)
    v_mfma_f32_16x16x32_bf16 v[104:107], v[152:155], v[8:11], 0
    s_waitcnt vmcnt(24)
    v_mfma_f32_16x16x32_bf16 v[108:111], v[156:159], v[8:11], 0
    v_add_f32_dpp v72, v81, v80 quad_perm:[1,1,1,1] row_mask:0xf bank_mask:0xf
    v_add_f32_dpp v73, v85, v84 quad_perm:[1,1,1,1] row_mask:0xf bank_mask:0xf
    v_add_f32_dpp v74, v89, v88 quad_perm:[1,1,1,1] row_mask:0xf bank_mask:0xf
    v_add_f32_dpp v75, v93, v92 quad_perm:[1,1,1,1] row_mask:0xf bank_mask:0xf
    v_add_f32_dpp v76, v97, v96 quad_perm:[1,1,1,1] row_mask:0xf bank_mask:0xf
    v_add_f32_dpp v77, v101, v100 quad_perm:[1,1,1,1] row_mask:0xf bank_mask:0xf
    v_add_f32_dpp v78, v105, v104 quad_perm:[1,1,1,1] row_mask:0xf bank_mask:0xf
    s_nop 0
    v_add_f32_dpp v79, v109, v108 quad_perm:[1,1,1,1] row_mask:0xf bank_mask:0xf
    v_add_f32_dpp v72, v82, v72 quad_perm:[2,2,2,2] row_mask:0xf bank_mask:0xf
    v_add_f32_dpp v73, v86, v73 quad_perm:[2,2,2,2] row_mask:0xf bank_mask:0xf
    v_add_f32_dpp v74, v90, v74 quad_perm:[2,2,2,2] row_mask:0xf bank_mask:0xf
    v_add_f32_dpp v75, v94, v75 quad_perm:[2,2,2,2] row_mask:0xf bank_mask:0xf
    v_add_f32_dpp v76, v98, v76 quad_perm:[2,2,2,2] row_mask:0xf bank_mask:0xf
    v_add_f32_dpp v77, v102, v77 quad_perm:[2,2,2,2] row_mask:0xf bank_mask:0xf
    v_add_f32_dpp v78, v106, v78 quad_perm:[2,2,2,2] row_mask:0xf bank_mask:0xf
    v_add_f32_dpp v79, v110, v79 quad_perm:[2,2,2,2] row_mask:0xf bank_mask:0xf
    v_add_f32_dpp v72, v83, v72 quad_perm:[3,3,3,3] row_mask:0xf bank_mask:0xf
    v_add_f32_dpp v73, v87, v73 quad_perm:[3,3,3,3] row_mask:0xf bank_mask:0xf
    v_add_f32_dpp v74, v91, v74 quad_perm:[3,3,3,3] row_mask:0xf bank_mask:0xf
    v_add_f32_dpp v75, v95, v75 quad_perm:[3,3,3,3] row_mask:0xf bank_mask:0xf
    v_add_f32_dpp v76, v99, v76 quad_perm:[3,3,3,3] row_mask:0xf bank_mask:0xf
    v_add_f32_dpp v77, v103, v77 quad_perm:[3,3,3,3] row_mask:0xf bank_mask:0xf
    v_add_f32_dpp v78, v107, v78 quad_perm:[3,3,3,3] row_mask:0xf bank_mask:0xf
    v_add_f32_dpp v79, v111, v79 quad_perm:[3,3,3,3] row_mask:0xf bank_mask:0xf
    s_waitcnt vmcnt(23)
    v_mfma_f32_16x16x32_bf16 v[80:83], v[160:163], v[8:11], 0
    s_waitcnt vmcnt(22)
    v_mfma_f32_16x16x32_bf16 v[84:87], v[164:167], v[8:11], 0
    s_waitcnt vmcnt(21)
    v_mfma_f32_16x16x32_bf16 v[88:91], v[168:171], v[8:11], 0
    s_waitcnt vmcnt(20)
    v_mfma_f32_16x16x32_bf16 v[92:95], v[172:175], v[8:11], 0
    s_waitcnt vmcnt(19)
    v_mfma_f32_16x16x32_bf16 v[96:99], v[176:179], v[8:11], 0
    s_waitcnt vmcnt(18)
    v_mfma_f32_16x16x32_bf16 v[100:103], v[180:183], v[8:11], 0
    s_waitcnt vmcnt(17)
    v_mfma_f32_16x16x32_bf16 v[104:107], v[184:187], v[8:11], 0
    s_waitcnt vmcnt(16)
    v_mfma_f32_16x16x32_bf16 v[108:111], v[188:191], v[8:11], 0
    v_add_f32_dpp v112, v80, v81 quad_perm:[0,0,0,0] row_mask:0xf bank_mask:0xf
    v_add_f32_dpp v113, v84, v85 quad_perm:[0,0,0,0] row_mask:0xf bank_mask:0xf
    v_add_f32_dpp v114, v88, v89 quad_perm:[0,0,0,0] row_mask:0xf bank_mask:0xf
    v_add_f32_dpp v115, v92, v93 quad_perm:[0,0,0,0] row_mask:0xf bank_mask:0xf
    v_add_f32_dpp v116, v96, v97 quad_perm:[0,0,0,0] row_mask:0xf bank_mask:0xf
    v_add_f32_dpp v117, v100, v101 quad_perm:[0,0,0,0] row_mask:0xf bank_mask:0xf
    v_add_f32_dpp v118, v104, v105 quad_perm:[0,0,0,0] row_mask:0xf bank_mask:0xf
    s_nop 0
    v_add_f32_dpp v119, v108, v109 quad_perm:[0,0,0,0] row_mask:0xf bank_mask:0xf
    v_add_f32_dpp v112, v82, v112 quad_perm:[2,2,2,2] row_mask:0xf bank_mask:0xf
    v_add_f32_dpp v113, v86, v113 quad_perm:[2,2,2,2] row_mask:0xf bank_mask:0xf
    v_add_f32_dpp v114, v90, v114 quad_perm:[2,2,2,2] row_mask:0xf bank_mask:0xf
    v_add_f32_dpp v115, v94, v115 quad_perm:[2,2,2,2] row_mask:0xf bank_mask:0xf
    v_add_f32_dpp v116, v98, v116 quad_perm:[2,2,2,2] row_mask:0xf bank_mask:0xf
    v_add_f32_dpp v117, v102, v117 quad_perm:[2,2,2,2] row_mask:0xf bank_mask:0xf
    v_add_f32_dpp v118, v106, v118 quad_perm:[2,2,2,2] row_mask:0xf bank_mask:0xf
    v_add_f32_dpp v119, v110, v119 quad_perm:[2,2,2,2] row_mask:0xf bank_mask:0xf
    v_add_f32_dpp v112, v83, v112 quad_perm:[3,3,3,3] row_mask:0xf bank_mask:0xf
    v_add_f32_dpp v113, v87, v113 quad_perm:[3,3,3,3] row_mask:0xf bank_mask:0xf
    v_add_f32_dpp v114, v91, v114 quad_perm:[3,3,3,3] row_mask:0xf bank_mask:0xf
    v_add_f32_dpp v115, v95, v115 quad_perm:[3,3,3,3] row_mask:0xf bank_mask:0xf
    v_add_f32_dpp v116, v99, v116 quad_perm:[3,3,3,3] row_mask:0xf bank_mask:0xf
    v_add_f32_dpp v117, v103, v117 quad_perm:[3,3,3,3] row_mask:0xf bank_mask:0xf
    v_add_f32_dpp v118, v107, v118 quad_perm:[3,3,3,3] row_mask:0xf bank_mask:0xf
    v_add_f32_dpp v119, v111, v119 quad_perm:[3,3,3,3] row_mask:0xf bank_mask:0xf
    v_cndmask_b32 v72, v72, v112, s[64:65]
    v_cndmask_b32 v73, v73, v113, s[64:65]
    v_cndmask_b32 v74, v74, v114, s[64:65]
    v_cndmask_b32 v75, v75, v115, s[64:65]
    v_cndmask_b32 v76, v76, v116, s[64:65]
    v_cndmask_b32 v77, v77, v117, s[64:65]
    v_cndmask_b32 v78, v78, v118, s[64:65]
    v_cndmask_b32 v79, v79, v119, s[64:65]
    s_waitcnt vmcnt(15)
    v_mfma_f32_16x16x32_bf16 v[80:83], v[192:195], v[8:11], 0
    s_waitcnt vmcnt(14)
    v_mfma_f32_16x16x32_bf16 v[84:87], v[196:199], v[8:11], 0
    s_waitcnt vmcnt(13)
    v_mfma_f32_16x16x32_bf16 v[88:91], v[200:203], v[8:11], 0
    s_waitcnt vmcnt(12)
    v_mfma_f32_16x16x32_bf16 v[92:95], v[204:207], v[8:11], 0
    s_waitcnt vmcnt(11)
    v_mfma_f32_16x16x32_bf16 v[96:99], v[208:211], v[8:11], 0
    s_waitcnt vmcnt(10)
    v_mfma_f32_16x16x32_bf16 v[100:103], v[212:215], v[8:11], 0
    s_waitcnt vmcnt(9)
    v_mfma_f32_16x16x32_bf16 v[104:107], v[216:219], v[8:11], 0
    s_waitcnt vmcnt(8)
    v_mfma_f32_16x16x32_bf16 v[108:111], v[220:223], v[8:11], 0
    v_add_f32_dpp v112, v80, v82 quad_perm:[0,0,0,0] row_mask:0xf bank_mask:0xf
    v_add_f32_dpp v113, v84, v86 quad_perm:[0,0,0,0] row_mask:0xf bank_mask:0xf
    v_add_f32_dpp v114, v88, v90 quad_perm:[0,0,0,0] row_mask:0xf bank_mask:0xf
    v_add_f32_dpp v115, v92, v94 quad_perm:[0,0,0,0] row_mask:0xf bank_mask:0xf
    v_add_f32_dpp v116, v96, v98 quad_perm:[0,0,0,0] row_mask:0xf bank_mask:0xf
    v_add_f32_dpp v117, v100, v102 quad_perm:[0,0,0,0] row_mask:0xf bank_mask:0xf
    v_add_f32_dpp v118, v104, v106 quad_perm:[0,0,0,0] row_mask:0xf bank_mask:0xf
    s_nop 0
    v_add_f32_dpp v119, v108, v110 quad_perm:[0,0,0,0] row_mask:0xf bank_mask:0xf
    v_add_f32_dpp v112, v81, v112 quad_perm:[1,1,1,1] row_mask:0xf bank_mask:0xf
    v_add_f32_dpp v113, v85, v113 quad_perm:[1,1,1,1] row_mask:0xf bank_mask:0xf
    v_add_f32_dpp v114, v89, v114 quad_perm:[1,1,1,1] row_mask:0xf bank_mask:0xf
    v_add_f32_dpp v115, v93, v115 quad_perm:[1,1,1,1] row_mask:0xf bank_mask:0xf
    v_add_f32_dpp v116, v97, v116 quad_perm:[1,1,1,1] row_mask:0xf bank_mask:0xf
    v_add_f32_dpp v117, v101, v117 quad_perm:[1,1,1,1] row_mask:0xf bank_mask:0xf
    v_add_f32_dpp v118, v105, v118 quad_perm:[1,1,1,1] row_mask:0xf bank_mask:0xf
    v_add_f32_dpp v119, v109, v119 quad_perm:[1,1,1,1] row_mask:0xf bank_mask:0xf
    v_add_f32_dpp v112, v83, v112 quad_perm:[3,3,3,3] row_mask:0xf bank_mask:0xf
    v_add_f32_dpp v113, v87, v113 quad_perm:[3,3,3,3] row_mask:0xf bank_mask:0xf
    v_add_f32_dpp v114, v91, v114 quad_perm:[3,3,3,3] row_mask:0xf bank_mask:0xf
    v_add_f32_dpp v115, v95, v115 quad_perm:[3,3,3,3] row_mask:0xf bank_mask:0xf
    v_add_f32_dpp v116, v99, v116 quad_perm:[3,3,3,3] row_mask:0xf bank_mask:0xf
    v_add_f32_dpp v117, v103, v117 quad_perm:[3,3,3,3] row_mask:0xf bank_mask:0xf
    v_add_f32_dpp v118, v107, v118 quad_perm:[3,3,3,3] row_mask:0xf bank_mask:0xf
    v_add_f32_dpp v119, v111, v119 quad_perm:[3,3,3,3] row_mask:0xf bank_mask:0xf
    v_cndmask_b32 v72, v72, v112, s[66:67]
    v_cndmask_b32 v73, v73, v113, s[66:67]
    v_cndmask_b32 v74, v74, v114, s[66:67]
    v_cndmask_b32 v75, v75, v115, s[66:67]
    v_cndmask_b32 v76, v76, v116, s[66:67]
    v_cndmask_b32 v77, v77, v117, s[66:67]
    v_cndmask_b32 v78, v78, v118, s[66:67]
    v_cndmask_b32 v79, v79, v119, s[66:67]
    s_waitcnt vmcnt(7)
    v_mfma_f32_16x16x32_bf16 v[80:83], v[224:227], v[8:11], 0
    s_waitcnt vmcnt(6)
    v_mfma_f32_16x16x32_bf16 v[84:87], v[228:231], v[8:11], 0
    s_waitcnt vmcnt(5)
    v_mfma_f32_16x16x32_bf16 v[88:91], v[232:235], v[8:11], 0
    s_waitcnt vmcnt(4)
    v_mfma_f32_16x16x32_bf16 v[92:95], v[236:239], v[8:11], 0
    s_waitcnt vmcnt(3)
    v_mfma_f32_16x16x32_bf16 v[96:99], v[240:243], v[8:11], 0
    s_waitcnt vmcnt(2)
    v_mfma_f32_16x16x32_bf16 v[100:103], v[244:247], v[8:11], 0
    s_waitcnt vmcnt(1)
    v_mfma_f32_16x16x32_bf16 v[104:107], v[248:251], v[8:11], 0
    s_waitcnt vmcnt(0)
    v_mfma_f32_16x16x32_bf16 v[108:111], v[252:255], v[8:11], 0
    v_add_f32_dpp v112, v80, v83 quad_perm:[0,0,0,0] row_mask:0xf bank_mask:0xf
    v_add_f32_dpp v113, v84, v87 quad_perm:[0,0,0,0] row_mask:0xf bank_mask:0xf
    v_add_f32_dpp v114, v88, v91 quad_perm:[0,0,0,0] row_mask:0xf bank_mask:0xf
    v_add_f32_dpp v115, v92, v95 quad_perm:[0,0,0,0] row_mask:0xf bank_mask:0xf
    v_add_f32_dpp v116, v96, v99 quad_perm:[0,0,0,0] row_mask:0xf bank_mask:0xf
    v_add_f32_dpp v117, v100, v103 quad_perm:[0,0,0,0] row_mask:0xf bank_mask:0xf
    v_add_f32_dpp v118, v104, v107 quad_perm:[0,0,0,0] row_mask:0xf bank_mask:0xf
    s_nop 0
    v_add_f32_dpp v119, v108, v111 quad_perm:[0,0,0,0] row_mask:0xf bank_mask:0xf
    v_add_f32_dpp v112, v81, v112 quad_perm:[1,1,1,1] row_mask:0xf bank_mask:0xf
    v_add_f32_dpp v113, v85, v113 quad_perm:[1,1,1,1] row_mask:0xf bank_mask:0xf
    v_add_f32_dpp v114, v89, v114 quad_perm:[1,1,1,1] row_mask:0xf bank_mask:0xf
    v_add_f32_dpp v115, v93, v115 quad_perm:[1,1,1,1] row_mask:0xf bank_mask:0xf
    v_add_f32_dpp v116, v97, v116 quad_perm:[1,1,1,1] row_mask:0xf bank_mask:0xf
    v_add_f32_dpp v117, v101, v117 quad_perm:[1,1,1,1] row_mask:0xf bank_mask:0xf
    v_add_f32_dpp v118, v105, v118 quad_perm:[1,1,1,1] row_mask:0xf bank_mask:0xf
    v_add_f32_dpp v119, v109, v119 quad_perm:[1,1,1,1] row_mask:0xf bank_mask:0xf
    v_add_f32_dpp v112, v82, v112 quad_perm:[2,2,2,2] row_mask:0xf bank_mask:0xf
    v_add_f32_dpp v113, v86, v113 quad_perm:[2,2,2,2] row_mask:0xf bank_mask:0xf
    v_add_f32_dpp v114, v90, v114 quad_perm:[2,2,2,2] row_mask:0xf bank_mask:0xf
    v_add_f32_dpp v115, v94, v115 quad_perm:[2,2,2,2] row_mask:0xf bank_mask:0xf
    v_add_f32_dpp v116, v98, v116 quad_perm:[2,2,2,2] row_mask:0xf bank_mask:0xf
    v_add_f32_dpp v117, v102, v117 quad_perm:[2,2,2,2] row_mask:0xf bank_mask:0xf
    v_add_f32_dpp v118, v106, v118 quad_perm:[2,2,2,2] row_mask:0xf bank_mask:0xf
    v_add_f32_dpp v119, v110, v119 quad_perm:[2,2,2,2] row_mask:0xf bank_mask:0xf
    v_cndmask_b32 v72, v72, v112, s[68:69]
    v_cndmask_b32 v73, v73, v113, s[68:69]
    v_cndmask_b32 v74, v74, v114, s[68:69]
    v_cndmask_b32 v75, v75, v115, s[68:69]
    v_cndmask_b32 v76, v76, v116, s[68:69]
    v_cndmask_b32 v77, v77, v117, s[68:69]
    v_cndmask_b32 v78, v78, v118, s[68:69]
    v_cndmask_b32 v79, v79, v119, s[68:69]
    s_mov_b32 s71, 0x3e0293ee
    v_mul_f32 v72, s71, v72
    v_mul_f32 v73, s71, v73
    v_mul_f32 v74, s71, v74
    v_mul_f32 v75, s71, v75
    v_mul_f32 v76, s71, v76
    v_mul_f32 v77, s71, v77
    v_mul_f32 v78, s71, v78
    v_mul_f32 v79, s71, v79
    v_cvt_pk_bf16_f32 v4, v72, v73
    v_cvt_pk_bf16_f32 v5, v74, v75
    v_cvt_pk_bf16_f32 v6, v76, v77
    v_cvt_pk_bf16_f32 v7, v78, v79
    s_lshl_b32 s24, s26, 10
    s_lshl_b32 s25, s3, 8
    s_add_u32 s24, s24, s25
    s_add_u32 s24, s24, 0x0
    buffer_store_dwordx4 v[4:7], v66, s[12:15], s24 offen sc1
    s_mov_b32 s8, s56
    s_mov_b32 s9, s57
    s_mov_b32 s10, 0x400000
    s_mov_b32 s11, 0x20000
    s_lshl_b32 s33, s26, 17
    s_lshl_b32 s24, s3, 15
    s_add_u32 s33, s33, s24
    s_add_u32 s33, s33, 0
    s_mul_i32 s34, s3, 17408
    s_add_u32 s34, s34, 0
    s_mov_b32 exec_hi, 0
    s_mov_b32 s70, 0
L_woW:
    s_and_b32 s24, s70, 1
    s_lshl_b32 s24, s24, 4
    s_and_b32 s25, s70, 4
    s_lshl_b32 s25, s25, 1
    s_or_b32 s24, s24, s25
    s_bfe_u32 s25, s70, 0x10001
    s_or_b32 s24, s24, s25
    s_lshl_b32 s24, s24, 10
    s_add_u32 s24, s24, s33
    s_mul_i32 s25, s70, 2176
    s_add_u32 m0, s25, s34
    s_waitcnt vmcnt(24)
    buffer_load_dwordx4 v2, s[8:11], s24 offen nt lds
    s_add_u32 m0, m0, 544
    s_add_u32 s24, s24, 2048
    s_waitcnt vmcnt(24)
    buffer_load_dwordx4 v2, s[8:11], s24 offen nt lds
    s_add_u32 m0, m0, 544
    s_add_u32 s24, s24, 2048
    s_waitcnt vmcnt(24)
    buffer_load_dwordx4 v2, s[8:11], s24 offen nt lds
    s_add_u32 m0, m0, 544
    s_add_u32 s24, s24, 2048
    s_waitcnt vmcnt(24)
    buffer_load_dwordx4 v2, s[8:11], s24 offen nt lds
    s_add_u32 s70, s70, 1
    s_cmp_lt_u32 s70, 8
    s_cbranch_scc1 L_woW
    s_mov_b64 exec, -1
    s_waitcnt vmcnt(0)
    s_barrier
    s_cmp_lg_u32 s3, 0
    s_cbranch_scc1 L_sig5
    s_mov_b64 exec, 1
    v_mov_b32 v3, 1
    buffer_atomic_add v3, off, s[16:19], 0 offset:0 sc0
    s_waitcnt vmcnt(0)
    v_readfirstlane_b32 s24, v3
    s_mov_b64 exec, -1
    s_and_b32 s24, s24, 63
    s_cmp_lg_u32 s24, 63
    s_cbranch_scc1 L_sig5
    v_lshlrev_b32 v4, 7, v0
    v_mov_b32 v3, 1
    s_mov_b32 s24, 0x170000
    buffer_store_dword v3, v4, s[12:15], s24 offen offset:0 sc1
L_sig5:
    v_lshrrev_b32 v3, 2, v0
    v_mul_u32_u24 v3, 544, v3
    v_and_b32 v4, 3, v0
    v_lshl_add_u32 v3, v4, 3, v3
    s_mul_i32 s24, s3, 128
    s_add_u32 s24, s24, 0
    v_add_u32 v3, s24, v3
    v_add_u32 v4, 34816, v3
    ds_read_b64_tr_b16 a[128:129], v3 offset:0
    ds_read_b64_tr_b16 a[130:131], v3 offset:8704
    ds_read_b64_tr_b16 a[132:133], v3 offset:17408
    ds_read_b64_tr_b16 a[134:135], v3 offset:26112
    ds_read_b64_tr_b16 a[136:137], v4 offset:0
    ds_read_b64_tr_b16 a[138:139], v4 offset:8704
    ds_read_b64_tr_b16 a[140:141], v4 offset:17408
    ds_read_b64_tr_b16 a[142:143], v4 offset:26112
    ds_read_b64_tr_b16 a[144:145], v3 offset:32
    ds_read_b64_tr_b16 a[146:147], v3 offset:8736
    ds_read_b64_tr_b16 a[148:149], v3 offset:17440
    ds_read_b64_tr_b16 a[150:151], v3 offset:26144
    ds_read_b64_tr_b16 a[152:153], v4 offset:32
    ds_read_b64_tr_b16 a[154:155], v4 offset:8736
    ds_read_b64_tr_b16 a[156:157], v4 offset:17440
    ds_read_b64_tr_b16 a[158:159], v4 offset:26144
    ds_read_b64_tr_b16 a[160:161], v3 offset:64
    ds_read_b64_tr_b16 a[162:163], v3 offset:8768
    ds_read_b64_tr_b16 a[164:165], v3 offset:17472
    ds_read_b64_tr_b16 a[166:167], v3 offset:26176
    ds_read_b64_tr_b16 a[168:169], v4 offset:64
    ds_read_b64_tr_b16 a[170:171], v4 offset:8768
    ds_read_b64_tr_b16 a[172:173], v4 offset:17472
    ds_read_b64_tr_b16 a[174:175], v4 offset:26176
    ds_read_b64_tr_b16 a[176:177], v3 offset:96
    ds_read_b64_tr_b16 a[178:179], v3 offset:8800
    ds_read_b64_tr_b16 a[180:181], v3 offset:17504
    ds_read_b64_tr_b16 a[182:183], v3 offset:26208
    ds_read_b64_tr_b16 a[184:185], v4 offset:96
    ds_read_b64_tr_b16 a[186:187], v4 offset:8800
    ds_read_b64_tr_b16 a[188:189], v4 offset:17504
    ds_read_b64_tr_b16 a[190:191], v4 offset:26208
    s_mov_b32 s4, s44
    s_mov_b32 s5, s45
    s_mov_b32 s6, 0x400000
    s_mov_b32 s7, 0x20000
    s_mov_b32 s8, s46
    s_mov_b32 s9, s47
    s_mov_b32 s10, 0x400000
    s_mov_b32 s11, 0x20000
    s_mov_b32 s32, s35
    buffer_load_dwordx4 v[128:131], v18, s[4:7], s32 offen nt
    s_add_u32 s32, s32, 8192
    buffer_load_dwordx4 v[132:135], v18, s[4:7], s32 offen nt
    s_add_u32 s32, s32, 8192
    buffer_load_dwordx4 v[136:139], v18, s[4:7], s32 offen nt
    s_add_u32 s32, s32, 8192
    buffer_load_dwordx4 v[140:143], v18, s[4:7], s32 offen nt
    s_add_u32 s32, s32, 8192
    buffer_load_dwordx4 v[144:147], v18, s[4:7], s32 offen nt
    s_add_u32 s32, s32, 8192
    buffer_load_dwordx4 v[148:151], v18, s[4:7], s32 offen nt
    s_add_u32 s32, s32, 8192
    buffer_load_dwordx4 v[152:155], v18, s[4:7], s32 offen nt
    s_add_u32 s32, s32, 8192
    buffer_load_dwordx4 v[156:159], v18, s[4:7], s32 offen nt
    s_add_u32 s32, s32, 8192
    buffer_load_dwordx4 v[160:163], v18, s[4:7], s32 offen nt
    s_add_u32 s32, s32, 8192
    buffer_load_dwordx4 v[164:167], v18, s[4:7], s32 offen nt
    s_add_u32 s32, s32, 8192
    buffer_load_dwordx4 v[168:171], v18, s[4:7], s32 offen nt
    s_add_u32 s32, s32, 8192
    buffer_load_dwordx4 v[172:175], v18, s[4:7], s32 offen nt
    s_add_u32 s32, s32, 8192
    buffer_load_dwordx4 v[176:179], v18, s[4:7], s32 offen nt
    s_add_u32 s32, s32, 8192
    buffer_load_dwordx4 v[180:183], v18, s[4:7], s32 offen nt
    s_add_u32 s32, s32, 8192
    buffer_load_dwordx4 v[184:187], v18, s[4:7], s32 offen nt
    s_add_u32 s32, s32, 8192
    buffer_load_dwordx4 v[188:191], v18, s[4:7], s32 offen nt
    s_add_u32 s32, s32, 8192
    buffer_load_dwordx4 v[192:195], v18, s[4:7], s32 offen nt
    s_add_u32 s32, s32, 8192
    buffer_load_dwordx4 v[196:199], v18, s[4:7], s32 offen nt
    s_add_u32 s32, s32, 8192
    buffer_load_dwordx4 v[200:203], v18, s[4:7], s32 offen nt
    s_add_u32 s32, s32, 8192
    buffer_load_dwordx4 v[204:207], v18, s[4:7], s32 offen nt
    s_add_u32 s32, s32, 8192
    buffer_load_dwordx4 v[208:211], v18, s[4:7], s32 offen nt
    s_add_u32 s32, s32, 8192
    buffer_load_dwordx4 v[212:215], v18, s[4:7], s32 offen nt
    s_add_u32 s32, s32, 8192
    buffer_load_dwordx4 v[216:219], v18, s[4:7], s32 offen nt
    s_add_u32 s32, s32, 8192
    buffer_load_dwordx4 v[220:223], v18, s[4:7], s32 offen nt
    s_add_u32 s32, s32, 8192
    buffer_load_dwordx4 v[224:227], v18, s[4:7], s32 offen nt
    s_add_u32 s32, s32, 8192
    buffer_load_dwordx4 v[228:231], v18, s[4:7], s32 offen nt
    s_add_u32 s32, s32, 8192
    buffer_load_dwordx4 v[232:235], v18, s[4:7], s32 offen nt
    s_add_u32 s32, s32, 8192
    buffer_load_dwordx4 v[236:239], v18, s[4:7], s32 offen nt
    s_add_u32 s32, s32, 8192
    buffer_load_dwordx4 v[240:243], v18, s[4:7], s32 offen nt
    s_add_u32 s32, s32, 8192
    buffer_load_dwordx4 v[244:247], v18, s[4:7], s32 offen nt
    s_add_u32 s32, s32, 8192
    buffer_load_dwordx4 v[248:251], v18, s[4:7], s32 offen nt
    s_add_u32 s32, s32, 8192
    buffer_load_dwordx4 v[252:255], v18, s[4:7], s32 offen nt
    s_add_u32 s32, s32, 8192
    s_lshl_b32 s33, s26, 17
    s_lshl_b32 s24, s3, 15
    s_add_u32 s33, s33, s24
    s_mul_i32 s34, s3, 33792
    s_waitcnt lgkmcnt(0)
    s_barrier
    s_mov_b32 s70, 0
L_woA:
    s_and_b32 s24, s70, 3
    s_lshl_b32 s24, s24, 1
    s_lshr_b32 s25, s70, 2
    s_or_b32 s24, s24, s25
    s_lshl_b32 s24, s24, 10
    s_add_u32 s24, s24, s33
    s_mul_i32 s25, s70, 4224
    s_add_u32 m0, s25, s34
    s_waitcnt vmcnt(24)
    buffer_load_dwordx4 v2, s[8:11], s24 offen nt lds
    s_add_u32 m0, m0, 1056
    s_add_u32 s24, s24, 8192
    s_waitcnt vmcnt(24)
    buffer_load_dwordx4 v2, s[8:11], s24 offen nt lds
    s_add_u32 m0, m0, 1056
    s_add_u32 s24, s24, 8192
    s_waitcnt vmcnt(24)
    buffer_load_dwordx4 v2, s[8:11], s24 offen nt lds
    s_add_u32 m0, m0, 1056
    s_add_u32 s24, s24, 8192
    s_waitcnt vmcnt(24)
    buffer_load_dwordx4 v2, s[8:11], s24 offen nt lds
    s_add_u32 s70, s70, 1
    s_cmp_lt_u32 s70, 8
    s_cbranch_scc1 L_woA
    s_waitcnt vmcnt(0)
    s_barrier
    v_lshrrev_b32 v3, 2, v0
    v_mul_u32_u24 v3, 1056, v3
    v_and_b32 v4, 3, v0
    v_lshl_add_u32 v3, v4, 3, v3
    s_mul_i32 s24, s3, 256
    s_add_u32 s24, s24, 0
    v_add_u32 v3, s24, v3
    v_add_u32 v4, 67584, v3
    ds_read_b64_tr_b16 a[0:1], v3 offset:0
    ds_read_b64_tr_b16 a[2:3], v3 offset:16896
    ds_read_b64_tr_b16 a[4:5], v3 offset:33792
    ds_read_b64_tr_b16 a[6:7], v3 offset:50688
    ds_read_b64_tr_b16 a[8:9], v4 offset:0
    ds_read_b64_tr_b16 a[10:11], v4 offset:16896
    ds_read_b64_tr_b16 a[12:13], v4 offset:33792
    ds_read_b64_tr_b16 a[14:15], v4 offset:50688
    ds_read_b64_tr_b16 a[16:17], v3 offset:32
    ds_read_b64_tr_b16 a[18:19], v3 offset:16928
    ds_read_b64_tr_b16 a[20:21], v3 offset:33824
    ds_read_b64_tr_b16 a[22:23], v3 offset:50720
    ds_read_b64_tr_b16 a[24:25], v4 offset:32
    ds_read_b64_tr_b16 a[26:27], v4 offset:16928
    ds_read_b64_tr_b16 a[28:29], v4 offset:33824
    ds_read_b64_tr_b16 a[30:31], v4 offset:50720
    ds_read_b64_tr_b16 a[32:33], v3 offset:64
    ds_read_b64_tr_b16 a[34:35], v3 offset:16960
    ds_read_b64_tr_b16 a[36:37], v3 offset:33856
    ds_read_b64_tr_b16 a[38:39], v3 offset:50752
    ds_read_b64_tr_b16 a[40:41], v4 offset:64
    ds_read_b64_tr_b16 a[42:43], v4 offset:16960
    ds_read_b64_tr_b16 a[44:45], v4 offset:33856
    ds_read_b64_tr_b16 a[46:47], v4 offset:50752
    ds_read_b64_tr_b16 a[48:49], v3 offset:96
    ds_read_b64_tr_b16 a[50:51], v3 offset:16992
    ds_read_b64_tr_b16 a[52:53], v3 offset:33888
    ds_read_b64_tr_b16 a[54:55], v3 offset:50784
    ds_read_b64_tr_b16 a[56:57], v4 offset:96
    ds_read_b64_tr_b16 a[58:59], v4 offset:16992
    ds_read_b64_tr_b16 a[60:61], v4 offset:33888
    ds_read_b64_tr_b16 a[62:63], v4 offset:50784
    ds_read_b64_tr_b16 a[64:65], v3 offset:128
    ds_read_b64_tr_b16 a[66:67], v3 offset:17024
    ds_read_b64_tr_b16 a[68:69], v3 offset:33920
    ds_read_b64_tr_b16 a[70:71], v3 offset:50816
    ds_read_b64_tr_b16 a[72:73], v4 offset:128
    ds_read_b64_tr_b16 a[74:75], v4 offset:17024
    ds_read_b64_tr_b16 a[76:77], v4 offset:33920
    ds_read_b64_tr_b16 a[78:79], v4 offset:50816
    ds_read_b64_tr_b16 a[80:81], v3 offset:160
    ds_read_b64_tr_b16 a[82:83], v3 offset:17056
    ds_read_b64_tr_b16 a[84:85], v3 offset:33952
    ds_read_b64_tr_b16 a[86:87], v3 offset:50848
    ds_read_b64_tr_b16 a[88:89], v4 offset:160
    ds_read_b64_tr_b16 a[90:91], v4 offset:17056
    ds_read_b64_tr_b16 a[92:93], v4 offset:33952
    ds_read_b64_tr_b16 a[94:95], v4 offset:50848
    ds_read_b64_tr_b16 a[96:97], v3 offset:192
    ds_read_b64_tr_b16 a[98:99], v3 offset:17088
    ds_read_b64_tr_b16 a[100:101], v3 offset:33984
    ds_read_b64_tr_b16 a[102:103], v3 offset:50880
    ds_read_b64_tr_b16 a[104:105], v4 offset:192
    ds_read_b64_tr_b16 a[106:107], v4 offset:17088
    ds_read_b64_tr_b16 a[108:109], v4 offset:33984
    ds_read_b64_tr_b16 a[110:111], v4 offset:50880
    ds_read_b64_tr_b16 a[112:113], v3 offset:224
    ds_read_b64_tr_b16 a[114:115], v3 offset:17120
    ds_read_b64_tr_b16 a[116:117], v3 offset:34016
    ds_read_b64_tr_b16 a[118:119], v3 offset:50912
    ds_read_b64_tr_b16 a[120:121], v4 offset:224
    ds_read_b64_tr_b16 a[122:123], v4 offset:17120
    ds_read_b64_tr_b16 a[124:125], v4 offset:34016
    ds_read_b64_tr_b16 a[126:127], v4 offset:50912
    s_waitcnt lgkmcnt(0)
    s_cmp_lg_u32 s3, 0
    s_cbranch_scc1 L_awx6
    s_mov_b32 s24, 262144
    s_mov_b64 exec, 1
L_aw7:
    buffer_load_dword v1, off, s[12:15], s73 offset:0 sc1
    s_waitcnt vmcnt(0)
    v_readfirstlane_b32 s25, v1
    s_nop 0
    s_cmp_eq_u32 s25, 1
    s_cbranch_scc1 L_awx6
    s_sleep 4
    s_sub_u32 s24, s24, 1
    s_cmp_lg_u32 s24, 0
    s_cbranch_scc1 L_aw7
L_awx6:
    s_mov_b64 exec, -1
    s_barrier
    s_cmp_lg_u32 s3, 0
    s_cbranch_scc1 L_xi8
    s_getreg_b32 s25, hwreg(HW_REG_XCC_ID, 0, 4)
    s_lshl_b32 s24, s26, 7
    s_add_u32 s24, s24, 0x1b6000
    s_mov_b64 exec, 1
    v_mov_b32 v3, s25
    buffer_store_dword v3, off, s[12:15], s24 offset:0 sc1
    s_mov_b64 exec, -1
L_xi8:
    s_cmp_lg_u32 s3, 0
    s_cbranch_scc1 L_awx9
    s_mov_b32 s24, 262144
    s_mov_b64 exec, 1
L_aw10:
    buffer_load_dword v1, off, s[12:15], s73 offset:4 sc1
    s_waitcnt vmcnt(0)
    v_readfirstlane_b32 s25, v1
    s_nop 0
    s_cmp_eq_u32 s25, 1
    s_cbranch_scc1 L_awx9
    s_sleep 4
    s_sub_u32 s24, s24, 1
    s_cmp_lg_u32 s24, 0
    s_cbranch_scc1 L_aw10
L_awx9:
    s_mov_b64 exec, -1
    s_barrier
    s_lshl_b32 s24, s3, 10
    s_lshl_b32 s25, s26, 3
    s_add_u32 s25, s25, s24
    s_add_u32 s25, s25, 0x120000
    s_lshl_b32 s24, s26, 2
    s_add_u32 s24, s24, s3
    v_and_b32 v3, 3, v0
    v_lshlrev_b32 v3, 8, v3
    buffer_load_dwordx2 v[4:5], v3, s[12:15], s25 offen sc1
    s_lshl_b32 s24, s24, 12
    s_add_u32 s24, s24, 0x20000
    buffer_load_dwordx4 v[72:75], v2, s[12:15], s24 offen offset:0 sc1
    buffer_load_dwordx4 v[76:79], v2, s[12:15], s24 offen offset:1024 sc1
    buffer_load_dwordx4 v[80:83], v2, s[12:15], s24 offen offset:2048 sc1
    buffer_load_dwordx4 v[84:87], v2, s[12:15], s24 offen offset:3072 sc1
    s_add_u32 s24, s24, 4096
    s_waitcnt vmcnt(4)
    v_mov_b32 v6, v4
    s_nop 1
    v_max_f32_dpp v6, v6, v6 row_ror:2 row_mask:0xf bank_mask:0xf
    s_nop 1
    v_max_f32_dpp v6, v6, v6 row_ror:1 row_mask:0xf bank_mask:0xf
    v_sub_f32 v4, v4, v6
    v_exp_f32 v4, v4
    s_nop 0
    v_mul_f32 v5, v4, v5
    s_nop 1
    v_add_f32_dpp v5, v5, v5 row_ror:2 row_mask:0xf bank_mask:0xf
    s_nop 1
    v_add_f32_dpp v5, v5, v5 row_ror:1 row_mask:0xf bank_mask:0xf
    v_rcp_f32 v5, v5
    s_nop 0
    v_mul_f32 v4, v4, v5
    s_nop 0
    v_readlane_b32 s24, v4, 0
    s_waitcnt vmcnt(3)
    v_lshlrev_b32 v5, 16, v72
    v_and_b32 v6, 0xffff0000, v72
    v_mul_f32 v104, s24, v5
    v_mul_f32 v105, s24, v6
    v_lshlrev_b32 v5, 16, v73
    v_and_b32 v6, 0xffff0000, v73
    v_mul_f32 v106, s24, v5
    v_mul_f32 v107, s24, v6
    v_lshlrev_b32 v5, 16, v74
    v_and_b32 v6, 0xffff0000, v74
    v_mul_f32 v108, s24, v5
    v_mul_f32 v109, s24, v6
    v_lshlrev_b32 v5, 16, v75
    v_and_b32 v6, 0xffff0000, v75
    v_mul_f32 v110, s24, v5
    v_mul_f32 v111, s24, v6
    v_readlane_b32 s24, v4, 1
    s_waitcnt vmcnt(2)
    v_lshlrev_b32 v5, 16, v76
    v_and_b32 v6, 0xffff0000, v76
    v_fmac_f32 v104, s24, v5
    v_fmac_f32 v105, s24, v6
    v_lshlrev_b32 v5, 16, v77
    v_and_b32 v6, 0xffff0000, v77
    v_fmac_f32 v106, s24, v5
    v_fmac_f32 v107, s24, v6
    v_lshlrev_b32 v5, 16, v78
    v_and_b32 v6, 0xffff0000, v78
    v_fmac_f32 v108, s24, v5
    v_fmac_f32 v109, s24, v6
    v_lshlrev_b32 v5, 16, v79
    v_and_b32 v6, 0xffff0000, v79
    v_fmac_f32 v110, s24, v5
    v_fmac_f32 v111, s24, v6
    v_readlane_b32 s24, v4, 2
    s_waitcnt vmcnt(1)
    v_lshlrev_b32 v5, 16, v80
    v_and_b32 v6, 0xffff0000, v80
    v_fmac_f32 v104, s24, v5
    v_fmac_f32 v105, s24, v6
    v_lshlrev_b32 v5, 16, v81
    v_and_b32 v6, 0xffff0000, v81
    v_fmac_f32 v106, s24, v5
    v_fmac_f32 v107, s24, v6
    v_lshlrev_b32 v5, 16, v82
    v_and_b32 v6, 0xffff0000, v82
    v_fmac_f32 v108, s24, v5
    v_fmac_f32 v109, s24, v6
    v_lshlrev_b32 v5, 16, v83
    v_and_b32 v6, 0xffff0000, v83
    v_fmac_f32 v110, s24, v5
    v_fmac_f32 v111, s24, v6
    v_readlane_b32 s24, v4, 3
    s_waitcnt vmcnt(0)
    v_lshlrev_b32 v5, 16, v84
    v_and_b32 v6, 0xffff0000, v84
    v_fmac_f32 v104, s24, v5
    v_fmac_f32 v105, s24, v6
    v_lshlrev_b32 v5, 16, v85
    v_and_b32 v6, 0xffff0000, v85
    v_fmac_f32 v106, s24, v5
    v_fmac_f32 v107, s24, v6
    v_lshlrev_b32 v5, 16, v86
    v_and_b32 v6, 0xffff0000, v86
    v_fmac_f32 v108, s24, v5
    v_fmac_f32 v109, s24, v6
    v_lshlrev_b32 v5, 16, v87
    v_and_b32 v6, 0xffff0000, v87
    v_fmac_f32 v110, s24, v5
    v_fmac_f32 v111, s24, v6
    v_cvt_pk_bf16_f32 v4, v104, v105
    v_cvt_pk_bf16_f32 v5, v106, v107
    v_cvt_pk_bf16_f32 v6, v108, v109
    v_cvt_pk_bf16_f32 v7, v110, v111
    s_lshl_b32 s24, s3, 10
    s_add_u32 s24, s24, 145408
    v_add_u32 v3, s24, v2
    ds_write_b128 v3, v[4:7]
    s_lshl_b32 s24, s3, 8
    s_add_u32 s24, s24, 145408
    v_add_u32 v3, s24, v19
    s_waitcnt lgkmcnt(0)
    s_barrier
    ds_read_b128 v[32:35], v3 offset:0
    ds_read_b128 v[36:39], v3 offset:16
    ds_read_b128 v[40:43], v3 offset:32
    ds_read_b128 v[44:47], v3 offset:48
    ds_read_b128 v[48:51], v3 offset:2048
    ds_read_b128 v[52:55], v3 offset:2064
    ds_read_b128 v[56:59], v3 offset:2080
    ds_read_b128 v[60:63], v3 offset:2096
    s_waitcnt lgkmcnt(0)
    v_perm_b32 v8, v32, v32, v24
    v_perm_b32 v9, v32, v32, v25
    v_perm_b32 v10, v32, v32, v26
    v_perm_b32 v11, v32, v32, v27
    v_perm_b32 v4, v48, v48, v24
    v_perm_b32 v5, v48, v48, v25
    v_perm_b32 v6, v48, v48, v26
    v_perm_b32 v7, v48, v48, v27
    v_mfma_f32_16x16x32_bf16 v[12:15], v[128:131], v[8:11], 0
    s_nop 0
    v_mfma_f32_16x16x32_bf16 v[68:71], v[128:131], v[4:7], 0
    v_perm_b32 v8, v32, v32, v28
    v_perm_b32 v9, v32, v32, v29
    v_perm_b32 v10, v32, v32, v30
    v_perm_b32 v11, v32, v32, v31
    v_perm_b32 v4, v48, v48, v28
    v_perm_b32 v5, v48, v48, v29
    v_perm_b32 v6, v48, v48, v30
    v_perm_b32 v7, v48, v48, v31
    v_mfma_f32_16x16x32_bf16 v[12:15], v[132:135], v[8:11], v[12:15]
    s_nop 0
    v_mfma_f32_16x16x32_bf16 v[68:71], v[132:135], v[4:7], v[68:71]
    v_perm_b32 v8, v33, v33, v24
    v_perm_b32 v9, v33, v33, v25
    v_perm_b32 v10, v33, v33, v26
    v_perm_b32 v11, v33, v33, v27
    v_perm_b32 v4, v49, v49, v24
    v_perm_b32 v5, v49, v49, v25
    v_perm_b32 v6, v49, v49, v26
    v_perm_b32 v7, v49, v49, v27
    v_mfma_f32_16x16x32_bf16 v[12:15], v[136:139], v[8:11], v[12:15]
    s_nop 0
    v_mfma_f32_16x16x32_bf16 v[68:71], v[136:139], v[4:7], v[68:71]
    v_perm_b32 v8, v33, v33, v28
    v_perm_b32 v9, v33, v33, v29
    v_perm_b32 v10, v33, v33, v30
    v_perm_b32 v11, v33, v33, v31
    v_perm_b32 v4, v49, v49, v28
    v_perm_b32 v5, v49, v49, v29
    v_perm_b32 v6, v49, v49, v30
    v_perm_b32 v7, v49, v49, v31
    v_mfma_f32_16x16x32_bf16 v[12:15], v[140:143], v[8:11], v[12:15]
    s_nop 0
    v_mfma_f32_16x16x32_bf16 v[68:71], v[140:143], v[4:7], v[68:71]
    v_perm_b32 v8, v34, v34, v24
    v_perm_b32 v9, v34, v34, v25
    v_perm_b32 v10, v34, v34, v26
    v_perm_b32 v11, v34, v34, v27
    v_perm_b32 v4, v50, v50, v24
    v_perm_b32 v5, v50, v50, v25
    v_perm_b32 v6, v50, v50, v26
    v_perm_b32 v7, v50, v50, v27
    v_mfma_f32_16x16x32_bf16 v[12:15], v[144:147], v[8:11], v[12:15]
    s_nop 0
    v_mfma_f32_16x16x32_bf16 v[68:71], v[144:147], v[4:7], v[68:71]
    v_perm_b32 v8, v34, v34, v28
    v_perm_b32 v9, v34, v34, v29
    v_perm_b32 v10, v34, v34, v30
    v_perm_b32 v11, v34, v34, v31
    v_perm_b32 v4, v50, v50, v28
    v_perm_b32 v5, v50, v50, v29
    v_perm_b32 v6, v50, v50, v30
    v_perm_b32 v7, v50, v50, v31
    v_mfma_f32_16x16x32_bf16 v[12:15], v[148:151], v[8:11], v[12:15]
    s_nop 0
    v_mfma_f32_16x16x32_bf16 v[68:71], v[148:151], v[4:7], v[68:71]
    v_perm_b32 v8, v35, v35, v24
    v_perm_b32 v9, v35, v35, v25
    v_perm_b32 v10, v35, v35, v26
    v_perm_b32 v11, v35, v35, v27
    v_perm_b32 v4, v51, v51, v24
    v_perm_b32 v5, v51, v51, v25
    v_perm_b32 v6, v51, v51, v26
    v_perm_b32 v7, v51, v51, v27
    v_mfma_f32_16x16x32_bf16 v[12:15], v[152:155], v[8:11], v[12:15]
    s_nop 0
    v_mfma_f32_16x16x32_bf16 v[68:71], v[152:155], v[4:7], v[68:71]
    v_perm_b32 v8, v35, v35, v28
    v_perm_b32 v9, v35, v35, v29
    v_perm_b32 v10, v35, v35, v30
    v_perm_b32 v11, v35, v35, v31
    v_perm_b32 v4, v51, v51, v28
    v_perm_b32 v5, v51, v51, v29
    v_perm_b32 v6, v51, v51, v30
    v_perm_b32 v7, v51, v51, v31
    v_mfma_f32_16x16x32_bf16 v[12:15], v[156:159], v[8:11], v[12:15]
    s_nop 0
    v_mfma_f32_16x16x32_bf16 v[68:71], v[156:159], v[4:7], v[68:71]
    v_perm_b32 v8, v36, v36, v24
    v_perm_b32 v9, v36, v36, v25
    v_perm_b32 v10, v36, v36, v26
    v_perm_b32 v11, v36, v36, v27
    v_perm_b32 v4, v52, v52, v24
    v_perm_b32 v5, v52, v52, v25
    v_perm_b32 v6, v52, v52, v26
    v_perm_b32 v7, v52, v52, v27
    v_mfma_f32_16x16x32_bf16 v[12:15], v[160:163], v[8:11], v[12:15]
    s_nop 0
    v_mfma_f32_16x16x32_bf16 v[68:71], v[160:163], v[4:7], v[68:71]
    v_perm_b32 v8, v36, v36, v28
    v_perm_b32 v9, v36, v36, v29
    v_perm_b32 v10, v36, v36, v30
    v_perm_b32 v11, v36, v36, v31
    v_perm_b32 v4, v52, v52, v28
    v_perm_b32 v5, v52, v52, v29
    v_perm_b32 v6, v52, v52, v30
    v_perm_b32 v7, v52, v52, v31
    v_mfma_f32_16x16x32_bf16 v[12:15], v[164:167], v[8:11], v[12:15]
    s_nop 0
    v_mfma_f32_16x16x32_bf16 v[68:71], v[164:167], v[4:7], v[68:71]
    v_perm_b32 v8, v37, v37, v24
    v_perm_b32 v9, v37, v37, v25
    v_perm_b32 v10, v37, v37, v26
    v_perm_b32 v11, v37, v37, v27
    v_perm_b32 v4, v53, v53, v24
    v_perm_b32 v5, v53, v53, v25
    v_perm_b32 v6, v53, v53, v26
    v_perm_b32 v7, v53, v53, v27
    v_mfma_f32_16x16x32_bf16 v[12:15], v[168:171], v[8:11], v[12:15]
    s_nop 0
    v_mfma_f32_16x16x32_bf16 v[68:71], v[168:171], v[4:7], v[68:71]
    v_perm_b32 v8, v37, v37, v28
    v_perm_b32 v9, v37, v37, v29
    v_perm_b32 v10, v37, v37, v30
    v_perm_b32 v11, v37, v37, v31
    v_perm_b32 v4, v53, v53, v28
    v_perm_b32 v5, v53, v53, v29
    v_perm_b32 v6, v53, v53, v30
    v_perm_b32 v7, v53, v53, v31
    v_mfma_f32_16x16x32_bf16 v[12:15], v[172:175], v[8:11], v[12:15]
    s_nop 0
    v_mfma_f32_16x16x32_bf16 v[68:71], v[172:175], v[4:7], v[68:71]
    v_perm_b32 v8, v38, v38, v24
    v_perm_b32 v9, v38, v38, v25
    v_perm_b32 v10, v38, v38, v26
    v_perm_b32 v11, v38, v38, v27
    v_perm_b32 v4, v54, v54, v24
    v_perm_b32 v5, v54, v54, v25
    v_perm_b32 v6, v54, v54, v26
    v_perm_b32 v7, v54, v54, v27
    v_mfma_f32_16x16x32_bf16 v[12:15], v[176:179], v[8:11], v[12:15]
    s_nop 0
    v_mfma_f32_16x16x32_bf16 v[68:71], v[176:179], v[4:7], v[68:71]
    v_perm_b32 v8, v38, v38, v28
    v_perm_b32 v9, v38, v38, v29
    v_perm_b32 v10, v38, v38, v30
    v_perm_b32 v11, v38, v38, v31
    v_perm_b32 v4, v54, v54, v28
    v_perm_b32 v5, v54, v54, v29
    v_perm_b32 v6, v54, v54, v30
    v_perm_b32 v7, v54, v54, v31
    v_mfma_f32_16x16x32_bf16 v[12:15], v[180:183], v[8:11], v[12:15]
    s_nop 0
    v_mfma_f32_16x16x32_bf16 v[68:71], v[180:183], v[4:7], v[68:71]
    v_perm_b32 v8, v39, v39, v24
    v_perm_b32 v9, v39, v39, v25
    v_perm_b32 v10, v39, v39, v26
    v_perm_b32 v11, v39, v39, v27
    v_perm_b32 v4, v55, v55, v24
    v_perm_b32 v5, v55, v55, v25
    v_perm_b32 v6, v55, v55, v26
    v_perm_b32 v7, v55, v55, v27
    v_mfma_f32_16x16x32_bf16 v[12:15], v[184:187], v[8:11], v[12:15]
    s_nop 0
    v_mfma_f32_16x16x32_bf16 v[68:71], v[184:187], v[4:7], v[68:71]
    v_perm_b32 v8, v39, v39, v28
    v_perm_b32 v9, v39, v39, v29
    v_perm_b32 v10, v39, v39, v30
    v_perm_b32 v11, v39, v39, v31
    v_perm_b32 v4, v55, v55, v28
    v_perm_b32 v5, v55, v55, v29
    v_perm_b32 v6, v55, v55, v30
    v_perm_b32 v7, v55, v55, v31
    v_mfma_f32_16x16x32_bf16 v[12:15], v[188:191], v[8:11], v[12:15]
    s_nop 0
    v_mfma_f32_16x16x32_bf16 v[68:71], v[188:191], v[4:7], v[68:71]
    v_perm_b32 v8, v40, v40, v24
    v_perm_b32 v9, v40, v40, v25
    v_perm_b32 v10, v40, v40, v26
    v_perm_b32 v11, v40, v40, v27
    v_perm_b32 v4, v56, v56, v24
    v_perm_b32 v5, v56, v56, v25
    v_perm_b32 v6, v56, v56, v26
    v_perm_b32 v7, v56, v56, v27
    v_mfma_f32_16x16x32_bf16 v[12:15], v[192:195], v[8:11], v[12:15]
    s_nop 0
    v_mfma_f32_16x16x32_bf16 v[68:71], v[192:195], v[4:7], v[68:71]
    v_perm_b32 v8, v40, v40, v28
    v_perm_b32 v9, v40, v40, v29
    v_perm_b32 v10, v40, v40, v30
    v_perm_b32 v11, v40, v40, v31
    v_perm_b32 v4, v56, v56, v28
    v_perm_b32 v5, v56, v56, v29
    v_perm_b32 v6, v56, v56, v30
    v_perm_b32 v7, v56, v56, v31
    v_mfma_f32_16x16x32_bf16 v[12:15], v[196:199], v[8:11], v[12:15]
    s_nop 0
    v_mfma_f32_16x16x32_bf16 v[68:71], v[196:199], v[4:7], v[68:71]
    v_perm_b32 v8, v41, v41, v24
    v_perm_b32 v9, v41, v41, v25
    v_perm_b32 v10, v41, v41, v26
    v_perm_b32 v11, v41, v41, v27
    v_perm_b32 v4, v57, v57, v24
    v_perm_b32 v5, v57, v57, v25
    v_perm_b32 v6, v57, v57, v26
    v_perm_b32 v7, v57, v57, v27
    v_mfma_f32_16x16x32_bf16 v[12:15], v[200:203], v[8:11], v[12:15]
    s_nop 0
    v_mfma_f32_16x16x32_bf16 v[68:71], v[200:203], v[4:7], v[68:71]
    v_perm_b32 v8, v41, v41, v28
    v_perm_b32 v9, v41, v41, v29
    v_perm_b32 v10, v41, v41, v30
    v_perm_b32 v11, v41, v41, v31
    v_perm_b32 v4, v57, v57, v28
    v_perm_b32 v5, v57, v57, v29
    v_perm_b32 v6, v57, v57, v30
    v_perm_b32 v7, v57, v57, v31
    v_mfma_f32_16x16x32_bf16 v[12:15], v[204:207], v[8:11], v[12:15]
    s_nop 0
    v_mfma_f32_16x16x32_bf16 v[68:71], v[204:207], v[4:7], v[68:71]
    v_perm_b32 v8, v42, v42, v24
    v_perm_b32 v9, v42, v42, v25
    v_perm_b32 v10, v42, v42, v26
    v_perm_b32 v11, v42, v42, v27
    v_perm_b32 v4, v58, v58, v24
    v_perm_b32 v5, v58, v58, v25
    v_perm_b32 v6, v58, v58, v26
    v_perm_b32 v7, v58, v58, v27
    v_mfma_f32_16x16x32_bf16 v[12:15], v[208:211], v[8:11], v[12:15]
    s_nop 0
    v_mfma_f32_16x16x32_bf16 v[68:71], v[208:211], v[4:7], v[68:71]
    v_perm_b32 v8, v42, v42, v28
    v_perm_b32 v9, v42, v42, v29
    v_perm_b32 v10, v42, v42, v30
    v_perm_b32 v11, v42, v42, v31
    v_perm_b32 v4, v58, v58, v28
    v_perm_b32 v5, v58, v58, v29
    v_perm_b32 v6, v58, v58, v30
    v_perm_b32 v7, v58, v58, v31
    v_mfma_f32_16x16x32_bf16 v[12:15], v[212:215], v[8:11], v[12:15]
    s_nop 0
    v_mfma_f32_16x16x32_bf16 v[68:71], v[212:215], v[4:7], v[68:71]
    v_perm_b32 v8, v43, v43, v24
    v_perm_b32 v9, v43, v43, v25
    v_perm_b32 v10, v43, v43, v26
    v_perm_b32 v11, v43, v43, v27
    v_perm_b32 v4, v59, v59, v24
    v_perm_b32 v5, v59, v59, v25
    v_perm_b32 v6, v59, v59, v26
    v_perm_b32 v7, v59, v59, v27
    v_mfma_f32_16x16x32_bf16 v[12:15], v[216:219], v[8:11], v[12:15]
    s_nop 0
    v_mfma_f32_16x16x32_bf16 v[68:71], v[216:219], v[4:7], v[68:71]
    v_perm_b32 v8, v43, v43, v28
    v_perm_b32 v9, v43, v43, v29
    v_perm_b32 v10, v43, v43, v30
    v_perm_b32 v11, v43, v43, v31
    v_perm_b32 v4, v59, v59, v28
    v_perm_b32 v5, v59, v59, v29
    v_perm_b32 v6, v59, v59, v30
    v_perm_b32 v7, v59, v59, v31
    v_mfma_f32_16x16x32_bf16 v[12:15], v[220:223], v[8:11], v[12:15]
    s_nop 0
    v_mfma_f32_16x16x32_bf16 v[68:71], v[220:223], v[4:7], v[68:71]
    v_perm_b32 v8, v44, v44, v24
    v_perm_b32 v9, v44, v44, v25
    v_perm_b32 v10, v44, v44, v26
    v_perm_b32 v11, v44, v44, v27
    v_perm_b32 v4, v60, v60, v24
    v_perm_b32 v5, v60, v60, v25
    v_perm_b32 v6, v60, v60, v26
    v_perm_b32 v7, v60, v60, v27
    v_mfma_f32_16x16x32_bf16 v[12:15], v[224:227], v[8:11], v[12:15]
    s_nop 0
    v_mfma_f32_16x16x32_bf16 v[68:71], v[224:227], v[4:7], v[68:71]
    v_perm_b32 v8, v44, v44, v28
    v_perm_b32 v9, v44, v44, v29
    v_perm_b32 v10, v44, v44, v30
    v_perm_b32 v11, v44, v44, v31
    v_perm_b32 v4, v60, v60, v28
    v_perm_b32 v5, v60, v60, v29
    v_perm_b32 v6, v60, v60, v30
    v_perm_b32 v7, v60, v60, v31
    v_mfma_f32_16x16x32_bf16 v[12:15], v[228:231], v[8:11], v[12:15]
    s_nop 0
    v_mfma_f32_16x16x32_bf16 v[68:71], v[228:231], v[4:7], v[68:71]
    v_perm_b32 v8, v45, v45, v24
    v_perm_b32 v9, v45, v45, v25
    v_perm_b32 v10, v45, v45, v26
    v_perm_b32 v11, v45, v45, v27
    v_perm_b32 v4, v61, v61, v24
    v_perm_b32 v5, v61, v61, v25
    v_perm_b32 v6, v61, v61, v26
    v_perm_b32 v7, v61, v61, v27
    v_mfma_f32_16x16x32_bf16 v[12:15], v[232:235], v[8:11], v[12:15]
    s_nop 0
    v_mfma_f32_16x16x32_bf16 v[68:71], v[232:235], v[4:7], v[68:71]
    v_perm_b32 v8, v45, v45, v28
    v_perm_b32 v9, v45, v45, v29
    v_perm_b32 v10, v45, v45, v30
    v_perm_b32 v11, v45, v45, v31
    v_perm_b32 v4, v61, v61, v28
    v_perm_b32 v5, v61, v61, v29
    v_perm_b32 v6, v61, v61, v30
    v_perm_b32 v7, v61, v61, v31
    v_mfma_f32_16x16x32_bf16 v[12:15], v[236:239], v[8:11], v[12:15]
    s_nop 0
    v_mfma_f32_16x16x32_bf16 v[68:71], v[236:239], v[4:7], v[68:71]
    v_perm_b32 v8, v46, v46, v24
    v_perm_b32 v9, v46, v46, v25
    v_perm_b32 v10, v46, v46, v26
    v_perm_b32 v11, v46, v46, v27
    v_perm_b32 v4, v62, v62, v24
    v_perm_b32 v5, v62, v62, v25
    v_perm_b32 v6, v62, v62, v26
    v_perm_b32 v7, v62, v62, v27
    v_mfma_f32_16x16x32_bf16 v[12:15], v[240:243], v[8:11], v[12:15]
    s_nop 0
    v_mfma_f32_16x16x32_bf16 v[68:71], v[240:243], v[4:7], v[68:71]
    v_perm_b32 v8, v46, v46, v28
    v_perm_b32 v9, v46, v46, v29
    v_perm_b32 v10, v46, v46, v30
    v_perm_b32 v11, v46, v46, v31
    v_perm_b32 v4, v62, v62, v28
    v_perm_b32 v5, v62, v62, v29
    v_perm_b32 v6, v62, v62, v30
    v_perm_b32 v7, v62, v62, v31
    v_mfma_f32_16x16x32_bf16 v[12:15], v[244:247], v[8:11], v[12:15]
    s_nop 0
    v_mfma_f32_16x16x32_bf16 v[68:71], v[244:247], v[4:7], v[68:71]
    v_perm_b32 v8, v47, v47, v24
    v_perm_b32 v9, v47, v47, v25
    v_perm_b32 v10, v47, v47, v26
    v_perm_b32 v11, v47, v47, v27
    v_perm_b32 v4, v63, v63, v24
    v_perm_b32 v5, v63, v63, v25
    v_perm_b32 v6, v63, v63, v26
    v_perm_b32 v7, v63, v63, v27
    v_mfma_f32_16x16x32_bf16 v[12:15], v[248:251], v[8:11], v[12:15]
    s_nop 0
    v_mfma_f32_16x16x32_bf16 v[68:71], v[248:251], v[4:7], v[68:71]
    v_perm_b32 v8, v47, v47, v28
    v_perm_b32 v9, v47, v47, v29
    v_perm_b32 v10, v47, v47, v30
    v_perm_b32 v11, v47, v47, v31
    v_perm_b32 v4, v63, v63, v28
    v_perm_b32 v5, v63, v63, v29
    v_perm_b32 v6, v63, v63, v30
    v_perm_b32 v7, v63, v63, v31
    v_mfma_f32_16x16x32_bf16 v[12:15], v[252:255], v[8:11], v[12:15]
    s_nop 0
    v_mfma_f32_16x16x32_bf16 v[68:71], v[252:255], v[4:7], v[68:71]
    v_lshrrev_b32 v3, 4, v0
    v_lshlrev_b32 v3, 7, v3
    v_and_b32 v4, 7, v0
    v_lshl_add_u32 v3, v4, 4, v3
    v_bfe_u32 v4, v0, 3, 1
    v_lshl_add_u32 v3, v4, 9, v3
    s_lshl_b32 s24, s3, 11
    s_add_u32 s24, s24, 135168
    v_add_u32 v3, s24, v3
    ds_write_b128 v3, v[12:15]
    ds_write_b128 v3, v[68:71] offset:1024
    s_waitcnt lgkmcnt(0)
    s_barrier
    v_and_b32 v5, 31, v0
    s_lshl_b32 s24, s3, 9
    s_add_u32 s24, s24, 135168
    v_lshl_add_u32 v3, v5, 4, s24
    ds_read_b128 v[72:75], v3 offset:0
    ds_read_b128 v[76:79], v3 offset:2048
    ds_read_b128 v[80:83], v3 offset:4096
    ds_read_b128 v[84:87], v3 offset:6144
    s_lshl_b32 s24, s3, 8
    s_add_u32 s24, s24, 143360
    v_lshl_add_u32 v5, v5, 3, s24
    s_waitcnt lgkmcnt(0)
    v_add_f32 v72, v72, v76
    v_add_f32 v73, v73, v77
    v_add_f32 v74, v74, v78
    v_add_f32 v75, v75, v79
    v_add_f32 v72, v72, v80
    v_add_f32 v73, v73, v81
    v_add_f32 v74, v74, v82
    v_add_f32 v75, v75, v83
    v_add_f32 v72, v72, v84
    v_add_f32 v73, v73, v85
    v_add_f32 v74, v74, v86
    v_add_f32 v75, v75, v87
    v_cvt_pk_bf16_f32 v6, v72, v73
    v_cvt_pk_bf16_f32 v7, v74, v75
    ds_write_b64 v5, v[6:7]
    v_lshrrev_b32 v3, 4, v0
    v_and_b32 v4, 3, v0
    v_lshlrev_b32 v5, 8, v4
    v_lshl_add_u32 v5, v3, 4, v5
    v_add_u32 v5, 143360, v5
    s_waitcnt lgkmcnt(0)
    s_barrier
    ds_read_b128 v[32:35], v5 offset:0
    ds_read_b128 v[36:39], v5 offset:64
    ds_read_b128 v[40:43], v5 offset:128
    ds_read_b128 v[44:47], v5 offset:192
    s_waitcnt lgkmcnt(3)
    v_mfma_f32_16x16x32_bf16 v[72:75], v[32:35], a[0:3], 0
    s_waitcnt lgkmcnt(2)
    v_mfma_f32_16x16x32_bf16 v[72:75], v[36:39], a[4:7], v[72:75]
    s_waitcnt lgkmcnt(1)
    v_mfma_f32_16x16x32_bf16 v[72:75], v[40:43], a[8:11], v[72:75]
    s_waitcnt lgkmcnt(0)
    v_mfma_f32_16x16x32_bf16 v[72:75], v[44:47], a[12:15], v[72:75]
    v_mfma_f32_16x16x32_bf16 v[76:79], v[32:35], a[16:19], 0
    v_mfma_f32_16x16x32_bf16 v[76:79], v[36:39], a[20:23], v[76:79]
    v_mfma_f32_16x16x32_bf16 v[76:79], v[40:43], a[24:27], v[76:79]
    v_mfma_f32_16x16x32_bf16 v[76:79], v[44:47], a[28:31], v[76:79]
    v_mfma_f32_16x16x32_bf16 v[80:83], v[32:35], a[32:35], 0
    v_mfma_f32_16x16x32_bf16 v[80:83], v[36:39], a[36:39], v[80:83]
    v_mfma_f32_16x16x32_bf16 v[80:83], v[40:43], a[40:43], v[80:83]
    v_mfma_f32_16x16x32_bf16 v[80:83], v[44:47], a[44:47], v[80:83]
    v_mov_b32_dpp v4, v72 quad_perm:[0,1,2,3] row_mask:0x1 bank_mask:0xf
    v_mov_b32_dpp v5, v73 quad_perm:[0,1,2,3] row_mask:0x1 bank_mask:0xf
    v_mov_b32_dpp v6, v74 quad_perm:[0,1,2,3] row_mask:0x1 bank_mask:0xf
    v_mov_b32_dpp v7, v75 quad_perm:[0,1,2,3] row_mask:0x1 bank_mask:0xf
    v_mfma_f32_16x16x32_bf16 v[84:87], v[32:35], a[48:51], 0
    v_mfma_f32_16x16x32_bf16 v[84:87], v[36:39], a[52:55], v[84:87]
    v_mfma_f32_16x16x32_bf16 v[84:87], v[40:43], a[56:59], v[84:87]
    v_mfma_f32_16x16x32_bf16 v[84:87], v[44:47], a[60:63], v[84:87]
    v_mov_b32_dpp v4, v76 quad_perm:[0,1,2,3] row_mask:0x2 bank_mask:0xf
    v_mov_b32_dpp v5, v77 quad_perm:[0,1,2,3] row_mask:0x2 bank_mask:0xf
    v_mov_b32_dpp v6, v78 quad_perm:[0,1,2,3] row_mask:0x2 bank_mask:0xf
    v_mov_b32_dpp v7, v79 quad_perm:[0,1,2,3] row_mask:0x2 bank_mask:0xf
    v_mfma_f32_16x16x32_bf16 v[88:91], v[32:35], a[64:67], 0
    v_mfma_f32_16x16x32_bf16 v[88:91], v[36:39], a[68:71], v[88:91]
    v_mfma_f32_16x16x32_bf16 v[88:91], v[40:43], a[72:75], v[88:91]
    v_mfma_f32_16x16x32_bf16 v[88:91], v[44:47], a[76:79], v[88:91]
    v_mov_b32_dpp v4, v80 quad_perm:[0,1,2,3] row_mask:0x4 bank_mask:0xf
    v_mov_b32_dpp v5, v81 quad_perm:[0,1,2,3] row_mask:0x4 bank_mask:0xf
    v_mov_b32_dpp v6, v82 quad_perm:[0,1,2,3] row_mask:0x4 bank_mask:0xf
    v_mov_b32_dpp v7, v83 quad_perm:[0,1,2,3] row_mask:0x4 bank_mask:0xf
    v_mfma_f32_16x16x32_bf16 v[92:95], v[32:35], a[80:83], 0
    v_mfma_f32_16x16x32_bf16 v[92:95], v[36:39], a[84:87], v[92:95]
    v_mfma_f32_16x16x32_bf16 v[92:95], v[40:43], a[88:91], v[92:95]
    v_mfma_f32_16x16x32_bf16 v[92:95], v[44:47], a[92:95], v[92:95]
    v_mov_b32_dpp v4, v84 quad_perm:[0,1,2,3] row_mask:0x8 bank_mask:0xf
    v_mov_b32_dpp v5, v85 quad_perm:[0,1,2,3] row_mask:0x8 bank_mask:0xf
    v_mov_b32_dpp v6, v86 quad_perm:[0,1,2,3] row_mask:0x8 bank_mask:0xf
    v_mov_b32_dpp v7, v87 quad_perm:[0,1,2,3] row_mask:0x8 bank_mask:0xf
    v_mfma_f32_16x16x32_bf16 v[96:99], v[32:35], a[96:99], 0
    v_mfma_f32_16x16x32_bf16 v[96:99], v[36:39], a[100:103], v[96:99]
    v_mfma_f32_16x16x32_bf16 v[96:99], v[40:43], a[104:107], v[96:99]
    v_mfma_f32_16x16x32_bf16 v[96:99], v[44:47], a[108:111], v[96:99]
    v_mov_b32_dpp v8, v88 quad_perm:[0,1,2,3] row_mask:0x1 bank_mask:0xf
    v_mov_b32_dpp v9, v89 quad_perm:[0,1,2,3] row_mask:0x1 bank_mask:0xf
    v_mov_b32_dpp v10, v90 quad_perm:[0,1,2,3] row_mask:0x1 bank_mask:0xf
    v_mov_b32_dpp v11, v91 quad_perm:[0,1,2,3] row_mask:0x1 bank_mask:0xf
    v_mfma_f32_16x16x32_bf16 v[100:103], v[32:35], a[112:115], 0
    v_mfma_f32_16x16x32_bf16 v[100:103], v[36:39], a[116:119], v[100:103]
    v_mfma_f32_16x16x32_bf16 v[100:103], v[40:43], a[120:123], v[100:103]
    v_mfma_f32_16x16x32_bf16 v[100:103], v[44:47], a[124:127], v[100:103]
    v_mov_b32_dpp v8, v92 quad_perm:[0,1,2,3] row_mask:0x2 bank_mask:0xf
    v_mov_b32_dpp v9, v93 quad_perm:[0,1,2,3] row_mask:0x2 bank_mask:0xf
    v_mov_b32_dpp v10, v94 quad_perm:[0,1,2,3] row_mask:0x2 bank_mask:0xf
    v_mov_b32_dpp v11, v95 quad_perm:[0,1,2,3] row_mask:0x2 bank_mask:0xf
    v_mov_b32_dpp v8, v96 quad_perm:[0,1,2,3] row_mask:0x4 bank_mask:0xf
    v_mov_b32_dpp v9, v97 quad_perm:[0,1,2,3] row_mask:0x4 bank_mask:0xf
    v_mov_b32_dpp v10, v98 quad_perm:[0,1,2,3] row_mask:0x4 bank_mask:0xf
    v_mov_b32_dpp v11, v99 quad_perm:[0,1,2,3] row_mask:0x4 bank_mask:0xf
    v_mov_b32_dpp v8, v100 quad_perm:[0,1,2,3] row_mask:0x8 bank_mask:0xf
    v_mov_b32_dpp v9, v101 quad_perm:[0,1,2,3] row_mask:0x8 bank_mask:0xf
    v_mov_b32_dpp v10, v102 quad_perm:[0,1,2,3] row_mask:0x8 bank_mask:0xf
    v_mov_b32_dpp v11, v103 quad_perm:[0,1,2,3] row_mask:0x8 bank_mask:0xf
    s_lshl_b32 s24, s26, 12
    s_lshl_b32 s25, s3, 10
    s_add_u32 s24, s24, s25
    s_add_u32 s24, s24, 0x124000
    v_lshlrev_b32 v3, 3, v0
    v_cvt_pk_bf16_f32 v4, v4, v5
    v_cvt_pk_bf16_f32 v5, v6, v7
    v_cvt_pk_bf16_f32 v6, v8, v9
    v_cvt_pk_bf16_f32 v7, v10, v11
    buffer_store_dwordx2 v[4:5], v3, s[12:15], s24 offen sc1
    buffer_store_dwordx2 v[6:7], v3, s[12:15], s24 offen offset:512 sc1
    s_waitcnt vmcnt(0)
    s_barrier
    s_cmp_lg_u32 s3, 0
    s_cbranch_scc1 L_sig11
    s_mov_b64 exec, 1
    v_mov_b32 v3, 1
    buffer_atomic_add v3, off, s[16:19], 0 offset:8 sc0
    s_waitcnt vmcnt(0)
    v_readfirstlane_b32 s24, v3
    s_mov_b64 exec, -1
    s_and_b32 s24, s24, 31
    s_cmp_lg_u32 s24, 31
    s_cbranch_scc1 L_sig11
    v_lshlrev_b32 v4, 7, v0
    v_mov_b32 v3, 1
    s_mov_b32 s24, 0x170000
    buffer_store_dword v3, v4, s[12:15], s24 offen offset:8 sc1
L_sig11:
L_R:
    s_mov_b32 s20, s58
    s_mov_b32 s21, s59
    s_mov_b32 s22, 0x2000
    s_mov_b32 s23, 0x20000
    v_and_b32 v3, 1, v0
    v_lshlrev_b32 v3, 4, v3
    v_mov_b32 v4, 0xffff
    v_lshlrev_b32 v4, v3, v4
    v_bfe_u32 v3, v0, 1, 2
    v_cmp_eq_u32 vcc, 0, v3
    s_nop 1
    v_cndmask_b32 v20, 0, v4, vcc
    v_cmp_eq_u32 vcc, 1, v3
    s_nop 1
    v_cndmask_b32 v21, 0, v4, vcc
    v_cmp_eq_u32 vcc, 2, v3
    s_nop 1
    v_cndmask_b32 v22, 0, v4, vcc
    v_cmp_eq_u32 vcc, 3, v3
    s_nop 1
    v_cndmask_b32 v23, 0, v4, vcc
    v_lshrrev_b32 v3, 4, v0
    v_and_b32 v4, 7, v0
    v_lshl_add_u32 v5, v3, 3, v4
    v_lshlrev_b32 v27, 4, v5
    v_add_u32 v27, 144384, v27
    s_lshl_b32 s24, s3, 2
    v_add_u32 v26, s24, v27
    s_lshl_b32 s24, s3, 8
    s_add_u32 s24, s24, 143360
    v_lshl_add_u32 v24, v5, 3, s24
    s_and_b32 s30, s74, 7
    s_lshl_b32 s30, s30, 3
    s_lshr_b32 s24, s74, 3
    s_or_b32 s30, s30, s24
    v_lshlrev_b32 v28, 11, v3
    v_lshl_add_u32 v28, v4, 1, v28
    s_lshl_b32 s24, s30, 4
    v_add_u32 v28, s24, v28
    v_lshrrev_b32 v5, 3, v0
    s_lshl_b32 s24, s3, 3
    v_add_u32 v5, s24, v5
    v_lshlrev_b32 v5, 12, v5
    v_lshl_add_u32 v30, v4, 3, v5
    v_and_b32 v6, 1, v0
    s_lshl_b32 s24, s3, 1
    v_add_u32 v6, s24, v6
    v_lshrrev_b32 v5, 1, v0
    v_lshlrev_b32 v5, 12, v5
    v_lshl_add_u32 v30, v6, 3, v5
    v_lshlrev_b32 v28, 11, v3
    v_lshl_add_u32 v28, v6, 1, v28
    s_lshl_b32 s24, s30, 4
    v_add_u32 v28, s24, v28
    v_lshlrev_b32 v80, 3, v0
    v_and_b32 v5, 3, v0
    v_lshlrev_b32 v25, 8, v5
    v_lshl_add_u32 v25, v3, 4, v25
    v_add_u32 v25, 143360, v25
    v_and_b32 v29, 0x1ff, v2
    v_min_u32 v6, 5, v4
    v_lshrrev_b32 v5, 1, v6
    v_lshlrev_b32 v31, 10, v5
    v_and_b32 v6, 1, v6
    v_lshl_add_u32 v31, v6, 4, v31
    s_cmp_lg_u32 s3, 0
    s_cbranch_scc1 L_awx12
    s_mov_b32 s24, 262144
    s_mov_b64 exec, 1
L_aw13:
    buffer_load_dword v1, off, s[12:15], s73 offset:8 sc1
    s_waitcnt vmcnt(0)
    v_readfirstlane_b32 s25, v1
    s_nop 0
    s_cmp_eq_u32 s25, 1
    s_cbranch_scc1 L_awx12
    s_sleep 4
    s_sub_u32 s24, s24, 1
    s_cmp_lg_u32 s24, 0
    s_cbranch_scc1 L_aw13
L_awx12:
    s_mov_b64 exec, -1
    s_barrier
    s_lshl_b32 s30, s30, 6
    s_add_u32 s24, s30, 0x124000
    buffer_load_dwordx2 v[8:9], v30, s[12:15], s24 offen sc1
    s_waitcnt vmcnt(0)
    v_lshlrev_b32 v4, 16, v8
    v_lshlrev_b32 v6, 16, v9
    v_and_b32 v5, 0xffff0000, v8
    v_and_b32 v7, 0xffff0000, v9
    v_permlane32_swap_b32 v4, v6
    s_nop 0
    v_permlane32_swap_b32 v5, v7
    v_add_f32 v4, v4, v6
    v_add_f32 v5, v5, v7
    s_nop 1
    v_permlane16_swap_b32 v4, v5
    v_add_f32 v4, v4, v5
    s_nop 1
    v_add_f32_dpp v4, v4, v4 row_ror:8 row_mask:0xf bank_mask:0xf
    s_nop 1
    v_add_f32_dpp v4, v4, v4 row_ror:4 row_mask:0xf bank_mask:0xf
    s_nop 1
    v_add_f32_dpp v4, v4, v4 row_ror:2 row_mask:0xf bank_mask:0xf
    v_cvt_pk_bf16_f32 v4, v4, v4
    s_mov_b32 exec_lo, 0x00030003
    s_mov_b32 exec_hi, 0x00030003
    buffer_store_short v4, v28, s[20:23], 0 offen offset:0
    s_mov_b64 exec, -1
    s_lshl_b32 s33, s26, 2
    s_add_u32 s33, s33, s3
    s_and_b32 s35, s72, 7
    s_lshl_b32 s35, s35, 7
    s_add_u32 s35, s35, 0x1b0000
    s_lshr_b32 s34, s72, 3
    s_mul_i32 s34, s34, 6
    s_lshr_b32 s24, s3, 1
    s_mul_i32 s24, s24, 3
    s_add_u32 s24, s24, s34
    s_lshl_b32 s29, s24, 10
    s_add_u32 s29, s29, s35
    s_and_b32 s24, s3, 1
    s_lshl_b32 s24, s24, 5
    s_add_u32 s29, s29, s24
    s_mov_b32 s24, 262144
    s_branch L_pd14_in
L_pd14:
    s_sleep 64
L_pd14_in:
    buffer_load_dwordx2 v[8:9], v31, s[12:15], s29 offen sc1
    s_waitcnt vmcnt(0)
    v_max_u32 v3, v8, v9
    v_cmp_eq_u32 vcc, -1, v3
    s_sub_u32 s24, s24, 1
    s_cmp_eq_u32 s24, 0
    s_cbranch_scc1 L_pd14_x
    s_and_b64 exec, exec, vcc
    s_cbranch_scc1 L_pd14
L_pd14_x:
    s_mov_b64 exec, -1
    v_mov_b32 v6, v8
    s_nop 1
    v_max_f32_dpp v6, v6, v6 quad_perm:[1,0,3,2] row_mask:0xf bank_mask:0xf
    s_nop 1
    v_max_f32_dpp v6, v6, v6 quad_perm:[2,3,0,1] row_mask:0xf bank_mask:0xf
    s_nop 1
    v_max_f32_dpp v6, v6, v6 row_half_mirror row_mask:0xf bank_mask:0xf
    v_sub_f32 v8, v8, v6
    v_exp_f32 v8, v8
    v_and_b32 v4, 7, v0
    v_cmp_gt_u32 vcc, 6, v4
    s_nop 1
    v_cndmask_b32 v8, 0, v8, vcc
    v_mul_f32 v9, v8, v9
    s_nop 1
    v_add_f32_dpp v9, v9, v9 quad_perm:[1,0,3,2] row_mask:0xf bank_mask:0xf
    s_nop 1
    v_add_f32_dpp v9, v9, v9 quad_perm:[2,3,0,1] row_mask:0xf bank_mask:0xf
    s_nop 1
    v_add_f32_dpp v9, v9, v9 row_half_mirror row_mask:0xf bank_mask:0xf
    v_rcp_f32 v9, v9
    s_nop 0
    v_mul_f32 v8, v8, v9
    v_cvt_pk_bf16_f32 v8, v8, v8
    v_lshrrev_b32 v5, 4, v0
    v_lshlrev_b32 v5, 2, v5
    ds_bpermute_b32 v6, v5, v8
    ds_bpermute_b32 v7, v5, v8 offset:16
    s_waitcnt lgkmcnt(0)
    v_and_b32 v32, v6, v20
    v_and_b32 v33, v6, v21
    v_and_b32 v34, v6, v22
    v_and_b32 v35, v6, v23
    v_and_b32 v36, v7, v20
    v_and_b32 v37, v7, v21
    v_and_b32 v38, v7, v22
    v_and_b32 v39, v7, v23
    s_mul_i32 s29, s33, 1536
    s_add_u32 s29, s29, 0x180000
    s_add_u32 s30, s30, 0x1b7000
    s_lshl_b32 s31, s26, 12
    s_lshr_b32 s24, s74, 5
    s_lshl_b32 s24, s24, 11
    s_add_u32 s31, s31, s24
    s_lshl_b32 s24, s3, 9
    s_add_u32 s31, s31, s24
    s_add_u32 s31, s31, 0x1b7000
    s_cmp_lg_u32 s3, 0
    s_cbranch_scc1 L_H_x
    s_lshr_b32 s24, s74, 5
    s_mul_i32 s25, s24, 3
    s_add_u32 s34, s34, s25
    s_lshl_b32 s24, s24, 6
    s_add_u32 s24, s24, s26
    s_lshl_b32 s24, s24, 20
    s_add_u32 s4, s52, s24
    s_addc_u32 s5, s53, 0
    s_mov_b32 s6, 0x100000
    s_mov_b32 s7, 0x20000
    s_add_u32 s8, s4, 0x2000000
    s_addc_u32 s9, s5, 0
    s_mov_b32 s10, s6
    s_mov_b32 s11, 0x20000
    v_lshrrev_b32 v3, 4, v0
    v_mul_u32_u24 v16, 6144, v3
    v_and_b32 v3, 15, v0
    v_lshl_add_u32 v16, v3, 7, v16
    v_lshlrev_b32 v17, 10, v0
    v_mov_b32 v18, 0
    s_mov_b32 s27, 43
    s_mov_b32 s28, 43
    s_mov_b32 s32, 43
    s_mov_b32 s75, 262144
L_H:
    s_sub_u32 s75, s75, 1
    s_cmp_eq_u32 s75, 0
    s_cbranch_scc1 L_H_x
    s_mov_b64 exec, 0xffffff
    buffer_load_dword v18, v17, s[12:15], s35 offen offset:64 sc1
    s_mov_b64 exec, -1
    s_waitcnt vmcnt(0)
    v_max_i32 v19, 0, v18
    s_nop 1
    v_add_u32_dpp v3, v19, v19 row_ror:8 row_mask:0xf bank_mask:0xf
    s_nop 1
    v_add_u32_dpp v3, v3, v3 row_ror:4 row_mask:0xf bank_mask:0xf
    s_nop 1
    v_add_u32_dpp v3, v3, v3 row_ror:2 row_mask:0xf bank_mask:0xf
    s_nop 1
    v_add_u32_dpp v3, v3, v3 row_ror:1 row_mask:0xf bank_mask:0xf
    s_nop 0
    v_readlane_b32 s70, v3, 0
    v_readlane_b32 s24, v3, 16
    s_nop 0
    s_add_u32 s70, s70, s24
    s_add_u32 s24, s34, 0
    s_nop 0
    v_readlane_b32 s24, v19, s24
    s_sub_u32 s25, 43, s27
    s_mul_i32 s25, s25, 17
    s_mul_i32 s64, s24, 24
    s_add_u32 s64, s64, s25
    s_add_u32 s24, s24, 8
    s_cmp_gt_u32 s24, s27
    s_cselect_b32 s64, 0xffff, s64
    s_add_u32 s24, s34, 1
    v_readlane_b32 s24, v19, s24
    s_sub_u32 s25, 43, s28
    s_mul_i32 s25, s25, 17
    s_mul_i32 s65, s24, 24
    s_add_u32 s65, s65, s25
    s_add_u32 s24, s24, 8
    s_cmp_gt_u32 s24, s28
    s_cselect_b32 s65, 0xffff, s65
    s_add_u32 s24, s34, 2
    v_readlane_b32 s24, v19, s24
    s_sub_u32 s25, 43, s32
    s_mul_i32 s25, s25, 17
    s_mul_i32 s66, s24, 24
    s_add_u32 s66, s66, s25
    s_add_u32 s24, s24, 8
    s_cmp_gt_u32 s24, s32
    s_cselect_b32 s66, 0xffff, s66
    s_min_u32 s71, s64, s65
    s_min_u32 s71, s71, s66
    s_cmp_eq_u32 s71, 0xffff
    s_cbranch_scc1 L_H_x
    s_add_u32 s24, s71, 36
    s_cmp_lt_i32 s24, s70
    s_cbranch_scc1 L_H_go
    s_sleep 4
    s_branch L_H
L_H_go:
    s_cmp_lg_u32 s71, s64
    s_cbranch_scc1 L_H_n0
    s_sub_u32 s27, s27, 2
    s_mul_i32 s24, s27, 24576
    s_add_u32 s24, s24, 0
    s_branch L_H_ld
L_H_n0:
    s_cmp_lg_u32 s71, s65
    s_cbranch_scc1 L_H_n1
    s_sub_u32 s28, s28, 2
    s_mul_i32 s24, s28, 24576
    s_add_u32 s24, s24, 2048
    s_branch L_H_ld
L_H_n1:
    s_sub_u32 s32, s32, 2
    s_mul_i32 s24, s32, 24576
    s_add_u32 s24, s24, 4096
L_H_ld:
    buffer_load_dword v5, v16, s[4:7], s24 offen
    buffer_load_dword v5, v16, s[8:11], s24 offen
    s_add_u32 s24, s24, 24576
    buffer_load_dword v5, v16, s[4:7], s24 offen
    buffer_load_dword v5, v16, s[8:11], s24 offen
    s_branch L_H
L_H_x:
    s_mov_b32 s24, 262144
    s_branch L_pd15_in
L_pd15:
L_pd15_in:
    buffer_load_dwordx4 v[40:43], v2, s[12:15], s29 offen sc1
    buffer_load_dwordx4 v[44:47], v29, s[12:15], s29 offen offset:1024 sc1
    s_waitcnt vmcnt(0)
    v_max_u32 v3, v40, v41
    v_max3_u32 v3, v3, v42, v43
    v_max3_u32 v3, v3, v44, v45
    v_max3_u32 v3, v3, v46, v47
    v_cmp_eq_u32 vcc, -1, v3
    s_sub_u32 s24, s24, 1
    s_cmp_eq_u32 s24, 0
    s_cbranch_scc1 L_pd15_x
    s_and_b64 exec, exec, vcc
    s_cbranch_scc1 L_pd15
L_pd15_x:
    s_mov_b64 exec, -1
    v_mfma_f32_16x16x32_bf16 v[12:15], v[40:43], v[32:35], 0
    v_mfma_f32_16x16x32_bf16 v[12:15], v[44:47], v[36:39], v[12:15]
    s_nop 7
    v_cvt_pk_bf16_f32 v4, v12, v13
    v_cvt_pk_bf16_f32 v5, v14, v15
    ds_write_b64 v24, v[4:5]
    s_waitcnt lgkmcnt(0)
    s_barrier
    ds_read_b128 v[48:51], v25 offset:0
    ds_read_b128 v[52:55], v25 offset:64
    ds_read_b128 v[56:59], v25 offset:128
    ds_read_b128 v[60:63], v25 offset:192
    s_waitcnt lgkmcnt(3)
    v_mfma_f32_16x16x32_bf16 v[64:67], v[48:51], a[128:131], 0
    v_mfma_f32_16x16x32_bf16 v[68:71], v[48:51], a[144:147], 0
    v_mfma_f32_16x16x32_bf16 v[72:75], v[48:51], a[160:163], 0
    v_mfma_f32_16x16x32_bf16 v[76:79], v[48:51], a[176:179], 0
    s_waitcnt lgkmcnt(2)
    v_mfma_f32_16x16x32_bf16 v[64:67], v[52:55], a[132:135], v[64:67]
    v_mfma_f32_16x16x32_bf16 v[68:71], v[52:55], a[148:151], v[68:71]
    v_mfma_f32_16x16x32_bf16 v[72:75], v[52:55], a[164:167], v[72:75]
    v_mfma_f32_16x16x32_bf16 v[76:79], v[52:55], a[180:183], v[76:79]
    s_waitcnt lgkmcnt(1)
    v_mfma_f32_16x16x32_bf16 v[64:67], v[56:59], a[136:139], v[64:67]
    v_mfma_f32_16x16x32_bf16 v[68:71], v[56:59], a[152:155], v[68:71]
    v_mfma_f32_16x16x32_bf16 v[72:75], v[56:59], a[168:171], v[72:75]
    v_mfma_f32_16x16x32_bf16 v[76:79], v[56:59], a[184:187], v[76:79]
    s_waitcnt lgkmcnt(0)
    v_mfma_f32_16x16x32_bf16 v[64:67], v[60:63], a[140:143], v[64:67]
    v_mfma_f32_16x16x32_bf16 v[68:71], v[60:63], a[156:159], v[68:71]
    v_mfma_f32_16x16x32_bf16 v[72:75], v[60:63], a[172:175], v[72:75]
    v_mfma_f32_16x16x32_bf16 v[76:79], v[60:63], a[188:191], v[76:79]
    s_nop 4
    v_cvt_pk_bf16_f32 v64, v64, v65
    v_cvt_pk_bf16_f32 v65, v66, v67
    v_cvt_pk_bf16_f32 v68, v68, v69
    v_cvt_pk_bf16_f32 v69, v70, v71
    v_cvt_pk_bf16_f32 v72, v72, v73
    v_cvt_pk_bf16_f32 v73, v74, v75
    v_cvt_pk_bf16_f32 v76, v76, v77
    v_cvt_pk_bf16_f32 v77, v78, v79
    v_mov_b32_dpp v64, v68 quad_perm:[0,1,2,3] row_mask:0x2 bank_mask:0xf
    v_mov_b32_dpp v65, v69 quad_perm:[0,1,2,3] row_mask:0x2 bank_mask:0xf
    s_nop 0
    v_mov_b32_dpp v64, v72 quad_perm:[0,1,2,3] row_mask:0x4 bank_mask:0xf
    v_mov_b32_dpp v65, v73 quad_perm:[0,1,2,3] row_mask:0x4 bank_mask:0xf
    s_nop 0
    v_mov_b32_dpp v64, v76 quad_perm:[0,1,2,3] row_mask:0x8 bank_mask:0xf
    v_mov_b32_dpp v65, v77 quad_perm:[0,1,2,3] row_mask:0x8 bank_mask:0xf
    buffer_store_dwordx2 v[64:65], v80, s[12:15], s31 offen sc1
    s_mov_b32 s24, 262144
    s_branch L_pd16_in
L_pd16:
L_pd16_in:
    buffer_load_dwordx2 v[8:9], v30, s[12:15], s30 offen sc1
    s_waitcnt vmcnt(0)
    v_max_u32 v3, v8, v9
    v_cmp_eq_u32 vcc, -1, v3
    s_sub_u32 s24, s24, 1
    s_cmp_eq_u32 s24, 0
    s_cbranch_scc1 L_pd16_x
    s_and_b64 exec, exec, vcc
    s_cbranch_scc1 L_pd16
L_pd16_x:
    s_mov_b64 exec, -1
    v_lshlrev_b32 v4, 16, v8
    v_lshlrev_b32 v6, 16, v9
    v_and_b32 v5, 0xffff0000, v8
    v_and_b32 v7, 0xffff0000, v9
    v_permlane32_swap_b32 v4, v6
    s_nop 0
    v_permlane32_swap_b32 v5, v7
    v_add_f32 v4, v4, v6
    v_add_f32 v5, v5, v7
    s_nop 1
    v_permlane16_swap_b32 v4, v5
    v_add_f32 v4, v4, v5
    s_nop 1
    v_add_f32_dpp v4, v4, v4 row_ror:8 row_mask:0xf bank_mask:0xf
    s_nop 1
    v_add_f32_dpp v4, v4, v4 row_ror:4 row_mask:0xf bank_mask:0xf
    s_nop 1
    v_add_f32_dpp v4, v4, v4 row_ror:2 row_mask:0xf bank_mask:0xf
    v_cvt_pk_bf16_f32 v4, v4, v4
    s_mov_b32 exec_lo, 0x00030003
    s_mov_b32 exec_hi, 0x00030003
    buffer_store_short v4, v28, s[20:23], 0 offen offset:1024
    s_mov_b64 exec, -1
L_end:
    s_endpgm
L_C:
    s_cmp_lg_u32 s3, 0
    s_cbranch_scc1 L_C_q
    v_lshrrev_b32 v3, 4, v0
    v_and_b32 v4, 3, v0
    v_lshlrev_b32 v5, 6, v3
    v_lshl_add_u32 v5, v4, 4, v5
    v_bfe_u32 v4, v0, 2, 2
    v_lshl_add_u32 v5, v4, 8, v5
    s_lshl_b32 s24, s26, 10
    s_add_u32 s24, s24, 0x164000
    buffer_store_dwordx4 v[8:11], v5, s[12:15], s24 offen sc1
L_C_q:
    s_mov_b32 s8, s56
    s_mov_b32 s9, s57
    s_mov_b32 s10, 0x400000
    s_mov_b32 s11, 0x20000
    s_lshl_b32 s33, s26, 17
    s_lshl_b32 s24, s3, 15
    s_add_u32 s33, s33, s24
    s_add_u32 s33, s33, 512
    s_mul_i32 s34, s3, 17408
    s_add_u32 s34, s34, 0
    s_mov_b32 exec_hi, 0
    s_mov_b32 s70, 0
L_woC:
    s_and_b32 s24, s70, 1
    s_lshl_b32 s24, s24, 4
    s_and_b32 s25, s70, 4
    s_lshl_b32 s25, s25, 1
    s_or_b32 s24, s24, s25
    s_bfe_u32 s25, s70, 0x10001
    s_or_b32 s24, s24, s25
    s_lshl_b32 s24, s24, 10
    s_add_u32 s24, s24, s33
    s_mul_i32 s25, s70, 2176
    s_add_u32 m0, s25, s34
    s_waitcnt vmcnt(24)
    buffer_load_dwordx4 v2, s[8:11], s24 offen nt lds
    s_add_u32 m0, m0, 544
    s_add_u32 s24, s24, 2048
    s_waitcnt vmcnt(24)
    buffer_load_dwordx4 v2, s[8:11], s24 offen nt lds
    s_add_u32 m0, m0, 544
    s_add_u32 s24, s24, 2048
    s_waitcnt vmcnt(24)
    buffer_load_dwordx4 v2, s[8:11], s24 offen nt lds
    s_add_u32 m0, m0, 544
    s_add_u32 s24, s24, 2048
    s_waitcnt vmcnt(24)
    buffer_load_dwordx4 v2, s[8:11], s24 offen nt lds
    s_add_u32 s70, s70, 1
    s_cmp_lt_u32 s70, 8
    s_cbranch_scc1 L_woC
    s_mov_b64 exec, -1
    s_waitcnt vmcnt(0)
    s_barrier
    s_cmp_lg_u32 s3, 0
    s_cbranch_scc1 L_sig17
    s_mov_b64 exec, 1
    v_mov_b32 v3, 1
    v_mov_b32 v4, 1
    buffer_atomic_add v4, off, s[16:19], 0 offset:128
    buffer_atomic_add v3, off, s[16:19], 0 offset:0 sc0
    s_waitcnt vmcnt(0)
    v_readfirstlane_b32 s24, v3
    s_mov_b64 exec, -1
    s_and_b32 s24, s24, 63
    s_cmp_lg_u32 s24, 63
    s_cbranch_scc1 L_sig17
    v_lshlrev_b32 v4, 7, v0
    v_mov_b32 v3, 1
    s_mov_b32 s24, 0x170000
    buffer_store_dword v3, v4, s[12:15], s24 offen offset:0 sc1
L_sig17:
    v_lshrrev_b32 v3, 2, v0
    v_mul_u32_u24 v3, 544, v3
    v_and_b32 v4, 3, v0
    v_lshl_add_u32 v3, v4, 3, v3
    s_mul_i32 s24, s3, 128
    s_add_u32 s24, s24, 0
    v_add_u32 v3, s24, v3
    v_add_u32 v4, 34816, v3
    ds_read_b64_tr_b16 a[128:129], v3 offset:0
    ds_read_b64_tr_b16 a[130:131], v3 offset:8704
    ds_read_b64_tr_b16 a[132:133], v3 offset:17408
    ds_read_b64_tr_b16 a[134:135], v3 offset:26112
    ds_read_b64_tr_b16 a[136:137], v4 offset:0
    ds_read_b64_tr_b16 a[138:139], v4 offset:8704
    ds_read_b64_tr_b16 a[140:141], v4 offset:17408
    ds_read_b64_tr_b16 a[142:143], v4 offset:26112
    ds_read_b64_tr_b16 a[144:145], v3 offset:32
    ds_read_b64_tr_b16 a[146:147], v3 offset:8736
    ds_read_b64_tr_b16 a[148:149], v3 offset:17440
    ds_read_b64_tr_b16 a[150:151], v3 offset:26144
    ds_read_b64_tr_b16 a[152:153], v4 offset:32
    ds_read_b64_tr_b16 a[154:155], v4 offset:8736
    ds_read_b64_tr_b16 a[156:157], v4 offset:17440
    ds_read_b64_tr_b16 a[158:159], v4 offset:26144
    ds_read_b64_tr_b16 a[160:161], v3 offset:64
    ds_read_b64_tr_b16 a[162:163], v3 offset:8768
    ds_read_b64_tr_b16 a[164:165], v3 offset:17472
    ds_read_b64_tr_b16 a[166:167], v3 offset:26176
    ds_read_b64_tr_b16 a[168:169], v4 offset:64
    ds_read_b64_tr_b16 a[170:171], v4 offset:8768
    ds_read_b64_tr_b16 a[172:173], v4 offset:17472
    ds_read_b64_tr_b16 a[174:175], v4 offset:26176
    ds_read_b64_tr_b16 a[176:177], v3 offset:96
    ds_read_b64_tr_b16 a[178:179], v3 offset:8800
    ds_read_b64_tr_b16 a[180:181], v3 offset:17504
    ds_read_b64_tr_b16 a[182:183], v3 offset:26208
    ds_read_b64_tr_b16 a[184:185], v4 offset:96
    ds_read_b64_tr_b16 a[186:187], v4 offset:8800
    ds_read_b64_tr_b16 a[188:189], v4 offset:17504
    ds_read_b64_tr_b16 a[190:191], v4 offset:26208
    s_and_b32 s70, s72, 3
    s_lshr_b32 s71, s72, 4
    s_bfe_u32 s24, s72, 0x10002
    s_lshl_b32 s24, s24, 1
    s_add_u32 s71, s71, s24
    s_bfe_u32 s75, s72, 0x10003
    s_lshl_b32 s30, s71, 22
    s_add_u32 s4, s38, s30
    s_addc_u32 s5, s39, 0
    s_mov_b32 s6, 0x400000
    s_mov_b32 s7, 0x20000
    s_mul_i32 s32, s3, 65536
    s_lshl_b32 s24, s70, 10
    s_add_u32 s32, s32, s24
    s_mul_i32 s34, s3, 16896
    s_waitcnt lgkmcnt(0)
    s_barrier
    s_add_u32 m0, s34, 0
    s_nop 0
    buffer_load_dwordx4 v2, s[4:7], s32 offen  lds
    s_add_u32 m0, m0, 1056
    s_add_u32 s32, s32, 4096
    buffer_load_dwordx4 v2, s[4:7], s32 offen  lds
    s_add_u32 m0, m0, 1056
    s_add_u32 s32, s32, 4096
    buffer_load_dwordx4 v2, s[4:7], s32 offen  lds
    s_add_u32 m0, m0, 1056
    s_add_u32 s32, s32, 4096
    buffer_load_dwordx4 v2, s[4:7], s32 offen  lds
    s_add_u32 m0, m0, 1056
    s_add_u32 s32, s32, 4096
    buffer_load_dwordx4 v2, s[4:7], s32 offen  lds
    s_add_u32 m0, m0, 1056
    s_add_u32 s32, s32, 4096
    buffer_load_dwordx4 v2, s[4:7], s32 offen  lds
    s_add_u32 m0, m0, 1056
    s_add_u32 s32, s32, 4096
    buffer_load_dwordx4 v2, s[4:7], s32 offen  lds
    s_add_u32 m0, m0, 1056
    s_add_u32 s32, s32, 4096
    buffer_load_dwordx4 v2, s[4:7], s32 offen  lds
    s_add_u32 m0, m0, 1056
    s_add_u32 s32, s32, 4096
    buffer_load_dwordx4 v2, s[4:7], s32 offen  lds
    s_add_u32 m0, m0, 1056
    s_add_u32 s32, s32, 4096
    buffer_load_dwordx4 v2, s[4:7], s32 offen  lds
    s_add_u32 m0, m0, 1056
    s_add_u32 s32, s32, 4096
    buffer_load_dwordx4 v2, s[4:7], s32 offen  lds
    s_add_u32 m0, m0, 1056
    s_add_u32 s32, s32, 4096
    buffer_load_dwordx4 v2, s[4:7], s32 offen  lds
    s_add_u32 m0, m0, 1056
    s_add_u32 s32, s32, 4096
    buffer_load_dwordx4 v2, s[4:7], s32 offen  lds
    s_add_u32 m0, m0, 1056
    s_add_u32 s32, s32, 4096
    buffer_load_dwordx4 v2, s[4:7], s32 offen  lds
    s_add_u32 m0, m0, 1056
    s_add_u32 s32, s32, 4096
    buffer_load_dwordx4 v2, s[4:7], s32 offen  lds
    s_add_u32 m0, m0, 1056
    s_add_u32 s32, s32, 4096
    buffer_load_dwordx4 v2, s[4:7], s32 offen  lds
    s_add_u32 m0, m0, 1056
    s_add_u32 s32, s32, 200704
    s_lshr_b32 s28, s3, 1
    s_and_b32 s29, s3, 1
    v_and_b32 v3, 15, v0
    v_lshrrev_b32 v4, 4, v0
    v_mul_u32_u24 v19, 1056, v3
    v_lshl_add_u32 v19, v4, 4, v19
    v_lshrrev_b32 v5, 2, v0
    v_mul_u32_u24 v20, 1056, v5
    v_and_b32 v5, 3, v0
    v_lshl_add_u32 v20, v5, 3, v20
    s_lshl_b32 s24, s29, 9
    v_add_u32 v20, s24, v20
    v_and_b32 v3, 15, v0
    v_mul_u32_u24 v18, 1056, v3
    v_lshl_add_u32 v18, v4, 4, v18
    v_add_u32 v18, 101376, v18
    s_mul_i32 s24, s28, 33792
    v_add_u32 v19, s24, v19
    v_add_u32 v20, s24, v20
    v_mov_b32 v128, 0
    v_mov_b32 v129, 0
    v_mov_b32 v130, 0
    v_mov_b32 v131, 0
    v_mov_b32 v132, 0
    v_mov_b32 v133, 0
    v_mov_b32 v134, 0
    v_mov_b32 v135, 0
    v_mov_b32 v136, 0
    v_mov_b32 v137, 0
    v_mov_b32 v138, 0
    v_mov_b32 v139, 0
    v_mov_b32 v140, 0
    v_mov_b32 v141, 0
    v_mov_b32 v142, 0
    v_mov_b32 v143, 0
    v_mov_b32 v144, 0
    v_mov_b32 v145, 0
    v_mov_b32 v146, 0
    v_mov_b32 v147, 0
    v_mov_b32 v148, 0
    v_mov_b32 v149, 0
    v_mov_b32 v150, 0
    v_mov_b32 v151, 0
    v_mov_b32 v152, 0
    v_mov_b32 v153, 0
    v_mov_b32 v154, 0
    v_mov_b32 v155, 0
    v_mov_b32 v156, 0
    v_mov_b32 v157, 0
    v_mov_b32 v158, 0
    v_mov_b32 v159, 0
    v_mov_b32 v160, 0
    v_mov_b32 v161, 0
    v_mov_b32 v162, 0
    v_mov_b32 v163, 0
    v_mov_b32 v164, 0
    v_mov_b32 v165, 0
    v_mov_b32 v166, 0
    v_mov_b32 v167, 0
    v_mov_b32 v168, 0
    v_mov_b32 v169, 0
    v_mov_b32 v170, 0
    v_mov_b32 v171, 0
    v_mov_b32 v172, 0
    v_mov_b32 v173, 0
    v_mov_b32 v174, 0
    v_mov_b32 v175, 0
    v_mov_b32 v176, 0
    v_mov_b32 v177, 0
    v_mov_b32 v178, 0
    v_mov_b32 v179, 0
    v_mov_b32 v180, 0
    v_mov_b32 v181, 0
    v_mov_b32 v182, 0
    v_mov_b32 v183, 0
    v_mov_b32 v184, 0
    v_mov_b32 v185, 0
    v_mov_b32 v186, 0
    v_mov_b32 v187, 0
    v_mov_b32 v188, 0
    v_mov_b32 v189, 0
    v_mov_b32 v190, 0
    v_mov_b32 v191, 0
    v_mov_b32 v22, 0xff800000
    v_mov_b32 v23, 0
    s_cmp_lg_u32 s3, 0
    s_cbranch_scc1 L_awx18
    s_mov_b32 s24, 262144
    s_mov_b64 exec, 1
L_aw19:
    buffer_load_dword v1, off, s[12:15], s73 offset:0 sc1
    s_waitcnt vmcnt(0)
    v_readfirstlane_b32 s25, v1
    s_nop 0
    s_cmp_eq_u32 s25, 1
    s_cbranch_scc1 L_awx18
    s_sleep 4
    s_sub_u32 s24, s24, 1
    s_cmp_lg_u32 s24, 0
    s_cbranch_scc1 L_aw19
L_awx18:
    s_mov_b64 exec, -1
    s_barrier
    s_lshl_b32 s24, s71, 15
    s_mul_i32 s25, s3, 4096
    s_add_u32 s24, s24, s25
    s_add_u32 s24, s24, 0x0
    s_mul_i32 s25, s75, 16384
    s_add_u32 s24, s24, s25
    buffer_load_dwordx4 v[32:35], v2, s[12:15], s24 offen offset:0 sc1
    buffer_load_dwordx4 v[36:39], v2, s[12:15], s24 offen offset:1024 sc1
    buffer_load_dwordx4 v[40:43], v2, s[12:15], s24 offen offset:2048 sc1
    buffer_load_dwordx4 v[44:47], v2, s[12:15], s24 offen offset:3072 sc1
    s_add_u32 s24, s24, 4096
    s_mul_i32 s24, s3, 4224
    s_add_u32 s24, s24, 101376
    v_add_u32 v3, s24, v2
    s_waitcnt vmcnt(3)
    ds_write_b128 v3, v[32:35] offset:0
    s_waitcnt vmcnt(2)
    ds_write_b128 v3, v[36:39] offset:1056
    s_waitcnt vmcnt(1)
    ds_write_b128 v3, v[40:43] offset:2112
    s_waitcnt vmcnt(0)
    ds_write_b128 v3, v[44:47] offset:3168
    s_waitcnt lgkmcnt(0)
    s_barrier
    ds_read_b128 a[0:3], v18 offset:0
    ds_read_b128 a[4:7], v18 offset:64
    ds_read_b128 a[8:11], v18 offset:128
    ds_read_b128 a[12:15], v18 offset:192
    ds_read_b128 a[16:19], v18 offset:256
    ds_read_b128 a[20:23], v18 offset:320
    ds_read_b128 a[24:27], v18 offset:384
    ds_read_b128 a[28:31], v18 offset:448
    ds_read_b128 a[32:35], v18 offset:512
    ds_read_b128 a[36:39], v18 offset:576
    ds_read_b128 a[40:43], v18 offset:640
    ds_read_b128 a[44:47], v18 offset:704
    ds_read_b128 a[48:51], v18 offset:768
    ds_read_b128 a[52:55], v18 offset:832
    ds_read_b128 a[56:59], v18 offset:896
    ds_read_b128 a[60:63], v18 offset:960
    s_cmp_lg_u32 s3, 0
    s_cbranch_scc1 L_xi20
    s_getreg_b32 s25, hwreg(HW_REG_XCC_ID, 0, 4)
    s_lshl_b32 s24, s26, 7
    s_add_u32 s24, s24, 0x1b6000
    s_mov_b64 exec, 1
    v_mov_b32 v3, s25
    buffer_store_dword v3, off, s[12:15], s24 offset:4 sc1
    s_mov_b64 exec, -1
L_xi20:
    s_mov_b32 s27, 0
    s_mov_b32 s33, 67584
    s_mov_b32 s35, 0
    s_waitcnt lgkmcnt(0)
L_CT:
    s_waitcnt vmcnt(0)
    s_barrier
    v_add_u32 v24, s35, v19
    v_add_u32 v25, s35, v20
    ds_read_b128 v[32:35], v24 offset:0
    ds_read_b128 v[36:39], v24 offset:16896
    ds_read_b128 v[40:43], v24 offset:64
    ds_read_b128 v[44:47], v24 offset:16960
    ds_read_b128 v[48:51], v24 offset:128
    ds_read_b128 v[52:55], v24 offset:17024
    ds_read_b128 v[56:59], v24 offset:192
    s_add_u32 m0, s33, s34
    s_mov_b32 s33, s35
    s_add_u32 s35, s35, 67584
    s_cmp_eq_u32 s35, 135168
    s_cselect_b32 s35, 0, s35
    s_waitcnt lgkmcnt(6)
    v_mfma_f32_16x16x32_bf16 v[64:67], v[32:35], a[0:3], 0
    ds_read_b128 v[60:63], v24 offset:17088
    buffer_load_dwordx4 v2, s[4:7], s32 offen  lds
    s_add_u32 m0, m0, 1056
    s_add_u32 s32, s32, 4096
    s_waitcnt lgkmcnt(6)
    v_mfma_f32_16x16x32_bf16 v[68:71], v[36:39], a[0:3], 0
    ds_read_b128 v[32:35], v24 offset:256
    s_waitcnt lgkmcnt(6)
    v_mfma_f32_16x16x32_bf16 v[64:67], v[40:43], a[4:7], v[64:67]
    ds_read_b128 v[36:39], v24 offset:17152
    buffer_load_dwordx4 v2, s[4:7], s32 offen  lds
    s_add_u32 m0, m0, 1056
    s_add_u32 s32, s32, 4096
    s_waitcnt lgkmcnt(6)
    v_mfma_f32_16x16x32_bf16 v[68:71], v[44:47], a[4:7], v[68:71]
    ds_read_b128 v[40:43], v24 offset:320
    s_waitcnt lgkmcnt(6)
    v_mfma_f32_16x16x32_bf16 v[64:67], v[48:51], a[8:11], v[64:67]
    ds_read_b128 v[44:47], v24 offset:17216
    buffer_load_dwordx4 v2, s[4:7], s32 offen  lds
    s_add_u32 m0, m0, 1056
    s_add_u32 s32, s32, 4096
    s_waitcnt lgkmcnt(6)
    v_mfma_f32_16x16x32_bf16 v[68:71], v[52:55], a[8:11], v[68:71]
    ds_read_b128 v[48:51], v24 offset:384
    s_waitcnt lgkmcnt(6)
    v_mfma_f32_16x16x32_bf16 v[64:67], v[56:59], a[12:15], v[64:67]
    ds_read_b128 v[52:55], v24 offset:17280
    buffer_load_dwordx4 v2, s[4:7], s32 offen  lds
    s_add_u32 m0, m0, 1056
    s_add_u32 s32, s32, 4096
    s_waitcnt lgkmcnt(6)
    v_mfma_f32_16x16x32_bf16 v[68:71], v[60:63], a[12:15], v[68:71]
    ds_read_b128 v[56:59], v24 offset:448
    s_waitcnt lgkmcnt(6)
    v_mfma_f32_16x16x32_bf16 v[64:67], v[32:35], a[16:19], v[64:67]
    ds_read_b128 v[60:63], v24 offset:17344
    buffer_load_dwordx4 v2, s[4:7], s32 offen  lds
    s_add_u32 m0, m0, 1056
    s_add_u32 s32, s32, 4096
    s_waitcnt lgkmcnt(6)
    v_mfma_f32_16x16x32_bf16 v[68:71], v[36:39], a[16:19], v[68:71]
    ds_read_b128 v[32:35], v24 offset:512
    s_waitcnt lgkmcnt(6)
    v_mfma_f32_16x16x32_bf16 v[64:67], v[40:43], a[20:23], v[64:67]
    ds_read_b128 v[36:39], v24 offset:17408
    buffer_load_dwordx4 v2, s[4:7], s32 offen  lds
    s_add_u32 m0, m0, 1056
    s_add_u32 s32, s32, 4096
    s_waitcnt lgkmcnt(6)
    v_mfma_f32_16x16x32_bf16 v[68:71], v[44:47], a[20:23], v[68:71]
    ds_read_b128 v[40:43], v24 offset:576
    s_waitcnt lgkmcnt(6)
    v_mfma_f32_16x16x32_bf16 v[64:67], v[48:51], a[24:27], v[64:67]
    ds_read_b128 v[44:47], v24 offset:17472
    buffer_load_dwordx4 v2, s[4:7], s32 offen  lds
    s_add_u32 m0, m0, 1056
    s_add_u32 s32, s32, 4096
    s_waitcnt lgkmcnt(6)
    v_mfma_f32_16x16x32_bf16 v[68:71], v[52:55], a[24:27], v[68:71]
    ds_read_b128 v[48:51], v24 offset:640
    s_waitcnt lgkmcnt(6)
    v_mfma_f32_16x16x32_bf16 v[64:67], v[56:59], a[28:31], v[64:67]
    ds_read_b128 v[52:55], v24 offset:17536
    buffer_load_dwordx4 v2, s[4:7], s32 offen  lds
    s_add_u32 m0, m0, 1056
    s_add_u32 s32, s32, 4096
    s_waitcnt lgkmcnt(6)
    v_mfma_f32_16x16x32_bf16 v[68:71], v[60:63], a[28:31], v[68:71]
    ds_read_b128 v[56:59], v24 offset:704
    s_waitcnt lgkmcnt(6)
    v_mfma_f32_16x16x32_bf16 v[64:67], v[32:35], a[32:35], v[64:67]
    ds_read_b128 v[60:63], v24 offset:17600
    buffer_load_dwordx4 v2, s[4:7], s32 offen  lds
    s_add_u32 m0, m0, 1056
    s_add_u32 s32, s32, 4096
    s_waitcnt lgkmcnt(6)
    v_mfma_f32_16x16x32_bf16 v[68:71], v[36:39], a[32:35], v[68:71]
    ds_read_b128 v[32:35], v24 offset:768
    s_waitcnt lgkmcnt(6)
    v_mfma_f32_16x16x32_bf16 v[64:67], v[40:43], a[36:39], v[64:67]
    ds_read_b128 v[36:39], v24 offset:17664
    buffer_load_dwordx4 v2, s[4:7], s32 offen  lds
    s_add_u32 m0, m0, 1056
    s_add_u32 s32, s32, 4096
    s_waitcnt lgkmcnt(6)
    v_mfma_f32_16x16x32_bf16 v[68:71], v[44:47], a[36:39], v[68:71]
    ds_read_b128 v[40:43], v24 offset:832
    s_waitcnt lgkmcnt(6)
    v_mfma_f32_16x16x32_bf16 v[64:67], v[48:51], a[40:43], v[64:67]
    ds_read_b128 v[44:47], v24 offset:17728
    buffer_load_dwordx4 v2, s[4:7], s32 offen  lds
    s_add_u32 m0, m0, 1056
    s_add_u32 s32, s32, 4096
    s_waitcnt lgkmcnt(6)
    v_mfma_f32_16x16x32_bf16 v[68:71], v[52:55], a[40:43], v[68:71]
    ds_read_b128 v[48:51], v24 offset:896
    s_waitcnt lgkmcnt(6)
    v_mfma_f32_16x16x32_bf16 v[64:67], v[56:59], a[44:47], v[64:67]
    ds_read_b128 v[52:55], v24 offset:17792
    buffer_load_dwordx4 v2, s[4:7], s32 offen  lds
    s_add_u32 m0, m0, 1056
    s_add_u32 s32, s32, 4096
    s_waitcnt lgkmcnt(6)
    v_mfma_f32_16x16x32_bf16 v[68:71], v[60:63], a[44:47], v[68:71]
    ds_read_b128 v[56:59], v24 offset:960
    s_waitcnt lgkmcnt(6)
    v_mfma_f32_16x16x32_bf16 v[64:67], v[32:35], a[48:51], v[64:67]
    ds_read_b128 v[60:63], v24 offset:17856
    buffer_load_dwordx4 v2, s[4:7], s32 offen  lds
    s_add_u32 m0, m0, 1056
    s_add_u32 s32, s32, 4096
    s_waitcnt lgkmcnt(6)
    v_mfma_f32_16x16x32_bf16 v[68:71], v[36:39], a[48:51], v[68:71]
    ds_read_b64_tr_b16 v[192:193], v25 offset:0
    s_waitcnt lgkmcnt(6)
    v_mfma_f32_16x16x32_bf16 v[64:67], v[40:43], a[52:55], v[64:67]
    ds_read_b64_tr_b16 v[194:195], v25 offset:16896
    buffer_load_dwordx4 v2, s[4:7], s32 offen  lds
    s_add_u32 m0, m0, 1056
    s_add_u32 s32, s32, 4096
    s_waitcnt lgkmcnt(6)
    v_mfma_f32_16x16x32_bf16 v[68:71], v[44:47], a[52:55], v[68:71]
    ds_read_b64_tr_b16 v[196:197], v25 offset:32
    s_waitcnt lgkmcnt(6)
    v_mfma_f32_16x16x32_bf16 v[64:67], v[48:51], a[56:59], v[64:67]
    ds_read_b64_tr_b16 v[198:199], v25 offset:16928
    buffer_load_dwordx4 v2, s[4:7], s32 offen  lds
    s_add_u32 m0, m0, 1056
    s_add_u32 s32, s32, 4096
    s_waitcnt lgkmcnt(6)
    v_mfma_f32_16x16x32_bf16 v[68:71], v[52:55], a[56:59], v[68:71]
    ds_read_b64_tr_b16 v[200:201], v25 offset:64
    s_waitcnt lgkmcnt(6)
    v_mfma_f32_16x16x32_bf16 v[64:67], v[56:59], a[60:63], v[64:67]
    ds_read_b64_tr_b16 v[202:203], v25 offset:16960
    buffer_load_dwordx4 v2, s[4:7], s32 offen  lds
    s_add_u32 m0, m0, 1056
    s_add_u32 s32, s32, 200704
    s_waitcnt lgkmcnt(6)
    v_mfma_f32_16x16x32_bf16 v[68:71], v[60:63], a[60:63], v[68:71]
    ds_read_b64_tr_b16 v[204:205], v25 offset:96
    ds_read_b64_tr_b16 v[206:207], v25 offset:16992
    ds_read_b64_tr_b16 v[208:209], v25 offset:128
    ds_read_b64_tr_b16 v[210:211], v25 offset:17024
    ds_read_b64_tr_b16 v[212:213], v25 offset:160
    ds_read_b64_tr_b16 v[214:215], v25 offset:17056
    ds_read_b64_tr_b16 v[216:217], v25 offset:192
    ds_read_b64_tr_b16 v[218:219], v25 offset:17088
    v_max3_f32 v3, v64, v65, v22
    v_max3_f32 v3, v3, v66, v67
    v_max3_f32 v3, v3, v68, v69
    v_max3_f32 v3, v3, v70, v71
    v_mov_b32 v4, v3
    ds_read_b64_tr_b16 v[220:221], v25 offset:224
    s_nop 0
    v_permlane32_swap_b32 v3, v4
    ds_read_b64_tr_b16 v[222:223], v25 offset:17120
    v_max_f32 v3, v3, v4
    ds_read_b64_tr_b16 v[224:225], v25 offset:256
    v_mov_b32 v4, v3
    ds_read_b64_tr_b16 v[226:227], v25 offset:17152
    s_nop 0
    v_permlane16_swap_b32 v3, v4
    ds_read_b64_tr_b16 v[228:229], v25 offset:288
    v_max_f32 v3, v3, v4
    ds_read_b64_tr_b16 v[230:231], v25 offset:17184
    v_sub_f32 v4, v22, v3
    ds_read_b64_tr_b16 v[232:233], v25 offset:320
    v_exp_f32 v4, v4
    ds_read_b64_tr_b16 v[234:235], v25 offset:17216
    v_mov_b32 v22, v3
    ds_read_b64_tr_b16 v[236:237], v25 offset:352
    v_sub_f32 v64, v64, v3
    ds_read_b64_tr_b16 v[238:239], v25 offset:17248
    v_sub_f32 v65, v65, v3
    ds_read_b64_tr_b16 v[240:241], v25 offset:384
    v_sub_f32 v66, v66, v3
    ds_read_b64_tr_b16 v[242:243], v25 offset:17280
    v_sub_f32 v67, v67, v3
    ds_read_b64_tr_b16 v[244:245], v25 offset:416
    v_sub_f32 v68, v68, v3
    ds_read_b64_tr_b16 v[246:247], v25 offset:17312
    v_sub_f32 v69, v69, v3
    ds_read_b64_tr_b16 v[248:249], v25 offset:448
    v_sub_f32 v70, v70, v3
    ds_read_b64_tr_b16 v[250:251], v25 offset:17344
    v_sub_f32 v71, v71, v3
    ds_read_b64_tr_b16 v[252:253], v25 offset:480
    v_exp_f32 v64, v64
    ds_read_b64_tr_b16 v[254:255], v25 offset:17376
    v_exp_f32 v65, v65
    v_exp_f32 v66, v66
    v_exp_f32 v67, v67
    v_exp_f32 v68, v68
    v_exp_f32 v69, v69
    v_exp_f32 v70, v70
    v_exp_f32 v71, v71
    v_cvt_pk_bf16_f32 v72, v64, v65
    v_cvt_pk_bf16_f32 v73, v66, v67
    v_cvt_pk_bf16_f32 v74, v68, v69
    v_cvt_pk_bf16_f32 v75, v70, v71
    v_pk_mul_f32 v[128:129], v[128:129], v[4:5] op_sel_hi:[1,0]
    v_pk_mul_f32 v[130:131], v[130:131], v[4:5] op_sel_hi:[1,0]
    v_pk_mul_f32 v[132:133], v[132:133], v[4:5] op_sel_hi:[1,0]
    v_pk_mul_f32 v[134:135], v[134:135], v[4:5] op_sel_hi:[1,0]
    s_waitcnt lgkmcnt(0)
    v_mfma_f32_16x16x32_bf16 v[128:131], v[192:195], v[72:75], v[128:131]
    v_pk_mul_f32 v[136:137], v[136:137], v[4:5] op_sel_hi:[1,0]
    v_pk_mul_f32 v[138:139], v[138:139], v[4:5] op_sel_hi:[1,0]
    v_mfma_f32_16x16x32_bf16 v[132:135], v[196:199], v[72:75], v[132:135]
    v_pk_mul_f32 v[140:141], v[140:141], v[4:5] op_sel_hi:[1,0]
    v_pk_mul_f32 v[142:143], v[142:143], v[4:5] op_sel_hi:[1,0]
    v_mfma_f32_16x16x32_bf16 v[136:139], v[200:203], v[72:75], v[136:139]
    v_pk_mul_f32 v[144:145], v[144:145], v[4:5] op_sel_hi:[1,0]
    v_pk_mul_f32 v[146:147], v[146:147], v[4:5] op_sel_hi:[1,0]
    v_mfma_f32_16x16x32_bf16 v[140:143], v[204:207], v[72:75], v[140:143]
    v_pk_mul_f32 v[148:149], v[148:149], v[4:5] op_sel_hi:[1,0]
    v_pk_mul_f32 v[150:151], v[150:151], v[4:5] op_sel_hi:[1,0]
    v_mfma_f32_16x16x32_bf16 v[144:147], v[208:211], v[72:75], v[144:147]
    v_pk_mul_f32 v[152:153], v[152:153], v[4:5] op_sel_hi:[1,0]
    v_pk_mul_f32 v[154:155], v[154:155], v[4:5] op_sel_hi:[1,0]
    v_mfma_f32_16x16x32_bf16 v[148:151], v[212:215], v[72:75], v[148:151]
    v_pk_mul_f32 v[156:157], v[156:157], v[4:5] op_sel_hi:[1,0]
    v_pk_mul_f32 v[158:159], v[158:159], v[4:5] op_sel_hi:[1,0]
    v_mfma_f32_16x16x32_bf16 v[152:155], v[216:219], v[72:75], v[152:155]
    v_pk_mul_f32 v[160:161], v[160:161], v[4:5] op_sel_hi:[1,0]
    v_pk_mul_f32 v[162:163], v[162:163], v[4:5] op_sel_hi:[1,0]
    v_mfma_f32_16x16x32_bf16 v[156:159], v[220:223], v[72:75], v[156:159]
    v_pk_mul_f32 v[164:165], v[164:165], v[4:5] op_sel_hi:[1,0]
    v_pk_mul_f32 v[166:167], v[166:167], v[4:5] op_sel_hi:[1,0]
    v_mfma_f32_16x16x32_bf16 v[160:163], v[224:227], v[72:75], v[160:163]
    v_pk_mul_f32 v[168:169], v[168:169], v[4:5] op_sel_hi:[1,0]
    v_pk_mul_f32 v[170:171], v[170:171], v[4:5] op_sel_hi:[1,0]
    v_mfma_f32_16x16x32_bf16 v[164:167], v[228:231], v[72:75], v[164:167]
    v_pk_mul_f32 v[172:173], v[172:173], v[4:5] op_sel_hi:[1,0]
    v_pk_mul_f32 v[174:175], v[174:175], v[4:5] op_sel_hi:[1,0]
    v_mfma_f32_16x16x32_bf16 v[168:171], v[232:235], v[72:75], v[168:171]
    v_pk_mul_f32 v[176:177], v[176:177], v[4:5] op_sel_hi:[1,0]
    v_pk_mul_f32 v[178:179], v[178:179], v[4:5] op_sel_hi:[1,0]
    v_mfma_f32_16x16x32_bf16 v[172:175], v[236:239], v[72:75], v[172:175]
    v_pk_mul_f32 v[180:181], v[180:181], v[4:5] op_sel_hi:[1,0]
    v_pk_mul_f32 v[182:183], v[182:183], v[4:5] op_sel_hi:[1,0]
    v_mfma_f32_16x16x32_bf16 v[176:179], v[240:243], v[72:75], v[176:179]
    v_pk_mul_f32 v[184:185], v[184:185], v[4:5] op_sel_hi:[1,0]
    v_pk_mul_f32 v[186:187], v[186:187], v[4:5] op_sel_hi:[1,0]
    v_mfma_f32_16x16x32_bf16 v[180:183], v[244:247], v[72:75], v[180:183]
    v_pk_mul_f32 v[188:189], v[188:189], v[4:5] op_sel_hi:[1,0]
    v_pk_mul_f32 v[190:191], v[190:191], v[4:5] op_sel_hi:[1,0]
    v_mfma_f32_16x16x32_bf16 v[184:187], v[248:251], v[72:75], v[184:187]
    s_nop 0
    v_mfma_f32_16x16x32_bf16 v[188:191], v[252:255], v[72:75], v[188:191]
    v_fma_f32 v23, v23, v4, v64
    v_add_f32 v23, v23, v65
    v_add_f32 v23, v23, v66
    v_add_f32 v23, v23, v67
    v_add_f32 v23, v23, v68
    v_add_f32 v23, v23, v69
    v_add_f32 v23, v23, v70
    v_add_f32 v23, v23, v71
    s_add_u32 s27, s27, 1
    s_cmp_lt_u32 s27, 16
    s_cbranch_scc1 L_CT
    s_waitcnt vmcnt(0)
    s_barrier
    v_mov_b32 v4, v23
    s_nop 1
    v_permlane32_swap_b32 v23, v4
    v_add_f32 v23, v23, v4
    v_mov_b32 v4, v23
    s_nop 1
    v_permlane16_swap_b32 v23, v4
    v_add_f32 v23, v23, v4
    s_lshl_b32 s24, s3, 9
    v_lshl_add_u32 v3, v0, 3, s24
    ds_write_b64 v3, v[22:23] offset:0
    v_xor_b32 v3, 0x400, v3
    s_waitcnt lgkmcnt(0)
    s_barrier
    ds_read_b64 v[6:7], v3 offset:0
    s_waitcnt lgkmcnt(0)
    v_max_f32 v3, v22, v6
    v_sub_f32 v4, v22, v3
    v_sub_f32 v6, v6, v3
    v_exp_f32 v4, v4
    v_exp_f32 v6, v6
    v_mov_b32 v22, v3
    v_mul_f32 v23, v23, v4
    v_fmac_f32 v23, v7, v6
    v_and_b32 v3, 15, v0
    v_lshlrev_b32 v5, 3, v3
    s_lshl_b32 s24, s71, 2
    s_add_u32 s31, s24, s70
    s_lshl_b32 s24, s31, 8
    s_mul_i32 s25, s75, 128
    s_add_u32 s24, s24, s25
    s_add_u32 s24, s24, 0x120000
    s_cmp_lg_u32 s3, 0
    s_cbranch_scc1 L_C_ml
    s_mov_b64 exec, 0xffff
    buffer_store_dwordx2 v[22:23], v5, s[12:15], s24 offen sc1
    s_mov_b64 exec, -1
L_C_ml:
    v_pk_mul_f32 v[128:129], v[128:129], v[4:5] op_sel_hi:[1,0]
    v_pk_mul_f32 v[130:131], v[130:131], v[4:5] op_sel_hi:[1,0]
    v_pk_mul_f32 v[132:133], v[132:133], v[4:5] op_sel_hi:[1,0]
    v_pk_mul_f32 v[134:135], v[134:135], v[4:5] op_sel_hi:[1,0]
    v_pk_mul_f32 v[136:137], v[136:137], v[4:5] op_sel_hi:[1,0]
    v_pk_mul_f32 v[138:139], v[138:139], v[4:5] op_sel_hi:[1,0]
    v_pk_mul_f32 v[140:141], v[140:141], v[4:5] op_sel_hi:[1,0]
    v_pk_mul_f32 v[142:143], v[142:143], v[4:5] op_sel_hi:[1,0]
    v_pk_mul_f32 v[144:145], v[144:145], v[4:5] op_sel_hi:[1,0]
    v_pk_mul_f32 v[146:147], v[146:147], v[4:5] op_sel_hi:[1,0]
    v_pk_mul_f32 v[148:149], v[148:149], v[4:5] op_sel_hi:[1,0]
    v_pk_mul_f32 v[150:151], v[150:151], v[4:5] op_sel_hi:[1,0]
    v_pk_mul_f32 v[152:153], v[152:153], v[4:5] op_sel_hi:[1,0]
    v_pk_mul_f32 v[154:155], v[154:155], v[4:5] op_sel_hi:[1,0]
    v_pk_mul_f32 v[156:157], v[156:157], v[4:5] op_sel_hi:[1,0]
    v_pk_mul_f32 v[158:159], v[158:159], v[4:5] op_sel_hi:[1,0]
    v_pk_mul_f32 v[160:161], v[160:161], v[4:5] op_sel_hi:[1,0]
    v_pk_mul_f32 v[162:163], v[162:163], v[4:5] op_sel_hi:[1,0]
    v_pk_mul_f32 v[164:165], v[164:165], v[4:5] op_sel_hi:[1,0]
    v_pk_mul_f32 v[166:167], v[166:167], v[4:5] op_sel_hi:[1,0]
    v_pk_mul_f32 v[168:169], v[168:169], v[4:5] op_sel_hi:[1,0]
    v_pk_mul_f32 v[170:171], v[170:171], v[4:5] op_sel_hi:[1,0]
    v_pk_mul_f32 v[172:173], v[172:173], v[4:5] op_sel_hi:[1,0]
    v_pk_mul_f32 v[174:175], v[174:175], v[4:5] op_sel_hi:[1,0]
    v_pk_mul_f32 v[176:177], v[176:177], v[4:5] op_sel_hi:[1,0]
    v_pk_mul_f32 v[178:179], v[178:179], v[4:5] op_sel_hi:[1,0]
    v_pk_mul_f32 v[180:181], v[180:181], v[4:5] op_sel_hi:[1,0]
    v_pk_mul_f32 v[182:183], v[182:183], v[4:5] op_sel_hi:[1,0]
    v_pk_mul_f32 v[184:185], v[184:185], v[4:5] op_sel_hi:[1,0]
    v_pk_mul_f32 v[186:187], v[186:187], v[4:5] op_sel_hi:[1,0]
    v_pk_mul_f32 v[188:189], v[188:189], v[4:5] op_sel_hi:[1,0]
    v_pk_mul_f32 v[190:191], v[190:191], v[4:5] op_sel_hi:[1,0]
    s_lshl_b32 s24, s3, 13
    s_add_u32 s24, s24, 4096
    v_add_u32 v6, s24, v2
    s_xor_b32 s24, s3, 2
    s_lshl_b32 s24, s24, 13
    s_add_u32 s24, s24, 4096
    v_add_u32 v7, s24, v2
    s_cmp_lg_u32 s28, 0
    s_cbranch_scc1 L_C_x1
    ds_write_b128 v6, v[160:163] offset:0
    ds_write_b128 v6, v[164:167] offset:1024
    ds_write_b128 v6, v[168:171] offset:2048
    ds_write_b128 v6, v[172:175] offset:3072
    ds_write_b128 v6, v[176:179] offset:4096
    ds_write_b128 v6, v[180:183] offset:5120
    ds_write_b128 v6, v[184:187] offset:6144
    ds_write_b128 v6, v[188:191] offset:7168
    s_branch L_C_x2
L_C_x1:
    ds_write_b128 v6, v[128:131] offset:0
    ds_write_b128 v6, v[132:135] offset:1024
    ds_write_b128 v6, v[136:139] offset:2048
    ds_write_b128 v6, v[140:143] offset:3072
    ds_write_b128 v6, v[144:147] offset:4096
    ds_write_b128 v6, v[148:151] offset:5120
    ds_write_b128 v6, v[152:155] offset:6144
    ds_write_b128 v6, v[156:159] offset:7168
    s_waitcnt lgkmcnt(0)
    v_mov_b32 v128, v160
    v_mov_b32 v129, v161
    v_mov_b32 v130, v162
    v_mov_b32 v131, v163
    v_mov_b32 v132, v164
    v_mov_b32 v133, v165
    v_mov_b32 v134, v166
    v_mov_b32 v135, v167
    v_mov_b32 v136, v168
    v_mov_b32 v137, v169
    v_mov_b32 v138, v170
    v_mov_b32 v139, v171
    v_mov_b32 v140, v172
    v_mov_b32 v141, v173
    v_mov_b32 v142, v174
    v_mov_b32 v143, v175
    v_mov_b32 v144, v176
    v_mov_b32 v145, v177
    v_mov_b32 v146, v178
    v_mov_b32 v147, v179
    v_mov_b32 v148, v180
    v_mov_b32 v149, v181
    v_mov_b32 v150, v182
    v_mov_b32 v151, v183
    v_mov_b32 v152, v184
    v_mov_b32 v153, v185
    v_mov_b32 v154, v186
    v_mov_b32 v155, v187
    v_mov_b32 v156, v188
    v_mov_b32 v157, v189
    v_mov_b32 v158, v190
    v_mov_b32 v159, v191
L_C_x2:
    s_waitcnt lgkmcnt(0)
    s_barrier
    ds_read_b128 v[192:195], v7 offset:0
    ds_read_b128 v[196:199], v7 offset:1024
    ds_read_b128 v[200:203], v7 offset:2048
    ds_read_b128 v[204:207], v7 offset:3072
    ds_read_b128 v[208:211], v7 offset:4096
    ds_read_b128 v[212:215], v7 offset:5120
    ds_read_b128 v[216:219], v7 offset:6144
    ds_read_b128 v[220:223], v7 offset:7168
    v_lshrrev_b32 v4, 4, v0
    v_mul_u32_u24 v3, 272, v3
    v_lshl_add_u32 v3, v4, 3, v3
    s_mul_i32 s24, s3, 4352
    s_add_u32 s24, s24, 40960
    v_add_u32 v3, s24, v3
    s_waitcnt lgkmcnt(7)
    v_add_f32 v128, v128, v192
    v_add_f32 v129, v129, v193
    v_add_f32 v130, v130, v194
    v_add_f32 v131, v131, v195
    v_cvt_pk_bf16_f32 v32, v128, v129
    v_cvt_pk_bf16_f32 v33, v130, v131
    ds_write_b64 v3, v[32:33] offset:0
    s_waitcnt lgkmcnt(7)
    v_add_f32 v132, v132, v196
    v_add_f32 v133, v133, v197
    v_add_f32 v134, v134, v198
    v_add_f32 v135, v135, v199
    v_cvt_pk_bf16_f32 v34, v132, v133
    v_cvt_pk_bf16_f32 v35, v134, v135
    ds_write_b64 v3, v[34:35] offset:32
    s_waitcnt lgkmcnt(7)
    v_add_f32 v136, v136, v200
    v_add_f32 v137, v137, v201
    v_add_f32 v138, v138, v202
    v_add_f32 v139, v139, v203
    v_cvt_pk_bf16_f32 v36, v136, v137
    v_cvt_pk_bf16_f32 v37, v138, v139
    ds_write_b64 v3, v[36:37] offset:64
    s_waitcnt lgkmcnt(7)
    v_add_f32 v140, v140, v204
    v_add_f32 v141, v141, v205
    v_add_f32 v142, v142, v206
    v_add_f32 v143, v143, v207
    v_cvt_pk_bf16_f32 v38, v140, v141
    v_cvt_pk_bf16_f32 v39, v142, v143
    ds_write_b64 v3, v[38:39] offset:96
    s_waitcnt lgkmcnt(7)
    v_add_f32 v144, v144, v208
    v_add_f32 v145, v145, v209
    v_add_f32 v146, v146, v210
    v_add_f32 v147, v147, v211
    v_cvt_pk_bf16_f32 v40, v144, v145
    v_cvt_pk_bf16_f32 v41, v146, v147
    ds_write_b64 v3, v[40:41] offset:128
    s_waitcnt lgkmcnt(7)
    v_add_f32 v148, v148, v212
    v_add_f32 v149, v149, v213
    v_add_f32 v150, v150, v214
    v_add_f32 v151, v151, v215
    v_cvt_pk_bf16_f32 v42, v148, v149
    v_cvt_pk_bf16_f32 v43, v150, v151
    ds_write_b64 v3, v[42:43] offset:160
    s_waitcnt lgkmcnt(7)
    v_add_f32 v152, v152, v216
    v_add_f32 v153, v153, v217
    v_add_f32 v154, v154, v218
    v_add_f32 v155, v155, v219
    v_cvt_pk_bf16_f32 v44, v152, v153
    v_cvt_pk_bf16_f32 v45, v154, v155
    ds_write_b64 v3, v[44:45] offset:192
    s_waitcnt lgkmcnt(7)
    v_add_f32 v156, v156, v220
    v_add_f32 v157, v157, v221
    v_add_f32 v158, v158, v222
    v_add_f32 v159, v159, v223
    v_cvt_pk_bf16_f32 v46, v156, v157
    v_cvt_pk_bf16_f32 v47, v158, v159
    ds_write_b64 v3, v[46:47] offset:224
    v_and_b32 v5, 15, v0
    v_mul_u32_u24 v3, 272, v4
    v_lshl_add_u32 v3, v5, 4, v3
    v_add_u32 v3, s24, v3
    v_lshlrev_b32 v4, 14, v4
    v_lshl_add_u32 v4, v5, 4, v4
    s_waitcnt lgkmcnt(0)
    ds_read_b128 v[64:67], v3 offset:0
    ds_read_b128 v[68:71], v3 offset:1088
    ds_read_b128 v[72:75], v3 offset:2176
    ds_read_b128 v[76:79], v3 offset:3264
    s_lshl_b32 s24, s31, 10
    s_lshl_b32 s25, s29, 9
    s_add_u32 s24, s24, s25
    s_lshl_b32 s25, s28, 8
    s_add_u32 s24, s24, s25
    s_mul_i32 s25, s75, 262144
    s_add_u32 s24, s24, s25
    s_add_u32 s24, s24, 0x20000
    s_waitcnt lgkmcnt(3)
    buffer_store_dwordx4 v[64:67], v4, s[12:15], s24 offen sc1
    s_add_u32 s24, s24, 65536
    s_waitcnt lgkmcnt(2)
    buffer_store_dwordx4 v[68:71], v4, s[12:15], s24 offen sc1
    s_add_u32 s24, s24, 65536
    s_waitcnt lgkmcnt(1)
    buffer_store_dwordx4 v[72:75], v4, s[12:15], s24 offen sc1
    s_add_u32 s24, s24, 65536
    s_waitcnt lgkmcnt(0)
    buffer_store_dwordx4 v[76:79], v4, s[12:15], s24 offen sc1
    s_add_u32 s24, s24, 65536
    s_waitcnt vmcnt(0)
    s_barrier
    s_cmp_lg_u32 s3, 0
    s_cbranch_scc1 L_sig21
    s_mov_b64 exec, 1
    v_mov_b32 v3, 1
    buffer_atomic_add v3, off, s[16:19], 0 offset:4 sc0
    s_waitcnt vmcnt(0)
    v_readfirstlane_b32 s24, v3
    s_mov_b64 exec, -1
    s_and_b32 s24, s24, 31
    s_cmp_lg_u32 s24, 31
    s_cbranch_scc1 L_sig21
    v_lshlrev_b32 v4, 7, v0
    v_mov_b32 v3, 1
    s_mov_b32 s24, 0x170000
    buffer_store_dword v3, v4, s[12:15], s24 offen offset:4 sc1
L_sig21:
    s_branch L_R
L_last:
    s_endpgm
.section .rodata,"a"
.p2align 6
.amdhsa_kernel concat_heads__compressed_kv_cla__mha_block_cached__decode_kernel
  .amdhsa_next_free_vgpr 512
  .amdhsa_next_free_sgpr 102
  .amdhsa_accum_offset 256
  .amdhsa_group_segment_fixed_size 0
  .amdhsa_kernarg_size 112
  .amdhsa_user_sgpr_count 2
  .amdhsa_user_sgpr_kernarg_segment_ptr 1
  .amdhsa_system_sgpr_workgroup_id_x 1
  .amdhsa_float_denorm_mode_32 3
.end_amdhsa_kernel
```

```asm
; @launch grid=(256,1,1) block=(256,1,1) lds=149504
.amdgcn_target "amdgcn-amd-amdhsa--gfx950"
.text
.globl concat_heads__compressed_kv_cla__mha_block_cached__decode_kernel
.p2align 8
.type concat_heads__compressed_kv_cla__mha_block_cached__decode_kernel,@function
concat_heads__compressed_kv_cla__mha_block_cached__decode_kernel:
    s_load_dwordx16 s[36:51], s[0:1], 0
    s_load_dwordx8 s[52:59], s[0:1], 64
    s_load_dwordx4 s[60:63], s[0:1], 96
    s_cmp_ge_u32 s2, 256
    s_cbranch_scc1 L_end
    s_cmp_lt_u32 s2, 64
    s_cbranch_scc1 L_A
L_B:
    s_and_b32 s70, s2, 6
    s_and_b32 s25, s2, 7
    s_add_u32 s70, s70, s25
    s_lshl_b32 s25, s70, 8
    v_and_b32 v6, 15, v0
    v_lshl_add_u32 v24, v6, 4, s25
    v_and_b32 v4, 16, v0
    v_lshl_add_u32 v24, v4, 5, v24
    v_lshrrev_b32 v4, 5, v0
    v_lshl_add_u32 v24, v4, 12, v24
    s_lshr_b32 s74, s2, 3
    s_lshl_b32 s74, s74, 2
    s_addk_i32 s74, -32
    s_mov_b32 s10, 0x400000
    s_mov_b32 s11, 0x20000
    s_waitcnt lgkmcnt(0)
    s_mov_b64 s[8:9], s[54:55]
L_pfb:
    s_lshl_b32 s24, s74, 13
    buffer_load_dwordx4 v[28:31], v24, s[8:11], s24 offen
    s_addk_i32 s74, 96
    s_cmpk_lt_u32 s74, 512
    s_cbranch_scc1 L_pfb
    s_addk_i32 s74, -512
    s_mov_b64 s[8:9], s[40:41]
L_pfq:
    s_lshl_b32 s24, s74, 13
    buffer_load_dwordx4 v[28:31], v24, s[8:11], s24 offen
    s_addk_i32 s74, 96
    s_cmpk_lt_u32 s74, 512
    s_cbranch_scc1 L_pfq
    s_addk_i32 s74, -512
    s_mov_b64 s[8:9], s[42:43]
L_pfk:
    s_lshl_b32 s24, s74, 13
    buffer_load_dwordx4 v[28:31], v24, s[8:11], s24 offen
    s_addk_i32 s74, 96
    s_cmpk_lt_u32 s74, 512
    s_cbranch_scc1 L_pfk
    s_addk_i32 s74, -512
    v_lshrrev_b32 v1, 6, v0
    v_and_b32 v0, 63, v0
    v_readfirstlane_b32 s3, v1
    v_lshlrev_b32 v2, 4, v0
    s_getpc_b64 s[20:21]
L_pc1:
    s_sub_u32 s20, s20, L_pc1-L_B
    s_subb_u32 s21, s21, 0
    s_mov_b32 s22, L_A-L_B
    s_mov_b32 s23, 0x20000
    v_lshl_add_u32 v3, v0, 2, s3
    v_lshlrev_b32 v3, 7, v3
    buffer_load_dword v17, v3, s[20:23], 0 offen
    s_lshr_b32 s24, s2, 3
    s_sub_u32 s24, s24, 8
    s_mul_i32 s26, s24, 43
    s_lshr_b32 s26, s26, 8
    s_mul_i32 s27, s26, 6
    s_sub_u32 s27, s24, s27
    s_and_b32 s25, s26, 1
    s_lshl_b32 s25, s25, 1
    s_and_b32 s26, s26, 2
    s_lshl_b32 s26, s26, 3
    s_or_b32 s26, s26, s25
    s_or_b32 s26, s26, s70
    s_lshl_b32 s25, s70, 17
    s_lshl_b32 s24, s3, 8
    s_add_u32 s25, s25, s24
    v_lshl_add_u32 v25, v6, 4, s25
    v_and_b32 v4, 16, v0
    v_lshl_add_u32 v25, v4, 14, v25
    v_and_b32 v4, 32, v0
    v_lshl_add_u32 v25, v4, 16, v25
    s_and_b32 s25, s2, 3
    s_lshl_b32 s25, s25, 10
    s_lshl_b32 s24, s3, 12
    s_add_u32 s25, s25, s24
    s_bfe_u32 s24, s2, 0x10002
    s_lshl_b32 s24, s24, 23
    s_add_u32 s25, s25, s24
    v_add_u32 v26, s25, v2
    s_cmp_ge_u32 s27, 3
    s_cselect_b32 s28, 1, 0
    s_mul_i32 s29, s28, 3
    s_sub_u32 s29, s27, s29
    s_lshr_b32 s72, s3, 1
    s_lshl_b32 s24, s28, 1
    s_add_u32 s72, s72, s24
    s_and_b32 s31, s3, 1
    s_lshl_b32 s24, s29, 1
    s_add_u32 s31, s31, s24
    s_lshl_b32 s30, s72, 5
    s_add_u32 s30, s30, s26
    s_lshl_b32 s30, s30, 20
    v_lshrrev_b32 v3, 4, v0
    v_and_b32 v4, 3, v0
    v_lshlrev_b32 v5, 6, v3
    v_lshl_add_u32 v5, v4, 4, v5
    v_bfe_u32 v1, v0, 2, 2
    v_lshl_add_u32 v1, v1, 8, v5
    s_mul_i32 s35, s31, 1024
    s_add_u32 s32, s35, 983040
    s_mul_i32 s28, s31, 1024
    s_add_u32 s28, s28, 1044480
    s_mov_b32 s6, 0x100000
    s_mov_b32 s7, 0x20000
    s_add_u32 s4, s50, s30
    s_addc_u32 s5, s51, 0
    s_mov_b32 s12, s62
    s_mov_b32 s13, s63
    s_mov_b32 s14, 0x400000
    s_mov_b32 s15, 0x20000
    s_mov_b32 s16, s60
    s_mov_b32 s17, s61
    s_mov_b32 s18, 0x100
    s_mov_b32 s19, 0x20000
    v_and_b32 v3, 1, v0
    v_lshlrev_b32 v3, 4, v3
    v_mov_b32 v4, 0xffff
    v_lshlrev_b32 v4, v3, v4
    v_bfe_u32 v3, v0, 1, 2
    v_cmp_eq_u32 vcc, 0, v3
    s_nop 1
    v_cndmask_b32 v20, 0, v4, vcc
    v_cmp_eq_u32 vcc, 1, v3
    s_nop 1
    v_cndmask_b32 v21, 0, v4, vcc
    v_cmp_eq_u32 vcc, 2, v3
    s_nop 1
    v_cndmask_b32 v22, 0, v4, vcc
    v_cmp_eq_u32 vcc, 3, v3
    s_nop 1
    v_cndmask_b32 v23, 0, v4, vcc
    s_mov_b32 s64, 0x22222222
    s_mov_b32 s65, 0x22222222
    s_mov_b32 s66, 0x44444444
    s_mov_b32 s67, 0x44444444
    s_mov_b32 s68, 0x88888888
    s_mov_b32 s69, 0x88888888
    v_mov_b32 v32, 0
    v_mov_b32 v33, 0
    v_mov_b32 v34, 0
    v_mov_b32 v35, 0
    v_mov_b32 v36, 0
    v_mov_b32 v37, 0
    v_mov_b32 v38, 0
    v_mov_b32 v39, 0
    v_mov_b32 v40, 0
    v_mov_b32 v41, 0
    v_mov_b32 v42, 0
    v_mov_b32 v43, 0
    v_mov_b32 v44, 0
    v_mov_b32 v45, 0
    v_mov_b32 v46, 0
    v_mov_b32 v47, 0
    v_lshrrev_b32 v3, 4, v0
    v_lshlrev_b32 v60, 6, v3
    v_and_b32 v4, 7, v0
    v_lshl_add_u32 v60, v4, 3, v60
    s_lshl_b32 s33, s26, 2
    s_add_u32 s33, s33, s72
    s_lshl_b32 s34, s33, 8
    s_add_u32 s34, s34, 0x164000
    s_mul_i32 s73, s33, 6
    s_add_u32 s73, s73, s31
    s_lshl_b32 s73, s73, 8
    s_add_u32 s73, s73, 0x180000
    s_mov_b64 s[8:9], s[56:57]
L_pfo:
    s_lshl_b32 s24, s74, 8
    s_waitcnt vmcnt(6)
    buffer_load_dwordx4 v[28:31], v25, s[8:11], s24 offen
    s_addk_i32 s74, 96
    s_cmpk_lt_u32 s74, 512
    s_cbranch_scc1 L_pfo
    s_addk_i32 s74, -512
    s_mov_b64 s[8:9], s[44:45]
L_pfu:
    s_lshl_b32 s24, s74, 13
    s_waitcnt vmcnt(6)
    buffer_load_dwordx4 v[28:31], v24, s[8:11], s24 offen
    s_addk_i32 s74, 96
    s_cmpk_lt_u32 s74, 512
    s_cbranch_scc1 L_pfu
    s_addk_i32 s74, -512
    s_mov_b64 s[8:9], s[46:47]
L_pfv:
    s_lshl_b32 s24, s74, 8
    s_waitcnt vmcnt(6)
    buffer_load_dwordx4 v[28:31], v25, s[8:11], s24 offen
    s_addk_i32 s74, 96
    s_cmpk_lt_u32 s74, 512
    s_cbranch_scc1 L_pfv
    s_addk_i32 s74, -512
    s_mov_b64 s[8:9], s[38:39]
    s_mov_b32 s10, 0x1000000
L_pfc:
    s_lshl_b32 s24, s74, 12
    s_waitcnt vmcnt(6)
    buffer_load_dwordx4 v[28:31], v26, s[8:11], s24 offen
    s_addk_i32 s74, 96
    s_cmpk_lt_u32 s74, 2048
    s_cbranch_scc1 L_pfc
    s_addk_i32 s74, -2048
    s_mov_b32 s10, 0x400000
    s_waitcnt vmcnt(15)
    buffer_load_dwordx4 a[0:3], v1, s[4:7], s32 offen offset:0 nt
    s_add_u32 s32, s32, 6144
    s_waitcnt vmcnt(15)
    buffer_load_dwordx4 a[4:7], v1, s[4:7], s32 offen offset:0 nt
    s_add_u32 s32, s32, 6144
    s_waitcnt vmcnt(15)
    buffer_load_dwordx4 a[8:11], v1, s[4:7], s32 offen offset:0 nt
    s_add_u32 s32, s32, 6144
    s_waitcnt vmcnt(15)
    buffer_load_dwordx4 a[12:15], v1, s[4:7], s32 offen offset:0 nt
    s_add_u32 s32, s32, 6144
    s_waitcnt vmcnt(15)
    buffer_load_dwordx4 a[16:19], v1, s[4:7], s32 offen offset:0 nt
    s_add_u32 s32, s32, 6144
    s_waitcnt vmcnt(15)
    buffer_load_dwordx4 a[20:23], v1, s[4:7], s32 offen offset:0 nt
    s_add_u32 s32, s32, 6144
    s_waitcnt vmcnt(15)
    buffer_load_dwordx4 a[24:27], v1, s[4:7], s32 offen offset:0 nt
    s_add_u32 s32, s32, 6144
    s_waitcnt vmcnt(15)
    buffer_load_dwordx4 a[28:31], v1, s[4:7], s32 offen offset:0 nt
    s_add_u32 s32, s32, 6144
    s_mov_b64 exec, 1
    buffer_load_dword v61, off, s[16:19], 0 offset:128 sc1
    s_mov_b64 exec, -1
    s_waitcnt vmcnt(15)
    buffer_load_dwordx4 a[32:35], v1, s[4:7], s32 offen offset:0 nt
    s_add_u32 s32, s32, 6144
    s_waitcnt vmcnt(15)
    buffer_load_dwordx4 a[36:39], v1, s[4:7], s32 offen offset:0 nt
    s_add_u32 s32, s32, 6144
    s_waitcnt vmcnt(15)
    buffer_load_dwordx4 a[40:43], v1, s[4:7], s28 offen offset:0 nt
    s_waitcnt vmcnt(15)
    s_mov_b32 s32, s35
    buffer_load_dwordx4 v[64:67], v1, s[4:7], s32 offen offset:0 nt
    s_add_u32 s32, s32, 6144
    s_waitcnt vmcnt(15)
    buffer_load_dwordx4 v[68:71], v1, s[4:7], s32 offen offset:0 nt
    s_add_u32 s32, s32, 6144
    s_waitcnt vmcnt(15)
    buffer_load_dwordx4 v[72:75], v1, s[4:7], s32 offen offset:0 nt
    s_add_u32 s32, s32, 6144
    s_waitcnt vmcnt(15)
    buffer_load_dwordx4 v[76:79], v1, s[4:7], s32 offen offset:0 nt
    s_add_u32 s32, s32, 6144
    s_waitcnt vmcnt(15)
    buffer_load_dwordx4 v[80:83], v1, s[4:7], s32 offen offset:0 nt
    s_add_u32 s32, s32, 6144
    s_waitcnt vmcnt(15)
    buffer_load_dwordx4 v[84:87], v1, s[4:7], s32 offen offset:0 nt
    s_add_u32 s32, s32, 6144
    s_waitcnt vmcnt(9)
    v_readfirstlane_b32 s25, v61
    s_nop 0
    s_cmp_ge_u32 s25, 32
    s_cbranch_scc1 L_B_q
    s_mov_b32 s24, 262144
    s_mov_b64 exec, 1
L_aw2:
    buffer_load_dword v61, off, s[16:19], 0 offset:128 sc1
    s_waitcnt vmcnt(0)
    v_readfirstlane_b32 s25, v61
    s_nop 0
    s_cmp_ge_u32 s25, 32
    s_cbranch_scc1 L_B_q
    s_sleep 16
    s_sub_u32 s24, s24, 1
    s_cmp_lg_u32 s24, 0
    s_cbranch_scc1 L_aw2
L_B_q:
    s_mov_b64 exec, -1
    buffer_load_dwordx4 v[8:11], v5, s[12:15], s34 offen sc1
    s_waitcnt vmcnt(15)
    buffer_load_dwordx4 v[88:91], v1, s[4:7], s32 offen offset:0 nt
    s_add_u32 s32, s32, 6144
    s_waitcnt vmcnt(15)
    buffer_load_dwordx4 v[92:95], v1, s[4:7], s32 offen offset:0 nt
    s_add_u32 s32, s32, 6144
    s_waitcnt vmcnt(15)
    buffer_load_dwordx4 v[96:99], v1, s[4:7], s32 offen offset:0 nt
    s_add_u32 s32, s32, 6144
    s_waitcnt vmcnt(15)
    buffer_load_dwordx4 v[100:103], v1, s[4:7], s32 offen offset:0 nt
    s_add_u32 s32, s32, 6144
    s_waitcnt vmcnt(15)
    buffer_load_dwordx4 v[104:107], v1, s[4:7], s32 offen offset:0 nt
    s_add_u32 s32, s32, 6144
    s_waitcnt vmcnt(15)
    buffer_load_dwordx4 v[108:111], v1, s[4:7], s32 offen offset:0 nt
    s_add_u32 s32, s32, 6144
    s_waitcnt vmcnt(15)
    buffer_load_dwordx4 v[112:115], v1, s[4:7], s32 offen offset:0 nt
    s_add_u32 s32, s32, 6144
    s_waitcnt vmcnt(15)
    buffer_load_dwordx4 v[116:119], v1, s[4:7], s32 offen offset:0 nt
    s_add_u32 s32, s32, 6144
    s_waitcnt vmcnt(15)
    buffer_load_dwordx4 v[120:123], v1, s[4:7], s32 offen offset:0 nt
    s_add_u32 s32, s32, 6144
    s_waitcnt vmcnt(15)
    buffer_load_dwordx4 v[124:127], v1, s[4:7], s32 offen offset:0 nt
    s_add_u32 s32, s32, 6144
    s_waitcnt vmcnt(10)
    v_mov_b32_dpp v32, v8 quad_perm:[0,1,2,3] row_mask:0xf bank_mask:0x1
    v_mov_b32_dpp v33, v9 quad_perm:[0,1,2,3] row_mask:0xf bank_mask:0x1
    v_mov_b32_dpp v34, v10 quad_perm:[0,1,2,3] row_mask:0xf bank_mask:0x1
    v_mov_b32_dpp v35, v11 quad_perm:[0,1,2,3] row_mask:0xf bank_mask:0x1
    v_mov_b32_dpp v36, v8 quad_perm:[0,1,2,3] row_mask:0xf bank_mask:0x2
    v_mov_b32_dpp v37, v9 quad_perm:[0,1,2,3] row_mask:0xf bank_mask:0x2
    v_mov_b32_dpp v38, v10 quad_perm:[0,1,2,3] row_mask:0xf bank_mask:0x2
    v_mov_b32_dpp v39, v11 quad_perm:[0,1,2,3] row_mask:0xf bank_mask:0x2
    v_mov_b32_dpp v40, v8 quad_perm:[0,1,2,3] row_mask:0xf bank_mask:0x4
    v_mov_b32_dpp v41, v9 quad_perm:[0,1,2,3] row_mask:0xf bank_mask:0x4
    v_mov_b32_dpp v42, v10 quad_perm:[0,1,2,3] row_mask:0xf bank_mask:0x4
    v_mov_b32_dpp v43, v11 quad_perm:[0,1,2,3] row_mask:0xf bank_mask:0x4
    v_mov_b32_dpp v44, v8 quad_perm:[0,1,2,3] row_mask:0xf bank_mask:0x8
    v_mov_b32_dpp v45, v9 quad_perm:[0,1,2,3] row_mask:0xf bank_mask:0x8
    v_mov_b32_dpp v46, v10 quad_perm:[0,1,2,3] row_mask:0xf bank_mask:0x8
    v_mov_b32_dpp v47, v11 quad_perm:[0,1,2,3] row_mask:0xf bank_mask:0x8
    s_mov_b32 s27, 0
L_BK:
    s_cmp_lg_u32 s27, 9
    s_cbranch_scc1 L_BK_a
    s_add_u32 s4, s52, s30
    s_addc_u32 s5, s53, 0
    s_mov_b32 s32, s35
    v_mov_b32 v1, v2
L_BK_a:
    s_barrier
    s_cmp_lg_u32 s27, 7
    s_cbranch_scc1 L_BV_x0
    s_lshl_b32 s24, s26, 7
    s_add_u32 s24, s24, 0x1b6000
    s_mov_b64 exec, 1
    buffer_load_dwordx2 v[62:63], off, s[12:15], s24 sc1
    s_mov_b64 exec, -1
L_BV_x0:
    s_cmp_lg_u32 s27, 8
    s_cbranch_scc1 L_BV_x1
    s_getreg_b32 s75, hwreg(HW_REG_XCC_ID, 0, 4)
    v_readfirstlane_b32 s24, v62
    v_readfirstlane_b32 s25, v63
    s_xor_b32 s24, s24, s75
    s_xor_b32 s25, s25, s75
    s_or_b32 s75, s24, s25
    v_mov_b32 v28, -1
    v_mov_b32 v29, -1
    v_mov_b32 v30, -1
    v_mov_b32 v31, -1
    s_mov_b64 exec, 0xffff
    s_cbranch_scc1 L_BK_cf
    buffer_store_dwordx4 v[28:31], v2, s[12:15], s73 offen
    s_branch L_BK_cd
L_BK_cf:
    buffer_store_dwordx4 v[28:31], v2, s[12:15], s73 offen sc1
L_BK_cd:
    s_mov_b64 exec, -1
L_BV_x1:
    v_mov_b32 v48, v49
    v_mov_b32 v49, v50
    v_mov_b32 v50, v51
    v_mov_b32 v51, v52
    v_mov_b32 v52, v53
    v_mov_b32 v53, v54
    v_mov_b32 v54, v55
    v_mov_b32 v55, v56
    v_mov_b32 v56, v57
    s_waitcnt vmcnt(15)
    v_mfma_f32_16x16x32_bf16 v[12:15], v[64:67], v[32:35], 0
    buffer_load_dwordx4 v[64:67], v1, s[4:7], s32 offen offset:0 nt
    s_add_u32 s32, s32, 6144
    s_waitcnt vmcnt(15)
    v_mfma_f32_16x16x32_bf16 v[12:15], v[68:71], v[36:39], v[12:15]
    buffer_load_dwordx4 v[68:71], v1, s[4:7], s32 offen offset:0 nt
    s_add_u32 s32, s32, 6144
    s_waitcnt vmcnt(15)
    v_mfma_f32_16x16x32_bf16 v[12:15], v[72:75], v[40:43], v[12:15]
    buffer_load_dwordx4 v[72:75], v1, s[4:7], s32 offen offset:0 nt
    s_add_u32 s32, s32, 6144
    s_waitcnt vmcnt(15)
    v_mfma_f32_16x16x32_bf16 v[12:15], v[76:79], v[44:47], v[12:15]
    buffer_load_dwordx4 v[76:79], v1, s[4:7], s32 offen offset:0 nt
    s_add_u32 s32, s32, 6144
    s_nop 5
    v_add_f32_dpp v57, v13, v12 quad_perm:[1,1,1,1] row_mask:0xf bank_mask:0xf
    s_nop 1
    v_add_f32_dpp v57, v14, v57 quad_perm:[2,2,2,2] row_mask:0xf bank_mask:0xf
    s_nop 1
    v_add_f32_dpp v57, v15, v57 quad_perm:[3,3,3,3] row_mask:0xf bank_mask:0xf
    s_waitcnt vmcnt(15)
    v_mfma_f32_16x16x32_bf16 v[16:19], v[80:83], v[32:35], 0
    buffer_load_dwordx4 v[80:83], v1, s[4:7], s32 offen offset:0 nt
    s_add_u32 s32, s32, 6144
    s_waitcnt vmcnt(15)
    v_mfma_f32_16x16x32_bf16 v[16:19], v[84:87], v[36:39], v[16:19]
    buffer_load_dwordx4 v[84:87], v1, s[4:7], s32 offen offset:0 nt
    s_add_u32 s32, s32, 6144
    s_waitcnt vmcnt(15)
    v_mfma_f32_16x16x32_bf16 v[16:19], v[88:91], v[40:43], v[16:19]
    buffer_load_dwordx4 v[88:91], v1, s[4:7], s32 offen offset:0 nt
    s_add_u32 s32, s32, 6144
    s_waitcnt vmcnt(15)
    v_mfma_f32_16x16x32_bf16 v[16:19], v[92:95], v[44:47], v[16:19]
    buffer_load_dwordx4 v[92:95], v1, s[4:7], s32 offen offset:0 nt
    s_add_u32 s32, s32, 6144
    s_nop 5
    v_add_f32_dpp v3, v16, v17 quad_perm:[0,0,0,0] row_mask:0xf bank_mask:0xf
    s_nop 1
    v_add_f32_dpp v3, v18, v3 quad_perm:[2,2,2,2] row_mask:0xf bank_mask:0xf
    s_nop 1
    v_add_f32_dpp v3, v19, v3 quad_perm:[3,3,3,3] row_mask:0xf bank_mask:0xf
    v_cndmask_b32 v57, v57, v3, s[64:65]
    s_waitcnt vmcnt(15)
    v_mfma_f32_16x16x32_bf16 v[12:15], v[96:99], v[32:35], 0
    buffer_load_dwordx4 v[96:99], v1, s[4:7], s32 offen offset:0 nt
    s_add_u32 s32, s32, 6144
    s_waitcnt vmcnt(15)
    v_mfma_f32_16x16x32_bf16 v[12:15], v[100:103], v[36:39], v[12:15]
    buffer_load_dwordx4 v[100:103], v1, s[4:7], s32 offen offset:0 nt
    s_add_u32 s32, s32, 6144
    s_waitcnt vmcnt(15)
    v_mfma_f32_16x16x32_bf16 v[12:15], v[104:107], v[40:43], v[12:15]
    buffer_load_dwordx4 v[104:107], v1, s[4:7], s32 offen offset:0 nt
    s_add_u32 s32, s32, 6144
    s_waitcnt vmcnt(15)
    v_mfma_f32_16x16x32_bf16 v[12:15], v[108:111], v[44:47], v[12:15]
    buffer_load_dwordx4 v[108:111], v1, s[4:7], s32 offen offset:0 nt
    s_add_u32 s32, s32, 6144
    s_nop 5
    v_add_f32_dpp v3, v12, v14 quad_perm:[0,0,0,0] row_mask:0xf bank_mask:0xf
    s_nop 1
    v_add_f32_dpp v3, v13, v3 quad_perm:[1,1,1,1] row_mask:0xf bank_mask:0xf
    s_nop 1
    v_add_f32_dpp v3, v15, v3 quad_perm:[3,3,3,3] row_mask:0xf bank_mask:0xf
    v_cndmask_b32 v57, v57, v3, s[66:67]
    s_waitcnt vmcnt(15)
    v_mfma_f32_16x16x32_bf16 v[16:19], v[112:115], v[32:35], 0
    buffer_load_dwordx4 v[112:115], v1, s[4:7], s32 offen offset:0 nt
    s_add_u32 s32, s32, 6144
    s_waitcnt vmcnt(15)
    v_mfma_f32_16x16x32_bf16 v[16:19], v[116:119], v[36:39], v[16:19]
    buffer_load_dwordx4 v[116:119], v1, s[4:7], s32 offen offset:0 nt
    s_add_u32 s32, s32, 6144
    s_waitcnt vmcnt(15)
    v_mfma_f32_16x16x32_bf16 v[16:19], v[120:123], v[40:43], v[16:19]
    buffer_load_dwordx4 v[120:123], v1, s[4:7], s32 offen offset:0 nt
    s_add_u32 s32, s32, 6144
    s_waitcnt vmcnt(15)
    v_mfma_f32_16x16x32_bf16 v[16:19], v[124:127], v[44:47], v[16:19]
    buffer_load_dwordx4 v[124:127], v1, s[4:7], s32 offen offset:0 nt
    s_add_u32 s32, s32, 6144
    s_nop 5
    v_add_f32_dpp v3, v16, v19 quad_perm:[0,0,0,0] row_mask:0xf bank_mask:0xf
    s_nop 1
    v_add_f32_dpp v3, v17, v3 quad_perm:[1,1,1,1] row_mask:0xf bank_mask:0xf
    s_nop 1
    v_add_f32_dpp v3, v18, v3 quad_perm:[2,2,2,2] row_mask:0xf bank_mask:0xf
    v_cndmask_b32 v57, v57, v3, s[68:69]
    s_cmp_lg_u32 s27, 1
    s_cbranch_scc1 L_BK_b
    v_mfma_f32_16x16x32_bf16 v[12:15], a[0:3], v[32:35], 0
    v_mfma_f32_16x16x32_bf16 v[12:15], a[4:7], v[36:39], v[12:15]
    v_mfma_f32_16x16x32_bf16 v[12:15], a[8:11], v[40:43], v[12:15]
    v_mfma_f32_16x16x32_bf16 v[12:15], a[12:15], v[44:47], v[12:15]
    s_nop 7
    v_add_f32_dpp v58, v13, v12 quad_perm:[1,1,1,1] row_mask:0xf bank_mask:0xf
    s_nop 1
    v_add_f32_dpp v58, v14, v58 quad_perm:[2,2,2,2] row_mask:0xf bank_mask:0xf
    s_nop 1
    v_add_f32_dpp v58, v15, v58 quad_perm:[3,3,3,3] row_mask:0xf bank_mask:0xf
    v_mfma_f32_16x16x32_bf16 v[16:19], a[16:19], v[32:35], 0
    v_mfma_f32_16x16x32_bf16 v[16:19], a[20:23], v[36:39], v[16:19]
    v_mfma_f32_16x16x32_bf16 v[16:19], a[24:27], v[40:43], v[16:19]
    v_mfma_f32_16x16x32_bf16 v[16:19], a[28:31], v[44:47], v[16:19]
    s_nop 7
    v_add_f32_dpp v3, v16, v17 quad_perm:[0,0,0,0] row_mask:0xf bank_mask:0xf
    s_nop 1
    v_add_f32_dpp v3, v18, v3 quad_perm:[2,2,2,2] row_mask:0xf bank_mask:0xf
    s_nop 1
    v_add_f32_dpp v3, v19, v3 quad_perm:[3,3,3,3] row_mask:0xf bank_mask:0xf
    v_cndmask_b32 v58, v58, v3, s[64:65]
    v_mfma_f32_16x16x32_bf16 v[12:15], a[32:35], v[32:35], 0
    v_mfma_f32_16x16x32_bf16 v[12:15], a[36:39], v[36:39], v[12:15]
    v_mfma_f32_16x16x32_bf16 v[12:15], a[40:43], v[40:43], v[12:15]
    s_nop 7
    v_add_f32_dpp v3, v12, v14 quad_perm:[0,0,0,0] row_mask:0xf bank_mask:0xf
    s_nop 1
    v_add_f32_dpp v3, v13, v3 quad_perm:[1,1,1,1] row_mask:0xf bank_mask:0xf
    s_nop 1
    v_add_f32_dpp v3, v15, v3 quad_perm:[3,3,3,3] row_mask:0xf bank_mask:0xf
    v_cndmask_b32 v58, v58, v3, s[66:67]
    s_mul_i32 s24, s31, 1
    s_sub_i32 s24, 4, s24
    s_max_i32 s24, s24, 0
    s_min_i32 s24, s24, 1
    s_add_u32 s24, s24, 10
    v_and_b32 v3, 3, v0
    v_bfe_u32 v4, v0, 2, 2
    v_lshl_add_u32 v3, v3, 2, v4
    v_mov_b32 v4, 0xff800000
    v_cmp_gt_u32 vcc, s24, v3
    s_nop 1
    v_cndmask_b32 v58, v4, v58, vcc
    v_mov_b32 v61, 0x3e0293ee
    v_mov_b32 v7, 0
    s_lshl_b32 s34, s2, 7
    s_add_u32 s34, s34, 0x1ae000
L_BK_b:
    s_add_u32 s27, s27, 1
    s_cmp_lt_u32 s27, 10
    s_cbranch_scc1 L_BK
    v_max3_f32 v3, v48, v49, v50
    v_max3_f32 v3, v3, v51, v52
    v_max3_f32 v3, v3, v53, v54
    v_max3_f32 v3, v3, v55, v56
    v_max3_f32 v3, v3, v57, v58
    s_nop 1
    v_max_f32_dpp v3, v3, v3 row_ror:8 row_mask:0xf bank_mask:0xf
    s_nop 1
    v_max_f32_dpp v3, v3, v3 row_ror:4 row_mask:0xf bank_mask:0xf
    s_nop 1
    v_max_f32_dpp v3, v3, v3 row_ror:2 row_mask:0xf bank_mask:0xf
    s_nop 1
    v_max_f32_dpp v3, v3, v3 row_ror:1 row_mask:0xf bank_mask:0xf
    s_nop 1
    v_max_f32_dpp v3, v3, v3 row_bcast:15 row_mask:0xa bank_mask:0xf
    s_nop 1
    v_max_f32_dpp v3, v3, v3 row_bcast:31 row_mask:0xc bank_mask:0xf
    s_nop 0
    v_readlane_b32 s24, v3, 63
    s_nop 1
    v_mul_f32 v6, s24, v61
    v_mov_b32 v12, 0
    v_mov_b32 v13, 0
    v_mov_b32 v14, 0
    v_mov_b32 v15, 0
    v_fma_f32 v48, v48, v61, -v6
    v_exp_f32 v48, v48
    s_nop 0
    v_add_f32 v7, v7, v48
    v_cvt_pk_bf16_f32 v48, v48, v48
    s_mov_b32 s27, 0
L_BV:
    s_barrier
    s_cmp_ge_u32 s27, 1
    s_cselect_b32 s71, s3, 4
    s_cmp_lg_u32 s71, 0
    s_cbranch_scc1 L_BV_p0
    s_lshl_b32 s24, s27, 2
    s_add_u32 s24, s24, 0
    s_mov_b64 exec, 1
    v_mov_b32 v63, s24
    s_cmp_eq_u32 s75, 0
    s_cbranch_scc0 L_BV_q0
    buffer_store_dword v63, off, s[12:15], s34 offset:64
    s_branch L_BV_r0
L_BV_q0:
    buffer_store_dword v63, off, s[12:15], s34 offset:64 sc1
L_BV_r0:
    s_mov_b64 exec, -1
L_BV_p0:
    v_and_b32_dpp v8, v48, v20 row_newbcast:0 row_mask:0xf bank_mask:0xf
    v_and_b32_dpp v9, v48, v21 row_newbcast:0 row_mask:0xf bank_mask:0xf
    v_and_b32_dpp v10, v48, v22 row_newbcast:0 row_mask:0xf bank_mask:0xf
    v_and_b32_dpp v11, v48, v23 row_newbcast:0 row_mask:0xf bank_mask:0xf
    s_waitcnt vmcnt(15)
    s_nop 0
    v_mfma_f32_16x16x32_bf16 v[12:15], v[64:67], v[8:11], v[12:15]
    buffer_load_dwordx4 v[64:67], v1, s[4:7], s32 offen offset:0 nt
    s_add_u32 s32, s32, 6144
    v_and_b32_dpp v8, v48, v20 row_newbcast:4 row_mask:0xf bank_mask:0xf
    v_and_b32_dpp v9, v48, v21 row_newbcast:4 row_mask:0xf bank_mask:0xf
    v_and_b32_dpp v10, v48, v22 row_newbcast:4 row_mask:0xf bank_mask:0xf
    v_and_b32_dpp v11, v48, v23 row_newbcast:4 row_mask:0xf bank_mask:0xf
    s_waitcnt vmcnt(15)
    s_nop 0
    v_mfma_f32_16x16x32_bf16 v[12:15], v[68:71], v[8:11], v[12:15]
    buffer_load_dwordx4 v[68:71], v1, s[4:7], s32 offen offset:0 nt
    s_add_u32 s32, s32, 6144
    v_and_b32_dpp v8, v48, v20 row_newbcast:8 row_mask:0xf bank_mask:0xf
    v_and_b32_dpp v9, v48, v21 row_newbcast:8 row_mask:0xf bank_mask:0xf
    v_and_b32_dpp v10, v48, v22 row_newbcast:8 row_mask:0xf bank_mask:0xf
    v_and_b32_dpp v11, v48, v23 row_newbcast:8 row_mask:0xf bank_mask:0xf
    s_waitcnt vmcnt(15)
    s_nop 0
    v_mfma_f32_16x16x32_bf16 v[12:15], v[72:75], v[8:11], v[12:15]
    buffer_load_dwordx4 v[72:75], v1, s[4:7], s32 offen offset:0 nt
    s_add_u32 s32, s32, 6144
    v_and_b32_dpp v8, v48, v20 row_newbcast:12 row_mask:0xf bank_mask:0xf
    v_and_b32_dpp v9, v48, v21 row_newbcast:12 row_mask:0xf bank_mask:0xf
    v_and_b32_dpp v10, v48, v22 row_newbcast:12 row_mask:0xf bank_mask:0xf
    v_and_b32_dpp v11, v48, v23 row_newbcast:12 row_mask:0xf bank_mask:0xf
    s_waitcnt vmcnt(15)
    s_nop 0
    v_mfma_f32_16x16x32_bf16 v[12:15], v[76:79], v[8:11], v[12:15]
    buffer_load_dwordx4 v[76:79], v1, s[4:7], s32 offen offset:0 nt
    s_add_u32 s32, s32, 6144
    s_cmp_lg_u32 s71, 1
    s_cbranch_scc1 L_BV_p1
    s_lshl_b32 s24, s27, 2
    s_add_u32 s24, s24, 1
    s_mov_b64 exec, 1
    v_mov_b32 v63, s24
    s_cmp_eq_u32 s75, 0
    s_cbranch_scc0 L_BV_q1
    buffer_store_dword v63, off, s[12:15], s34 offset:64
    s_branch L_BV_r1
L_BV_q1:
    buffer_store_dword v63, off, s[12:15], s34 offset:64 sc1
L_BV_r1:
    s_mov_b64 exec, -1
L_BV_p1:
    v_and_b32_dpp v8, v48, v20 row_newbcast:1 row_mask:0xf bank_mask:0xf
    v_and_b32_dpp v9, v48, v21 row_newbcast:1 row_mask:0xf bank_mask:0xf
    v_and_b32_dpp v10, v48, v22 row_newbcast:1 row_mask:0xf bank_mask:0xf
    v_and_b32_dpp v11, v48, v23 row_newbcast:1 row_mask:0xf bank_mask:0xf
    s_waitcnt vmcnt(15)
    s_nop 0
    v_mfma_f32_16x16x32_bf16 v[12:15], v[80:83], v[8:11], v[12:15]
    buffer_load_dwordx4 v[80:83], v1, s[4:7], s32 offen offset:0 nt
    s_add_u32 s32, s32, 6144
    v_and_b32_dpp v8, v48, v20 row_newbcast:5 row_mask:0xf bank_mask:0xf
    v_and_b32_dpp v9, v48, v21 row_newbcast:5 row_mask:0xf bank_mask:0xf
    v_and_b32_dpp v10, v48, v22 row_newbcast:5 row_mask:0xf bank_mask:0xf
    v_and_b32_dpp v11, v48, v23 row_newbcast:5 row_mask:0xf bank_mask:0xf
    s_waitcnt vmcnt(15)
    s_nop 0
    v_mfma_f32_16x16x32_bf16 v[12:15], v[84:87], v[8:11], v[12:15]
    buffer_load_dwordx4 v[84:87], v1, s[4:7], s32 offen offset:0 nt
    s_add_u32 s32, s32, 6144
    v_and_b32_dpp v8, v48, v20 row_newbcast:9 row_mask:0xf bank_mask:0xf
    v_and_b32_dpp v9, v48, v21 row_newbcast:9 row_mask:0xf bank_mask:0xf
    v_and_b32_dpp v10, v48, v22 row_newbcast:9 row_mask:0xf bank_mask:0xf
    v_and_b32_dpp v11, v48, v23 row_newbcast:9 row_mask:0xf bank_mask:0xf
    s_waitcnt vmcnt(15)
    s_nop 0
    v_mfma_f32_16x16x32_bf16 v[12:15], v[88:91], v[8:11], v[12:15]
    buffer_load_dwordx4 v[88:91], v1, s[4:7], s32 offen offset:0 nt
    s_add_u32 s32, s32, 6144
    v_and_b32_dpp v8, v48, v20 row_newbcast:13 row_mask:0xf bank_mask:0xf
    v_and_b32_dpp v9, v48, v21 row_newbcast:13 row_mask:0xf bank_mask:0xf
    v_and_b32_dpp v10, v48, v22 row_newbcast:13 row_mask:0xf bank_mask:0xf
    v_and_b32_dpp v11, v48, v23 row_newbcast:13 row_mask:0xf bank_mask:0xf
    s_waitcnt vmcnt(15)
    s_nop 0
    v_mfma_f32_16x16x32_bf16 v[12:15], v[92:95], v[8:11], v[12:15]
    buffer_load_dwordx4 v[92:95], v1, s[4:7], s32 offen offset:0 nt
    s_add_u32 s32, s32, 6144
    s_cmp_lg_u32 s71, 2
    s_cbranch_scc1 L_BV_p2
    s_lshl_b32 s24, s27, 2
    s_add_u32 s24, s24, 2
    s_mov_b64 exec, 1
    v_mov_b32 v63, s24
    s_cmp_eq_u32 s75, 0
    s_cbranch_scc0 L_BV_q2
    buffer_store_dword v63, off, s[12:15], s34 offset:64
    s_branch L_BV_r2
L_BV_q2:
    buffer_store_dword v63, off, s[12:15], s34 offset:64 sc1
L_BV_r2:
    s_mov_b64 exec, -1
L_BV_p2:
    v_and_b32_dpp v8, v48, v20 row_newbcast:2 row_mask:0xf bank_mask:0xf
    v_and_b32_dpp v9, v48, v21 row_newbcast:2 row_mask:0xf bank_mask:0xf
    v_and_b32_dpp v10, v48, v22 row_newbcast:2 row_mask:0xf bank_mask:0xf
    v_and_b32_dpp v11, v48, v23 row_newbcast:2 row_mask:0xf bank_mask:0xf
    s_waitcnt vmcnt(15)
    s_nop 0
    v_mfma_f32_16x16x32_bf16 v[12:15], v[96:99], v[8:11], v[12:15]
    buffer_load_dwordx4 v[96:99], v1, s[4:7], s32 offen offset:0 nt
    s_add_u32 s32, s32, 6144
    v_and_b32_dpp v8, v48, v20 row_newbcast:6 row_mask:0xf bank_mask:0xf
    v_and_b32_dpp v9, v48, v21 row_newbcast:6 row_mask:0xf bank_mask:0xf
    v_and_b32_dpp v10, v48, v22 row_newbcast:6 row_mask:0xf bank_mask:0xf
    v_and_b32_dpp v11, v48, v23 row_newbcast:6 row_mask:0xf bank_mask:0xf
    s_waitcnt vmcnt(15)
    s_nop 0
    v_mfma_f32_16x16x32_bf16 v[12:15], v[100:103], v[8:11], v[12:15]
    buffer_load_dwordx4 v[100:103], v1, s[4:7], s32 offen offset:0 nt
    s_add_u32 s32, s32, 6144
    s_cmp_eq_u32 s27, 9
    s_cbranch_scc1 L_BT
    v_and_b32_dpp v8, v48, v20 row_newbcast:10 row_mask:0xf bank_mask:0xf
    v_and_b32_dpp v9, v48, v21 row_newbcast:10 row_mask:0xf bank_mask:0xf
    v_and_b32_dpp v10, v48, v22 row_newbcast:10 row_mask:0xf bank_mask:0xf
    v_and_b32_dpp v11, v48, v23 row_newbcast:10 row_mask:0xf bank_mask:0xf
    s_waitcnt vmcnt(15)
    s_nop 0
    v_mfma_f32_16x16x32_bf16 v[12:15], v[104:107], v[8:11], v[12:15]
    buffer_load_dwordx4 v[104:107], v1, s[4:7], s32 offen offset:0 nt
    s_add_u32 s32, s32, 6144
    v_and_b32_dpp v8, v48, v20 row_newbcast:14 row_mask:0xf bank_mask:0xf
    v_and_b32_dpp v9, v48, v21 row_newbcast:14 row_mask:0xf bank_mask:0xf
    v_and_b32_dpp v10, v48, v22 row_newbcast:14 row_mask:0xf bank_mask:0xf
    v_and_b32_dpp v11, v48, v23 row_newbcast:14 row_mask:0xf bank_mask:0xf
    s_waitcnt vmcnt(15)
    s_nop 0
    v_mfma_f32_16x16x32_bf16 v[12:15], v[108:111], v[8:11], v[12:15]
    buffer_load_dwordx4 v[108:111], v1, s[4:7], s32 offen offset:0 nt
    s_add_u32 s32, s32, 6144
    s_cmp_lg_u32 s71, 3
    s_cbranch_scc1 L_BV_p3
    s_lshl_b32 s24, s27, 2
    s_add_u32 s24, s24, 3
    s_mov_b64 exec, 1
    v_mov_b32 v63, s24
    s_cmp_eq_u32 s75, 0
    s_cbranch_scc0 L_BV_q3
    buffer_store_dword v63, off, s[12:15], s34 offset:64
    s_branch L_BV_r3
L_BV_q3:
    buffer_store_dword v63, off, s[12:15], s34 offset:64 sc1
L_BV_r3:
    s_mov_b64 exec, -1
L_BV_p3:
    v_and_b32_dpp v8, v48, v20 row_newbcast:3 row_mask:0xf bank_mask:0xf
    v_and_b32_dpp v9, v48, v21 row_newbcast:3 row_mask:0xf bank_mask:0xf
    v_and_b32_dpp v10, v48, v22 row_newbcast:3 row_mask:0xf bank_mask:0xf
    v_and_b32_dpp v11, v48, v23 row_newbcast:3 row_mask:0xf bank_mask:0xf
    s_waitcnt vmcnt(15)
    s_nop 0
    v_mfma_f32_16x16x32_bf16 v[12:15], v[112:115], v[8:11], v[12:15]
    buffer_load_dwordx4 v[112:115], v1, s[4:7], s32 offen offset:0 nt
    s_add_u32 s32, s32, 6144
    s_cmp_lg_u32 s27, 0
    s_cbranch_scc1 L_BV_d
    v_fma_f32 v49, v49, v61, -v6
    v_fma_f32 v50, v50, v61, -v6
    v_fma_f32 v51, v51, v61, -v6
    v_fma_f32 v52, v52, v61, -v6
    v_fma_f32 v53, v53, v61, -v6
    v_fma_f32 v54, v54, v61, -v6
    v_fma_f32 v55, v55, v61, -v6
    v_fma_f32 v56, v56, v61, -v6
    v_fma_f32 v57, v57, v61, -v6
    v_fma_f32 v58, v58, v61, -v6
    v_exp_f32 v49, v49
    v_exp_f32 v50, v50
    v_exp_f32 v51, v51
    v_exp_f32 v52, v52
    v_exp_f32 v53, v53
    v_exp_f32 v54, v54
    v_exp_f32 v55, v55
    v_exp_f32 v56, v56
    v_exp_f32 v57, v57
    v_exp_f32 v58, v58
    v_add_f32 v7, v7, v49
    v_add_f32 v7, v7, v50
    v_add_f32 v7, v7, v51
    v_add_f32 v7, v7, v52
    v_add_f32 v7, v7, v53
    v_add_f32 v7, v7, v54
    v_add_f32 v7, v7, v55
    v_add_f32 v7, v7, v56
    v_add_f32 v7, v7, v57
    v_add_f32 v7, v7, v58
    v_cvt_pk_bf16_f32 v49, v49, v49
    v_cvt_pk_bf16_f32 v50, v50, v50
    v_cvt_pk_bf16_f32 v51, v51, v51
    v_cvt_pk_bf16_f32 v52, v52, v52
    v_cvt_pk_bf16_f32 v53, v53, v53
    v_cvt_pk_bf16_f32 v54, v54, v54
    v_cvt_pk_bf16_f32 v55, v55, v55
    v_cvt_pk_bf16_f32 v56, v56, v56
    v_cvt_pk_bf16_f32 v57, v57, v57
    v_cvt_pk_bf16_f32 v58, v58, v58
    v_add_f32_dpp v7, v7, v7 row_ror:8 row_mask:0xf bank_mask:0xf
    s_nop 1
    v_add_f32_dpp v7, v7, v7 row_ror:4 row_mask:0xf bank_mask:0xf
    s_nop 1
    v_add_f32_dpp v7, v7, v7 row_ror:2 row_mask:0xf bank_mask:0xf
    s_nop 1
    v_add_f32_dpp v7, v7, v7 row_ror:1 row_mask:0xf bank_mask:0xf
    s_nop 1
    v_add_f32_dpp v7, v7, v7 row_bcast:15 row_mask:0xa bank_mask:0xf
    s_nop 1
    v_add_f32_dpp v7, v7, v7 row_bcast:31 row_mask:0xc bank_mask:0xf
    s_nop 0
    v_readlane_b32 s70, v7, 63
    s_lshl_b32 s25, s3, 4
    s_add_u32 s25, s25, s34
    s_mov_b64 exec, 1
    v_mov_b32 v7, s70
    s_cmp_eq_u32 s75, 0
    s_cbranch_scc0 L_B_mlf
    buffer_store_dwordx2 v[6:7], off, s[12:15], s25
    s_branch L_B_mld
L_B_mlf:
    buffer_store_dwordx2 v[6:7], off, s[12:15], s25 sc1
L_B_mld:
    s_mov_b64 exec, -1
L_BV_d:
    v_and_b32_dpp v8, v48, v20 row_newbcast:7 row_mask:0xf bank_mask:0xf
    v_and_b32_dpp v9, v48, v21 row_newbcast:7 row_mask:0xf bank_mask:0xf
    v_and_b32_dpp v10, v48, v22 row_newbcast:7 row_mask:0xf bank_mask:0xf
    v_and_b32_dpp v11, v48, v23 row_newbcast:7 row_mask:0xf bank_mask:0xf
    s_waitcnt vmcnt(15)
    s_nop 0
    v_mfma_f32_16x16x32_bf16 v[12:15], v[116:119], v[8:11], v[12:15]
    buffer_load_dwordx4 v[116:119], v1, s[4:7], s32 offen offset:0 nt
    s_add_u32 s32, s32, 6144
    v_and_b32_dpp v8, v48, v20 row_newbcast:11 row_mask:0xf bank_mask:0xf
    v_and_b32_dpp v9, v48, v21 row_newbcast:11 row_mask:0xf bank_mask:0xf
    v_and_b32_dpp v10, v48, v22 row_newbcast:11 row_mask:0xf bank_mask:0xf
    v_and_b32_dpp v11, v48, v23 row_newbcast:11 row_mask:0xf bank_mask:0xf
    s_waitcnt vmcnt(15)
    s_nop 0
    v_mfma_f32_16x16x32_bf16 v[12:15], v[120:123], v[8:11], v[12:15]
    buffer_load_dwordx4 v[120:123], v1, s[4:7], s32 offen offset:0 nt
    s_add_u32 s32, s32, 6144
    v_and_b32_dpp v8, v48, v20 row_newbcast:15 row_mask:0xf bank_mask:0xf
    v_and_b32_dpp v9, v48, v21 row_newbcast:15 row_mask:0xf bank_mask:0xf
    v_and_b32_dpp v10, v48, v22 row_newbcast:15 row_mask:0xf bank_mask:0xf
    v_and_b32_dpp v11, v48, v23 row_newbcast:15 row_mask:0xf bank_mask:0xf
    s_waitcnt vmcnt(15)
    s_nop 0
    v_mfma_f32_16x16x32_bf16 v[12:15], v[124:127], v[8:11], v[12:15]
    buffer_load_dwordx4 v[124:127], v1, s[4:7], s32 offen offset:0 nt
    s_add_u32 s32, s32, 6144
    v_mov_b32 v48, v49
    v_mov_b32 v49, v50
    v_mov_b32 v50, v51
    v_mov_b32 v51, v52
    v_mov_b32 v52, v53
    v_mov_b32 v53, v54
    v_mov_b32 v54, v55
    v_mov_b32 v55, v56
    v_mov_b32 v56, v57
    v_mov_b32 v57, v58
    s_add_u32 s27, s27, 1
    s_branch L_BV
L_BT:
    v_and_b32_dpp v8, v48, v20 row_newbcast:10 row_mask:0xf bank_mask:0xf
    v_and_b32_dpp v9, v48, v21 row_newbcast:10 row_mask:0xf bank_mask:0xf
    v_and_b32_dpp v10, v48, v22 row_newbcast:10 row_mask:0xf bank_mask:0xf
    v_and_b32_dpp v11, v48, v23 row_newbcast:10 row_mask:0xf bank_mask:0xf
    s_waitcnt vmcnt(15)
    s_nop 0
    v_mfma_f32_16x16x32_bf16 v[12:15], v[104:107], v[8:11], v[12:15]
    buffer_load_dwordx4 v[104:107], v1, s[4:7], s28 offen offset:0 nt
    v_and_b32_dpp v8, v48, v20 row_newbcast:14 row_mask:0xf bank_mask:0xf
    v_and_b32_dpp v9, v48, v21 row_newbcast:14 row_mask:0xf bank_mask:0xf
    v_and_b32_dpp v10, v48, v22 row_newbcast:14 row_mask:0xf bank_mask:0xf
    v_and_b32_dpp v11, v48, v23 row_newbcast:14 row_mask:0xf bank_mask:0xf
    s_waitcnt vmcnt(15)
    s_nop 0
    v_mfma_f32_16x16x32_bf16 v[12:15], v[108:111], v[8:11], v[12:15]
    v_and_b32_dpp v8, v48, v20 row_newbcast:3 row_mask:0xf bank_mask:0xf
    v_and_b32_dpp v9, v48, v21 row_newbcast:3 row_mask:0xf bank_mask:0xf
    v_and_b32_dpp v10, v48, v22 row_newbcast:3 row_mask:0xf bank_mask:0xf
    v_and_b32_dpp v11, v48, v23 row_newbcast:3 row_mask:0xf bank_mask:0xf
    s_waitcnt vmcnt(14)
    s_nop 0
    v_mfma_f32_16x16x32_bf16 v[12:15], v[112:115], v[8:11], v[12:15]
    v_and_b32_dpp v8, v48, v20 row_newbcast:7 row_mask:0xf bank_mask:0xf
    v_and_b32_dpp v9, v48, v21 row_newbcast:7 row_mask:0xf bank_mask:0xf
    v_and_b32_dpp v10, v48, v22 row_newbcast:7 row_mask:0xf bank_mask:0xf
    v_and_b32_dpp v11, v48, v23 row_newbcast:7 row_mask:0xf bank_mask:0xf
    s_waitcnt vmcnt(13)
    s_nop 0
    v_mfma_f32_16x16x32_bf16 v[12:15], v[116:119], v[8:11], v[12:15]
    v_and_b32_dpp v8, v48, v20 row_newbcast:11 row_mask:0xf bank_mask:0xf
    v_and_b32_dpp v9, v48, v21 row_newbcast:11 row_mask:0xf bank_mask:0xf
    v_and_b32_dpp v10, v48, v22 row_newbcast:11 row_mask:0xf bank_mask:0xf
    v_and_b32_dpp v11, v48, v23 row_newbcast:11 row_mask:0xf bank_mask:0xf
    s_waitcnt vmcnt(12)
    s_nop 0
    v_mfma_f32_16x16x32_bf16 v[12:15], v[120:123], v[8:11], v[12:15]
    v_and_b32_dpp v8, v48, v20 row_newbcast:15 row_mask:0xf bank_mask:0xf
    v_and_b32_dpp v9, v48, v21 row_newbcast:15 row_mask:0xf bank_mask:0xf
    v_and_b32_dpp v10, v48, v22 row_newbcast:15 row_mask:0xf bank_mask:0xf
    v_and_b32_dpp v11, v48, v23 row_newbcast:15 row_mask:0xf bank_mask:0xf
    s_waitcnt vmcnt(11)
    s_nop 0
    v_mfma_f32_16x16x32_bf16 v[12:15], v[124:127], v[8:11], v[12:15]
    v_and_b32_dpp v8, v49, v20 row_newbcast:0 row_mask:0xf bank_mask:0xf
    v_and_b32_dpp v9, v49, v21 row_newbcast:0 row_mask:0xf bank_mask:0xf
    v_and_b32_dpp v10, v49, v22 row_newbcast:0 row_mask:0xf bank_mask:0xf
    v_and_b32_dpp v11, v49, v23 row_newbcast:0 row_mask:0xf bank_mask:0xf
    s_waitcnt vmcnt(10)
    s_nop 0
    v_mfma_f32_16x16x32_bf16 v[12:15], v[64:67], v[8:11], v[12:15]
    v_and_b32_dpp v8, v49, v20 row_newbcast:4 row_mask:0xf bank_mask:0xf
    v_and_b32_dpp v9, v49, v21 row_newbcast:4 row_mask:0xf bank_mask:0xf
    v_and_b32_dpp v10, v49, v22 row_newbcast:4 row_mask:0xf bank_mask:0xf
    v_and_b32_dpp v11, v49, v23 row_newbcast:4 row_mask:0xf bank_mask:0xf
    s_waitcnt vmcnt(9)
    s_nop 0
    v_mfma_f32_16x16x32_bf16 v[12:15], v[68:71], v[8:11], v[12:15]
    v_and_b32_dpp v8, v49, v20 row_newbcast:8 row_mask:0xf bank_mask:0xf
    v_and_b32_dpp v9, v49, v21 row_newbcast:8 row_mask:0xf bank_mask:0xf
    v_and_b32_dpp v10, v49, v22 row_newbcast:8 row_mask:0xf bank_mask:0xf
    v_and_b32_dpp v11, v49, v23 row_newbcast:8 row_mask:0xf bank_mask:0xf
    s_waitcnt vmcnt(8)
    s_nop 0
    v_mfma_f32_16x16x32_bf16 v[12:15], v[72:75], v[8:11], v[12:15]
    v_and_b32_dpp v8, v49, v20 row_newbcast:12 row_mask:0xf bank_mask:0xf
    v_and_b32_dpp v9, v49, v21 row_newbcast:12 row_mask:0xf bank_mask:0xf
    v_and_b32_dpp v10, v49, v22 row_newbcast:12 row_mask:0xf bank_mask:0xf
    v_and_b32_dpp v11, v49, v23 row_newbcast:12 row_mask:0xf bank_mask:0xf
    s_waitcnt vmcnt(7)
    s_nop 0
    v_mfma_f32_16x16x32_bf16 v[12:15], v[76:79], v[8:11], v[12:15]
    v_and_b32_dpp v8, v49, v20 row_newbcast:1 row_mask:0xf bank_mask:0xf
    v_and_b32_dpp v9, v49, v21 row_newbcast:1 row_mask:0xf bank_mask:0xf
    v_and_b32_dpp v10, v49, v22 row_newbcast:1 row_mask:0xf bank_mask:0xf
    v_and_b32_dpp v11, v49, v23 row_newbcast:1 row_mask:0xf bank_mask:0xf
    s_waitcnt vmcnt(6)
    s_nop 0
    v_mfma_f32_16x16x32_bf16 v[12:15], v[80:83], v[8:11], v[12:15]
    v_and_b32_dpp v8, v49, v20 row_newbcast:5 row_mask:0xf bank_mask:0xf
    v_and_b32_dpp v9, v49, v21 row_newbcast:5 row_mask:0xf bank_mask:0xf
    v_and_b32_dpp v10, v49, v22 row_newbcast:5 row_mask:0xf bank_mask:0xf
    v_and_b32_dpp v11, v49, v23 row_newbcast:5 row_mask:0xf bank_mask:0xf
    s_waitcnt vmcnt(5)
    s_nop 0
    v_mfma_f32_16x16x32_bf16 v[12:15], v[84:87], v[8:11], v[12:15]
    v_and_b32_dpp v8, v49, v20 row_newbcast:9 row_mask:0xf bank_mask:0xf
    v_and_b32_dpp v9, v49, v21 row_newbcast:9 row_mask:0xf bank_mask:0xf
    v_and_b32_dpp v10, v49, v22 row_newbcast:9 row_mask:0xf bank_mask:0xf
    v_and_b32_dpp v11, v49, v23 row_newbcast:9 row_mask:0xf bank_mask:0xf
    s_waitcnt vmcnt(4)
    s_nop 0
    v_mfma_f32_16x16x32_bf16 v[12:15], v[88:91], v[8:11], v[12:15]
    v_and_b32_dpp v8, v49, v20 row_newbcast:13 row_mask:0xf bank_mask:0xf
    v_and_b32_dpp v9, v49, v21 row_newbcast:13 row_mask:0xf bank_mask:0xf
    v_and_b32_dpp v10, v49, v22 row_newbcast:13 row_mask:0xf bank_mask:0xf
    v_and_b32_dpp v11, v49, v23 row_newbcast:13 row_mask:0xf bank_mask:0xf
    s_waitcnt vmcnt(3)
    s_nop 0
    v_mfma_f32_16x16x32_bf16 v[12:15], v[92:95], v[8:11], v[12:15]
    v_and_b32_dpp v8, v49, v20 row_newbcast:2 row_mask:0xf bank_mask:0xf
    v_and_b32_dpp v9, v49, v21 row_newbcast:2 row_mask:0xf bank_mask:0xf
    v_and_b32_dpp v10, v49, v22 row_newbcast:2 row_mask:0xf bank_mask:0xf
    v_and_b32_dpp v11, v49, v23 row_newbcast:2 row_mask:0xf bank_mask:0xf
    s_waitcnt vmcnt(2)
    s_nop 0
    v_mfma_f32_16x16x32_bf16 v[12:15], v[96:99], v[8:11], v[12:15]
    v_and_b32_dpp v8, v49, v20 row_newbcast:6 row_mask:0xf bank_mask:0xf
    v_and_b32_dpp v9, v49, v21 row_newbcast:6 row_mask:0xf bank_mask:0xf
    v_and_b32_dpp v10, v49, v22 row_newbcast:6 row_mask:0xf bank_mask:0xf
    v_and_b32_dpp v11, v49, v23 row_newbcast:6 row_mask:0xf bank_mask:0xf
    s_waitcnt vmcnt(1)
    s_nop 0
    v_mfma_f32_16x16x32_bf16 v[12:15], v[100:103], v[8:11], v[12:15]
    v_and_b32_dpp v8, v49, v20 row_newbcast:10 row_mask:0xf bank_mask:0xf
    v_and_b32_dpp v9, v49, v21 row_newbcast:10 row_mask:0xf bank_mask:0xf
    v_and_b32_dpp v10, v49, v22 row_newbcast:10 row_mask:0xf bank_mask:0xf
    v_and_b32_dpp v11, v49, v23 row_newbcast:10 row_mask:0xf bank_mask:0xf
    s_waitcnt vmcnt(0)
    s_nop 0
    v_mfma_f32_16x16x32_bf16 v[12:15], v[104:107], v[8:11], v[12:15]
    s_mov_b32 exec_lo, 0x00ff00ff
    s_mov_b32 exec_hi, 0x00ff00ff
    s_cmp_eq_u32 s75, 0
    s_nop 4
    v_cvt_pk_bf16_f32 v4, v12, v13
    v_cvt_pk_bf16_f32 v5, v14, v15
    s_cbranch_scc0 L_BV_far
    buffer_store_dwordx2 v[4:5], v60, s[12:15], s73 offen
    s_branch L_BV_done
L_BV_far:
    buffer_store_dwordx2 v[4:5], v60, s[12:15], s73 offen sc1
L_BV_done:
    s_endpgm
L_A:
    v_lshrrev_b32 v1, 6, v0
    v_and_b32 v0, 63, v0
    v_readfirstlane_b32 s3, v1
    v_lshlrev_b32 v2, 4, v0
    s_getpc_b64 s[20:21]
L_pc3:
    s_sub_u32 s20, s20, L_pc3-L_A
    s_subb_u32 s21, s21, 0
    s_mov_b32 s22, L_A2-L_A
    s_mov_b32 s23, 0x20000
    v_lshl_add_u32 v3, v0, 2, s3
    v_lshlrev_b32 v3, 7, v3
    buffer_load_dword v17, v3, s[20:23], 0 offen
    s_mov_b32 s74, s2
    s_and_b32 s72, s2, 31
    s_and_b32 s25, s72, 7
    s_lshr_b32 s26, s72, 3
    s_mov_b32 s70, 0x5040100
    s_mov_b32 s71, 0xd0c0908
    s_lshl_b32 s25, s25, 3
    s_lshr_b64 s[70:71], s[70:71], s25
    s_lshl_b32 s26, s26, 3
    s_lshr_b32 s26, 0x12100200, s26
    s_or_b32 s26, s26, s70
    s_and_b32 s26, s26, 31
    v_lshrrev_b32 v3, 4, v0
    v_and_b32 v4, 15, v0
    v_lshlrev_b32 v18, 18, v3
    v_lshl_add_u32 v18, v4, 4, v18
    v_lshrrev_b32 v6, 3, v4
    v_lshlrev_b32 v6, 10, v6
    v_lshl_add_u32 v19, v3, 6, v6
    v_bfe_u32 v1, v0, 2, 2
    v_lshlrev_b32 v64, 18, v1
    v_lshl_add_u32 v64, v3, 6, v64
    v_and_b32 v4, 3, v0
    v_lshl_add_u32 v64, v4, 4, v64
    v_lshlrev_b32 v65, 9, v1
    v_lshl_add_u32 v65, v3, 7, v65
    v_lshl_add_u32 v65, v4, 5, v65
    v_add_u32 v65, 135168, v65
    v_lshlrev_b32 v66, 15, v1
    v_lshl_add_u32 v66, v3, 6, v66
    v_lshl_add_u32 v66, v4, 4, v66
    v_and_b32 v4, 15, v0
    v_lshlrev_b32 v67, 10, v3
    v_lshl_add_u32 v67, v4, 4, v67
    s_lshl_b32 s35, s3, 20
    s_lshl_b32 s24, s26, 8
    s_add_u32 s35, s35, s24
    s_waitcnt lgkmcnt(0)
    s_cmp_lt_u32 s74, 32
    s_cselect_b64 s[4:5], s[40:41], s[54:55]
    s_mov_b32 s6, 0x400000
    s_mov_b32 s7, 0x20000
    s_cselect_b64 s[20:21], s[36:37], s[48:49]
    s_mov_b32 s22, 4096
    s_mov_b32 s23, 0x20000
    s_cselect_b32 s75, 0x400000, 0
    s_lshl_b32 s24, s3, 8
    s_mov_b32 s32, s35
    buffer_load_dwordx4 v[12:15], v67, s[20:23], s24 offen
    buffer_load_dwordx4 v[128:131], v18, s[4:7], s32 offen
    s_add_u32 s32, s32, 8192
    buffer_load_dwordx4 v[132:135], v18, s[4:7], s32 offen
    s_add_u32 s32, s32, 8192
    buffer_load_dwordx4 v[136:139], v18, s[4:7], s32 offen
    s_add_u32 s32, s32, 8192
    buffer_load_dwordx4 v[140:143], v18, s[4:7], s32 offen
    s_add_u32 s32, s32, 8192
    buffer_load_dwordx4 v[144:147], v18, s[4:7], s32 offen
    s_add_u32 s32, s32, 8192
    buffer_load_dwordx4 v[148:151], v18, s[4:7], s32 offen
    s_add_u32 s32, s32, 8192
    buffer_load_dwordx4 v[152:155], v18, s[4:7], s32 offen
    s_add_u32 s32, s32, 8192
    buffer_load_dwordx4 v[156:159], v18, s[4:7], s32 offen
    s_add_u32 s32, s32, 8192
    buffer_load_dwordx4 v[160:163], v18, s[4:7], s32 offen
    s_add_u32 s32, s32, 8192
    buffer_load_dwordx4 v[164:167], v18, s[4:7], s32 offen
    s_add_u32 s32, s32, 8192
    buffer_load_dwordx4 v[168:171], v18, s[4:7], s32 offen
    s_add_u32 s32, s32, 8192
    buffer_load_dwordx4 v[172:175], v18, s[4:7], s32 offen
    s_add_u32 s32, s32, 8192
    buffer_load_dwordx4 v[176:179], v18, s[4:7], s32 offen
    s_add_u32 s32, s32, 8192
    buffer_load_dwordx4 v[180:183], v18, s[4:7], s32 offen
    s_add_u32 s32, s32, 8192
    buffer_load_dwordx4 v[184:187], v18, s[4:7], s32 offen
    s_add_u32 s32, s32, 8192
    buffer_load_dwordx4 v[188:191], v18, s[4:7], s32 offen
    s_add_u32 s32, s32, 8192
    s_mov_b32 s12, s62
    s_mov_b32 s13, s63
    s_mov_b32 s14, 0x400000
    s_mov_b32 s15, 0x20000
    s_mov_b32 s16, s60
    s_mov_b32 s17, s61
    s_mov_b32 s18, 0x100
    s_mov_b32 s19, 0x20000
    v_and_b32 v3, 1, v0
    v_lshlrev_b32 v3, 4, v3
    v_mov_b32 v4, 0xffff
    v_lshlrev_b32 v4, v3, v4
    v_bfe_u32 v3, v0, 1, 2
    v_cmp_eq_u32 vcc, 0, v3
    s_nop 1
    v_cndmask_b32 v20, 0, v4, vcc
    v_cmp_eq_u32 vcc, 1, v3
    s_nop 1
    v_cndmask_b32 v21, 0, v4, vcc
    v_cmp_eq_u32 vcc, 2, v3
    s_nop 1
    v_cndmask_b32 v22, 0, v4, vcc
    v_cmp_eq_u32 vcc, 3, v3
    s_nop 1
    v_cndmask_b32 v23, 0, v4, vcc
    v_mov_b32 v3, 0x0c0c0c0c
    s_mov_b32 s24, 0x01000100
    s_mov_b32 s25, 0x03020302
    v_bfi_b32 v24, v20, s24, v3
    v_bfi_b32 v28, v20, s25, v3
    v_bfi_b32 v25, v21, s24, v3
    v_bfi_b32 v29, v21, s25, v3
    v_bfi_b32 v26, v22, s24, v3
    v_bfi_b32 v30, v22, s25, v3
    v_bfi_b32 v27, v23, s24, v3
    v_bfi_b32 v31, v23, s25, v3
    s_mov_b32 s64, 0x22222222
    s_mov_b32 s65, 0x22222222
    s_mov_b32 s66, 0x44444444
    s_mov_b32 s67, 0x44444444
    s_mov_b32 s68, 0x88888888
    s_mov_b32 s69, 0x88888888
    s_lshl_b32 s24, s3, 8
    s_add_u32 s24, s24, 145408
    v_add_u32 v3, s24, v67
    v_add_u32 v4, s24, v19
    s_waitcnt vmcnt(16)
    ds_write_b128 v3, v[12:15]
    s_waitcnt lgkmcnt(0)
    ds_read_b128 v[32:35], v4 offset:0
    ds_read_b128 v[36:39], v4 offset:16
    ds_read_b128 v[40:43], v4 offset:32
    ds_read_b128 v[44:47], v4 offset:48
    ds_read_b128 v[48:51], v4 offset:2048
    ds_read_b128 v[52:55], v4 offset:2064
    ds_read_b128 v[56:59], v4 offset:2080
    ds_read_b128 v[60:63], v4 offset:2096
    s_waitcnt lgkmcnt(0)
    v_mov_b32 v76, -1
    v_mov_b32 v77, -1
    v_mov_b32 v78, -1
    v_mov_b32 v79, -1
    s_lshl_b32 s71, s72, 2
    s_add_u32 s71, s71, s3
    s_lshl_b32 s71, s71, 10
    s_add_u32 s71, s71, 0x1b0000
    s_cmp_lt_u32 s74, 32
    s_cselect_b32 s71, 0x400000, s71
    v_perm_b32 v8, v32, v32, v24
    v_perm_b32 v9, v32, v32, v25
    v_perm_b32 v10, v32, v32, v26
    v_perm_b32 v11, v32, v32, v27
    v_perm_b32 v4, v48, v48, v24
    v_perm_b32 v5, v48, v48, v25
    v_perm_b32 v6, v48, v48, v26
    v_perm_b32 v7, v48, v48, v27
    s_waitcnt vmcnt(15)
    v_mfma_f32_16x16x32_bf16 v[12:15], v[128:131], v[8:11], 0
    v_mfma_f32_16x16x32_bf16 v[68:71], v[128:131], v[4:7], 0
    buffer_load_dwordx4 v[192:195], v18, s[4:7], s32 offen nt
    s_add_u32 s32, s32, 8192
    v_perm_b32 v8, v32, v32, v28
    v_perm_b32 v9, v32, v32, v29
    v_perm_b32 v10, v32, v32, v30
    v_perm_b32 v11, v32, v32, v31
    v_perm_b32 v4, v48, v48, v28
    v_perm_b32 v5, v48, v48, v29
    v_perm_b32 v6, v48, v48, v30
    v_perm_b32 v7, v48, v48, v31
    s_waitcnt vmcnt(15)
    v_mfma_f32_16x16x32_bf16 v[12:15], v[132:135], v[8:11], v[12:15]
    v_mfma_f32_16x16x32_bf16 v[68:71], v[132:135], v[4:7], v[68:71]
    buffer_load_dwordx4 v[196:199], v18, s[4:7], s32 offen nt
    s_add_u32 s32, s32, 8192
    v_perm_b32 v8, v33, v33, v24
    v_perm_b32 v9, v33, v33, v25
    v_perm_b32 v10, v33, v33, v26
    v_perm_b32 v11, v33, v33, v27
    v_perm_b32 v4, v49, v49, v24
    v_perm_b32 v5, v49, v49, v25
    v_perm_b32 v6, v49, v49, v26
    v_perm_b32 v7, v49, v49, v27
    s_waitcnt vmcnt(15)
    v_mfma_f32_16x16x32_bf16 v[12:15], v[136:139], v[8:11], v[12:15]
    v_mfma_f32_16x16x32_bf16 v[68:71], v[136:139], v[4:7], v[68:71]
    buffer_load_dwordx4 v[200:203], v18, s[4:7], s32 offen nt
    s_add_u32 s32, s32, 8192
    v_perm_b32 v8, v33, v33, v28
    v_perm_b32 v9, v33, v33, v29
    v_perm_b32 v10, v33, v33, v30
    v_perm_b32 v11, v33, v33, v31
    v_perm_b32 v4, v49, v49, v28
    v_perm_b32 v5, v49, v49, v29
    v_perm_b32 v6, v49, v49, v30
    v_perm_b32 v7, v49, v49, v31
    s_waitcnt vmcnt(15)
    v_mfma_f32_16x16x32_bf16 v[12:15], v[140:143], v[8:11], v[12:15]
    v_mfma_f32_16x16x32_bf16 v[68:71], v[140:143], v[4:7], v[68:71]
    buffer_load_dwordx4 v[204:207], v18, s[4:7], s32 offen nt
    s_add_u32 s32, s32, 8192
    v_perm_b32 v8, v34, v34, v24
    v_perm_b32 v9, v34, v34, v25
    v_perm_b32 v10, v34, v34, v26
    v_perm_b32 v11, v34, v34, v27
    v_perm_b32 v4, v50, v50, v24
    v_perm_b32 v5, v50, v50, v25
    v_perm_b32 v6, v50, v50, v26
    v_perm_b32 v7, v50, v50, v27
    s_waitcnt vmcnt(15)
    v_mfma_f32_16x16x32_bf16 v[12:15], v[144:147], v[8:11], v[12:15]
    v_mfma_f32_16x16x32_bf16 v[68:71], v[144:147], v[4:7], v[68:71]
    buffer_load_dwordx4 v[208:211], v18, s[4:7], s32 offen nt
    s_add_u32 s32, s32, 8192
    v_perm_b32 v8, v34, v34, v28
    v_perm_b32 v9, v34, v34, v29
    v_perm_b32 v10, v34, v34, v30
    v_perm_b32 v11, v34, v34, v31
    v_perm_b32 v4, v50, v50, v28
    v_perm_b32 v5, v50, v50, v29
    v_perm_b32 v6, v50, v50, v30
    v_perm_b32 v7, v50, v50, v31
    s_waitcnt vmcnt(15)
    v_mfma_f32_16x16x32_bf16 v[12:15], v[148:151], v[8:11], v[12:15]
    v_mfma_f32_16x16x32_bf16 v[68:71], v[148:151], v[4:7], v[68:71]
    buffer_load_dwordx4 v[212:215], v18, s[4:7], s32 offen nt
    s_add_u32 s32, s32, 8192
    v_perm_b32 v8, v35, v35, v24
    v_perm_b32 v9, v35, v35, v25
    v_perm_b32 v10, v35, v35, v26
    v_perm_b32 v11, v35, v35, v27
    v_perm_b32 v4, v51, v51, v24
    v_perm_b32 v5, v51, v51, v25
    v_perm_b32 v6, v51, v51, v26
    v_perm_b32 v7, v51, v51, v27
    s_waitcnt vmcnt(15)
    v_mfma_f32_16x16x32_bf16 v[12:15], v[152:155], v[8:11], v[12:15]
    v_mfma_f32_16x16x32_bf16 v[68:71], v[152:155], v[4:7], v[68:71]
    buffer_load_dwordx4 v[216:219], v18, s[4:7], s32 offen nt
    s_add_u32 s32, s32, 8192
    v_perm_b32 v8, v35, v35, v28
    v_perm_b32 v9, v35, v35, v29
    v_perm_b32 v10, v35, v35, v30
    v_perm_b32 v11, v35, v35, v31
    v_perm_b32 v4, v51, v51, v28
    v_perm_b32 v5, v51, v51, v29
    v_perm_b32 v6, v51, v51, v30
    v_perm_b32 v7, v51, v51, v31
    s_waitcnt vmcnt(15)
    v_mfma_f32_16x16x32_bf16 v[12:15], v[156:159], v[8:11], v[12:15]
    v_mfma_f32_16x16x32_bf16 v[68:71], v[156:159], v[4:7], v[68:71]
    buffer_load_dwordx4 v[220:223], v18, s[4:7], s32 offen nt
    s_add_u32 s32, s32, 8192
    v_perm_b32 v8, v36, v36, v24
    v_perm_b32 v9, v36, v36, v25
    v_perm_b32 v10, v36, v36, v26
    v_perm_b32 v11, v36, v36, v27
    v_perm_b32 v4, v52, v52, v24
    v_perm_b32 v5, v52, v52, v25
    v_perm_b32 v6, v52, v52, v26
    v_perm_b32 v7, v52, v52, v27
    s_waitcnt vmcnt(15)
    v_mfma_f32_16x16x32_bf16 v[12:15], v[160:163], v[8:11], v[12:15]
    v_mfma_f32_16x16x32_bf16 v[68:71], v[160:163], v[4:7], v[68:71]
    buffer_load_dwordx4 v[224:227], v18, s[4:7], s32 offen nt
    s_add_u32 s32, s32, 8192
    v_perm_b32 v8, v36, v36, v28
    v_perm_b32 v9, v36, v36, v29
    v_perm_b32 v10, v36, v36, v30
    v_perm_b32 v11, v36, v36, v31
    v_perm_b32 v4, v52, v52, v28
    v_perm_b32 v5, v52, v52, v29
    v_perm_b32 v6, v52, v52, v30
    v_perm_b32 v7, v52, v52, v31
    s_waitcnt vmcnt(15)
    v_mfma_f32_16x16x32_bf16 v[12:15], v[164:167], v[8:11], v[12:15]
    v_mfma_f32_16x16x32_bf16 v[68:71], v[164:167], v[4:7], v[68:71]
    buffer_load_dwordx4 v[228:231], v18, s[4:7], s32 offen nt
    s_add_u32 s32, s32, 8192
    v_perm_b32 v8, v37, v37, v24
    v_perm_b32 v9, v37, v37, v25
    v_perm_b32 v10, v37, v37, v26
    v_perm_b32 v11, v37, v37, v27
    v_perm_b32 v4, v53, v53, v24
    v_perm_b32 v5, v53, v53, v25
    v_perm_b32 v6, v53, v53, v26
    v_perm_b32 v7, v53, v53, v27
    s_waitcnt vmcnt(15)
    v_mfma_f32_16x16x32_bf16 v[12:15], v[168:171], v[8:11], v[12:15]
    v_mfma_f32_16x16x32_bf16 v[68:71], v[168:171], v[4:7], v[68:71]
    buffer_load_dwordx4 v[232:235], v18, s[4:7], s32 offen nt
    s_add_u32 s32, s32, 8192
    v_perm_b32 v8, v37, v37, v28
    v_perm_b32 v9, v37, v37, v29
    v_perm_b32 v10, v37, v37, v30
    v_perm_b32 v11, v37, v37, v31
    v_perm_b32 v4, v53, v53, v28
    v_perm_b32 v5, v53, v53, v29
    v_perm_b32 v6, v53, v53, v30
    v_perm_b32 v7, v53, v53, v31
    s_waitcnt vmcnt(15)
    v_mfma_f32_16x16x32_bf16 v[12:15], v[172:175], v[8:11], v[12:15]
    v_mfma_f32_16x16x32_bf16 v[68:71], v[172:175], v[4:7], v[68:71]
    buffer_load_dwordx4 v[236:239], v18, s[4:7], s32 offen nt
    s_add_u32 s32, s32, 8192
    v_perm_b32 v8, v38, v38, v24
    v_perm_b32 v9, v38, v38, v25
    v_perm_b32 v10, v38, v38, v26
    v_perm_b32 v11, v38, v38, v27
    v_perm_b32 v4, v54, v54, v24
    v_perm_b32 v5, v54, v54, v25
    v_perm_b32 v6, v54, v54, v26
    v_perm_b32 v7, v54, v54, v27
    s_waitcnt vmcnt(15)
    v_mfma_f32_16x16x32_bf16 v[12:15], v[176:179], v[8:11], v[12:15]
    v_mfma_f32_16x16x32_bf16 v[68:71], v[176:179], v[4:7], v[68:71]
    buffer_load_dwordx4 v[240:243], v18, s[4:7], s32 offen nt
    s_add_u32 s32, s32, 8192
    v_perm_b32 v8, v38, v38, v28
    v_perm_b32 v9, v38, v38, v29
    v_perm_b32 v10, v38, v38, v30
    v_perm_b32 v11, v38, v38, v31
    v_perm_b32 v4, v54, v54, v28
    v_perm_b32 v5, v54, v54, v29
    v_perm_b32 v6, v54, v54, v30
    v_perm_b32 v7, v54, v54, v31
    s_waitcnt vmcnt(15)
    v_mfma_f32_16x16x32_bf16 v[12:15], v[180:183], v[8:11], v[12:15]
    v_mfma_f32_16x16x32_bf16 v[68:71], v[180:183], v[4:7], v[68:71]
    buffer_load_dwordx4 v[244:247], v18, s[4:7], s32 offen nt
    s_add_u32 s32, s32, 8192
    v_perm_b32 v8, v39, v39, v24
    v_perm_b32 v9, v39, v39, v25
    v_perm_b32 v10, v39, v39, v26
    v_perm_b32 v11, v39, v39, v27
    v_perm_b32 v4, v55, v55, v24
    v_perm_b32 v5, v55, v55, v25
    v_perm_b32 v6, v55, v55, v26
    v_perm_b32 v7, v55, v55, v27
    s_waitcnt vmcnt(15)
    v_mfma_f32_16x16x32_bf16 v[12:15], v[184:187], v[8:11], v[12:15]
    v_mfma_f32_16x16x32_bf16 v[68:71], v[184:187], v[4:7], v[68:71]
    buffer_load_dwordx4 v[248:251], v18, s[4:7], s32 offen nt
    s_add_u32 s32, s32, 8192
    v_perm_b32 v8, v39, v39, v28
    v_perm_b32 v9, v39, v39, v29
    v_perm_b32 v10, v39, v39, v30
    v_perm_b32 v11, v39, v39, v31
    v_perm_b32 v4, v55, v55, v28
    v_perm_b32 v5, v55, v55, v29
    v_perm_b32 v6, v55, v55, v30
    v_perm_b32 v7, v55, v55, v31
    s_waitcnt vmcnt(15)
    v_mfma_f32_16x16x32_bf16 v[12:15], v[188:191], v[8:11], v[12:15]
    v_mfma_f32_16x16x32_bf16 v[68:71], v[188:191], v[4:7], v[68:71]
    buffer_load_dwordx4 v[252:255], v18, s[4:7], s32 offen nt
    s_add_u32 s32, s32, 8192
    v_perm_b32 v8, v40, v40, v24
    v_perm_b32 v9, v40, v40, v25
    v_perm_b32 v10, v40, v40, v26
    v_perm_b32 v11, v40, v40, v27
    v_perm_b32 v4, v56, v56, v24
    v_perm_b32 v5, v56, v56, v25
    v_perm_b32 v6, v56, v56, v26
    v_perm_b32 v7, v56, v56, v27
    s_waitcnt vmcnt(15)
    v_mfma_f32_16x16x32_bf16 v[12:15], v[192:195], v[8:11], v[12:15]
    v_mfma_f32_16x16x32_bf16 v[68:71], v[192:195], v[4:7], v[68:71]
    s_lshl_b32 s73, s74, 7
    s_add_u32 s73, s73, 0x170000
    s_cmp_lg_u32 s3, 0
    s_cbranch_scc1 L_A_nofl
    s_mov_b64 exec, 1
    buffer_store_dwordx4 v[76:79], off, s[12:15], s73 sc1
    s_mov_b64 exec, -1
L_A_nofl:
    s_cmp_ge_u32 s71, 0x1d7000
    s_cselect_b32 s71, 0x400000, s71
    buffer_store_dwordx4 v[76:79], v2, s[12:15], s71 offen sc1
    s_add_u32 s71, s71, 0x20000
    s_cmp_ge_u32 s71, 0x1d7000
    s_cselect_b32 s71, 0x400000, s71
    buffer_store_dwordx4 v[76:79], v2, s[12:15], s71 offen sc1
    s_add_u32 s71, s71, 0x20000
    s_getpc_b64 s[20:21]
L_pc4:
    s_add_u32 s20, s20, L_A2-L_pc4
    s_addc_u32 s21, s21, 0
    s_mov_b32 s22, L_last-L_A2
    s_mov_b32 s23, 0x20000
    v_lshl_add_u32 v3, v0, 2, s3
    v_lshlrev_b32 v3, 7, v3
    buffer_load_dword v17, v3, s[20:23], 0 offen
    s_mov_b32 s4, s42
    s_mov_b32 s5, s43
    s_mov_b32 s6, s75
    s_mov_b32 s32, s35
    buffer_load_dwordx4 v[128:131], v64, s[4:7], s32 offen nt
    s_add_u32 s32, s32, 8192
    v_perm_b32 v8, v40, v40, v28
    v_perm_b32 v9, v40, v40, v29
    v_perm_b32 v10, v40, v40, v30
    v_perm_b32 v11, v40, v40, v31
    v_perm_b32 v4, v56, v56, v28
    v_perm_b32 v5, v56, v56, v29
    v_perm_b32 v6, v56, v56, v30
    v_perm_b32 v7, v56, v56, v31
    s_waitcnt vmcnt(15)
    v_mfma_f32_16x16x32_bf16 v[12:15], v[196:199], v[8:11], v[12:15]
    v_mfma_f32_16x16x32_bf16 v[68:71], v[196:199], v[4:7], v[68:71]
    buffer_load_dwordx4 v[132:135], v64, s[4:7], s32 offen nt
    s_add_u32 s32, s32, 8192
    v_perm_b32 v8, v41, v41, v24
    v_perm_b32 v9, v41, v41, v25
    v_perm_b32 v10, v41, v41, v26
    v_perm_b32 v11, v41, v41, v27
    v_perm_b32 v4, v57, v57, v24
    v_perm_b32 v5, v57, v57, v25
    v_perm_b32 v6, v57, v57, v26
    v_perm_b32 v7, v57, v57, v27
    s_waitcnt vmcnt(15)
    v_mfma_f32_16x16x32_bf16 v[12:15], v[200:203], v[8:11], v[12:15]
    v_mfma_f32_16x16x32_bf16 v[68:71], v[200:203], v[4:7], v[68:71]
    buffer_load_dwordx4 v[136:139], v64, s[4:7], s32 offen nt
    s_add_u32 s32, s32, 8192
    v_perm_b32 v8, v41, v41, v28
    v_perm_b32 v9, v41, v41, v29
    v_perm_b32 v10, v41, v41, v30
    v_perm_b32 v11, v41, v41, v31
    v_perm_b32 v4, v57, v57, v28
    v_perm_b32 v5, v57, v57, v29
    v_perm_b32 v6, v57, v57, v30
    v_perm_b32 v7, v57, v57, v31
    s_waitcnt vmcnt(15)
    v_mfma_f32_16x16x32_bf16 v[12:15], v[204:207], v[8:11], v[12:15]
    v_mfma_f32_16x16x32_bf16 v[68:71], v[204:207], v[4:7], v[68:71]
    buffer_load_dwordx4 v[140:143], v64, s[4:7], s32 offen nt
    s_add_u32 s32, s32, 8192
    v_perm_b32 v8, v42, v42, v24
    v_perm_b32 v9, v42, v42, v25
    v_perm_b32 v10, v42, v42, v26
    v_perm_b32 v11, v42, v42, v27
    v_perm_b32 v4, v58, v58, v24
    v_perm_b32 v5, v58, v58, v25
    v_perm_b32 v6, v58, v58, v26
    v_perm_b32 v7, v58, v58, v27
    s_waitcnt vmcnt(15)
    v_mfma_f32_16x16x32_bf16 v[12:15], v[208:211], v[8:11], v[12:15]
    v_mfma_f32_16x16x32_bf16 v[68:71], v[208:211], v[4:7], v[68:71]
    buffer_load_dwordx4 v[144:147], v64, s[4:7], s32 offen nt
    s_add_u32 s32, s32, 8192
    v_perm_b32 v8, v42, v42, v28
    v_perm_b32 v9, v42, v42, v29
    v_perm_b32 v10, v42, v42, v30
    v_perm_b32 v11, v42, v42, v31
    v_perm_b32 v4, v58, v58, v28
    v_perm_b32 v5, v58, v58, v29
    v_perm_b32 v6, v58, v58, v30
    v_perm_b32 v7, v58, v58, v31
    s_waitcnt vmcnt(15)
    v_mfma_f32_16x16x32_bf16 v[12:15], v[212:215], v[8:11], v[12:15]
    v_mfma_f32_16x16x32_bf16 v[68:71], v[212:215], v[4:7], v[68:71]
    buffer_load_dwordx4 v[148:151], v64, s[4:7], s32 offen nt
    s_add_u32 s32, s32, 8192
    v_perm_b32 v8, v43, v43, v24
    v_perm_b32 v9, v43, v43, v25
    v_perm_b32 v10, v43, v43, v26
    v_perm_b32 v11, v43, v43, v27
    v_perm_b32 v4, v59, v59, v24
    v_perm_b32 v5, v59, v59, v25
    v_perm_b32 v6, v59, v59, v26
    v_perm_b32 v7, v59, v59, v27
    s_waitcnt vmcnt(15)
    v_mfma_f32_16x16x32_bf16 v[12:15], v[216:219], v[8:11], v[12:15]
    v_mfma_f32_16x16x32_bf16 v[68:71], v[216:219], v[4:7], v[68:71]
    buffer_load_dwordx4 v[152:155], v64, s[4:7], s32 offen nt
    s_add_u32 s32, s32, 8192
    v_perm_b32 v8, v43, v43, v28
    v_perm_b32 v9, v43, v43, v29
    v_perm_b32 v10, v43, v43, v30
    v_perm_b32 v11, v43, v43, v31
    v_perm_b32 v4, v59, v59, v28
    v_perm_b32 v5, v59, v59, v29
    v_perm_b32 v6, v59, v59, v30
    v_perm_b32 v7, v59, v59, v31
    s_waitcnt vmcnt(15)
    v_mfma_f32_16x16x32_bf16 v[12:15], v[220:223], v[8:11], v[12:15]
    v_mfma_f32_16x16x32_bf16 v[68:71], v[220:223], v[4:7], v[68:71]
    buffer_load_dwordx4 v[156:159], v64, s[4:7], s32 offen nt
    s_add_u32 s32, s32, 8192
    v_perm_b32 v8, v44, v44, v24
    v_perm_b32 v9, v44, v44, v25
    v_perm_b32 v10, v44, v44, v26
    v_perm_b32 v11, v44, v44, v27
    v_perm_b32 v4, v60, v60, v24
    v_perm_b32 v5, v60, v60, v25
    v_perm_b32 v6, v60, v60, v26
    v_perm_b32 v7, v60, v60, v27
    s_waitcnt vmcnt(15)
    v_mfma_f32_16x16x32_bf16 v[12:15], v[224:227], v[8:11], v[12:15]
    v_mfma_f32_16x16x32_bf16 v[68:71], v[224:227], v[4:7], v[68:71]
    buffer_load_dwordx4 v[160:163], v64, s[4:7], s32 offen nt
    s_add_u32 s32, s32, 8192
    v_perm_b32 v8, v44, v44, v28
    v_perm_b32 v9, v44, v44, v29
    v_perm_b32 v10, v44, v44, v30
    v_perm_b32 v11, v44, v44, v31
    v_perm_b32 v4, v60, v60, v28
    v_perm_b32 v5, v60, v60, v29
    v_perm_b32 v6, v60, v60, v30
    v_perm_b32 v7, v60, v60, v31
    s_waitcnt vmcnt(15)
    v_mfma_f32_16x16x32_bf16 v[12:15], v[228:231], v[8:11], v[12:15]
    v_mfma_f32_16x16x32_bf16 v[68:71], v[228:231], v[4:7], v[68:71]
    buffer_load_dwordx4 v[164:167], v64, s[4:7], s32 offen nt
    s_add_u32 s32, s32, 8192
    v_perm_b32 v8, v45, v45, v24
    v_perm_b32 v9, v45, v45, v25
    v_perm_b32 v10, v45, v45, v26
    v_perm_b32 v11, v45, v45, v27
    v_perm_b32 v4, v61, v61, v24
    v_perm_b32 v5, v61, v61, v25
    v_perm_b32 v6, v61, v61, v26
    v_perm_b32 v7, v61, v61, v27
    s_waitcnt vmcnt(15)
    v_mfma_f32_16x16x32_bf16 v[12:15], v[232:235], v[8:11], v[12:15]
    v_mfma_f32_16x16x32_bf16 v[68:71], v[232:235], v[4:7], v[68:71]
    buffer_load_dwordx4 v[168:171], v64, s[4:7], s32 offen nt
    s_add_u32 s32, s32, 8192
    v_perm_b32 v8, v45, v45, v28
    v_perm_b32 v9, v45, v45, v29
    v_perm_b32 v10, v45, v45, v30
    v_perm_b32 v11, v45, v45, v31
    v_perm_b32 v4, v61, v61, v28
    v_perm_b32 v5, v61, v61, v29
    v_perm_b32 v6, v61, v61, v30
    v_perm_b32 v7, v61, v61, v31
    s_waitcnt vmcnt(15)
    v_mfma_f32_16x16x32_bf16 v[12:15], v[236:239], v[8:11], v[12:15]
    v_mfma_f32_16x16x32_bf16 v[68:71], v[236:239], v[4:7], v[68:71]
    buffer_load_dwordx4 v[172:175], v64, s[4:7], s32 offen nt
    s_add_u32 s32, s32, 8192
    v_perm_b32 v8, v46, v46, v24
    v_perm_b32 v9, v46, v46, v25
    v_perm_b32 v10, v46, v46, v26
    v_perm_b32 v11, v46, v46, v27
    v_perm_b32 v4, v62, v62, v24
    v_perm_b32 v5, v62, v62, v25
    v_perm_b32 v6, v62, v62, v26
    v_perm_b32 v7, v62, v62, v27
    s_waitcnt vmcnt(15)
    v_mfma_f32_16x16x32_bf16 v[12:15], v[240:243], v[8:11], v[12:15]
    v_mfma_f32_16x16x32_bf16 v[68:71], v[240:243], v[4:7], v[68:71]
    buffer_load_dwordx4 v[176:179], v64, s[4:7], s32 offen nt
    s_add_u32 s32, s32, 8192
    v_perm_b32 v8, v46, v46, v28
    v_perm_b32 v9, v46, v46, v29
    v_perm_b32 v10, v46, v46, v30
    v_perm_b32 v11, v46, v46, v31
    v_perm_b32 v4, v62, v62, v28
    v_perm_b32 v5, v62, v62, v29
    v_perm_b32 v6, v62, v62, v30
    v_perm_b32 v7, v62, v62, v31
    s_waitcnt vmcnt(15)
    v_mfma_f32_16x16x32_bf16 v[12:15], v[244:247], v[8:11], v[12:15]
    v_mfma_f32_16x16x32_bf16 v[68:71], v[244:247], v[4:7], v[68:71]
    buffer_load_dwordx4 v[180:183], v64, s[4:7], s32 offen nt
    s_add_u32 s32, s32, 8192
    v_perm_b32 v8, v47, v47, v24
    v_perm_b32 v9, v47, v47, v25
    v_perm_b32 v10, v47, v47, v26
    v_perm_b32 v11, v47, v47, v27
    v_perm_b32 v4, v63, v63, v24
    v_perm_b32 v5, v63, v63, v25
    v_perm_b32 v6, v63, v63, v26
    v_perm_b32 v7, v63, v63, v27
    s_waitcnt vmcnt(15)
    v_mfma_f32_16x16x32_bf16 v[12:15], v[248:251], v[8:11], v[12:15]
    v_mfma_f32_16x16x32_bf16 v[68:71], v[248:251], v[4:7], v[68:71]
    buffer_load_dwordx4 v[184:187], v64, s[4:7], s32 offen nt
    s_add_u32 s32, s32, 8192
    v_perm_b32 v8, v47, v47, v28
    v_perm_b32 v9, v47, v47, v29
    v_perm_b32 v10, v47, v47, v30
    v_perm_b32 v11, v47, v47, v31
    v_perm_b32 v4, v63, v63, v28
    v_perm_b32 v5, v63, v63, v29
    v_perm_b32 v6, v63, v63, v30
    v_perm_b32 v7, v63, v63, v31
    s_waitcnt vmcnt(15)
    v_mfma_f32_16x16x32_bf16 v[12:15], v[252:255], v[8:11], v[12:15]
    v_mfma_f32_16x16x32_bf16 v[68:71], v[252:255], v[4:7], v[68:71]
    buffer_load_dwordx4 v[188:191], v64, s[4:7], s32 offen nt
    s_add_u32 s32, s32, 8192
    v_lshrrev_b32 v3, 4, v0
    v_lshlrev_b32 v3, 7, v3
    v_and_b32 v4, 7, v0
    v_lshl_add_u32 v3, v4, 2, v3
    v_bfe_u32 v4, v0, 3, 1
    v_lshl_add_u32 v3, v4, 9, v3
    s_lshl_b32 s24, s3, 11
    s_add_u32 s24, s24, 135168
    v_add_u32 v3, s24, v3
    ds_write_b32 v3, v12 offset:0
    ds_write_b32 v3, v13 offset:32
    ds_write_b32 v3, v14 offset:64
    ds_write_b32 v3, v15 offset:96
    ds_write_b32 v3, v68 offset:1024
    ds_write_b32 v3, v69 offset:1056
    ds_write_b32 v3, v70 offset:1088
    ds_write_b32 v3, v71 offset:1120
    s_waitcnt lgkmcnt(0)
    s_barrier
    ds_read_b128 v[72:75], v65 offset:0
    ds_read_b128 v[76:79], v65 offset:16
    ds_read_b128 v[80:83], v65 offset:2048
    ds_read_b128 v[84:87], v65 offset:2064
    ds_read_b128 v[88:91], v65 offset:4096
    ds_read_b128 v[92:95], v65 offset:4112
    ds_read_b128 v[96:99], v65 offset:6144
    ds_read_b128 v[100:103], v65 offset:6160
    s_waitcnt lgkmcnt(4)
    v_add_f32 v72, v72, v80
    v_add_f32 v73, v73, v81
    v_add_f32 v74, v74, v82
    v_add_f32 v75, v75, v83
    v_add_f32 v76, v76, v84
    v_add_f32 v77, v77, v85
    v_add_f32 v78, v78, v86
    v_add_f32 v79, v79, v87
    s_waitcnt lgkmcnt(2)
    v_add_f32 v72, v72, v88
    v_add_f32 v73, v73, v89
    v_add_f32 v74, v74, v90
    v_add_f32 v75, v75, v91
    v_add_f32 v76, v76, v92
    v_add_f32 v77, v77, v93
    v_add_f32 v78, v78, v94
    v_add_f32 v79, v79, v95
    s_waitcnt lgkmcnt(0)
    v_add_f32 v72, v72, v96
    v_add_f32 v73, v73, v97
    v_add_f32 v74, v74, v98
    v_add_f32 v75, v75, v99
    v_add_f32 v76, v76, v100
    v_add_f32 v77, v77, v101
    v_add_f32 v78, v78, v102
    v_add_f32 v79, v79, v103
    v_cvt_pk_bf16_f32 v8, v72, v73
    v_cvt_pk_bf16_f32 v9, v74, v75
    v_cvt_pk_bf16_f32 v10, v76, v77
    v_cvt_pk_bf16_f32 v11, v78, v79
    s_cmp_ge_u32 s74, 32
    s_cbranch_scc1 L_C
L_A2:
    buffer_load_dwordx4 v[192:195], v64, s[4:7], s32 offen nt
    s_add_u32 s32, s32, 8192
    buffer_load_dwordx4 v[196:199], v64, s[4:7], s32 offen nt
    s_add_u32 s32, s32, 8192
    buffer_load_dwordx4 v[200:203], v64, s[4:7], s32 offen nt
    s_add_u32 s32, s32, 8192
    buffer_load_dwordx4 v[204:207], v64, s[4:7], s32 offen nt
    s_add_u32 s32, s32, 8192
    buffer_load_dwordx4 v[208:211], v64, s[4:7], s32 offen nt
    s_add_u32 s32, s32, 8192
    buffer_load_dwordx4 v[212:215], v64, s[4:7], s32 offen nt
    s_add_u32 s32, s32, 8192
    buffer_load_dwordx4 v[216:219], v64, s[4:7], s32 offen nt
    s_add_u32 s32, s32, 8192
    buffer_load_dwordx4 v[220:223], v64, s[4:7], s32 offen nt
    s_add_u32 s32, s32, 8192
    buffer_load_dwordx4 v[224:227], v64, s[4:7], s32 offen nt
    s_add_u32 s32, s32, 8192
    buffer_load_dwordx4 v[228:231], v64, s[4:7], s32 offen nt
    s_add_u32 s32, s32, 8192
    buffer_load_dwordx4 v[232:235], v64, s[4:7], s32 offen nt
    s_add_u32 s32, s32, 8192
    buffer_load_dwordx4 v[236:239], v64, s[4:7], s32 offen nt
    s_add_u32 s32, s32, 8192
    buffer_load_dwordx4 v[240:243], v64, s[4:7], s32 offen nt
    s_add_u32 s32, s32, 8192
    buffer_load_dwordx4 v[244:247], v64, s[4:7], s32 offen nt
    s_add_u32 s32, s32, 8192
    buffer_load_dwordx4 v[248:251], v64, s[4:7], s32 offen nt
    s_add_u32 s32, s32, 8192
    buffer_load_dwordx4 v[252:255], v64, s[4:7], s32 offen nt
    s_add_u32 s32, s32, 8192
    s_waitcnt vmcnt(31)
    v_mfma_f32_16x16x32_bf16 v[80:83], v[128:131], v[8:11], 0
    s_waitcnt vmcnt(30)
    v_mfma_f32_16x16x32_bf16 v[84:87], v[132:135], v[8:11], 0
    s_waitcnt vmcnt(29)
    v_mfma_f32_16x16x32_bf16 v[88:91], v[136:139], v[8:11], 0
    s_waitcnt vmcnt(28)
    v_mfma_f32_16x16x32_bf16 v[92:95], v[140:143], v[8:11], 0
    s_waitcnt vmcnt(27)
    v_mfma_f32_16x16x32_bf16 v[96:99], v[144:147], v[8:11], 0
    s_waitcnt vmcnt(26)
    v_mfma_f32_16x16x32_bf16 v[100:103], v[148:151], v[8:11], 0
    s_waitcnt vmcnt(25)
    v_mfma_f32_16x16x32_bf16 v[104:107], v[152:155], v[8:11], 0
    s_waitcnt vmcnt(24)
    v_mfma_f32_16x16x32_bf16 v[108:111], v[156:159], v[8:11], 0
    v_add_f32_dpp v72, v81, v80 quad_perm:[1,1,1,1] row_mask:0xf bank_mask:0xf
    v_add_f32_dpp v73, v85, v84 quad_perm:[1,1,1,1] row_mask:0xf bank_mask:0xf
    v_add_f32_dpp v74, v89, v88 quad_perm:[1,1,1,1] row_mask:0xf bank_mask:0xf
    v_add_f32_dpp v75, v93, v92 quad_perm:[1,1,1,1] row_mask:0xf bank_mask:0xf
    v_add_f32_dpp v76, v97, v96 quad_perm:[1,1,1,1] row_mask:0xf bank_mask:0xf
    v_add_f32_dpp v77, v101, v100 quad_perm:[1,1,1,1] row_mask:0xf bank_mask:0xf
    v_add_f32_dpp v78, v105, v104 quad_perm:[1,1,1,1] row_mask:0xf bank_mask:0xf
    s_nop 0
    v_add_f32_dpp v79, v109, v108 quad_perm:[1,1,1,1] row_mask:0xf bank_mask:0xf
    v_add_f32_dpp v72, v82, v72 quad_perm:[2,2,2,2] row_mask:0xf bank_mask:0xf
    v_add_f32_dpp v73, v86, v73 quad_perm:[2,2,2,2] row_mask:0xf bank_mask:0xf
    v_add_f32_dpp v74, v90, v74 quad_perm:[2,2,2,2] row_mask:0xf bank_mask:0xf
    v_add_f32_dpp v75, v94, v75 quad_perm:[2,2,2,2] row_mask:0xf bank_mask:0xf
    v_add_f32_dpp v76, v98, v76 quad_perm:[2,2,2,2] row_mask:0xf bank_mask:0xf
    v_add_f32_dpp v77, v102, v77 quad_perm:[2,2,2,2] row_mask:0xf bank_mask:0xf
    v_add_f32_dpp v78, v106, v78 quad_perm:[2,2,2,2] row_mask:0xf bank_mask:0xf
    v_add_f32_dpp v79, v110, v79 quad_perm:[2,2,2,2] row_mask:0xf bank_mask:0xf
    v_add_f32_dpp v72, v83, v72 quad_perm:[3,3,3,3] row_mask:0xf bank_mask:0xf
    v_add_f32_dpp v73, v87, v73 quad_perm:[3,3,3,3] row_mask:0xf bank_mask:0xf
    v_add_f32_dpp v74, v91, v74 quad_perm:[3,3,3,3] row_mask:0xf bank_mask:0xf
    v_add_f32_dpp v75, v95, v75 quad_perm:[3,3,3,3] row_mask:0xf bank_mask:0xf
    v_add_f32_dpp v76, v99, v76 quad_perm:[3,3,3,3] row_mask:0xf bank_mask:0xf
    v_add_f32_dpp v77, v103, v77 quad_perm:[3,3,3,3] row_mask:0xf bank_mask:0xf
    v_add_f32_dpp v78, v107, v78 quad_perm:[3,3,3,3] row_mask:0xf bank_mask:0xf
    v_add_f32_dpp v79, v111, v79 quad_perm:[3,3,3,3] row_mask:0xf bank_mask:0xf
    s_waitcnt vmcnt(23)
    v_mfma_f32_16x16x32_bf16 v[80:83], v[160:163], v[8:11], 0
    s_waitcnt vmcnt(22)
    v_mfma_f32_16x16x32_bf16 v[84:87], v[164:167], v[8:11], 0
    s_waitcnt vmcnt(21)
    v_mfma_f32_16x16x32_bf16 v[88:91], v[168:171], v[8:11], 0
    s_waitcnt vmcnt(20)
    v_mfma_f32_16x16x32_bf16 v[92:95], v[172:175], v[8:11], 0
    s_waitcnt vmcnt(19)
    v_mfma_f32_16x16x32_bf16 v[96:99], v[176:179], v[8:11], 0
    s_waitcnt vmcnt(18)
    v_mfma_f32_16x16x32_bf16 v[100:103], v[180:183], v[8:11], 0
    s_waitcnt vmcnt(17)
    v_mfma_f32_16x16x32_bf16 v[104:107], v[184:187], v[8:11], 0
    s_waitcnt vmcnt(16)
    v_mfma_f32_16x16x32_bf16 v[108:111], v[188:191], v[8:11], 0
    v_add_f32_dpp v112, v80, v81 quad_perm:[0,0,0,0] row_mask:0xf bank_mask:0xf
    v_add_f32_dpp v113, v84, v85 quad_perm:[0,0,0,0] row_mask:0xf bank_mask:0xf
    v_add_f32_dpp v114, v88, v89 quad_perm:[0,0,0,0] row_mask:0xf bank_mask:0xf
    v_add_f32_dpp v115, v92, v93 quad_perm:[0,0,0,0] row_mask:0xf bank_mask:0xf
    v_add_f32_dpp v116, v96, v97 quad_perm:[0,0,0,0] row_mask:0xf bank_mask:0xf
    v_add_f32_dpp v117, v100, v101 quad_perm:[0,0,0,0] row_mask:0xf bank_mask:0xf
    v_add_f32_dpp v118, v104, v105 quad_perm:[0,0,0,0] row_mask:0xf bank_mask:0xf
    s_nop 0
    v_add_f32_dpp v119, v108, v109 quad_perm:[0,0,0,0] row_mask:0xf bank_mask:0xf
    v_add_f32_dpp v112, v82, v112 quad_perm:[2,2,2,2] row_mask:0xf bank_mask:0xf
    v_add_f32_dpp v113, v86, v113 quad_perm:[2,2,2,2] row_mask:0xf bank_mask:0xf
    v_add_f32_dpp v114, v90, v114 quad_perm:[2,2,2,2] row_mask:0xf bank_mask:0xf
    v_add_f32_dpp v115, v94, v115 quad_perm:[2,2,2,2] row_mask:0xf bank_mask:0xf
    v_add_f32_dpp v116, v98, v116 quad_perm:[2,2,2,2] row_mask:0xf bank_mask:0xf
    v_add_f32_dpp v117, v102, v117 quad_perm:[2,2,2,2] row_mask:0xf bank_mask:0xf
    v_add_f32_dpp v118, v106, v118 quad_perm:[2,2,2,2] row_mask:0xf bank_mask:0xf
    v_add_f32_dpp v119, v110, v119 quad_perm:[2,2,2,2] row_mask:0xf bank_mask:0xf
    v_add_f32_dpp v112, v83, v112 quad_perm:[3,3,3,3] row_mask:0xf bank_mask:0xf
    v_add_f32_dpp v113, v87, v113 quad_perm:[3,3,3,3] row_mask:0xf bank_mask:0xf
    v_add_f32_dpp v114, v91, v114 quad_perm:[3,3,3,3] row_mask:0xf bank_mask:0xf
    v_add_f32_dpp v115, v95, v115 quad_perm:[3,3,3,3] row_mask:0xf bank_mask:0xf
    v_add_f32_dpp v116, v99, v116 quad_perm:[3,3,3,3] row_mask:0xf bank_mask:0xf
    v_add_f32_dpp v117, v103, v117 quad_perm:[3,3,3,3] row_mask:0xf bank_mask:0xf
    v_add_f32_dpp v118, v107, v118 quad_perm:[3,3,3,3] row_mask:0xf bank_mask:0xf
    v_add_f32_dpp v119, v111, v119 quad_perm:[3,3,3,3] row_mask:0xf bank_mask:0xf
    v_cndmask_b32 v72, v72, v112, s[64:65]
    v_cndmask_b32 v73, v73, v113, s[64:65]
    v_cndmask_b32 v74, v74, v114, s[64:65]
    v_cndmask_b32 v75, v75, v115, s[64:65]
    v_cndmask_b32 v76, v76, v116, s[64:65]
    v_cndmask_b32 v77, v77, v117, s[64:65]
    v_cndmask_b32 v78, v78, v118, s[64:65]
    v_cndmask_b32 v79, v79, v119, s[64:65]
    s_waitcnt vmcnt(15)
    v_mfma_f32_16x16x32_bf16 v[80:83], v[192:195], v[8:11], 0
    s_waitcnt vmcnt(14)
    v_mfma_f32_16x16x32_bf16 v[84:87], v[196:199], v[8:11], 0
    s_waitcnt vmcnt(13)
    v_mfma_f32_16x16x32_bf16 v[88:91], v[200:203], v[8:11], 0
    s_waitcnt vmcnt(12)
    v_mfma_f32_16x16x32_bf16 v[92:95], v[204:207], v[8:11], 0
    s_waitcnt vmcnt(11)
    v_mfma_f32_16x16x32_bf16 v[96:99], v[208:211], v[8:11], 0
    s_waitcnt vmcnt(10)
    v_mfma_f32_16x16x32_bf16 v[100:103], v[212:215], v[8:11], 0
    s_waitcnt vmcnt(9)
    v_mfma_f32_16x16x32_bf16 v[104:107], v[216:219], v[8:11], 0
    s_waitcnt vmcnt(8)
    v_mfma_f32_16x16x32_bf16 v[108:111], v[220:223], v[8:11], 0
    v_add_f32_dpp v112, v80, v82 quad_perm:[0,0,0,0] row_mask:0xf bank_mask:0xf
    v_add_f32_dpp v113, v84, v86 quad_perm:[0,0,0,0] row_mask:0xf bank_mask:0xf
    v_add_f32_dpp v114, v88, v90 quad_perm:[0,0,0,0] row_mask:0xf bank_mask:0xf
    v_add_f32_dpp v115, v92, v94 quad_perm:[0,0,0,0] row_mask:0xf bank_mask:0xf
    v_add_f32_dpp v116, v96, v98 quad_perm:[0,0,0,0] row_mask:0xf bank_mask:0xf
    v_add_f32_dpp v117, v100, v102 quad_perm:[0,0,0,0] row_mask:0xf bank_mask:0xf
    v_add_f32_dpp v118, v104, v106 quad_perm:[0,0,0,0] row_mask:0xf bank_mask:0xf
    s_nop 0
    v_add_f32_dpp v119, v108, v110 quad_perm:[0,0,0,0] row_mask:0xf bank_mask:0xf
    v_add_f32_dpp v112, v81, v112 quad_perm:[1,1,1,1] row_mask:0xf bank_mask:0xf
    v_add_f32_dpp v113, v85, v113 quad_perm:[1,1,1,1] row_mask:0xf bank_mask:0xf
    v_add_f32_dpp v114, v89, v114 quad_perm:[1,1,1,1] row_mask:0xf bank_mask:0xf
    v_add_f32_dpp v115, v93, v115 quad_perm:[1,1,1,1] row_mask:0xf bank_mask:0xf
    v_add_f32_dpp v116, v97, v116 quad_perm:[1,1,1,1] row_mask:0xf bank_mask:0xf
    v_add_f32_dpp v117, v101, v117 quad_perm:[1,1,1,1] row_mask:0xf bank_mask:0xf
    v_add_f32_dpp v118, v105, v118 quad_perm:[1,1,1,1] row_mask:0xf bank_mask:0xf
    v_add_f32_dpp v119, v109, v119 quad_perm:[1,1,1,1] row_mask:0xf bank_mask:0xf
    v_add_f32_dpp v112, v83, v112 quad_perm:[3,3,3,3] row_mask:0xf bank_mask:0xf
    v_add_f32_dpp v113, v87, v113 quad_perm:[3,3,3,3] row_mask:0xf bank_mask:0xf
    v_add_f32_dpp v114, v91, v114 quad_perm:[3,3,3,3] row_mask:0xf bank_mask:0xf
    v_add_f32_dpp v115, v95, v115 quad_perm:[3,3,3,3] row_mask:0xf bank_mask:0xf
    v_add_f32_dpp v116, v99, v116 quad_perm:[3,3,3,3] row_mask:0xf bank_mask:0xf
    v_add_f32_dpp v117, v103, v117 quad_perm:[3,3,3,3] row_mask:0xf bank_mask:0xf
    v_add_f32_dpp v118, v107, v118 quad_perm:[3,3,3,3] row_mask:0xf bank_mask:0xf
    v_add_f32_dpp v119, v111, v119 quad_perm:[3,3,3,3] row_mask:0xf bank_mask:0xf
    v_cndmask_b32 v72, v72, v112, s[66:67]
    v_cndmask_b32 v73, v73, v113, s[66:67]
    v_cndmask_b32 v74, v74, v114, s[66:67]
    v_cndmask_b32 v75, v75, v115, s[66:67]
    v_cndmask_b32 v76, v76, v116, s[66:67]
    v_cndmask_b32 v77, v77, v117, s[66:67]
    v_cndmask_b32 v78, v78, v118, s[66:67]
    v_cndmask_b32 v79, v79, v119, s[66:67]
    s_waitcnt vmcnt(7)
    v_mfma_f32_16x16x32_bf16 v[80:83], v[224:227], v[8:11], 0
    s_waitcnt vmcnt(6)
    v_mfma_f32_16x16x32_bf16 v[84:87], v[228:231], v[8:11], 0
    s_waitcnt vmcnt(5)
    v_mfma_f32_16x16x32_bf16 v[88:91], v[232:235], v[8:11], 0
    s_waitcnt vmcnt(4)
    v_mfma_f32_16x16x32_bf16 v[92:95], v[236:239], v[8:11], 0
    s_waitcnt vmcnt(3)
    v_mfma_f32_16x16x32_bf16 v[96:99], v[240:243], v[8:11], 0
    s_waitcnt vmcnt(2)
    v_mfma_f32_16x16x32_bf16 v[100:103], v[244:247], v[8:11], 0
    s_waitcnt vmcnt(1)
    v_mfma_f32_16x16x32_bf16 v[104:107], v[248:251], v[8:11], 0
    s_waitcnt vmcnt(0)
    v_mfma_f32_16x16x32_bf16 v[108:111], v[252:255], v[8:11], 0
    v_add_f32_dpp v112, v80, v83 quad_perm:[0,0,0,0] row_mask:0xf bank_mask:0xf
    v_add_f32_dpp v113, v84, v87 quad_perm:[0,0,0,0] row_mask:0xf bank_mask:0xf
    v_add_f32_dpp v114, v88, v91 quad_perm:[0,0,0,0] row_mask:0xf bank_mask:0xf
    v_add_f32_dpp v115, v92, v95 quad_perm:[0,0,0,0] row_mask:0xf bank_mask:0xf
    v_add_f32_dpp v116, v96, v99 quad_perm:[0,0,0,0] row_mask:0xf bank_mask:0xf
    v_add_f32_dpp v117, v100, v103 quad_perm:[0,0,0,0] row_mask:0xf bank_mask:0xf
    v_add_f32_dpp v118, v104, v107 quad_perm:[0,0,0,0] row_mask:0xf bank_mask:0xf
    s_nop 0
    v_add_f32_dpp v119, v108, v111 quad_perm:[0,0,0,0] row_mask:0xf bank_mask:0xf
    v_add_f32_dpp v112, v81, v112 quad_perm:[1,1,1,1] row_mask:0xf bank_mask:0xf
    v_add_f32_dpp v113, v85, v113 quad_perm:[1,1,1,1] row_mask:0xf bank_mask:0xf
    v_add_f32_dpp v114, v89, v114 quad_perm:[1,1,1,1] row_mask:0xf bank_mask:0xf
    v_add_f32_dpp v115, v93, v115 quad_perm:[1,1,1,1] row_mask:0xf bank_mask:0xf
    v_add_f32_dpp v116, v97, v116 quad_perm:[1,1,1,1] row_mask:0xf bank_mask:0xf
    v_add_f32_dpp v117, v101, v117 quad_perm:[1,1,1,1] row_mask:0xf bank_mask:0xf
    v_add_f32_dpp v118, v105, v118 quad_perm:[1,1,1,1] row_mask:0xf bank_mask:0xf
    v_add_f32_dpp v119, v109, v119 quad_perm:[1,1,1,1] row_mask:0xf bank_mask:0xf
    v_add_f32_dpp v112, v82, v112 quad_perm:[2,2,2,2] row_mask:0xf bank_mask:0xf
    v_add_f32_dpp v113, v86, v113 quad_perm:[2,2,2,2] row_mask:0xf bank_mask:0xf
    v_add_f32_dpp v114, v90, v114 quad_perm:[2,2,2,2] row_mask:0xf bank_mask:0xf
    v_add_f32_dpp v115, v94, v115 quad_perm:[2,2,2,2] row_mask:0xf bank_mask:0xf
    v_add_f32_dpp v116, v98, v116 quad_perm:[2,2,2,2] row_mask:0xf bank_mask:0xf
    v_add_f32_dpp v117, v102, v117 quad_perm:[2,2,2,2] row_mask:0xf bank_mask:0xf
    v_add_f32_dpp v118, v106, v118 quad_perm:[2,2,2,2] row_mask:0xf bank_mask:0xf
    v_add_f32_dpp v119, v110, v119 quad_perm:[2,2,2,2] row_mask:0xf bank_mask:0xf
    v_cndmask_b32 v72, v72, v112, s[68:69]
    v_cndmask_b32 v73, v73, v113, s[68:69]
    v_cndmask_b32 v74, v74, v114, s[68:69]
    v_cndmask_b32 v75, v75, v115, s[68:69]
    v_cndmask_b32 v76, v76, v116, s[68:69]
    v_cndmask_b32 v77, v77, v117, s[68:69]
    v_cndmask_b32 v78, v78, v118, s[68:69]
    v_cndmask_b32 v79, v79, v119, s[68:69]
    s_mov_b32 s71, 0x3e0293ee
    v_mul_f32 v72, s71, v72
    v_mul_f32 v73, s71, v73
    v_mul_f32 v74, s71, v74
    v_mul_f32 v75, s71, v75
    v_mul_f32 v76, s71, v76
    v_mul_f32 v77, s71, v77
    v_mul_f32 v78, s71, v78
    v_mul_f32 v79, s71, v79
    v_cvt_pk_bf16_f32 v4, v72, v73
    v_cvt_pk_bf16_f32 v5, v74, v75
    v_cvt_pk_bf16_f32 v6, v76, v77
    v_cvt_pk_bf16_f32 v7, v78, v79
    s_lshl_b32 s24, s26, 10
    s_lshl_b32 s25, s3, 8
    s_add_u32 s24, s24, s25
    s_add_u32 s24, s24, 0x0
    buffer_store_dwordx4 v[4:7], v66, s[12:15], s24 offen sc1
    s_mov_b32 s8, s56
    s_mov_b32 s9, s57
    s_mov_b32 s10, 0x400000
    s_mov_b32 s11, 0x20000
    s_lshl_b32 s24, s26, 17
    s_lshl_b32 s25, s3, 15
    s_add_u32 s24, s24, s25
    s_add_u32 s24, s24, 0
    v_lshrrev_b32 v3, 5, v0
    v_and_b32 v4, 0x1ff, v2
    v_lshl_add_u32 v3, v3, 13, v4
    s_mul_i32 m0, s3, 16896
    s_nop 0
    buffer_load_dwordx4 v3, s[8:11], s24 offen nt lds
    s_add_u32 m0, m0, 1056
    s_add_u32 s24, s24, 2048
    buffer_load_dwordx4 v3, s[8:11], s24 offen nt lds
    s_add_u32 m0, m0, 1056
    s_add_u32 s24, s24, 2048
    buffer_load_dwordx4 v3, s[8:11], s24 offen nt lds
    s_add_u32 m0, m0, 1056
    s_add_u32 s24, s24, 2048
    buffer_load_dwordx4 v3, s[8:11], s24 offen nt lds
    s_add_u32 m0, m0, 1056
    s_add_u32 s24, s24, 10240
    buffer_load_dwordx4 v3, s[8:11], s24 offen nt lds
    s_add_u32 m0, m0, 1056
    s_add_u32 s24, s24, 2048
    buffer_load_dwordx4 v3, s[8:11], s24 offen nt lds
    s_add_u32 m0, m0, 1056
    s_add_u32 s24, s24, 2048
    buffer_load_dwordx4 v3, s[8:11], s24 offen nt lds
    s_add_u32 m0, m0, 1056
    s_add_u32 s24, s24, 2048
    buffer_load_dwordx4 v3, s[8:11], s24 offen nt lds
    s_add_u32 m0, m0, 1056
    s_add_u32 s24, s24, -21504
    buffer_load_dwordx4 v3, s[8:11], s24 offen nt lds
    s_add_u32 m0, m0, 1056
    s_add_u32 s24, s24, 2048
    buffer_load_dwordx4 v3, s[8:11], s24 offen nt lds
    s_add_u32 m0, m0, 1056
    s_add_u32 s24, s24, 2048
    buffer_load_dwordx4 v3, s[8:11], s24 offen nt lds
    s_add_u32 m0, m0, 1056
    s_add_u32 s24, s24, 2048
    buffer_load_dwordx4 v3, s[8:11], s24 offen nt lds
    s_add_u32 m0, m0, 1056
    s_add_u32 s24, s24, 10240
    buffer_load_dwordx4 v3, s[8:11], s24 offen nt lds
    s_add_u32 m0, m0, 1056
    s_add_u32 s24, s24, 2048
    buffer_load_dwordx4 v3, s[8:11], s24 offen nt lds
    s_add_u32 m0, m0, 1056
    s_add_u32 s24, s24, 2048
    buffer_load_dwordx4 v3, s[8:11], s24 offen nt lds
    s_add_u32 m0, m0, 1056
    s_add_u32 s24, s24, 2048
    buffer_load_dwordx4 v3, s[8:11], s24 offen nt lds
    s_waitcnt vmcnt(0)
    s_barrier
    s_cmp_lg_u32 s3, 0
    s_cbranch_scc1 L_sig5
    s_mov_b64 exec, 1
    v_mov_b32 v3, 1
    buffer_atomic_add v3, off, s[16:19], 0 offset:0 sc0
    s_waitcnt vmcnt(0)
    v_readfirstlane_b32 s24, v3
    s_mov_b64 exec, -1
    s_and_b32 s24, s24, 63
    s_cmp_lg_u32 s24, 63
    s_cbranch_scc1 L_sig5
    v_lshlrev_b32 v4, 7, v0
    v_mov_b32 v3, 1
    s_mov_b32 s24, 0x170000
    buffer_store_dword v3, v4, s[12:15], s24 offen offset:0 sc1
L_sig5:
    v_lshrrev_b32 v3, 2, v0
    v_mul_u32_u24 v3, 1056, v3
    v_and_b32 v4, 3, v0
    v_lshl_add_u32 v3, v4, 3, v3
    s_lshl_b32 s24, s3, 7
    v_add_u32 v3, s24, v3
    ds_read_b64_tr_b16 a[128:129], v3 offset:0
    ds_read_b64_tr_b16 a[130:131], v3 offset:512
    ds_read_b64_tr_b16 a[144:145], v3 offset:32
    ds_read_b64_tr_b16 a[146:147], v3 offset:544
    ds_read_b64_tr_b16 a[160:161], v3 offset:64
    ds_read_b64_tr_b16 a[162:163], v3 offset:576
    ds_read_b64_tr_b16 a[176:177], v3 offset:96
    ds_read_b64_tr_b16 a[178:179], v3 offset:608
    ds_read_b64_tr_b16 a[132:133], v3 offset:16896
    ds_read_b64_tr_b16 a[134:135], v3 offset:17408
    ds_read_b64_tr_b16 a[148:149], v3 offset:16928
    ds_read_b64_tr_b16 a[150:151], v3 offset:17440
    ds_read_b64_tr_b16 a[164:165], v3 offset:16960
    ds_read_b64_tr_b16 a[166:167], v3 offset:17472
    ds_read_b64_tr_b16 a[180:181], v3 offset:16992
    ds_read_b64_tr_b16 a[182:183], v3 offset:17504
    ds_read_b64_tr_b16 a[136:137], v3 offset:33792
    ds_read_b64_tr_b16 a[138:139], v3 offset:34304
    ds_read_b64_tr_b16 a[152:153], v3 offset:33824
    ds_read_b64_tr_b16 a[154:155], v3 offset:34336
    ds_read_b64_tr_b16 a[168:169], v3 offset:33856
    ds_read_b64_tr_b16 a[170:171], v3 offset:34368
    ds_read_b64_tr_b16 a[184:185], v3 offset:33888
    ds_read_b64_tr_b16 a[186:187], v3 offset:34400
    ds_read_b64_tr_b16 a[140:141], v3 offset:50688
    ds_read_b64_tr_b16 a[142:143], v3 offset:51200
    ds_read_b64_tr_b16 a[156:157], v3 offset:50720
    ds_read_b64_tr_b16 a[158:159], v3 offset:51232
    ds_read_b64_tr_b16 a[172:173], v3 offset:50752
    ds_read_b64_tr_b16 a[174:175], v3 offset:51264
    ds_read_b64_tr_b16 a[188:189], v3 offset:50784
    ds_read_b64_tr_b16 a[190:191], v3 offset:51296
    s_mov_b32 s4, s44
    s_mov_b32 s5, s45
    s_mov_b32 s6, 0x400000
    s_mov_b32 s7, 0x20000
    s_mov_b32 s8, s46
    s_mov_b32 s9, s47
    s_mov_b32 s10, 0x400000
    s_mov_b32 s11, 0x20000
    s_mov_b32 s32, s35
    buffer_load_dwordx4 v[128:131], v18, s[4:7], s32 offen nt
    s_add_u32 s32, s32, 8192
    buffer_load_dwordx4 v[132:135], v18, s[4:7], s32 offen nt
    s_add_u32 s32, s32, 8192
    buffer_load_dwordx4 v[136:139], v18, s[4:7], s32 offen nt
    s_add_u32 s32, s32, 8192
    buffer_load_dwordx4 v[140:143], v18, s[4:7], s32 offen nt
    s_add_u32 s32, s32, 8192
    buffer_load_dwordx4 v[144:147], v18, s[4:7], s32 offen nt
    s_add_u32 s32, s32, 8192
    buffer_load_dwordx4 v[148:151], v18, s[4:7], s32 offen nt
    s_add_u32 s32, s32, 8192
    buffer_load_dwordx4 v[152:155], v18, s[4:7], s32 offen nt
    s_add_u32 s32, s32, 8192
    buffer_load_dwordx4 v[156:159], v18, s[4:7], s32 offen nt
    s_add_u32 s32, s32, 8192
    buffer_load_dwordx4 v[160:163], v18, s[4:7], s32 offen nt
    s_add_u32 s32, s32, 8192
    buffer_load_dwordx4 v[164:167], v18, s[4:7], s32 offen nt
    s_add_u32 s32, s32, 8192
    buffer_load_dwordx4 v[168:171], v18, s[4:7], s32 offen nt
    s_add_u32 s32, s32, 8192
    buffer_load_dwordx4 v[172:175], v18, s[4:7], s32 offen nt
    s_add_u32 s32, s32, 8192
    buffer_load_dwordx4 v[176:179], v18, s[4:7], s32 offen nt
    s_add_u32 s32, s32, 8192
    buffer_load_dwordx4 v[180:183], v18, s[4:7], s32 offen nt
    s_add_u32 s32, s32, 8192
    buffer_load_dwordx4 v[184:187], v18, s[4:7], s32 offen nt
    s_add_u32 s32, s32, 8192
    buffer_load_dwordx4 v[188:191], v18, s[4:7], s32 offen nt
    s_add_u32 s32, s32, 8192
    buffer_load_dwordx4 v[192:195], v18, s[4:7], s32 offen nt
    s_add_u32 s32, s32, 8192
    buffer_load_dwordx4 v[196:199], v18, s[4:7], s32 offen nt
    s_add_u32 s32, s32, 8192
    buffer_load_dwordx4 v[200:203], v18, s[4:7], s32 offen nt
    s_add_u32 s32, s32, 8192
    buffer_load_dwordx4 v[204:207], v18, s[4:7], s32 offen nt
    s_add_u32 s32, s32, 8192
    buffer_load_dwordx4 v[208:211], v18, s[4:7], s32 offen nt
    s_add_u32 s32, s32, 8192
    buffer_load_dwordx4 v[212:215], v18, s[4:7], s32 offen nt
    s_add_u32 s32, s32, 8192
    buffer_load_dwordx4 v[216:219], v18, s[4:7], s32 offen nt
    s_add_u32 s32, s32, 8192
    buffer_load_dwordx4 v[220:223], v18, s[4:7], s32 offen nt
    s_add_u32 s32, s32, 8192
    buffer_load_dwordx4 v[224:227], v18, s[4:7], s32 offen nt
    s_add_u32 s32, s32, 8192
    buffer_load_dwordx4 v[228:231], v18, s[4:7], s32 offen nt
    s_add_u32 s32, s32, 8192
    buffer_load_dwordx4 v[232:235], v18, s[4:7], s32 offen nt
    s_add_u32 s32, s32, 8192
    buffer_load_dwordx4 v[236:239], v18, s[4:7], s32 offen nt
    s_add_u32 s32, s32, 8192
    buffer_load_dwordx4 v[240:243], v18, s[4:7], s32 offen nt
    s_add_u32 s32, s32, 8192
    buffer_load_dwordx4 v[244:247], v18, s[4:7], s32 offen nt
    s_add_u32 s32, s32, 8192
    buffer_load_dwordx4 v[248:251], v18, s[4:7], s32 offen nt
    s_add_u32 s32, s32, 8192
    buffer_load_dwordx4 v[252:255], v18, s[4:7], s32 offen nt
    s_add_u32 s32, s32, 8192
    s_lshl_b32 s33, s26, 17
    s_lshl_b32 s24, s3, 15
    s_add_u32 s33, s33, s24
    s_mul_i32 s34, s3, 33792
    s_waitcnt lgkmcnt(0)
    s_barrier
    s_mov_b32 s70, 0
L_woA:
    s_and_b32 s24, s70, 3
    s_lshl_b32 s24, s24, 1
    s_lshr_b32 s25, s70, 2
    s_or_b32 s24, s24, s25
    s_lshl_b32 s24, s24, 10
    s_add_u32 s24, s24, s33
    s_mul_i32 s25, s70, 4224
    s_add_u32 m0, s25, s34
    s_waitcnt vmcnt(24)
    buffer_load_dwordx4 v2, s[8:11], s24 offen nt lds
    s_add_u32 m0, m0, 1056
    s_add_u32 s24, s24, 8192
    s_waitcnt vmcnt(24)
    buffer_load_dwordx4 v2, s[8:11], s24 offen nt lds
    s_add_u32 m0, m0, 1056
    s_add_u32 s24, s24, 8192
    s_waitcnt vmcnt(24)
    buffer_load_dwordx4 v2, s[8:11], s24 offen nt lds
    s_add_u32 m0, m0, 1056
    s_add_u32 s24, s24, 8192
    s_waitcnt vmcnt(24)
    buffer_load_dwordx4 v2, s[8:11], s24 offen nt lds
    s_add_u32 s70, s70, 1
    s_cmp_lt_u32 s70, 8
    s_cbranch_scc1 L_woA
    s_waitcnt vmcnt(0)
    s_barrier
    v_lshrrev_b32 v3, 2, v0
    v_mul_u32_u24 v3, 1056, v3
    v_and_b32 v4, 3, v0
    v_lshl_add_u32 v3, v4, 3, v3
    s_mul_i32 s24, s3, 256
    s_add_u32 s24, s24, 0
    v_add_u32 v3, s24, v3
    v_add_u32 v4, 67584, v3
    ds_read_b64_tr_b16 a[0:1], v3 offset:0
    ds_read_b64_tr_b16 a[2:3], v3 offset:16896
    ds_read_b64_tr_b16 a[4:5], v3 offset:33792
    ds_read_b64_tr_b16 a[6:7], v3 offset:50688
    ds_read_b64_tr_b16 a[8:9], v4 offset:0
    ds_read_b64_tr_b16 a[10:11], v4 offset:16896
    ds_read_b64_tr_b16 a[12:13], v4 offset:33792
    ds_read_b64_tr_b16 a[14:15], v4 offset:50688
    ds_read_b64_tr_b16 a[16:17], v3 offset:32
    ds_read_b64_tr_b16 a[18:19], v3 offset:16928
    ds_read_b64_tr_b16 a[20:21], v3 offset:33824
    ds_read_b64_tr_b16 a[22:23], v3 offset:50720
    ds_read_b64_tr_b16 a[24:25], v4 offset:32
    ds_read_b64_tr_b16 a[26:27], v4 offset:16928
    ds_read_b64_tr_b16 a[28:29], v4 offset:33824
    ds_read_b64_tr_b16 a[30:31], v4 offset:50720
    ds_read_b64_tr_b16 a[32:33], v3 offset:64
    ds_read_b64_tr_b16 a[34:35], v3 offset:16960
    ds_read_b64_tr_b16 a[36:37], v3 offset:33856
    ds_read_b64_tr_b16 a[38:39], v3 offset:50752
    ds_read_b64_tr_b16 a[40:41], v4 offset:64
    ds_read_b64_tr_b16 a[42:43], v4 offset:16960
    ds_read_b64_tr_b16 a[44:45], v4 offset:33856
    ds_read_b64_tr_b16 a[46:47], v4 offset:50752
    ds_read_b64_tr_b16 a[48:49], v3 offset:96
    ds_read_b64_tr_b16 a[50:51], v3 offset:16992
    ds_read_b64_tr_b16 a[52:53], v3 offset:33888
    ds_read_b64_tr_b16 a[54:55], v3 offset:50784
    ds_read_b64_tr_b16 a[56:57], v4 offset:96
    ds_read_b64_tr_b16 a[58:59], v4 offset:16992
    ds_read_b64_tr_b16 a[60:61], v4 offset:33888
    ds_read_b64_tr_b16 a[62:63], v4 offset:50784
    ds_read_b64_tr_b16 a[64:65], v3 offset:128
    ds_read_b64_tr_b16 a[66:67], v3 offset:17024
    ds_read_b64_tr_b16 a[68:69], v3 offset:33920
    ds_read_b64_tr_b16 a[70:71], v3 offset:50816
    ds_read_b64_tr_b16 a[72:73], v4 offset:128
    ds_read_b64_tr_b16 a[74:75], v4 offset:17024
    ds_read_b64_tr_b16 a[76:77], v4 offset:33920
    ds_read_b64_tr_b16 a[78:79], v4 offset:50816
    ds_read_b64_tr_b16 a[80:81], v3 offset:160
    ds_read_b64_tr_b16 a[82:83], v3 offset:17056
    ds_read_b64_tr_b16 a[84:85], v3 offset:33952
    ds_read_b64_tr_b16 a[86:87], v3 offset:50848
    ds_read_b64_tr_b16 a[88:89], v4 offset:160
    ds_read_b64_tr_b16 a[90:91], v4 offset:17056
    ds_read_b64_tr_b16 a[92:93], v4 offset:33952
    ds_read_b64_tr_b16 a[94:95], v4 offset:50848
    ds_read_b64_tr_b16 a[96:97], v3 offset:192
    ds_read_b64_tr_b16 a[98:99], v3 offset:17088
    ds_read_b64_tr_b16 a[100:101], v3 offset:33984
    ds_read_b64_tr_b16 a[102:103], v3 offset:50880
    ds_read_b64_tr_b16 a[104:105], v4 offset:192
    ds_read_b64_tr_b16 a[106:107], v4 offset:17088
    ds_read_b64_tr_b16 a[108:109], v4 offset:33984
    ds_read_b64_tr_b16 a[110:111], v4 offset:50880
    ds_read_b64_tr_b16 a[112:113], v3 offset:224
    ds_read_b64_tr_b16 a[114:115], v3 offset:17120
    ds_read_b64_tr_b16 a[116:117], v3 offset:34016
    ds_read_b64_tr_b16 a[118:119], v3 offset:50912
    ds_read_b64_tr_b16 a[120:121], v4 offset:224
    ds_read_b64_tr_b16 a[122:123], v4 offset:17120
    ds_read_b64_tr_b16 a[124:125], v4 offset:34016
    ds_read_b64_tr_b16 a[126:127], v4 offset:50912
    s_waitcnt lgkmcnt(0)
    s_cmp_lg_u32 s3, 0
    s_cbranch_scc1 L_awx6
    s_mov_b32 s24, 262144
    s_mov_b64 exec, 1
L_aw7:
    buffer_load_dword v1, off, s[12:15], s73 offset:0 sc1
    s_waitcnt vmcnt(0)
    v_readfirstlane_b32 s25, v1
    s_nop 0
    s_cmp_eq_u32 s25, 1
    s_cbranch_scc1 L_awx6
    s_sleep 4
    s_sub_u32 s24, s24, 1
    s_cmp_lg_u32 s24, 0
    s_cbranch_scc1 L_aw7
L_awx6:
    s_mov_b64 exec, -1
    s_barrier
    s_cmp_lg_u32 s3, 0
    s_cbranch_scc1 L_xi8
    s_getreg_b32 s25, hwreg(HW_REG_XCC_ID, 0, 4)
    s_lshl_b32 s24, s26, 7
    s_add_u32 s24, s24, 0x1b6000
    s_mov_b64 exec, 1
    v_mov_b32 v3, s25
    buffer_store_dword v3, off, s[12:15], s24 offset:0 sc1
    s_mov_b64 exec, -1
L_xi8:
    s_cmp_lg_u32 s3, 0
    s_cbranch_scc1 L_awx9
    s_mov_b32 s24, 262144
    s_mov_b64 exec, 1
L_aw10:
    buffer_load_dword v1, off, s[12:15], s73 offset:4 sc1
    s_waitcnt vmcnt(0)
    v_readfirstlane_b32 s25, v1
    s_nop 0
    s_cmp_eq_u32 s25, 1
    s_cbranch_scc1 L_awx9
    s_sleep 4
    s_sub_u32 s24, s24, 1
    s_cmp_lg_u32 s24, 0
    s_cbranch_scc1 L_aw10
L_awx9:
    s_mov_b64 exec, -1
    s_barrier
    s_lshl_b32 s24, s3, 10
    s_lshl_b32 s25, s26, 3
    s_add_u32 s25, s25, s24
    s_add_u32 s25, s25, 0x120000
    s_lshl_b32 s24, s26, 2
    s_add_u32 s24, s24, s3
    v_and_b32 v3, 3, v0
    v_lshlrev_b32 v3, 8, v3
    buffer_load_dwordx2 v[4:5], v3, s[12:15], s25 offen sc1
    s_lshl_b32 s24, s3, 17
    s_lshl_b32 s25, s26, 10
    s_add_u32 s24, s24, s25
    s_add_u32 s24, s24, 0x20000
    buffer_load_dwordx4 v[72:75], v2, s[12:15], s24 offen sc1
    s_add_u32 s24, s24, 0x8000
    buffer_load_dwordx4 v[76:79], v2, s[12:15], s24 offen sc1
    s_add_u32 s24, s24, 0x8000
    buffer_load_dwordx4 v[80:83], v2, s[12:15], s24 offen sc1
    s_add_u32 s24, s24, 0x8000
    buffer_load_dwordx4 v[84:87], v2, s[12:15], s24 offen sc1
    s_add_u32 s24, s24, 0x8000
    s_waitcnt vmcnt(4)
    v_mov_b32 v6, v4
    s_nop 1
    v_max_f32_dpp v6, v6, v6 row_ror:2 row_mask:0xf bank_mask:0xf
    s_nop 1
    v_max_f32_dpp v6, v6, v6 row_ror:1 row_mask:0xf bank_mask:0xf
    v_sub_f32 v4, v4, v6
    v_exp_f32 v4, v4
    s_nop 0
    v_mul_f32 v5, v4, v5
    s_nop 1
    v_add_f32_dpp v5, v5, v5 row_ror:2 row_mask:0xf bank_mask:0xf
    s_nop 1
    v_add_f32_dpp v5, v5, v5 row_ror:1 row_mask:0xf bank_mask:0xf
    v_rcp_f32 v5, v5
    s_nop 0
    v_mul_f32 v4, v4, v5
    s_nop 0
    v_readlane_b32 s24, v4, 0
    s_waitcnt vmcnt(3)
    v_lshlrev_b32 v5, 16, v72
    v_and_b32 v6, 0xffff0000, v72
    v_mul_f32 v104, s24, v5
    v_mul_f32 v105, s24, v6
    v_lshlrev_b32 v5, 16, v73
    v_and_b32 v6, 0xffff0000, v73
    v_mul_f32 v106, s24, v5
    v_mul_f32 v107, s24, v6
    v_lshlrev_b32 v5, 16, v74
    v_and_b32 v6, 0xffff0000, v74
    v_mul_f32 v108, s24, v5
    v_mul_f32 v109, s24, v6
    v_lshlrev_b32 v5, 16, v75
    v_and_b32 v6, 0xffff0000, v75
    v_mul_f32 v110, s24, v5
    v_mul_f32 v111, s24, v6
    v_readlane_b32 s24, v4, 1
    s_waitcnt vmcnt(2)
    v_lshlrev_b32 v5, 16, v76
    v_and_b32 v6, 0xffff0000, v76
    v_fmac_f32 v104, s24, v5
    v_fmac_f32 v105, s24, v6
    v_lshlrev_b32 v5, 16, v77
    v_and_b32 v6, 0xffff0000, v77
    v_fmac_f32 v106, s24, v5
    v_fmac_f32 v107, s24, v6
    v_lshlrev_b32 v5, 16, v78
    v_and_b32 v6, 0xffff0000, v78
    v_fmac_f32 v108, s24, v5
    v_fmac_f32 v109, s24, v6
    v_lshlrev_b32 v5, 16, v79
    v_and_b32 v6, 0xffff0000, v79
    v_fmac_f32 v110, s24, v5
    v_fmac_f32 v111, s24, v6
    v_readlane_b32 s24, v4, 2
    s_waitcnt vmcnt(1)
    v_lshlrev_b32 v5, 16, v80
    v_and_b32 v6, 0xffff0000, v80
    v_fmac_f32 v104, s24, v5
    v_fmac_f32 v105, s24, v6
    v_lshlrev_b32 v5, 16, v81
    v_and_b32 v6, 0xffff0000, v81
    v_fmac_f32 v106, s24, v5
    v_fmac_f32 v107, s24, v6
    v_lshlrev_b32 v5, 16, v82
    v_and_b32 v6, 0xffff0000, v82
    v_fmac_f32 v108, s24, v5
    v_fmac_f32 v109, s24, v6
    v_lshlrev_b32 v5, 16, v83
    v_and_b32 v6, 0xffff0000, v83
    v_fmac_f32 v110, s24, v5
    v_fmac_f32 v111, s24, v6
    v_readlane_b32 s24, v4, 3
    s_waitcnt vmcnt(0)
    v_lshlrev_b32 v5, 16, v84
    v_and_b32 v6, 0xffff0000, v84
    v_fmac_f32 v104, s24, v5
    v_fmac_f32 v105, s24, v6
    v_lshlrev_b32 v5, 16, v85
    v_and_b32 v6, 0xffff0000, v85
    v_fmac_f32 v106, s24, v5
    v_fmac_f32 v107, s24, v6
    v_lshlrev_b32 v5, 16, v86
    v_and_b32 v6, 0xffff0000, v86
    v_fmac_f32 v108, s24, v5
    v_fmac_f32 v109, s24, v6
    v_lshlrev_b32 v5, 16, v87
    v_and_b32 v6, 0xffff0000, v87
    v_fmac_f32 v110, s24, v5
    v_fmac_f32 v111, s24, v6
    v_cvt_pk_bf16_f32 v4, v104, v105
    v_cvt_pk_bf16_f32 v5, v106, v107
    v_cvt_pk_bf16_f32 v6, v108, v109
    v_cvt_pk_bf16_f32 v7, v110, v111
    s_lshl_b32 s24, s3, 10
    s_add_u32 s24, s24, 145408
    v_add_u32 v3, s24, v2
    ds_write_b128 v3, v[4:7]
    s_lshl_b32 s24, s3, 8
    s_add_u32 s24, s24, 145408
    v_add_u32 v3, s24, v19
    s_waitcnt lgkmcnt(0)
    s_barrier
    ds_read_b128 v[32:35], v3 offset:0
    ds_read_b128 v[36:39], v3 offset:16
    ds_read_b128 v[40:43], v3 offset:32
    ds_read_b128 v[44:47], v3 offset:48
    ds_read_b128 v[48:51], v3 offset:2048
    ds_read_b128 v[52:55], v3 offset:2064
    ds_read_b128 v[56:59], v3 offset:2080
    ds_read_b128 v[60:63], v3 offset:2096
    s_waitcnt lgkmcnt(0)
    v_perm_b32 v8, v32, v32, v24
    v_perm_b32 v9, v32, v32, v25
    v_perm_b32 v10, v32, v32, v26
    v_perm_b32 v11, v32, v32, v27
    v_perm_b32 v4, v48, v48, v24
    v_perm_b32 v5, v48, v48, v25
    v_perm_b32 v6, v48, v48, v26
    v_perm_b32 v7, v48, v48, v27
    v_mfma_f32_16x16x32_bf16 v[12:15], v[128:131], v[8:11], 0
    s_nop 0
    v_mfma_f32_16x16x32_bf16 v[68:71], v[128:131], v[4:7], 0
    v_perm_b32 v8, v32, v32, v28
    v_perm_b32 v9, v32, v32, v29
    v_perm_b32 v10, v32, v32, v30
    v_perm_b32 v11, v32, v32, v31
    v_perm_b32 v4, v48, v48, v28
    v_perm_b32 v5, v48, v48, v29
    v_perm_b32 v6, v48, v48, v30
    v_perm_b32 v7, v48, v48, v31
    v_mfma_f32_16x16x32_bf16 v[12:15], v[132:135], v[8:11], v[12:15]
    s_nop 0
    v_mfma_f32_16x16x32_bf16 v[68:71], v[132:135], v[4:7], v[68:71]
    v_perm_b32 v8, v33, v33, v24
    v_perm_b32 v9, v33, v33, v25
    v_perm_b32 v10, v33, v33, v26
    v_perm_b32 v11, v33, v33, v27
    v_perm_b32 v4, v49, v49, v24
    v_perm_b32 v5, v49, v49, v25
    v_perm_b32 v6, v49, v49, v26
    v_perm_b32 v7, v49, v49, v27
    v_mfma_f32_16x16x32_bf16 v[12:15], v[136:139], v[8:11], v[12:15]
    s_nop 0
    v_mfma_f32_16x16x32_bf16 v[68:71], v[136:139], v[4:7], v[68:71]
    v_perm_b32 v8, v33, v33, v28
    v_perm_b32 v9, v33, v33, v29
    v_perm_b32 v10, v33, v33, v30
    v_perm_b32 v11, v33, v33, v31
    v_perm_b32 v4, v49, v49, v28
    v_perm_b32 v5, v49, v49, v29
    v_perm_b32 v6, v49, v49, v30
    v_perm_b32 v7, v49, v49, v31
    v_mfma_f32_16x16x32_bf16 v[12:15], v[140:143], v[8:11], v[12:15]
    s_nop 0
    v_mfma_f32_16x16x32_bf16 v[68:71], v[140:143], v[4:7], v[68:71]
    v_perm_b32 v8, v34, v34, v24
    v_perm_b32 v9, v34, v34, v25
    v_perm_b32 v10, v34, v34, v26
    v_perm_b32 v11, v34, v34, v27
    v_perm_b32 v4, v50, v50, v24
    v_perm_b32 v5, v50, v50, v25
    v_perm_b32 v6, v50, v50, v26
    v_perm_b32 v7, v50, v50, v27
    v_mfma_f32_16x16x32_bf16 v[12:15], v[144:147], v[8:11], v[12:15]
    s_nop 0
    v_mfma_f32_16x16x32_bf16 v[68:71], v[144:147], v[4:7], v[68:71]
    v_perm_b32 v8, v34, v34, v28
    v_perm_b32 v9, v34, v34, v29
    v_perm_b32 v10, v34, v34, v30
    v_perm_b32 v11, v34, v34, v31
    v_perm_b32 v4, v50, v50, v28
    v_perm_b32 v5, v50, v50, v29
    v_perm_b32 v6, v50, v50, v30
    v_perm_b32 v7, v50, v50, v31
    v_mfma_f32_16x16x32_bf16 v[12:15], v[148:151], v[8:11], v[12:15]
    s_nop 0
    v_mfma_f32_16x16x32_bf16 v[68:71], v[148:151], v[4:7], v[68:71]
    v_perm_b32 v8, v35, v35, v24
    v_perm_b32 v9, v35, v35, v25
    v_perm_b32 v10, v35, v35, v26
    v_perm_b32 v11, v35, v35, v27
    v_perm_b32 v4, v51, v51, v24
    v_perm_b32 v5, v51, v51, v25
    v_perm_b32 v6, v51, v51, v26
    v_perm_b32 v7, v51, v51, v27
    v_mfma_f32_16x16x32_bf16 v[12:15], v[152:155], v[8:11], v[12:15]
    s_nop 0
    v_mfma_f32_16x16x32_bf16 v[68:71], v[152:155], v[4:7], v[68:71]
    v_perm_b32 v8, v35, v35, v28
    v_perm_b32 v9, v35, v35, v29
    v_perm_b32 v10, v35, v35, v30
    v_perm_b32 v11, v35, v35, v31
    v_perm_b32 v4, v51, v51, v28
    v_perm_b32 v5, v51, v51, v29
    v_perm_b32 v6, v51, v51, v30
    v_perm_b32 v7, v51, v51, v31
    v_mfma_f32_16x16x32_bf16 v[12:15], v[156:159], v[8:11], v[12:15]
    s_nop 0
    v_mfma_f32_16x16x32_bf16 v[68:71], v[156:159], v[4:7], v[68:71]
    v_perm_b32 v8, v36, v36, v24
    v_perm_b32 v9, v36, v36, v25
    v_perm_b32 v10, v36, v36, v26
    v_perm_b32 v11, v36, v36, v27
    v_perm_b32 v4, v52, v52, v24
    v_perm_b32 v5, v52, v52, v25
    v_perm_b32 v6, v52, v52, v26
    v_perm_b32 v7, v52, v52, v27
    v_mfma_f32_16x16x32_bf16 v[12:15], v[160:163], v[8:11], v[12:15]
    s_nop 0
    v_mfma_f32_16x16x32_bf16 v[68:71], v[160:163], v[4:7], v[68:71]
    v_perm_b32 v8, v36, v36, v28
    v_perm_b32 v9, v36, v36, v29
    v_perm_b32 v10, v36, v36, v30
    v_perm_b32 v11, v36, v36, v31
    v_perm_b32 v4, v52, v52, v28
    v_perm_b32 v5, v52, v52, v29
    v_perm_b32 v6, v52, v52, v30
    v_perm_b32 v7, v52, v52, v31
    v_mfma_f32_16x16x32_bf16 v[12:15], v[164:167], v[8:11], v[12:15]
    s_nop 0
    v_mfma_f32_16x16x32_bf16 v[68:71], v[164:167], v[4:7], v[68:71]
    v_perm_b32 v8, v37, v37, v24
    v_perm_b32 v9, v37, v37, v25
    v_perm_b32 v10, v37, v37, v26
    v_perm_b32 v11, v37, v37, v27
    v_perm_b32 v4, v53, v53, v24
    v_perm_b32 v5, v53, v53, v25
    v_perm_b32 v6, v53, v53, v26
    v_perm_b32 v7, v53, v53, v27
    v_mfma_f32_16x16x32_bf16 v[12:15], v[168:171], v[8:11], v[12:15]
    s_nop 0
    v_mfma_f32_16x16x32_bf16 v[68:71], v[168:171], v[4:7], v[68:71]
    v_perm_b32 v8, v37, v37, v28
    v_perm_b32 v9, v37, v37, v29
    v_perm_b32 v10, v37, v37, v30
    v_perm_b32 v11, v37, v37, v31
    v_perm_b32 v4, v53, v53, v28
    v_perm_b32 v5, v53, v53, v29
    v_perm_b32 v6, v53, v53, v30
    v_perm_b32 v7, v53, v53, v31
    v_mfma_f32_16x16x32_bf16 v[12:15], v[172:175], v[8:11], v[12:15]
    s_nop 0
    v_mfma_f32_16x16x32_bf16 v[68:71], v[172:175], v[4:7], v[68:71]
    v_perm_b32 v8, v38, v38, v24
    v_perm_b32 v9, v38, v38, v25
    v_perm_b32 v10, v38, v38, v26
    v_perm_b32 v11, v38, v38, v27
    v_perm_b32 v4, v54, v54, v24
    v_perm_b32 v5, v54, v54, v25
    v_perm_b32 v6, v54, v54, v26
    v_perm_b32 v7, v54, v54, v27
    v_mfma_f32_16x16x32_bf16 v[12:15], v[176:179], v[8:11], v[12:15]
    s_nop 0
    v_mfma_f32_16x16x32_bf16 v[68:71], v[176:179], v[4:7], v[68:71]
    v_perm_b32 v8, v38, v38, v28
    v_perm_b32 v9, v38, v38, v29
    v_perm_b32 v10, v38, v38, v30
    v_perm_b32 v11, v38, v38, v31
    v_perm_b32 v4, v54, v54, v28
    v_perm_b32 v5, v54, v54, v29
    v_perm_b32 v6, v54, v54, v30
    v_perm_b32 v7, v54, v54, v31
    v_mfma_f32_16x16x32_bf16 v[12:15], v[180:183], v[8:11], v[12:15]
    s_nop 0
    v_mfma_f32_16x16x32_bf16 v[68:71], v[180:183], v[4:7], v[68:71]
    v_perm_b32 v8, v39, v39, v24
    v_perm_b32 v9, v39, v39, v25
    v_perm_b32 v10, v39, v39, v26
    v_perm_b32 v11, v39, v39, v27
    v_perm_b32 v4, v55, v55, v24
    v_perm_b32 v5, v55, v55, v25
    v_perm_b32 v6, v55, v55, v26
    v_perm_b32 v7, v55, v55, v27
    v_mfma_f32_16x16x32_bf16 v[12:15], v[184:187], v[8:11], v[12:15]
    s_nop 0
    v_mfma_f32_16x16x32_bf16 v[68:71], v[184:187], v[4:7], v[68:71]
    v_perm_b32 v8, v39, v39, v28
    v_perm_b32 v9, v39, v39, v29
    v_perm_b32 v10, v39, v39, v30
    v_perm_b32 v11, v39, v39, v31
    v_perm_b32 v4, v55, v55, v28
    v_perm_b32 v5, v55, v55, v29
    v_perm_b32 v6, v55, v55, v30
    v_perm_b32 v7, v55, v55, v31
    v_mfma_f32_16x16x32_bf16 v[12:15], v[188:191], v[8:11], v[12:15]
    s_nop 0
    v_mfma_f32_16x16x32_bf16 v[68:71], v[188:191], v[4:7], v[68:71]
    v_perm_b32 v8, v40, v40, v24
    v_perm_b32 v9, v40, v40, v25
    v_perm_b32 v10, v40, v40, v26
    v_perm_b32 v11, v40, v40, v27
    v_perm_b32 v4, v56, v56, v24
    v_perm_b32 v5, v56, v56, v25
    v_perm_b32 v6, v56, v56, v26
    v_perm_b32 v7, v56, v56, v27
    v_mfma_f32_16x16x32_bf16 v[12:15], v[192:195], v[8:11], v[12:15]
    s_nop 0
    v_mfma_f32_16x16x32_bf16 v[68:71], v[192:195], v[4:7], v[68:71]
    v_perm_b32 v8, v40, v40, v28
    v_perm_b32 v9, v40, v40, v29
    v_perm_b32 v10, v40, v40, v30
    v_perm_b32 v11, v40, v40, v31
    v_perm_b32 v4, v56, v56, v28
    v_perm_b32 v5, v56, v56, v29
    v_perm_b32 v6, v56, v56, v30
    v_perm_b32 v7, v56, v56, v31
    v_mfma_f32_16x16x32_bf16 v[12:15], v[196:199], v[8:11], v[12:15]
    s_nop 0
    v_mfma_f32_16x16x32_bf16 v[68:71], v[196:199], v[4:7], v[68:71]
    v_perm_b32 v8, v41, v41, v24
    v_perm_b32 v9, v41, v41, v25
    v_perm_b32 v10, v41, v41, v26
    v_perm_b32 v11, v41, v41, v27
    v_perm_b32 v4, v57, v57, v24
    v_perm_b32 v5, v57, v57, v25
    v_perm_b32 v6, v57, v57, v26
    v_perm_b32 v7, v57, v57, v27
    v_mfma_f32_16x16x32_bf16 v[12:15], v[200:203], v[8:11], v[12:15]
    s_nop 0
    v_mfma_f32_16x16x32_bf16 v[68:71], v[200:203], v[4:7], v[68:71]
    v_perm_b32 v8, v41, v41, v28
    v_perm_b32 v9, v41, v41, v29
    v_perm_b32 v10, v41, v41, v30
    v_perm_b32 v11, v41, v41, v31
    v_perm_b32 v4, v57, v57, v28
    v_perm_b32 v5, v57, v57, v29
    v_perm_b32 v6, v57, v57, v30
    v_perm_b32 v7, v57, v57, v31
    v_mfma_f32_16x16x32_bf16 v[12:15], v[204:207], v[8:11], v[12:15]
    s_nop 0
    v_mfma_f32_16x16x32_bf16 v[68:71], v[204:207], v[4:7], v[68:71]
    v_perm_b32 v8, v42, v42, v24
    v_perm_b32 v9, v42, v42, v25
    v_perm_b32 v10, v42, v42, v26
    v_perm_b32 v11, v42, v42, v27
    v_perm_b32 v4, v58, v58, v24
    v_perm_b32 v5, v58, v58, v25
    v_perm_b32 v6, v58, v58, v26
    v_perm_b32 v7, v58, v58, v27
    v_mfma_f32_16x16x32_bf16 v[12:15], v[208:211], v[8:11], v[12:15]
    s_nop 0
    v_mfma_f32_16x16x32_bf16 v[68:71], v[208:211], v[4:7], v[68:71]
    v_perm_b32 v8, v42, v42, v28
    v_perm_b32 v9, v42, v42, v29
    v_perm_b32 v10, v42, v42, v30
    v_perm_b32 v11, v42, v42, v31
    v_perm_b32 v4, v58, v58, v28
    v_perm_b32 v5, v58, v58, v29
    v_perm_b32 v6, v58, v58, v30
    v_perm_b32 v7, v58, v58, v31
    v_mfma_f32_16x16x32_bf16 v[12:15], v[212:215], v[8:11], v[12:15]
    s_nop 0
    v_mfma_f32_16x16x32_bf16 v[68:71], v[212:215], v[4:7], v[68:71]
    v_perm_b32 v8, v43, v43, v24
    v_perm_b32 v9, v43, v43, v25
    v_perm_b32 v10, v43, v43, v26
    v_perm_b32 v11, v43, v43, v27
    v_perm_b32 v4, v59, v59, v24
    v_perm_b32 v5, v59, v59, v25
    v_perm_b32 v6, v59, v59, v26
    v_perm_b32 v7, v59, v59, v27
    v_mfma_f32_16x16x32_bf16 v[12:15], v[216:219], v[8:11], v[12:15]
    s_nop 0
    v_mfma_f32_16x16x32_bf16 v[68:71], v[216:219], v[4:7], v[68:71]
    v_perm_b32 v8, v43, v43, v28
    v_perm_b32 v9, v43, v43, v29
    v_perm_b32 v10, v43, v43, v30
    v_perm_b32 v11, v43, v43, v31
    v_perm_b32 v4, v59, v59, v28
    v_perm_b32 v5, v59, v59, v29
    v_perm_b32 v6, v59, v59, v30
    v_perm_b32 v7, v59, v59, v31
    v_mfma_f32_16x16x32_bf16 v[12:15], v[220:223], v[8:11], v[12:15]
    s_nop 0
    v_mfma_f32_16x16x32_bf16 v[68:71], v[220:223], v[4:7], v[68:71]
    v_perm_b32 v8, v44, v44, v24
    v_perm_b32 v9, v44, v44, v25
    v_perm_b32 v10, v44, v44, v26
    v_perm_b32 v11, v44, v44, v27
    v_perm_b32 v4, v60, v60, v24
    v_perm_b32 v5, v60, v60, v25
    v_perm_b32 v6, v60, v60, v26
    v_perm_b32 v7, v60, v60, v27
    v_mfma_f32_16x16x32_bf16 v[12:15], v[224:227], v[8:11], v[12:15]
    s_nop 0
    v_mfma_f32_16x16x32_bf16 v[68:71], v[224:227], v[4:7], v[68:71]
    v_perm_b32 v8, v44, v44, v28
    v_perm_b32 v9, v44, v44, v29
    v_perm_b32 v10, v44, v44, v30
    v_perm_b32 v11, v44, v44, v31
    v_perm_b32 v4, v60, v60, v28
    v_perm_b32 v5, v60, v60, v29
    v_perm_b32 v6, v60, v60, v30
    v_perm_b32 v7, v60, v60, v31
    v_mfma_f32_16x16x32_bf16 v[12:15], v[228:231], v[8:11], v[12:15]
    s_nop 0
    v_mfma_f32_16x16x32_bf16 v[68:71], v[228:231], v[4:7], v[68:71]
    v_perm_b32 v8, v45, v45, v24
    v_perm_b32 v9, v45, v45, v25
    v_perm_b32 v10, v45, v45, v26
    v_perm_b32 v11, v45, v45, v27
    v_perm_b32 v4, v61, v61, v24
    v_perm_b32 v5, v61, v61, v25
    v_perm_b32 v6, v61, v61, v26
    v_perm_b32 v7, v61, v61, v27
    v_mfma_f32_16x16x32_bf16 v[12:15], v[232:235], v[8:11], v[12:15]
    s_nop 0
    v_mfma_f32_16x16x32_bf16 v[68:71], v[232:235], v[4:7], v[68:71]
    v_perm_b32 v8, v45, v45, v28
    v_perm_b32 v9, v45, v45, v29
    v_perm_b32 v10, v45, v45, v30
    v_perm_b32 v11, v45, v45, v31
    v_perm_b32 v4, v61, v61, v28
    v_perm_b32 v5, v61, v61, v29
    v_perm_b32 v6, v61, v61, v30
    v_perm_b32 v7, v61, v61, v31
    v_mfma_f32_16x16x32_bf16 v[12:15], v[236:239], v[8:11], v[12:15]
    s_nop 0
    v_mfma_f32_16x16x32_bf16 v[68:71], v[236:239], v[4:7], v[68:71]
    v_perm_b32 v8, v46, v46, v24
    v_perm_b32 v9, v46, v46, v25
    v_perm_b32 v10, v46, v46, v26
    v_perm_b32 v11, v46, v46, v27
    v_perm_b32 v4, v62, v62, v24
    v_perm_b32 v5, v62, v62, v25
    v_perm_b32 v6, v62, v62, v26
    v_perm_b32 v7, v62, v62, v27
    v_mfma_f32_16x16x32_bf16 v[12:15], v[240:243], v[8:11], v[12:15]
    s_nop 0
    v_mfma_f32_16x16x32_bf16 v[68:71], v[240:243], v[4:7], v[68:71]
    v_perm_b32 v8, v46, v46, v28
    v_perm_b32 v9, v46, v46, v29
    v_perm_b32 v10, v46, v46, v30
    v_perm_b32 v11, v46, v46, v31
    v_perm_b32 v4, v62, v62, v28
    v_perm_b32 v5, v62, v62, v29
    v_perm_b32 v6, v62, v62, v30
    v_perm_b32 v7, v62, v62, v31
    v_mfma_f32_16x16x32_bf16 v[12:15], v[244:247], v[8:11], v[12:15]
    s_nop 0
    v_mfma_f32_16x16x32_bf16 v[68:71], v[244:247], v[4:7], v[68:71]
    v_perm_b32 v8, v47, v47, v24
    v_perm_b32 v9, v47, v47, v25
    v_perm_b32 v10, v47, v47, v26
    v_perm_b32 v11, v47, v47, v27
    v_perm_b32 v4, v63, v63, v24
    v_perm_b32 v5, v63, v63, v25
    v_perm_b32 v6, v63, v63, v26
    v_perm_b32 v7, v63, v63, v27
    v_mfma_f32_16x16x32_bf16 v[12:15], v[248:251], v[8:11], v[12:15]
    s_nop 0
    v_mfma_f32_16x16x32_bf16 v[68:71], v[248:251], v[4:7], v[68:71]
    v_perm_b32 v8, v47, v47, v28
    v_perm_b32 v9, v47, v47, v29
    v_perm_b32 v10, v47, v47, v30
    v_perm_b32 v11, v47, v47, v31
    v_perm_b32 v4, v63, v63, v28
    v_perm_b32 v5, v63, v63, v29
    v_perm_b32 v6, v63, v63, v30
    v_perm_b32 v7, v63, v63, v31
    v_mfma_f32_16x16x32_bf16 v[12:15], v[252:255], v[8:11], v[12:15]
    s_nop 0
    v_mfma_f32_16x16x32_bf16 v[68:71], v[252:255], v[4:7], v[68:71]
    v_lshrrev_b32 v3, 4, v0
    v_lshlrev_b32 v3, 7, v3
    v_and_b32 v4, 7, v0
    v_lshl_add_u32 v3, v4, 4, v3
    v_bfe_u32 v4, v0, 3, 1
    v_lshl_add_u32 v3, v4, 9, v3
    s_lshl_b32 s24, s3, 11
    s_add_u32 s24, s24, 135168
    v_add_u32 v3, s24, v3
    ds_write_b128 v3, v[12:15]
    ds_write_b128 v3, v[68:71] offset:1024
    s_waitcnt lgkmcnt(0)
    s_barrier
    v_and_b32 v5, 31, v0
    s_lshl_b32 s24, s3, 9
    s_add_u32 s24, s24, 135168
    v_lshl_add_u32 v3, v5, 4, s24
    ds_read_b128 v[72:75], v3 offset:0
    ds_read_b128 v[76:79], v3 offset:2048
    ds_read_b128 v[80:83], v3 offset:4096
    ds_read_b128 v[84:87], v3 offset:6144
    s_lshl_b32 s24, s3, 8
    s_add_u32 s24, s24, 143360
    v_lshl_add_u32 v5, v5, 3, s24
    s_waitcnt lgkmcnt(0)
    v_add_f32 v72, v72, v76
    v_add_f32 v73, v73, v77
    v_add_f32 v74, v74, v78
    v_add_f32 v75, v75, v79
    v_add_f32 v72, v72, v80
    v_add_f32 v73, v73, v81
    v_add_f32 v74, v74, v82
    v_add_f32 v75, v75, v83
    v_add_f32 v72, v72, v84
    v_add_f32 v73, v73, v85
    v_add_f32 v74, v74, v86
    v_add_f32 v75, v75, v87
    v_cvt_pk_bf16_f32 v6, v72, v73
    v_cvt_pk_bf16_f32 v7, v74, v75
    ds_write_b64 v5, v[6:7]
    v_lshrrev_b32 v3, 4, v0
    v_and_b32 v4, 3, v0
    v_lshlrev_b32 v5, 8, v4
    v_lshl_add_u32 v5, v3, 4, v5
    v_add_u32 v5, 143360, v5
    s_waitcnt lgkmcnt(0)
    s_barrier
    ds_read_b128 v[32:35], v5 offset:0
    ds_read_b128 v[36:39], v5 offset:64
    ds_read_b128 v[40:43], v5 offset:128
    ds_read_b128 v[44:47], v5 offset:192
    s_waitcnt lgkmcnt(3)
    v_mfma_f32_16x16x32_bf16 v[72:75], v[32:35], a[0:3], 0
    s_waitcnt lgkmcnt(2)
    v_mfma_f32_16x16x32_bf16 v[72:75], v[36:39], a[4:7], v[72:75]
    s_waitcnt lgkmcnt(1)
    v_mfma_f32_16x16x32_bf16 v[72:75], v[40:43], a[8:11], v[72:75]
    s_waitcnt lgkmcnt(0)
    v_mfma_f32_16x16x32_bf16 v[72:75], v[44:47], a[12:15], v[72:75]
    v_mfma_f32_16x16x32_bf16 v[76:79], v[32:35], a[16:19], 0
    v_mfma_f32_16x16x32_bf16 v[76:79], v[36:39], a[20:23], v[76:79]
    v_mfma_f32_16x16x32_bf16 v[76:79], v[40:43], a[24:27], v[76:79]
    v_mfma_f32_16x16x32_bf16 v[76:79], v[44:47], a[28:31], v[76:79]
    v_mfma_f32_16x16x32_bf16 v[80:83], v[32:35], a[32:35], 0
    v_mfma_f32_16x16x32_bf16 v[80:83], v[36:39], a[36:39], v[80:83]
    v_mfma_f32_16x16x32_bf16 v[80:83], v[40:43], a[40:43], v[80:83]
    v_mfma_f32_16x16x32_bf16 v[80:83], v[44:47], a[44:47], v[80:83]
    v_mov_b32_dpp v4, v72 quad_perm:[0,1,2,3] row_mask:0x1 bank_mask:0xf
    v_mov_b32_dpp v5, v73 quad_perm:[0,1,2,3] row_mask:0x1 bank_mask:0xf
    v_mov_b32_dpp v6, v74 quad_perm:[0,1,2,3] row_mask:0x1 bank_mask:0xf
    v_mov_b32_dpp v7, v75 quad_perm:[0,1,2,3] row_mask:0x1 bank_mask:0xf
    v_mfma_f32_16x16x32_bf16 v[84:87], v[32:35], a[48:51], 0
    v_mfma_f32_16x16x32_bf16 v[84:87], v[36:39], a[52:55], v[84:87]
    v_mfma_f32_16x16x32_bf16 v[84:87], v[40:43], a[56:59], v[84:87]
    v_mfma_f32_16x16x32_bf16 v[84:87], v[44:47], a[60:63], v[84:87]
    v_mov_b32_dpp v4, v76 quad_perm:[0,1,2,3] row_mask:0x2 bank_mask:0xf
    v_mov_b32_dpp v5, v77 quad_perm:[0,1,2,3] row_mask:0x2 bank_mask:0xf
    v_mov_b32_dpp v6, v78 quad_perm:[0,1,2,3] row_mask:0x2 bank_mask:0xf
    v_mov_b32_dpp v7, v79 quad_perm:[0,1,2,3] row_mask:0x2 bank_mask:0xf
    v_mfma_f32_16x16x32_bf16 v[88:91], v[32:35], a[64:67], 0
    v_mfma_f32_16x16x32_bf16 v[88:91], v[36:39], a[68:71], v[88:91]
    v_mfma_f32_16x16x32_bf16 v[88:91], v[40:43], a[72:75], v[88:91]
    v_mfma_f32_16x16x32_bf16 v[88:91], v[44:47], a[76:79], v[88:91]
    v_mov_b32_dpp v4, v80 quad_perm:[0,1,2,3] row_mask:0x4 bank_mask:0xf
    v_mov_b32_dpp v5, v81 quad_perm:[0,1,2,3] row_mask:0x4 bank_mask:0xf
    v_mov_b32_dpp v6, v82 quad_perm:[0,1,2,3] row_mask:0x4 bank_mask:0xf
    v_mov_b32_dpp v7, v83 quad_perm:[0,1,2,3] row_mask:0x4 bank_mask:0xf
    v_mfma_f32_16x16x32_bf16 v[92:95], v[32:35], a[80:83], 0
    v_mfma_f32_16x16x32_bf16 v[92:95], v[36:39], a[84:87], v[92:95]
    v_mfma_f32_16x16x32_bf16 v[92:95], v[40:43], a[88:91], v[92:95]
    v_mfma_f32_16x16x32_bf16 v[92:95], v[44:47], a[92:95], v[92:95]
    v_mov_b32_dpp v4, v84 quad_perm:[0,1,2,3] row_mask:0x8 bank_mask:0xf
    v_mov_b32_dpp v5, v85 quad_perm:[0,1,2,3] row_mask:0x8 bank_mask:0xf
    v_mov_b32_dpp v6, v86 quad_perm:[0,1,2,3] row_mask:0x8 bank_mask:0xf
    v_mov_b32_dpp v7, v87 quad_perm:[0,1,2,3] row_mask:0x8 bank_mask:0xf
    v_mfma_f32_16x16x32_bf16 v[96:99], v[32:35], a[96:99], 0
    v_mfma_f32_16x16x32_bf16 v[96:99], v[36:39], a[100:103], v[96:99]
    v_mfma_f32_16x16x32_bf16 v[96:99], v[40:43], a[104:107], v[96:99]
    v_mfma_f32_16x16x32_bf16 v[96:99], v[44:47], a[108:111], v[96:99]
    v_mov_b32_dpp v8, v88 quad_perm:[0,1,2,3] row_mask:0x1 bank_mask:0xf
    v_mov_b32_dpp v9, v89 quad_perm:[0,1,2,3] row_mask:0x1 bank_mask:0xf
    v_mov_b32_dpp v10, v90 quad_perm:[0,1,2,3] row_mask:0x1 bank_mask:0xf
    v_mov_b32_dpp v11, v91 quad_perm:[0,1,2,3] row_mask:0x1 bank_mask:0xf
    v_mfma_f32_16x16x32_bf16 v[100:103], v[32:35], a[112:115], 0
    v_mfma_f32_16x16x32_bf16 v[100:103], v[36:39], a[116:119], v[100:103]
    v_mfma_f32_16x16x32_bf16 v[100:103], v[40:43], a[120:123], v[100:103]
    v_mfma_f32_16x16x32_bf16 v[100:103], v[44:47], a[124:127], v[100:103]
    v_mov_b32_dpp v8, v92 quad_perm:[0,1,2,3] row_mask:0x2 bank_mask:0xf
    v_mov_b32_dpp v9, v93 quad_perm:[0,1,2,3] row_mask:0x2 bank_mask:0xf
    v_mov_b32_dpp v10, v94 quad_perm:[0,1,2,3] row_mask:0x2 bank_mask:0xf
    v_mov_b32_dpp v11, v95 quad_perm:[0,1,2,3] row_mask:0x2 bank_mask:0xf
    v_mov_b32_dpp v8, v96 quad_perm:[0,1,2,3] row_mask:0x4 bank_mask:0xf
    v_mov_b32_dpp v9, v97 quad_perm:[0,1,2,3] row_mask:0x4 bank_mask:0xf
    v_mov_b32_dpp v10, v98 quad_perm:[0,1,2,3] row_mask:0x4 bank_mask:0xf
    v_mov_b32_dpp v11, v99 quad_perm:[0,1,2,3] row_mask:0x4 bank_mask:0xf
    v_mov_b32_dpp v8, v100 quad_perm:[0,1,2,3] row_mask:0x8 bank_mask:0xf
    v_mov_b32_dpp v9, v101 quad_perm:[0,1,2,3] row_mask:0x8 bank_mask:0xf
    v_mov_b32_dpp v10, v102 quad_perm:[0,1,2,3] row_mask:0x8 bank_mask:0xf
    v_mov_b32_dpp v11, v103 quad_perm:[0,1,2,3] row_mask:0x8 bank_mask:0xf
    s_lshl_b32 s24, s26, 12
    s_lshl_b32 s25, s3, 10
    s_add_u32 s24, s24, s25
    s_add_u32 s24, s24, 0x124000
    v_lshlrev_b32 v3, 3, v0
    v_cvt_pk_bf16_f32 v4, v4, v5
    v_cvt_pk_bf16_f32 v5, v6, v7
    v_cvt_pk_bf16_f32 v6, v8, v9
    v_cvt_pk_bf16_f32 v7, v10, v11
    buffer_store_dwordx2 v[4:5], v3, s[12:15], s24 offen sc1
    buffer_store_dwordx2 v[6:7], v3, s[12:15], s24 offen offset:512 sc1
    s_waitcnt vmcnt(0)
    s_barrier
    s_cmp_lg_u32 s3, 0
    s_cbranch_scc1 L_sig11
    s_mov_b64 exec, 1
    v_mov_b32 v3, 1
    buffer_atomic_add v3, off, s[16:19], 0 offset:8 sc0
    s_waitcnt vmcnt(0)
    v_readfirstlane_b32 s24, v3
    s_mov_b64 exec, -1
    s_and_b32 s24, s24, 31
    s_cmp_lg_u32 s24, 31
    s_cbranch_scc1 L_sig11
    v_lshlrev_b32 v4, 7, v0
    v_mov_b32 v3, 1
    s_mov_b32 s24, 0x170000
    buffer_store_dword v3, v4, s[12:15], s24 offen offset:8 sc1
L_sig11:
L_R:
    s_mov_b32 s20, s58
    s_mov_b32 s21, s59
    s_mov_b32 s22, 0x2000
    s_mov_b32 s23, 0x20000
    v_and_b32 v3, 1, v0
    v_lshlrev_b32 v3, 4, v3
    v_mov_b32 v4, 0xffff
    v_lshlrev_b32 v4, v3, v4
    v_bfe_u32 v3, v0, 1, 2
    v_cmp_eq_u32 vcc, 0, v3
    s_nop 1
    v_cndmask_b32 v20, 0, v4, vcc
    v_cmp_eq_u32 vcc, 1, v3
    s_nop 1
    v_cndmask_b32 v21, 0, v4, vcc
    v_cmp_eq_u32 vcc, 2, v3
    s_nop 1
    v_cndmask_b32 v22, 0, v4, vcc
    v_cmp_eq_u32 vcc, 3, v3
    s_nop 1
    v_cndmask_b32 v23, 0, v4, vcc
    v_lshrrev_b32 v3, 4, v0
    v_and_b32 v4, 7, v0
    v_lshl_add_u32 v5, v3, 3, v4
    v_lshlrev_b32 v27, 4, v5
    v_add_u32 v27, 144384, v27
    s_lshl_b32 s24, s3, 2
    v_add_u32 v26, s24, v27
    s_lshl_b32 s24, s3, 8
    s_add_u32 s24, s24, 143360
    v_lshl_add_u32 v24, v5, 3, s24
    s_and_b32 s30, s74, 7
    s_lshl_b32 s30, s30, 3
    s_lshr_b32 s24, s74, 3
    s_or_b32 s30, s30, s24
    v_lshlrev_b32 v28, 11, v3
    v_lshl_add_u32 v28, v4, 1, v28
    s_lshl_b32 s24, s30, 4
    v_add_u32 v28, s24, v28
    v_lshrrev_b32 v5, 3, v0
    s_lshl_b32 s24, s3, 3
    v_add_u32 v5, s24, v5
    v_lshlrev_b32 v5, 12, v5
    v_lshl_add_u32 v30, v4, 3, v5
    v_and_b32 v6, 1, v0
    s_lshl_b32 s24, s3, 1
    v_add_u32 v6, s24, v6
    v_lshrrev_b32 v5, 1, v0
    v_lshlrev_b32 v5, 12, v5
    v_lshl_add_u32 v30, v6, 3, v5
    v_lshlrev_b32 v28, 11, v3
    v_lshl_add_u32 v28, v6, 1, v28
    s_lshl_b32 s24, s30, 4
    v_add_u32 v28, s24, v28
    v_lshlrev_b32 v80, 3, v0
    v_and_b32 v5, 3, v0
    v_lshlrev_b32 v25, 8, v5
    v_lshl_add_u32 v25, v3, 4, v25
    v_add_u32 v25, 143360, v25
    v_and_b32 v29, 0x1ff, v2
    v_min_u32 v6, 5, v4
    v_lshrrev_b32 v5, 1, v6
    v_lshlrev_b32 v31, 10, v5
    v_and_b32 v6, 1, v6
    v_lshl_add_u32 v31, v6, 4, v31
    s_cmp_lg_u32 s3, 0
    s_cbranch_scc1 L_awx12
    s_mov_b32 s24, 262144
    s_mov_b64 exec, 1
L_aw13:
    buffer_load_dword v1, off, s[12:15], s73 offset:8 sc1
    s_waitcnt vmcnt(0)
    v_readfirstlane_b32 s25, v1
    s_nop 0
    s_cmp_eq_u32 s25, 1
    s_cbranch_scc1 L_awx12
    s_sleep 4
    s_sub_u32 s24, s24, 1
    s_cmp_lg_u32 s24, 0
    s_cbranch_scc1 L_aw13
L_awx12:
    s_mov_b64 exec, -1
    s_barrier
    s_lshl_b32 s30, s30, 6
    s_add_u32 s24, s30, 0x124000
    buffer_load_dwordx2 v[8:9], v30, s[12:15], s24 offen sc1
    s_waitcnt vmcnt(0)
    v_lshlrev_b32 v4, 16, v8
    v_lshlrev_b32 v6, 16, v9
    v_and_b32 v5, 0xffff0000, v8
    v_and_b32 v7, 0xffff0000, v9
    v_permlane32_swap_b32 v4, v6
    s_nop 0
    v_permlane32_swap_b32 v5, v7
    v_add_f32 v4, v4, v6
    v_add_f32 v5, v5, v7
    s_nop 1
    v_permlane16_swap_b32 v4, v5
    v_add_f32 v4, v4, v5
    s_nop 1
    v_add_f32_dpp v4, v4, v4 row_ror:8 row_mask:0xf bank_mask:0xf
    s_nop 1
    v_add_f32_dpp v4, v4, v4 row_ror:4 row_mask:0xf bank_mask:0xf
    s_nop 1
    v_add_f32_dpp v4, v4, v4 row_ror:2 row_mask:0xf bank_mask:0xf
    v_cvt_pk_bf16_f32 v4, v4, v4
    s_mov_b32 exec_lo, 0x00030003
    s_mov_b32 exec_hi, 0x00030003
    buffer_store_short v4, v28, s[20:23], 0 offen offset:0
    s_mov_b64 exec, -1
    s_lshl_b32 s33, s26, 2
    s_add_u32 s33, s33, s3
    s_and_b32 s35, s72, 7
    s_lshl_b32 s35, s35, 7
    s_add_u32 s35, s35, 0x1b0000
    s_lshr_b32 s34, s72, 3
    s_mul_i32 s34, s34, 6
    s_lshr_b32 s24, s3, 1
    s_mul_i32 s24, s24, 3
    s_add_u32 s24, s24, s34
    s_lshl_b32 s29, s24, 10
    s_add_u32 s29, s29, s35
    s_and_b32 s24, s3, 1
    s_lshl_b32 s24, s24, 5
    s_add_u32 s29, s29, s24
    s_mov_b32 s24, 262144
    s_branch L_pd14_in
L_pd14:
    s_sleep 64
L_pd14_in:
    buffer_load_dwordx2 v[8:9], v31, s[12:15], s29 offen sc1
    s_waitcnt vmcnt(0)
    v_max_u32 v3, v8, v9
    v_cmp_eq_u32 vcc, -1, v3
    s_sub_u32 s24, s24, 1
    s_cmp_eq_u32 s24, 0
    s_cbranch_scc1 L_pd14_x
    s_and_b64 exec, exec, vcc
    s_cbranch_scc1 L_pd14
L_pd14_x:
    s_mov_b64 exec, -1
    v_mov_b32 v6, v8
    s_nop 1
    v_max_f32_dpp v6, v6, v6 quad_perm:[1,0,3,2] row_mask:0xf bank_mask:0xf
    s_nop 1
    v_max_f32_dpp v6, v6, v6 quad_perm:[2,3,0,1] row_mask:0xf bank_mask:0xf
    s_nop 1
    v_max_f32_dpp v6, v6, v6 row_half_mirror row_mask:0xf bank_mask:0xf
    v_sub_f32 v8, v8, v6
    v_exp_f32 v8, v8
    v_and_b32 v4, 7, v0
    v_cmp_gt_u32 vcc, 6, v4
    s_nop 1
    v_cndmask_b32 v8, 0, v8, vcc
    v_mul_f32 v9, v8, v9
    s_nop 1
    v_add_f32_dpp v9, v9, v9 quad_perm:[1,0,3,2] row_mask:0xf bank_mask:0xf
    s_nop 1
    v_add_f32_dpp v9, v9, v9 quad_perm:[2,3,0,1] row_mask:0xf bank_mask:0xf
    s_nop 1
    v_add_f32_dpp v9, v9, v9 row_half_mirror row_mask:0xf bank_mask:0xf
    v_rcp_f32 v9, v9
    s_nop 0
    v_mul_f32 v8, v8, v9
    v_cvt_pk_bf16_f32 v8, v8, v8
    v_lshrrev_b32 v5, 4, v0
    v_lshlrev_b32 v5, 2, v5
    ds_bpermute_b32 v6, v5, v8
    ds_bpermute_b32 v7, v5, v8 offset:16
    s_waitcnt lgkmcnt(0)
    v_and_b32 v32, v6, v20
    v_and_b32 v33, v6, v21
    v_and_b32 v34, v6, v22
    v_and_b32 v35, v6, v23
    v_and_b32 v36, v7, v20
    v_and_b32 v37, v7, v21
    v_and_b32 v38, v7, v22
    v_and_b32 v39, v7, v23
    s_mul_i32 s29, s33, 1536
    s_add_u32 s29, s29, 0x180000
    s_add_u32 s30, s30, 0x1b7000
    s_lshl_b32 s31, s26, 12
    s_lshr_b32 s24, s74, 5
    s_lshl_b32 s24, s24, 11
    s_add_u32 s31, s31, s24
    s_lshl_b32 s24, s3, 9
    s_add_u32 s31, s31, s24
    s_add_u32 s31, s31, 0x1b7000
    s_cmp_lg_u32 s3, 0
    s_cbranch_scc1 L_H_x
    s_lshr_b32 s24, s74, 5
    s_mul_i32 s25, s24, 3
    s_add_u32 s34, s34, s25
    s_lshl_b32 s24, s24, 6
    s_add_u32 s24, s24, s26
    s_lshl_b32 s24, s24, 20
    s_add_u32 s4, s52, s24
    s_addc_u32 s5, s53, 0
    s_mov_b32 s6, 0x100000
    s_mov_b32 s7, 0x20000
    s_add_u32 s8, s4, 0x2000000
    s_addc_u32 s9, s5, 0
    s_mov_b32 s10, s6
    s_mov_b32 s11, 0x20000
    v_lshrrev_b32 v3, 4, v0
    v_mul_u32_u24 v16, 6144, v3
    v_and_b32 v3, 15, v0
    v_lshl_add_u32 v16, v3, 7, v16
    v_lshlrev_b32 v17, 10, v0
    v_mov_b32 v18, 0
    s_mov_b32 s27, 43
    s_mov_b32 s28, 43
    s_mov_b32 s32, 43
    s_mov_b32 s75, 1024
L_H:
    s_sub_u32 s75, s75, 1
    s_cmp_eq_u32 s75, 0
    s_cbranch_scc1 L_H_x
    s_mov_b64 exec, 0xffffff
    buffer_load_dword v18, v17, s[12:15], s35 offen offset:64 sc1
    s_mov_b64 exec, -1
    s_waitcnt vmcnt(0)
    v_max_i32 v19, 0, v18
    s_nop 1
    v_add_u32_dpp v3, v19, v19 row_ror:8 row_mask:0xf bank_mask:0xf
    s_nop 1
    v_add_u32_dpp v3, v3, v3 row_ror:4 row_mask:0xf bank_mask:0xf
    s_nop 1
    v_add_u32_dpp v3, v3, v3 row_ror:2 row_mask:0xf bank_mask:0xf
    s_nop 1
    v_add_u32_dpp v3, v3, v3 row_ror:1 row_mask:0xf bank_mask:0xf
    s_nop 0
    v_readlane_b32 s70, v3, 0
    v_readlane_b32 s24, v3, 16
    s_nop 0
    s_add_u32 s70, s70, s24
    s_add_u32 s24, s34, 0
    s_nop 0
    v_readlane_b32 s24, v19, s24
    s_sub_u32 s25, 43, s27
    s_mul_i32 s25, s25, 17
    s_mul_i32 s64, s24, 24
    s_add_u32 s64, s64, s25
    s_add_u32 s24, s24, 8
    s_cmp_gt_u32 s24, s27
    s_cselect_b32 s64, 0xffff, s64
    s_add_u32 s24, s34, 1
    v_readlane_b32 s24, v19, s24
    s_sub_u32 s25, 43, s28
    s_mul_i32 s25, s25, 17
    s_mul_i32 s65, s24, 24
    s_add_u32 s65, s65, s25
    s_add_u32 s24, s24, 8
    s_cmp_gt_u32 s24, s28
    s_cselect_b32 s65, 0xffff, s65
    s_add_u32 s24, s34, 2
    v_readlane_b32 s24, v19, s24
    s_sub_u32 s25, 43, s32
    s_mul_i32 s25, s25, 17
    s_mul_i32 s66, s24, 24
    s_add_u32 s66, s66, s25
    s_add_u32 s24, s24, 8
    s_cmp_gt_u32 s24, s32
    s_cselect_b32 s66, 0xffff, s66
    s_min_u32 s71, s64, s65
    s_min_u32 s71, s71, s66
    s_cmp_eq_u32 s71, 0xffff
    s_cbranch_scc1 L_H_x
    s_add_u32 s24, s71, 36
    s_cmp_lt_i32 s24, s70
    s_cbranch_scc1 L_H_go
    s_sleep 4
    s_branch L_H
L_H_go:
    s_cmp_lg_u32 s71, s64
    s_cbranch_scc1 L_H_n0
    s_sub_u32 s27, s27, 2
    s_mul_i32 s24, s27, 24576
    s_add_u32 s24, s24, 0
    s_branch L_H_ld
L_H_n0:
    s_cmp_lg_u32 s71, s65
    s_cbranch_scc1 L_H_n1
    s_sub_u32 s28, s28, 2
    s_mul_i32 s24, s28, 24576
    s_add_u32 s24, s24, 2048
    s_branch L_H_ld
L_H_n1:
    s_sub_u32 s32, s32, 2
    s_mul_i32 s24, s32, 24576
    s_add_u32 s24, s24, 4096
L_H_ld:
    buffer_load_dword v5, v16, s[4:7], s24 offen
    buffer_load_dword v5, v16, s[8:11], s24 offen
    s_add_u32 s24, s24, 24576
    buffer_load_dword v5, v16, s[4:7], s24 offen
    buffer_load_dword v5, v16, s[8:11], s24 offen
    s_branch L_H
L_H_x:
    s_mov_b32 s24, 262144
    s_branch L_pd15_in
L_pd15:
L_pd15_in:
    buffer_load_dwordx4 v[40:43], v2, s[12:15], s29 offen sc1
    buffer_load_dwordx4 v[44:47], v29, s[12:15], s29 offen offset:1024 sc1
    s_waitcnt vmcnt(0)
    v_max_u32 v3, v40, v41
    v_max3_u32 v3, v3, v42, v43
    v_max3_u32 v3, v3, v44, v45
    v_max3_u32 v3, v3, v46, v47
    v_cmp_eq_u32 vcc, -1, v3
    s_sub_u32 s24, s24, 1
    s_cmp_eq_u32 s24, 0
    s_cbranch_scc1 L_pd15_x
    s_and_b64 exec, exec, vcc
    s_cbranch_scc1 L_pd15
L_pd15_x:
    s_mov_b64 exec, -1
    v_mfma_f32_16x16x32_bf16 v[12:15], v[40:43], v[32:35], 0
    v_mfma_f32_16x16x32_bf16 v[12:15], v[44:47], v[36:39], v[12:15]
    s_nop 7
    v_cvt_pk_bf16_f32 v4, v12, v13
    v_cvt_pk_bf16_f32 v5, v14, v15
    ds_write_b64 v24, v[4:5]
    s_waitcnt lgkmcnt(0)
    s_barrier
    ds_read_b128 v[48:51], v25 offset:0
    ds_read_b128 v[52:55], v25 offset:64
    ds_read_b128 v[56:59], v25 offset:128
    ds_read_b128 v[60:63], v25 offset:192
    s_waitcnt lgkmcnt(3)
    v_mfma_f32_16x16x32_bf16 v[64:67], v[48:51], a[128:131], 0
    v_mfma_f32_16x16x32_bf16 v[68:71], v[48:51], a[144:147], 0
    v_mfma_f32_16x16x32_bf16 v[72:75], v[48:51], a[160:163], 0
    v_mfma_f32_16x16x32_bf16 v[76:79], v[48:51], a[176:179], 0
    s_waitcnt lgkmcnt(2)
    v_mfma_f32_16x16x32_bf16 v[64:67], v[52:55], a[132:135], v[64:67]
    v_mfma_f32_16x16x32_bf16 v[68:71], v[52:55], a[148:151], v[68:71]
    v_mfma_f32_16x16x32_bf16 v[72:75], v[52:55], a[164:167], v[72:75]
    v_mfma_f32_16x16x32_bf16 v[76:79], v[52:55], a[180:183], v[76:79]
    s_waitcnt lgkmcnt(1)
    v_mfma_f32_16x16x32_bf16 v[64:67], v[56:59], a[136:139], v[64:67]
    v_mfma_f32_16x16x32_bf16 v[68:71], v[56:59], a[152:155], v[68:71]
    v_mfma_f32_16x16x32_bf16 v[72:75], v[56:59], a[168:171], v[72:75]
    v_mfma_f32_16x16x32_bf16 v[76:79], v[56:59], a[184:187], v[76:79]
    s_waitcnt lgkmcnt(0)
    v_mfma_f32_16x16x32_bf16 v[64:67], v[60:63], a[140:143], v[64:67]
    v_mfma_f32_16x16x32_bf16 v[68:71], v[60:63], a[156:159], v[68:71]
    v_mfma_f32_16x16x32_bf16 v[72:75], v[60:63], a[172:175], v[72:75]
    v_mfma_f32_16x16x32_bf16 v[76:79], v[60:63], a[188:191], v[76:79]
    s_nop 4
    v_cvt_pk_bf16_f32 v64, v64, v65
    v_cvt_pk_bf16_f32 v65, v66, v67
    v_cvt_pk_bf16_f32 v68, v68, v69
    v_cvt_pk_bf16_f32 v69, v70, v71
    v_cvt_pk_bf16_f32 v72, v72, v73
    v_cvt_pk_bf16_f32 v73, v74, v75
    v_cvt_pk_bf16_f32 v76, v76, v77
    v_cvt_pk_bf16_f32 v77, v78, v79
    v_mov_b32_dpp v64, v68 quad_perm:[0,1,2,3] row_mask:0x2 bank_mask:0xf
    v_mov_b32_dpp v65, v69 quad_perm:[0,1,2,3] row_mask:0x2 bank_mask:0xf
    s_nop 0
    v_mov_b32_dpp v64, v72 quad_perm:[0,1,2,3] row_mask:0x4 bank_mask:0xf
    v_mov_b32_dpp v65, v73 quad_perm:[0,1,2,3] row_mask:0x4 bank_mask:0xf
    s_nop 0
    v_mov_b32_dpp v64, v76 quad_perm:[0,1,2,3] row_mask:0x8 bank_mask:0xf
    v_mov_b32_dpp v65, v77 quad_perm:[0,1,2,3] row_mask:0x8 bank_mask:0xf
    buffer_store_dwordx2 v[64:65], v80, s[12:15], s31 offen sc1
    s_mov_b32 s24, 262144
    s_branch L_pd16_in
L_pd16:
L_pd16_in:
    buffer_load_dwordx2 v[8:9], v30, s[12:15], s30 offen sc1
    s_waitcnt vmcnt(0)
    v_max_u32 v3, v8, v9
    v_cmp_eq_u32 vcc, -1, v3
    s_sub_u32 s24, s24, 1
    s_cmp_eq_u32 s24, 0
    s_cbranch_scc1 L_pd16_x
    s_and_b64 exec, exec, vcc
    s_cbranch_scc1 L_pd16
L_pd16_x:
    s_mov_b64 exec, -1
    v_lshlrev_b32 v4, 16, v8
    v_lshlrev_b32 v6, 16, v9
    v_and_b32 v5, 0xffff0000, v8
    v_and_b32 v7, 0xffff0000, v9
    v_permlane32_swap_b32 v4, v6
    s_nop 0
    v_permlane32_swap_b32 v5, v7
    v_add_f32 v4, v4, v6
    v_add_f32 v5, v5, v7
    s_nop 1
    v_permlane16_swap_b32 v4, v5
    v_add_f32 v4, v4, v5
    s_nop 1
    v_add_f32_dpp v4, v4, v4 row_ror:8 row_mask:0xf bank_mask:0xf
    s_nop 1
    v_add_f32_dpp v4, v4, v4 row_ror:4 row_mask:0xf bank_mask:0xf
    s_nop 1
    v_add_f32_dpp v4, v4, v4 row_ror:2 row_mask:0xf bank_mask:0xf
    v_cvt_pk_bf16_f32 v4, v4, v4
    s_mov_b32 exec_lo, 0x00030003
    s_mov_b32 exec_hi, 0x00030003
    buffer_store_short v4, v28, s[20:23], 0 offen offset:1024
    s_mov_b64 exec, -1
L_end:
    s_endpgm
L_C:
    s_cmp_lg_u32 s3, 0
    s_cbranch_scc1 L_C_q
    v_lshrrev_b32 v3, 4, v0
    v_and_b32 v4, 3, v0
    v_lshlrev_b32 v5, 6, v3
    v_lshl_add_u32 v5, v4, 4, v5
    v_bfe_u32 v4, v0, 2, 2
    v_lshl_add_u32 v5, v4, 8, v5
    s_lshl_b32 s24, s26, 10
    s_add_u32 s24, s24, 0x164000
    buffer_store_dwordx4 v[8:11], v5, s[12:15], s24 offen sc1
L_C_q:
    s_waitcnt vmcnt(0)
    s_barrier
    s_cmp_lg_u32 s3, 0
    s_cbranch_scc1 L_sig17
    s_mov_b64 exec, 1
    v_mov_b32 v3, 1
    v_mov_b32 v4, 1
    buffer_atomic_add v4, off, s[16:19], 0 offset:128
    buffer_atomic_add v3, off, s[16:19], 0 offset:0 sc0
    s_waitcnt vmcnt(0)
    v_readfirstlane_b32 s24, v3
    s_mov_b64 exec, -1
    s_and_b32 s24, s24, 63
    s_cmp_lg_u32 s24, 63
    s_cbranch_scc1 L_sig17
    v_lshlrev_b32 v4, 7, v0
    v_mov_b32 v3, 1
    s_mov_b32 s24, 0x170000
    buffer_store_dword v3, v4, s[12:15], s24 offen offset:0 sc1
L_sig17:
    s_mov_b32 s8, s56
    s_mov_b32 s9, s57
    s_mov_b32 s10, 0x400000
    s_mov_b32 s11, 0x20000
    s_lshl_b32 s24, s26, 17
    s_lshl_b32 s25, s3, 15
    s_add_u32 s24, s24, s25
    s_add_u32 s24, s24, 512
    v_lshrrev_b32 v3, 5, v0
    v_and_b32 v4, 0x1ff, v2
    v_lshl_add_u32 v3, v3, 13, v4
    s_mul_i32 m0, s3, 16896
    s_nop 0
    buffer_load_dwordx4 v3, s[8:11], s24 offen nt lds
    s_add_u32 m0, m0, 1056
    s_add_u32 s24, s24, 2048
    buffer_load_dwordx4 v3, s[8:11], s24 offen nt lds
    s_add_u32 m0, m0, 1056
    s_add_u32 s24, s24, 2048
    buffer_load_dwordx4 v3, s[8:11], s24 offen nt lds
    s_add_u32 m0, m0, 1056
    s_add_u32 s24, s24, 2048
    buffer_load_dwordx4 v3, s[8:11], s24 offen nt lds
    s_add_u32 m0, m0, 1056
    s_add_u32 s24, s24, 10240
    buffer_load_dwordx4 v3, s[8:11], s24 offen nt lds
    s_add_u32 m0, m0, 1056
    s_add_u32 s24, s24, 2048
    buffer_load_dwordx4 v3, s[8:11], s24 offen nt lds
    s_add_u32 m0, m0, 1056
    s_add_u32 s24, s24, 2048
    buffer_load_dwordx4 v3, s[8:11], s24 offen nt lds
    s_add_u32 m0, m0, 1056
    s_add_u32 s24, s24, 2048
    buffer_load_dwordx4 v3, s[8:11], s24 offen nt lds
    s_add_u32 m0, m0, 1056
    s_add_u32 s24, s24, -21504
    buffer_load_dwordx4 v3, s[8:11], s24 offen nt lds
    s_add_u32 m0, m0, 1056
    s_add_u32 s24, s24, 2048
    buffer_load_dwordx4 v3, s[8:11], s24 offen nt lds
    s_add_u32 m0, m0, 1056
    s_add_u32 s24, s24, 2048
    buffer_load_dwordx4 v3, s[8:11], s24 offen nt lds
    s_add_u32 m0, m0, 1056
    s_add_u32 s24, s24, 2048
    buffer_load_dwordx4 v3, s[8:11], s24 offen nt lds
    s_add_u32 m0, m0, 1056
    s_add_u32 s24, s24, 10240
    buffer_load_dwordx4 v3, s[8:11], s24 offen nt lds
    s_add_u32 m0, m0, 1056
    s_add_u32 s24, s24, 2048
    buffer_load_dwordx4 v3, s[8:11], s24 offen nt lds
    s_add_u32 m0, m0, 1056
    s_add_u32 s24, s24, 2048
    buffer_load_dwordx4 v3, s[8:11], s24 offen nt lds
    s_add_u32 m0, m0, 1056
    s_add_u32 s24, s24, 2048
    buffer_load_dwordx4 v3, s[8:11], s24 offen nt lds
    s_waitcnt vmcnt(0)
    s_barrier
    v_lshrrev_b32 v3, 2, v0
    v_mul_u32_u24 v3, 1056, v3
    v_and_b32 v4, 3, v0
    v_lshl_add_u32 v3, v4, 3, v3
    s_lshl_b32 s24, s3, 7
    v_add_u32 v3, s24, v3
    ds_read_b64_tr_b16 a[128:129], v3 offset:0
    ds_read_b64_tr_b16 a[130:131], v3 offset:512
    ds_read_b64_tr_b16 a[144:145], v3 offset:32
    ds_read_b64_tr_b16 a[146:147], v3 offset:544
    ds_read_b64_tr_b16 a[160:161], v3 offset:64
    ds_read_b64_tr_b16 a[162:163], v3 offset:576
    ds_read_b64_tr_b16 a[176:177], v3 offset:96
    ds_read_b64_tr_b16 a[178:179], v3 offset:608
    ds_read_b64_tr_b16 a[132:133], v3 offset:16896
    ds_read_b64_tr_b16 a[134:135], v3 offset:17408
    ds_read_b64_tr_b16 a[148:149], v3 offset:16928
    ds_read_b64_tr_b16 a[150:151], v3 offset:17440
    ds_read_b64_tr_b16 a[164:165], v3 offset:16960
    ds_read_b64_tr_b16 a[166:167], v3 offset:17472
    ds_read_b64_tr_b16 a[180:181], v3 offset:16992
    ds_read_b64_tr_b16 a[182:183], v3 offset:17504
    ds_read_b64_tr_b16 a[136:137], v3 offset:33792
    ds_read_b64_tr_b16 a[138:139], v3 offset:34304
    ds_read_b64_tr_b16 a[152:153], v3 offset:33824
    ds_read_b64_tr_b16 a[154:155], v3 offset:34336
    ds_read_b64_tr_b16 a[168:169], v3 offset:33856
    ds_read_b64_tr_b16 a[170:171], v3 offset:34368
    ds_read_b64_tr_b16 a[184:185], v3 offset:33888
    ds_read_b64_tr_b16 a[186:187], v3 offset:34400
    ds_read_b64_tr_b16 a[140:141], v3 offset:50688
    ds_read_b64_tr_b16 a[142:143], v3 offset:51200
    ds_read_b64_tr_b16 a[156:157], v3 offset:50720
    ds_read_b64_tr_b16 a[158:159], v3 offset:51232
    ds_read_b64_tr_b16 a[172:173], v3 offset:50752
    ds_read_b64_tr_b16 a[174:175], v3 offset:51264
    ds_read_b64_tr_b16 a[188:189], v3 offset:50784
    ds_read_b64_tr_b16 a[190:191], v3 offset:51296
    s_and_b32 s70, s72, 3
    s_lshr_b32 s71, s72, 4
    s_bfe_u32 s24, s72, 0x10002
    s_lshl_b32 s24, s24, 1
    s_add_u32 s71, s71, s24
    s_bfe_u32 s75, s72, 0x10003
    s_lshl_b32 s30, s71, 22
    s_add_u32 s4, s38, s30
    s_addc_u32 s5, s39, 0
    s_mov_b32 s6, 0x400000
    s_mov_b32 s7, 0x20000
    s_mul_i32 s32, s3, 65536
    s_lshl_b32 s24, s70, 10
    s_add_u32 s32, s32, s24
    s_mul_i32 s34, s3, 16896
    s_waitcnt lgkmcnt(0)
    s_barrier
    s_add_u32 m0, s34, 0
    s_nop 0
    buffer_load_dwordx4 v2, s[4:7], s32 offen  lds
    s_add_u32 m0, m0, 1056
    s_add_u32 s32, s32, 4096
    buffer_load_dwordx4 v2, s[4:7], s32 offen  lds
    s_add_u32 m0, m0, 1056
    s_add_u32 s32, s32, 4096
    buffer_load_dwordx4 v2, s[4:7], s32 offen  lds
    s_add_u32 m0, m0, 1056
    s_add_u32 s32, s32, 4096
    buffer_load_dwordx4 v2, s[4:7], s32 offen  lds
    s_add_u32 m0, m0, 1056
    s_add_u32 s32, s32, 4096
    buffer_load_dwordx4 v2, s[4:7], s32 offen  lds
    s_add_u32 m0, m0, 1056
    s_add_u32 s32, s32, 4096
    buffer_load_dwordx4 v2, s[4:7], s32 offen  lds
    s_add_u32 m0, m0, 1056
    s_add_u32 s32, s32, 4096
    buffer_load_dwordx4 v2, s[4:7], s32 offen  lds
    s_add_u32 m0, m0, 1056
    s_add_u32 s32, s32, 4096
    buffer_load_dwordx4 v2, s[4:7], s32 offen  lds
    s_add_u32 m0, m0, 1056
    s_add_u32 s32, s32, 4096
    buffer_load_dwordx4 v2, s[4:7], s32 offen  lds
    s_add_u32 m0, m0, 1056
    s_add_u32 s32, s32, 4096
    buffer_load_dwordx4 v2, s[4:7], s32 offen  lds
    s_add_u32 m0, m0, 1056
    s_add_u32 s32, s32, 4096
    buffer_load_dwordx4 v2, s[4:7], s32 offen  lds
    s_add_u32 m0, m0, 1056
    s_add_u32 s32, s32, 4096
    buffer_load_dwordx4 v2, s[4:7], s32 offen  lds
    s_add_u32 m0, m0, 1056
    s_add_u32 s32, s32, 4096
    buffer_load_dwordx4 v2, s[4:7], s32 offen  lds
    s_add_u32 m0, m0, 1056
    s_add_u32 s32, s32, 4096
    buffer_load_dwordx4 v2, s[4:7], s32 offen  lds
    s_add_u32 m0, m0, 1056
    s_add_u32 s32, s32, 4096
    buffer_load_dwordx4 v2, s[4:7], s32 offen  lds
    s_add_u32 m0, m0, 1056
    s_add_u32 s32, s32, 4096
    buffer_load_dwordx4 v2, s[4:7], s32 offen  lds
    s_add_u32 m0, m0, 1056
    s_add_u32 s32, s32, 200704
    s_lshr_b32 s28, s3, 1
    s_and_b32 s29, s3, 1
    v_and_b32 v3, 15, v0
    v_lshrrev_b32 v4, 4, v0
    v_mul_u32_u24 v19, 1056, v3
    v_lshl_add_u32 v19, v4, 4, v19
    v_lshrrev_b32 v5, 2, v0
    v_mul_u32_u24 v20, 1056, v5
    v_and_b32 v5, 3, v0
    v_lshl_add_u32 v20, v5, 3, v20
    s_lshl_b32 s24, s29, 9
    v_add_u32 v20, s24, v20
    v_and_b32 v3, 15, v0
    v_mul_u32_u24 v18, 1056, v3
    v_lshl_add_u32 v18, v4, 4, v18
    v_add_u32 v18, 101376, v18
    s_mul_i32 s24, s28, 33792
    v_add_u32 v19, s24, v19
    v_add_u32 v20, s24, v20
    v_mov_b32 v128, 0
    v_mov_b32 v129, 0
    v_mov_b32 v130, 0
    v_mov_b32 v131, 0
    v_mov_b32 v132, 0
    v_mov_b32 v133, 0
    v_mov_b32 v134, 0
    v_mov_b32 v135, 0
    v_mov_b32 v136, 0
    v_mov_b32 v137, 0
    v_mov_b32 v138, 0
    v_mov_b32 v139, 0
    v_mov_b32 v140, 0
    v_mov_b32 v141, 0
    v_mov_b32 v142, 0
    v_mov_b32 v143, 0
    v_mov_b32 v144, 0
    v_mov_b32 v145, 0
    v_mov_b32 v146, 0
    v_mov_b32 v147, 0
    v_mov_b32 v148, 0
    v_mov_b32 v149, 0
    v_mov_b32 v150, 0
    v_mov_b32 v151, 0
    v_mov_b32 v152, 0
    v_mov_b32 v153, 0
    v_mov_b32 v154, 0
    v_mov_b32 v155, 0
    v_mov_b32 v156, 0
    v_mov_b32 v157, 0
    v_mov_b32 v158, 0
    v_mov_b32 v159, 0
    v_mov_b32 v160, 0
    v_mov_b32 v161, 0
    v_mov_b32 v162, 0
    v_mov_b32 v163, 0
    v_mov_b32 v164, 0
    v_mov_b32 v165, 0
    v_mov_b32 v166, 0
    v_mov_b32 v167, 0
    v_mov_b32 v168, 0
    v_mov_b32 v169, 0
    v_mov_b32 v170, 0
    v_mov_b32 v171, 0
    v_mov_b32 v172, 0
    v_mov_b32 v173, 0
    v_mov_b32 v174, 0
    v_mov_b32 v175, 0
    v_mov_b32 v176, 0
    v_mov_b32 v177, 0
    v_mov_b32 v178, 0
    v_mov_b32 v179, 0
    v_mov_b32 v180, 0
    v_mov_b32 v181, 0
    v_mov_b32 v182, 0
    v_mov_b32 v183, 0
    v_mov_b32 v184, 0
    v_mov_b32 v185, 0
    v_mov_b32 v186, 0
    v_mov_b32 v187, 0
    v_mov_b32 v188, 0
    v_mov_b32 v189, 0
    v_mov_b32 v190, 0
    v_mov_b32 v191, 0
    v_mov_b32 v22, 0xff800000
    v_mov_b32 v23, 0
    s_cmp_lg_u32 s3, 0
    s_cbranch_scc1 L_awx18
    s_mov_b32 s24, 262144
    s_mov_b64 exec, 1
L_aw19:
    buffer_load_dword v1, off, s[12:15], s73 offset:0 sc1
    s_waitcnt vmcnt(0)
    v_readfirstlane_b32 s25, v1
    s_nop 0
    s_cmp_eq_u32 s25, 1
    s_cbranch_scc1 L_awx18
    s_sleep 4
    s_sub_u32 s24, s24, 1
    s_cmp_lg_u32 s24, 0
    s_cbranch_scc1 L_aw19
L_awx18:
    s_mov_b64 exec, -1
    s_barrier
    s_lshl_b32 s24, s71, 15
    s_mul_i32 s25, s3, 4096
    s_add_u32 s24, s24, s25
    s_add_u32 s24, s24, 0x0
    s_mul_i32 s25, s75, 16384
    s_add_u32 s24, s24, s25
    buffer_load_dwordx4 v[32:35], v2, s[12:15], s24 offen offset:0 sc1
    buffer_load_dwordx4 v[36:39], v2, s[12:15], s24 offen offset:1024 sc1
    buffer_load_dwordx4 v[40:43], v2, s[12:15], s24 offen offset:2048 sc1
    buffer_load_dwordx4 v[44:47], v2, s[12:15], s24 offen offset:3072 sc1
    s_add_u32 s24, s24, 4096
    s_mul_i32 s24, s3, 4224
    s_add_u32 s24, s24, 101376
    v_add_u32 v3, s24, v2
    s_waitcnt vmcnt(3)
    ds_write_b128 v3, v[32:35] offset:0
    s_waitcnt vmcnt(2)
    ds_write_b128 v3, v[36:39] offset:1056
    s_waitcnt vmcnt(1)
    ds_write_b128 v3, v[40:43] offset:2112
    s_waitcnt vmcnt(0)
    ds_write_b128 v3, v[44:47] offset:3168
    s_waitcnt lgkmcnt(0)
    s_barrier
    ds_read_b128 a[0:3], v18 offset:0
    ds_read_b128 a[4:7], v18 offset:64
    ds_read_b128 a[8:11], v18 offset:128
    ds_read_b128 a[12:15], v18 offset:192
    ds_read_b128 a[16:19], v18 offset:256
    ds_read_b128 a[20:23], v18 offset:320
    ds_read_b128 a[24:27], v18 offset:384
    ds_read_b128 a[28:31], v18 offset:448
    ds_read_b128 a[32:35], v18 offset:512
    ds_read_b128 a[36:39], v18 offset:576
    ds_read_b128 a[40:43], v18 offset:640
    ds_read_b128 a[44:47], v18 offset:704
    ds_read_b128 a[48:51], v18 offset:768
    ds_read_b128 a[52:55], v18 offset:832
    ds_read_b128 a[56:59], v18 offset:896
    ds_read_b128 a[60:63], v18 offset:960
    s_cmp_lg_u32 s3, 0
    s_cbranch_scc1 L_xi20
    s_getreg_b32 s25, hwreg(HW_REG_XCC_ID, 0, 4)
    s_lshl_b32 s24, s26, 7
    s_add_u32 s24, s24, 0x1b6000
    s_mov_b64 exec, 1
    v_mov_b32 v3, s25
    buffer_store_dword v3, off, s[12:15], s24 offset:4 sc1
    s_mov_b64 exec, -1
L_xi20:
    s_mov_b32 s27, 0
    s_mov_b32 s33, 67584
    s_mov_b32 s35, 0
    s_waitcnt lgkmcnt(0)
L_CT:
    s_waitcnt vmcnt(0)
    s_barrier
    v_add_u32 v24, s35, v19
    v_add_u32 v25, s35, v20
    ds_read_b128 v[32:35], v24 offset:0
    ds_read_b128 v[36:39], v24 offset:16896
    ds_read_b128 v[40:43], v24 offset:64
    ds_read_b128 v[44:47], v24 offset:16960
    ds_read_b128 v[48:51], v24 offset:128
    ds_read_b128 v[52:55], v24 offset:17024
    ds_read_b128 v[56:59], v24 offset:192
    s_add_u32 m0, s33, s34
    s_mov_b32 s33, s35
    s_add_u32 s35, s35, 67584
    s_cmp_eq_u32 s35, 135168
    s_cselect_b32 s35, 0, s35
    s_waitcnt lgkmcnt(6)
    v_mfma_f32_16x16x32_bf16 v[64:67], v[32:35], a[0:3], 0
    ds_read_b128 v[60:63], v24 offset:17088
    buffer_load_dwordx4 v2, s[4:7], s32 offen  lds
    s_add_u32 m0, m0, 1056
    s_add_u32 s32, s32, 4096
    s_waitcnt lgkmcnt(6)
    v_mfma_f32_16x16x32_bf16 v[68:71], v[36:39], a[0:3], 0
    ds_read_b128 v[32:35], v24 offset:256
    s_waitcnt lgkmcnt(6)
    v_mfma_f32_16x16x32_bf16 v[64:67], v[40:43], a[4:7], v[64:67]
    ds_read_b128 v[36:39], v24 offset:17152
    buffer_load_dwordx4 v2, s[4:7], s32 offen  lds
    s_add_u32 m0, m0, 1056
    s_add_u32 s32, s32, 4096
    s_waitcnt lgkmcnt(6)
    v_mfma_f32_16x16x32_bf16 v[68:71], v[44:47], a[4:7], v[68:71]
    ds_read_b128 v[40:43], v24 offset:320
    s_waitcnt lgkmcnt(6)
    v_mfma_f32_16x16x32_bf16 v[64:67], v[48:51], a[8:11], v[64:67]
    ds_read_b128 v[44:47], v24 offset:17216
    buffer_load_dwordx4 v2, s[4:7], s32 offen  lds
    s_add_u32 m0, m0, 1056
    s_add_u32 s32, s32, 4096
    s_waitcnt lgkmcnt(6)
    v_mfma_f32_16x16x32_bf16 v[68:71], v[52:55], a[8:11], v[68:71]
    ds_read_b128 v[48:51], v24 offset:384
    s_waitcnt lgkmcnt(6)
    v_mfma_f32_16x16x32_bf16 v[64:67], v[56:59], a[12:15], v[64:67]
    ds_read_b128 v[52:55], v24 offset:17280
    buffer_load_dwordx4 v2, s[4:7], s32 offen  lds
    s_add_u32 m0, m0, 1056
    s_add_u32 s32, s32, 4096
    s_waitcnt lgkmcnt(6)
    v_mfma_f32_16x16x32_bf16 v[68:71], v[60:63], a[12:15], v[68:71]
    ds_read_b128 v[56:59], v24 offset:448
    s_waitcnt lgkmcnt(6)
    v_mfma_f32_16x16x32_bf16 v[64:67], v[32:35], a[16:19], v[64:67]
    ds_read_b128 v[60:63], v24 offset:17344
    buffer_load_dwordx4 v2, s[4:7], s32 offen  lds
    s_add_u32 m0, m0, 1056
    s_add_u32 s32, s32, 4096
    s_waitcnt lgkmcnt(6)
    v_mfma_f32_16x16x32_bf16 v[68:71], v[36:39], a[16:19], v[68:71]
    ds_read_b128 v[32:35], v24 offset:512
    s_waitcnt lgkmcnt(6)
    v_mfma_f32_16x16x32_bf16 v[64:67], v[40:43], a[20:23], v[64:67]
    ds_read_b128 v[36:39], v24 offset:17408
    buffer_load_dwordx4 v2, s[4:7], s32 offen  lds
    s_add_u32 m0, m0, 1056
    s_add_u32 s32, s32, 4096
    s_waitcnt lgkmcnt(6)
    v_mfma_f32_16x16x32_bf16 v[68:71], v[44:47], a[20:23], v[68:71]
    ds_read_b128 v[40:43], v24 offset:576
    s_waitcnt lgkmcnt(6)
    v_mfma_f32_16x16x32_bf16 v[64:67], v[48:51], a[24:27], v[64:67]
    ds_read_b128 v[44:47], v24 offset:17472
    buffer_load_dwordx4 v2, s[4:7], s32 offen  lds
    s_add_u32 m0, m0, 1056
    s_add_u32 s32, s32, 4096
    s_waitcnt lgkmcnt(6)
    v_mfma_f32_16x16x32_bf16 v[68:71], v[52:55], a[24:27], v[68:71]
    ds_read_b128 v[48:51], v24 offset:640
    s_waitcnt lgkmcnt(6)
    v_mfma_f32_16x16x32_bf16 v[64:67], v[56:59], a[28:31], v[64:67]
    ds_read_b128 v[52:55], v24 offset:17536
    buffer_load_dwordx4 v2, s[4:7], s32 offen  lds
    s_add_u32 m0, m0, 1056
    s_add_u32 s32, s32, 4096
    s_waitcnt lgkmcnt(6)
    v_mfma_f32_16x16x32_bf16 v[68:71], v[60:63], a[28:31], v[68:71]
    ds_read_b128 v[56:59], v24 offset:704
    s_waitcnt lgkmcnt(6)
    v_mfma_f32_16x16x32_bf16 v[64:67], v[32:35], a[32:35], v[64:67]
    ds_read_b128 v[60:63], v24 offset:17600
    buffer_load_dwordx4 v2, s[4:7], s32 offen  lds
    s_add_u32 m0, m0, 1056
    s_add_u32 s32, s32, 4096
    s_waitcnt lgkmcnt(6)
    v_mfma_f32_16x16x32_bf16 v[68:71], v[36:39], a[32:35], v[68:71]
    ds_read_b128 v[32:35], v24 offset:768
    s_waitcnt lgkmcnt(6)
    v_mfma_f32_16x16x32_bf16 v[64:67], v[40:43], a[36:39], v[64:67]
    ds_read_b128 v[36:39], v24 offset:17664
    buffer_load_dwordx4 v2, s[4:7], s32 offen  lds
    s_add_u32 m0, m0, 1056
    s_add_u32 s32, s32, 4096
    s_waitcnt lgkmcnt(6)
    v_mfma_f32_16x16x32_bf16 v[68:71], v[44:47], a[36:39], v[68:71]
    ds_read_b128 v[40:43], v24 offset:832
    s_waitcnt lgkmcnt(6)
    v_mfma_f32_16x16x32_bf16 v[64:67], v[48:51], a[40:43], v[64:67]
    ds_read_b128 v[44:47], v24 offset:17728
    buffer_load_dwordx4 v2, s[4:7], s32 offen  lds
    s_add_u32 m0, m0, 1056
    s_add_u32 s32, s32, 4096
    s_waitcnt lgkmcnt(6)
    v_mfma_f32_16x16x32_bf16 v[68:71], v[52:55], a[40:43], v[68:71]
    ds_read_b128 v[48:51], v24 offset:896
    s_waitcnt lgkmcnt(6)
    v_mfma_f32_16x16x32_bf16 v[64:67], v[56:59], a[44:47], v[64:67]
    ds_read_b128 v[52:55], v24 offset:17792
    buffer_load_dwordx4 v2, s[4:7], s32 offen  lds
    s_add_u32 m0, m0, 1056
    s_add_u32 s32, s32, 4096
    s_waitcnt lgkmcnt(6)
    v_mfma_f32_16x16x32_bf16 v[68:71], v[60:63], a[44:47], v[68:71]
    ds_read_b128 v[56:59], v24 offset:960
    s_waitcnt lgkmcnt(6)
    v_mfma_f32_16x16x32_bf16 v[64:67], v[32:35], a[48:51], v[64:67]
    ds_read_b128 v[60:63], v24 offset:17856
    buffer_load_dwordx4 v2, s[4:7], s32 offen  lds
    s_add_u32 m0, m0, 1056
    s_add_u32 s32, s32, 4096
    s_waitcnt lgkmcnt(6)
    v_mfma_f32_16x16x32_bf16 v[68:71], v[36:39], a[48:51], v[68:71]
    ds_read_b64_tr_b16 v[192:193], v25 offset:0
    s_waitcnt lgkmcnt(6)
    v_mfma_f32_16x16x32_bf16 v[64:67], v[40:43], a[52:55], v[64:67]
    ds_read_b64_tr_b16 v[194:195], v25 offset:16896
    buffer_load_dwordx4 v2, s[4:7], s32 offen  lds
    s_add_u32 m0, m0, 1056
    s_add_u32 s32, s32, 4096
    s_waitcnt lgkmcnt(6)
    v_mfma_f32_16x16x32_bf16 v[68:71], v[44:47], a[52:55], v[68:71]
    ds_read_b64_tr_b16 v[196:197], v25 offset:32
    s_waitcnt lgkmcnt(6)
    v_mfma_f32_16x16x32_bf16 v[64:67], v[48:51], a[56:59], v[64:67]
    ds_read_b64_tr_b16 v[198:199], v25 offset:16928
    buffer_load_dwordx4 v2, s[4:7], s32 offen  lds
    s_add_u32 m0, m0, 1056
    s_add_u32 s32, s32, 4096
    s_waitcnt lgkmcnt(6)
    v_mfma_f32_16x16x32_bf16 v[68:71], v[52:55], a[56:59], v[68:71]
    ds_read_b64_tr_b16 v[200:201], v25 offset:64
    s_waitcnt lgkmcnt(6)
    v_mfma_f32_16x16x32_bf16 v[64:67], v[56:59], a[60:63], v[64:67]
    ds_read_b64_tr_b16 v[202:203], v25 offset:16960
    buffer_load_dwordx4 v2, s[4:7], s32 offen  lds
    s_add_u32 m0, m0, 1056
    s_add_u32 s32, s32, 200704
    s_waitcnt lgkmcnt(6)
    v_mfma_f32_16x16x32_bf16 v[68:71], v[60:63], a[60:63], v[68:71]
    ds_read_b64_tr_b16 v[204:205], v25 offset:96
    ds_read_b64_tr_b16 v[206:207], v25 offset:16992
    ds_read_b64_tr_b16 v[208:209], v25 offset:128
    ds_read_b64_tr_b16 v[210:211], v25 offset:17024
    ds_read_b64_tr_b16 v[212:213], v25 offset:160
    ds_read_b64_tr_b16 v[214:215], v25 offset:17056
    ds_read_b64_tr_b16 v[216:217], v25 offset:192
    ds_read_b64_tr_b16 v[218:219], v25 offset:17088
    v_max3_f32 v3, v64, v65, v22
    v_max3_f32 v3, v3, v66, v67
    v_max3_f32 v3, v3, v68, v69
    v_max3_f32 v3, v3, v70, v71
    v_mov_b32 v4, v3
    ds_read_b64_tr_b16 v[220:221], v25 offset:224
    s_nop 0
    v_permlane32_swap_b32 v3, v4
    ds_read_b64_tr_b16 v[222:223], v25 offset:17120
    v_max_f32 v3, v3, v4
    ds_read_b64_tr_b16 v[224:225], v25 offset:256
    v_mov_b32 v4, v3
    ds_read_b64_tr_b16 v[226:227], v25 offset:17152
    s_nop 0
    v_permlane16_swap_b32 v3, v4
    ds_read_b64_tr_b16 v[228:229], v25 offset:288
    v_max_f32 v3, v3, v4
    ds_read_b64_tr_b16 v[230:231], v25 offset:17184
    v_sub_f32 v4, v22, v3
    ds_read_b64_tr_b16 v[232:233], v25 offset:320
    v_exp_f32 v4, v4
    ds_read_b64_tr_b16 v[234:235], v25 offset:17216
    v_mov_b32 v22, v3
    ds_read_b64_tr_b16 v[236:237], v25 offset:352
    v_sub_f32 v64, v64, v3
    ds_read_b64_tr_b16 v[238:239], v25 offset:17248
    v_sub_f32 v65, v65, v3
    ds_read_b64_tr_b16 v[240:241], v25 offset:384
    v_sub_f32 v66, v66, v3
    ds_read_b64_tr_b16 v[242:243], v25 offset:17280
    v_sub_f32 v67, v67, v3
    ds_read_b64_tr_b16 v[244:245], v25 offset:416
    v_sub_f32 v68, v68, v3
    ds_read_b64_tr_b16 v[246:247], v25 offset:17312
    v_sub_f32 v69, v69, v3
    ds_read_b64_tr_b16 v[248:249], v25 offset:448
    v_sub_f32 v70, v70, v3
    ds_read_b64_tr_b16 v[250:251], v25 offset:17344
    v_sub_f32 v71, v71, v3
    ds_read_b64_tr_b16 v[252:253], v25 offset:480
    v_exp_f32 v64, v64
    ds_read_b64_tr_b16 v[254:255], v25 offset:17376
    v_exp_f32 v65, v65
    v_exp_f32 v66, v66
    v_exp_f32 v67, v67
    v_exp_f32 v68, v68
    v_exp_f32 v69, v69
    v_exp_f32 v70, v70
    v_exp_f32 v71, v71
    v_cvt_pk_bf16_f32 v72, v64, v65
    v_cvt_pk_bf16_f32 v73, v66, v67
    v_cvt_pk_bf16_f32 v74, v68, v69
    v_cvt_pk_bf16_f32 v75, v70, v71
    v_pk_mul_f32 v[128:129], v[128:129], v[4:5] op_sel_hi:[1,0]
    v_pk_mul_f32 v[130:131], v[130:131], v[4:5] op_sel_hi:[1,0]
    v_pk_mul_f32 v[132:133], v[132:133], v[4:5] op_sel_hi:[1,0]
    v_pk_mul_f32 v[134:135], v[134:135], v[4:5] op_sel_hi:[1,0]
    s_waitcnt lgkmcnt(0)
    v_mfma_f32_16x16x32_bf16 v[128:131], v[192:195], v[72:75], v[128:131]
    v_pk_mul_f32 v[136:137], v[136:137], v[4:5] op_sel_hi:[1,0]
    v_pk_mul_f32 v[138:139], v[138:139], v[4:5] op_sel_hi:[1,0]
    v_mfma_f32_16x16x32_bf16 v[132:135], v[196:199], v[72:75], v[132:135]
    v_pk_mul_f32 v[140:141], v[140:141], v[4:5] op_sel_hi:[1,0]
    v_pk_mul_f32 v[142:143], v[142:143], v[4:5] op_sel_hi:[1,0]
    v_mfma_f32_16x16x32_bf16 v[136:139], v[200:203], v[72:75], v[136:139]
    v_pk_mul_f32 v[144:145], v[144:145], v[4:5] op_sel_hi:[1,0]
    v_pk_mul_f32 v[146:147], v[146:147], v[4:5] op_sel_hi:[1,0]
    v_mfma_f32_16x16x32_bf16 v[140:143], v[204:207], v[72:75], v[140:143]
    v_pk_mul_f32 v[148:149], v[148:149], v[4:5] op_sel_hi:[1,0]
    v_pk_mul_f32 v[150:151], v[150:151], v[4:5] op_sel_hi:[1,0]
    v_mfma_f32_16x16x32_bf16 v[144:147], v[208:211], v[72:75], v[144:147]
    v_pk_mul_f32 v[152:153], v[152:153], v[4:5] op_sel_hi:[1,0]
    v_pk_mul_f32 v[154:155], v[154:155], v[4:5] op_sel_hi:[1,0]
    v_mfma_f32_16x16x32_bf16 v[148:151], v[212:215], v[72:75], v[148:151]
    v_pk_mul_f32 v[156:157], v[156:157], v[4:5] op_sel_hi:[1,0]
    v_pk_mul_f32 v[158:159], v[158:159], v[4:5] op_sel_hi:[1,0]
    v_mfma_f32_16x16x32_bf16 v[152:155], v[216:219], v[72:75], v[152:155]
    v_pk_mul_f32 v[160:161], v[160:161], v[4:5] op_sel_hi:[1,0]
    v_pk_mul_f32 v[162:163], v[162:163], v[4:5] op_sel_hi:[1,0]
    v_mfma_f32_16x16x32_bf16 v[156:159], v[220:223], v[72:75], v[156:159]
    v_pk_mul_f32 v[164:165], v[164:165], v[4:5] op_sel_hi:[1,0]
    v_pk_mul_f32 v[166:167], v[166:167], v[4:5] op_sel_hi:[1,0]
    v_mfma_f32_16x16x32_bf16 v[160:163], v[224:227], v[72:75], v[160:163]
    v_pk_mul_f32 v[168:169], v[168:169], v[4:5] op_sel_hi:[1,0]
    v_pk_mul_f32 v[170:171], v[170:171], v[4:5] op_sel_hi:[1,0]
    v_mfma_f32_16x16x32_bf16 v[164:167], v[228:231], v[72:75], v[164:167]
    v_pk_mul_f32 v[172:173], v[172:173], v[4:5] op_sel_hi:[1,0]
    v_pk_mul_f32 v[174:175], v[174:175], v[4:5] op_sel_hi:[1,0]
    v_mfma_f32_16x16x32_bf16 v[168:171], v[232:235], v[72:75], v[168:171]
    v_pk_mul_f32 v[176:177], v[176:177], v[4:5] op_sel_hi:[1,0]
    v_pk_mul_f32 v[178:179], v[178:179], v[4:5] op_sel_hi:[1,0]
    v_mfma_f32_16x16x32_bf16 v[172:175], v[236:239], v[72:75], v[172:175]
    v_pk_mul_f32 v[180:181], v[180:181], v[4:5] op_sel_hi:[1,0]
    v_pk_mul_f32 v[182:183], v[182:183], v[4:5] op_sel_hi:[1,0]
    v_mfma_f32_16x16x32_bf16 v[176:179], v[240:243], v[72:75], v[176:179]
    v_pk_mul_f32 v[184:185], v[184:185], v[4:5] op_sel_hi:[1,0]
    v_pk_mul_f32 v[186:187], v[186:187], v[4:5] op_sel_hi:[1,0]
    v_mfma_f32_16x16x32_bf16 v[180:183], v[244:247], v[72:75], v[180:183]
    v_pk_mul_f32 v[188:189], v[188:189], v[4:5] op_sel_hi:[1,0]
    v_pk_mul_f32 v[190:191], v[190:191], v[4:5] op_sel_hi:[1,0]
    v_mfma_f32_16x16x32_bf16 v[184:187], v[248:251], v[72:75], v[184:187]
    s_nop 0
    v_mfma_f32_16x16x32_bf16 v[188:191], v[252:255], v[72:75], v[188:191]
    v_fma_f32 v23, v23, v4, v64
    v_add_f32 v23, v23, v65
    v_add_f32 v23, v23, v66
    v_add_f32 v23, v23, v67
    v_add_f32 v23, v23, v68
    v_add_f32 v23, v23, v69
    v_add_f32 v23, v23, v70
    v_add_f32 v23, v23, v71
    s_add_u32 s27, s27, 1
    s_cmp_lt_u32 s27, 16
    s_cbranch_scc1 L_CT
    s_waitcnt vmcnt(0)
    s_barrier
    v_mov_b32 v4, v23
    s_nop 1
    v_permlane32_swap_b32 v23, v4
    v_add_f32 v23, v23, v4
    v_mov_b32 v4, v23
    s_nop 1
    v_permlane16_swap_b32 v23, v4
    v_add_f32 v23, v23, v4
    s_lshl_b32 s24, s3, 9
    v_lshl_add_u32 v3, v0, 3, s24
    ds_write_b64 v3, v[22:23] offset:0
    v_xor_b32 v3, 0x400, v3
    s_waitcnt lgkmcnt(0)
    s_barrier
    ds_read_b64 v[6:7], v3 offset:0
    s_waitcnt lgkmcnt(0)
    v_max_f32 v3, v22, v6
    v_sub_f32 v4, v22, v3
    v_sub_f32 v6, v6, v3
    v_exp_f32 v4, v4
    v_exp_f32 v6, v6
    v_mov_b32 v22, v3
    v_mul_f32 v23, v23, v4
    v_fmac_f32 v23, v7, v6
    v_and_b32 v3, 15, v0
    v_lshlrev_b32 v5, 3, v3
    s_lshl_b32 s24, s71, 2
    s_add_u32 s31, s24, s70
    s_lshl_b32 s24, s31, 8
    s_mul_i32 s25, s75, 128
    s_add_u32 s24, s24, s25
    s_add_u32 s24, s24, 0x120000
    s_cmp_lg_u32 s3, 0
    s_cbranch_scc1 L_C_ml
    s_mov_b64 exec, 0xffff
    buffer_store_dwordx2 v[22:23], v5, s[12:15], s24 offen sc1
    s_mov_b64 exec, -1
L_C_ml:
    v_pk_mul_f32 v[128:129], v[128:129], v[4:5] op_sel_hi:[1,0]
    v_pk_mul_f32 v[130:131], v[130:131], v[4:5] op_sel_hi:[1,0]
    v_pk_mul_f32 v[132:133], v[132:133], v[4:5] op_sel_hi:[1,0]
    v_pk_mul_f32 v[134:135], v[134:135], v[4:5] op_sel_hi:[1,0]
    v_pk_mul_f32 v[136:137], v[136:137], v[4:5] op_sel_hi:[1,0]
    v_pk_mul_f32 v[138:139], v[138:139], v[4:5] op_sel_hi:[1,0]
    v_pk_mul_f32 v[140:141], v[140:141], v[4:5] op_sel_hi:[1,0]
    v_pk_mul_f32 v[142:143], v[142:143], v[4:5] op_sel_hi:[1,0]
    v_pk_mul_f32 v[144:145], v[144:145], v[4:5] op_sel_hi:[1,0]
    v_pk_mul_f32 v[146:147], v[146:147], v[4:5] op_sel_hi:[1,0]
    v_pk_mul_f32 v[148:149], v[148:149], v[4:5] op_sel_hi:[1,0]
    v_pk_mul_f32 v[150:151], v[150:151], v[4:5] op_sel_hi:[1,0]
    v_pk_mul_f32 v[152:153], v[152:153], v[4:5] op_sel_hi:[1,0]
    v_pk_mul_f32 v[154:155], v[154:155], v[4:5] op_sel_hi:[1,0]
    v_pk_mul_f32 v[156:157], v[156:157], v[4:5] op_sel_hi:[1,0]
    v_pk_mul_f32 v[158:159], v[158:159], v[4:5] op_sel_hi:[1,0]
    v_pk_mul_f32 v[160:161], v[160:161], v[4:5] op_sel_hi:[1,0]
    v_pk_mul_f32 v[162:163], v[162:163], v[4:5] op_sel_hi:[1,0]
    v_pk_mul_f32 v[164:165], v[164:165], v[4:5] op_sel_hi:[1,0]
    v_pk_mul_f32 v[166:167], v[166:167], v[4:5] op_sel_hi:[1,0]
    v_pk_mul_f32 v[168:169], v[168:169], v[4:5] op_sel_hi:[1,0]
    v_pk_mul_f32 v[170:171], v[170:171], v[4:5] op_sel_hi:[1,0]
    v_pk_mul_f32 v[172:173], v[172:173], v[4:5] op_sel_hi:[1,0]
    v_pk_mul_f32 v[174:175], v[174:175], v[4:5] op_sel_hi:[1,0]
    v_pk_mul_f32 v[176:177], v[176:177], v[4:5] op_sel_hi:[1,0]
    v_pk_mul_f32 v[178:179], v[178:179], v[4:5] op_sel_hi:[1,0]
    v_pk_mul_f32 v[180:181], v[180:181], v[4:5] op_sel_hi:[1,0]
    v_pk_mul_f32 v[182:183], v[182:183], v[4:5] op_sel_hi:[1,0]
    v_pk_mul_f32 v[184:185], v[184:185], v[4:5] op_sel_hi:[1,0]
    v_pk_mul_f32 v[186:187], v[186:187], v[4:5] op_sel_hi:[1,0]
    v_pk_mul_f32 v[188:189], v[188:189], v[4:5] op_sel_hi:[1,0]
    v_pk_mul_f32 v[190:191], v[190:191], v[4:5] op_sel_hi:[1,0]
    s_lshl_b32 s24, s3, 13
    s_add_u32 s24, s24, 4096
    v_add_u32 v6, s24, v2
    s_xor_b32 s24, s3, 2
    s_lshl_b32 s24, s24, 13
    s_add_u32 s24, s24, 4096
    v_add_u32 v7, s24, v2
    s_cmp_lg_u32 s28, 0
    s_cbranch_scc1 L_C_x1
    ds_write_b128 v6, v[160:163] offset:0
    ds_write_b128 v6, v[164:167] offset:1024
    ds_write_b128 v6, v[168:171] offset:2048
    ds_write_b128 v6, v[172:175] offset:3072
    ds_write_b128 v6, v[176:179] offset:4096
    ds_write_b128 v6, v[180:183] offset:5120
    ds_write_b128 v6, v[184:187] offset:6144
    ds_write_b128 v6, v[188:191] offset:7168
    s_branch L_C_x2
L_C_x1:
    ds_write_b128 v6, v[128:131] offset:0
    ds_write_b128 v6, v[132:135] offset:1024
    ds_write_b128 v6, v[136:139] offset:2048
    ds_write_b128 v6, v[140:143] offset:3072
    ds_write_b128 v6, v[144:147] offset:4096
    ds_write_b128 v6, v[148:151] offset:5120
    ds_write_b128 v6, v[152:155] offset:6144
    ds_write_b128 v6, v[156:159] offset:7168
    s_waitcnt lgkmcnt(0)
    v_mov_b32 v128, v160
    v_mov_b32 v129, v161
    v_mov_b32 v130, v162
    v_mov_b32 v131, v163
    v_mov_b32 v132, v164
    v_mov_b32 v133, v165
    v_mov_b32 v134, v166
    v_mov_b32 v135, v167
    v_mov_b32 v136, v168
    v_mov_b32 v137, v169
    v_mov_b32 v138, v170
    v_mov_b32 v139, v171
    v_mov_b32 v140, v172
    v_mov_b32 v141, v173
    v_mov_b32 v142, v174
    v_mov_b32 v143, v175
    v_mov_b32 v144, v176
    v_mov_b32 v145, v177
    v_mov_b32 v146, v178
    v_mov_b32 v147, v179
    v_mov_b32 v148, v180
    v_mov_b32 v149, v181
    v_mov_b32 v150, v182
    v_mov_b32 v151, v183
    v_mov_b32 v152, v184
    v_mov_b32 v153, v185
    v_mov_b32 v154, v186
    v_mov_b32 v155, v187
    v_mov_b32 v156, v188
    v_mov_b32 v157, v189
    v_mov_b32 v158, v190
    v_mov_b32 v159, v191
L_C_x2:
    s_waitcnt lgkmcnt(0)
    s_barrier
    ds_read_b128 v[192:195], v7 offset:0
    ds_read_b128 v[196:199], v7 offset:1024
    ds_read_b128 v[200:203], v7 offset:2048
    ds_read_b128 v[204:207], v7 offset:3072
    ds_read_b128 v[208:211], v7 offset:4096
    ds_read_b128 v[212:215], v7 offset:5120
    ds_read_b128 v[216:219], v7 offset:6144
    ds_read_b128 v[220:223], v7 offset:7168
    v_lshrrev_b32 v4, 4, v0
    v_mul_u32_u24 v3, 272, v3
    v_lshl_add_u32 v3, v4, 3, v3
    s_mul_i32 s24, s3, 4352
    s_add_u32 s24, s24, 40960
    v_add_u32 v3, s24, v3
    s_waitcnt lgkmcnt(7)
    v_add_f32 v128, v128, v192
    v_add_f32 v129, v129, v193
    v_add_f32 v130, v130, v194
    v_add_f32 v131, v131, v195
    v_cvt_pk_bf16_f32 v32, v128, v129
    v_cvt_pk_bf16_f32 v33, v130, v131
    ds_write_b64 v3, v[32:33] offset:0
    s_waitcnt lgkmcnt(7)
    v_add_f32 v132, v132, v196
    v_add_f32 v133, v133, v197
    v_add_f32 v134, v134, v198
    v_add_f32 v135, v135, v199
    v_cvt_pk_bf16_f32 v34, v132, v133
    v_cvt_pk_bf16_f32 v35, v134, v135
    ds_write_b64 v3, v[34:35] offset:32
    s_waitcnt lgkmcnt(7)
    v_add_f32 v136, v136, v200
    v_add_f32 v137, v137, v201
    v_add_f32 v138, v138, v202
    v_add_f32 v139, v139, v203
    v_cvt_pk_bf16_f32 v36, v136, v137
    v_cvt_pk_bf16_f32 v37, v138, v139
    ds_write_b64 v3, v[36:37] offset:64
    s_waitcnt lgkmcnt(7)
    v_add_f32 v140, v140, v204
    v_add_f32 v141, v141, v205
    v_add_f32 v142, v142, v206
    v_add_f32 v143, v143, v207
    v_cvt_pk_bf16_f32 v38, v140, v141
    v_cvt_pk_bf16_f32 v39, v142, v143
    ds_write_b64 v3, v[38:39] offset:96
    s_waitcnt lgkmcnt(7)
    v_add_f32 v144, v144, v208
    v_add_f32 v145, v145, v209
    v_add_f32 v146, v146, v210
    v_add_f32 v147, v147, v211
    v_cvt_pk_bf16_f32 v40, v144, v145
    v_cvt_pk_bf16_f32 v41, v146, v147
    ds_write_b64 v3, v[40:41] offset:128
    s_waitcnt lgkmcnt(7)
    v_add_f32 v148, v148, v212
    v_add_f32 v149, v149, v213
    v_add_f32 v150, v150, v214
    v_add_f32 v151, v151, v215
    v_cvt_pk_bf16_f32 v42, v148, v149
    v_cvt_pk_bf16_f32 v43, v150, v151
    ds_write_b64 v3, v[42:43] offset:160
    s_waitcnt lgkmcnt(7)
    v_add_f32 v152, v152, v216
    v_add_f32 v153, v153, v217
    v_add_f32 v154, v154, v218
    v_add_f32 v155, v155, v219
    v_cvt_pk_bf16_f32 v44, v152, v153
    v_cvt_pk_bf16_f32 v45, v154, v155
    ds_write_b64 v3, v[44:45] offset:192
    s_waitcnt lgkmcnt(7)
    v_add_f32 v156, v156, v220
    v_add_f32 v157, v157, v221
    v_add_f32 v158, v158, v222
    v_add_f32 v159, v159, v223
    v_cvt_pk_bf16_f32 v46, v156, v157
    v_cvt_pk_bf16_f32 v47, v158, v159
    ds_write_b64 v3, v[46:47] offset:224
    v_and_b32 v5, 15, v0
    v_mul_u32_u24 v3, 272, v4
    v_lshl_add_u32 v3, v5, 4, v3
    v_add_u32 v3, s24, v3
    v_lshlrev_b32 v4, 10, v4
    v_lshl_add_u32 v4, v5, 4, v4
    s_waitcnt lgkmcnt(0)
    ds_read_b128 v[64:67], v3 offset:0
    ds_read_b128 v[68:71], v3 offset:1088
    ds_read_b128 v[72:75], v3 offset:2176
    ds_read_b128 v[76:79], v3 offset:3264
    s_lshl_b32 s24, s31, 15
    s_lshl_b32 s25, s29, 9
    s_add_u32 s24, s24, s25
    s_lshl_b32 s25, s28, 8
    s_add_u32 s24, s24, s25
    s_mul_i32 s25, s75, 16384
    s_add_u32 s24, s24, s25
    s_add_u32 s24, s24, 0x20000
    s_waitcnt lgkmcnt(3)
    buffer_store_dwordx4 v[64:67], v4, s[12:15], s24 offen sc1
    s_add_u32 s24, s24, 4096
    s_waitcnt lgkmcnt(2)
    buffer_store_dwordx4 v[68:71], v4, s[12:15], s24 offen sc1
    s_add_u32 s24, s24, 4096
    s_waitcnt lgkmcnt(1)
    buffer_store_dwordx4 v[72:75], v4, s[12:15], s24 offen sc1
    s_add_u32 s24, s24, 4096
    s_waitcnt lgkmcnt(0)
    buffer_store_dwordx4 v[76:79], v4, s[12:15], s24 offen sc1
    s_add_u32 s24, s24, 4096
    s_waitcnt vmcnt(0)
    s_barrier
    s_cmp_lg_u32 s3, 0
    s_cbranch_scc1 L_sig21
    s_mov_b64 exec, 1
    v_mov_b32 v3, 1
    buffer_atomic_add v3, off, s[16:19], 0 offset:4 sc0
    s_waitcnt vmcnt(0)
    v_readfirstlane_b32 s24, v3
    s_mov_b64 exec, -1
    s_and_b32 s24, s24, 31
    s_cmp_lg_u32 s24, 31
    s_cbranch_scc1 L_sig21
    v_lshlrev_b32 v4, 7, v0
    v_mov_b32 v3, 1
    s_mov_b32 s24, 0x170000
    buffer_store_dword v3, v4, s[12:15], s24 offen offset:4 sc1
L_sig21:
    s_branch L_R
L_last:
    s_endpgm
.section .rodata,"a"
.p2align 6
.amdhsa_kernel concat_heads__compressed_kv_cla__mha_block_cached__decode_kernel
  .amdhsa_next_free_vgpr 512
  .amdhsa_next_free_sgpr 102
  .amdhsa_accum_offset 256
  .amdhsa_group_segment_fixed_size 0
  .amdhsa_kernarg_size 112
  .amdhsa_user_sgpr_count 2
  .amdhsa_user_sgpr_kernarg_segment_ptr 1
  .amdhsa_system_sgpr_workgroup_id_x 1
  .amdhsa_float_denorm_mode_32 3
.end_amdhsa_kernel
```

```asm
; @launch grid=(256,1,1) block=(256,1,1) lds=149504
.amdgcn_target "amdgcn-amd-amdhsa--gfx950"
.text
.globl concat_heads__compressed_kv_cla__mha_block_cached__decode_kernel
.p2align 8
.type concat_heads__compressed_kv_cla__mha_block_cached__decode_kernel,@function
concat_heads__compressed_kv_cla__mha_block_cached__decode_kernel:
    s_load_dwordx16 s[36:51], s[0:1], 0
    s_load_dwordx8 s[52:59], s[0:1], 64
    s_load_dwordx4 s[60:63], s[0:1], 96
    s_cmp_ge_u32 s2, 256
    s_cbranch_scc1 L_end
    s_cmp_lt_u32 s2, 64
    s_getpc_b64 s[24:25]
L_pc0:
    s_cselect_b32 s20, L_A-L_pc0, 0
    v_lshlrev_b32 v16, 7, v0
    v_min_u32 v16, L_A-L_pc0-4, v16
    v_add_u32 v16, s20, v16
    v_add_co_u32 v16, vcc, s24, v16
    v_mov_b32 v17, s25
    s_nop 0
    v_addc_co_u32 v17, vcc, 0, v17, vcc
    global_load_dword v17, v[16:17], off
    s_cbranch_scc1 L_A
L_B:
    s_and_b32 s70, s2, 6
    s_and_b32 s25, s2, 7
    s_add_u32 s70, s70, s25
    s_lshl_b32 s25, s70, 8
    v_and_b32 v6, 15, v0
    v_lshl_add_u32 v24, v6, 4, s25
    v_and_b32 v4, 16, v0
    v_lshl_add_u32 v24, v4, 5, v24
    v_lshrrev_b32 v4, 5, v0
    v_lshl_add_u32 v24, v4, 12, v24
    s_lshr_b32 s74, s2, 3
    s_lshl_b32 s74, s74, 2
    s_addk_i32 s74, -32
    s_mov_b32 s10, 0x400000
    s_mov_b32 s11, 0x20000
    s_waitcnt lgkmcnt(0)
    s_mov_b64 s[8:9], s[54:55]
L_pfb:
    s_lshl_b32 s24, s74, 13
    buffer_load_dwordx4 v[28:31], v24, s[8:11], s24 offen
    s_addk_i32 s74, 96
    s_cmpk_lt_u32 s74, 512
    s_cbranch_scc1 L_pfb
    s_addk_i32 s74, -512
    s_mov_b64 s[8:9], s[40:41]
L_pfq:
    s_lshl_b32 s24, s74, 13
    buffer_load_dwordx4 v[28:31], v24, s[8:11], s24 offen
    s_addk_i32 s74, 96
    s_cmpk_lt_u32 s74, 512
    s_cbranch_scc1 L_pfq
    s_addk_i32 s74, -512
    s_mov_b64 s[8:9], s[42:43]
L_pfk:
    s_lshl_b32 s24, s74, 13
    buffer_load_dwordx4 v[28:31], v24, s[8:11], s24 offen
    s_addk_i32 s74, 96
    s_cmpk_lt_u32 s74, 512
    s_cbranch_scc1 L_pfk
    s_addk_i32 s74, -512
    v_lshrrev_b32 v1, 6, v0
    v_and_b32 v0, 63, v0
    v_readfirstlane_b32 s3, v1
    v_lshlrev_b32 v2, 4, v0
    s_lshr_b32 s24, s2, 3
    s_sub_u32 s24, s24, 8
    s_mul_i32 s26, s24, 43
    s_lshr_b32 s26, s26, 8
    s_mul_i32 s27, s26, 6
    s_sub_u32 s27, s24, s27
    s_and_b32 s25, s26, 1
    s_lshl_b32 s25, s25, 1
    s_and_b32 s26, s26, 2
    s_lshl_b32 s26, s26, 3
    s_or_b32 s26, s26, s25
    s_or_b32 s26, s26, s70
    s_lshl_b32 s25, s70, 17
    s_lshl_b32 s24, s3, 8
    s_add_u32 s25, s25, s24
    v_lshl_add_u32 v25, v6, 4, s25
    v_and_b32 v4, 16, v0
    v_lshl_add_u32 v25, v4, 14, v25
    v_and_b32 v4, 32, v0
    v_lshl_add_u32 v25, v4, 16, v25
    s_and_b32 s25, s2, 3
    s_lshl_b32 s25, s25, 10
    s_lshl_b32 s24, s3, 12
    s_add_u32 s25, s25, s24
    s_bfe_u32 s24, s2, 0x10002
    s_lshl_b32 s24, s24, 23
    s_add_u32 s25, s25, s24
    v_add_u32 v26, s25, v2
    s_cmp_ge_u32 s27, 3
    s_cselect_b32 s28, 1, 0
    s_mul_i32 s29, s28, 3
    s_sub_u32 s29, s27, s29
    s_lshr_b32 s72, s3, 1
    s_lshl_b32 s24, s28, 1
    s_add_u32 s72, s72, s24
    s_and_b32 s31, s3, 1
    s_lshl_b32 s24, s29, 1
    s_add_u32 s31, s31, s24
    s_lshl_b32 s30, s72, 5
    s_add_u32 s30, s30, s26
    s_lshl_b32 s30, s30, 20
    v_lshrrev_b32 v3, 4, v0
    v_and_b32 v4, 3, v0
    v_lshlrev_b32 v5, 6, v3
    v_lshl_add_u32 v5, v4, 4, v5
    v_bfe_u32 v1, v0, 2, 2
    v_lshl_add_u32 v1, v1, 8, v5
    s_mul_i32 s35, s31, 1024
    s_add_u32 s32, s35, 983040
    s_mul_i32 s28, s31, 1024
    s_add_u32 s28, s28, 1044480
    s_mov_b32 s6, 0x100000
    s_mov_b32 s7, 0x20000
    s_add_u32 s4, s50, s30
    s_addc_u32 s5, s51, 0
    s_mov_b32 s12, s62
    s_mov_b32 s13, s63
    s_mov_b32 s14, 0x400000
    s_mov_b32 s15, 0x20000
    s_mov_b32 s16, s60
    s_mov_b32 s17, s61
    s_mov_b32 s18, 0x100
    s_mov_b32 s19, 0x20000
    v_and_b32 v3, 1, v0
    v_lshlrev_b32 v3, 4, v3
    v_mov_b32 v4, 0xffff
    v_lshlrev_b32 v4, v3, v4
    v_bfe_u32 v3, v0, 1, 2
    v_cmp_eq_u32 vcc, 0, v3
    s_nop 1
    v_cndmask_b32 v20, 0, v4, vcc
    v_cmp_eq_u32 vcc, 1, v3
    s_nop 1
    v_cndmask_b32 v21, 0, v4, vcc
    v_cmp_eq_u32 vcc, 2, v3
    s_nop 1
    v_cndmask_b32 v22, 0, v4, vcc
    v_cmp_eq_u32 vcc, 3, v3
    s_nop 1
    v_cndmask_b32 v23, 0, v4, vcc
    s_mov_b32 s64, 0x22222222
    s_mov_b32 s65, 0x22222222
    s_mov_b32 s66, 0x44444444
    s_mov_b32 s67, 0x44444444
    s_mov_b32 s68, 0x88888888
    s_mov_b32 s69, 0x88888888
    v_mov_b32 v32, 0
    v_mov_b32 v33, 0
    v_mov_b32 v34, 0
    v_mov_b32 v35, 0
    v_mov_b32 v36, 0
    v_mov_b32 v37, 0
    v_mov_b32 v38, 0
    v_mov_b32 v39, 0
    v_mov_b32 v40, 0
    v_mov_b32 v41, 0
    v_mov_b32 v42, 0
    v_mov_b32 v43, 0
    v_mov_b32 v44, 0
    v_mov_b32 v45, 0
    v_mov_b32 v46, 0
    v_mov_b32 v47, 0
    v_lshrrev_b32 v3, 4, v0
    v_lshlrev_b32 v60, 6, v3
    v_and_b32 v4, 7, v0
    v_lshl_add_u32 v60, v4, 3, v60
    s_lshl_b32 s33, s26, 2
    s_add_u32 s33, s33, s72
    s_lshl_b32 s34, s33, 8
    s_add_u32 s34, s34, 0x164000
    s_mul_i32 s73, s33, 6
    s_add_u32 s73, s73, s31
    s_lshl_b32 s73, s73, 8
    s_add_u32 s73, s73, 0x180000
    s_mov_b64 s[8:9], s[56:57]
L_pfo:
    s_lshl_b32 s24, s74, 8
    s_waitcnt vmcnt(6)
    buffer_load_dwordx4 v[28:31], v25, s[8:11], s24 offen
    s_addk_i32 s74, 96
    s_cmpk_lt_u32 s74, 512
    s_cbranch_scc1 L_pfo
    s_addk_i32 s74, -512
    s_mov_b64 s[8:9], s[44:45]
L_pfu:
    s_lshl_b32 s24, s74, 13
    s_waitcnt vmcnt(6)
    buffer_load_dwordx4 v[28:31], v24, s[8:11], s24 offen
    s_addk_i32 s74, 96
    s_cmpk_lt_u32 s74, 512
    s_cbranch_scc1 L_pfu
    s_addk_i32 s74, -512
    s_mov_b64 s[8:9], s[46:47]
L_pfv:
    s_lshl_b32 s24, s74, 8
    s_waitcnt vmcnt(6)
    buffer_load_dwordx4 v[28:31], v25, s[8:11], s24 offen
    s_addk_i32 s74, 96
    s_cmpk_lt_u32 s74, 512
    s_cbranch_scc1 L_pfv
    s_addk_i32 s74, -512
    s_mov_b64 s[8:9], s[38:39]
    s_mov_b32 s10, 0x1000000
L_pfc:
    s_lshl_b32 s24, s74, 12
    s_waitcnt vmcnt(6)
    buffer_load_dwordx4 v[28:31], v26, s[8:11], s24 offen
    s_addk_i32 s74, 96
    s_cmpk_lt_u32 s74, 2048
    s_cbranch_scc1 L_pfc
    s_addk_i32 s74, -2048
    s_mov_b32 s10, 0x400000
    s_waitcnt vmcnt(15)
    buffer_load_dwordx4 a[0:3], v1, s[4:7], s32 offen offset:0 nt
    s_add_u32 s32, s32, 6144
    s_waitcnt vmcnt(15)
    buffer_load_dwordx4 a[4:7], v1, s[4:7], s32 offen offset:0 nt
    s_add_u32 s32, s32, 6144
    s_waitcnt vmcnt(15)
    buffer_load_dwordx4 a[8:11], v1, s[4:7], s32 offen offset:0 nt
    s_add_u32 s32, s32, 6144
    s_waitcnt vmcnt(15)
    buffer_load_dwordx4 a[12:15], v1, s[4:7], s32 offen offset:0 nt
    s_add_u32 s32, s32, 6144
    s_waitcnt vmcnt(15)
    buffer_load_dwordx4 a[16:19], v1, s[4:7], s32 offen offset:0 nt
    s_add_u32 s32, s32, 6144
    s_waitcnt vmcnt(15)
    buffer_load_dwordx4 a[20:23], v1, s[4:7], s32 offen offset:0 nt
    s_add_u32 s32, s32, 6144
    s_waitcnt vmcnt(15)
    buffer_load_dwordx4 a[24:27], v1, s[4:7], s32 offen offset:0 nt
    s_add_u32 s32, s32, 6144
    s_waitcnt vmcnt(15)
    buffer_load_dwordx4 a[28:31], v1, s[4:7], s32 offen offset:0 nt
    s_add_u32 s32, s32, 6144
    s_waitcnt vmcnt(15)
    buffer_load_dwordx4 a[32:35], v1, s[4:7], s32 offen offset:0 nt
    s_add_u32 s32, s32, 6144
    s_waitcnt vmcnt(15)
    buffer_load_dwordx4 a[36:39], v1, s[4:7], s32 offen offset:0 nt
    s_add_u32 s32, s32, 6144
    s_waitcnt vmcnt(15)
    buffer_load_dwordx4 a[40:43], v1, s[4:7], s28 offen offset:0 nt
    s_waitcnt vmcnt(15)
    s_mov_b32 s32, s35
    buffer_load_dwordx4 a[64:67], v1, s[4:7], s32 offen offset:0 nt
    s_add_u32 s32, s32, 6144
    s_waitcnt vmcnt(15)
    buffer_load_dwordx4 a[68:71], v1, s[4:7], s32 offen offset:0 nt
    s_add_u32 s32, s32, 6144
    s_waitcnt vmcnt(15)
    buffer_load_dwordx4 a[72:75], v1, s[4:7], s32 offen offset:0 nt
    s_add_u32 s32, s32, 6144
    s_waitcnt vmcnt(15)
    buffer_load_dwordx4 a[76:79], v1, s[4:7], s32 offen offset:0 nt
    s_add_u32 s32, s32, 6144
    s_waitcnt vmcnt(15)
    buffer_load_dwordx4 a[80:83], v1, s[4:7], s32 offen offset:0 nt
    s_add_u32 s32, s32, 6144
    s_mov_b64 exec, 1
    buffer_load_dword v61, off, s[16:19], 0 offset:128 sc1
    s_mov_b64 exec, -1
    s_waitcnt vmcnt(15)
    buffer_load_dwordx4 a[84:87], v1, s[4:7], s32 offen offset:0 nt
    s_add_u32 s32, s32, 6144
    s_waitcnt vmcnt(15)
    buffer_load_dwordx4 a[88:91], v1, s[4:7], s32 offen offset:0 nt
    s_add_u32 s32, s32, 6144
    s_waitcnt vmcnt(15)
    buffer_load_dwordx4 a[92:95], v1, s[4:7], s32 offen offset:0 nt
    s_add_u32 s32, s32, 6144
    s_waitcnt vmcnt(15)
    buffer_load_dwordx4 a[96:99], v1, s[4:7], s32 offen offset:0 nt
    s_add_u32 s32, s32, 6144
    s_waitcnt vmcnt(15)
    buffer_load_dwordx4 a[100:103], v1, s[4:7], s32 offen offset:0 nt
    s_add_u32 s32, s32, 6144
    s_waitcnt vmcnt(15)
    buffer_load_dwordx4 a[104:107], v1, s[4:7], s32 offen offset:0 nt
    s_add_u32 s32, s32, 6144
    s_waitcnt vmcnt(15)
    buffer_load_dwordx4 a[108:111], v1, s[4:7], s32 offen offset:0 nt
    s_add_u32 s32, s32, 6144
    s_waitcnt vmcnt(15)
    buffer_load_dwordx4 a[112:115], v1, s[4:7], s32 offen offset:0 nt
    s_add_u32 s32, s32, 6144
    s_waitcnt vmcnt(15)
    buffer_load_dwordx4 a[116:119], v1, s[4:7], s32 offen offset:0 nt
    s_add_u32 s32, s32, 6144
    s_waitcnt vmcnt(15)
    buffer_load_dwordx4 a[120:123], v1, s[4:7], s32 offen offset:0 nt
    s_add_u32 s32, s32, 6144
    s_waitcnt vmcnt(15)
    buffer_load_dwordx4 a[124:127], v1, s[4:7], s32 offen offset:0 nt
    s_add_u32 s32, s32, 6144
    s_waitcnt vmcnt(15)
    buffer_load_dwordx4 v[64:67], v1, s[4:7], s32 offen offset:0 nt
    s_add_u32 s32, s32, 6144
    s_waitcnt vmcnt(12)
    v_readfirstlane_b32 s25, v61
    s_nop 0
    s_cmp_ge_u32 s25, 32
    s_cbranch_scc1 L_B_q
    s_mov_b32 s24, 262144
    s_mov_b64 exec, 1
L_aw1:
    buffer_load_dword v61, off, s[16:19], 0 offset:128 sc1
    s_waitcnt vmcnt(0)
    v_readfirstlane_b32 s25, v61
    s_nop 0
    s_cmp_ge_u32 s25, 32
    s_cbranch_scc1 L_B_q
    s_sleep 16
    s_sub_u32 s24, s24, 1
    s_cmp_lg_u32 s24, 0
    s_cbranch_scc1 L_aw1
L_B_q:
    s_mov_b64 exec, -1
    buffer_load_dwordx4 v[8:11], v5, s[12:15], s34 offen sc1
    s_waitcnt vmcnt(15)
    buffer_load_dwordx4 v[68:71], v1, s[4:7], s32 offen offset:0 nt
    s_add_u32 s32, s32, 6144
    s_waitcnt vmcnt(15)
    buffer_load_dwordx4 v[72:75], v1, s[4:7], s32 offen offset:0 nt
    s_add_u32 s32, s32, 6144
    s_waitcnt vmcnt(15)
    buffer_load_dwordx4 v[76:79], v1, s[4:7], s32 offen offset:0 nt
    s_add_u32 s32, s32, 6144
    s_waitcnt vmcnt(15)
    buffer_load_dwordx4 v[80:83], v1, s[4:7], s32 offen offset:0 nt
    s_add_u32 s32, s32, 6144
    s_waitcnt vmcnt(15)
    buffer_load_dwordx4 v[84:87], v1, s[4:7], s32 offen offset:0 nt
    s_add_u32 s32, s32, 6144
    s_waitcnt vmcnt(15)
    buffer_load_dwordx4 v[88:91], v1, s[4:7], s32 offen offset:0 nt
    s_add_u32 s32, s32, 6144
    s_waitcnt vmcnt(15)
    buffer_load_dwordx4 v[92:95], v1, s[4:7], s32 offen offset:0 nt
    s_add_u32 s32, s32, 6144
    s_waitcnt vmcnt(15)
    buffer_load_dwordx4 v[96:99], v1, s[4:7], s32 offen offset:0 nt
    s_add_u32 s32, s32, 6144
    s_waitcnt vmcnt(15)
    buffer_load_dwordx4 v[100:103], v1, s[4:7], s32 offen offset:0 nt
    s_add_u32 s32, s32, 6144
    s_waitcnt vmcnt(15)
    buffer_load_dwordx4 v[104:107], v1, s[4:7], s32 offen offset:0 nt
    s_add_u32 s32, s32, 6144
    s_waitcnt vmcnt(15)
    buffer_load_dwordx4 v[108:111], v1, s[4:7], s32 offen offset:0 nt
    s_add_u32 s32, s32, 6144
    s_waitcnt vmcnt(15)
    buffer_load_dwordx4 v[112:115], v1, s[4:7], s32 offen offset:0 nt
    s_add_u32 s32, s32, 6144
    s_waitcnt vmcnt(15)
    buffer_load_dwordx4 v[116:119], v1, s[4:7], s32 offen offset:0 nt
    s_add_u32 s32, s32, 6144
    s_waitcnt vmcnt(15)
    buffer_load_dwordx4 v[120:123], v1, s[4:7], s32 offen offset:0 nt
    s_add_u32 s32, s32, 6144
    s_waitcnt vmcnt(15)
    buffer_load_dwordx4 v[124:127], v1, s[4:7], s32 offen offset:0 nt
    s_add_u32 s32, s32, 6144
    s_waitcnt vmcnt(15)
    v_mov_b32_dpp v32, v8 quad_perm:[0,1,2,3] row_mask:0xf bank_mask:0x1
    v_mov_b32_dpp v33, v9 quad_perm:[0,1,2,3] row_mask:0xf bank_mask:0x1
    v_mov_b32_dpp v34, v10 quad_perm:[0,1,2,3] row_mask:0xf bank_mask:0x1
    v_mov_b32_dpp v35, v11 quad_perm:[0,1,2,3] row_mask:0xf bank_mask:0x1
    v_mov_b32_dpp v36, v8 quad_perm:[0,1,2,3] row_mask:0xf bank_mask:0x2
    v_mov_b32_dpp v37, v9 quad_perm:[0,1,2,3] row_mask:0xf bank_mask:0x2
    v_mov_b32_dpp v38, v10 quad_perm:[0,1,2,3] row_mask:0xf bank_mask:0x2
    v_mov_b32_dpp v39, v11 quad_perm:[0,1,2,3] row_mask:0xf bank_mask:0x2
    v_mov_b32_dpp v40, v8 quad_perm:[0,1,2,3] row_mask:0xf bank_mask:0x4
    v_mov_b32_dpp v41, v9 quad_perm:[0,1,2,3] row_mask:0xf bank_mask:0x4
    v_mov_b32_dpp v42, v10 quad_perm:[0,1,2,3] row_mask:0xf bank_mask:0x4
    v_mov_b32_dpp v43, v11 quad_perm:[0,1,2,3] row_mask:0xf bank_mask:0x4
    v_mov_b32_dpp v44, v8 quad_perm:[0,1,2,3] row_mask:0xf bank_mask:0x8
    v_mov_b32_dpp v45, v9 quad_perm:[0,1,2,3] row_mask:0xf bank_mask:0x8
    v_mov_b32_dpp v46, v10 quad_perm:[0,1,2,3] row_mask:0xf bank_mask:0x8
    v_mov_b32_dpp v47, v11 quad_perm:[0,1,2,3] row_mask:0xf bank_mask:0x8
    s_mov_b32 s27, 1
L_BK:
    s_cmp_lg_u32 s27, 9
    s_cbranch_scc1 L_BK_a
    s_add_u32 s4, s52, s30
    s_addc_u32 s5, s53, 0
    s_mov_b32 s32, s35
    v_mov_b32 v1, v2
L_BK_a:
    s_barrier
    s_cmp_lg_u32 s27, 7
    s_cbranch_scc1 L_BK_x0
    s_lshl_b32 s24, s26, 7
    s_add_u32 s24, s24, 0x1b6000
    s_mov_b64 exec, 1
    buffer_load_dwordx2 v[62:63], off, s[12:15], s24 sc1
    s_mov_b64 exec, -1
L_BK_x0:
    s_cmp_lg_u32 s27, 8
    s_cbranch_scc1 L_BK_x1
    s_getreg_b32 s75, hwreg(HW_REG_XCC_ID, 0, 4)
    v_readfirstlane_b32 s24, v62
    v_readfirstlane_b32 s25, v63
    s_xor_b32 s24, s24, s75
    s_xor_b32 s25, s25, s75
    s_or_b32 s75, s24, s25
    v_mov_b32 v28, -1
    v_mov_b32 v29, -1
    v_mov_b32 v30, -1
    v_mov_b32 v31, -1
    s_mov_b64 exec, 0xffff
    s_cbranch_scc1 L_far2
    buffer_store_dwordx4 v[28:31], v2, s[12:15], s73 offen
    s_branch L_near2
L_far2:
    buffer_store_dwordx4 v[28:31], v2, s[12:15], s73 offen sc1
L_near2:
    s_mov_b64 exec, -1
L_BK_x1:
    v_mov_b32 v49, v50
    v_mov_b32 v50, v51
    v_mov_b32 v51, v52
    v_mov_b32 v52, v53
    v_mov_b32 v53, v54
    v_mov_b32 v54, v55
    v_mov_b32 v55, v56
    v_mov_b32 v56, v57
    s_waitcnt vmcnt(15)
    v_mfma_f32_16x16x32_bf16 v[12:15], v[64:67], v[32:35], 0
    buffer_load_dwordx4 v[64:67], v1, s[4:7], s32 offen offset:0 nt
    s_add_u32 s32, s32, 6144
    s_waitcnt vmcnt(15)
    v_mfma_f32_16x16x32_bf16 v[12:15], v[68:71], v[36:39], v[12:15]
    buffer_load_dwordx4 v[68:71], v1, s[4:7], s32 offen offset:0 nt
    s_add_u32 s32, s32, 6144
    s_waitcnt vmcnt(15)
    v_mfma_f32_16x16x32_bf16 v[12:15], v[72:75], v[40:43], v[12:15]
    buffer_load_dwordx4 v[72:75], v1, s[4:7], s32 offen offset:0 nt
    s_add_u32 s32, s32, 6144
    s_waitcnt vmcnt(15)
    v_mfma_f32_16x16x32_bf16 v[12:15], v[76:79], v[44:47], v[12:15]
    buffer_load_dwordx4 v[76:79], v1, s[4:7], s32 offen offset:0 nt
    s_add_u32 s32, s32, 6144
    s_nop 5
    v_add_f32_dpp v57, v13, v12 quad_perm:[1,1,1,1] row_mask:0xf bank_mask:0xf
    s_nop 1
    v_add_f32_dpp v57, v14, v57 quad_perm:[2,2,2,2] row_mask:0xf bank_mask:0xf
    s_nop 1
    v_add_f32_dpp v57, v15, v57 quad_perm:[3,3,3,3] row_mask:0xf bank_mask:0xf
    s_waitcnt vmcnt(15)
    v_mfma_f32_16x16x32_bf16 v[16:19], v[80:83], v[32:35], 0
    buffer_load_dwordx4 v[80:83], v1, s[4:7], s32 offen offset:0 nt
    s_add_u32 s32, s32, 6144
    s_waitcnt vmcnt(15)
    v_mfma_f32_16x16x32_bf16 v[16:19], v[84:87], v[36:39], v[16:19]
    buffer_load_dwordx4 v[84:87], v1, s[4:7], s32 offen offset:0 nt
    s_add_u32 s32, s32, 6144
    s_waitcnt vmcnt(15)
    v_mfma_f32_16x16x32_bf16 v[16:19], v[88:91], v[40:43], v[16:19]
    buffer_load_dwordx4 v[88:91], v1, s[4:7], s32 offen offset:0 nt
    s_add_u32 s32, s32, 6144
    s_waitcnt vmcnt(15)
    v_mfma_f32_16x16x32_bf16 v[16:19], v[92:95], v[44:47], v[16:19]
    buffer_load_dwordx4 v[92:95], v1, s[4:7], s32 offen offset:0 nt
    s_add_u32 s32, s32, 6144
    s_nop 5
    v_add_f32_dpp v3, v16, v17 quad_perm:[0,0,0,0] row_mask:0xf bank_mask:0xf
    s_nop 1
    v_add_f32_dpp v3, v18, v3 quad_perm:[2,2,2,2] row_mask:0xf bank_mask:0xf
    s_nop 1
    v_add_f32_dpp v3, v19, v3 quad_perm:[3,3,3,3] row_mask:0xf bank_mask:0xf
    v_cndmask_b32 v57, v57, v3, s[64:65]
    s_waitcnt vmcnt(15)
    v_mfma_f32_16x16x32_bf16 v[12:15], v[96:99], v[32:35], 0
    buffer_load_dwordx4 v[96:99], v1, s[4:7], s32 offen offset:0 nt
    s_add_u32 s32, s32, 6144
    s_waitcnt vmcnt(15)
    v_mfma_f32_16x16x32_bf16 v[12:15], v[100:103], v[36:39], v[12:15]
    buffer_load_dwordx4 v[100:103], v1, s[4:7], s32 offen offset:0 nt
    s_add_u32 s32, s32, 6144
    s_waitcnt vmcnt(15)
    v_mfma_f32_16x16x32_bf16 v[12:15], v[104:107], v[40:43], v[12:15]
    buffer_load_dwordx4 v[104:107], v1, s[4:7], s32 offen offset:0 nt
    s_add_u32 s32, s32, 6144
    s_waitcnt vmcnt(15)
    v_mfma_f32_16x16x32_bf16 v[12:15], v[108:111], v[44:47], v[12:15]
    buffer_load_dwordx4 v[108:111], v1, s[4:7], s32 offen offset:0 nt
    s_add_u32 s32, s32, 6144
    s_nop 5
    v_add_f32_dpp v3, v12, v14 quad_perm:[0,0,0,0] row_mask:0xf bank_mask:0xf
    s_nop 1
    v_add_f32_dpp v3, v13, v3 quad_perm:[1,1,1,1] row_mask:0xf bank_mask:0xf
    s_nop 1
    v_add_f32_dpp v3, v15, v3 quad_perm:[3,3,3,3] row_mask:0xf bank_mask:0xf
    v_cndmask_b32 v57, v57, v3, s[66:67]
    s_waitcnt vmcnt(15)
    v_mfma_f32_16x16x32_bf16 v[16:19], v[112:115], v[32:35], 0
    buffer_load_dwordx4 v[112:115], v1, s[4:7], s32 offen offset:0 nt
    s_add_u32 s32, s32, 6144
    s_waitcnt vmcnt(15)
    v_mfma_f32_16x16x32_bf16 v[16:19], v[116:119], v[36:39], v[16:19]
    buffer_load_dwordx4 v[116:119], v1, s[4:7], s32 offen offset:0 nt
    s_add_u32 s32, s32, 6144
    s_waitcnt vmcnt(15)
    v_mfma_f32_16x16x32_bf16 v[16:19], v[120:123], v[40:43], v[16:19]
    buffer_load_dwordx4 v[120:123], v1, s[4:7], s32 offen offset:0 nt
    s_add_u32 s32, s32, 6144
    s_waitcnt vmcnt(15)
    v_mfma_f32_16x16x32_bf16 v[16:19], v[124:127], v[44:47], v[16:19]
    buffer_load_dwordx4 v[124:127], v1, s[4:7], s32 offen offset:0 nt
    s_add_u32 s32, s32, 6144
    s_nop 5
    v_add_f32_dpp v3, v16, v19 quad_perm:[0,0,0,0] row_mask:0xf bank_mask:0xf
    s_nop 1
    v_add_f32_dpp v3, v17, v3 quad_perm:[1,1,1,1] row_mask:0xf bank_mask:0xf
    s_nop 1
    v_add_f32_dpp v3, v18, v3 quad_perm:[2,2,2,2] row_mask:0xf bank_mask:0xf
    v_cndmask_b32 v57, v57, v3, s[68:69]
    s_cmp_lg_u32 s27, 3
    s_cbranch_scc1 L_BK_c0
    v_mfma_f32_16x16x32_bf16 v[12:15], a[64:67], v[32:35], 0
    v_mfma_f32_16x16x32_bf16 v[12:15], a[68:71], v[36:39], v[12:15]
    v_mfma_f32_16x16x32_bf16 v[12:15], a[72:75], v[40:43], v[12:15]
    v_mfma_f32_16x16x32_bf16 v[12:15], a[76:79], v[44:47], v[12:15]
    s_nop 7
    v_add_f32_dpp v48, v13, v12 quad_perm:[1,1,1,1] row_mask:0xf bank_mask:0xf
    s_nop 1
    v_add_f32_dpp v48, v14, v48 quad_perm:[2,2,2,2] row_mask:0xf bank_mask:0xf
    s_nop 1
    v_add_f32_dpp v48, v15, v48 quad_perm:[3,3,3,3] row_mask:0xf bank_mask:0xf
    v_mfma_f32_16x16x32_bf16 v[16:19], a[80:83], v[32:35], 0
    v_mfma_f32_16x16x32_bf16 v[16:19], a[84:87], v[36:39], v[16:19]
    v_mfma_f32_16x16x32_bf16 v[16:19], a[88:91], v[40:43], v[16:19]
    v_mfma_f32_16x16x32_bf16 v[16:19], a[92:95], v[44:47], v[16:19]
    s_nop 7
    v_add_f32_dpp v3, v16, v17 quad_perm:[0,0,0,0] row_mask:0xf bank_mask:0xf
    s_nop 1
    v_add_f32_dpp v3, v18, v3 quad_perm:[2,2,2,2] row_mask:0xf bank_mask:0xf
    s_nop 1
    v_add_f32_dpp v3, v19, v3 quad_perm:[3,3,3,3] row_mask:0xf bank_mask:0xf
    v_cndmask_b32 v48, v48, v3, s[64:65]
    v_mfma_f32_16x16x32_bf16 v[12:15], a[96:99], v[32:35], 0
    v_mfma_f32_16x16x32_bf16 v[12:15], a[100:103], v[36:39], v[12:15]
    v_mfma_f32_16x16x32_bf16 v[12:15], a[104:107], v[40:43], v[12:15]
    v_mfma_f32_16x16x32_bf16 v[12:15], a[108:111], v[44:47], v[12:15]
    s_nop 7
    v_add_f32_dpp v3, v12, v14 quad_perm:[0,0,0,0] row_mask:0xf bank_mask:0xf
    s_nop 1
    v_add_f32_dpp v3, v13, v3 quad_perm:[1,1,1,1] row_mask:0xf bank_mask:0xf
    s_nop 1
    v_add_f32_dpp v3, v15, v3 quad_perm:[3,3,3,3] row_mask:0xf bank_mask:0xf
    v_cndmask_b32 v48, v48, v3, s[66:67]
    v_mfma_f32_16x16x32_bf16 v[16:19], a[112:115], v[32:35], 0
    v_mfma_f32_16x16x32_bf16 v[16:19], a[116:119], v[36:39], v[16:19]
    v_mfma_f32_16x16x32_bf16 v[16:19], a[120:123], v[40:43], v[16:19]
    v_mfma_f32_16x16x32_bf16 v[16:19], a[124:127], v[44:47], v[16:19]
    s_nop 7
    v_add_f32_dpp v3, v16, v19 quad_perm:[0,0,0,0] row_mask:0xf bank_mask:0xf
    s_nop 1
    v_add_f32_dpp v3, v17, v3 quad_perm:[1,1,1,1] row_mask:0xf bank_mask:0xf
    s_nop 1
    v_add_f32_dpp v3, v18, v3 quad_perm:[2,2,2,2] row_mask:0xf bank_mask:0xf
    v_cndmask_b32 v48, v48, v3, s[68:69]
L_BK_c0:
    s_cmp_lg_u32 s27, 2
    s_cbranch_scc1 L_BK_b
    v_mfma_f32_16x16x32_bf16 v[12:15], a[0:3], v[32:35], 0
    v_mfma_f32_16x16x32_bf16 v[12:15], a[4:7], v[36:39], v[12:15]
    v_mfma_f32_16x16x32_bf16 v[12:15], a[8:11], v[40:43], v[12:15]
    v_mfma_f32_16x16x32_bf16 v[12:15], a[12:15], v[44:47], v[12:15]
    s_nop 7
    v_add_f32_dpp v58, v13, v12 quad_perm:[1,1,1,1] row_mask:0xf bank_mask:0xf
    s_nop 1
    v_add_f32_dpp v58, v14, v58 quad_perm:[2,2,2,2] row_mask:0xf bank_mask:0xf
    s_nop 1
    v_add_f32_dpp v58, v15, v58 quad_perm:[3,3,3,3] row_mask:0xf bank_mask:0xf
    v_mfma_f32_16x16x32_bf16 v[16:19], a[16:19], v[32:35], 0
    v_mfma_f32_16x16x32_bf16 v[16:19], a[20:23], v[36:39], v[16:19]
    v_mfma_f32_16x16x32_bf16 v[16:19], a[24:27], v[40:43], v[16:19]
    v_mfma_f32_16x16x32_bf16 v[16:19], a[28:31], v[44:47], v[16:19]
    s_nop 7
    v_add_f32_dpp v3, v16, v17 quad_perm:[0,0,0,0] row_mask:0xf bank_mask:0xf
    s_nop 1
    v_add_f32_dpp v3, v18, v3 quad_perm:[2,2,2,2] row_mask:0xf bank_mask:0xf
    s_nop 1
    v_add_f32_dpp v3, v19, v3 quad_perm:[3,3,3,3] row_mask:0xf bank_mask:0xf
    v_cndmask_b32 v58, v58, v3, s[64:65]
    v_mfma_f32_16x16x32_bf16 v[12:15], a[32:35], v[32:35], 0
    v_mfma_f32_16x16x32_bf16 v[12:15], a[36:39], v[36:39], v[12:15]
    v_mfma_f32_16x16x32_bf16 v[12:15], a[40:43], v[40:43], v[12:15]
    s_nop 7
    v_add_f32_dpp v3, v12, v14 quad_perm:[0,0,0,0] row_mask:0xf bank_mask:0xf
    s_nop 1
    v_add_f32_dpp v3, v13, v3 quad_perm:[1,1,1,1] row_mask:0xf bank_mask:0xf
    s_nop 1
    v_add_f32_dpp v3, v15, v3 quad_perm:[3,3,3,3] row_mask:0xf bank_mask:0xf
    v_cndmask_b32 v58, v58, v3, s[66:67]
    s_mul_i32 s24, s31, 1
    s_sub_i32 s24, 4, s24
    s_max_i32 s24, s24, 0
    s_min_i32 s24, s24, 1
    s_add_u32 s24, s24, 10
    v_and_b32 v3, 3, v0
    v_bfe_u32 v4, v0, 2, 2
    v_lshl_add_u32 v3, v3, 2, v4
    v_mov_b32 v4, 0xff800000
    v_cmp_gt_u32 vcc, s24, v3
    s_nop 1
    v_cndmask_b32 v58, v4, v58, vcc
    v_mov_b32 v61, 0x3e0293ee
    v_mov_b32 v7, 0
    s_lshl_b32 s34, s2, 7
    s_add_u32 s34, s34, 0x1ae000
L_BK_b:
    s_add_u32 s27, s27, 1
    s_cmp_lt_u32 s27, 10
    s_cbranch_scc1 L_BK
    v_max3_f32 v3, v48, v49, v50
    v_max3_f32 v3, v3, v51, v52
    v_max3_f32 v3, v3, v53, v54
    v_max3_f32 v3, v3, v55, v56
    v_max3_f32 v3, v3, v57, v58
    s_nop 1
    v_max_f32_dpp v3, v3, v3 row_ror:8 row_mask:0xf bank_mask:0xf
    s_nop 1
    v_max_f32_dpp v3, v3, v3 row_ror:4 row_mask:0xf bank_mask:0xf
    s_nop 1
    v_max_f32_dpp v3, v3, v3 row_ror:2 row_mask:0xf bank_mask:0xf
    s_nop 1
    v_max_f32_dpp v3, v3, v3 row_ror:1 row_mask:0xf bank_mask:0xf
    s_nop 1
    v_max_f32_dpp v3, v3, v3 row_bcast:15 row_mask:0xa bank_mask:0xf
    s_nop 1
    v_max_f32_dpp v3, v3, v3 row_bcast:31 row_mask:0xc bank_mask:0xf
    s_nop 0
    v_readlane_b32 s24, v3, 63
    s_nop 1
    v_mul_f32 v6, s24, v61
    v_mov_b32 v12, 0
    v_mov_b32 v13, 0
    v_mov_b32 v14, 0
    v_mov_b32 v15, 0
    v_fma_f32 v48, v48, v61, -v6
    v_exp_f32 v48, v48
    s_nop 0
    v_add_f32 v7, v7, v48
    v_cvt_pk_bf16_f32 v48, v48, v48
    s_mov_b32 s27, 0
L_BV:
    s_barrier
    s_cmp_ge_u32 s27, 1
    s_cselect_b32 s71, s3, 4
    s_cmp_lg_u32 s71, 0
    s_cbranch_scc1 L_BV_p0
    s_lshl_b32 s24, s27, 2
    s_add_u32 s24, s24, 0
    s_mov_b64 exec, 1
    v_mov_b32 v63, s24
    s_cmp_lg_u32 s75, 0
    s_cbranch_scc1 L_far3
    buffer_store_dword v63, off, s[12:15], s34 offset:64
    s_branch L_near3
L_far3:
    buffer_store_dword v63, off, s[12:15], s34 offset:64 sc1
L_near3:
    s_mov_b64 exec, -1
L_BV_p0:
    v_and_b32_dpp v8, v48, v20 row_newbcast:0 row_mask:0xf bank_mask:0xf
    v_and_b32_dpp v9, v48, v21 row_newbcast:0 row_mask:0xf bank_mask:0xf
    v_and_b32_dpp v10, v48, v22 row_newbcast:0 row_mask:0xf bank_mask:0xf
    v_and_b32_dpp v11, v48, v23 row_newbcast:0 row_mask:0xf bank_mask:0xf
    s_waitcnt vmcnt(15)
    s_nop 0
    v_mfma_f32_16x16x32_bf16 v[12:15], v[64:67], v[8:11], v[12:15]
    buffer_load_dwordx4 v[64:67], v1, s[4:7], s32 offen offset:0 nt
    s_add_u32 s32, s32, 6144
    v_and_b32_dpp v8, v48, v20 row_newbcast:4 row_mask:0xf bank_mask:0xf
    v_and_b32_dpp v9, v48, v21 row_newbcast:4 row_mask:0xf bank_mask:0xf
    v_and_b32_dpp v10, v48, v22 row_newbcast:4 row_mask:0xf bank_mask:0xf
    v_and_b32_dpp v11, v48, v23 row_newbcast:4 row_mask:0xf bank_mask:0xf
    s_waitcnt vmcnt(15)
    s_nop 0
    v_mfma_f32_16x16x32_bf16 v[12:15], v[68:71], v[8:11], v[12:15]
    buffer_load_dwordx4 v[68:71], v1, s[4:7], s32 offen offset:0 nt
    s_add_u32 s32, s32, 6144
    v_and_b32_dpp v8, v48, v20 row_newbcast:8 row_mask:0xf bank_mask:0xf
    v_and_b32_dpp v9, v48, v21 row_newbcast:8 row_mask:0xf bank_mask:0xf
    v_and_b32_dpp v10, v48, v22 row_newbcast:8 row_mask:0xf bank_mask:0xf
    v_and_b32_dpp v11, v48, v23 row_newbcast:8 row_mask:0xf bank_mask:0xf
    s_waitcnt vmcnt(15)
    s_nop 0
    v_mfma_f32_16x16x32_bf16 v[12:15], v[72:75], v[8:11], v[12:15]
    buffer_load_dwordx4 v[72:75], v1, s[4:7], s32 offen offset:0 nt
    s_add_u32 s32, s32, 6144
    v_and_b32_dpp v8, v48, v20 row_newbcast:12 row_mask:0xf bank_mask:0xf
    v_and_b32_dpp v9, v48, v21 row_newbcast:12 row_mask:0xf bank_mask:0xf
    v_and_b32_dpp v10, v48, v22 row_newbcast:12 row_mask:0xf bank_mask:0xf
    v_and_b32_dpp v11, v48, v23 row_newbcast:12 row_mask:0xf bank_mask:0xf
    s_waitcnt vmcnt(15)
    s_nop 0
    v_mfma_f32_16x16x32_bf16 v[12:15], v[76:79], v[8:11], v[12:15]
    buffer_load_dwordx4 v[76:79], v1, s[4:7], s32 offen offset:0 nt
    s_add_u32 s32, s32, 6144
    s_cmp_lg_u32 s71, 1
    s_cbranch_scc1 L_BV_p1
    s_lshl_b32 s24, s27, 2
    s_add_u32 s24, s24, 1
    s_mov_b64 exec, 1
    v_mov_b32 v63, s24
    s_cmp_lg_u32 s75, 0
    s_cbranch_scc1 L_far4
    buffer_store_dword v63, off, s[12:15], s34 offset:64
    s_branch L_near4
L_far4:
    buffer_store_dword v63, off, s[12:15], s34 offset:64 sc1
L_near4:
    s_mov_b64 exec, -1
L_BV_p1:
    v_and_b32_dpp v8, v48, v20 row_newbcast:1 row_mask:0xf bank_mask:0xf
    v_and_b32_dpp v9, v48, v21 row_newbcast:1 row_mask:0xf bank_mask:0xf
    v_and_b32_dpp v10, v48, v22 row_newbcast:1 row_mask:0xf bank_mask:0xf
    v_and_b32_dpp v11, v48, v23 row_newbcast:1 row_mask:0xf bank_mask:0xf
    s_waitcnt vmcnt(15)
    s_nop 0
    v_mfma_f32_16x16x32_bf16 v[12:15], v[80:83], v[8:11], v[12:15]
    buffer_load_dwordx4 v[80:83], v1, s[4:7], s32 offen offset:0 nt
    s_add_u32 s32, s32, 6144
    v_and_b32_dpp v8, v48, v20 row_newbcast:5 row_mask:0xf bank_mask:0xf
    v_and_b32_dpp v9, v48, v21 row_newbcast:5 row_mask:0xf bank_mask:0xf
    v_and_b32_dpp v10, v48, v22 row_newbcast:5 row_mask:0xf bank_mask:0xf
    v_and_b32_dpp v11, v48, v23 row_newbcast:5 row_mask:0xf bank_mask:0xf
    s_waitcnt vmcnt(15)
    s_nop 0
    v_mfma_f32_16x16x32_bf16 v[12:15], v[84:87], v[8:11], v[12:15]
    buffer_load_dwordx4 v[84:87], v1, s[4:7], s32 offen offset:0 nt
    s_add_u32 s32, s32, 6144
    v_and_b32_dpp v8, v48, v20 row_newbcast:9 row_mask:0xf bank_mask:0xf
    v_and_b32_dpp v9, v48, v21 row_newbcast:9 row_mask:0xf bank_mask:0xf
    v_and_b32_dpp v10, v48, v22 row_newbcast:9 row_mask:0xf bank_mask:0xf
    v_and_b32_dpp v11, v48, v23 row_newbcast:9 row_mask:0xf bank_mask:0xf
    s_waitcnt vmcnt(15)
    s_nop 0
    v_mfma_f32_16x16x32_bf16 v[12:15], v[88:91], v[8:11], v[12:15]
    buffer_load_dwordx4 v[88:91], v1, s[4:7], s32 offen offset:0 nt
    s_add_u32 s32, s32, 6144
    v_and_b32_dpp v8, v48, v20 row_newbcast:13 row_mask:0xf bank_mask:0xf
    v_and_b32_dpp v9, v48, v21 row_newbcast:13 row_mask:0xf bank_mask:0xf
    v_and_b32_dpp v10, v48, v22 row_newbcast:13 row_mask:0xf bank_mask:0xf
    v_and_b32_dpp v11, v48, v23 row_newbcast:13 row_mask:0xf bank_mask:0xf
    s_waitcnt vmcnt(15)
    s_nop 0
    v_mfma_f32_16x16x32_bf16 v[12:15], v[92:95], v[8:11], v[12:15]
    buffer_load_dwordx4 v[92:95], v1, s[4:7], s32 offen offset:0 nt
    s_add_u32 s32, s32, 6144
    s_cmp_lg_u32 s71, 2
    s_cbranch_scc1 L_BV_p2
    s_lshl_b32 s24, s27, 2
    s_add_u32 s24, s24, 2
    s_mov_b64 exec, 1
    v_mov_b32 v63, s24
    s_cmp_lg_u32 s75, 0
    s_cbranch_scc1 L_far5
    buffer_store_dword v63, off, s[12:15], s34 offset:64
    s_branch L_near5
L_far5:
    buffer_store_dword v63, off, s[12:15], s34 offset:64 sc1
L_near5:
    s_mov_b64 exec, -1
L_BV_p2:
    v_and_b32_dpp v8, v48, v20 row_newbcast:2 row_mask:0xf bank_mask:0xf
    v_and_b32_dpp v9, v48, v21 row_newbcast:2 row_mask:0xf bank_mask:0xf
    v_and_b32_dpp v10, v48, v22 row_newbcast:2 row_mask:0xf bank_mask:0xf
    v_and_b32_dpp v11, v48, v23 row_newbcast:2 row_mask:0xf bank_mask:0xf
    s_waitcnt vmcnt(15)
    s_nop 0
    v_mfma_f32_16x16x32_bf16 v[12:15], v[96:99], v[8:11], v[12:15]
    buffer_load_dwordx4 v[96:99], v1, s[4:7], s32 offen offset:0 nt
    s_add_u32 s32, s32, 6144
    v_and_b32_dpp v8, v48, v20 row_newbcast:6 row_mask:0xf bank_mask:0xf
    v_and_b32_dpp v9, v48, v21 row_newbcast:6 row_mask:0xf bank_mask:0xf
    v_and_b32_dpp v10, v48, v22 row_newbcast:6 row_mask:0xf bank_mask:0xf
    v_and_b32_dpp v11, v48, v23 row_newbcast:6 row_mask:0xf bank_mask:0xf
    s_waitcnt vmcnt(15)
    s_nop 0
    v_mfma_f32_16x16x32_bf16 v[12:15], v[100:103], v[8:11], v[12:15]
    buffer_load_dwordx4 v[100:103], v1, s[4:7], s32 offen offset:0 nt
    s_add_u32 s32, s32, 6144
    s_cmp_eq_u32 s27, 9
    s_cbranch_scc1 L_BT
    v_and_b32_dpp v8, v48, v20 row_newbcast:10 row_mask:0xf bank_mask:0xf
    v_and_b32_dpp v9, v48, v21 row_newbcast:10 row_mask:0xf bank_mask:0xf
    v_and_b32_dpp v10, v48, v22 row_newbcast:10 row_mask:0xf bank_mask:0xf
    v_and_b32_dpp v11, v48, v23 row_newbcast:10 row_mask:0xf bank_mask:0xf
    s_waitcnt vmcnt(15)
    s_nop 0
    v_mfma_f32_16x16x32_bf16 v[12:15], v[104:107], v[8:11], v[12:15]
    buffer_load_dwordx4 v[104:107], v1, s[4:7], s32 offen offset:0 nt
    s_add_u32 s32, s32, 6144
    v_and_b32_dpp v8, v48, v20 row_newbcast:14 row_mask:0xf bank_mask:0xf
    v_and_b32_dpp v9, v48, v21 row_newbcast:14 row_mask:0xf bank_mask:0xf
    v_and_b32_dpp v10, v48, v22 row_newbcast:14 row_mask:0xf bank_mask:0xf
    v_and_b32_dpp v11, v48, v23 row_newbcast:14 row_mask:0xf bank_mask:0xf
    s_waitcnt vmcnt(15)
    s_nop 0
    v_mfma_f32_16x16x32_bf16 v[12:15], v[108:111], v[8:11], v[12:15]
    buffer_load_dwordx4 v[108:111], v1, s[4:7], s32 offen offset:0 nt
    s_add_u32 s32, s32, 6144
    s_cmp_lg_u32 s71, 3
    s_cbranch_scc1 L_BV_p3
    s_lshl_b32 s24, s27, 2
    s_add_u32 s24, s24, 3
    s_mov_b64 exec, 1
    v_mov_b32 v63, s24
    s_cmp_lg_u32 s75, 0
    s_cbranch_scc1 L_far6
    buffer_store_dword v63, off, s[12:15], s34 offset:64
    s_branch L_near6
L_far6:
    buffer_store_dword v63, off, s[12:15], s34 offset:64 sc1
L_near6:
    s_mov_b64 exec, -1
L_BV_p3:
    v_and_b32_dpp v8, v48, v20 row_newbcast:3 row_mask:0xf bank_mask:0xf
    v_and_b32_dpp v9, v48, v21 row_newbcast:3 row_mask:0xf bank_mask:0xf
    v_and_b32_dpp v10, v48, v22 row_newbcast:3 row_mask:0xf bank_mask:0xf
    v_and_b32_dpp v11, v48, v23 row_newbcast:3 row_mask:0xf bank_mask:0xf
    s_waitcnt vmcnt(15)
    s_nop 0
    v_mfma_f32_16x16x32_bf16 v[12:15], v[112:115], v[8:11], v[12:15]
    buffer_load_dwordx4 v[112:115], v1, s[4:7], s32 offen offset:0 nt
    s_add_u32 s32, s32, 6144
    s_cmp_lg_u32 s27, 0
    s_cbranch_scc1 L_BV_d
    v_fma_f32 v49, v49, v61, -v6
    v_fma_f32 v50, v50, v61, -v6
    v_fma_f32 v51, v51, v61, -v6
    v_fma_f32 v52, v52, v61, -v6
    v_fma_f32 v53, v53, v61, -v6
    v_fma_f32 v54, v54, v61, -v6
    v_fma_f32 v55, v55, v61, -v6
    v_fma_f32 v56, v56, v61, -v6
    v_fma_f32 v57, v57, v61, -v6
    v_fma_f32 v58, v58, v61, -v6
    v_exp_f32 v49, v49
    v_exp_f32 v50, v50
    v_exp_f32 v51, v51
    v_exp_f32 v52, v52
    v_exp_f32 v53, v53
    v_exp_f32 v54, v54
    v_exp_f32 v55, v55
    v_exp_f32 v56, v56
    v_exp_f32 v57, v57
    v_exp_f32 v58, v58
    v_add_f32 v7, v7, v49
    v_add_f32 v7, v7, v50
    v_add_f32 v7, v7, v51
    v_add_f32 v7, v7, v52
    v_add_f32 v7, v7, v53
    v_add_f32 v7, v7, v54
    v_add_f32 v7, v7, v55
    v_add_f32 v7, v7, v56
    v_add_f32 v7, v7, v57
    v_add_f32 v7, v7, v58
    v_cvt_pk_bf16_f32 v49, v49, v49
    v_cvt_pk_bf16_f32 v50, v50, v50
    v_cvt_pk_bf16_f32 v51, v51, v51
    v_cvt_pk_bf16_f32 v52, v52, v52
    v_cvt_pk_bf16_f32 v53, v53, v53
    v_cvt_pk_bf16_f32 v54, v54, v54
    v_cvt_pk_bf16_f32 v55, v55, v55
    v_cvt_pk_bf16_f32 v56, v56, v56
    v_cvt_pk_bf16_f32 v57, v57, v57
    v_cvt_pk_bf16_f32 v58, v58, v58
    v_add_f32_dpp v7, v7, v7 row_ror:8 row_mask:0xf bank_mask:0xf
    s_nop 1
    v_add_f32_dpp v7, v7, v7 row_ror:4 row_mask:0xf bank_mask:0xf
    s_nop 1
    v_add_f32_dpp v7, v7, v7 row_ror:2 row_mask:0xf bank_mask:0xf
    s_nop 1
    v_add_f32_dpp v7, v7, v7 row_ror:1 row_mask:0xf bank_mask:0xf
    s_nop 1
    v_add_f32_dpp v7, v7, v7 row_bcast:15 row_mask:0xa bank_mask:0xf
    s_nop 1
    v_add_f32_dpp v7, v7, v7 row_bcast:31 row_mask:0xc bank_mask:0xf
    s_nop 0
    v_readlane_b32 s70, v7, 63
    s_lshl_b32 s25, s3, 4
    s_add_u32 s25, s25, s34
    s_mov_b64 exec, 1
    v_mov_b32 v7, s70
    s_cmp_lg_u32 s75, 0
    s_cbranch_scc1 L_far7
    buffer_store_dwordx2 v[6:7], off, s[12:15], s25
    s_branch L_near7
L_far7:
    buffer_store_dwordx2 v[6:7], off, s[12:15], s25 sc1
L_near7:
    s_mov_b64 exec, -1
L_BV_d:
    v_and_b32_dpp v8, v48, v20 row_newbcast:7 row_mask:0xf bank_mask:0xf
    v_and_b32_dpp v9, v48, v21 row_newbcast:7 row_mask:0xf bank_mask:0xf
    v_and_b32_dpp v10, v48, v22 row_newbcast:7 row_mask:0xf bank_mask:0xf
    v_and_b32_dpp v11, v48, v23 row_newbcast:7 row_mask:0xf bank_mask:0xf
    s_waitcnt vmcnt(15)
    s_nop 0
    v_mfma_f32_16x16x32_bf16 v[12:15], v[116:119], v[8:11], v[12:15]
    buffer_load_dwordx4 v[116:119], v1, s[4:7], s32 offen offset:0 nt
    s_add_u32 s32, s32, 6144
    v_and_b32_dpp v8, v48, v20 row_newbcast:11 row_mask:0xf bank_mask:0xf
    v_and_b32_dpp v9, v48, v21 row_newbcast:11 row_mask:0xf bank_mask:0xf
    v_and_b32_dpp v10, v48, v22 row_newbcast:11 row_mask:0xf bank_mask:0xf
    v_and_b32_dpp v11, v48, v23 row_newbcast:11 row_mask:0xf bank_mask:0xf
    s_waitcnt vmcnt(15)
    s_nop 0
    v_mfma_f32_16x16x32_bf16 v[12:15], v[120:123], v[8:11], v[12:15]
    buffer_load_dwordx4 v[120:123], v1, s[4:7], s32 offen offset:0 nt
    s_add_u32 s32, s32, 6144
    v_and_b32_dpp v8, v48, v20 row_newbcast:15 row_mask:0xf bank_mask:0xf
    v_and_b32_dpp v9, v48, v21 row_newbcast:15 row_mask:0xf bank_mask:0xf
    v_and_b32_dpp v10, v48, v22 row_newbcast:15 row_mask:0xf bank_mask:0xf
    v_and_b32_dpp v11, v48, v23 row_newbcast:15 row_mask:0xf bank_mask:0xf
    s_waitcnt vmcnt(15)
    s_nop 0
    v_mfma_f32_16x16x32_bf16 v[12:15], v[124:127], v[8:11], v[12:15]
    buffer_load_dwordx4 v[124:127], v1, s[4:7], s32 offen offset:0 nt
    s_add_u32 s32, s32, 6144
    v_mov_b32 v48, v49
    v_mov_b32 v49, v50
    v_mov_b32 v50, v51
    v_mov_b32 v51, v52
    v_mov_b32 v52, v53
    v_mov_b32 v53, v54
    v_mov_b32 v54, v55
    v_mov_b32 v55, v56
    v_mov_b32 v56, v57
    v_mov_b32 v57, v58
    s_add_u32 s27, s27, 1
    s_branch L_BV
L_BT:
    v_and_b32_dpp v8, v48, v20 row_newbcast:10 row_mask:0xf bank_mask:0xf
    v_and_b32_dpp v9, v48, v21 row_newbcast:10 row_mask:0xf bank_mask:0xf
    v_and_b32_dpp v10, v48, v22 row_newbcast:10 row_mask:0xf bank_mask:0xf
    v_and_b32_dpp v11, v48, v23 row_newbcast:10 row_mask:0xf bank_mask:0xf
    s_waitcnt vmcnt(15)
    s_nop 0
    v_mfma_f32_16x16x32_bf16 v[12:15], v[104:107], v[8:11], v[12:15]
    buffer_load_dwordx4 v[104:107], v1, s[4:7], s28 offen offset:0 nt
    v_and_b32_dpp v8, v48, v20 row_newbcast:14 row_mask:0xf bank_mask:0xf
    v_and_b32_dpp v9, v48, v21 row_newbcast:14 row_mask:0xf bank_mask:0xf
    v_and_b32_dpp v10, v48, v22 row_newbcast:14 row_mask:0xf bank_mask:0xf
    v_and_b32_dpp v11, v48, v23 row_newbcast:14 row_mask:0xf bank_mask:0xf
    s_waitcnt vmcnt(15)
    s_nop 0
    v_mfma_f32_16x16x32_bf16 v[12:15], v[108:111], v[8:11], v[12:15]
    v_and_b32_dpp v8, v48, v20 row_newbcast:3 row_mask:0xf bank_mask:0xf
    v_and_b32_dpp v9, v48, v21 row_newbcast:3 row_mask:0xf bank_mask:0xf
    v_and_b32_dpp v10, v48, v22 row_newbcast:3 row_mask:0xf bank_mask:0xf
    v_and_b32_dpp v11, v48, v23 row_newbcast:3 row_mask:0xf bank_mask:0xf
    s_waitcnt vmcnt(14)
    s_nop 0
    v_mfma_f32_16x16x32_bf16 v[12:15], v[112:115], v[8:11], v[12:15]
    v_and_b32_dpp v8, v48, v20 row_newbcast:7 row_mask:0xf bank_mask:0xf
    v_and_b32_dpp v9, v48, v21 row_newbcast:7 row_mask:0xf bank_mask:0xf
    v_and_b32_dpp v10, v48, v22 row_newbcast:7 row_mask:0xf bank_mask:0xf
    v_and_b32_dpp v11, v48, v23 row_newbcast:7 row_mask:0xf bank_mask:0xf
    s_waitcnt vmcnt(13)
    s_nop 0
    v_mfma_f32_16x16x32_bf16 v[12:15], v[116:119], v[8:11], v[12:15]
    v_and_b32_dpp v8, v48, v20 row_newbcast:11 row_mask:0xf bank_mask:0xf
    v_and_b32_dpp v9, v48, v21 row_newbcast:11 row_mask:0xf bank_mask:0xf
    v_and_b32_dpp v10, v48, v22 row_newbcast:11 row_mask:0xf bank_mask:0xf
    v_and_b32_dpp v11, v48, v23 row_newbcast:11 row_mask:0xf bank_mask:0xf
    s_waitcnt vmcnt(12)
    s_nop 0
    v_mfma_f32_16x16x32_bf16 v[12:15], v[120:123], v[8:11], v[12:15]
    v_and_b32_dpp v8, v48, v20 row_newbcast:15 row_mask:0xf bank_mask:0xf
    v_and_b32_dpp v9, v48, v21 row_newbcast:15 row_mask:0xf bank_mask:0xf
    v_and_b32_dpp v10, v48, v22 row_newbcast:15 row_mask:0xf bank_mask:0xf
    v_and_b32_dpp v11, v48, v23 row_newbcast:15 row_mask:0xf bank_mask:0xf
    s_waitcnt vmcnt(11)
    s_nop 0
    v_mfma_f32_16x16x32_bf16 v[12:15], v[124:127], v[8:11], v[12:15]
    v_and_b32_dpp v8, v49, v20 row_newbcast:0 row_mask:0xf bank_mask:0xf
    v_and_b32_dpp v9, v49, v21 row_newbcast:0 row_mask:0xf bank_mask:0xf
    v_and_b32_dpp v10, v49, v22 row_newbcast:0 row_mask:0xf bank_mask:0xf
    v_and_b32_dpp v11, v49, v23 row_newbcast:0 row_mask:0xf bank_mask:0xf
    s_waitcnt vmcnt(10)
    s_nop 0
    v_mfma_f32_16x16x32_bf16 v[12:15], v[64:67], v[8:11], v[12:15]
    v_and_b32_dpp v8, v49, v20 row_newbcast:4 row_mask:0xf bank_mask:0xf
    v_and_b32_dpp v9, v49, v21 row_newbcast:4 row_mask:0xf bank_mask:0xf
    v_and_b32_dpp v10, v49, v22 row_newbcast:4 row_mask:0xf bank_mask:0xf
    v_and_b32_dpp v11, v49, v23 row_newbcast:4 row_mask:0xf bank_mask:0xf
    s_waitcnt vmcnt(9)
    s_nop 0
    v_mfma_f32_16x16x32_bf16 v[12:15], v[68:71], v[8:11], v[12:15]
    v_and_b32_dpp v8, v49, v20 row_newbcast:8 row_mask:0xf bank_mask:0xf
    v_and_b32_dpp v9, v49, v21 row_newbcast:8 row_mask:0xf bank_mask:0xf
    v_and_b32_dpp v10, v49, v22 row_newbcast:8 row_mask:0xf bank_mask:0xf
    v_and_b32_dpp v11, v49, v23 row_newbcast:8 row_mask:0xf bank_mask:0xf
    s_waitcnt vmcnt(8)
    s_nop 0
    v_mfma_f32_16x16x32_bf16 v[12:15], v[72:75], v[8:11], v[12:15]
    v_and_b32_dpp v8, v49, v20 row_newbcast:12 row_mask:0xf bank_mask:0xf
    v_and_b32_dpp v9, v49, v21 row_newbcast:12 row_mask:0xf bank_mask:0xf
    v_and_b32_dpp v10, v49, v22 row_newbcast:12 row_mask:0xf bank_mask:0xf
    v_and_b32_dpp v11, v49, v23 row_newbcast:12 row_mask:0xf bank_mask:0xf
    s_waitcnt vmcnt(7)
    s_nop 0
    v_mfma_f32_16x16x32_bf16 v[12:15], v[76:79], v[8:11], v[12:15]
    v_and_b32_dpp v8, v49, v20 row_newbcast:1 row_mask:0xf bank_mask:0xf
    v_and_b32_dpp v9, v49, v21 row_newbcast:1 row_mask:0xf bank_mask:0xf
    v_and_b32_dpp v10, v49, v22 row_newbcast:1 row_mask:0xf bank_mask:0xf
    v_and_b32_dpp v11, v49, v23 row_newbcast:1 row_mask:0xf bank_mask:0xf
    s_waitcnt vmcnt(6)
    s_nop 0
    v_mfma_f32_16x16x32_bf16 v[12:15], v[80:83], v[8:11], v[12:15]
    v_and_b32_dpp v8, v49, v20 row_newbcast:5 row_mask:0xf bank_mask:0xf
    v_and_b32_dpp v9, v49, v21 row_newbcast:5 row_mask:0xf bank_mask:0xf
    v_and_b32_dpp v10, v49, v22 row_newbcast:5 row_mask:0xf bank_mask:0xf
    v_and_b32_dpp v11, v49, v23 row_newbcast:5 row_mask:0xf bank_mask:0xf
    s_waitcnt vmcnt(5)
    s_nop 0
    v_mfma_f32_16x16x32_bf16 v[12:15], v[84:87], v[8:11], v[12:15]
    v_and_b32_dpp v8, v49, v20 row_newbcast:9 row_mask:0xf bank_mask:0xf
    v_and_b32_dpp v9, v49, v21 row_newbcast:9 row_mask:0xf bank_mask:0xf
    v_and_b32_dpp v10, v49, v22 row_newbcast:9 row_mask:0xf bank_mask:0xf
    v_and_b32_dpp v11, v49, v23 row_newbcast:9 row_mask:0xf bank_mask:0xf
    s_waitcnt vmcnt(4)
    s_nop 0
    v_mfma_f32_16x16x32_bf16 v[12:15], v[88:91], v[8:11], v[12:15]
    v_and_b32_dpp v8, v49, v20 row_newbcast:13 row_mask:0xf bank_mask:0xf
    v_and_b32_dpp v9, v49, v21 row_newbcast:13 row_mask:0xf bank_mask:0xf
    v_and_b32_dpp v10, v49, v22 row_newbcast:13 row_mask:0xf bank_mask:0xf
    v_and_b32_dpp v11, v49, v23 row_newbcast:13 row_mask:0xf bank_mask:0xf
    s_waitcnt vmcnt(3)
    s_nop 0
    v_mfma_f32_16x16x32_bf16 v[12:15], v[92:95], v[8:11], v[12:15]
    v_and_b32_dpp v8, v49, v20 row_newbcast:2 row_mask:0xf bank_mask:0xf
    v_and_b32_dpp v9, v49, v21 row_newbcast:2 row_mask:0xf bank_mask:0xf
    v_and_b32_dpp v10, v49, v22 row_newbcast:2 row_mask:0xf bank_mask:0xf
    v_and_b32_dpp v11, v49, v23 row_newbcast:2 row_mask:0xf bank_mask:0xf
    s_waitcnt vmcnt(2)
    s_nop 0
    v_mfma_f32_16x16x32_bf16 v[12:15], v[96:99], v[8:11], v[12:15]
    v_and_b32_dpp v8, v49, v20 row_newbcast:6 row_mask:0xf bank_mask:0xf
    v_and_b32_dpp v9, v49, v21 row_newbcast:6 row_mask:0xf bank_mask:0xf
    v_and_b32_dpp v10, v49, v22 row_newbcast:6 row_mask:0xf bank_mask:0xf
    v_and_b32_dpp v11, v49, v23 row_newbcast:6 row_mask:0xf bank_mask:0xf
    s_waitcnt vmcnt(1)
    s_nop 0
    v_mfma_f32_16x16x32_bf16 v[12:15], v[100:103], v[8:11], v[12:15]
    v_and_b32_dpp v8, v49, v20 row_newbcast:10 row_mask:0xf bank_mask:0xf
    v_and_b32_dpp v9, v49, v21 row_newbcast:10 row_mask:0xf bank_mask:0xf
    v_and_b32_dpp v10, v49, v22 row_newbcast:10 row_mask:0xf bank_mask:0xf
    v_and_b32_dpp v11, v49, v23 row_newbcast:10 row_mask:0xf bank_mask:0xf
    s_waitcnt vmcnt(0)
    s_nop 0
    v_mfma_f32_16x16x32_bf16 v[12:15], v[104:107], v[8:11], v[12:15]
    s_mov_b32 exec_lo, 0x00ff00ff
    s_mov_b32 exec_hi, 0x00ff00ff
    s_cmp_lg_u32 s75, 0
    s_nop 4
    v_cvt_pk_bf16_f32 v4, v12, v13
    v_cvt_pk_bf16_f32 v5, v14, v15
    s_cbranch_scc1 L_far8
    buffer_store_dwordx2 v[4:5], v60, s[12:15], s73 offen
    s_branch L_near8
L_far8:
    buffer_store_dwordx2 v[4:5], v60, s[12:15], s73 offen sc1
L_near8:
    s_endpgm
L_A:
    v_lshrrev_b32 v1, 6, v0
    v_and_b32 v0, 63, v0
    v_readfirstlane_b32 s3, v1
    v_lshlrev_b32 v2, 4, v0
    s_mov_b32 s74, s2
    s_and_b32 s72, s2, 31
    s_and_b32 s70, s2, 6
    s_and_b32 s25, s2, 7
    s_add_u32 s70, s70, s25
    s_lshr_b32 s26, s72, 3
    s_and_b32 s25, s26, 1
    s_lshl_b32 s25, s25, 1
    s_and_b32 s26, s26, 2
    s_lshl_b32 s26, s26, 3
    s_or_b32 s26, s26, s25
    s_or_b32 s26, s26, s70
    v_lshrrev_b32 v3, 4, v0
    v_and_b32 v4, 15, v0
    v_lshlrev_b32 v18, 18, v3
    v_lshl_add_u32 v18, v4, 4, v18
    v_lshrrev_b32 v6, 3, v4
    v_lshlrev_b32 v6, 10, v6
    v_lshl_add_u32 v19, v3, 6, v6
    v_bfe_u32 v1, v0, 2, 2
    v_lshlrev_b32 v64, 18, v1
    v_lshl_add_u32 v64, v3, 6, v64
    v_and_b32 v4, 3, v0
    v_lshl_add_u32 v64, v4, 4, v64
    v_lshlrev_b32 v65, 9, v1
    v_lshl_add_u32 v65, v3, 7, v65
    v_lshl_add_u32 v65, v4, 5, v65
    v_add_u32 v65, 135168, v65
    v_lshlrev_b32 v66, 15, v1
    v_lshl_add_u32 v66, v3, 6, v66
    v_lshl_add_u32 v66, v4, 4, v66
    v_and_b32 v4, 15, v0
    v_lshlrev_b32 v67, 10, v3
    v_lshl_add_u32 v67, v4, 4, v67
    s_lshl_b32 s35, s3, 20
    s_lshl_b32 s24, s26, 8
    s_add_u32 s35, s35, s24
    s_waitcnt lgkmcnt(0)
    s_cmp_lt_u32 s74, 32
    s_cselect_b64 s[4:5], s[40:41], s[54:55]
    s_mov_b32 s6, 0x400000
    s_mov_b32 s7, 0x20000
    s_cselect_b64 s[20:21], s[36:37], s[48:49]
    s_mov_b32 s22, 4096
    s_mov_b32 s23, 0x20000
    s_cselect_b32 s75, 0x400000, 0
    s_lshl_b32 s24, s3, 8
    s_mov_b32 s32, s35
    buffer_load_dwordx4 v[12:15], v67, s[20:23], s24 offen
    buffer_load_dwordx4 v[128:131], v18, s[4:7], s32 offen
    s_add_u32 s32, s32, 8192
    buffer_load_dwordx4 v[132:135], v18, s[4:7], s32 offen
    s_add_u32 s32, s32, 8192
    buffer_load_dwordx4 v[136:139], v18, s[4:7], s32 offen
    s_add_u32 s32, s32, 8192
    buffer_load_dwordx4 v[140:143], v18, s[4:7], s32 offen
    s_add_u32 s32, s32, 8192
    buffer_load_dwordx4 v[144:147], v18, s[4:7], s32 offen
    s_add_u32 s32, s32, 8192
    buffer_load_dwordx4 v[148:151], v18, s[4:7], s32 offen
    s_add_u32 s32, s32, 8192
    buffer_load_dwordx4 v[152:155], v18, s[4:7], s32 offen
    s_add_u32 s32, s32, 8192
    buffer_load_dwordx4 v[156:159], v18, s[4:7], s32 offen
    s_add_u32 s32, s32, 8192
    buffer_load_dwordx4 v[160:163], v18, s[4:7], s32 offen
    s_add_u32 s32, s32, 8192
    buffer_load_dwordx4 v[164:167], v18, s[4:7], s32 offen
    s_add_u32 s32, s32, 8192
    buffer_load_dwordx4 v[168:171], v18, s[4:7], s32 offen
    s_add_u32 s32, s32, 8192
    buffer_load_dwordx4 v[172:175], v18, s[4:7], s32 offen
    s_add_u32 s32, s32, 8192
    s_mov_b32 s12, s62
    s_mov_b32 s13, s63
    s_mov_b32 s14, 0x400000
    s_mov_b32 s15, 0x20000
    s_mov_b32 s16, s60
    s_mov_b32 s17, s61
    s_mov_b32 s18, 0x100
    s_mov_b32 s19, 0x20000
    v_and_b32 v3, 1, v0
    v_lshlrev_b32 v3, 4, v3
    v_mov_b32 v4, 0xffff
    v_lshlrev_b32 v4, v3, v4
    v_bfe_u32 v3, v0, 1, 2
    v_cmp_eq_u32 vcc, 0, v3
    s_nop 1
    v_cndmask_b32 v20, 0, v4, vcc
    v_cmp_eq_u32 vcc, 1, v3
    s_nop 1
    v_cndmask_b32 v21, 0, v4, vcc
    v_cmp_eq_u32 vcc, 2, v3
    s_nop 1
    v_cndmask_b32 v22, 0, v4, vcc
    v_cmp_eq_u32 vcc, 3, v3
    s_nop 1
    v_cndmask_b32 v23, 0, v4, vcc
    v_mov_b32 v3, 0x0c0c0c0c
    s_mov_b32 s24, 0x01000100
    s_mov_b32 s25, 0x03020302
    v_bfi_b32 v24, v20, s24, v3
    v_bfi_b32 v28, v20, s25, v3
    v_bfi_b32 v25, v21, s24, v3
    v_bfi_b32 v29, v21, s25, v3
    v_bfi_b32 v26, v22, s24, v3
    v_bfi_b32 v30, v22, s25, v3
    v_bfi_b32 v27, v23, s24, v3
    v_bfi_b32 v31, v23, s25, v3
    s_mov_b32 s64, 0x22222222
    s_mov_b32 s65, 0x22222222
    s_mov_b32 s66, 0x44444444
    s_mov_b32 s67, 0x44444444
    s_mov_b32 s68, 0x88888888
    s_mov_b32 s69, 0x88888888
    s_lshl_b32 s24, s3, 8
    s_add_u32 s24, s24, 145408
    v_add_u32 v3, s24, v67
    v_add_u32 v4, s24, v19
    s_waitcnt vmcnt(12)
    ds_write_b128 v3, v[12:15]
    s_waitcnt lgkmcnt(0)
    ds_read_b128 v[32:35], v4 offset:0
    ds_read_b128 v[36:39], v4 offset:16
    ds_read_b128 v[40:43], v4 offset:32
    ds_read_b128 v[44:47], v4 offset:48
    ds_read_b128 v[48:51], v4 offset:2048
    ds_read_b128 v[52:55], v4 offset:2064
    ds_read_b128 v[56:59], v4 offset:2080
    ds_read_b128 v[60:63], v4 offset:2096
    s_waitcnt lgkmcnt(0)
    v_mov_b32 v76, -1
    v_mov_b32 v77, -1
    v_mov_b32 v78, -1
    v_mov_b32 v79, -1
    s_lshl_b32 s71, s72, 2
    s_add_u32 s71, s71, s3
    s_lshl_b32 s71, s71, 10
    s_add_u32 s71, s71, 0x1b0000
    s_cmp_lt_u32 s74, 32
    s_cselect_b32 s71, 0x400000, s71
    v_perm_b32 v8, v32, v32, v24
    v_perm_b32 v9, v32, v32, v25
    v_perm_b32 v10, v32, v32, v26
    v_perm_b32 v11, v32, v32, v27
    v_perm_b32 v4, v48, v48, v24
    v_perm_b32 v5, v48, v48, v25
    v_perm_b32 v6, v48, v48, v26
    v_perm_b32 v7, v48, v48, v27
    s_waitcnt vmcnt(11)
    v_mfma_f32_16x16x32_bf16 v[12:15], v[128:131], v[8:11], 0
    v_mfma_f32_16x16x32_bf16 v[68:71], v[128:131], v[4:7], 0
    buffer_load_dwordx4 v[176:179], v18, s[4:7], s32 offen nt
    s_add_u32 s32, s32, 8192
    v_perm_b32 v8, v32, v32, v28
    v_perm_b32 v9, v32, v32, v29
    v_perm_b32 v10, v32, v32, v30
    v_perm_b32 v11, v32, v32, v31
    v_perm_b32 v4, v48, v48, v28
    v_perm_b32 v5, v48, v48, v29
    v_perm_b32 v6, v48, v48, v30
    v_perm_b32 v7, v48, v48, v31
    s_waitcnt vmcnt(11)
    v_mfma_f32_16x16x32_bf16 v[12:15], v[132:135], v[8:11], v[12:15]
    v_mfma_f32_16x16x32_bf16 v[68:71], v[132:135], v[4:7], v[68:71]
    buffer_load_dwordx4 v[180:183], v18, s[4:7], s32 offen nt
    s_add_u32 s32, s32, 8192
    v_perm_b32 v8, v33, v33, v24
    v_perm_b32 v9, v33, v33, v25
    v_perm_b32 v10, v33, v33, v26
    v_perm_b32 v11, v33, v33, v27
    v_perm_b32 v4, v49, v49, v24
    v_perm_b32 v5, v49, v49, v25
    v_perm_b32 v6, v49, v49, v26
    v_perm_b32 v7, v49, v49, v27
    s_waitcnt vmcnt(11)
    v_mfma_f32_16x16x32_bf16 v[12:15], v[136:139], v[8:11], v[12:15]
    v_mfma_f32_16x16x32_bf16 v[68:71], v[136:139], v[4:7], v[68:71]
    buffer_load_dwordx4 v[184:187], v18, s[4:7], s32 offen nt
    s_add_u32 s32, s32, 8192
    v_perm_b32 v8, v33, v33, v28
    v_perm_b32 v9, v33, v33, v29
    v_perm_b32 v10, v33, v33, v30
    v_perm_b32 v11, v33, v33, v31
    v_perm_b32 v4, v49, v49, v28
    v_perm_b32 v5, v49, v49, v29
    v_perm_b32 v6, v49, v49, v30
    v_perm_b32 v7, v49, v49, v31
    s_waitcnt vmcnt(11)
    v_mfma_f32_16x16x32_bf16 v[12:15], v[140:143], v[8:11], v[12:15]
    v_mfma_f32_16x16x32_bf16 v[68:71], v[140:143], v[4:7], v[68:71]
    buffer_load_dwordx4 v[188:191], v18, s[4:7], s32 offen nt
    s_add_u32 s32, s32, 8192
    v_perm_b32 v8, v34, v34, v24
    v_perm_b32 v9, v34, v34, v25
    v_perm_b32 v10, v34, v34, v26
    v_perm_b32 v11, v34, v34, v27
    v_perm_b32 v4, v50, v50, v24
    v_perm_b32 v5, v50, v50, v25
    v_perm_b32 v6, v50, v50, v26
    v_perm_b32 v7, v50, v50, v27
    s_waitcnt vmcnt(11)
    v_mfma_f32_16x16x32_bf16 v[12:15], v[144:147], v[8:11], v[12:15]
    v_mfma_f32_16x16x32_bf16 v[68:71], v[144:147], v[4:7], v[68:71]
    buffer_load_dwordx4 v[192:195], v18, s[4:7], s32 offen nt
    s_add_u32 s32, s32, 8192
    v_perm_b32 v8, v34, v34, v28
    v_perm_b32 v9, v34, v34, v29
    v_perm_b32 v10, v34, v34, v30
    v_perm_b32 v11, v34, v34, v31
    v_perm_b32 v4, v50, v50, v28
    v_perm_b32 v5, v50, v50, v29
    v_perm_b32 v6, v50, v50, v30
    v_perm_b32 v7, v50, v50, v31
    s_waitcnt vmcnt(11)
    v_mfma_f32_16x16x32_bf16 v[12:15], v[148:151], v[8:11], v[12:15]
    v_mfma_f32_16x16x32_bf16 v[68:71], v[148:151], v[4:7], v[68:71]
    buffer_load_dwordx4 v[196:199], v18, s[4:7], s32 offen nt
    s_add_u32 s32, s32, 8192
    v_perm_b32 v8, v35, v35, v24
    v_perm_b32 v9, v35, v35, v25
    v_perm_b32 v10, v35, v35, v26
    v_perm_b32 v11, v35, v35, v27
    v_perm_b32 v4, v51, v51, v24
    v_perm_b32 v5, v51, v51, v25
    v_perm_b32 v6, v51, v51, v26
    v_perm_b32 v7, v51, v51, v27
    s_waitcnt vmcnt(11)
    v_mfma_f32_16x16x32_bf16 v[12:15], v[152:155], v[8:11], v[12:15]
    v_mfma_f32_16x16x32_bf16 v[68:71], v[152:155], v[4:7], v[68:71]
    buffer_load_dwordx4 v[200:203], v18, s[4:7], s32 offen nt
    s_add_u32 s32, s32, 8192
    v_perm_b32 v8, v35, v35, v28
    v_perm_b32 v9, v35, v35, v29
    v_perm_b32 v10, v35, v35, v30
    v_perm_b32 v11, v35, v35, v31
    v_perm_b32 v4, v51, v51, v28
    v_perm_b32 v5, v51, v51, v29
    v_perm_b32 v6, v51, v51, v30
    v_perm_b32 v7, v51, v51, v31
    s_waitcnt vmcnt(11)
    v_mfma_f32_16x16x32_bf16 v[12:15], v[156:159], v[8:11], v[12:15]
    v_mfma_f32_16x16x32_bf16 v[68:71], v[156:159], v[4:7], v[68:71]
    buffer_load_dwordx4 v[204:207], v18, s[4:7], s32 offen nt
    s_add_u32 s32, s32, 8192
    v_perm_b32 v8, v36, v36, v24
    v_perm_b32 v9, v36, v36, v25
    v_perm_b32 v10, v36, v36, v26
    v_perm_b32 v11, v36, v36, v27
    v_perm_b32 v4, v52, v52, v24
    v_perm_b32 v5, v52, v52, v25
    v_perm_b32 v6, v52, v52, v26
    v_perm_b32 v7, v52, v52, v27
    s_waitcnt vmcnt(11)
    v_mfma_f32_16x16x32_bf16 v[12:15], v[160:163], v[8:11], v[12:15]
    v_mfma_f32_16x16x32_bf16 v[68:71], v[160:163], v[4:7], v[68:71]
    buffer_load_dwordx4 v[208:211], v18, s[4:7], s32 offen nt
    s_add_u32 s32, s32, 8192
    v_perm_b32 v8, v36, v36, v28
    v_perm_b32 v9, v36, v36, v29
    v_perm_b32 v10, v36, v36, v30
    v_perm_b32 v11, v36, v36, v31
    v_perm_b32 v4, v52, v52, v28
    v_perm_b32 v5, v52, v52, v29
    v_perm_b32 v6, v52, v52, v30
    v_perm_b32 v7, v52, v52, v31
    s_waitcnt vmcnt(11)
    v_mfma_f32_16x16x32_bf16 v[12:15], v[164:167], v[8:11], v[12:15]
    v_mfma_f32_16x16x32_bf16 v[68:71], v[164:167], v[4:7], v[68:71]
    buffer_load_dwordx4 v[212:215], v18, s[4:7], s32 offen nt
    s_add_u32 s32, s32, 8192
    v_perm_b32 v8, v37, v37, v24
    v_perm_b32 v9, v37, v37, v25
    v_perm_b32 v10, v37, v37, v26
    v_perm_b32 v11, v37, v37, v27
    v_perm_b32 v4, v53, v53, v24
    v_perm_b32 v5, v53, v53, v25
    v_perm_b32 v6, v53, v53, v26
    v_perm_b32 v7, v53, v53, v27
    s_waitcnt vmcnt(11)
    v_mfma_f32_16x16x32_bf16 v[12:15], v[168:171], v[8:11], v[12:15]
    v_mfma_f32_16x16x32_bf16 v[68:71], v[168:171], v[4:7], v[68:71]
    buffer_load_dwordx4 v[216:219], v18, s[4:7], s32 offen nt
    s_add_u32 s32, s32, 8192
    v_perm_b32 v8, v37, v37, v28
    v_perm_b32 v9, v37, v37, v29
    v_perm_b32 v10, v37, v37, v30
    v_perm_b32 v11, v37, v37, v31
    v_perm_b32 v4, v53, v53, v28
    v_perm_b32 v5, v53, v53, v29
    v_perm_b32 v6, v53, v53, v30
    v_perm_b32 v7, v53, v53, v31
    s_waitcnt vmcnt(11)
    v_mfma_f32_16x16x32_bf16 v[12:15], v[172:175], v[8:11], v[12:15]
    v_mfma_f32_16x16x32_bf16 v[68:71], v[172:175], v[4:7], v[68:71]
    buffer_load_dwordx4 v[220:223], v18, s[4:7], s32 offen nt
    s_add_u32 s32, s32, 8192
    v_perm_b32 v8, v38, v38, v24
    v_perm_b32 v9, v38, v38, v25
    v_perm_b32 v10, v38, v38, v26
    v_perm_b32 v11, v38, v38, v27
    v_perm_b32 v4, v54, v54, v24
    v_perm_b32 v5, v54, v54, v25
    v_perm_b32 v6, v54, v54, v26
    v_perm_b32 v7, v54, v54, v27
    s_waitcnt vmcnt(11)
    v_mfma_f32_16x16x32_bf16 v[12:15], v[176:179], v[8:11], v[12:15]
    v_mfma_f32_16x16x32_bf16 v[68:71], v[176:179], v[4:7], v[68:71]
    buffer_load_dwordx4 v[224:227], v18, s[4:7], s32 offen nt
    s_add_u32 s32, s32, 8192
    v_perm_b32 v8, v38, v38, v28
    v_perm_b32 v9, v38, v38, v29
    v_perm_b32 v10, v38, v38, v30
    v_perm_b32 v11, v38, v38, v31
    v_perm_b32 v4, v54, v54, v28
    v_perm_b32 v5, v54, v54, v29
    v_perm_b32 v6, v54, v54, v30
    v_perm_b32 v7, v54, v54, v31
    s_waitcnt vmcnt(11)
    v_mfma_f32_16x16x32_bf16 v[12:15], v[180:183], v[8:11], v[12:15]
    v_mfma_f32_16x16x32_bf16 v[68:71], v[180:183], v[4:7], v[68:71]
    buffer_load_dwordx4 v[228:231], v18, s[4:7], s32 offen nt
    s_add_u32 s32, s32, 8192
    v_perm_b32 v8, v39, v39, v24
    v_perm_b32 v9, v39, v39, v25
    v_perm_b32 v10, v39, v39, v26
    v_perm_b32 v11, v39, v39, v27
    v_perm_b32 v4, v55, v55, v24
    v_perm_b32 v5, v55, v55, v25
    v_perm_b32 v6, v55, v55, v26
    v_perm_b32 v7, v55, v55, v27
    s_waitcnt vmcnt(11)
    v_mfma_f32_16x16x32_bf16 v[12:15], v[184:187], v[8:11], v[12:15]
    v_mfma_f32_16x16x32_bf16 v[68:71], v[184:187], v[4:7], v[68:71]
    buffer_load_dwordx4 v[232:235], v18, s[4:7], s32 offen nt
    s_add_u32 s32, s32, 8192
    v_perm_b32 v8, v39, v39, v28
    v_perm_b32 v9, v39, v39, v29
    v_perm_b32 v10, v39, v39, v30
    v_perm_b32 v11, v39, v39, v31
    v_perm_b32 v4, v55, v55, v28
    v_perm_b32 v5, v55, v55, v29
    v_perm_b32 v6, v55, v55, v30
    v_perm_b32 v7, v55, v55, v31
    s_waitcnt vmcnt(11)
    v_mfma_f32_16x16x32_bf16 v[12:15], v[188:191], v[8:11], v[12:15]
    v_mfma_f32_16x16x32_bf16 v[68:71], v[188:191], v[4:7], v[68:71]
    buffer_load_dwordx4 v[236:239], v18, s[4:7], s32 offen nt
    s_add_u32 s32, s32, 8192
    v_perm_b32 v8, v40, v40, v24
    v_perm_b32 v9, v40, v40, v25
    v_perm_b32 v10, v40, v40, v26
    v_perm_b32 v11, v40, v40, v27
    v_perm_b32 v4, v56, v56, v24
    v_perm_b32 v5, v56, v56, v25
    v_perm_b32 v6, v56, v56, v26
    v_perm_b32 v7, v56, v56, v27
    s_waitcnt vmcnt(11)
    v_mfma_f32_16x16x32_bf16 v[12:15], v[192:195], v[8:11], v[12:15]
    v_mfma_f32_16x16x32_bf16 v[68:71], v[192:195], v[4:7], v[68:71]
    buffer_load_dwordx4 v[240:243], v18, s[4:7], s32 offen nt
    s_add_u32 s32, s32, 8192
    v_perm_b32 v8, v40, v40, v28
    v_perm_b32 v9, v40, v40, v29
    v_perm_b32 v10, v40, v40, v30
    v_perm_b32 v11, v40, v40, v31
    v_perm_b32 v4, v56, v56, v28
    v_perm_b32 v5, v56, v56, v29
    v_perm_b32 v6, v56, v56, v30
    v_perm_b32 v7, v56, v56, v31
    s_waitcnt vmcnt(11)
    v_mfma_f32_16x16x32_bf16 v[12:15], v[196:199], v[8:11], v[12:15]
    v_mfma_f32_16x16x32_bf16 v[68:71], v[196:199], v[4:7], v[68:71]
    buffer_load_dwordx4 v[244:247], v18, s[4:7], s32 offen nt
    s_add_u32 s32, s32, 8192
    v_perm_b32 v8, v41, v41, v24
    v_perm_b32 v9, v41, v41, v25
    v_perm_b32 v10, v41, v41, v26
    v_perm_b32 v11, v41, v41, v27
    v_perm_b32 v4, v57, v57, v24
    v_perm_b32 v5, v57, v57, v25
    v_perm_b32 v6, v57, v57, v26
    v_perm_b32 v7, v57, v57, v27
    s_waitcnt vmcnt(11)
    v_mfma_f32_16x16x32_bf16 v[12:15], v[200:203], v[8:11], v[12:15]
    v_mfma_f32_16x16x32_bf16 v[68:71], v[200:203], v[4:7], v[68:71]
    buffer_load_dwordx4 v[248:251], v18, s[4:7], s32 offen nt
    s_add_u32 s32, s32, 8192
    v_perm_b32 v8, v41, v41, v28
    v_perm_b32 v9, v41, v41, v29
    v_perm_b32 v10, v41, v41, v30
    v_perm_b32 v11, v41, v41, v31
    v_perm_b32 v4, v57, v57, v28
    v_perm_b32 v5, v57, v57, v29
    v_perm_b32 v6, v57, v57, v30
    v_perm_b32 v7, v57, v57, v31
    s_waitcnt vmcnt(11)
    v_mfma_f32_16x16x32_bf16 v[12:15], v[204:207], v[8:11], v[12:15]
    v_mfma_f32_16x16x32_bf16 v[68:71], v[204:207], v[4:7], v[68:71]
    buffer_load_dwordx4 v[252:255], v18, s[4:7], s32 offen nt
    s_add_u32 s32, s32, 8192
    v_perm_b32 v8, v42, v42, v24
    v_perm_b32 v9, v42, v42, v25
    v_perm_b32 v10, v42, v42, v26
    v_perm_b32 v11, v42, v42, v27
    v_perm_b32 v4, v58, v58, v24
    v_perm_b32 v5, v58, v58, v25
    v_perm_b32 v6, v58, v58, v26
    v_perm_b32 v7, v58, v58, v27
    s_waitcnt vmcnt(11)
    v_mfma_f32_16x16x32_bf16 v[12:15], v[208:211], v[8:11], v[12:15]
    v_mfma_f32_16x16x32_bf16 v[68:71], v[208:211], v[4:7], v[68:71]
    s_lshl_b32 s73, s74, 7
    s_add_u32 s73, s73, 0x170000
    s_cmp_lg_u32 s3, 0
    s_cbranch_scc1 L_A_nofl
    s_mov_b64 exec, 1
    buffer_store_dwordx4 v[76:79], off, s[12:15], s73 sc1
    s_mov_b64 exec, -1
L_A_nofl:
    s_cmp_ge_u32 s71, 0x1d7000
    s_cselect_b32 s71, 0x400000, s71
    buffer_store_dwordx4 v[76:79], v2, s[12:15], s71 offen sc1
    s_add_u32 s71, s71, 0x20000
    s_cmp_ge_u32 s71, 0x1d7000
    s_cselect_b32 s71, 0x400000, s71
    buffer_store_dwordx4 v[76:79], v2, s[12:15], s71 offen sc1
    s_add_u32 s71, s71, 0x20000
    s_getpc_b64 s[24:25]
L_pc9:
    s_add_u32 s24, s24, L_A2-L_pc9
    s_addc_u32 s25, s25, 0
    v_lshl_add_u32 v16, v0, 2, s3
    v_lshlrev_b32 v16, 7, v16
    v_min_u32 v16, L_last-L_A2-4, v16
    v_mov_b32 v17, s25
    v_add_co_u32 v16, vcc, s24, v16
    s_nop 1
    v_addc_co_u32 v17, vcc, 0, v17, vcc
    global_load_dword v17, v[16:17], off
    s_mov_b32 s4, s42
    s_mov_b32 s5, s43
    s_mov_b32 s6, s75
    s_mov_b32 s32, s35
    buffer_load_dwordx4 v[128:131], v64, s[4:7], s32 offen nt
    s_add_u32 s32, s32, 8192
    v_perm_b32 v8, v42, v42, v28
    v_perm_b32 v9, v42, v42, v29
    v_perm_b32 v10, v42, v42, v30
    v_perm_b32 v11, v42, v42, v31
    v_perm_b32 v4, v58, v58, v28
    v_perm_b32 v5, v58, v58, v29
    v_perm_b32 v6, v58, v58, v30
    v_perm_b32 v7, v58, v58, v31
    s_waitcnt vmcnt(14)
    v_mfma_f32_16x16x32_bf16 v[12:15], v[212:215], v[8:11], v[12:15]
    v_mfma_f32_16x16x32_bf16 v[68:71], v[212:215], v[4:7], v[68:71]
    buffer_load_dwordx4 v[132:135], v64, s[4:7], s32 offen nt
    s_add_u32 s32, s32, 8192
    v_perm_b32 v8, v43, v43, v24
    v_perm_b32 v9, v43, v43, v25
    v_perm_b32 v10, v43, v43, v26
    v_perm_b32 v11, v43, v43, v27
    v_perm_b32 v4, v59, v59, v24
    v_perm_b32 v5, v59, v59, v25
    v_perm_b32 v6, v59, v59, v26
    v_perm_b32 v7, v59, v59, v27
    s_waitcnt vmcnt(14)
    v_mfma_f32_16x16x32_bf16 v[12:15], v[216:219], v[8:11], v[12:15]
    v_mfma_f32_16x16x32_bf16 v[68:71], v[216:219], v[4:7], v[68:71]
    buffer_load_dwordx4 v[136:139], v64, s[4:7], s32 offen nt
    s_add_u32 s32, s32, 8192
    v_perm_b32 v8, v43, v43, v28
    v_perm_b32 v9, v43, v43, v29
    v_perm_b32 v10, v43, v43, v30
    v_perm_b32 v11, v43, v43, v31
    v_perm_b32 v4, v59, v59, v28
    v_perm_b32 v5, v59, v59, v29
    v_perm_b32 v6, v59, v59, v30
    v_perm_b32 v7, v59, v59, v31
    s_waitcnt vmcnt(14)
    v_mfma_f32_16x16x32_bf16 v[12:15], v[220:223], v[8:11], v[12:15]
    v_mfma_f32_16x16x32_bf16 v[68:71], v[220:223], v[4:7], v[68:71]
    buffer_load_dwordx4 v[140:143], v64, s[4:7], s32 offen nt
    s_add_u32 s32, s32, 8192
    v_perm_b32 v8, v44, v44, v24
    v_perm_b32 v9, v44, v44, v25
    v_perm_b32 v10, v44, v44, v26
    v_perm_b32 v11, v44, v44, v27
    v_perm_b32 v4, v60, v60, v24
    v_perm_b32 v5, v60, v60, v25
    v_perm_b32 v6, v60, v60, v26
    v_perm_b32 v7, v60, v60, v27
    s_waitcnt vmcnt(14)
    v_mfma_f32_16x16x32_bf16 v[12:15], v[224:227], v[8:11], v[12:15]
    v_mfma_f32_16x16x32_bf16 v[68:71], v[224:227], v[4:7], v[68:71]
    buffer_load_dwordx4 v[144:147], v64, s[4:7], s32 offen nt
    s_add_u32 s32, s32, 8192
    v_perm_b32 v8, v44, v44, v28
    v_perm_b32 v9, v44, v44, v29
    v_perm_b32 v10, v44, v44, v30
    v_perm_b32 v11, v44, v44, v31
    v_perm_b32 v4, v60, v60, v28
    v_perm_b32 v5, v60, v60, v29
    v_perm_b32 v6, v60, v60, v30
    v_perm_b32 v7, v60, v60, v31
    s_waitcnt vmcnt(14)
    v_mfma_f32_16x16x32_bf16 v[12:15], v[228:231], v[8:11], v[12:15]
    v_mfma_f32_16x16x32_bf16 v[68:71], v[228:231], v[4:7], v[68:71]
    buffer_load_dwordx4 v[148:151], v64, s[4:7], s32 offen nt
    s_add_u32 s32, s32, 8192
    v_perm_b32 v8, v45, v45, v24
    v_perm_b32 v9, v45, v45, v25
    v_perm_b32 v10, v45, v45, v26
    v_perm_b32 v11, v45, v45, v27
    v_perm_b32 v4, v61, v61, v24
    v_perm_b32 v5, v61, v61, v25
    v_perm_b32 v6, v61, v61, v26
    v_perm_b32 v7, v61, v61, v27
    s_waitcnt vmcnt(14)
    v_mfma_f32_16x16x32_bf16 v[12:15], v[232:235], v[8:11], v[12:15]
    v_mfma_f32_16x16x32_bf16 v[68:71], v[232:235], v[4:7], v[68:71]
    buffer_load_dwordx4 v[152:155], v64, s[4:7], s32 offen nt
    s_add_u32 s32, s32, 8192
    v_perm_b32 v8, v45, v45, v28
    v_perm_b32 v9, v45, v45, v29
    v_perm_b32 v10, v45, v45, v30
    v_perm_b32 v11, v45, v45, v31
    v_perm_b32 v4, v61, v61, v28
    v_perm_b32 v5, v61, v61, v29
    v_perm_b32 v6, v61, v61, v30
    v_perm_b32 v7, v61, v61, v31
    s_waitcnt vmcnt(14)
    v_mfma_f32_16x16x32_bf16 v[12:15], v[236:239], v[8:11], v[12:15]
    v_mfma_f32_16x16x32_bf16 v[68:71], v[236:239], v[4:7], v[68:71]
    buffer_load_dwordx4 v[156:159], v64, s[4:7], s32 offen nt
    s_add_u32 s32, s32, 8192
    v_perm_b32 v8, v46, v46, v24
    v_perm_b32 v9, v46, v46, v25
    v_perm_b32 v10, v46, v46, v26
    v_perm_b32 v11, v46, v46, v27
    v_perm_b32 v4, v62, v62, v24
    v_perm_b32 v5, v62, v62, v25
    v_perm_b32 v6, v62, v62, v26
    v_perm_b32 v7, v62, v62, v27
    s_waitcnt vmcnt(14)
    v_mfma_f32_16x16x32_bf16 v[12:15], v[240:243], v[8:11], v[12:15]
    v_mfma_f32_16x16x32_bf16 v[68:71], v[240:243], v[4:7], v[68:71]
    buffer_load_dwordx4 v[160:163], v64, s[4:7], s32 offen nt
    s_add_u32 s32, s32, 8192
    v_perm_b32 v8, v46, v46, v28
    v_perm_b32 v9, v46, v46, v29
    v_perm_b32 v10, v46, v46, v30
    v_perm_b32 v11, v46, v46, v31
    v_perm_b32 v4, v62, v62, v28
    v_perm_b32 v5, v62, v62, v29
    v_perm_b32 v6, v62, v62, v30
    v_perm_b32 v7, v62, v62, v31
    s_waitcnt vmcnt(14)
    v_mfma_f32_16x16x32_bf16 v[12:15], v[244:247], v[8:11], v[12:15]
    v_mfma_f32_16x16x32_bf16 v[68:71], v[244:247], v[4:7], v[68:71]
    buffer_load_dwordx4 v[164:167], v64, s[4:7], s32 offen nt
    s_add_u32 s32, s32, 8192
    v_perm_b32 v8, v47, v47, v24
    v_perm_b32 v9, v47, v47, v25
    v_perm_b32 v10, v47, v47, v26
    v_perm_b32 v11, v47, v47, v27
    v_perm_b32 v4, v63, v63, v24
    v_perm_b32 v5, v63, v63, v25
    v_perm_b32 v6, v63, v63, v26
    v_perm_b32 v7, v63, v63, v27
    s_waitcnt vmcnt(14)
    v_mfma_f32_16x16x32_bf16 v[12:15], v[248:251], v[8:11], v[12:15]
    v_mfma_f32_16x16x32_bf16 v[68:71], v[248:251], v[4:7], v[68:71]
    buffer_load_dwordx4 v[168:171], v64, s[4:7], s32 offen nt
    s_add_u32 s32, s32, 8192
    v_perm_b32 v8, v47, v47, v28
    v_perm_b32 v9, v47, v47, v29
    v_perm_b32 v10, v47, v47, v30
    v_perm_b32 v11, v47, v47, v31
    v_perm_b32 v4, v63, v63, v28
    v_perm_b32 v5, v63, v63, v29
    v_perm_b32 v6, v63, v63, v30
    v_perm_b32 v7, v63, v63, v31
    s_waitcnt vmcnt(14)
    v_mfma_f32_16x16x32_bf16 v[12:15], v[252:255], v[8:11], v[12:15]
    v_mfma_f32_16x16x32_bf16 v[68:71], v[252:255], v[4:7], v[68:71]
    buffer_load_dwordx4 v[172:175], v64, s[4:7], s32 offen nt
    s_add_u32 s32, s32, 8192
    v_lshrrev_b32 v3, 4, v0
    v_lshlrev_b32 v3, 7, v3
    v_and_b32 v4, 7, v0
    v_lshl_add_u32 v3, v4, 2, v3
    v_bfe_u32 v4, v0, 3, 1
    v_lshl_add_u32 v3, v4, 9, v3
    s_lshl_b32 s24, s3, 11
    s_add_u32 s24, s24, 135168
    v_add_u32 v3, s24, v3
    ds_write_b32 v3, v12 offset:0
    ds_write_b32 v3, v13 offset:32
    ds_write_b32 v3, v14 offset:64
    ds_write_b32 v3, v15 offset:96
    ds_write_b32 v3, v68 offset:1024
    ds_write_b32 v3, v69 offset:1056
    ds_write_b32 v3, v70 offset:1088
    ds_write_b32 v3, v71 offset:1120
    s_waitcnt lgkmcnt(0)
    s_barrier
    ds_read_b128 v[72:75], v65 offset:0
    ds_read_b128 v[76:79], v65 offset:16
    ds_read_b128 v[80:83], v65 offset:2048
    ds_read_b128 v[84:87], v65 offset:2064
    ds_read_b128 v[88:91], v65 offset:4096
    ds_read_b128 v[92:95], v65 offset:4112
    ds_read_b128 v[96:99], v65 offset:6144
    ds_read_b128 v[100:103], v65 offset:6160
    s_waitcnt lgkmcnt(4)
    v_add_f32 v72, v72, v80
    v_add_f32 v73, v73, v81
    v_add_f32 v74, v74, v82
    v_add_f32 v75, v75, v83
    v_add_f32 v76, v76, v84
    v_add_f32 v77, v77, v85
    v_add_f32 v78, v78, v86
    v_add_f32 v79, v79, v87
    s_waitcnt lgkmcnt(2)
    v_add_f32 v72, v72, v88
    v_add_f32 v73, v73, v89
    v_add_f32 v74, v74, v90
    v_add_f32 v75, v75, v91
    v_add_f32 v76, v76, v92
    v_add_f32 v77, v77, v93
    v_add_f32 v78, v78, v94
    v_add_f32 v79, v79, v95
    s_waitcnt lgkmcnt(0)
    v_add_f32 v72, v72, v96
    v_add_f32 v73, v73, v97
    v_add_f32 v74, v74, v98
    v_add_f32 v75, v75, v99
    v_add_f32 v76, v76, v100
    v_add_f32 v77, v77, v101
    v_add_f32 v78, v78, v102
    v_add_f32 v79, v79, v103
    v_cvt_pk_bf16_f32 v8, v72, v73
    v_cvt_pk_bf16_f32 v9, v74, v75
    v_cvt_pk_bf16_f32 v10, v76, v77
    v_cvt_pk_bf16_f32 v11, v78, v79
    s_cmp_ge_u32 s74, 32
    s_cbranch_scc1 L_C
L_A2:
    buffer_load_dwordx4 v[176:179], v64, s[4:7], s32 offen nt
    s_add_u32 s32, s32, 8192
    buffer_load_dwordx4 v[180:183], v64, s[4:7], s32 offen nt
    s_add_u32 s32, s32, 8192
    buffer_load_dwordx4 v[184:187], v64, s[4:7], s32 offen nt
    s_add_u32 s32, s32, 8192
    buffer_load_dwordx4 v[188:191], v64, s[4:7], s32 offen nt
    s_add_u32 s32, s32, 8192
    buffer_load_dwordx4 v[192:195], v64, s[4:7], s32 offen nt
    s_add_u32 s32, s32, 8192
    buffer_load_dwordx4 v[196:199], v64, s[4:7], s32 offen nt
    s_add_u32 s32, s32, 8192
    buffer_load_dwordx4 v[200:203], v64, s[4:7], s32 offen nt
    s_add_u32 s32, s32, 8192
    buffer_load_dwordx4 v[204:207], v64, s[4:7], s32 offen nt
    s_add_u32 s32, s32, 8192
    buffer_load_dwordx4 v[208:211], v64, s[4:7], s32 offen nt
    s_add_u32 s32, s32, 8192
    buffer_load_dwordx4 v[212:215], v64, s[4:7], s32 offen nt
    s_add_u32 s32, s32, 8192
    buffer_load_dwordx4 v[216:219], v64, s[4:7], s32 offen nt
    s_add_u32 s32, s32, 8192
    buffer_load_dwordx4 v[220:223], v64, s[4:7], s32 offen nt
    s_add_u32 s32, s32, 8192
    buffer_load_dwordx4 v[224:227], v64, s[4:7], s32 offen nt
    s_add_u32 s32, s32, 8192
    buffer_load_dwordx4 v[228:231], v64, s[4:7], s32 offen nt
    s_add_u32 s32, s32, 8192
    buffer_load_dwordx4 v[232:235], v64, s[4:7], s32 offen nt
    s_add_u32 s32, s32, 8192
    buffer_load_dwordx4 v[236:239], v64, s[4:7], s32 offen nt
    s_add_u32 s32, s32, 8192
    buffer_load_dwordx4 v[240:243], v64, s[4:7], s32 offen nt
    s_add_u32 s32, s32, 8192
    buffer_load_dwordx4 v[244:247], v64, s[4:7], s32 offen nt
    s_add_u32 s32, s32, 8192
    buffer_load_dwordx4 v[248:251], v64, s[4:7], s32 offen nt
    s_add_u32 s32, s32, 8192
    buffer_load_dwordx4 v[252:255], v64, s[4:7], s32 offen nt
    s_add_u32 s32, s32, 8192
    s_waitcnt vmcnt(31)
    v_mfma_f32_16x16x32_bf16 v[80:83], v[128:131], v[8:11], 0
    s_waitcnt vmcnt(30)
    v_mfma_f32_16x16x32_bf16 v[84:87], v[132:135], v[8:11], 0
    s_waitcnt vmcnt(29)
    v_mfma_f32_16x16x32_bf16 v[88:91], v[136:139], v[8:11], 0
    s_waitcnt vmcnt(28)
    v_mfma_f32_16x16x32_bf16 v[92:95], v[140:143], v[8:11], 0
    s_waitcnt vmcnt(27)
    v_mfma_f32_16x16x32_bf16 v[96:99], v[144:147], v[8:11], 0
    s_waitcnt vmcnt(26)
    v_mfma_f32_16x16x32_bf16 v[100:103], v[148:151], v[8:11], 0
    s_waitcnt vmcnt(25)
    v_mfma_f32_16x16x32_bf16 v[104:107], v[152:155], v[8:11], 0
    s_waitcnt vmcnt(24)
    v_mfma_f32_16x16x32_bf16 v[108:111], v[156:159], v[8:11], 0
    v_add_f32_dpp v72, v81, v80 quad_perm:[1,1,1,1] row_mask:0xf bank_mask:0xf
    v_add_f32_dpp v73, v85, v84 quad_perm:[1,1,1,1] row_mask:0xf bank_mask:0xf
    v_add_f32_dpp v74, v89, v88 quad_perm:[1,1,1,1] row_mask:0xf bank_mask:0xf
    v_add_f32_dpp v75, v93, v92 quad_perm:[1,1,1,1] row_mask:0xf bank_mask:0xf
    v_add_f32_dpp v76, v97, v96 quad_perm:[1,1,1,1] row_mask:0xf bank_mask:0xf
    v_add_f32_dpp v77, v101, v100 quad_perm:[1,1,1,1] row_mask:0xf bank_mask:0xf
    v_add_f32_dpp v78, v105, v104 quad_perm:[1,1,1,1] row_mask:0xf bank_mask:0xf
    s_nop 0
    v_add_f32_dpp v79, v109, v108 quad_perm:[1,1,1,1] row_mask:0xf bank_mask:0xf
    v_add_f32_dpp v72, v82, v72 quad_perm:[2,2,2,2] row_mask:0xf bank_mask:0xf
    v_add_f32_dpp v73, v86, v73 quad_perm:[2,2,2,2] row_mask:0xf bank_mask:0xf
    v_add_f32_dpp v74, v90, v74 quad_perm:[2,2,2,2] row_mask:0xf bank_mask:0xf
    v_add_f32_dpp v75, v94, v75 quad_perm:[2,2,2,2] row_mask:0xf bank_mask:0xf
    v_add_f32_dpp v76, v98, v76 quad_perm:[2,2,2,2] row_mask:0xf bank_mask:0xf
    v_add_f32_dpp v77, v102, v77 quad_perm:[2,2,2,2] row_mask:0xf bank_mask:0xf
    v_add_f32_dpp v78, v106, v78 quad_perm:[2,2,2,2] row_mask:0xf bank_mask:0xf
    v_add_f32_dpp v79, v110, v79 quad_perm:[2,2,2,2] row_mask:0xf bank_mask:0xf
    v_add_f32_dpp v72, v83, v72 quad_perm:[3,3,3,3] row_mask:0xf bank_mask:0xf
    v_add_f32_dpp v73, v87, v73 quad_perm:[3,3,3,3] row_mask:0xf bank_mask:0xf
    v_add_f32_dpp v74, v91, v74 quad_perm:[3,3,3,3] row_mask:0xf bank_mask:0xf
    v_add_f32_dpp v75, v95, v75 quad_perm:[3,3,3,3] row_mask:0xf bank_mask:0xf
    v_add_f32_dpp v76, v99, v76 quad_perm:[3,3,3,3] row_mask:0xf bank_mask:0xf
    v_add_f32_dpp v77, v103, v77 quad_perm:[3,3,3,3] row_mask:0xf bank_mask:0xf
    v_add_f32_dpp v78, v107, v78 quad_perm:[3,3,3,3] row_mask:0xf bank_mask:0xf
    v_add_f32_dpp v79, v111, v79 quad_perm:[3,3,3,3] row_mask:0xf bank_mask:0xf
    s_waitcnt vmcnt(23)
    v_mfma_f32_16x16x32_bf16 v[80:83], v[160:163], v[8:11], 0
    s_waitcnt vmcnt(22)
    v_mfma_f32_16x16x32_bf16 v[84:87], v[164:167], v[8:11], 0
    s_waitcnt vmcnt(21)
    v_mfma_f32_16x16x32_bf16 v[88:91], v[168:171], v[8:11], 0
    s_waitcnt vmcnt(20)
    v_mfma_f32_16x16x32_bf16 v[92:95], v[172:175], v[8:11], 0
    s_waitcnt vmcnt(19)
    v_mfma_f32_16x16x32_bf16 v[96:99], v[176:179], v[8:11], 0
    s_waitcnt vmcnt(18)
    v_mfma_f32_16x16x32_bf16 v[100:103], v[180:183], v[8:11], 0
    s_waitcnt vmcnt(17)
    v_mfma_f32_16x16x32_bf16 v[104:107], v[184:187], v[8:11], 0
    s_waitcnt vmcnt(16)
    v_mfma_f32_16x16x32_bf16 v[108:111], v[188:191], v[8:11], 0
    v_add_f32_dpp v112, v80, v81 quad_perm:[0,0,0,0] row_mask:0xf bank_mask:0xf
    v_add_f32_dpp v113, v84, v85 quad_perm:[0,0,0,0] row_mask:0xf bank_mask:0xf
    v_add_f32_dpp v114, v88, v89 quad_perm:[0,0,0,0] row_mask:0xf bank_mask:0xf
    v_add_f32_dpp v115, v92, v93 quad_perm:[0,0,0,0] row_mask:0xf bank_mask:0xf
    v_add_f32_dpp v116, v96, v97 quad_perm:[0,0,0,0] row_mask:0xf bank_mask:0xf
    v_add_f32_dpp v117, v100, v101 quad_perm:[0,0,0,0] row_mask:0xf bank_mask:0xf
    v_add_f32_dpp v118, v104, v105 quad_perm:[0,0,0,0] row_mask:0xf bank_mask:0xf
    s_nop 0
    v_add_f32_dpp v119, v108, v109 quad_perm:[0,0,0,0] row_mask:0xf bank_mask:0xf
    v_add_f32_dpp v112, v82, v112 quad_perm:[2,2,2,2] row_mask:0xf bank_mask:0xf
    v_add_f32_dpp v113, v86, v113 quad_perm:[2,2,2,2] row_mask:0xf bank_mask:0xf
    v_add_f32_dpp v114, v90, v114 quad_perm:[2,2,2,2] row_mask:0xf bank_mask:0xf
    v_add_f32_dpp v115, v94, v115 quad_perm:[2,2,2,2] row_mask:0xf bank_mask:0xf
    v_add_f32_dpp v116, v98, v116 quad_perm:[2,2,2,2] row_mask:0xf bank_mask:0xf
    v_add_f32_dpp v117, v102, v117 quad_perm:[2,2,2,2] row_mask:0xf bank_mask:0xf
    v_add_f32_dpp v118, v106, v118 quad_perm:[2,2,2,2] row_mask:0xf bank_mask:0xf
    v_add_f32_dpp v119, v110, v119 quad_perm:[2,2,2,2] row_mask:0xf bank_mask:0xf
    v_add_f32_dpp v112, v83, v112 quad_perm:[3,3,3,3] row_mask:0xf bank_mask:0xf
    v_add_f32_dpp v113, v87, v113 quad_perm:[3,3,3,3] row_mask:0xf bank_mask:0xf
    v_add_f32_dpp v114, v91, v114 quad_perm:[3,3,3,3] row_mask:0xf bank_mask:0xf
    v_add_f32_dpp v115, v95, v115 quad_perm:[3,3,3,3] row_mask:0xf bank_mask:0xf
    v_add_f32_dpp v116, v99, v116 quad_perm:[3,3,3,3] row_mask:0xf bank_mask:0xf
    v_add_f32_dpp v117, v103, v117 quad_perm:[3,3,3,3] row_mask:0xf bank_mask:0xf
    v_add_f32_dpp v118, v107, v118 quad_perm:[3,3,3,3] row_mask:0xf bank_mask:0xf
    v_add_f32_dpp v119, v111, v119 quad_perm:[3,3,3,3] row_mask:0xf bank_mask:0xf
    v_cndmask_b32 v72, v72, v112, s[64:65]
    v_cndmask_b32 v73, v73, v113, s[64:65]
    v_cndmask_b32 v74, v74, v114, s[64:65]
    v_cndmask_b32 v75, v75, v115, s[64:65]
    v_cndmask_b32 v76, v76, v116, s[64:65]
    v_cndmask_b32 v77, v77, v117, s[64:65]
    v_cndmask_b32 v78, v78, v118, s[64:65]
    v_cndmask_b32 v79, v79, v119, s[64:65]
    s_waitcnt vmcnt(15)
    v_mfma_f32_16x16x32_bf16 v[80:83], v[192:195], v[8:11], 0
    s_waitcnt vmcnt(14)
    v_mfma_f32_16x16x32_bf16 v[84:87], v[196:199], v[8:11], 0
    s_waitcnt vmcnt(13)
    v_mfma_f32_16x16x32_bf16 v[88:91], v[200:203], v[8:11], 0
    s_waitcnt vmcnt(12)
    v_mfma_f32_16x16x32_bf16 v[92:95], v[204:207], v[8:11], 0
    s_waitcnt vmcnt(11)
    v_mfma_f32_16x16x32_bf16 v[96:99], v[208:211], v[8:11], 0
    s_waitcnt vmcnt(10)
    v_mfma_f32_16x16x32_bf16 v[100:103], v[212:215], v[8:11], 0
    s_waitcnt vmcnt(9)
    v_mfma_f32_16x16x32_bf16 v[104:107], v[216:219], v[8:11], 0
    s_waitcnt vmcnt(8)
    v_mfma_f32_16x16x32_bf16 v[108:111], v[220:223], v[8:11], 0
    v_add_f32_dpp v112, v80, v82 quad_perm:[0,0,0,0] row_mask:0xf bank_mask:0xf
    v_add_f32_dpp v113, v84, v86 quad_perm:[0,0,0,0] row_mask:0xf bank_mask:0xf
    v_add_f32_dpp v114, v88, v90 quad_perm:[0,0,0,0] row_mask:0xf bank_mask:0xf
    v_add_f32_dpp v115, v92, v94 quad_perm:[0,0,0,0] row_mask:0xf bank_mask:0xf
    v_add_f32_dpp v116, v96, v98 quad_perm:[0,0,0,0] row_mask:0xf bank_mask:0xf
    v_add_f32_dpp v117, v100, v102 quad_perm:[0,0,0,0] row_mask:0xf bank_mask:0xf
    v_add_f32_dpp v118, v104, v106 quad_perm:[0,0,0,0] row_mask:0xf bank_mask:0xf
    s_nop 0
    v_add_f32_dpp v119, v108, v110 quad_perm:[0,0,0,0] row_mask:0xf bank_mask:0xf
    v_add_f32_dpp v112, v81, v112 quad_perm:[1,1,1,1] row_mask:0xf bank_mask:0xf
    v_add_f32_dpp v113, v85, v113 quad_perm:[1,1,1,1] row_mask:0xf bank_mask:0xf
    v_add_f32_dpp v114, v89, v114 quad_perm:[1,1,1,1] row_mask:0xf bank_mask:0xf
    v_add_f32_dpp v115, v93, v115 quad_perm:[1,1,1,1] row_mask:0xf bank_mask:0xf
    v_add_f32_dpp v116, v97, v116 quad_perm:[1,1,1,1] row_mask:0xf bank_mask:0xf
    v_add_f32_dpp v117, v101, v117 quad_perm:[1,1,1,1] row_mask:0xf bank_mask:0xf
    v_add_f32_dpp v118, v105, v118 quad_perm:[1,1,1,1] row_mask:0xf bank_mask:0xf
    v_add_f32_dpp v119, v109, v119 quad_perm:[1,1,1,1] row_mask:0xf bank_mask:0xf
    v_add_f32_dpp v112, v83, v112 quad_perm:[3,3,3,3] row_mask:0xf bank_mask:0xf
    v_add_f32_dpp v113, v87, v113 quad_perm:[3,3,3,3] row_mask:0xf bank_mask:0xf
    v_add_f32_dpp v114, v91, v114 quad_perm:[3,3,3,3] row_mask:0xf bank_mask:0xf
    v_add_f32_dpp v115, v95, v115 quad_perm:[3,3,3,3] row_mask:0xf bank_mask:0xf
    v_add_f32_dpp v116, v99, v116 quad_perm:[3,3,3,3] row_mask:0xf bank_mask:0xf
    v_add_f32_dpp v117, v103, v117 quad_perm:[3,3,3,3] row_mask:0xf bank_mask:0xf
    v_add_f32_dpp v118, v107, v118 quad_perm:[3,3,3,3] row_mask:0xf bank_mask:0xf
    v_add_f32_dpp v119, v111, v119 quad_perm:[3,3,3,3] row_mask:0xf bank_mask:0xf
    v_cndmask_b32 v72, v72, v112, s[66:67]
    v_cndmask_b32 v73, v73, v113, s[66:67]
    v_cndmask_b32 v74, v74, v114, s[66:67]
    v_cndmask_b32 v75, v75, v115, s[66:67]
    v_cndmask_b32 v76, v76, v116, s[66:67]
    v_cndmask_b32 v77, v77, v117, s[66:67]
    v_cndmask_b32 v78, v78, v118, s[66:67]
    v_cndmask_b32 v79, v79, v119, s[66:67]
    s_waitcnt vmcnt(7)
    v_mfma_f32_16x16x32_bf16 v[80:83], v[224:227], v[8:11], 0
    s_waitcnt vmcnt(6)
    v_mfma_f32_16x16x32_bf16 v[84:87], v[228:231], v[8:11], 0
    s_waitcnt vmcnt(5)
    v_mfma_f32_16x16x32_bf16 v[88:91], v[232:235], v[8:11], 0
    s_waitcnt vmcnt(4)
    v_mfma_f32_16x16x32_bf16 v[92:95], v[236:239], v[8:11], 0
    s_waitcnt vmcnt(3)
    v_mfma_f32_16x16x32_bf16 v[96:99], v[240:243], v[8:11], 0
    s_waitcnt vmcnt(2)
    v_mfma_f32_16x16x32_bf16 v[100:103], v[244:247], v[8:11], 0
    s_waitcnt vmcnt(1)
    v_mfma_f32_16x16x32_bf16 v[104:107], v[248:251], v[8:11], 0
    s_waitcnt vmcnt(0)
    v_mfma_f32_16x16x32_bf16 v[108:111], v[252:255], v[8:11], 0
    v_add_f32_dpp v112, v80, v83 quad_perm:[0,0,0,0] row_mask:0xf bank_mask:0xf
    v_add_f32_dpp v113, v84, v87 quad_perm:[0,0,0,0] row_mask:0xf bank_mask:0xf
    v_add_f32_dpp v114, v88, v91 quad_perm:[0,0,0,0] row_mask:0xf bank_mask:0xf
    v_add_f32_dpp v115, v92, v95 quad_perm:[0,0,0,0] row_mask:0xf bank_mask:0xf
    v_add_f32_dpp v116, v96, v99 quad_perm:[0,0,0,0] row_mask:0xf bank_mask:0xf
    v_add_f32_dpp v117, v100, v103 quad_perm:[0,0,0,0] row_mask:0xf bank_mask:0xf
    v_add_f32_dpp v118, v104, v107 quad_perm:[0,0,0,0] row_mask:0xf bank_mask:0xf
    s_nop 0
    v_add_f32_dpp v119, v108, v111 quad_perm:[0,0,0,0] row_mask:0xf bank_mask:0xf
    v_add_f32_dpp v112, v81, v112 quad_perm:[1,1,1,1] row_mask:0xf bank_mask:0xf
    v_add_f32_dpp v113, v85, v113 quad_perm:[1,1,1,1] row_mask:0xf bank_mask:0xf
    v_add_f32_dpp v114, v89, v114 quad_perm:[1,1,1,1] row_mask:0xf bank_mask:0xf
    v_add_f32_dpp v115, v93, v115 quad_perm:[1,1,1,1] row_mask:0xf bank_mask:0xf
    v_add_f32_dpp v116, v97, v116 quad_perm:[1,1,1,1] row_mask:0xf bank_mask:0xf
    v_add_f32_dpp v117, v101, v117 quad_perm:[1,1,1,1] row_mask:0xf bank_mask:0xf
    v_add_f32_dpp v118, v105, v118 quad_perm:[1,1,1,1] row_mask:0xf bank_mask:0xf
    v_add_f32_dpp v119, v109, v119 quad_perm:[1,1,1,1] row_mask:0xf bank_mask:0xf
    v_add_f32_dpp v112, v82, v112 quad_perm:[2,2,2,2] row_mask:0xf bank_mask:0xf
    v_add_f32_dpp v113, v86, v113 quad_perm:[2,2,2,2] row_mask:0xf bank_mask:0xf
    v_add_f32_dpp v114, v90, v114 quad_perm:[2,2,2,2] row_mask:0xf bank_mask:0xf
    v_add_f32_dpp v115, v94, v115 quad_perm:[2,2,2,2] row_mask:0xf bank_mask:0xf
    v_add_f32_dpp v116, v98, v116 quad_perm:[2,2,2,2] row_mask:0xf bank_mask:0xf
    v_add_f32_dpp v117, v102, v117 quad_perm:[2,2,2,2] row_mask:0xf bank_mask:0xf
    v_add_f32_dpp v118, v106, v118 quad_perm:[2,2,2,2] row_mask:0xf bank_mask:0xf
    v_add_f32_dpp v119, v110, v119 quad_perm:[2,2,2,2] row_mask:0xf bank_mask:0xf
    v_cndmask_b32 v72, v72, v112, s[68:69]
    v_cndmask_b32 v73, v73, v113, s[68:69]
    v_cndmask_b32 v74, v74, v114, s[68:69]
    v_cndmask_b32 v75, v75, v115, s[68:69]
    v_cndmask_b32 v76, v76, v116, s[68:69]
    v_cndmask_b32 v77, v77, v117, s[68:69]
    v_cndmask_b32 v78, v78, v118, s[68:69]
    v_cndmask_b32 v79, v79, v119, s[68:69]
    s_mov_b32 s71, 0x3e0293ee
    v_mul_f32 v72, s71, v72
    v_mul_f32 v73, s71, v73
    v_mul_f32 v74, s71, v74
    v_mul_f32 v75, s71, v75
    v_mul_f32 v76, s71, v76
    v_mul_f32 v77, s71, v77
    v_mul_f32 v78, s71, v78
    v_mul_f32 v79, s71, v79
    v_cvt_pk_bf16_f32 v4, v72, v73
    v_cvt_pk_bf16_f32 v5, v74, v75
    v_cvt_pk_bf16_f32 v6, v76, v77
    v_cvt_pk_bf16_f32 v7, v78, v79
    s_lshl_b32 s24, s26, 10
    s_lshl_b32 s25, s3, 8
    s_add_u32 s24, s24, s25
    s_add_u32 s24, s24, 0x0
    buffer_store_dwordx4 v[4:7], v66, s[12:15], s24 offen sc1
    s_mov_b32 s8, s56
    s_mov_b32 s9, s57
    s_mov_b32 s10, 0x400000
    s_mov_b32 s11, 0x20000
    s_lshl_b32 s24, s26, 17
    s_lshl_b32 s25, s3, 15
    s_add_u32 s24, s24, s25
    s_add_u32 s24, s24, 0
    v_lshrrev_b32 v3, 5, v0
    v_and_b32 v4, 0x1ff, v2
    v_lshl_add_u32 v3, v3, 13, v4
    s_mul_i32 m0, s3, 16896
    s_nop 0
    buffer_load_dwordx4 v3, s[8:11], s24 offen nt lds
    s_add_u32 m0, m0, 1056
    s_add_u32 s24, s24, 2048
    buffer_load_dwordx4 v3, s[8:11], s24 offen nt lds
    s_add_u32 m0, m0, 1056
    s_add_u32 s24, s24, 2048
    buffer_load_dwordx4 v3, s[8:11], s24 offen nt lds
    s_add_u32 m0, m0, 1056
    s_add_u32 s24, s24, 2048
    buffer_load_dwordx4 v3, s[8:11], s24 offen nt lds
    s_add_u32 m0, m0, 1056
    s_add_u32 s24, s24, 10240
    buffer_load_dwordx4 v3, s[8:11], s24 offen nt lds
    s_add_u32 m0, m0, 1056
    s_add_u32 s24, s24, 2048
    buffer_load_dwordx4 v3, s[8:11], s24 offen nt lds
    s_add_u32 m0, m0, 1056
    s_add_u32 s24, s24, 2048
    buffer_load_dwordx4 v3, s[8:11], s24 offen nt lds
    s_add_u32 m0, m0, 1056
    s_add_u32 s24, s24, 2048
    buffer_load_dwordx4 v3, s[8:11], s24 offen nt lds
    s_add_u32 m0, m0, 1056
    s_add_u32 s24, s24, -21504
    buffer_load_dwordx4 v3, s[8:11], s24 offen nt lds
    s_add_u32 m0, m0, 1056
    s_add_u32 s24, s24, 2048
    buffer_load_dwordx4 v3, s[8:11], s24 offen nt lds
    s_add_u32 m0, m0, 1056
    s_add_u32 s24, s24, 2048
    buffer_load_dwordx4 v3, s[8:11], s24 offen nt lds
    s_add_u32 m0, m0, 1056
    s_add_u32 s24, s24, 2048
    buffer_load_dwordx4 v3, s[8:11], s24 offen nt lds
    s_add_u32 m0, m0, 1056
    s_add_u32 s24, s24, 10240
    buffer_load_dwordx4 v3, s[8:11], s24 offen nt lds
    s_add_u32 m0, m0, 1056
    s_add_u32 s24, s24, 2048
    buffer_load_dwordx4 v3, s[8:11], s24 offen nt lds
    s_add_u32 m0, m0, 1056
    s_add_u32 s24, s24, 2048
    buffer_load_dwordx4 v3, s[8:11], s24 offen nt lds
    s_add_u32 m0, m0, 1056
    s_add_u32 s24, s24, 2048
    buffer_load_dwordx4 v3, s[8:11], s24 offen nt lds
    s_waitcnt vmcnt(0)
    s_barrier
    s_cmp_lg_u32 s3, 0
    s_cbranch_scc1 L_sig10
    s_mov_b64 exec, 1
    v_mov_b32 v3, 1
    buffer_atomic_add v3, off, s[16:19], 0 offset:0 sc0
    s_waitcnt vmcnt(0)
    v_readfirstlane_b32 s24, v3
    s_mov_b64 exec, -1
    s_and_b32 s24, s24, 63
    s_cmp_lg_u32 s24, 63
    s_cbranch_scc1 L_sig10
    v_lshlrev_b32 v4, 7, v0
    v_mov_b32 v3, 1
    s_mov_b32 s24, 0x170000
    buffer_store_dword v3, v4, s[12:15], s24 offen offset:0 sc1
L_sig10:
    v_lshrrev_b32 v3, 2, v0
    v_mul_u32_u24 v3, 1056, v3
    v_and_b32 v4, 3, v0
    v_lshl_add_u32 v3, v4, 3, v3
    s_lshl_b32 s24, s3, 7
    v_add_u32 v3, s24, v3
    ds_read_b64_tr_b16 a[128:129], v3 offset:0
    ds_read_b64_tr_b16 a[130:131], v3 offset:512
    ds_read_b64_tr_b16 a[144:145], v3 offset:32
    ds_read_b64_tr_b16 a[146:147], v3 offset:544
    ds_read_b64_tr_b16 a[160:161], v3 offset:64
    ds_read_b64_tr_b16 a[162:163], v3 offset:576
    ds_read_b64_tr_b16 a[176:177], v3 offset:96
    ds_read_b64_tr_b16 a[178:179], v3 offset:608
    ds_read_b64_tr_b16 a[132:133], v3 offset:16896
    ds_read_b64_tr_b16 a[134:135], v3 offset:17408
    ds_read_b64_tr_b16 a[148:149], v3 offset:16928
    ds_read_b64_tr_b16 a[150:151], v3 offset:17440
    ds_read_b64_tr_b16 a[164:165], v3 offset:16960
    ds_read_b64_tr_b16 a[166:167], v3 offset:17472
    ds_read_b64_tr_b16 a[180:181], v3 offset:16992
    ds_read_b64_tr_b16 a[182:183], v3 offset:17504
    ds_read_b64_tr_b16 a[136:137], v3 offset:33792
    ds_read_b64_tr_b16 a[138:139], v3 offset:34304
    ds_read_b64_tr_b16 a[152:153], v3 offset:33824
    ds_read_b64_tr_b16 a[154:155], v3 offset:34336
    ds_read_b64_tr_b16 a[168:169], v3 offset:33856
    ds_read_b64_tr_b16 a[170:171], v3 offset:34368
    ds_read_b64_tr_b16 a[184:185], v3 offset:33888
    ds_read_b64_tr_b16 a[186:187], v3 offset:34400
    ds_read_b64_tr_b16 a[140:141], v3 offset:50688
    ds_read_b64_tr_b16 a[142:143], v3 offset:51200
    ds_read_b64_tr_b16 a[156:157], v3 offset:50720
    ds_read_b64_tr_b16 a[158:159], v3 offset:51232
    ds_read_b64_tr_b16 a[172:173], v3 offset:50752
    ds_read_b64_tr_b16 a[174:175], v3 offset:51264
    ds_read_b64_tr_b16 a[188:189], v3 offset:50784
    ds_read_b64_tr_b16 a[190:191], v3 offset:51296
    s_mov_b32 s4, s44
    s_mov_b32 s5, s45
    s_mov_b32 s6, 0x400000
    s_mov_b32 s7, 0x20000
    s_mov_b32 s8, s46
    s_mov_b32 s9, s47
    s_mov_b32 s10, 0x400000
    s_mov_b32 s11, 0x20000
    s_mov_b32 s32, s35
    buffer_load_dwordx4 v[128:131], v18, s[4:7], s32 offen nt
    s_add_u32 s32, s32, 8192
    buffer_load_dwordx4 v[132:135], v18, s[4:7], s32 offen nt
    s_add_u32 s32, s32, 8192
    buffer_load_dwordx4 v[136:139], v18, s[4:7], s32 offen nt
    s_add_u32 s32, s32, 8192
    buffer_load_dwordx4 v[140:143], v18, s[4:7], s32 offen nt
    s_add_u32 s32, s32, 8192
    buffer_load_dwordx4 v[144:147], v18, s[4:7], s32 offen nt
    s_add_u32 s32, s32, 8192
    buffer_load_dwordx4 v[148:151], v18, s[4:7], s32 offen nt
    s_add_u32 s32, s32, 8192
    buffer_load_dwordx4 v[152:155], v18, s[4:7], s32 offen nt
    s_add_u32 s32, s32, 8192
    buffer_load_dwordx4 v[156:159], v18, s[4:7], s32 offen nt
    s_add_u32 s32, s32, 8192
    buffer_load_dwordx4 v[160:163], v18, s[4:7], s32 offen nt
    s_add_u32 s32, s32, 8192
    buffer_load_dwordx4 v[164:167], v18, s[4:7], s32 offen nt
    s_add_u32 s32, s32, 8192
    buffer_load_dwordx4 v[168:171], v18, s[4:7], s32 offen nt
    s_add_u32 s32, s32, 8192
    buffer_load_dwordx4 v[172:175], v18, s[4:7], s32 offen nt
    s_add_u32 s32, s32, 8192
    buffer_load_dwordx4 v[176:179], v18, s[4:7], s32 offen nt
    s_add_u32 s32, s32, 8192
    buffer_load_dwordx4 v[180:183], v18, s[4:7], s32 offen nt
    s_add_u32 s32, s32, 8192
    buffer_load_dwordx4 v[184:187], v18, s[4:7], s32 offen nt
    s_add_u32 s32, s32, 8192
    buffer_load_dwordx4 v[188:191], v18, s[4:7], s32 offen nt
    s_add_u32 s32, s32, 8192
    buffer_load_dwordx4 v[192:195], v18, s[4:7], s32 offen nt
    s_add_u32 s32, s32, 8192
    buffer_load_dwordx4 v[196:199], v18, s[4:7], s32 offen nt
    s_add_u32 s32, s32, 8192
    buffer_load_dwordx4 v[200:203], v18, s[4:7], s32 offen nt
    s_add_u32 s32, s32, 8192
    buffer_load_dwordx4 v[204:207], v18, s[4:7], s32 offen nt
    s_add_u32 s32, s32, 8192
    buffer_load_dwordx4 v[208:211], v18, s[4:7], s32 offen nt
    s_add_u32 s32, s32, 8192
    buffer_load_dwordx4 v[212:215], v18, s[4:7], s32 offen nt
    s_add_u32 s32, s32, 8192
    buffer_load_dwordx4 v[216:219], v18, s[4:7], s32 offen nt
    s_add_u32 s32, s32, 8192
    buffer_load_dwordx4 v[220:223], v18, s[4:7], s32 offen nt
    s_add_u32 s32, s32, 8192
    buffer_load_dwordx4 v[224:227], v18, s[4:7], s32 offen nt
    s_add_u32 s32, s32, 8192
    buffer_load_dwordx4 v[228:231], v18, s[4:7], s32 offen nt
    s_add_u32 s32, s32, 8192
    buffer_load_dwordx4 v[232:235], v18, s[4:7], s32 offen nt
    s_add_u32 s32, s32, 8192
    buffer_load_dwordx4 v[236:239], v18, s[4:7], s32 offen nt
    s_add_u32 s32, s32, 8192
    buffer_load_dwordx4 v[240:243], v18, s[4:7], s32 offen nt
    s_add_u32 s32, s32, 8192
    buffer_load_dwordx4 v[244:247], v18, s[4:7], s32 offen nt
    s_add_u32 s32, s32, 8192
    buffer_load_dwordx4 v[248:251], v18, s[4:7], s32 offen nt
    s_add_u32 s32, s32, 8192
    buffer_load_dwordx4 v[252:255], v18, s[4:7], s32 offen nt
    s_add_u32 s32, s32, 8192
    s_lshl_b32 s33, s26, 17
    s_lshl_b32 s24, s3, 15
    s_add_u32 s33, s33, s24
    s_mul_i32 s34, s3, 33792
    s_waitcnt lgkmcnt(0)
    s_barrier
    s_mov_b32 s70, 0
L_woA:
    s_and_b32 s24, s70, 3
    s_lshl_b32 s24, s24, 1
    s_lshr_b32 s25, s70, 2
    s_or_b32 s24, s24, s25
    s_lshl_b32 s24, s24, 10
    s_add_u32 s24, s24, s33
    s_mul_i32 s25, s70, 4224
    s_add_u32 m0, s25, s34
    s_waitcnt vmcnt(24)
    buffer_load_dwordx4 v2, s[8:11], s24 offen nt lds
    s_add_u32 m0, m0, 1056
    s_add_u32 s24, s24, 8192
    s_waitcnt vmcnt(24)
    buffer_load_dwordx4 v2, s[8:11], s24 offen nt lds
    s_add_u32 m0, m0, 1056
    s_add_u32 s24, s24, 8192
    s_waitcnt vmcnt(24)
    buffer_load_dwordx4 v2, s[8:11], s24 offen nt lds
    s_add_u32 m0, m0, 1056
    s_add_u32 s24, s24, 8192
    s_waitcnt vmcnt(24)
    buffer_load_dwordx4 v2, s[8:11], s24 offen nt lds
    s_add_u32 s70, s70, 1
    s_cmp_lt_u32 s70, 8
    s_cbranch_scc1 L_woA
    s_waitcnt vmcnt(0)
    s_barrier
    v_lshrrev_b32 v3, 2, v0
    v_mul_u32_u24 v3, 1056, v3
    v_and_b32 v4, 3, v0
    v_lshl_add_u32 v3, v4, 3, v3
    s_lshl_b32 s24, s3, 8
    v_add_u32 v3, s24, v3
    v_add_u32 v4, 67584, v3
    ds_read_b64_tr_b16 a[0:1], v3 offset:0
    ds_read_b64_tr_b16 a[2:3], v3 offset:16896
    ds_read_b64_tr_b16 a[4:5], v3 offset:33792
    ds_read_b64_tr_b16 a[6:7], v3 offset:50688
    ds_read_b64_tr_b16 a[8:9], v4 offset:0
    ds_read_b64_tr_b16 a[10:11], v4 offset:16896
    ds_read_b64_tr_b16 a[12:13], v4 offset:33792
    ds_read_b64_tr_b16 a[14:15], v4 offset:50688
    ds_read_b64_tr_b16 a[16:17], v3 offset:32
    ds_read_b64_tr_b16 a[18:19], v3 offset:16928
    ds_read_b64_tr_b16 a[20:21], v3 offset:33824
    ds_read_b64_tr_b16 a[22:23], v3 offset:50720
    ds_read_b64_tr_b16 a[24:25], v4 offset:32
    ds_read_b64_tr_b16 a[26:27], v4 offset:16928
    ds_read_b64_tr_b16 a[28:29], v4 offset:33824
    ds_read_b64_tr_b16 a[30:31], v4 offset:50720
    ds_read_b64_tr_b16 a[32:33], v3 offset:64
    ds_read_b64_tr_b16 a[34:35], v3 offset:16960
    ds_read_b64_tr_b16 a[36:37], v3 offset:33856
    ds_read_b64_tr_b16 a[38:39], v3 offset:50752
    ds_read_b64_tr_b16 a[40:41], v4 offset:64
    ds_read_b64_tr_b16 a[42:43], v4 offset:16960
    ds_read_b64_tr_b16 a[44:45], v4 offset:33856
    ds_read_b64_tr_b16 a[46:47], v4 offset:50752
    ds_read_b64_tr_b16 a[48:49], v3 offset:96
    ds_read_b64_tr_b16 a[50:51], v3 offset:16992
    ds_read_b64_tr_b16 a[52:53], v3 offset:33888
    ds_read_b64_tr_b16 a[54:55], v3 offset:50784
    ds_read_b64_tr_b16 a[56:57], v4 offset:96
    ds_read_b64_tr_b16 a[58:59], v4 offset:16992
    ds_read_b64_tr_b16 a[60:61], v4 offset:33888
    ds_read_b64_tr_b16 a[62:63], v4 offset:50784
    ds_read_b64_tr_b16 a[64:65], v3 offset:128
    ds_read_b64_tr_b16 a[66:67], v3 offset:17024
    ds_read_b64_tr_b16 a[68:69], v3 offset:33920
    ds_read_b64_tr_b16 a[70:71], v3 offset:50816
    ds_read_b64_tr_b16 a[72:73], v4 offset:128
    ds_read_b64_tr_b16 a[74:75], v4 offset:17024
    ds_read_b64_tr_b16 a[76:77], v4 offset:33920
    ds_read_b64_tr_b16 a[78:79], v4 offset:50816
    ds_read_b64_tr_b16 a[80:81], v3 offset:160
    ds_read_b64_tr_b16 a[82:83], v3 offset:17056
    ds_read_b64_tr_b16 a[84:85], v3 offset:33952
    ds_read_b64_tr_b16 a[86:87], v3 offset:50848
    ds_read_b64_tr_b16 a[88:89], v4 offset:160
    ds_read_b64_tr_b16 a[90:91], v4 offset:17056
    ds_read_b64_tr_b16 a[92:93], v4 offset:33952
    ds_read_b64_tr_b16 a[94:95], v4 offset:50848
    ds_read_b64_tr_b16 a[96:97], v3 offset:192
    ds_read_b64_tr_b16 a[98:99], v3 offset:17088
    ds_read_b64_tr_b16 a[100:101], v3 offset:33984
    ds_read_b64_tr_b16 a[102:103], v3 offset:50880
    ds_read_b64_tr_b16 a[104:105], v4 offset:192
    ds_read_b64_tr_b16 a[106:107], v4 offset:17088
    ds_read_b64_tr_b16 a[108:109], v4 offset:33984
    ds_read_b64_tr_b16 a[110:111], v4 offset:50880
    ds_read_b64_tr_b16 a[112:113], v3 offset:224
    ds_read_b64_tr_b16 a[114:115], v3 offset:17120
    ds_read_b64_tr_b16 a[116:117], v3 offset:34016
    ds_read_b64_tr_b16 a[118:119], v3 offset:50912
    ds_read_b64_tr_b16 a[120:121], v4 offset:224
    ds_read_b64_tr_b16 a[122:123], v4 offset:17120
    ds_read_b64_tr_b16 a[124:125], v4 offset:34016
    ds_read_b64_tr_b16 a[126:127], v4 offset:50912
    s_waitcnt lgkmcnt(0)
    s_cmp_lg_u32 s3, 0
    s_cbranch_scc1 L_awx11
    s_mov_b32 s24, 262144
    s_mov_b64 exec, 1
L_aw12:
    buffer_load_dword v1, off, s[12:15], s73 offset:0 sc1
    s_waitcnt vmcnt(0)
    v_readfirstlane_b32 s25, v1
    s_nop 0
    s_cmp_eq_u32 s25, 1
    s_cbranch_scc1 L_awx11
    s_sleep 4
    s_sub_u32 s24, s24, 1
    s_cmp_lg_u32 s24, 0
    s_cbranch_scc1 L_aw12
L_awx11:
    s_mov_b64 exec, -1
    s_barrier
    s_cmp_lg_u32 s3, 0
    s_cbranch_scc1 L_xi13
    s_getreg_b32 s25, hwreg(HW_REG_XCC_ID, 0, 4)
    s_lshl_b32 s24, s26, 7
    s_add_u32 s24, s24, 0x1b6000
    s_mov_b64 exec, 1
    v_mov_b32 v3, s25
    buffer_store_dword v3, off, s[12:15], s24 offset:0 sc1
    s_mov_b64 exec, -1
L_xi13:
    s_cmp_lg_u32 s3, 0
    s_cbranch_scc1 L_awx14
    s_mov_b32 s24, 262144
    s_mov_b64 exec, 1
L_aw15:
    buffer_load_dword v1, off, s[12:15], s73 offset:4 sc1
    s_waitcnt vmcnt(0)
    v_readfirstlane_b32 s25, v1
    s_nop 0
    s_cmp_eq_u32 s25, 1
    s_cbranch_scc1 L_awx14
    s_sleep 4
    s_sub_u32 s24, s24, 1
    s_cmp_lg_u32 s24, 0
    s_cbranch_scc1 L_aw15
L_awx14:
    s_mov_b64 exec, -1
    s_barrier
    s_lshl_b32 s24, s3, 10
    s_lshl_b32 s25, s26, 3
    s_add_u32 s25, s25, s24
    s_add_u32 s25, s25, 0x120000
    v_and_b32 v3, 3, v0
    v_lshlrev_b32 v3, 8, v3
    buffer_load_dwordx2 v[4:5], v3, s[12:15], s25 offen sc1
    s_lshl_b32 s24, s3, 17
    s_lshl_b32 s25, s26, 10
    s_add_u32 s24, s24, s25
    s_add_u32 s24, s24, 0x20000
    buffer_load_dwordx4 v[72:75], v2, s[12:15], s24 offen sc1 nt
    s_add_u32 s24, s24, 0x8000
    buffer_load_dwordx4 v[76:79], v2, s[12:15], s24 offen sc1 nt
    s_add_u32 s24, s24, 0x8000
    buffer_load_dwordx4 v[80:83], v2, s[12:15], s24 offen sc1 nt
    s_add_u32 s24, s24, 0x8000
    buffer_load_dwordx4 v[84:87], v2, s[12:15], s24 offen sc1 nt
    s_add_u32 s24, s24, 0x8000
    s_waitcnt vmcnt(4)
    v_mov_b32 v6, v4
    s_nop 1
    v_max_f32_dpp v6, v6, v6 row_ror:2 row_mask:0xf bank_mask:0xf
    s_nop 1
    v_max_f32_dpp v6, v6, v6 row_ror:1 row_mask:0xf bank_mask:0xf
    v_sub_f32 v4, v4, v6
    v_exp_f32 v4, v4
    s_nop 0
    v_mul_f32 v5, v4, v5
    s_nop 1
    v_add_f32_dpp v5, v5, v5 row_ror:2 row_mask:0xf bank_mask:0xf
    s_nop 1
    v_add_f32_dpp v5, v5, v5 row_ror:1 row_mask:0xf bank_mask:0xf
    v_rcp_f32 v5, v5
    s_nop 0
    v_mul_f32 v4, v4, v5
    s_nop 0
    v_readlane_b32 s24, v4, 0
    s_waitcnt vmcnt(3)
    v_lshlrev_b32 v5, 16, v72
    v_and_b32 v6, 0xffff0000, v72
    v_mul_f32 v104, s24, v5
    v_mul_f32 v105, s24, v6
    v_lshlrev_b32 v5, 16, v73
    v_and_b32 v6, 0xffff0000, v73
    v_mul_f32 v106, s24, v5
    v_mul_f32 v107, s24, v6
    v_lshlrev_b32 v5, 16, v74
    v_and_b32 v6, 0xffff0000, v74
    v_mul_f32 v108, s24, v5
    v_mul_f32 v109, s24, v6
    v_lshlrev_b32 v5, 16, v75
    v_and_b32 v6, 0xffff0000, v75
    v_mul_f32 v110, s24, v5
    v_mul_f32 v111, s24, v6
    v_readlane_b32 s24, v4, 1
    s_waitcnt vmcnt(2)
    v_lshlrev_b32 v5, 16, v76
    v_and_b32 v6, 0xffff0000, v76
    v_fmac_f32 v104, s24, v5
    v_fmac_f32 v105, s24, v6
    v_lshlrev_b32 v5, 16, v77
    v_and_b32 v6, 0xffff0000, v77
    v_fmac_f32 v106, s24, v5
    v_fmac_f32 v107, s24, v6
    v_lshlrev_b32 v5, 16, v78
    v_and_b32 v6, 0xffff0000, v78
    v_fmac_f32 v108, s24, v5
    v_fmac_f32 v109, s24, v6
    v_lshlrev_b32 v5, 16, v79
    v_and_b32 v6, 0xffff0000, v79
    v_fmac_f32 v110, s24, v5
    v_fmac_f32 v111, s24, v6
    v_readlane_b32 s24, v4, 2
    s_waitcnt vmcnt(1)
    v_lshlrev_b32 v5, 16, v80
    v_and_b32 v6, 0xffff0000, v80
    v_fmac_f32 v104, s24, v5
    v_fmac_f32 v105, s24, v6
    v_lshlrev_b32 v5, 16, v81
    v_and_b32 v6, 0xffff0000, v81
    v_fmac_f32 v106, s24, v5
    v_fmac_f32 v107, s24, v6
    v_lshlrev_b32 v5, 16, v82
    v_and_b32 v6, 0xffff0000, v82
    v_fmac_f32 v108, s24, v5
    v_fmac_f32 v109, s24, v6
    v_lshlrev_b32 v5, 16, v83
    v_and_b32 v6, 0xffff0000, v83
    v_fmac_f32 v110, s24, v5
    v_fmac_f32 v111, s24, v6
    v_readlane_b32 s24, v4, 3
    s_waitcnt vmcnt(0)
    v_lshlrev_b32 v5, 16, v84
    v_and_b32 v6, 0xffff0000, v84
    v_fmac_f32 v104, s24, v5
    v_fmac_f32 v105, s24, v6
    v_lshlrev_b32 v5, 16, v85
    v_and_b32 v6, 0xffff0000, v85
    v_fmac_f32 v106, s24, v5
    v_fmac_f32 v107, s24, v6
    v_lshlrev_b32 v5, 16, v86
    v_and_b32 v6, 0xffff0000, v86
    v_fmac_f32 v108, s24, v5
    v_fmac_f32 v109, s24, v6
    v_lshlrev_b32 v5, 16, v87
    v_and_b32 v6, 0xffff0000, v87
    v_fmac_f32 v110, s24, v5
    v_fmac_f32 v111, s24, v6
    v_cvt_pk_bf16_f32 v4, v104, v105
    v_cvt_pk_bf16_f32 v5, v106, v107
    v_cvt_pk_bf16_f32 v6, v108, v109
    v_cvt_pk_bf16_f32 v7, v110, v111
    s_lshl_b32 s24, s3, 10
    s_add_u32 s24, s24, 145408
    v_add_u32 v3, s24, v2
    ds_write_b128 v3, v[4:7]
    s_lshl_b32 s24, s3, 8
    s_add_u32 s24, s24, 145408
    v_add_u32 v3, s24, v19
    s_waitcnt lgkmcnt(0)
    s_barrier
    ds_read_b128 v[32:35], v3 offset:0
    ds_read_b128 v[36:39], v3 offset:16
    ds_read_b128 v[40:43], v3 offset:32
    ds_read_b128 v[44:47], v3 offset:48
    ds_read_b128 v[48:51], v3 offset:2048
    ds_read_b128 v[52:55], v3 offset:2064
    ds_read_b128 v[56:59], v3 offset:2080
    ds_read_b128 v[60:63], v3 offset:2096
    s_waitcnt lgkmcnt(0)
    v_perm_b32 v8, v32, v32, v24
    v_perm_b32 v9, v32, v32, v25
    v_perm_b32 v10, v32, v32, v26
    v_perm_b32 v11, v32, v32, v27
    v_perm_b32 v4, v48, v48, v24
    v_perm_b32 v5, v48, v48, v25
    v_perm_b32 v6, v48, v48, v26
    v_perm_b32 v7, v48, v48, v27
    v_mfma_f32_16x16x32_bf16 v[12:15], v[128:131], v[8:11], 0
    s_nop 0
    v_mfma_f32_16x16x32_bf16 v[68:71], v[128:131], v[4:7], 0
    v_perm_b32 v8, v32, v32, v28
    v_perm_b32 v9, v32, v32, v29
    v_perm_b32 v10, v32, v32, v30
    v_perm_b32 v11, v32, v32, v31
    v_perm_b32 v4, v48, v48, v28
    v_perm_b32 v5, v48, v48, v29
    v_perm_b32 v6, v48, v48, v30
    v_perm_b32 v7, v48, v48, v31
    v_mfma_f32_16x16x32_bf16 v[12:15], v[132:135], v[8:11], v[12:15]
    s_nop 0
    v_mfma_f32_16x16x32_bf16 v[68:71], v[132:135], v[4:7], v[68:71]
    v_perm_b32 v8, v33, v33, v24
    v_perm_b32 v9, v33, v33, v25
    v_perm_b32 v10, v33, v33, v26
    v_perm_b32 v11, v33, v33, v27
    v_perm_b32 v4, v49, v49, v24
    v_perm_b32 v5, v49, v49, v25
    v_perm_b32 v6, v49, v49, v26
    v_perm_b32 v7, v49, v49, v27
    v_mfma_f32_16x16x32_bf16 v[12:15], v[136:139], v[8:11], v[12:15]
    s_nop 0
    v_mfma_f32_16x16x32_bf16 v[68:71], v[136:139], v[4:7], v[68:71]
    v_perm_b32 v8, v33, v33, v28
    v_perm_b32 v9, v33, v33, v29
    v_perm_b32 v10, v33, v33, v30
    v_perm_b32 v11, v33, v33, v31
    v_perm_b32 v4, v49, v49, v28
    v_perm_b32 v5, v49, v49, v29
    v_perm_b32 v6, v49, v49, v30
    v_perm_b32 v7, v49, v49, v31
    v_mfma_f32_16x16x32_bf16 v[12:15], v[140:143], v[8:11], v[12:15]
    s_nop 0
    v_mfma_f32_16x16x32_bf16 v[68:71], v[140:143], v[4:7], v[68:71]
    v_perm_b32 v8, v34, v34, v24
    v_perm_b32 v9, v34, v34, v25
    v_perm_b32 v10, v34, v34, v26
    v_perm_b32 v11, v34, v34, v27
    v_perm_b32 v4, v50, v50, v24
    v_perm_b32 v5, v50, v50, v25
    v_perm_b32 v6, v50, v50, v26
    v_perm_b32 v7, v50, v50, v27
    v_mfma_f32_16x16x32_bf16 v[12:15], v[144:147], v[8:11], v[12:15]
    s_nop 0
    v_mfma_f32_16x16x32_bf16 v[68:71], v[144:147], v[4:7], v[68:71]
    v_perm_b32 v8, v34, v34, v28
    v_perm_b32 v9, v34, v34, v29
    v_perm_b32 v10, v34, v34, v30
    v_perm_b32 v11, v34, v34, v31
    v_perm_b32 v4, v50, v50, v28
    v_perm_b32 v5, v50, v50, v29
    v_perm_b32 v6, v50, v50, v30
    v_perm_b32 v7, v50, v50, v31
    v_mfma_f32_16x16x32_bf16 v[12:15], v[148:151], v[8:11], v[12:15]
    s_nop 0
    v_mfma_f32_16x16x32_bf16 v[68:71], v[148:151], v[4:7], v[68:71]
    v_perm_b32 v8, v35, v35, v24
    v_perm_b32 v9, v35, v35, v25
    v_perm_b32 v10, v35, v35, v26
    v_perm_b32 v11, v35, v35, v27
    v_perm_b32 v4, v51, v51, v24
    v_perm_b32 v5, v51, v51, v25
    v_perm_b32 v6, v51, v51, v26
    v_perm_b32 v7, v51, v51, v27
    v_mfma_f32_16x16x32_bf16 v[12:15], v[152:155], v[8:11], v[12:15]
    s_nop 0
    v_mfma_f32_16x16x32_bf16 v[68:71], v[152:155], v[4:7], v[68:71]
    v_perm_b32 v8, v35, v35, v28
    v_perm_b32 v9, v35, v35, v29
    v_perm_b32 v10, v35, v35, v30
    v_perm_b32 v11, v35, v35, v31
    v_perm_b32 v4, v51, v51, v28
    v_perm_b32 v5, v51, v51, v29
    v_perm_b32 v6, v51, v51, v30
    v_perm_b32 v7, v51, v51, v31
    v_mfma_f32_16x16x32_bf16 v[12:15], v[156:159], v[8:11], v[12:15]
    s_nop 0
    v_mfma_f32_16x16x32_bf16 v[68:71], v[156:159], v[4:7], v[68:71]
    v_perm_b32 v8, v36, v36, v24
    v_perm_b32 v9, v36, v36, v25
    v_perm_b32 v10, v36, v36, v26
    v_perm_b32 v11, v36, v36, v27
    v_perm_b32 v4, v52, v52, v24
    v_perm_b32 v5, v52, v52, v25
    v_perm_b32 v6, v52, v52, v26
    v_perm_b32 v7, v52, v52, v27
    v_mfma_f32_16x16x32_bf16 v[12:15], v[160:163], v[8:11], v[12:15]
    s_nop 0
    v_mfma_f32_16x16x32_bf16 v[68:71], v[160:163], v[4:7], v[68:71]
    v_perm_b32 v8, v36, v36, v28
    v_perm_b32 v9, v36, v36, v29
    v_perm_b32 v10, v36, v36, v30
    v_perm_b32 v11, v36, v36, v31
    v_perm_b32 v4, v52, v52, v28
    v_perm_b32 v5, v52, v52, v29
    v_perm_b32 v6, v52, v52, v30
    v_perm_b32 v7, v52, v52, v31
    v_mfma_f32_16x16x32_bf16 v[12:15], v[164:167], v[8:11], v[12:15]
    s_nop 0
    v_mfma_f32_16x16x32_bf16 v[68:71], v[164:167], v[4:7], v[68:71]
    v_perm_b32 v8, v37, v37, v24
    v_perm_b32 v9, v37, v37, v25
    v_perm_b32 v10, v37, v37, v26
    v_perm_b32 v11, v37, v37, v27
    v_perm_b32 v4, v53, v53, v24
    v_perm_b32 v5, v53, v53, v25
    v_perm_b32 v6, v53, v53, v26
    v_perm_b32 v7, v53, v53, v27
    v_mfma_f32_16x16x32_bf16 v[12:15], v[168:171], v[8:11], v[12:15]
    s_nop 0
    v_mfma_f32_16x16x32_bf16 v[68:71], v[168:171], v[4:7], v[68:71]
    v_perm_b32 v8, v37, v37, v28
    v_perm_b32 v9, v37, v37, v29
    v_perm_b32 v10, v37, v37, v30
    v_perm_b32 v11, v37, v37, v31
    v_perm_b32 v4, v53, v53, v28
    v_perm_b32 v5, v53, v53, v29
    v_perm_b32 v6, v53, v53, v30
    v_perm_b32 v7, v53, v53, v31
    v_mfma_f32_16x16x32_bf16 v[12:15], v[172:175], v[8:11], v[12:15]
    s_nop 0
    v_mfma_f32_16x16x32_bf16 v[68:71], v[172:175], v[4:7], v[68:71]
    v_perm_b32 v8, v38, v38, v24
    v_perm_b32 v9, v38, v38, v25
    v_perm_b32 v10, v38, v38, v26
    v_perm_b32 v11, v38, v38, v27
    v_perm_b32 v4, v54, v54, v24
    v_perm_b32 v5, v54, v54, v25
    v_perm_b32 v6, v54, v54, v26
    v_perm_b32 v7, v54, v54, v27
    v_mfma_f32_16x16x32_bf16 v[12:15], v[176:179], v[8:11], v[12:15]
    s_nop 0
    v_mfma_f32_16x16x32_bf16 v[68:71], v[176:179], v[4:7], v[68:71]
    v_perm_b32 v8, v38, v38, v28
    v_perm_b32 v9, v38, v38, v29
    v_perm_b32 v10, v38, v38, v30
    v_perm_b32 v11, v38, v38, v31
    v_perm_b32 v4, v54, v54, v28
    v_perm_b32 v5, v54, v54, v29
    v_perm_b32 v6, v54, v54, v30
    v_perm_b32 v7, v54, v54, v31
    v_mfma_f32_16x16x32_bf16 v[12:15], v[180:183], v[8:11], v[12:15]
    s_nop 0
    v_mfma_f32_16x16x32_bf16 v[68:71], v[180:183], v[4:7], v[68:71]
    v_perm_b32 v8, v39, v39, v24
    v_perm_b32 v9, v39, v39, v25
    v_perm_b32 v10, v39, v39, v26
    v_perm_b32 v11, v39, v39, v27
    v_perm_b32 v4, v55, v55, v24
    v_perm_b32 v5, v55, v55, v25
    v_perm_b32 v6, v55, v55, v26
    v_perm_b32 v7, v55, v55, v27
    v_mfma_f32_16x16x32_bf16 v[12:15], v[184:187], v[8:11], v[12:15]
    s_nop 0
    v_mfma_f32_16x16x32_bf16 v[68:71], v[184:187], v[4:7], v[68:71]
    v_perm_b32 v8, v39, v39, v28
    v_perm_b32 v9, v39, v39, v29
    v_perm_b32 v10, v39, v39, v30
    v_perm_b32 v11, v39, v39, v31
    v_perm_b32 v4, v55, v55, v28
    v_perm_b32 v5, v55, v55, v29
    v_perm_b32 v6, v55, v55, v30
    v_perm_b32 v7, v55, v55, v31
    v_mfma_f32_16x16x32_bf16 v[12:15], v[188:191], v[8:11], v[12:15]
    s_nop 0
    v_mfma_f32_16x16x32_bf16 v[68:71], v[188:191], v[4:7], v[68:71]
    v_perm_b32 v8, v40, v40, v24
    v_perm_b32 v9, v40, v40, v25
    v_perm_b32 v10, v40, v40, v26
    v_perm_b32 v11, v40, v40, v27
    v_perm_b32 v4, v56, v56, v24
    v_perm_b32 v5, v56, v56, v25
    v_perm_b32 v6, v56, v56, v26
    v_perm_b32 v7, v56, v56, v27
    v_mfma_f32_16x16x32_bf16 v[12:15], v[192:195], v[8:11], v[12:15]
    s_nop 0
    v_mfma_f32_16x16x32_bf16 v[68:71], v[192:195], v[4:7], v[68:71]
    v_perm_b32 v8, v40, v40, v28
    v_perm_b32 v9, v40, v40, v29
    v_perm_b32 v10, v40, v40, v30
    v_perm_b32 v11, v40, v40, v31
    v_perm_b32 v4, v56, v56, v28
    v_perm_b32 v5, v56, v56, v29
    v_perm_b32 v6, v56, v56, v30
    v_perm_b32 v7, v56, v56, v31
    v_mfma_f32_16x16x32_bf16 v[12:15], v[196:199], v[8:11], v[12:15]
    s_nop 0
    v_mfma_f32_16x16x32_bf16 v[68:71], v[196:199], v[4:7], v[68:71]
    v_perm_b32 v8, v41, v41, v24
    v_perm_b32 v9, v41, v41, v25
    v_perm_b32 v10, v41, v41, v26
    v_perm_b32 v11, v41, v41, v27
    v_perm_b32 v4, v57, v57, v24
    v_perm_b32 v5, v57, v57, v25
    v_perm_b32 v6, v57, v57, v26
    v_perm_b32 v7, v57, v57, v27
    v_mfma_f32_16x16x32_bf16 v[12:15], v[200:203], v[8:11], v[12:15]
    s_nop 0
    v_mfma_f32_16x16x32_bf16 v[68:71], v[200:203], v[4:7], v[68:71]
    v_perm_b32 v8, v41, v41, v28
    v_perm_b32 v9, v41, v41, v29
    v_perm_b32 v10, v41, v41, v30
    v_perm_b32 v11, v41, v41, v31
    v_perm_b32 v4, v57, v57, v28
    v_perm_b32 v5, v57, v57, v29
    v_perm_b32 v6, v57, v57, v30
    v_perm_b32 v7, v57, v57, v31
    v_mfma_f32_16x16x32_bf16 v[12:15], v[204:207], v[8:11], v[12:15]
    s_nop 0
    v_mfma_f32_16x16x32_bf16 v[68:71], v[204:207], v[4:7], v[68:71]
    v_perm_b32 v8, v42, v42, v24
    v_perm_b32 v9, v42, v42, v25
    v_perm_b32 v10, v42, v42, v26
    v_perm_b32 v11, v42, v42, v27
    v_perm_b32 v4, v58, v58, v24
    v_perm_b32 v5, v58, v58, v25
    v_perm_b32 v6, v58, v58, v26
    v_perm_b32 v7, v58, v58, v27
    v_mfma_f32_16x16x32_bf16 v[12:15], v[208:211], v[8:11], v[12:15]
    s_nop 0
    v_mfma_f32_16x16x32_bf16 v[68:71], v[208:211], v[4:7], v[68:71]
    v_perm_b32 v8, v42, v42, v28
    v_perm_b32 v9, v42, v42, v29
    v_perm_b32 v10, v42, v42, v30
    v_perm_b32 v11, v42, v42, v31
    v_perm_b32 v4, v58, v58, v28
    v_perm_b32 v5, v58, v58, v29
    v_perm_b32 v6, v58, v58, v30
    v_perm_b32 v7, v58, v58, v31
    v_mfma_f32_16x16x32_bf16 v[12:15], v[212:215], v[8:11], v[12:15]
    s_nop 0
    v_mfma_f32_16x16x32_bf16 v[68:71], v[212:215], v[4:7], v[68:71]
    v_perm_b32 v8, v43, v43, v24
    v_perm_b32 v9, v43, v43, v25
    v_perm_b32 v10, v43, v43, v26
    v_perm_b32 v11, v43, v43, v27
    v_perm_b32 v4, v59, v59, v24
    v_perm_b32 v5, v59, v59, v25
    v_perm_b32 v6, v59, v59, v26
    v_perm_b32 v7, v59, v59, v27
    v_mfma_f32_16x16x32_bf16 v[12:15], v[216:219], v[8:11], v[12:15]
    s_nop 0
    v_mfma_f32_16x16x32_bf16 v[68:71], v[216:219], v[4:7], v[68:71]
    v_perm_b32 v8, v43, v43, v28
    v_perm_b32 v9, v43, v43, v29
    v_perm_b32 v10, v43, v43, v30
    v_perm_b32 v11, v43, v43, v31
    v_perm_b32 v4, v59, v59, v28
    v_perm_b32 v5, v59, v59, v29
    v_perm_b32 v6, v59, v59, v30
    v_perm_b32 v7, v59, v59, v31
    v_mfma_f32_16x16x32_bf16 v[12:15], v[220:223], v[8:11], v[12:15]
    s_nop 0
    v_mfma_f32_16x16x32_bf16 v[68:71], v[220:223], v[4:7], v[68:71]
    v_perm_b32 v8, v44, v44, v24
    v_perm_b32 v9, v44, v44, v25
    v_perm_b32 v10, v44, v44, v26
    v_perm_b32 v11, v44, v44, v27
    v_perm_b32 v4, v60, v60, v24
    v_perm_b32 v5, v60, v60, v25
    v_perm_b32 v6, v60, v60, v26
    v_perm_b32 v7, v60, v60, v27
    v_mfma_f32_16x16x32_bf16 v[12:15], v[224:227], v[8:11], v[12:15]
    s_nop 0
    v_mfma_f32_16x16x32_bf16 v[68:71], v[224:227], v[4:7], v[68:71]
    v_perm_b32 v8, v44, v44, v28
    v_perm_b32 v9, v44, v44, v29
    v_perm_b32 v10, v44, v44, v30
    v_perm_b32 v11, v44, v44, v31
    v_perm_b32 v4, v60, v60, v28
    v_perm_b32 v5, v60, v60, v29
    v_perm_b32 v6, v60, v60, v30
    v_perm_b32 v7, v60, v60, v31
    v_mfma_f32_16x16x32_bf16 v[12:15], v[228:231], v[8:11], v[12:15]
    s_nop 0
    v_mfma_f32_16x16x32_bf16 v[68:71], v[228:231], v[4:7], v[68:71]
    v_perm_b32 v8, v45, v45, v24
    v_perm_b32 v9, v45, v45, v25
    v_perm_b32 v10, v45, v45, v26
    v_perm_b32 v11, v45, v45, v27
    v_perm_b32 v4, v61, v61, v24
    v_perm_b32 v5, v61, v61, v25
    v_perm_b32 v6, v61, v61, v26
    v_perm_b32 v7, v61, v61, v27
    v_mfma_f32_16x16x32_bf16 v[12:15], v[232:235], v[8:11], v[12:15]
    s_nop 0
    v_mfma_f32_16x16x32_bf16 v[68:71], v[232:235], v[4:7], v[68:71]
    v_perm_b32 v8, v45, v45, v28
    v_perm_b32 v9, v45, v45, v29
    v_perm_b32 v10, v45, v45, v30
    v_perm_b32 v11, v45, v45, v31
    v_perm_b32 v4, v61, v61, v28
    v_perm_b32 v5, v61, v61, v29
    v_perm_b32 v6, v61, v61, v30
    v_perm_b32 v7, v61, v61, v31
    v_mfma_f32_16x16x32_bf16 v[12:15], v[236:239], v[8:11], v[12:15]
    s_nop 0
    v_mfma_f32_16x16x32_bf16 v[68:71], v[236:239], v[4:7], v[68:71]
    v_perm_b32 v8, v46, v46, v24
    v_perm_b32 v9, v46, v46, v25
    v_perm_b32 v10, v46, v46, v26
    v_perm_b32 v11, v46, v46, v27
    v_perm_b32 v4, v62, v62, v24
    v_perm_b32 v5, v62, v62, v25
    v_perm_b32 v6, v62, v62, v26
    v_perm_b32 v7, v62, v62, v27
    v_mfma_f32_16x16x32_bf16 v[12:15], v[240:243], v[8:11], v[12:15]
    s_nop 0
    v_mfma_f32_16x16x32_bf16 v[68:71], v[240:243], v[4:7], v[68:71]
    v_perm_b32 v8, v46, v46, v28
    v_perm_b32 v9, v46, v46, v29
    v_perm_b32 v10, v46, v46, v30
    v_perm_b32 v11, v46, v46, v31
    v_perm_b32 v4, v62, v62, v28
    v_perm_b32 v5, v62, v62, v29
    v_perm_b32 v6, v62, v62, v30
    v_perm_b32 v7, v62, v62, v31
    v_mfma_f32_16x16x32_bf16 v[12:15], v[244:247], v[8:11], v[12:15]
    s_nop 0
    v_mfma_f32_16x16x32_bf16 v[68:71], v[244:247], v[4:7], v[68:71]
    v_perm_b32 v8, v47, v47, v24
    v_perm_b32 v9, v47, v47, v25
    v_perm_b32 v10, v47, v47, v26
    v_perm_b32 v11, v47, v47, v27
    v_perm_b32 v4, v63, v63, v24
    v_perm_b32 v5, v63, v63, v25
    v_perm_b32 v6, v63, v63, v26
    v_perm_b32 v7, v63, v63, v27
    v_mfma_f32_16x16x32_bf16 v[12:15], v[248:251], v[8:11], v[12:15]
    s_nop 0
    v_mfma_f32_16x16x32_bf16 v[68:71], v[248:251], v[4:7], v[68:71]
    v_perm_b32 v8, v47, v47, v28
    v_perm_b32 v9, v47, v47, v29
    v_perm_b32 v10, v47, v47, v30
    v_perm_b32 v11, v47, v47, v31
    v_perm_b32 v4, v63, v63, v28
    v_perm_b32 v5, v63, v63, v29
    v_perm_b32 v6, v63, v63, v30
    v_perm_b32 v7, v63, v63, v31
    v_mfma_f32_16x16x32_bf16 v[12:15], v[252:255], v[8:11], v[12:15]
    s_nop 0
    v_mfma_f32_16x16x32_bf16 v[68:71], v[252:255], v[4:7], v[68:71]
    v_lshrrev_b32 v3, 4, v0
    v_lshlrev_b32 v3, 7, v3
    v_and_b32 v4, 7, v0
    v_lshl_add_u32 v3, v4, 4, v3
    v_bfe_u32 v4, v0, 3, 1
    v_lshl_add_u32 v3, v4, 9, v3
    s_lshl_b32 s24, s3, 11
    s_add_u32 s24, s24, 135168
    v_add_u32 v3, s24, v3
    ds_write_b128 v3, v[12:15]
    ds_write_b128 v3, v[68:71] offset:1024
    s_waitcnt lgkmcnt(0)
    s_barrier
    v_and_b32 v5, 31, v0
    s_lshl_b32 s24, s3, 9
    s_add_u32 s24, s24, 135168
    v_lshl_add_u32 v3, v5, 4, s24
    ds_read_b128 v[72:75], v3 offset:0
    ds_read_b128 v[76:79], v3 offset:2048
    ds_read_b128 v[80:83], v3 offset:4096
    ds_read_b128 v[84:87], v3 offset:6144
    s_mul_i32 s24, s3, 320
    s_add_u32 s24, s24, 143360
    v_lshl_add_u32 v5, v5, 3, s24
    s_waitcnt lgkmcnt(0)
    v_add_f32 v72, v72, v76
    v_add_f32 v73, v73, v77
    v_add_f32 v74, v74, v78
    v_add_f32 v75, v75, v79
    v_add_f32 v72, v72, v80
    v_add_f32 v73, v73, v81
    v_add_f32 v74, v74, v82
    v_add_f32 v75, v75, v83
    v_add_f32 v72, v72, v84
    v_add_f32 v73, v73, v85
    v_add_f32 v74, v74, v86
    v_add_f32 v75, v75, v87
    v_cvt_pk_bf16_f32 v6, v72, v73
    v_cvt_pk_bf16_f32 v7, v74, v75
    ds_write_b64 v5, v[6:7]
    v_lshrrev_b32 v3, 4, v0
    v_and_b32 v4, 3, v0
    v_mul_u32_u24 v5, 320, v4
    v_lshl_add_u32 v5, v3, 4, v5
    v_add_u32 v5, 143360, v5
    s_waitcnt lgkmcnt(0)
    s_barrier
    ds_read_b128 v[32:35], v5 offset:0
    ds_read_b128 v[36:39], v5 offset:64
    ds_read_b128 v[40:43], v5 offset:128
    ds_read_b128 v[44:47], v5 offset:192
    s_waitcnt lgkmcnt(3)
    v_mfma_f32_16x16x32_bf16 v[72:75], v[32:35], a[0:3], 0
    s_waitcnt lgkmcnt(2)
    v_mfma_f32_16x16x32_bf16 v[72:75], v[36:39], a[4:7], v[72:75]
    s_waitcnt lgkmcnt(1)
    v_mfma_f32_16x16x32_bf16 v[72:75], v[40:43], a[8:11], v[72:75]
    s_waitcnt lgkmcnt(0)
    v_mfma_f32_16x16x32_bf16 v[72:75], v[44:47], a[12:15], v[72:75]
    v_mfma_f32_16x16x32_bf16 v[76:79], v[32:35], a[16:19], 0
    v_mfma_f32_16x16x32_bf16 v[76:79], v[36:39], a[20:23], v[76:79]
    v_mfma_f32_16x16x32_bf16 v[76:79], v[40:43], a[24:27], v[76:79]
    v_mfma_f32_16x16x32_bf16 v[76:79], v[44:47], a[28:31], v[76:79]
    v_mfma_f32_16x16x32_bf16 v[80:83], v[32:35], a[32:35], 0
    v_mfma_f32_16x16x32_bf16 v[80:83], v[36:39], a[36:39], v[80:83]
    v_mfma_f32_16x16x32_bf16 v[80:83], v[40:43], a[40:43], v[80:83]
    v_mfma_f32_16x16x32_bf16 v[80:83], v[44:47], a[44:47], v[80:83]
    v_mov_b32_dpp v4, v72 quad_perm:[0,1,2,3] row_mask:0x1 bank_mask:0xf
    v_mov_b32_dpp v5, v73 quad_perm:[0,1,2,3] row_mask:0x1 bank_mask:0xf
    v_mov_b32_dpp v6, v74 quad_perm:[0,1,2,3] row_mask:0x1 bank_mask:0xf
    v_mov_b32_dpp v7, v75 quad_perm:[0,1,2,3] row_mask:0x1 bank_mask:0xf
    v_mfma_f32_16x16x32_bf16 v[84:87], v[32:35], a[48:51], 0
    v_mfma_f32_16x16x32_bf16 v[84:87], v[36:39], a[52:55], v[84:87]
    v_mfma_f32_16x16x32_bf16 v[84:87], v[40:43], a[56:59], v[84:87]
    v_mfma_f32_16x16x32_bf16 v[84:87], v[44:47], a[60:63], v[84:87]
    v_mov_b32_dpp v4, v76 quad_perm:[0,1,2,3] row_mask:0x2 bank_mask:0xf
    v_mov_b32_dpp v5, v77 quad_perm:[0,1,2,3] row_mask:0x2 bank_mask:0xf
    v_mov_b32_dpp v6, v78 quad_perm:[0,1,2,3] row_mask:0x2 bank_mask:0xf
    v_mov_b32_dpp v7, v79 quad_perm:[0,1,2,3] row_mask:0x2 bank_mask:0xf
    v_mfma_f32_16x16x32_bf16 v[88:91], v[32:35], a[64:67], 0
    v_mfma_f32_16x16x32_bf16 v[88:91], v[36:39], a[68:71], v[88:91]
    v_mfma_f32_16x16x32_bf16 v[88:91], v[40:43], a[72:75], v[88:91]
    v_mfma_f32_16x16x32_bf16 v[88:91], v[44:47], a[76:79], v[88:91]
    v_mov_b32_dpp v4, v80 quad_perm:[0,1,2,3] row_mask:0x4 bank_mask:0xf
    v_mov_b32_dpp v5, v81 quad_perm:[0,1,2,3] row_mask:0x4 bank_mask:0xf
    v_mov_b32_dpp v6, v82 quad_perm:[0,1,2,3] row_mask:0x4 bank_mask:0xf
    v_mov_b32_dpp v7, v83 quad_perm:[0,1,2,3] row_mask:0x4 bank_mask:0xf
    v_mfma_f32_16x16x32_bf16 v[92:95], v[32:35], a[80:83], 0
    v_mfma_f32_16x16x32_bf16 v[92:95], v[36:39], a[84:87], v[92:95]
    v_mfma_f32_16x16x32_bf16 v[92:95], v[40:43], a[88:91], v[92:95]
    v_mfma_f32_16x16x32_bf16 v[92:95], v[44:47], a[92:95], v[92:95]
    v_mov_b32_dpp v4, v84 quad_perm:[0,1,2,3] row_mask:0x8 bank_mask:0xf
    v_mov_b32_dpp v5, v85 quad_perm:[0,1,2,3] row_mask:0x8 bank_mask:0xf
    v_mov_b32_dpp v6, v86 quad_perm:[0,1,2,3] row_mask:0x8 bank_mask:0xf
    v_mov_b32_dpp v7, v87 quad_perm:[0,1,2,3] row_mask:0x8 bank_mask:0xf
    v_mfma_f32_16x16x32_bf16 v[96:99], v[32:35], a[96:99], 0
    v_mfma_f32_16x16x32_bf16 v[96:99], v[36:39], a[100:103], v[96:99]
    v_mfma_f32_16x16x32_bf16 v[96:99], v[40:43], a[104:107], v[96:99]
    v_mfma_f32_16x16x32_bf16 v[96:99], v[44:47], a[108:111], v[96:99]
    v_mov_b32_dpp v8, v88 quad_perm:[0,1,2,3] row_mask:0x1 bank_mask:0xf
    v_mov_b32_dpp v9, v89 quad_perm:[0,1,2,3] row_mask:0x1 bank_mask:0xf
    v_mov_b32_dpp v10, v90 quad_perm:[0,1,2,3] row_mask:0x1 bank_mask:0xf
    v_mov_b32_dpp v11, v91 quad_perm:[0,1,2,3] row_mask:0x1 bank_mask:0xf
    v_mfma_f32_16x16x32_bf16 v[100:103], v[32:35], a[112:115], 0
    v_mfma_f32_16x16x32_bf16 v[100:103], v[36:39], a[116:119], v[100:103]
    v_mfma_f32_16x16x32_bf16 v[100:103], v[40:43], a[120:123], v[100:103]
    v_mfma_f32_16x16x32_bf16 v[100:103], v[44:47], a[124:127], v[100:103]
    v_mov_b32_dpp v8, v92 quad_perm:[0,1,2,3] row_mask:0x2 bank_mask:0xf
    v_mov_b32_dpp v9, v93 quad_perm:[0,1,2,3] row_mask:0x2 bank_mask:0xf
    v_mov_b32_dpp v10, v94 quad_perm:[0,1,2,3] row_mask:0x2 bank_mask:0xf
    v_mov_b32_dpp v11, v95 quad_perm:[0,1,2,3] row_mask:0x2 bank_mask:0xf
    v_mov_b32_dpp v8, v96 quad_perm:[0,1,2,3] row_mask:0x4 bank_mask:0xf
    v_mov_b32_dpp v9, v97 quad_perm:[0,1,2,3] row_mask:0x4 bank_mask:0xf
    v_mov_b32_dpp v10, v98 quad_perm:[0,1,2,3] row_mask:0x4 bank_mask:0xf
    v_mov_b32_dpp v11, v99 quad_perm:[0,1,2,3] row_mask:0x4 bank_mask:0xf
    v_mov_b32_dpp v8, v100 quad_perm:[0,1,2,3] row_mask:0x8 bank_mask:0xf
    v_mov_b32_dpp v9, v101 quad_perm:[0,1,2,3] row_mask:0x8 bank_mask:0xf
    v_mov_b32_dpp v10, v102 quad_perm:[0,1,2,3] row_mask:0x8 bank_mask:0xf
    v_mov_b32_dpp v11, v103 quad_perm:[0,1,2,3] row_mask:0x8 bank_mask:0xf
    s_lshl_b32 s24, s26, 12
    s_lshl_b32 s25, s3, 10
    s_add_u32 s24, s24, s25
    s_add_u32 s24, s24, 0x124000
    v_lshlrev_b32 v3, 3, v0
    v_cvt_pk_bf16_f32 v4, v4, v5
    v_cvt_pk_bf16_f32 v5, v6, v7
    v_cvt_pk_bf16_f32 v6, v8, v9
    v_cvt_pk_bf16_f32 v7, v10, v11
    buffer_store_dwordx2 v[4:5], v3, s[12:15], s24 offen sc1
    buffer_store_dwordx2 v[6:7], v3, s[12:15], s24 offen offset:512 sc1
    s_waitcnt vmcnt(0)
    s_barrier
    s_cmp_lg_u32 s3, 0
    s_cbranch_scc1 L_sig16
    s_mov_b64 exec, 1
    v_mov_b32 v3, 1
    buffer_atomic_add v3, off, s[16:19], 0 offset:8 sc0
    s_waitcnt vmcnt(0)
    v_readfirstlane_b32 s24, v3
    s_mov_b64 exec, -1
    s_and_b32 s24, s24, 31
    s_cmp_lg_u32 s24, 31
    s_cbranch_scc1 L_sig16
    v_lshlrev_b32 v4, 7, v0
    v_mov_b32 v3, 1
    s_mov_b32 s24, 0x170000
    buffer_store_dword v3, v4, s[12:15], s24 offen offset:8 sc1
L_sig16:
L_R:
    s_mov_b32 s20, s58
    s_mov_b32 s21, s59
    s_mov_b32 s22, 0x2000
    s_mov_b32 s23, 0x20000
    v_and_b32 v3, 1, v0
    v_lshlrev_b32 v3, 4, v3
    v_mov_b32 v4, 0xffff
    v_lshlrev_b32 v4, v3, v4
    v_bfe_u32 v3, v0, 1, 2
    v_cmp_eq_u32 vcc, 0, v3
    s_nop 1
    v_cndmask_b32 v20, 0, v4, vcc
    v_cmp_eq_u32 vcc, 1, v3
    s_nop 1
    v_cndmask_b32 v21, 0, v4, vcc
    v_cmp_eq_u32 vcc, 2, v3
    s_nop 1
    v_cndmask_b32 v22, 0, v4, vcc
    v_cmp_eq_u32 vcc, 3, v3
    s_nop 1
    v_cndmask_b32 v23, 0, v4, vcc
    v_lshrrev_b32 v3, 4, v0
    v_and_b32 v4, 7, v0
    v_lshl_add_u32 v5, v3, 3, v4
    s_mul_i32 s24, s3, 320
    s_add_u32 s24, s24, 143360
    v_lshl_add_u32 v24, v5, 3, s24
    s_and_b32 s30, s74, 7
    s_lshl_b32 s30, s30, 3
    s_lshr_b32 s24, s74, 3
    s_or_b32 s30, s30, s24
    v_and_b32 v6, 1, v0
    s_lshl_b32 s24, s3, 1
    v_add_u32 v6, s24, v6
    v_lshrrev_b32 v5, 1, v0
    v_lshlrev_b32 v5, 12, v5
    v_lshl_add_u32 v30, v6, 3, v5
    v_lshlrev_b32 v28, 11, v3
    v_lshl_add_u32 v28, v6, 1, v28
    s_lshl_b32 s24, s30, 4
    v_add_u32 v28, s24, v28
    v_lshlrev_b32 v80, 3, v0
    v_and_b32 v5, 3, v0
    v_mul_u32_u24 v25, 320, v5
    v_lshl_add_u32 v25, v3, 4, v25
    v_add_u32 v25, 143360, v25
    v_and_b32 v29, 0x1ff, v2
    v_min_u32 v6, 5, v4
    v_lshrrev_b32 v5, 1, v6
    v_lshlrev_b32 v31, 10, v5
    v_and_b32 v6, 1, v6
    v_lshl_add_u32 v31, v6, 4, v31
    s_cmp_lg_u32 s3, 0
    s_cbranch_scc1 L_awx17
    s_mov_b32 s24, 262144
    s_mov_b64 exec, 1
L_aw18:
    buffer_load_dword v1, off, s[12:15], s73 offset:8 sc1
    s_waitcnt vmcnt(0)
    v_readfirstlane_b32 s25, v1
    s_nop 0
    s_cmp_eq_u32 s25, 1
    s_cbranch_scc1 L_awx17
    s_sleep 4
    s_sub_u32 s24, s24, 1
    s_cmp_lg_u32 s24, 0
    s_cbranch_scc1 L_aw18
L_awx17:
    s_mov_b64 exec, -1
    s_barrier
    s_lshl_b32 s30, s30, 6
    s_add_u32 s24, s30, 0x124000
    buffer_load_dwordx2 v[8:9], v30, s[12:15], s24 offen sc1
    s_waitcnt vmcnt(0)
    v_lshlrev_b32 v4, 16, v8
    v_lshlrev_b32 v6, 16, v9
    v_and_b32 v5, 0xffff0000, v8
    v_and_b32 v7, 0xffff0000, v9
    v_permlane32_swap_b32 v4, v6
    s_nop 0
    v_permlane32_swap_b32 v5, v7
    v_add_f32 v4, v4, v6
    v_add_f32 v5, v5, v7
    s_nop 1
    v_permlane16_swap_b32 v4, v5
    v_add_f32 v4, v4, v5
    s_nop 1
    v_add_f32_dpp v4, v4, v4 row_ror:8 row_mask:0xf bank_mask:0xf
    s_nop 1
    v_add_f32_dpp v4, v4, v4 row_ror:4 row_mask:0xf bank_mask:0xf
    s_nop 1
    v_add_f32_dpp v4, v4, v4 row_ror:2 row_mask:0xf bank_mask:0xf
    v_cvt_pk_bf16_f32 v4, v4, v4
    s_mov_b32 exec_lo, 0x00030003
    s_mov_b32 exec_hi, 0x00030003
    buffer_store_short v4, v28, s[20:23], 0 offen offset:0
    s_mov_b64 exec, -1
    s_lshl_b32 s33, s26, 2
    s_add_u32 s33, s33, s3
    s_and_b32 s35, s72, 7
    s_lshl_b32 s35, s35, 7
    s_add_u32 s35, s35, 0x1b0000
    s_lshr_b32 s34, s72, 3
    s_mul_i32 s34, s34, 6
    s_lshr_b32 s24, s3, 1
    s_mul_i32 s24, s24, 3
    s_add_u32 s24, s24, s34
    s_lshl_b32 s29, s24, 10
    s_add_u32 s29, s29, s35
    s_and_b32 s24, s3, 1
    s_lshl_b32 s24, s24, 5
    s_add_u32 s29, s29, s24
    s_mov_b32 s24, 262144
    s_branch L_pd19_in
L_pd19:
    s_sleep 64
L_pd19_in:
    buffer_load_dwordx2 v[8:9], v31, s[12:15], s29 offen sc1
    s_waitcnt vmcnt(0)
    v_max_u32 v3, v8, v9
    v_cmp_eq_u32 vcc, -1, v3
    s_sub_u32 s24, s24, 1
    s_cmp_eq_u32 s24, 0
    s_cbranch_scc1 L_pd19_x
    s_and_b64 exec, exec, vcc
    s_cbranch_scc1 L_pd19
L_pd19_x:
    s_mov_b64 exec, -1
    v_mov_b32 v6, v8
    s_nop 1
    v_max_f32_dpp v6, v6, v6 quad_perm:[1,0,3,2] row_mask:0xf bank_mask:0xf
    s_nop 1
    v_max_f32_dpp v6, v6, v6 quad_perm:[2,3,0,1] row_mask:0xf bank_mask:0xf
    s_nop 1
    v_max_f32_dpp v6, v6, v6 row_half_mirror row_mask:0xf bank_mask:0xf
    v_sub_f32 v8, v8, v6
    v_exp_f32 v8, v8
    v_and_b32 v4, 7, v0
    v_cmp_gt_u32 vcc, 6, v4
    s_nop 1
    v_cndmask_b32 v8, 0, v8, vcc
    v_mul_f32 v9, v8, v9
    s_nop 1
    v_add_f32_dpp v9, v9, v9 quad_perm:[1,0,3,2] row_mask:0xf bank_mask:0xf
    s_nop 1
    v_add_f32_dpp v9, v9, v9 quad_perm:[2,3,0,1] row_mask:0xf bank_mask:0xf
    s_nop 1
    v_add_f32_dpp v9, v9, v9 row_half_mirror row_mask:0xf bank_mask:0xf
    v_rcp_f32 v9, v9
    s_nop 0
    v_mul_f32 v8, v8, v9
    v_cvt_pk_bf16_f32 v8, v8, v8
    v_lshrrev_b32 v5, 4, v0
    v_lshlrev_b32 v5, 2, v5
    ds_bpermute_b32 v6, v5, v8
    ds_bpermute_b32 v7, v5, v8 offset:16
    s_waitcnt lgkmcnt(0)
    v_and_b32 v32, v6, v20
    v_and_b32 v33, v6, v21
    v_and_b32 v34, v6, v22
    v_and_b32 v35, v6, v23
    v_and_b32 v36, v7, v20
    v_and_b32 v37, v7, v21
    v_and_b32 v38, v7, v22
    v_and_b32 v39, v7, v23
    s_mul_i32 s29, s33, 1536
    s_add_u32 s29, s29, 0x180000
    s_add_u32 s30, s30, 0x1b7000
    s_lshl_b32 s31, s26, 12
    s_lshr_b32 s24, s74, 5
    s_lshl_b32 s24, s24, 11
    s_add_u32 s31, s31, s24
    s_lshl_b32 s24, s3, 9
    s_add_u32 s31, s31, s24
    s_add_u32 s31, s31, 0x1b7000
    s_mov_b32 s27, s31
    s_mov_b32 s31, 0x400000
    s_branch L_P_go
L_P:
    s_cmp_lg_u32 s3, 0
    s_cbranch_scc1 L_H_x
    s_lshr_b32 s24, s74, 5
    s_mul_i32 s25, s24, 3
    s_add_u32 s34, s34, s25
    s_lshl_b32 s24, s24, 6
    s_add_u32 s24, s24, s26
    s_lshl_b32 s24, s24, 20
    s_add_u32 s4, s52, s24
    s_addc_u32 s5, s53, 0
    s_mov_b32 s6, 0x100000
    s_mov_b32 s7, 0x20000
    s_add_u32 s8, s4, 0x2000000
    s_addc_u32 s9, s5, 0
    s_mov_b32 s10, s6
    s_mov_b32 s11, 0x20000
    v_lshrrev_b32 v3, 4, v0
    v_mul_u32_u24 v16, 6144, v3
    v_and_b32 v3, 15, v0
    v_lshl_add_u32 v16, v3, 7, v16
    v_lshlrev_b32 v17, 10, v0
    v_mov_b32 v18, 0
    s_mov_b32 s27, 43
    s_mov_b32 s28, 43
    s_mov_b32 s32, 43
    s_mov_b32 s75, 1024
L_H:
    s_sub_u32 s75, s75, 1
    s_cmp_eq_u32 s75, 0
    s_cbranch_scc1 L_H_x
    s_mov_b64 exec, 0xffffff
    buffer_load_dword v18, v17, s[12:15], s35 offen offset:64 sc1
    s_mov_b64 exec, -1
    s_waitcnt vmcnt(0)
    v_max_i32 v19, 0, v18
    s_nop 1
    v_add_u32_dpp v3, v19, v19 row_ror:8 row_mask:0xf bank_mask:0xf
    s_nop 1
    v_add_u32_dpp v3, v3, v3 row_ror:4 row_mask:0xf bank_mask:0xf
    s_nop 1
    v_add_u32_dpp v3, v3, v3 row_ror:2 row_mask:0xf bank_mask:0xf
    s_nop 1
    v_add_u32_dpp v3, v3, v3 row_ror:1 row_mask:0xf bank_mask:0xf
    s_nop 0
    v_readlane_b32 s70, v3, 0
    v_readlane_b32 s24, v3, 16
    s_nop 0
    s_add_u32 s70, s70, s24
    s_add_u32 s24, s34, 0
    s_nop 0
    v_readlane_b32 s24, v19, s24
    s_sub_u32 s25, 43, s27
    s_mul_i32 s25, s25, 17
    s_mul_i32 s64, s24, 24
    s_add_u32 s64, s64, s25
    s_add_u32 s24, s24, 8
    s_cmp_gt_u32 s24, s27
    s_cselect_b32 s64, 0xffff, s64
    s_add_u32 s24, s34, 1
    v_readlane_b32 s24, v19, s24
    s_sub_u32 s25, 43, s28
    s_mul_i32 s25, s25, 17
    s_mul_i32 s65, s24, 24
    s_add_u32 s65, s65, s25
    s_add_u32 s24, s24, 8
    s_cmp_gt_u32 s24, s28
    s_cselect_b32 s65, 0xffff, s65
    s_add_u32 s24, s34, 2
    v_readlane_b32 s24, v19, s24
    s_sub_u32 s25, 43, s32
    s_mul_i32 s25, s25, 17
    s_mul_i32 s66, s24, 24
    s_add_u32 s66, s66, s25
    s_add_u32 s24, s24, 8
    s_cmp_gt_u32 s24, s32
    s_cselect_b32 s66, 0xffff, s66
    s_min_u32 s71, s64, s65
    s_min_u32 s71, s71, s66
    s_cmp_eq_u32 s71, 0xffff
    s_cbranch_scc1 L_H_x
    s_add_u32 s24, s71, 36
    s_cmp_lt_i32 s24, s70
    s_cbranch_scc1 L_H_go
    s_sleep 4
    s_branch L_H
L_H_go:
    s_cmp_lg_u32 s71, s64
    s_cbranch_scc1 L_H_n0
    s_sub_u32 s27, s27, 2
    s_mul_i32 s24, s27, 24576
    s_add_u32 s24, s24, 0
    s_branch L_H_ld
L_H_n0:
    s_cmp_lg_u32 s71, s65
    s_cbranch_scc1 L_H_n1
    s_sub_u32 s28, s28, 2
    s_mul_i32 s24, s28, 24576
    s_add_u32 s24, s24, 2048
    s_branch L_H_ld
L_H_n1:
    s_sub_u32 s32, s32, 2
    s_mul_i32 s24, s32, 24576
    s_add_u32 s24, s24, 4096
L_H_ld:
    buffer_load_dword v5, v16, s[4:7], s24 offen
    buffer_load_dword v5, v16, s[8:11], s24 offen
    s_add_u32 s24, s24, 24576
    buffer_load_dword v5, v16, s[4:7], s24 offen
    buffer_load_dword v5, v16, s[8:11], s24 offen
    s_branch L_H
L_H_x:
    s_mov_b32 s24, 262144
L_pd20:
    buffer_load_dwordx4 v[40:43], v2, s[12:15], s29 offen sc1
    buffer_load_dwordx4 v[44:47], v29, s[12:15], s29 offen offset:1024 sc1
    s_waitcnt vmcnt(0)
    v_max_u32 v3, v40, v41
    v_max3_u32 v3, v3, v42, v43
    v_max3_u32 v3, v3, v44, v45
    v_max3_u32 v3, v3, v46, v47
    v_cmp_eq_u32 vcc, -1, v3
    s_sub_u32 s24, s24, 1
    s_cmp_eq_u32 s24, 0
    s_cbranch_scc1 L_pd20_x
    s_and_b64 exec, exec, vcc
    s_cbranch_scc1 L_pd20
L_pd20_x:
    s_mov_b64 exec, -1
L_P_go:
    v_mfma_f32_16x16x32_bf16 v[12:15], v[40:43], v[32:35], 0
    v_mfma_f32_16x16x32_bf16 v[12:15], v[44:47], v[36:39], v[12:15]
    s_nop 7
    v_cvt_pk_bf16_f32 v4, v12, v13
    v_cvt_pk_bf16_f32 v5, v14, v15
    ds_write_b64 v24, v[4:5]
    s_waitcnt lgkmcnt(0)
    s_barrier
    ds_read_b128 v[48:51], v25 offset:0
    ds_read_b128 v[52:55], v25 offset:64
    ds_read_b128 v[56:59], v25 offset:128
    ds_read_b128 v[60:63], v25 offset:192
    s_waitcnt lgkmcnt(3)
    v_mfma_f32_16x16x32_bf16 v[64:67], v[48:51], a[128:131], 0
    v_mfma_f32_16x16x32_bf16 v[68:71], v[48:51], a[144:147], 0
    v_mfma_f32_16x16x32_bf16 v[72:75], v[48:51], a[160:163], 0
    v_mfma_f32_16x16x32_bf16 v[76:79], v[48:51], a[176:179], 0
    s_waitcnt lgkmcnt(2)
    v_mfma_f32_16x16x32_bf16 v[64:67], v[52:55], a[132:135], v[64:67]
    v_mfma_f32_16x16x32_bf16 v[68:71], v[52:55], a[148:151], v[68:71]
    v_mfma_f32_16x16x32_bf16 v[72:75], v[52:55], a[164:167], v[72:75]
    v_mfma_f32_16x16x32_bf16 v[76:79], v[52:55], a[180:183], v[76:79]
    s_waitcnt lgkmcnt(1)
    v_mfma_f32_16x16x32_bf16 v[64:67], v[56:59], a[136:139], v[64:67]
    v_mfma_f32_16x16x32_bf16 v[68:71], v[56:59], a[152:155], v[68:71]
    v_mfma_f32_16x16x32_bf16 v[72:75], v[56:59], a[168:171], v[72:75]
    v_mfma_f32_16x16x32_bf16 v[76:79], v[56:59], a[184:187], v[76:79]
    s_waitcnt lgkmcnt(0)
    v_mfma_f32_16x16x32_bf16 v[64:67], v[60:63], a[140:143], v[64:67]
    v_mfma_f32_16x16x32_bf16 v[68:71], v[60:63], a[156:159], v[68:71]
    v_mfma_f32_16x16x32_bf16 v[72:75], v[60:63], a[172:175], v[72:75]
    v_mfma_f32_16x16x32_bf16 v[76:79], v[60:63], a[188:191], v[76:79]
    s_nop 4
    v_cvt_pk_bf16_f32 v64, v64, v65
    v_cvt_pk_bf16_f32 v65, v66, v67
    v_cvt_pk_bf16_f32 v68, v68, v69
    v_cvt_pk_bf16_f32 v69, v70, v71
    v_cvt_pk_bf16_f32 v72, v72, v73
    v_cvt_pk_bf16_f32 v73, v74, v75
    v_cvt_pk_bf16_f32 v76, v76, v77
    v_cvt_pk_bf16_f32 v77, v78, v79
    v_mov_b32_dpp v64, v68 quad_perm:[0,1,2,3] row_mask:0x2 bank_mask:0xf
    v_mov_b32_dpp v65, v69 quad_perm:[0,1,2,3] row_mask:0x2 bank_mask:0xf
    s_nop 0
    v_mov_b32_dpp v64, v72 quad_perm:[0,1,2,3] row_mask:0x4 bank_mask:0xf
    v_mov_b32_dpp v65, v73 quad_perm:[0,1,2,3] row_mask:0x4 bank_mask:0xf
    s_nop 0
    v_mov_b32_dpp v64, v76 quad_perm:[0,1,2,3] row_mask:0x8 bank_mask:0xf
    v_mov_b32_dpp v65, v77 quad_perm:[0,1,2,3] row_mask:0x8 bank_mask:0xf
    buffer_store_dwordx2 v[64:65], v80, s[12:15], s31 offen sc1
    s_cmp_lg_u32 s31, 0x400000
    s_cbranch_scc1 L_P_x
    s_mov_b32 s31, s27
    s_barrier
    s_branch L_P
L_P_x:
    s_mov_b32 s24, 262144
L_pd21:
    buffer_load_dwordx2 v[8:9], v30, s[12:15], s30 offen sc1
    s_waitcnt vmcnt(0)
    v_max_u32 v3, v8, v9
    v_cmp_eq_u32 vcc, -1, v3
    s_sub_u32 s24, s24, 1
    s_cmp_eq_u32 s24, 0
    s_cbranch_scc1 L_pd21_x
    s_and_b64 exec, exec, vcc
    s_cbranch_scc1 L_pd21
L_pd21_x:
    s_mov_b64 exec, -1
    v_lshlrev_b32 v4, 16, v8
    v_lshlrev_b32 v6, 16, v9
    v_and_b32 v5, 0xffff0000, v8
    v_and_b32 v7, 0xffff0000, v9
    v_permlane32_swap_b32 v4, v6
    s_nop 0
    v_permlane32_swap_b32 v5, v7
    v_add_f32 v4, v4, v6
    v_add_f32 v5, v5, v7
    s_nop 1
    v_permlane16_swap_b32 v4, v5
    v_add_f32 v4, v4, v5
    s_nop 1
    v_add_f32_dpp v4, v4, v4 row_ror:8 row_mask:0xf bank_mask:0xf
    s_nop 1
    v_add_f32_dpp v4, v4, v4 row_ror:4 row_mask:0xf bank_mask:0xf
    s_nop 1
    v_add_f32_dpp v4, v4, v4 row_ror:2 row_mask:0xf bank_mask:0xf
    v_cvt_pk_bf16_f32 v4, v4, v4
    s_mov_b32 exec_lo, 0x00030003
    s_mov_b32 exec_hi, 0x00030003
    buffer_store_short v4, v28, s[20:23], 0 offen offset:1024
    s_mov_b64 exec, -1
L_end:
    s_endpgm
L_C:
    s_cmp_lg_u32 s3, 0
    s_cbranch_scc1 L_C_q
    v_lshrrev_b32 v3, 4, v0
    v_and_b32 v4, 3, v0
    v_lshlrev_b32 v5, 6, v3
    v_lshl_add_u32 v5, v4, 4, v5
    v_bfe_u32 v4, v0, 2, 2
    v_lshl_add_u32 v5, v4, 8, v5
    s_lshl_b32 s24, s26, 10
    s_add_u32 s24, s24, 0x164000
    buffer_store_dwordx4 v[8:11], v5, s[12:15], s24 offen sc1
L_C_q:
    s_waitcnt vmcnt(0)
    s_barrier
    s_cmp_lg_u32 s3, 0
    s_cbranch_scc1 L_sig22
    s_mov_b64 exec, 1
    v_mov_b32 v3, 1
    v_mov_b32 v4, 1
    buffer_atomic_add v4, off, s[16:19], 0 offset:128
    buffer_atomic_add v3, off, s[16:19], 0 offset:0 sc0
    s_waitcnt vmcnt(0)
    v_readfirstlane_b32 s24, v3
    s_mov_b64 exec, -1
    s_and_b32 s24, s24, 63
    s_cmp_lg_u32 s24, 63
    s_cbranch_scc1 L_sig22
    v_lshlrev_b32 v4, 7, v0
    v_mov_b32 v3, 1
    s_mov_b32 s24, 0x170000
    buffer_store_dword v3, v4, s[12:15], s24 offen offset:0 sc1
L_sig22:
    s_mov_b32 s8, s56
    s_mov_b32 s9, s57
    s_mov_b32 s10, 0x400000
    s_mov_b32 s11, 0x20000
    s_lshl_b32 s24, s26, 17
    s_lshl_b32 s25, s3, 15
    s_add_u32 s24, s24, s25
    s_add_u32 s24, s24, 512
    v_lshrrev_b32 v3, 5, v0
    v_and_b32 v4, 0x1ff, v2
    v_lshl_add_u32 v3, v3, 13, v4
    s_mul_i32 m0, s3, 16896
    s_nop 0
    buffer_load_dwordx4 v3, s[8:11], s24 offen nt lds
    s_add_u32 m0, m0, 1056
    s_add_u32 s24, s24, 2048
    buffer_load_dwordx4 v3, s[8:11], s24 offen nt lds
    s_add_u32 m0, m0, 1056
    s_add_u32 s24, s24, 2048
    buffer_load_dwordx4 v3, s[8:11], s24 offen nt lds
    s_add_u32 m0, m0, 1056
    s_add_u32 s24, s24, 2048
    buffer_load_dwordx4 v3, s[8:11], s24 offen nt lds
    s_add_u32 m0, m0, 1056
    s_add_u32 s24, s24, 10240
    buffer_load_dwordx4 v3, s[8:11], s24 offen nt lds
    s_add_u32 m0, m0, 1056
    s_add_u32 s24, s24, 2048
    buffer_load_dwordx4 v3, s[8:11], s24 offen nt lds
    s_add_u32 m0, m0, 1056
    s_add_u32 s24, s24, 2048
    buffer_load_dwordx4 v3, s[8:11], s24 offen nt lds
    s_add_u32 m0, m0, 1056
    s_add_u32 s24, s24, 2048
    buffer_load_dwordx4 v3, s[8:11], s24 offen nt lds
    s_add_u32 m0, m0, 1056
    s_add_u32 s24, s24, -21504
    buffer_load_dwordx4 v3, s[8:11], s24 offen nt lds
    s_add_u32 m0, m0, 1056
    s_add_u32 s24, s24, 2048
    buffer_load_dwordx4 v3, s[8:11], s24 offen nt lds
    s_add_u32 m0, m0, 1056
    s_add_u32 s24, s24, 2048
    buffer_load_dwordx4 v3, s[8:11], s24 offen nt lds
    s_add_u32 m0, m0, 1056
    s_add_u32 s24, s24, 2048
    buffer_load_dwordx4 v3, s[8:11], s24 offen nt lds
    s_add_u32 m0, m0, 1056
    s_add_u32 s24, s24, 10240
    buffer_load_dwordx4 v3, s[8:11], s24 offen nt lds
    s_add_u32 m0, m0, 1056
    s_add_u32 s24, s24, 2048
    buffer_load_dwordx4 v3, s[8:11], s24 offen nt lds
    s_add_u32 m0, m0, 1056
    s_add_u32 s24, s24, 2048
    buffer_load_dwordx4 v3, s[8:11], s24 offen nt lds
    s_add_u32 m0, m0, 1056
    s_add_u32 s24, s24, 2048
    buffer_load_dwordx4 v3, s[8:11], s24 offen nt lds
    s_waitcnt vmcnt(0)
    s_barrier
    v_lshrrev_b32 v3, 2, v0
    v_mul_u32_u24 v3, 1056, v3
    v_and_b32 v4, 3, v0
    v_lshl_add_u32 v3, v4, 3, v3
    s_lshl_b32 s24, s3, 7
    v_add_u32 v3, s24, v3
    ds_read_b64_tr_b16 a[128:129], v3 offset:0
    ds_read_b64_tr_b16 a[130:131], v3 offset:512
    ds_read_b64_tr_b16 a[144:145], v3 offset:32
    ds_read_b64_tr_b16 a[146:147], v3 offset:544
    ds_read_b64_tr_b16 a[160:161], v3 offset:64
    ds_read_b64_tr_b16 a[162:163], v3 offset:576
    ds_read_b64_tr_b16 a[176:177], v3 offset:96
    ds_read_b64_tr_b16 a[178:179], v3 offset:608
    ds_read_b64_tr_b16 a[132:133], v3 offset:16896
    ds_read_b64_tr_b16 a[134:135], v3 offset:17408
    ds_read_b64_tr_b16 a[148:149], v3 offset:16928
    ds_read_b64_tr_b16 a[150:151], v3 offset:17440
    ds_read_b64_tr_b16 a[164:165], v3 offset:16960
    ds_read_b64_tr_b16 a[166:167], v3 offset:17472
    ds_read_b64_tr_b16 a[180:181], v3 offset:16992
    ds_read_b64_tr_b16 a[182:183], v3 offset:17504
    ds_read_b64_tr_b16 a[136:137], v3 offset:33792
    ds_read_b64_tr_b16 a[138:139], v3 offset:34304
    ds_read_b64_tr_b16 a[152:153], v3 offset:33824
    ds_read_b64_tr_b16 a[154:155], v3 offset:34336
    ds_read_b64_tr_b16 a[168:169], v3 offset:33856
    ds_read_b64_tr_b16 a[170:171], v3 offset:34368
    ds_read_b64_tr_b16 a[184:185], v3 offset:33888
    ds_read_b64_tr_b16 a[186:187], v3 offset:34400
    ds_read_b64_tr_b16 a[140:141], v3 offset:50688
    ds_read_b64_tr_b16 a[142:143], v3 offset:51200
    ds_read_b64_tr_b16 a[156:157], v3 offset:50720
    ds_read_b64_tr_b16 a[158:159], v3 offset:51232
    ds_read_b64_tr_b16 a[172:173], v3 offset:50752
    ds_read_b64_tr_b16 a[174:175], v3 offset:51264
    ds_read_b64_tr_b16 a[188:189], v3 offset:50784
    ds_read_b64_tr_b16 a[190:191], v3 offset:51296
    s_and_b32 s70, s72, 3
    s_lshr_b32 s71, s72, 4
    s_bfe_u32 s24, s72, 0x10002
    s_lshl_b32 s24, s24, 1
    s_add_u32 s71, s71, s24
    s_bfe_u32 s75, s72, 0x10003
    s_lshl_b32 s30, s71, 22
    s_add_u32 s4, s38, s30
    s_addc_u32 s5, s39, 0
    s_mov_b32 s6, 0x400000
    s_mov_b32 s7, 0x20000
    s_mul_i32 s32, s3, 65536
    s_lshl_b32 s24, s70, 10
    s_add_u32 s32, s32, s24
    s_mul_i32 s34, s3, 16896
    s_waitcnt lgkmcnt(0)
    s_barrier
    s_mov_b32 m0, s34
    s_nop 0
    buffer_load_dwordx4 v2, s[4:7], s32 offen lds
    s_add_u32 m0, m0, 1056
    s_add_u32 s32, s32, 4096
    buffer_load_dwordx4 v2, s[4:7], s32 offen lds
    s_add_u32 m0, m0, 1056
    s_add_u32 s32, s32, 4096
    buffer_load_dwordx4 v2, s[4:7], s32 offen lds
    s_add_u32 m0, m0, 1056
    s_add_u32 s32, s32, 4096
    buffer_load_dwordx4 v2, s[4:7], s32 offen lds
    s_add_u32 m0, m0, 1056
    s_add_u32 s32, s32, 4096
    buffer_load_dwordx4 v2, s[4:7], s32 offen lds
    s_add_u32 m0, m0, 1056
    s_add_u32 s32, s32, 4096
    buffer_load_dwordx4 v2, s[4:7], s32 offen lds
    s_add_u32 m0, m0, 1056
    s_add_u32 s32, s32, 4096
    buffer_load_dwordx4 v2, s[4:7], s32 offen lds
    s_add_u32 m0, m0, 1056
    s_add_u32 s32, s32, 4096
    buffer_load_dwordx4 v2, s[4:7], s32 offen lds
    s_add_u32 m0, m0, 1056
    s_add_u32 s32, s32, 4096
    buffer_load_dwordx4 v2, s[4:7], s32 offen lds
    s_add_u32 m0, m0, 1056
    s_add_u32 s32, s32, 4096
    buffer_load_dwordx4 v2, s[4:7], s32 offen lds
    s_add_u32 m0, m0, 1056
    s_add_u32 s32, s32, 4096
    buffer_load_dwordx4 v2, s[4:7], s32 offen lds
    s_add_u32 m0, m0, 1056
    s_add_u32 s32, s32, 4096
    buffer_load_dwordx4 v2, s[4:7], s32 offen lds
    s_add_u32 m0, m0, 1056
    s_add_u32 s32, s32, 4096
    buffer_load_dwordx4 v2, s[4:7], s32 offen lds
    s_add_u32 m0, m0, 1056
    s_add_u32 s32, s32, 4096
    buffer_load_dwordx4 v2, s[4:7], s32 offen lds
    s_add_u32 m0, m0, 1056
    s_add_u32 s32, s32, 4096
    buffer_load_dwordx4 v2, s[4:7], s32 offen lds
    s_add_u32 m0, m0, 1056
    s_add_u32 s32, s32, 4096
    buffer_load_dwordx4 v2, s[4:7], s32 offen lds
    s_add_u32 m0, m0, 1056
    s_add_u32 s32, s32, 200704
    s_lshr_b32 s28, s3, 1
    s_and_b32 s29, s3, 1
    v_and_b32 v3, 15, v0
    v_lshrrev_b32 v4, 4, v0
    v_mul_u32_u24 v19, 1056, v3
    v_lshl_add_u32 v19, v4, 4, v19
    v_lshrrev_b32 v5, 2, v0
    v_mul_u32_u24 v20, 1056, v5
    v_and_b32 v5, 3, v0
    v_lshl_add_u32 v20, v5, 3, v20
    s_lshl_b32 s24, s29, 9
    v_add_u32 v20, s24, v20
    v_and_b32 v3, 15, v0
    v_mul_u32_u24 v18, 1056, v3
    v_lshl_add_u32 v18, v4, 4, v18
    v_add_u32 v18, 101376, v18
    s_mul_i32 s24, s28, 33792
    v_add_u32 v19, s24, v19
    v_add_u32 v20, s24, v20
    v_mov_b32 v128, 0
    v_mov_b32 v129, 0
    v_mov_b32 v130, 0
    v_mov_b32 v131, 0
    v_mov_b32 v132, 0
    v_mov_b32 v133, 0
    v_mov_b32 v134, 0
    v_mov_b32 v135, 0
    v_mov_b32 v136, 0
    v_mov_b32 v137, 0
    v_mov_b32 v138, 0
    v_mov_b32 v139, 0
    v_mov_b32 v140, 0
    v_mov_b32 v141, 0
    v_mov_b32 v142, 0
    v_mov_b32 v143, 0
    v_mov_b32 v144, 0
    v_mov_b32 v145, 0
    v_mov_b32 v146, 0
    v_mov_b32 v147, 0
    v_mov_b32 v148, 0
    v_mov_b32 v149, 0
    v_mov_b32 v150, 0
    v_mov_b32 v151, 0
    v_mov_b32 v152, 0
    v_mov_b32 v153, 0
    v_mov_b32 v154, 0
    v_mov_b32 v155, 0
    v_mov_b32 v156, 0
    v_mov_b32 v157, 0
    v_mov_b32 v158, 0
    v_mov_b32 v159, 0
    v_mov_b32 v160, 0
    v_mov_b32 v161, 0
    v_mov_b32 v162, 0
    v_mov_b32 v163, 0
    v_mov_b32 v164, 0
    v_mov_b32 v165, 0
    v_mov_b32 v166, 0
    v_mov_b32 v167, 0
    v_mov_b32 v168, 0
    v_mov_b32 v169, 0
    v_mov_b32 v170, 0
    v_mov_b32 v171, 0
    v_mov_b32 v172, 0
    v_mov_b32 v173, 0
    v_mov_b32 v174, 0
    v_mov_b32 v175, 0
    v_mov_b32 v176, 0
    v_mov_b32 v177, 0
    v_mov_b32 v178, 0
    v_mov_b32 v179, 0
    v_mov_b32 v180, 0
    v_mov_b32 v181, 0
    v_mov_b32 v182, 0
    v_mov_b32 v183, 0
    v_mov_b32 v184, 0
    v_mov_b32 v185, 0
    v_mov_b32 v186, 0
    v_mov_b32 v187, 0
    v_mov_b32 v188, 0
    v_mov_b32 v189, 0
    v_mov_b32 v190, 0
    v_mov_b32 v191, 0
    v_mov_b32 v22, 0xff800000
    v_mov_b32 v23, 0
    s_cmp_lg_u32 s3, 0
    s_cbranch_scc1 L_awx23
    s_mov_b32 s24, 262144
    s_mov_b64 exec, 1
L_aw24:
    buffer_load_dword v1, off, s[12:15], s73 offset:0 sc1
    s_waitcnt vmcnt(0)
    v_readfirstlane_b32 s25, v1
    s_nop 0
    s_cmp_eq_u32 s25, 1
    s_cbranch_scc1 L_awx23
    s_sleep 4
    s_sub_u32 s24, s24, 1
    s_cmp_lg_u32 s24, 0
    s_cbranch_scc1 L_aw24
L_awx23:
    s_mov_b64 exec, -1
    s_barrier
    s_lshl_b32 s24, s71, 15
    s_mul_i32 s25, s3, 4096
    s_add_u32 s24, s24, s25
    s_add_u32 s24, s24, 0x0
    s_mul_i32 s25, s75, 16384
    s_add_u32 s24, s24, s25
    buffer_load_dwordx4 v[32:35], v2, s[12:15], s24 offen offset:0 sc1
    buffer_load_dwordx4 v[36:39], v2, s[12:15], s24 offen offset:1024 sc1
    buffer_load_dwordx4 v[40:43], v2, s[12:15], s24 offen offset:2048 sc1
    buffer_load_dwordx4 v[44:47], v2, s[12:15], s24 offen offset:3072 sc1
    s_mul_i32 s24, s3, 4224
    s_add_u32 s24, s24, 101376
    v_add_u32 v3, s24, v2
    s_waitcnt vmcnt(3)
    ds_write_b128 v3, v[32:35] offset:0
    s_waitcnt vmcnt(2)
    ds_write_b128 v3, v[36:39] offset:1056
    s_waitcnt vmcnt(1)
    ds_write_b128 v3, v[40:43] offset:2112
    s_waitcnt vmcnt(0)
    ds_write_b128 v3, v[44:47] offset:3168
    s_waitcnt lgkmcnt(0)
    s_barrier
    ds_read_b128 a[0:3], v18 offset:0
    ds_read_b128 a[4:7], v18 offset:64
    ds_read_b128 a[8:11], v18 offset:128
    ds_read_b128 a[12:15], v18 offset:192
    ds_read_b128 a[16:19], v18 offset:256
    ds_read_b128 a[20:23], v18 offset:320
    ds_read_b128 a[24:27], v18 offset:384
    ds_read_b128 a[28:31], v18 offset:448
    ds_read_b128 a[32:35], v18 offset:512
    ds_read_b128 a[36:39], v18 offset:576
    ds_read_b128 a[40:43], v18 offset:640
    ds_read_b128 a[44:47], v18 offset:704
    ds_read_b128 a[48:51], v18 offset:768
    ds_read_b128 a[52:55], v18 offset:832
    ds_read_b128 a[56:59], v18 offset:896
    ds_read_b128 a[60:63], v18 offset:960
    s_cmp_lg_u32 s3, 0
    s_cbranch_scc1 L_xi25
    s_getreg_b32 s25, hwreg(HW_REG_XCC_ID, 0, 4)
    s_lshl_b32 s24, s26, 7
    s_add_u32 s24, s24, 0x1b6000
    s_mov_b64 exec, 1
    v_mov_b32 v3, s25
    buffer_store_dword v3, off, s[12:15], s24 offset:4 sc1
    s_mov_b64 exec, -1
L_xi25:
    s_mov_b32 s27, 0
    s_mov_b32 s33, 67584
    s_mov_b32 s35, 0
    s_waitcnt lgkmcnt(0)
L_CT:
    s_waitcnt vmcnt(0)
    s_barrier
    v_add_u32 v24, s35, v19
    v_add_u32 v25, s35, v20
    ds_read_b128 v[32:35], v24 offset:0
    ds_read_b128 v[36:39], v24 offset:16896
    ds_read_b128 v[40:43], v24 offset:64
    ds_read_b128 v[44:47], v24 offset:16960
    ds_read_b128 v[48:51], v24 offset:128
    ds_read_b128 v[52:55], v24 offset:17024
    ds_read_b128 v[56:59], v24 offset:192
    s_add_u32 m0, s33, s34
    s_mov_b32 s33, s35
    s_add_u32 s35, s35, 67584
    s_cmp_eq_u32 s35, 135168
    s_cselect_b32 s35, 0, s35
    s_waitcnt lgkmcnt(6)
    v_mfma_f32_16x16x32_bf16 v[64:67], v[32:35], a[0:3], 0
    ds_read_b128 v[60:63], v24 offset:17088
    buffer_load_dwordx4 v2, s[4:7], s32 offen lds
    s_add_u32 m0, m0, 1056
    s_add_u32 s32, s32, 4096
    s_waitcnt lgkmcnt(6)
    v_mfma_f32_16x16x32_bf16 v[68:71], v[36:39], a[0:3], 0
    ds_read_b128 v[32:35], v24 offset:256
    s_waitcnt lgkmcnt(6)
    v_mfma_f32_16x16x32_bf16 v[64:67], v[40:43], a[4:7], v[64:67]
    ds_read_b128 v[36:39], v24 offset:17152
    buffer_load_dwordx4 v2, s[4:7], s32 offen lds
    s_add_u32 m0, m0, 1056
    s_add_u32 s32, s32, 4096
    s_waitcnt lgkmcnt(6)
    v_mfma_f32_16x16x32_bf16 v[68:71], v[44:47], a[4:7], v[68:71]
    ds_read_b128 v[40:43], v24 offset:320
    s_waitcnt lgkmcnt(6)
    v_mfma_f32_16x16x32_bf16 v[64:67], v[48:51], a[8:11], v[64:67]
    ds_read_b128 v[44:47], v24 offset:17216
    buffer_load_dwordx4 v2, s[4:7], s32 offen lds
    s_add_u32 m0, m0, 1056
    s_add_u32 s32, s32, 4096
    s_waitcnt lgkmcnt(6)
    v_mfma_f32_16x16x32_bf16 v[68:71], v[52:55], a[8:11], v[68:71]
    ds_read_b128 v[48:51], v24 offset:384
    s_waitcnt lgkmcnt(6)
    v_mfma_f32_16x16x32_bf16 v[64:67], v[56:59], a[12:15], v[64:67]
    ds_read_b128 v[52:55], v24 offset:17280
    buffer_load_dwordx4 v2, s[4:7], s32 offen lds
    s_add_u32 m0, m0, 1056
    s_add_u32 s32, s32, 4096
    s_waitcnt lgkmcnt(6)
    v_mfma_f32_16x16x32_bf16 v[68:71], v[60:63], a[12:15], v[68:71]
    ds_read_b128 v[56:59], v24 offset:448
    s_waitcnt lgkmcnt(6)
    v_mfma_f32_16x16x32_bf16 v[64:67], v[32:35], a[16:19], v[64:67]
    ds_read_b128 v[60:63], v24 offset:17344
    buffer_load_dwordx4 v2, s[4:7], s32 offen lds
    s_add_u32 m0, m0, 1056
    s_add_u32 s32, s32, 4096
    s_waitcnt lgkmcnt(6)
    v_mfma_f32_16x16x32_bf16 v[68:71], v[36:39], a[16:19], v[68:71]
    ds_read_b128 v[32:35], v24 offset:512
    s_waitcnt lgkmcnt(6)
    v_mfma_f32_16x16x32_bf16 v[64:67], v[40:43], a[20:23], v[64:67]
    ds_read_b128 v[36:39], v24 offset:17408
    buffer_load_dwordx4 v2, s[4:7], s32 offen lds
    s_add_u32 m0, m0, 1056
    s_add_u32 s32, s32, 4096
    s_waitcnt lgkmcnt(6)
    v_mfma_f32_16x16x32_bf16 v[68:71], v[44:47], a[20:23], v[68:71]
    ds_read_b128 v[40:43], v24 offset:576
    s_waitcnt lgkmcnt(6)
    v_mfma_f32_16x16x32_bf16 v[64:67], v[48:51], a[24:27], v[64:67]
    ds_read_b128 v[44:47], v24 offset:17472
    buffer_load_dwordx4 v2, s[4:7], s32 offen lds
    s_add_u32 m0, m0, 1056
    s_add_u32 s32, s32, 4096
    s_waitcnt lgkmcnt(6)
    v_mfma_f32_16x16x32_bf16 v[68:71], v[52:55], a[24:27], v[68:71]
    ds_read_b128 v[48:51], v24 offset:640
    s_waitcnt lgkmcnt(6)
    v_mfma_f32_16x16x32_bf16 v[64:67], v[56:59], a[28:31], v[64:67]
    ds_read_b128 v[52:55], v24 offset:17536
    buffer_load_dwordx4 v2, s[4:7], s32 offen lds
    s_add_u32 m0, m0, 1056
    s_add_u32 s32, s32, 4096
    s_waitcnt lgkmcnt(6)
    v_mfma_f32_16x16x32_bf16 v[68:71], v[60:63], a[28:31], v[68:71]
    ds_read_b128 v[56:59], v24 offset:704
    s_waitcnt lgkmcnt(6)
    v_mfma_f32_16x16x32_bf16 v[64:67], v[32:35], a[32:35], v[64:67]
    ds_read_b128 v[60:63], v24 offset:17600
    buffer_load_dwordx4 v2, s[4:7], s32 offen lds
    s_add_u32 m0, m0, 1056
    s_add_u32 s32, s32, 4096
    s_waitcnt lgkmcnt(6)
    v_mfma_f32_16x16x32_bf16 v[68:71], v[36:39], a[32:35], v[68:71]
    ds_read_b128 v[32:35], v24 offset:768
    s_waitcnt lgkmcnt(6)
    v_mfma_f32_16x16x32_bf16 v[64:67], v[40:43], a[36:39], v[64:67]
    ds_read_b128 v[36:39], v24 offset:17664
    buffer_load_dwordx4 v2, s[4:7], s32 offen lds
    s_add_u32 m0, m0, 1056
    s_add_u32 s32, s32, 4096
    s_waitcnt lgkmcnt(6)
    v_mfma_f32_16x16x32_bf16 v[68:71], v[44:47], a[36:39], v[68:71]
    ds_read_b128 v[40:43], v24 offset:832
    s_waitcnt lgkmcnt(6)
    v_mfma_f32_16x16x32_bf16 v[64:67], v[48:51], a[40:43], v[64:67]
    ds_read_b128 v[44:47], v24 offset:17728
    buffer_load_dwordx4 v2, s[4:7], s32 offen lds
    s_add_u32 m0, m0, 1056
    s_add_u32 s32, s32, 4096
    s_waitcnt lgkmcnt(6)
    v_mfma_f32_16x16x32_bf16 v[68:71], v[52:55], a[40:43], v[68:71]
    ds_read_b128 v[48:51], v24 offset:896
    s_waitcnt lgkmcnt(6)
    v_mfma_f32_16x16x32_bf16 v[64:67], v[56:59], a[44:47], v[64:67]
    ds_read_b128 v[52:55], v24 offset:17792
    buffer_load_dwordx4 v2, s[4:7], s32 offen lds
    s_add_u32 m0, m0, 1056
    s_add_u32 s32, s32, 4096
    s_waitcnt lgkmcnt(6)
    v_mfma_f32_16x16x32_bf16 v[68:71], v[60:63], a[44:47], v[68:71]
    ds_read_b128 v[56:59], v24 offset:960
    s_waitcnt lgkmcnt(6)
    v_mfma_f32_16x16x32_bf16 v[64:67], v[32:35], a[48:51], v[64:67]
    ds_read_b128 v[60:63], v24 offset:17856
    buffer_load_dwordx4 v2, s[4:7], s32 offen lds
    s_add_u32 m0, m0, 1056
    s_add_u32 s32, s32, 4096
    s_waitcnt lgkmcnt(6)
    v_mfma_f32_16x16x32_bf16 v[68:71], v[36:39], a[48:51], v[68:71]
    ds_read_b64_tr_b16 v[192:193], v25 offset:0
    s_waitcnt lgkmcnt(6)
    v_mfma_f32_16x16x32_bf16 v[64:67], v[40:43], a[52:55], v[64:67]
    ds_read_b64_tr_b16 v[194:195], v25 offset:16896
    buffer_load_dwordx4 v2, s[4:7], s32 offen lds
    s_add_u32 m0, m0, 1056
    s_add_u32 s32, s32, 4096
    s_waitcnt lgkmcnt(6)
    v_mfma_f32_16x16x32_bf16 v[68:71], v[44:47], a[52:55], v[68:71]
    ds_read_b64_tr_b16 v[196:197], v25 offset:32
    s_waitcnt lgkmcnt(6)
    v_mfma_f32_16x16x32_bf16 v[64:67], v[48:51], a[56:59], v[64:67]
    ds_read_b64_tr_b16 v[198:199], v25 offset:16928
    buffer_load_dwordx4 v2, s[4:7], s32 offen lds
    s_add_u32 m0, m0, 1056
    s_add_u32 s32, s32, 4096
    s_waitcnt lgkmcnt(6)
    v_mfma_f32_16x16x32_bf16 v[68:71], v[52:55], a[56:59], v[68:71]
    ds_read_b64_tr_b16 v[200:201], v25 offset:64
    s_waitcnt lgkmcnt(6)
    v_mfma_f32_16x16x32_bf16 v[64:67], v[56:59], a[60:63], v[64:67]
    ds_read_b64_tr_b16 v[202:203], v25 offset:16960
    buffer_load_dwordx4 v2, s[4:7], s32 offen lds
    s_add_u32 m0, m0, 1056
    s_add_u32 s32, s32, 200704
    s_waitcnt lgkmcnt(6)
    v_mfma_f32_16x16x32_bf16 v[68:71], v[60:63], a[60:63], v[68:71]
    ds_read_b64_tr_b16 v[204:205], v25 offset:96
    ds_read_b64_tr_b16 v[206:207], v25 offset:16992
    ds_read_b64_tr_b16 v[208:209], v25 offset:128
    ds_read_b64_tr_b16 v[210:211], v25 offset:17024
    ds_read_b64_tr_b16 v[212:213], v25 offset:160
    ds_read_b64_tr_b16 v[214:215], v25 offset:17056
    ds_read_b64_tr_b16 v[216:217], v25 offset:192
    ds_read_b64_tr_b16 v[218:219], v25 offset:17088
    v_max3_f32 v3, v64, v65, v22
    v_max3_f32 v3, v3, v66, v67
    v_max3_f32 v3, v3, v68, v69
    v_max3_f32 v3, v3, v70, v71
    v_mov_b32 v4, v3
    ds_read_b64_tr_b16 v[220:221], v25 offset:224
    s_nop 0
    v_permlane32_swap_b32 v3, v4
    ds_read_b64_tr_b16 v[222:223], v25 offset:17120
    v_max_f32 v3, v3, v4
    ds_read_b64_tr_b16 v[224:225], v25 offset:256
    v_mov_b32 v4, v3
    ds_read_b64_tr_b16 v[226:227], v25 offset:17152
    s_nop 0
    v_permlane16_swap_b32 v3, v4
    ds_read_b64_tr_b16 v[228:229], v25 offset:288
    v_max_f32 v3, v3, v4
    ds_read_b64_tr_b16 v[230:231], v25 offset:17184
    v_sub_f32 v4, v22, v3
    ds_read_b64_tr_b16 v[232:233], v25 offset:320
    v_exp_f32 v4, v4
    ds_read_b64_tr_b16 v[234:235], v25 offset:17216
    v_mov_b32 v22, v3
    ds_read_b64_tr_b16 v[236:237], v25 offset:352
    v_sub_f32 v64, v64, v3
    ds_read_b64_tr_b16 v[238:239], v25 offset:17248
    v_sub_f32 v65, v65, v3
    ds_read_b64_tr_b16 v[240:241], v25 offset:384
    v_sub_f32 v66, v66, v3
    ds_read_b64_tr_b16 v[242:243], v25 offset:17280
    v_sub_f32 v67, v67, v3
    ds_read_b64_tr_b16 v[244:245], v25 offset:416
    v_sub_f32 v68, v68, v3
    ds_read_b64_tr_b16 v[246:247], v25 offset:17312
    v_sub_f32 v69, v69, v3
    ds_read_b64_tr_b16 v[248:249], v25 offset:448
    v_sub_f32 v70, v70, v3
    ds_read_b64_tr_b16 v[250:251], v25 offset:17344
    v_sub_f32 v71, v71, v3
    ds_read_b64_tr_b16 v[252:253], v25 offset:480
    v_exp_f32 v64, v64
    ds_read_b64_tr_b16 v[254:255], v25 offset:17376
    v_exp_f32 v65, v65
    v_exp_f32 v66, v66
    v_exp_f32 v67, v67
    v_exp_f32 v68, v68
    v_exp_f32 v69, v69
    v_exp_f32 v70, v70
    v_exp_f32 v71, v71
    v_cvt_pk_bf16_f32 v72, v64, v65
    v_cvt_pk_bf16_f32 v73, v66, v67
    v_cvt_pk_bf16_f32 v74, v68, v69
    v_cvt_pk_bf16_f32 v75, v70, v71
    v_pk_mul_f32 v[128:129], v[128:129], v[4:5] op_sel_hi:[1,0]
    v_pk_mul_f32 v[130:131], v[130:131], v[4:5] op_sel_hi:[1,0]
    v_pk_mul_f32 v[132:133], v[132:133], v[4:5] op_sel_hi:[1,0]
    v_pk_mul_f32 v[134:135], v[134:135], v[4:5] op_sel_hi:[1,0]
    s_waitcnt lgkmcnt(0)
    v_mfma_f32_16x16x32_bf16 v[128:131], v[192:195], v[72:75], v[128:131]
    v_pk_mul_f32 v[136:137], v[136:137], v[4:5] op_sel_hi:[1,0]
    v_pk_mul_f32 v[138:139], v[138:139], v[4:5] op_sel_hi:[1,0]
    v_mfma_f32_16x16x32_bf16 v[132:135], v[196:199], v[72:75], v[132:135]
    v_pk_mul_f32 v[140:141], v[140:141], v[4:5] op_sel_hi:[1,0]
    v_pk_mul_f32 v[142:143], v[142:143], v[4:5] op_sel_hi:[1,0]
    v_mfma_f32_16x16x32_bf16 v[136:139], v[200:203], v[72:75], v[136:139]
    v_pk_mul_f32 v[144:145], v[144:145], v[4:5] op_sel_hi:[1,0]
    v_pk_mul_f32 v[146:147], v[146:147], v[4:5] op_sel_hi:[1,0]
    v_mfma_f32_16x16x32_bf16 v[140:143], v[204:207], v[72:75], v[140:143]
    v_pk_mul_f32 v[148:149], v[148:149], v[4:5] op_sel_hi:[1,0]
    v_pk_mul_f32 v[150:151], v[150:151], v[4:5] op_sel_hi:[1,0]
    v_mfma_f32_16x16x32_bf16 v[144:147], v[208:211], v[72:75], v[144:147]
    v_pk_mul_f32 v[152:153], v[152:153], v[4:5] op_sel_hi:[1,0]
    v_pk_mul_f32 v[154:155], v[154:155], v[4:5] op_sel_hi:[1,0]
    v_mfma_f32_16x16x32_bf16 v[148:151], v[212:215], v[72:75], v[148:151]
    v_pk_mul_f32 v[156:157], v[156:157], v[4:5] op_sel_hi:[1,0]
    v_pk_mul_f32 v[158:159], v[158:159], v[4:5] op_sel_hi:[1,0]
    v_mfma_f32_16x16x32_bf16 v[152:155], v[216:219], v[72:75], v[152:155]
    v_pk_mul_f32 v[160:161], v[160:161], v[4:5] op_sel_hi:[1,0]
    v_pk_mul_f32 v[162:163], v[162:163], v[4:5] op_sel_hi:[1,0]
    v_mfma_f32_16x16x32_bf16 v[156:159], v[220:223], v[72:75], v[156:159]
    v_pk_mul_f32 v[164:165], v[164:165], v[4:5] op_sel_hi:[1,0]
    v_pk_mul_f32 v[166:167], v[166:167], v[4:5] op_sel_hi:[1,0]
    v_mfma_f32_16x16x32_bf16 v[160:163], v[224:227], v[72:75], v[160:163]
    v_pk_mul_f32 v[168:169], v[168:169], v[4:5] op_sel_hi:[1,0]
    v_pk_mul_f32 v[170:171], v[170:171], v[4:5] op_sel_hi:[1,0]
    v_mfma_f32_16x16x32_bf16 v[164:167], v[228:231], v[72:75], v[164:167]
    v_pk_mul_f32 v[172:173], v[172:173], v[4:5] op_sel_hi:[1,0]
    v_pk_mul_f32 v[174:175], v[174:175], v[4:5] op_sel_hi:[1,0]
    v_mfma_f32_16x16x32_bf16 v[168:171], v[232:235], v[72:75], v[168:171]
    v_pk_mul_f32 v[176:177], v[176:177], v[4:5] op_sel_hi:[1,0]
    v_pk_mul_f32 v[178:179], v[178:179], v[4:5] op_sel_hi:[1,0]
    v_mfma_f32_16x16x32_bf16 v[172:175], v[236:239], v[72:75], v[172:175]
    v_pk_mul_f32 v[180:181], v[180:181], v[4:5] op_sel_hi:[1,0]
    v_pk_mul_f32 v[182:183], v[182:183], v[4:5] op_sel_hi:[1,0]
    v_mfma_f32_16x16x32_bf16 v[176:179], v[240:243], v[72:75], v[176:179]
    v_pk_mul_f32 v[184:185], v[184:185], v[4:5] op_sel_hi:[1,0]
    v_pk_mul_f32 v[186:187], v[186:187], v[4:5] op_sel_hi:[1,0]
    v_mfma_f32_16x16x32_bf16 v[180:183], v[244:247], v[72:75], v[180:183]
    v_pk_mul_f32 v[188:189], v[188:189], v[4:5] op_sel_hi:[1,0]
    v_pk_mul_f32 v[190:191], v[190:191], v[4:5] op_sel_hi:[1,0]
    v_mfma_f32_16x16x32_bf16 v[184:187], v[248:251], v[72:75], v[184:187]
    s_nop 0
    v_mfma_f32_16x16x32_bf16 v[188:191], v[252:255], v[72:75], v[188:191]
    v_fma_f32 v23, v23, v4, v64
    v_add_f32 v23, v23, v65
    v_add_f32 v23, v23, v66
    v_add_f32 v23, v23, v67
    v_add_f32 v23, v23, v68
    v_add_f32 v23, v23, v69
    v_add_f32 v23, v23, v70
    v_add_f32 v23, v23, v71
    s_add_u32 s27, s27, 1
    s_cmp_lt_u32 s27, 16
    s_cbranch_scc1 L_CT
    s_waitcnt vmcnt(0)
    s_barrier
    v_mov_b32 v4, v23
    s_nop 1
    v_permlane32_swap_b32 v23, v4
    v_add_f32 v23, v23, v4
    v_mov_b32 v4, v23
    s_nop 1
    v_permlane16_swap_b32 v23, v4
    v_add_f32 v23, v23, v4
    s_lshl_b32 s24, s3, 9
    v_lshl_add_u32 v3, v0, 3, s24
    ds_write_b64 v3, v[22:23] offset:0
    v_xor_b32 v3, 0x400, v3
    s_waitcnt lgkmcnt(0)
    s_barrier
    ds_read_b64 v[6:7], v3 offset:0
    s_waitcnt lgkmcnt(0)
    v_max_f32 v3, v22, v6
    v_sub_f32 v4, v22, v3
    v_sub_f32 v6, v6, v3
    v_exp_f32 v4, v4
    v_exp_f32 v6, v6
    v_mov_b32 v22, v3
    v_mul_f32 v23, v23, v4
    v_fmac_f32 v23, v7, v6
    v_and_b32 v3, 15, v0
    v_lshlrev_b32 v5, 3, v3
    s_lshl_b32 s24, s71, 2
    s_add_u32 s31, s24, s70
    s_lshl_b32 s24, s31, 8
    s_mul_i32 s25, s75, 128
    s_add_u32 s24, s24, s25
    s_add_u32 s24, s24, 0x120000
    s_cmp_lg_u32 s3, 0
    s_cbranch_scc1 L_C_ml
    s_mov_b64 exec, 0xffff
    buffer_store_dwordx2 v[22:23], v5, s[12:15], s24 offen sc1
    s_mov_b64 exec, -1
L_C_ml:
    v_pk_mul_f32 v[128:129], v[128:129], v[4:5] op_sel_hi:[1,0]
    v_pk_mul_f32 v[130:131], v[130:131], v[4:5] op_sel_hi:[1,0]
    v_pk_mul_f32 v[132:133], v[132:133], v[4:5] op_sel_hi:[1,0]
    v_pk_mul_f32 v[134:135], v[134:135], v[4:5] op_sel_hi:[1,0]
    v_pk_mul_f32 v[136:137], v[136:137], v[4:5] op_sel_hi:[1,0]
    v_pk_mul_f32 v[138:139], v[138:139], v[4:5] op_sel_hi:[1,0]
    v_pk_mul_f32 v[140:141], v[140:141], v[4:5] op_sel_hi:[1,0]
    v_pk_mul_f32 v[142:143], v[142:143], v[4:5] op_sel_hi:[1,0]
    v_pk_mul_f32 v[144:145], v[144:145], v[4:5] op_sel_hi:[1,0]
    v_pk_mul_f32 v[146:147], v[146:147], v[4:5] op_sel_hi:[1,0]
    v_pk_mul_f32 v[148:149], v[148:149], v[4:5] op_sel_hi:[1,0]
    v_pk_mul_f32 v[150:151], v[150:151], v[4:5] op_sel_hi:[1,0]
    v_pk_mul_f32 v[152:153], v[152:153], v[4:5] op_sel_hi:[1,0]
    v_pk_mul_f32 v[154:155], v[154:155], v[4:5] op_sel_hi:[1,0]
    v_pk_mul_f32 v[156:157], v[156:157], v[4:5] op_sel_hi:[1,0]
    v_pk_mul_f32 v[158:159], v[158:159], v[4:5] op_sel_hi:[1,0]
    v_pk_mul_f32 v[160:161], v[160:161], v[4:5] op_sel_hi:[1,0]
    v_pk_mul_f32 v[162:163], v[162:163], v[4:5] op_sel_hi:[1,0]
    v_pk_mul_f32 v[164:165], v[164:165], v[4:5] op_sel_hi:[1,0]
    v_pk_mul_f32 v[166:167], v[166:167], v[4:5] op_sel_hi:[1,0]
    v_pk_mul_f32 v[168:169], v[168:169], v[4:5] op_sel_hi:[1,0]
    v_pk_mul_f32 v[170:171], v[170:171], v[4:5] op_sel_hi:[1,0]
    v_pk_mul_f32 v[172:173], v[172:173], v[4:5] op_sel_hi:[1,0]
    v_pk_mul_f32 v[174:175], v[174:175], v[4:5] op_sel_hi:[1,0]
    v_pk_mul_f32 v[176:177], v[176:177], v[4:5] op_sel_hi:[1,0]
    v_pk_mul_f32 v[178:179], v[178:179], v[4:5] op_sel_hi:[1,0]
    v_pk_mul_f32 v[180:181], v[180:181], v[4:5] op_sel_hi:[1,0]
    v_pk_mul_f32 v[182:183], v[182:183], v[4:5] op_sel_hi:[1,0]
    v_pk_mul_f32 v[184:185], v[184:185], v[4:5] op_sel_hi:[1,0]
    v_pk_mul_f32 v[186:187], v[186:187], v[4:5] op_sel_hi:[1,0]
    v_pk_mul_f32 v[188:189], v[188:189], v[4:5] op_sel_hi:[1,0]
    v_pk_mul_f32 v[190:191], v[190:191], v[4:5] op_sel_hi:[1,0]
    s_lshl_b32 s24, s3, 13
    s_add_u32 s24, s24, 4096
    v_add_u32 v6, s24, v2
    s_xor_b32 s24, s3, 2
    s_lshl_b32 s24, s24, 13
    s_add_u32 s24, s24, 4096
    v_add_u32 v7, s24, v2
    s_cmp_lg_u32 s28, 0
    s_cbranch_scc1 L_C_x1
    ds_write_b128 v6, v[160:163] offset:0
    ds_write_b128 v6, v[164:167] offset:1024
    ds_write_b128 v6, v[168:171] offset:2048
    ds_write_b128 v6, v[172:175] offset:3072
    ds_write_b128 v6, v[176:179] offset:4096
    ds_write_b128 v6, v[180:183] offset:5120
    ds_write_b128 v6, v[184:187] offset:6144
    ds_write_b128 v6, v[188:191] offset:7168
    s_branch L_C_x2
L_C_x1:
    ds_write_b128 v6, v[128:131] offset:0
    ds_write_b128 v6, v[132:135] offset:1024
    ds_write_b128 v6, v[136:139] offset:2048
    ds_write_b128 v6, v[140:143] offset:3072
    ds_write_b128 v6, v[144:147] offset:4096
    ds_write_b128 v6, v[148:151] offset:5120
    ds_write_b128 v6, v[152:155] offset:6144
    ds_write_b128 v6, v[156:159] offset:7168
    s_waitcnt lgkmcnt(0)
    v_mov_b32 v128, v160
    v_mov_b32 v129, v161
    v_mov_b32 v130, v162
    v_mov_b32 v131, v163
    v_mov_b32 v132, v164
    v_mov_b32 v133, v165
    v_mov_b32 v134, v166
    v_mov_b32 v135, v167
    v_mov_b32 v136, v168
    v_mov_b32 v137, v169
    v_mov_b32 v138, v170
    v_mov_b32 v139, v171
    v_mov_b32 v140, v172
    v_mov_b32 v141, v173
    v_mov_b32 v142, v174
    v_mov_b32 v143, v175
    v_mov_b32 v144, v176
    v_mov_b32 v145, v177
    v_mov_b32 v146, v178
    v_mov_b32 v147, v179
    v_mov_b32 v148, v180
    v_mov_b32 v149, v181
    v_mov_b32 v150, v182
    v_mov_b32 v151, v183
    v_mov_b32 v152, v184
    v_mov_b32 v153, v185
    v_mov_b32 v154, v186
    v_mov_b32 v155, v187
    v_mov_b32 v156, v188
    v_mov_b32 v157, v189
    v_mov_b32 v158, v190
    v_mov_b32 v159, v191
L_C_x2:
    s_waitcnt lgkmcnt(0)
    s_barrier
    ds_read_b128 v[192:195], v7 offset:0
    ds_read_b128 v[196:199], v7 offset:1024
    ds_read_b128 v[200:203], v7 offset:2048
    ds_read_b128 v[204:207], v7 offset:3072
    ds_read_b128 v[208:211], v7 offset:4096
    ds_read_b128 v[212:215], v7 offset:5120
    ds_read_b128 v[216:219], v7 offset:6144
    ds_read_b128 v[220:223], v7 offset:7168
    v_lshrrev_b32 v4, 4, v0
    v_mul_u32_u24 v3, 272, v3
    v_lshl_add_u32 v3, v4, 3, v3
    s_mul_i32 s24, s3, 4352
    s_add_u32 s24, s24, 40960
    v_add_u32 v3, s24, v3
    s_waitcnt lgkmcnt(7)
    v_add_f32 v128, v128, v192
    v_add_f32 v129, v129, v193
    v_add_f32 v130, v130, v194
    v_add_f32 v131, v131, v195
    v_cvt_pk_bf16_f32 v32, v128, v129
    v_cvt_pk_bf16_f32 v33, v130, v131
    ds_write_b64 v3, v[32:33] offset:0
    s_waitcnt lgkmcnt(7)
    v_add_f32 v132, v132, v196
    v_add_f32 v133, v133, v197
    v_add_f32 v134, v134, v198
    v_add_f32 v135, v135, v199
    v_cvt_pk_bf16_f32 v34, v132, v133
    v_cvt_pk_bf16_f32 v35, v134, v135
    ds_write_b64 v3, v[34:35] offset:32
    s_waitcnt lgkmcnt(7)
    v_add_f32 v136, v136, v200
    v_add_f32 v137, v137, v201
    v_add_f32 v138, v138, v202
    v_add_f32 v139, v139, v203
    v_cvt_pk_bf16_f32 v36, v136, v137
    v_cvt_pk_bf16_f32 v37, v138, v139
    ds_write_b64 v3, v[36:37] offset:64
    s_waitcnt lgkmcnt(7)
    v_add_f32 v140, v140, v204
    v_add_f32 v141, v141, v205
    v_add_f32 v142, v142, v206
    v_add_f32 v143, v143, v207
    v_cvt_pk_bf16_f32 v38, v140, v141
    v_cvt_pk_bf16_f32 v39, v142, v143
    ds_write_b64 v3, v[38:39] offset:96
    s_waitcnt lgkmcnt(7)
    v_add_f32 v144, v144, v208
    v_add_f32 v145, v145, v209
    v_add_f32 v146, v146, v210
    v_add_f32 v147, v147, v211
    v_cvt_pk_bf16_f32 v40, v144, v145
    v_cvt_pk_bf16_f32 v41, v146, v147
    ds_write_b64 v3, v[40:41] offset:128
    s_waitcnt lgkmcnt(7)
    v_add_f32 v148, v148, v212
    v_add_f32 v149, v149, v213
    v_add_f32 v150, v150, v214
    v_add_f32 v151, v151, v215
    v_cvt_pk_bf16_f32 v42, v148, v149
    v_cvt_pk_bf16_f32 v43, v150, v151
    ds_write_b64 v3, v[42:43] offset:160
    s_waitcnt lgkmcnt(7)
    v_add_f32 v152, v152, v216
    v_add_f32 v153, v153, v217
    v_add_f32 v154, v154, v218
    v_add_f32 v155, v155, v219
    v_cvt_pk_bf16_f32 v44, v152, v153
    v_cvt_pk_bf16_f32 v45, v154, v155
    ds_write_b64 v3, v[44:45] offset:192
    s_waitcnt lgkmcnt(7)
    v_add_f32 v156, v156, v220
    v_add_f32 v157, v157, v221
    v_add_f32 v158, v158, v222
    v_add_f32 v159, v159, v223
    v_cvt_pk_bf16_f32 v46, v156, v157
    v_cvt_pk_bf16_f32 v47, v158, v159
    ds_write_b64 v3, v[46:47] offset:224
    v_and_b32 v5, 15, v0
    v_mul_u32_u24 v3, 272, v4
    v_lshl_add_u32 v3, v5, 4, v3
    v_add_u32 v3, s24, v3
    v_lshlrev_b32 v4, 10, v4
    v_lshl_add_u32 v4, v5, 4, v4
    s_waitcnt lgkmcnt(0)
    ds_read_b128 v[64:67], v3 offset:0
    ds_read_b128 v[68:71], v3 offset:1088
    ds_read_b128 v[72:75], v3 offset:2176
    ds_read_b128 v[76:79], v3 offset:3264
    s_lshl_b32 s24, s31, 15
    s_lshl_b32 s25, s29, 9
    s_add_u32 s24, s24, s25
    s_lshl_b32 s25, s28, 8
    s_add_u32 s24, s24, s25
    s_mul_i32 s25, s75, 16384
    s_add_u32 s24, s24, s25
    s_add_u32 s24, s24, 0x20000
    s_waitcnt lgkmcnt(3)
    buffer_store_dwordx4 v[64:67], v4, s[12:15], s24 offen sc1 nt
    s_add_u32 s24, s24, 4096
    s_waitcnt lgkmcnt(2)
    buffer_store_dwordx4 v[68:71], v4, s[12:15], s24 offen sc1 nt
    s_add_u32 s24, s24, 4096
    s_waitcnt lgkmcnt(1)
    buffer_store_dwordx4 v[72:75], v4, s[12:15], s24 offen sc1 nt
    s_add_u32 s24, s24, 4096
    s_waitcnt lgkmcnt(0)
    buffer_store_dwordx4 v[76:79], v4, s[12:15], s24 offen sc1 nt
    s_add_u32 s24, s24, 4096
    s_waitcnt vmcnt(0)
    s_barrier
    s_cmp_lg_u32 s3, 0
    s_cbranch_scc1 L_sig26
    s_mov_b64 exec, 1
    v_mov_b32 v3, 1
    buffer_atomic_add v3, off, s[16:19], 0 offset:4 sc0
    s_waitcnt vmcnt(0)
    v_readfirstlane_b32 s24, v3
    s_mov_b64 exec, -1
    s_and_b32 s24, s24, 31
    s_cmp_lg_u32 s24, 31
    s_cbranch_scc1 L_sig26
    v_lshlrev_b32 v4, 7, v0
    v_mov_b32 v3, 1
    s_mov_b32 s24, 0x170000
    s_mov_b32 exec_hi, 0
    buffer_store_dword v3, v4, s[12:15], s24 offen offset:4 sc1
    s_mov_b64 exec, -1
L_sig26:
    s_branch L_R
L_last:
    s_endpgm
.section .rodata,"a"
.p2align 6
.amdhsa_kernel concat_heads__compressed_kv_cla__mha_block_cached__decode_kernel
  .amdhsa_next_free_vgpr 448
  .amdhsa_next_free_sgpr 102
  .amdhsa_accum_offset 256
  .amdhsa_group_segment_fixed_size 0
  .amdhsa_kernarg_size 112
  .amdhsa_user_sgpr_count 2
  .amdhsa_user_sgpr_kernarg_segment_ptr 1
  .amdhsa_system_sgpr_workgroup_id_x 1
  .amdhsa_float_denorm_mode_32 3
.end_amdhsa_kernel
```

```asm
; @launch grid=(256,1,1) block=(256,1,1) lds=149504
.amdgcn_target "amdgcn-amd-amdhsa--gfx950"
.text
.globl concat_heads__compressed_kv_cla__mha_block_cached__decode_kernel
.p2align 8
.type concat_heads__compressed_kv_cla__mha_block_cached__decode_kernel,@function
concat_heads__compressed_kv_cla__mha_block_cached__decode_kernel:
    s_load_dwordx16 s[36:51], s[0:1], 0
    s_load_dwordx8 s[52:59], s[0:1], 64
    s_load_dwordx4 s[60:63], s[0:1], 96
    s_cmp_ge_u32 s2, 256
    s_cbranch_scc1 L_end
    s_cmp_lt_u32 s2, 64
    s_getpc_b64 s[24:25]
L_pc0:
    s_cselect_b32 s20, L_A-L_pc0, 0
    v_lshlrev_b32 v16, 7, v0
    v_min_u32 v16, L_A-L_pc0-4, v16
    v_add_u32 v16, s20, v16
    v_add_co_u32 v16, vcc, s24, v16
    v_mov_b32 v17, s25
    s_nop 0
    v_addc_co_u32 v17, vcc, 0, v17, vcc
    global_load_dword v17, v[16:17], off
    s_cbranch_scc1 L_A
L_B:
    s_and_b32 s70, s2, 6
    s_and_b32 s25, s2, 7
    s_add_u32 s70, s70, s25
    s_lshl_b32 s25, s70, 8
    v_and_b32 v6, 15, v0
    v_lshl_add_u32 v24, v6, 4, s25
    v_and_b32 v4, 16, v0
    v_lshl_add_u32 v24, v4, 5, v24
    v_lshrrev_b32 v4, 5, v0
    v_lshl_add_u32 v24, v4, 12, v24
    s_lshr_b32 s74, s2, 3
    s_lshl_b32 s74, s74, 2
    s_addk_i32 s74, -32
    s_mov_b32 s10, 0x400000
    s_mov_b32 s11, 0x20000
    s_waitcnt lgkmcnt(0)
    s_mov_b64 s[8:9], s[54:55]
L_pfb:
    s_lshl_b32 s24, s74, 13
    buffer_load_dwordx4 v[28:31], v24, s[8:11], s24 offen
    s_addk_i32 s74, 96
    s_cmpk_lt_u32 s74, 512
    s_cbranch_scc1 L_pfb
    s_addk_i32 s74, -512
    s_mov_b64 s[8:9], s[40:41]
L_pfq:
    s_lshl_b32 s24, s74, 13
    buffer_load_dwordx4 v[28:31], v24, s[8:11], s24 offen
    s_addk_i32 s74, 96
    s_cmpk_lt_u32 s74, 512
    s_cbranch_scc1 L_pfq
    s_addk_i32 s74, -512
    s_mov_b64 s[8:9], s[42:43]
L_pfk:
    s_lshl_b32 s24, s74, 13
    buffer_load_dwordx4 v[28:31], v24, s[8:11], s24 offen
    s_addk_i32 s74, 96
    s_cmpk_lt_u32 s74, 512
    s_cbranch_scc1 L_pfk
    s_addk_i32 s74, -512
    v_lshrrev_b32 v1, 6, v0
    v_and_b32 v0, 63, v0
    v_readfirstlane_b32 s3, v1
    v_lshlrev_b32 v2, 4, v0
    s_lshr_b32 s24, s2, 3
    s_sub_u32 s24, s24, 8
    s_mul_i32 s26, s24, 43
    s_lshr_b32 s26, s26, 8
    s_mul_i32 s27, s26, 6
    s_sub_u32 s27, s24, s27
    s_and_b32 s25, s26, 1
    s_lshl_b32 s25, s25, 1
    s_and_b32 s26, s26, 2
    s_lshl_b32 s26, s26, 3
    s_or_b32 s26, s26, s25
    s_or_b32 s26, s26, s70
    s_lshl_b32 s25, s70, 17
    s_lshl_b32 s24, s3, 8
    s_add_u32 s25, s25, s24
    v_lshl_add_u32 v25, v6, 4, s25
    v_and_b32 v4, 16, v0
    v_lshl_add_u32 v25, v4, 14, v25
    v_and_b32 v4, 32, v0
    v_lshl_add_u32 v25, v4, 16, v25
    s_and_b32 s25, s2, 3
    s_lshl_b32 s25, s25, 10
    s_lshl_b32 s24, s3, 12
    s_add_u32 s25, s25, s24
    s_bfe_u32 s24, s2, 0x10002
    s_lshl_b32 s24, s24, 23
    s_add_u32 s25, s25, s24
    v_add_u32 v26, s25, v2
    s_cmp_ge_u32 s27, 3
    s_cselect_b32 s28, 1, 0
    s_mul_i32 s29, s28, 3
    s_sub_u32 s29, s27, s29
    s_lshr_b32 s72, s3, 1
    s_lshl_b32 s24, s28, 1
    s_add_u32 s72, s72, s24
    s_and_b32 s31, s3, 1
    s_lshl_b32 s24, s29, 1
    s_add_u32 s31, s31, s24
    s_lshl_b32 s30, s72, 5
    s_add_u32 s30, s30, s26
    s_lshl_b32 s30, s30, 20
    v_lshrrev_b32 v3, 4, v0
    v_and_b32 v4, 3, v0
    v_lshlrev_b32 v5, 6, v3
    v_lshl_add_u32 v5, v4, 4, v5
    v_bfe_u32 v1, v0, 2, 2
    v_lshl_add_u32 v1, v1, 8, v5
    s_mul_i32 s35, s31, 1024
    s_add_u32 s32, s35, 983040
    s_mul_i32 s28, s31, 1024
    s_add_u32 s28, s28, 1044480
    s_mov_b32 s6, 0x100000
    s_mov_b32 s7, 0x20000
    s_add_u32 s4, s50, s30
    s_addc_u32 s5, s51, 0
    s_mov_b32 s12, s62
    s_mov_b32 s13, s63
    s_mov_b32 s14, 0x400000
    s_mov_b32 s15, 0x20000
    s_mov_b32 s16, s60
    s_mov_b32 s17, s61
    s_mov_b32 s18, 0x100
    s_mov_b32 s19, 0x20000
    v_and_b32 v3, 1, v0
    v_lshlrev_b32 v3, 4, v3
    v_mov_b32 v4, 0xffff
    v_lshlrev_b32 v4, v3, v4
    v_bfe_u32 v3, v0, 1, 2
    v_cmp_eq_u32 vcc, 0, v3
    s_nop 1
    v_cndmask_b32 v20, 0, v4, vcc
    v_cmp_eq_u32 vcc, 1, v3
    s_nop 1
    v_cndmask_b32 v21, 0, v4, vcc
    v_cmp_eq_u32 vcc, 2, v3
    s_nop 1
    v_cndmask_b32 v22, 0, v4, vcc
    v_cmp_eq_u32 vcc, 3, v3
    s_nop 1
    v_cndmask_b32 v23, 0, v4, vcc
    s_mov_b32 s64, 0x22222222
    s_mov_b32 s65, 0x22222222
    s_mov_b32 s66, 0x44444444
    s_mov_b32 s67, 0x44444444
    s_mov_b32 s68, 0x88888888
    s_mov_b32 s69, 0x88888888
    v_mov_b32 v32, 0
    v_mov_b32 v33, 0
    v_mov_b32 v34, 0
    v_mov_b32 v35, 0
    v_mov_b32 v36, 0
    v_mov_b32 v37, 0
    v_mov_b32 v38, 0
    v_mov_b32 v39, 0
    v_mov_b32 v40, 0
    v_mov_b32 v41, 0
    v_mov_b32 v42, 0
    v_mov_b32 v43, 0
    v_mov_b32 v44, 0
    v_mov_b32 v45, 0
    v_mov_b32 v46, 0
    v_mov_b32 v47, 0
    v_lshrrev_b32 v3, 4, v0
    v_lshlrev_b32 v60, 6, v3
    v_and_b32 v4, 7, v0
    v_lshl_add_u32 v60, v4, 3, v60
    s_lshl_b32 s33, s26, 2
    s_add_u32 s33, s33, s72
    s_lshl_b32 s34, s33, 8
    s_add_u32 s34, s34, 0x164000
    s_mul_i32 s73, s33, 6
    s_add_u32 s73, s73, s31
    s_lshl_b32 s73, s73, 8
    s_add_u32 s73, s73, 0x180000
    s_mov_b64 s[8:9], s[56:57]
L_pfo:
    s_lshl_b32 s24, s74, 8
    s_waitcnt vmcnt(6)
    buffer_load_dwordx4 v[28:31], v25, s[8:11], s24 offen
    s_addk_i32 s74, 96
    s_cmpk_lt_u32 s74, 512
    s_cbranch_scc1 L_pfo
    s_addk_i32 s74, -512
    s_mov_b64 s[8:9], s[44:45]
L_pfu:
    s_lshl_b32 s24, s74, 13
    s_waitcnt vmcnt(6)
    buffer_load_dwordx4 v[28:31], v24, s[8:11], s24 offen
    s_addk_i32 s74, 96
    s_cmpk_lt_u32 s74, 512
    s_cbranch_scc1 L_pfu
    s_addk_i32 s74, -512
    s_mov_b64 s[8:9], s[46:47]
L_pfv:
    s_lshl_b32 s24, s74, 8
    s_waitcnt vmcnt(6)
    buffer_load_dwordx4 v[28:31], v25, s[8:11], s24 offen
    s_addk_i32 s74, 96
    s_cmpk_lt_u32 s74, 512
    s_cbranch_scc1 L_pfv
    s_addk_i32 s74, -512
    s_mov_b64 s[8:9], s[38:39]
    s_mov_b32 s10, 0x1000000
L_pfc:
    s_lshl_b32 s24, s74, 12
    s_waitcnt vmcnt(6)
    buffer_load_dwordx4 v[28:31], v26, s[8:11], s24 offen
    s_addk_i32 s74, 96
    s_cmpk_lt_u32 s74, 2048
    s_cbranch_scc1 L_pfc
    s_addk_i32 s74, -2048
    s_mov_b32 s10, 0x400000
    s_waitcnt vmcnt(15)
    buffer_load_dwordx4 a[0:3], v1, s[4:7], s32 offen offset:0 nt
    s_add_u32 s32, s32, 6144
    s_waitcnt vmcnt(15)
    buffer_load_dwordx4 a[4:7], v1, s[4:7], s32 offen offset:0 nt
    s_add_u32 s32, s32, 6144
    s_waitcnt vmcnt(15)
    buffer_load_dwordx4 a[8:11], v1, s[4:7], s32 offen offset:0 nt
    s_add_u32 s32, s32, 6144
    s_waitcnt vmcnt(15)
    buffer_load_dwordx4 a[12:15], v1, s[4:7], s32 offen offset:0 nt
    s_add_u32 s32, s32, 6144
    s_waitcnt vmcnt(15)
    buffer_load_dwordx4 a[16:19], v1, s[4:7], s32 offen offset:0 nt
    s_add_u32 s32, s32, 6144
    s_waitcnt vmcnt(15)
    buffer_load_dwordx4 a[20:23], v1, s[4:7], s32 offen offset:0 nt
    s_add_u32 s32, s32, 6144
    s_waitcnt vmcnt(15)
    buffer_load_dwordx4 a[24:27], v1, s[4:7], s32 offen offset:0 nt
    s_add_u32 s32, s32, 6144
    s_waitcnt vmcnt(15)
    buffer_load_dwordx4 a[28:31], v1, s[4:7], s32 offen offset:0 nt
    s_add_u32 s32, s32, 6144
    s_waitcnt vmcnt(15)
    buffer_load_dwordx4 a[32:35], v1, s[4:7], s32 offen offset:0 nt
    s_add_u32 s32, s32, 6144
    s_waitcnt vmcnt(15)
    buffer_load_dwordx4 a[36:39], v1, s[4:7], s32 offen offset:0 nt
    s_add_u32 s32, s32, 6144
    s_waitcnt vmcnt(15)
    buffer_load_dwordx4 a[40:43], v1, s[4:7], s28 offen offset:0 nt
    s_waitcnt vmcnt(15)
    s_mov_b32 s32, s35
    buffer_load_dwordx4 a[64:67], v1, s[4:7], s32 offen offset:0 nt
    s_add_u32 s32, s32, 6144
    s_waitcnt vmcnt(15)
    buffer_load_dwordx4 a[68:71], v1, s[4:7], s32 offen offset:0 nt
    s_add_u32 s32, s32, 6144
    s_waitcnt vmcnt(15)
    buffer_load_dwordx4 a[72:75], v1, s[4:7], s32 offen offset:0 nt
    s_add_u32 s32, s32, 6144
    s_waitcnt vmcnt(15)
    buffer_load_dwordx4 a[76:79], v1, s[4:7], s32 offen offset:0 nt
    s_add_u32 s32, s32, 6144
    s_waitcnt vmcnt(15)
    buffer_load_dwordx4 a[80:83], v1, s[4:7], s32 offen offset:0 nt
    s_add_u32 s32, s32, 6144
    s_mov_b64 exec, 1
    buffer_load_dword v61, off, s[16:19], 0 offset:128 sc1
    s_mov_b64 exec, -1
    s_waitcnt vmcnt(15)
    buffer_load_dwordx4 a[84:87], v1, s[4:7], s32 offen offset:0 nt
    s_add_u32 s32, s32, 6144
    s_waitcnt vmcnt(15)
    buffer_load_dwordx4 a[88:91], v1, s[4:7], s32 offen offset:0 nt
    s_add_u32 s32, s32, 6144
    s_waitcnt vmcnt(15)
    buffer_load_dwordx4 a[92:95], v1, s[4:7], s32 offen offset:0 nt
    s_add_u32 s32, s32, 6144
    s_waitcnt vmcnt(15)
    buffer_load_dwordx4 a[96:99], v1, s[4:7], s32 offen offset:0 nt
    s_add_u32 s32, s32, 6144
    s_waitcnt vmcnt(15)
    buffer_load_dwordx4 a[100:103], v1, s[4:7], s32 offen offset:0 nt
    s_add_u32 s32, s32, 6144
    s_waitcnt vmcnt(15)
    buffer_load_dwordx4 a[104:107], v1, s[4:7], s32 offen offset:0 nt
    s_add_u32 s32, s32, 6144
    s_waitcnt vmcnt(15)
    buffer_load_dwordx4 a[108:111], v1, s[4:7], s32 offen offset:0 nt
    s_add_u32 s32, s32, 6144
    s_waitcnt vmcnt(15)
    buffer_load_dwordx4 a[112:115], v1, s[4:7], s32 offen offset:0 nt
    s_add_u32 s32, s32, 6144
    s_waitcnt vmcnt(15)
    buffer_load_dwordx4 a[116:119], v1, s[4:7], s32 offen offset:0 nt
    s_add_u32 s32, s32, 6144
    s_waitcnt vmcnt(15)
    buffer_load_dwordx4 a[120:123], v1, s[4:7], s32 offen offset:0 nt
    s_add_u32 s32, s32, 6144
    s_waitcnt vmcnt(15)
    buffer_load_dwordx4 a[124:127], v1, s[4:7], s32 offen offset:0 nt
    s_add_u32 s32, s32, 6144
    s_waitcnt vmcnt(15)
    buffer_load_dwordx4 v[64:67], v1, s[4:7], s32 offen offset:0 nt
    s_add_u32 s32, s32, 6144
    s_waitcnt vmcnt(12)
    v_readfirstlane_b32 s25, v61
    s_nop 0
    s_cmp_ge_u32 s25, 32
    s_cbranch_scc1 L_B_q
    s_mov_b32 s24, 262144
    s_mov_b64 exec, 1
L_aw1:
    buffer_load_dword v61, off, s[16:19], 0 offset:128 sc1
    s_waitcnt vmcnt(0)
    v_readfirstlane_b32 s25, v61
    s_nop 0
    s_cmp_ge_u32 s25, 32
    s_cbranch_scc1 L_B_q
    s_sleep 16
    s_sub_u32 s24, s24, 1
    s_cmp_lg_u32 s24, 0
    s_cbranch_scc1 L_aw1
L_B_q:
    s_mov_b64 exec, -1
    buffer_load_dwordx4 v[8:11], v5, s[12:15], s34 offen sc1
    s_waitcnt vmcnt(15)
    buffer_load_dwordx4 v[68:71], v1, s[4:7], s32 offen offset:0 nt
    s_add_u32 s32, s32, 6144
    s_waitcnt vmcnt(15)
    buffer_load_dwordx4 v[72:75], v1, s[4:7], s32 offen offset:0 nt
    s_add_u32 s32, s32, 6144
    s_waitcnt vmcnt(15)
    buffer_load_dwordx4 v[76:79], v1, s[4:7], s32 offen offset:0 nt
    s_add_u32 s32, s32, 6144
    s_waitcnt vmcnt(15)
    buffer_load_dwordx4 v[80:83], v1, s[4:7], s32 offen offset:0 nt
    s_add_u32 s32, s32, 6144
    s_waitcnt vmcnt(15)
    buffer_load_dwordx4 v[84:87], v1, s[4:7], s32 offen offset:0 nt
    s_add_u32 s32, s32, 6144
    s_waitcnt vmcnt(15)
    buffer_load_dwordx4 v[88:91], v1, s[4:7], s32 offen offset:0 nt
    s_add_u32 s32, s32, 6144
    s_waitcnt vmcnt(15)
    buffer_load_dwordx4 v[92:95], v1, s[4:7], s32 offen offset:0 nt
    s_add_u32 s32, s32, 6144
    s_waitcnt vmcnt(15)
    buffer_load_dwordx4 v[96:99], v1, s[4:7], s32 offen offset:0 nt
    s_add_u32 s32, s32, 6144
    s_waitcnt vmcnt(15)
    buffer_load_dwordx4 v[100:103], v1, s[4:7], s32 offen offset:0 nt
    s_add_u32 s32, s32, 6144
    s_waitcnt vmcnt(15)
    buffer_load_dwordx4 v[104:107], v1, s[4:7], s32 offen offset:0 nt
    s_add_u32 s32, s32, 6144
    s_waitcnt vmcnt(15)
    buffer_load_dwordx4 v[108:111], v1, s[4:7], s32 offen offset:0 nt
    s_add_u32 s32, s32, 6144
    s_waitcnt vmcnt(15)
    buffer_load_dwordx4 v[112:115], v1, s[4:7], s32 offen offset:0 nt
    s_add_u32 s32, s32, 6144
    s_waitcnt vmcnt(15)
    buffer_load_dwordx4 v[116:119], v1, s[4:7], s32 offen offset:0 nt
    s_add_u32 s32, s32, 6144
    s_waitcnt vmcnt(15)
    buffer_load_dwordx4 v[120:123], v1, s[4:7], s32 offen offset:0 nt
    s_add_u32 s32, s32, 6144
    s_waitcnt vmcnt(15)
    buffer_load_dwordx4 v[124:127], v1, s[4:7], s32 offen offset:0 nt
    s_add_u32 s32, s32, 6144
    s_waitcnt vmcnt(15)
    v_mov_b32_dpp v32, v8 quad_perm:[0,1,2,3] row_mask:0xf bank_mask:0x1
    v_mov_b32_dpp v33, v9 quad_perm:[0,1,2,3] row_mask:0xf bank_mask:0x1
    v_mov_b32_dpp v34, v10 quad_perm:[0,1,2,3] row_mask:0xf bank_mask:0x1
    v_mov_b32_dpp v35, v11 quad_perm:[0,1,2,3] row_mask:0xf bank_mask:0x1
    v_mov_b32_dpp v36, v8 quad_perm:[0,1,2,3] row_mask:0xf bank_mask:0x2
    v_mov_b32_dpp v37, v9 quad_perm:[0,1,2,3] row_mask:0xf bank_mask:0x2
    v_mov_b32_dpp v38, v10 quad_perm:[0,1,2,3] row_mask:0xf bank_mask:0x2
    v_mov_b32_dpp v39, v11 quad_perm:[0,1,2,3] row_mask:0xf bank_mask:0x2
    v_mov_b32_dpp v40, v8 quad_perm:[0,1,2,3] row_mask:0xf bank_mask:0x4
    v_mov_b32_dpp v41, v9 quad_perm:[0,1,2,3] row_mask:0xf bank_mask:0x4
    v_mov_b32_dpp v42, v10 quad_perm:[0,1,2,3] row_mask:0xf bank_mask:0x4
    v_mov_b32_dpp v43, v11 quad_perm:[0,1,2,3] row_mask:0xf bank_mask:0x4
    v_mov_b32_dpp v44, v8 quad_perm:[0,1,2,3] row_mask:0xf bank_mask:0x8
    v_mov_b32_dpp v45, v9 quad_perm:[0,1,2,3] row_mask:0xf bank_mask:0x8
    v_mov_b32_dpp v46, v10 quad_perm:[0,1,2,3] row_mask:0xf bank_mask:0x8
    v_mov_b32_dpp v47, v11 quad_perm:[0,1,2,3] row_mask:0xf bank_mask:0x8
    s_mov_b32 s27, 1
L_BK:
    s_cmp_lg_u32 s27, 9
    s_cbranch_scc1 L_BK_a
    s_add_u32 s4, s52, s30
    s_addc_u32 s5, s53, 0
    s_mov_b32 s32, s35
    v_mov_b32 v1, v2
L_BK_a:
    s_barrier
    s_cmp_lg_u32 s27, 7
    s_cbranch_scc1 L_BK_x0
    s_and_b32 s24, s2, 7
    s_lshl_b32 s24, s24, 7
    s_add_u32 s24, s24, 0x1b6000
    v_and_b32 v63, 7, v0
    v_lshlrev_b32 v63, 2, v63
    buffer_load_dword v62, v63, s[12:15], s24 offen sc1
L_BK_x0:
    s_cmp_lg_u32 s27, 8
    s_cbranch_scc1 L_BK_x1
    s_getreg_b32 s24, hwreg(HW_REG_XCC_ID, 0, 4)
    v_cmp_ne_u32 vcc, s24, v62
    s_nop 0
    s_or_b32 s75, vcc_lo, vcc_hi
    v_mov_b32 v28, -1
    v_mov_b32 v29, -1
    v_mov_b32 v30, -1
    v_mov_b32 v31, -1
    s_mov_b64 exec, 0xffff
    s_cbranch_scc1 L_far2
    buffer_store_dwordx4 v[28:31], v2, s[12:15], s73 offen
    s_branch L_near2
L_far2:
    buffer_store_dwordx4 v[28:31], v2, s[12:15], s73 offen sc1
L_near2:
    s_mov_b64 exec, -1
L_BK_x1:
    v_mov_b32 v49, v50
    v_mov_b32 v50, v51
    v_mov_b32 v51, v52
    v_mov_b32 v52, v53
    v_mov_b32 v53, v54
    v_mov_b32 v54, v55
    v_mov_b32 v55, v56
    v_mov_b32 v56, v57
    s_waitcnt vmcnt(15)
    v_mfma_f32_16x16x32_bf16 v[12:15], v[64:67], v[32:35], 0
    buffer_load_dwordx4 v[64:67], v1, s[4:7], s32 offen offset:0 nt
    s_add_u32 s32, s32, 6144
    s_waitcnt vmcnt(15)
    v_mfma_f32_16x16x32_bf16 v[12:15], v[68:71], v[36:39], v[12:15]
    buffer_load_dwordx4 v[68:71], v1, s[4:7], s32 offen offset:0 nt
    s_add_u32 s32, s32, 6144
    s_waitcnt vmcnt(15)
    v_mfma_f32_16x16x32_bf16 v[12:15], v[72:75], v[40:43], v[12:15]
    buffer_load_dwordx4 v[72:75], v1, s[4:7], s32 offen offset:0 nt
    s_add_u32 s32, s32, 6144
    s_waitcnt vmcnt(15)
    v_mfma_f32_16x16x32_bf16 v[12:15], v[76:79], v[44:47], v[12:15]
    buffer_load_dwordx4 v[76:79], v1, s[4:7], s32 offen offset:0 nt
    s_add_u32 s32, s32, 6144
    s_nop 5
    v_add_f32_dpp v57, v13, v12 quad_perm:[1,1,1,1] row_mask:0xf bank_mask:0xf
    s_nop 1
    v_add_f32_dpp v57, v14, v57 quad_perm:[2,2,2,2] row_mask:0xf bank_mask:0xf
    s_nop 1
    v_add_f32_dpp v57, v15, v57 quad_perm:[3,3,3,3] row_mask:0xf bank_mask:0xf
    s_waitcnt vmcnt(15)
    v_mfma_f32_16x16x32_bf16 v[16:19], v[80:83], v[32:35], 0
    buffer_load_dwordx4 v[80:83], v1, s[4:7], s32 offen offset:0 nt
    s_add_u32 s32, s32, 6144
    s_waitcnt vmcnt(15)
    v_mfma_f32_16x16x32_bf16 v[16:19], v[84:87], v[36:39], v[16:19]
    buffer_load_dwordx4 v[84:87], v1, s[4:7], s32 offen offset:0 nt
    s_add_u32 s32, s32, 6144
    s_waitcnt vmcnt(15)
    v_mfma_f32_16x16x32_bf16 v[16:19], v[88:91], v[40:43], v[16:19]
    buffer_load_dwordx4 v[88:91], v1, s[4:7], s32 offen offset:0 nt
    s_add_u32 s32, s32, 6144
    s_waitcnt vmcnt(15)
    v_mfma_f32_16x16x32_bf16 v[16:19], v[92:95], v[44:47], v[16:19]
    buffer_load_dwordx4 v[92:95], v1, s[4:7], s32 offen offset:0 nt
    s_add_u32 s32, s32, 6144
    s_nop 5
    v_add_f32_dpp v3, v16, v17 quad_perm:[0,0,0,0] row_mask:0xf bank_mask:0xf
    s_nop 1
    v_add_f32_dpp v3, v18, v3 quad_perm:[2,2,2,2] row_mask:0xf bank_mask:0xf
    s_nop 1
    v_add_f32_dpp v3, v19, v3 quad_perm:[3,3,3,3] row_mask:0xf bank_mask:0xf
    v_cndmask_b32 v57, v57, v3, s[64:65]
    s_waitcnt vmcnt(15)
    v_mfma_f32_16x16x32_bf16 v[12:15], v[96:99], v[32:35], 0
    buffer_load_dwordx4 v[96:99], v1, s[4:7], s32 offen offset:0 nt
    s_add_u32 s32, s32, 6144
    s_waitcnt vmcnt(15)
    v_mfma_f32_16x16x32_bf16 v[12:15], v[100:103], v[36:39], v[12:15]
    buffer_load_dwordx4 v[100:103], v1, s[4:7], s32 offen offset:0 nt
    s_add_u32 s32, s32, 6144
    s_waitcnt vmcnt(15)
    v_mfma_f32_16x16x32_bf16 v[12:15], v[104:107], v[40:43], v[12:15]
    buffer_load_dwordx4 v[104:107], v1, s[4:7], s32 offen offset:0 nt
    s_add_u32 s32, s32, 6144
    s_waitcnt vmcnt(15)
    v_mfma_f32_16x16x32_bf16 v[12:15], v[108:111], v[44:47], v[12:15]
    buffer_load_dwordx4 v[108:111], v1, s[4:7], s32 offen offset:0 nt
    s_add_u32 s32, s32, 6144
    s_nop 5
    v_add_f32_dpp v3, v12, v14 quad_perm:[0,0,0,0] row_mask:0xf bank_mask:0xf
    s_nop 1
    v_add_f32_dpp v3, v13, v3 quad_perm:[1,1,1,1] row_mask:0xf bank_mask:0xf
    s_nop 1
    v_add_f32_dpp v3, v15, v3 quad_perm:[3,3,3,3] row_mask:0xf bank_mask:0xf
    v_cndmask_b32 v57, v57, v3, s[66:67]
    s_waitcnt vmcnt(15)
    v_mfma_f32_16x16x32_bf16 v[16:19], v[112:115], v[32:35], 0
    buffer_load_dwordx4 v[112:115], v1, s[4:7], s32 offen offset:0 nt
    s_add_u32 s32, s32, 6144
    s_waitcnt vmcnt(15)
    v_mfma_f32_16x16x32_bf16 v[16:19], v[116:119], v[36:39], v[16:19]
    buffer_load_dwordx4 v[116:119], v1, s[4:7], s32 offen offset:0 nt
    s_add_u32 s32, s32, 6144
    s_waitcnt vmcnt(15)
    v_mfma_f32_16x16x32_bf16 v[16:19], v[120:123], v[40:43], v[16:19]
    buffer_load_dwordx4 v[120:123], v1, s[4:7], s32 offen offset:0 nt
    s_add_u32 s32, s32, 6144
    s_waitcnt vmcnt(15)
    v_mfma_f32_16x16x32_bf16 v[16:19], v[124:127], v[44:47], v[16:19]
    buffer_load_dwordx4 v[124:127], v1, s[4:7], s32 offen offset:0 nt
    s_add_u32 s32, s32, 6144
    s_nop 5
    v_add_f32_dpp v3, v16, v19 quad_perm:[0,0,0,0] row_mask:0xf bank_mask:0xf
    s_nop 1
    v_add_f32_dpp v3, v17, v3 quad_perm:[1,1,1,1] row_mask:0xf bank_mask:0xf
    s_nop 1
    v_add_f32_dpp v3, v18, v3 quad_perm:[2,2,2,2] row_mask:0xf bank_mask:0xf
    v_cndmask_b32 v57, v57, v3, s[68:69]
    s_cmp_lg_u32 s27, 3
    s_cbranch_scc1 L_BK_c0
    v_mfma_f32_16x16x32_bf16 v[12:15], a[64:67], v[32:35], 0
    v_mfma_f32_16x16x32_bf16 v[12:15], a[68:71], v[36:39], v[12:15]
    v_mfma_f32_16x16x32_bf16 v[12:15], a[72:75], v[40:43], v[12:15]
    v_mfma_f32_16x16x32_bf16 v[12:15], a[76:79], v[44:47], v[12:15]
    s_nop 7
    v_add_f32_dpp v48, v13, v12 quad_perm:[1,1,1,1] row_mask:0xf bank_mask:0xf
    s_nop 1
    v_add_f32_dpp v48, v14, v48 quad_perm:[2,2,2,2] row_mask:0xf bank_mask:0xf
    s_nop 1
    v_add_f32_dpp v48, v15, v48 quad_perm:[3,3,3,3] row_mask:0xf bank_mask:0xf
    v_mfma_f32_16x16x32_bf16 v[16:19], a[80:83], v[32:35], 0
    v_mfma_f32_16x16x32_bf16 v[16:19], a[84:87], v[36:39], v[16:19]
    v_mfma_f32_16x16x32_bf16 v[16:19], a[88:91], v[40:43], v[16:19]
    v_mfma_f32_16x16x32_bf16 v[16:19], a[92:95], v[44:47], v[16:19]
    s_nop 7
    v_add_f32_dpp v3, v16, v17 quad_perm:[0,0,0,0] row_mask:0xf bank_mask:0xf
    s_nop 1
    v_add_f32_dpp v3, v18, v3 quad_perm:[2,2,2,2] row_mask:0xf bank_mask:0xf
    s_nop 1
    v_add_f32_dpp v3, v19, v3 quad_perm:[3,3,3,3] row_mask:0xf bank_mask:0xf
    v_cndmask_b32 v48, v48, v3, s[64:65]
    v_mfma_f32_16x16x32_bf16 v[12:15], a[96:99], v[32:35], 0
    v_mfma_f32_16x16x32_bf16 v[12:15], a[100:103], v[36:39], v[12:15]
    v_mfma_f32_16x16x32_bf16 v[12:15], a[104:107], v[40:43], v[12:15]
    v_mfma_f32_16x16x32_bf16 v[12:15], a[108:111], v[44:47], v[12:15]
    s_nop 7
    v_add_f32_dpp v3, v12, v14 quad_perm:[0,0,0,0] row_mask:0xf bank_mask:0xf
    s_nop 1
    v_add_f32_dpp v3, v13, v3 quad_perm:[1,1,1,1] row_mask:0xf bank_mask:0xf
    s_nop 1
    v_add_f32_dpp v3, v15, v3 quad_perm:[3,3,3,3] row_mask:0xf bank_mask:0xf
    v_cndmask_b32 v48, v48, v3, s[66:67]
    v_mfma_f32_16x16x32_bf16 v[16:19], a[112:115], v[32:35], 0
    v_mfma_f32_16x16x32_bf16 v[16:19], a[116:119], v[36:39], v[16:19]
    v_mfma_f32_16x16x32_bf16 v[16:19], a[120:123], v[40:43], v[16:19]
    v_mfma_f32_16x16x32_bf16 v[16:19], a[124:127], v[44:47], v[16:19]
    s_nop 7
    v_add_f32_dpp v3, v16, v19 quad_perm:[0,0,0,0] row_mask:0xf bank_mask:0xf
    s_nop 1
    v_add_f32_dpp v3, v17, v3 quad_perm:[1,1,1,1] row_mask:0xf bank_mask:0xf
    s_nop 1
    v_add_f32_dpp v3, v18, v3 quad_perm:[2,2,2,2] row_mask:0xf bank_mask:0xf
    v_cndmask_b32 v48, v48, v3, s[68:69]
L_BK_c0:
    s_cmp_lg_u32 s27, 2
    s_cbranch_scc1 L_BK_b
    v_mfma_f32_16x16x32_bf16 v[12:15], a[0:3], v[32:35], 0
    v_mfma_f32_16x16x32_bf16 v[12:15], a[4:7], v[36:39], v[12:15]
    v_mfma_f32_16x16x32_bf16 v[12:15], a[8:11], v[40:43], v[12:15]
    v_mfma_f32_16x16x32_bf16 v[12:15], a[12:15], v[44:47], v[12:15]
    s_nop 7
    v_add_f32_dpp v58, v13, v12 quad_perm:[1,1,1,1] row_mask:0xf bank_mask:0xf
    s_nop 1
    v_add_f32_dpp v58, v14, v58 quad_perm:[2,2,2,2] row_mask:0xf bank_mask:0xf
    s_nop 1
    v_add_f32_dpp v58, v15, v58 quad_perm:[3,3,3,3] row_mask:0xf bank_mask:0xf
    v_mfma_f32_16x16x32_bf16 v[16:19], a[16:19], v[32:35], 0
    v_mfma_f32_16x16x32_bf16 v[16:19], a[20:23], v[36:39], v[16:19]
    v_mfma_f32_16x16x32_bf16 v[16:19], a[24:27], v[40:43], v[16:19]
    v_mfma_f32_16x16x32_bf16 v[16:19], a[28:31], v[44:47], v[16:19]
    s_nop 7
    v_add_f32_dpp v3, v16, v17 quad_perm:[0,0,0,0] row_mask:0xf bank_mask:0xf
    s_nop 1
    v_add_f32_dpp v3, v18, v3 quad_perm:[2,2,2,2] row_mask:0xf bank_mask:0xf
    s_nop 1
    v_add_f32_dpp v3, v19, v3 quad_perm:[3,3,3,3] row_mask:0xf bank_mask:0xf
    v_cndmask_b32 v58, v58, v3, s[64:65]
    v_mfma_f32_16x16x32_bf16 v[12:15], a[32:35], v[32:35], 0
    v_mfma_f32_16x16x32_bf16 v[12:15], a[36:39], v[36:39], v[12:15]
    v_mfma_f32_16x16x32_bf16 v[12:15], a[40:43], v[40:43], v[12:15]
    s_nop 7
    v_add_f32_dpp v3, v12, v14 quad_perm:[0,0,0,0] row_mask:0xf bank_mask:0xf
    s_nop 1
    v_add_f32_dpp v3, v13, v3 quad_perm:[1,1,1,1] row_mask:0xf bank_mask:0xf
    s_nop 1
    v_add_f32_dpp v3, v15, v3 quad_perm:[3,3,3,3] row_mask:0xf bank_mask:0xf
    v_cndmask_b32 v58, v58, v3, s[66:67]
    s_mul_i32 s24, s31, 1
    s_sub_i32 s24, 4, s24
    s_max_i32 s24, s24, 0
    s_min_i32 s24, s24, 1
    s_add_u32 s24, s24, 10
    v_and_b32 v3, 3, v0
    v_bfe_u32 v4, v0, 2, 2
    v_lshl_add_u32 v3, v3, 2, v4
    v_mov_b32 v4, 0xff800000
    v_cmp_gt_u32 vcc, s24, v3
    s_nop 1
    v_cndmask_b32 v58, v4, v58, vcc
    v_mov_b32 v61, 0x3e0293ee
    v_mov_b32 v7, 0
    s_lshl_b32 s34, s2, 7
    s_add_u32 s34, s34, 0x1ae000
L_BK_b:
    s_add_u32 s27, s27, 1
    s_cmp_lt_u32 s27, 10
    s_cbranch_scc1 L_BK
    v_max3_f32 v3, v48, v49, v50
    v_max3_f32 v3, v3, v51, v52
    v_max3_f32 v3, v3, v53, v54
    v_max3_f32 v3, v3, v55, v56
    v_max3_f32 v3, v3, v57, v58
    s_nop 1
    v_max_f32_dpp v3, v3, v3 row_ror:8 row_mask:0xf bank_mask:0xf
    s_nop 1
    v_max_f32_dpp v3, v3, v3 row_ror:4 row_mask:0xf bank_mask:0xf
    s_nop 1
    v_max_f32_dpp v3, v3, v3 row_ror:2 row_mask:0xf bank_mask:0xf
    s_nop 1
    v_max_f32_dpp v3, v3, v3 row_ror:1 row_mask:0xf bank_mask:0xf
    s_nop 1
    v_max_f32_dpp v3, v3, v3 row_bcast:15 row_mask:0xa bank_mask:0xf
    s_nop 1
    v_max_f32_dpp v3, v3, v3 row_bcast:31 row_mask:0xc bank_mask:0xf
    s_nop 0
    v_readlane_b32 s24, v3, 63
    s_nop 1
    v_mul_f32 v6, s24, v61
    v_mov_b32 v12, 0
    v_mov_b32 v13, 0
    v_mov_b32 v14, 0
    v_mov_b32 v15, 0
    v_fma_f32 v48, v48, v61, -v6
    v_exp_f32 v48, v48
    s_nop 0
    v_add_f32 v7, v7, v48
    v_cvt_pk_bf16_f32 v48, v48, v48
    s_mov_b32 s27, 0
L_BV:
    s_barrier
    s_cmp_ge_u32 s27, 1
    s_cselect_b32 s71, s3, 4
    s_cmp_lg_u32 s71, 0
    s_cbranch_scc1 L_BV_p0
    s_lshl_b32 s24, s27, 2
    s_add_u32 s24, s24, 0
    s_mov_b64 exec, 1
    v_mov_b32 v63, s24
    s_cmp_lg_u32 s75, 0
    s_cbranch_scc1 L_far3
    buffer_store_dword v63, off, s[12:15], s34 offset:64
    s_branch L_near3
L_far3:
    buffer_store_dword v63, off, s[12:15], s34 offset:64 sc1
L_near3:
    s_mov_b64 exec, -1
L_BV_p0:
    v_and_b32_dpp v8, v48, v20 row_newbcast:0 row_mask:0xf bank_mask:0xf
    v_and_b32_dpp v9, v48, v21 row_newbcast:0 row_mask:0xf bank_mask:0xf
    v_and_b32_dpp v10, v48, v22 row_newbcast:0 row_mask:0xf bank_mask:0xf
    v_and_b32_dpp v11, v48, v23 row_newbcast:0 row_mask:0xf bank_mask:0xf
    s_waitcnt vmcnt(15)
    s_nop 0
    v_mfma_f32_16x16x32_bf16 v[12:15], v[64:67], v[8:11], v[12:15]
    buffer_load_dwordx4 v[64:67], v1, s[4:7], s32 offen offset:0 nt
    s_add_u32 s32, s32, 6144
    v_and_b32_dpp v8, v48, v20 row_newbcast:4 row_mask:0xf bank_mask:0xf
    v_and_b32_dpp v9, v48, v21 row_newbcast:4 row_mask:0xf bank_mask:0xf
    v_and_b32_dpp v10, v48, v22 row_newbcast:4 row_mask:0xf bank_mask:0xf
    v_and_b32_dpp v11, v48, v23 row_newbcast:4 row_mask:0xf bank_mask:0xf
    s_waitcnt vmcnt(15)
    s_nop 0
    v_mfma_f32_16x16x32_bf16 v[12:15], v[68:71], v[8:11], v[12:15]
    buffer_load_dwordx4 v[68:71], v1, s[4:7], s32 offen offset:0 nt
    s_add_u32 s32, s32, 6144
    v_and_b32_dpp v8, v48, v20 row_newbcast:8 row_mask:0xf bank_mask:0xf
    v_and_b32_dpp v9, v48, v21 row_newbcast:8 row_mask:0xf bank_mask:0xf
    v_and_b32_dpp v10, v48, v22 row_newbcast:8 row_mask:0xf bank_mask:0xf
    v_and_b32_dpp v11, v48, v23 row_newbcast:8 row_mask:0xf bank_mask:0xf
    s_waitcnt vmcnt(15)
    s_nop 0
    v_mfma_f32_16x16x32_bf16 v[12:15], v[72:75], v[8:11], v[12:15]
    buffer_load_dwordx4 v[72:75], v1, s[4:7], s32 offen offset:0 nt
    s_add_u32 s32, s32, 6144
    v_and_b32_dpp v8, v48, v20 row_newbcast:12 row_mask:0xf bank_mask:0xf
    v_and_b32_dpp v9, v48, v21 row_newbcast:12 row_mask:0xf bank_mask:0xf
    v_and_b32_dpp v10, v48, v22 row_newbcast:12 row_mask:0xf bank_mask:0xf
    v_and_b32_dpp v11, v48, v23 row_newbcast:12 row_mask:0xf bank_mask:0xf
    s_waitcnt vmcnt(15)
    s_nop 0
    v_mfma_f32_16x16x32_bf16 v[12:15], v[76:79], v[8:11], v[12:15]
    buffer_load_dwordx4 v[76:79], v1, s[4:7], s32 offen offset:0 nt
    s_add_u32 s32, s32, 6144
    s_cmp_lg_u32 s71, 1
    s_cbranch_scc1 L_BV_p1
    s_lshl_b32 s24, s27, 2
    s_add_u32 s24, s24, 1
    s_mov_b64 exec, 1
    v_mov_b32 v63, s24
    s_cmp_lg_u32 s75, 0
    s_cbranch_scc1 L_far4
    buffer_store_dword v63, off, s[12:15], s34 offset:64
    s_branch L_near4
L_far4:
    buffer_store_dword v63, off, s[12:15], s34 offset:64 sc1
L_near4:
    s_mov_b64 exec, -1
L_BV_p1:
    v_and_b32_dpp v8, v48, v20 row_newbcast:1 row_mask:0xf bank_mask:0xf
    v_and_b32_dpp v9, v48, v21 row_newbcast:1 row_mask:0xf bank_mask:0xf
    v_and_b32_dpp v10, v48, v22 row_newbcast:1 row_mask:0xf bank_mask:0xf
    v_and_b32_dpp v11, v48, v23 row_newbcast:1 row_mask:0xf bank_mask:0xf
    s_waitcnt vmcnt(15)
    s_nop 0
    v_mfma_f32_16x16x32_bf16 v[12:15], v[80:83], v[8:11], v[12:15]
    buffer_load_dwordx4 v[80:83], v1, s[4:7], s32 offen offset:0 nt
    s_add_u32 s32, s32, 6144
    v_and_b32_dpp v8, v48, v20 row_newbcast:5 row_mask:0xf bank_mask:0xf
    v_and_b32_dpp v9, v48, v21 row_newbcast:5 row_mask:0xf bank_mask:0xf
    v_and_b32_dpp v10, v48, v22 row_newbcast:5 row_mask:0xf bank_mask:0xf
    v_and_b32_dpp v11, v48, v23 row_newbcast:5 row_mask:0xf bank_mask:0xf
    s_waitcnt vmcnt(15)
    s_nop 0
    v_mfma_f32_16x16x32_bf16 v[12:15], v[84:87], v[8:11], v[12:15]
    buffer_load_dwordx4 v[84:87], v1, s[4:7], s32 offen offset:0 nt
    s_add_u32 s32, s32, 6144
    v_and_b32_dpp v8, v48, v20 row_newbcast:9 row_mask:0xf bank_mask:0xf
    v_and_b32_dpp v9, v48, v21 row_newbcast:9 row_mask:0xf bank_mask:0xf
    v_and_b32_dpp v10, v48, v22 row_newbcast:9 row_mask:0xf bank_mask:0xf
    v_and_b32_dpp v11, v48, v23 row_newbcast:9 row_mask:0xf bank_mask:0xf
    s_waitcnt vmcnt(15)
    s_nop 0
    v_mfma_f32_16x16x32_bf16 v[12:15], v[88:91], v[8:11], v[12:15]
    buffer_load_dwordx4 v[88:91], v1, s[4:7], s32 offen offset:0 nt
    s_add_u32 s32, s32, 6144
    v_and_b32_dpp v8, v48, v20 row_newbcast:13 row_mask:0xf bank_mask:0xf
    v_and_b32_dpp v9, v48, v21 row_newbcast:13 row_mask:0xf bank_mask:0xf
    v_and_b32_dpp v10, v48, v22 row_newbcast:13 row_mask:0xf bank_mask:0xf
    v_and_b32_dpp v11, v48, v23 row_newbcast:13 row_mask:0xf bank_mask:0xf
    s_waitcnt vmcnt(15)
    s_nop 0
    v_mfma_f32_16x16x32_bf16 v[12:15], v[92:95], v[8:11], v[12:15]
    buffer_load_dwordx4 v[92:95], v1, s[4:7], s32 offen offset:0 nt
    s_add_u32 s32, s32, 6144
    s_cmp_lg_u32 s71, 2
    s_cbranch_scc1 L_BV_p2
    s_lshl_b32 s24, s27, 2
    s_add_u32 s24, s24, 2
    s_mov_b64 exec, 1
    v_mov_b32 v63, s24
    s_cmp_lg_u32 s75, 0
    s_cbranch_scc1 L_far5
    buffer_store_dword v63, off, s[12:15], s34 offset:64
    s_branch L_near5
L_far5:
    buffer_store_dword v63, off, s[12:15], s34 offset:64 sc1
L_near5:
    s_mov_b64 exec, -1
L_BV_p2:
    v_and_b32_dpp v8, v48, v20 row_newbcast:2 row_mask:0xf bank_mask:0xf
    v_and_b32_dpp v9, v48, v21 row_newbcast:2 row_mask:0xf bank_mask:0xf
    v_and_b32_dpp v10, v48, v22 row_newbcast:2 row_mask:0xf bank_mask:0xf
    v_and_b32_dpp v11, v48, v23 row_newbcast:2 row_mask:0xf bank_mask:0xf
    s_waitcnt vmcnt(15)
    s_nop 0
    v_mfma_f32_16x16x32_bf16 v[12:15], v[96:99], v[8:11], v[12:15]
    buffer_load_dwordx4 v[96:99], v1, s[4:7], s32 offen offset:0 nt
    s_add_u32 s32, s32, 6144
    v_and_b32_dpp v8, v48, v20 row_newbcast:6 row_mask:0xf bank_mask:0xf
    v_and_b32_dpp v9, v48, v21 row_newbcast:6 row_mask:0xf bank_mask:0xf
    v_and_b32_dpp v10, v48, v22 row_newbcast:6 row_mask:0xf bank_mask:0xf
    v_and_b32_dpp v11, v48, v23 row_newbcast:6 row_mask:0xf bank_mask:0xf
    s_waitcnt vmcnt(15)
    s_nop 0
    v_mfma_f32_16x16x32_bf16 v[12:15], v[100:103], v[8:11], v[12:15]
    buffer_load_dwordx4 v[100:103], v1, s[4:7], s32 offen offset:0 nt
    s_add_u32 s32, s32, 6144
    s_cmp_eq_u32 s27, 9
    s_cbranch_scc1 L_BT
    v_and_b32_dpp v8, v48, v20 row_newbcast:10 row_mask:0xf bank_mask:0xf
    v_and_b32_dpp v9, v48, v21 row_newbcast:10 row_mask:0xf bank_mask:0xf
    v_and_b32_dpp v10, v48, v22 row_newbcast:10 row_mask:0xf bank_mask:0xf
    v_and_b32_dpp v11, v48, v23 row_newbcast:10 row_mask:0xf bank_mask:0xf
    s_waitcnt vmcnt(15)
    s_nop 0
    v_mfma_f32_16x16x32_bf16 v[12:15], v[104:107], v[8:11], v[12:15]
    buffer_load_dwordx4 v[104:107], v1, s[4:7], s32 offen offset:0 nt
    s_add_u32 s32, s32, 6144
    v_and_b32_dpp v8, v48, v20 row_newbcast:14 row_mask:0xf bank_mask:0xf
    v_and_b32_dpp v9, v48, v21 row_newbcast:14 row_mask:0xf bank_mask:0xf
    v_and_b32_dpp v10, v48, v22 row_newbcast:14 row_mask:0xf bank_mask:0xf
    v_and_b32_dpp v11, v48, v23 row_newbcast:14 row_mask:0xf bank_mask:0xf
    s_waitcnt vmcnt(15)
    s_nop 0
    v_mfma_f32_16x16x32_bf16 v[12:15], v[108:111], v[8:11], v[12:15]
    buffer_load_dwordx4 v[108:111], v1, s[4:7], s32 offen offset:0 nt
    s_add_u32 s32, s32, 6144
    s_cmp_lg_u32 s71, 3
    s_cbranch_scc1 L_BV_p3
    s_lshl_b32 s24, s27, 2
    s_add_u32 s24, s24, 3
    s_mov_b64 exec, 1
    v_mov_b32 v63, s24
    s_cmp_lg_u32 s75, 0
    s_cbranch_scc1 L_far6
    buffer_store_dword v63, off, s[12:15], s34 offset:64
    s_branch L_near6
L_far6:
    buffer_store_dword v63, off, s[12:15], s34 offset:64 sc1
L_near6:
    s_mov_b64 exec, -1
L_BV_p3:
    v_and_b32_dpp v8, v48, v20 row_newbcast:3 row_mask:0xf bank_mask:0xf
    v_and_b32_dpp v9, v48, v21 row_newbcast:3 row_mask:0xf bank_mask:0xf
    v_and_b32_dpp v10, v48, v22 row_newbcast:3 row_mask:0xf bank_mask:0xf
    v_and_b32_dpp v11, v48, v23 row_newbcast:3 row_mask:0xf bank_mask:0xf
    s_waitcnt vmcnt(15)
    s_nop 0
    v_mfma_f32_16x16x32_bf16 v[12:15], v[112:115], v[8:11], v[12:15]
    buffer_load_dwordx4 v[112:115], v1, s[4:7], s32 offen offset:0 nt
    s_add_u32 s32, s32, 6144
    s_cmp_lg_u32 s27, 0
    s_cbranch_scc1 L_BV_d
    v_fma_f32 v49, v49, v61, -v6
    v_fma_f32 v50, v50, v61, -v6
    v_fma_f32 v51, v51, v61, -v6
    v_fma_f32 v52, v52, v61, -v6
    v_fma_f32 v53, v53, v61, -v6
    v_fma_f32 v54, v54, v61, -v6
    v_fma_f32 v55, v55, v61, -v6
    v_fma_f32 v56, v56, v61, -v6
    v_fma_f32 v57, v57, v61, -v6
    v_fma_f32 v58, v58, v61, -v6
    v_exp_f32 v49, v49
    v_exp_f32 v50, v50
    v_exp_f32 v51, v51
    v_exp_f32 v52, v52
    v_exp_f32 v53, v53
    v_exp_f32 v54, v54
    v_exp_f32 v55, v55
    v_exp_f32 v56, v56
    v_exp_f32 v57, v57
    v_exp_f32 v58, v58
    v_add_f32 v7, v7, v49
    v_add_f32 v7, v7, v50
    v_add_f32 v7, v7, v51
    v_add_f32 v7, v7, v52
    v_add_f32 v7, v7, v53
    v_add_f32 v7, v7, v54
    v_add_f32 v7, v7, v55
    v_add_f32 v7, v7, v56
    v_add_f32 v7, v7, v57
    v_add_f32 v7, v7, v58
    v_cvt_pk_bf16_f32 v49, v49, v49
    v_cvt_pk_bf16_f32 v50, v50, v50
    v_cvt_pk_bf16_f32 v51, v51, v51
    v_cvt_pk_bf16_f32 v52, v52, v52
    v_cvt_pk_bf16_f32 v53, v53, v53
    v_cvt_pk_bf16_f32 v54, v54, v54
    v_cvt_pk_bf16_f32 v55, v55, v55
    v_cvt_pk_bf16_f32 v56, v56, v56
    v_cvt_pk_bf16_f32 v57, v57, v57
    v_cvt_pk_bf16_f32 v58, v58, v58
    v_add_f32_dpp v7, v7, v7 row_ror:8 row_mask:0xf bank_mask:0xf
    s_nop 1
    v_add_f32_dpp v7, v7, v7 row_ror:4 row_mask:0xf bank_mask:0xf
    s_nop 1
    v_add_f32_dpp v7, v7, v7 row_ror:2 row_mask:0xf bank_mask:0xf
    s_nop 1
    v_add_f32_dpp v7, v7, v7 row_ror:1 row_mask:0xf bank_mask:0xf
    s_nop 1
    v_add_f32_dpp v7, v7, v7 row_bcast:15 row_mask:0xa bank_mask:0xf
    s_nop 1
    v_add_f32_dpp v7, v7, v7 row_bcast:31 row_mask:0xc bank_mask:0xf
    s_nop 0
    v_readlane_b32 s70, v7, 63
    s_lshl_b32 s25, s3, 4
    s_add_u32 s25, s25, s34
    s_mov_b64 exec, 1
    v_mov_b32 v7, s70
    s_cmp_lg_u32 s75, 0
    s_cbranch_scc1 L_far7
    buffer_store_dwordx2 v[6:7], off, s[12:15], s25
    s_branch L_near7
L_far7:
    buffer_store_dwordx2 v[6:7], off, s[12:15], s25 sc1
L_near7:
    s_mov_b64 exec, -1
L_BV_d:
    v_and_b32_dpp v8, v48, v20 row_newbcast:7 row_mask:0xf bank_mask:0xf
    v_and_b32_dpp v9, v48, v21 row_newbcast:7 row_mask:0xf bank_mask:0xf
    v_and_b32_dpp v10, v48, v22 row_newbcast:7 row_mask:0xf bank_mask:0xf
    v_and_b32_dpp v11, v48, v23 row_newbcast:7 row_mask:0xf bank_mask:0xf
    s_waitcnt vmcnt(15)
    s_nop 0
    v_mfma_f32_16x16x32_bf16 v[12:15], v[116:119], v[8:11], v[12:15]
    buffer_load_dwordx4 v[116:119], v1, s[4:7], s32 offen offset:0 nt
    s_add_u32 s32, s32, 6144
    v_and_b32_dpp v8, v48, v20 row_newbcast:11 row_mask:0xf bank_mask:0xf
    v_and_b32_dpp v9, v48, v21 row_newbcast:11 row_mask:0xf bank_mask:0xf
    v_and_b32_dpp v10, v48, v22 row_newbcast:11 row_mask:0xf bank_mask:0xf
    v_and_b32_dpp v11, v48, v23 row_newbcast:11 row_mask:0xf bank_mask:0xf
    s_waitcnt vmcnt(15)
    s_nop 0
    v_mfma_f32_16x16x32_bf16 v[12:15], v[120:123], v[8:11], v[12:15]
    buffer_load_dwordx4 v[120:123], v1, s[4:7], s32 offen offset:0 nt
    s_add_u32 s32, s32, 6144
    v_and_b32_dpp v8, v48, v20 row_newbcast:15 row_mask:0xf bank_mask:0xf
    v_and_b32_dpp v9, v48, v21 row_newbcast:15 row_mask:0xf bank_mask:0xf
    v_and_b32_dpp v10, v48, v22 row_newbcast:15 row_mask:0xf bank_mask:0xf
    v_and_b32_dpp v11, v48, v23 row_newbcast:15 row_mask:0xf bank_mask:0xf
    s_waitcnt vmcnt(15)
    s_nop 0
    v_mfma_f32_16x16x32_bf16 v[12:15], v[124:127], v[8:11], v[12:15]
    buffer_load_dwordx4 v[124:127], v1, s[4:7], s32 offen offset:0 nt
    s_add_u32 s32, s32, 6144
    v_mov_b32 v48, v49
    v_mov_b32 v49, v50
    v_mov_b32 v50, v51
    v_mov_b32 v51, v52
    v_mov_b32 v52, v53
    v_mov_b32 v53, v54
    v_mov_b32 v54, v55
    v_mov_b32 v55, v56
    v_mov_b32 v56, v57
    v_mov_b32 v57, v58
    s_add_u32 s27, s27, 1
    s_branch L_BV
L_BT:
    v_and_b32_dpp v8, v48, v20 row_newbcast:10 row_mask:0xf bank_mask:0xf
    v_and_b32_dpp v9, v48, v21 row_newbcast:10 row_mask:0xf bank_mask:0xf
    v_and_b32_dpp v10, v48, v22 row_newbcast:10 row_mask:0xf bank_mask:0xf
    v_and_b32_dpp v11, v48, v23 row_newbcast:10 row_mask:0xf bank_mask:0xf
    s_waitcnt vmcnt(15)
    s_nop 0
    v_mfma_f32_16x16x32_bf16 v[12:15], v[104:107], v[8:11], v[12:15]
    buffer_load_dwordx4 v[104:107], v1, s[4:7], s28 offen offset:0 nt
    v_and_b32_dpp v8, v48, v20 row_newbcast:14 row_mask:0xf bank_mask:0xf
    v_and_b32_dpp v9, v48, v21 row_newbcast:14 row_mask:0xf bank_mask:0xf
    v_and_b32_dpp v10, v48, v22 row_newbcast:14 row_mask:0xf bank_mask:0xf
    v_and_b32_dpp v11, v48, v23 row_newbcast:14 row_mask:0xf bank_mask:0xf
    s_waitcnt vmcnt(15)
    s_nop 0
    v_mfma_f32_16x16x32_bf16 v[12:15], v[108:111], v[8:11], v[12:15]
    v_and_b32_dpp v8, v48, v20 row_newbcast:3 row_mask:0xf bank_mask:0xf
    v_and_b32_dpp v9, v48, v21 row_newbcast:3 row_mask:0xf bank_mask:0xf
    v_and_b32_dpp v10, v48, v22 row_newbcast:3 row_mask:0xf bank_mask:0xf
    v_and_b32_dpp v11, v48, v23 row_newbcast:3 row_mask:0xf bank_mask:0xf
    s_waitcnt vmcnt(14)
    s_nop 0
    v_mfma_f32_16x16x32_bf16 v[12:15], v[112:115], v[8:11], v[12:15]
    v_and_b32_dpp v8, v48, v20 row_newbcast:7 row_mask:0xf bank_mask:0xf
    v_and_b32_dpp v9, v48, v21 row_newbcast:7 row_mask:0xf bank_mask:0xf
    v_and_b32_dpp v10, v48, v22 row_newbcast:7 row_mask:0xf bank_mask:0xf
    v_and_b32_dpp v11, v48, v23 row_newbcast:7 row_mask:0xf bank_mask:0xf
    s_waitcnt vmcnt(13)
    s_nop 0
    v_mfma_f32_16x16x32_bf16 v[12:15], v[116:119], v[8:11], v[12:15]
    v_and_b32_dpp v8, v48, v20 row_newbcast:11 row_mask:0xf bank_mask:0xf
    v_and_b32_dpp v9, v48, v21 row_newbcast:11 row_mask:0xf bank_mask:0xf
    v_and_b32_dpp v10, v48, v22 row_newbcast:11 row_mask:0xf bank_mask:0xf
    v_and_b32_dpp v11, v48, v23 row_newbcast:11 row_mask:0xf bank_mask:0xf
    s_waitcnt vmcnt(12)
    s_nop 0
    v_mfma_f32_16x16x32_bf16 v[12:15], v[120:123], v[8:11], v[12:15]
    v_and_b32_dpp v8, v48, v20 row_newbcast:15 row_mask:0xf bank_mask:0xf
    v_and_b32_dpp v9, v48, v21 row_newbcast:15 row_mask:0xf bank_mask:0xf
    v_and_b32_dpp v10, v48, v22 row_newbcast:15 row_mask:0xf bank_mask:0xf
    v_and_b32_dpp v11, v48, v23 row_newbcast:15 row_mask:0xf bank_mask:0xf
    s_waitcnt vmcnt(11)
    s_nop 0
    v_mfma_f32_16x16x32_bf16 v[12:15], v[124:127], v[8:11], v[12:15]
    v_and_b32_dpp v8, v49, v20 row_newbcast:0 row_mask:0xf bank_mask:0xf
    v_and_b32_dpp v9, v49, v21 row_newbcast:0 row_mask:0xf bank_mask:0xf
    v_and_b32_dpp v10, v49, v22 row_newbcast:0 row_mask:0xf bank_mask:0xf
    v_and_b32_dpp v11, v49, v23 row_newbcast:0 row_mask:0xf bank_mask:0xf
    s_waitcnt vmcnt(10)
    s_nop 0
    v_mfma_f32_16x16x32_bf16 v[12:15], v[64:67], v[8:11], v[12:15]
    v_and_b32_dpp v8, v49, v20 row_newbcast:4 row_mask:0xf bank_mask:0xf
    v_and_b32_dpp v9, v49, v21 row_newbcast:4 row_mask:0xf bank_mask:0xf
    v_and_b32_dpp v10, v49, v22 row_newbcast:4 row_mask:0xf bank_mask:0xf
    v_and_b32_dpp v11, v49, v23 row_newbcast:4 row_mask:0xf bank_mask:0xf
    s_waitcnt vmcnt(9)
    s_nop 0
    v_mfma_f32_16x16x32_bf16 v[12:15], v[68:71], v[8:11], v[12:15]
    v_and_b32_dpp v8, v49, v20 row_newbcast:8 row_mask:0xf bank_mask:0xf
    v_and_b32_dpp v9, v49, v21 row_newbcast:8 row_mask:0xf bank_mask:0xf
    v_and_b32_dpp v10, v49, v22 row_newbcast:8 row_mask:0xf bank_mask:0xf
    v_and_b32_dpp v11, v49, v23 row_newbcast:8 row_mask:0xf bank_mask:0xf
    s_waitcnt vmcnt(8)
    s_nop 0
    v_mfma_f32_16x16x32_bf16 v[12:15], v[72:75], v[8:11], v[12:15]
    v_and_b32_dpp v8, v49, v20 row_newbcast:12 row_mask:0xf bank_mask:0xf
    v_and_b32_dpp v9, v49, v21 row_newbcast:12 row_mask:0xf bank_mask:0xf
    v_and_b32_dpp v10, v49, v22 row_newbcast:12 row_mask:0xf bank_mask:0xf
    v_and_b32_dpp v11, v49, v23 row_newbcast:12 row_mask:0xf bank_mask:0xf
    s_waitcnt vmcnt(7)
    s_nop 0
    v_mfma_f32_16x16x32_bf16 v[12:15], v[76:79], v[8:11], v[12:15]
    v_and_b32_dpp v8, v49, v20 row_newbcast:1 row_mask:0xf bank_mask:0xf
    v_and_b32_dpp v9, v49, v21 row_newbcast:1 row_mask:0xf bank_mask:0xf
    v_and_b32_dpp v10, v49, v22 row_newbcast:1 row_mask:0xf bank_mask:0xf
    v_and_b32_dpp v11, v49, v23 row_newbcast:1 row_mask:0xf bank_mask:0xf
    s_waitcnt vmcnt(6)
    s_nop 0
    v_mfma_f32_16x16x32_bf16 v[12:15], v[80:83], v[8:11], v[12:15]
    v_and_b32_dpp v8, v49, v20 row_newbcast:5 row_mask:0xf bank_mask:0xf
    v_and_b32_dpp v9, v49, v21 row_newbcast:5 row_mask:0xf bank_mask:0xf
    v_and_b32_dpp v10, v49, v22 row_newbcast:5 row_mask:0xf bank_mask:0xf
    v_and_b32_dpp v11, v49, v23 row_newbcast:5 row_mask:0xf bank_mask:0xf
    s_waitcnt vmcnt(5)
    s_nop 0
    v_mfma_f32_16x16x32_bf16 v[12:15], v[84:87], v[8:11], v[12:15]
    v_and_b32_dpp v8, v49, v20 row_newbcast:9 row_mask:0xf bank_mask:0xf
    v_and_b32_dpp v9, v49, v21 row_newbcast:9 row_mask:0xf bank_mask:0xf
    v_and_b32_dpp v10, v49, v22 row_newbcast:9 row_mask:0xf bank_mask:0xf
    v_and_b32_dpp v11, v49, v23 row_newbcast:9 row_mask:0xf bank_mask:0xf
    s_waitcnt vmcnt(4)
    s_nop 0
    v_mfma_f32_16x16x32_bf16 v[12:15], v[88:91], v[8:11], v[12:15]
    v_and_b32_dpp v8, v49, v20 row_newbcast:13 row_mask:0xf bank_mask:0xf
    v_and_b32_dpp v9, v49, v21 row_newbcast:13 row_mask:0xf bank_mask:0xf
    v_and_b32_dpp v10, v49, v22 row_newbcast:13 row_mask:0xf bank_mask:0xf
    v_and_b32_dpp v11, v49, v23 row_newbcast:13 row_mask:0xf bank_mask:0xf
    s_waitcnt vmcnt(3)
    s_nop 0
    v_mfma_f32_16x16x32_bf16 v[12:15], v[92:95], v[8:11], v[12:15]
    v_and_b32_dpp v8, v49, v20 row_newbcast:2 row_mask:0xf bank_mask:0xf
    v_and_b32_dpp v9, v49, v21 row_newbcast:2 row_mask:0xf bank_mask:0xf
    v_and_b32_dpp v10, v49, v22 row_newbcast:2 row_mask:0xf bank_mask:0xf
    v_and_b32_dpp v11, v49, v23 row_newbcast:2 row_mask:0xf bank_mask:0xf
    s_waitcnt vmcnt(2)
    s_nop 0
    v_mfma_f32_16x16x32_bf16 v[12:15], v[96:99], v[8:11], v[12:15]
    v_and_b32_dpp v8, v49, v20 row_newbcast:6 row_mask:0xf bank_mask:0xf
    v_and_b32_dpp v9, v49, v21 row_newbcast:6 row_mask:0xf bank_mask:0xf
    v_and_b32_dpp v10, v49, v22 row_newbcast:6 row_mask:0xf bank_mask:0xf
    v_and_b32_dpp v11, v49, v23 row_newbcast:6 row_mask:0xf bank_mask:0xf
    s_waitcnt vmcnt(1)
    s_nop 0
    v_mfma_f32_16x16x32_bf16 v[12:15], v[100:103], v[8:11], v[12:15]
    v_and_b32_dpp v8, v49, v20 row_newbcast:10 row_mask:0xf bank_mask:0xf
    v_and_b32_dpp v9, v49, v21 row_newbcast:10 row_mask:0xf bank_mask:0xf
    v_and_b32_dpp v10, v49, v22 row_newbcast:10 row_mask:0xf bank_mask:0xf
    v_and_b32_dpp v11, v49, v23 row_newbcast:10 row_mask:0xf bank_mask:0xf
    s_waitcnt vmcnt(0)
    s_nop 0
    v_mfma_f32_16x16x32_bf16 v[12:15], v[104:107], v[8:11], v[12:15]
    s_mov_b32 exec_lo, 0x00ff00ff
    s_mov_b32 exec_hi, 0x00ff00ff
    s_cmp_lg_u32 s75, 0
    s_nop 4
    v_cvt_pk_bf16_f32 v4, v12, v13
    v_cvt_pk_bf16_f32 v5, v14, v15
    s_cbranch_scc1 L_far8
    buffer_store_dwordx2 v[4:5], v60, s[12:15], s73 offen
    s_branch L_near8
L_far8:
    buffer_store_dwordx2 v[4:5], v60, s[12:15], s73 offen sc1
L_near8:
    s_endpgm
L_A:
    v_lshrrev_b32 v1, 6, v0
    v_and_b32 v0, 63, v0
    v_readfirstlane_b32 s3, v1
    v_lshlrev_b32 v2, 4, v0
    s_mov_b32 s74, s2
    s_and_b32 s72, s2, 31
    s_and_b32 s70, s2, 6
    s_and_b32 s25, s2, 7
    s_add_u32 s70, s70, s25
    s_lshr_b32 s26, s72, 3
    s_and_b32 s25, s26, 1
    s_lshl_b32 s25, s25, 1
    s_and_b32 s26, s26, 2
    s_lshl_b32 s26, s26, 3
    s_or_b32 s26, s26, s25
    s_or_b32 s26, s26, s70
    v_lshrrev_b32 v3, 4, v0
    v_and_b32 v4, 15, v0
    v_lshlrev_b32 v18, 18, v3
    v_lshl_add_u32 v18, v4, 4, v18
    v_lshrrev_b32 v6, 3, v4
    v_lshlrev_b32 v6, 10, v6
    v_lshl_add_u32 v19, v3, 6, v6
    v_bfe_u32 v1, v0, 2, 2
    v_lshlrev_b32 v64, 18, v1
    v_lshl_add_u32 v64, v3, 6, v64
    v_and_b32 v4, 3, v0
    v_lshl_add_u32 v64, v4, 4, v64
    v_lshlrev_b32 v65, 9, v1
    v_lshl_add_u32 v65, v3, 7, v65
    v_lshl_add_u32 v65, v4, 5, v65
    v_add_u32 v65, 135168, v65
    v_lshlrev_b32 v66, 15, v1
    v_lshl_add_u32 v66, v3, 6, v66
    v_lshl_add_u32 v66, v4, 4, v66
    v_and_b32 v4, 15, v0
    v_lshlrev_b32 v67, 10, v3
    v_lshl_add_u32 v67, v4, 4, v67
    s_lshl_b32 s35, s3, 20
    s_lshl_b32 s24, s26, 8
    s_add_u32 s35, s35, s24
    s_waitcnt lgkmcnt(0)
    s_cmp_lt_u32 s74, 32
    s_cselect_b64 s[4:5], s[40:41], s[54:55]
    s_mov_b32 s6, 0x400000
    s_mov_b32 s7, 0x20000
    s_cselect_b64 s[20:21], s[36:37], s[48:49]
    s_mov_b32 s22, 4096
    s_mov_b32 s23, 0x20000
    s_cselect_b32 s75, 0x400000, 0
    s_lshl_b32 s24, s3, 8
    s_mov_b32 s32, s35
    buffer_load_dwordx4 v[12:15], v67, s[20:23], s24 offen
    buffer_load_dwordx4 v[128:131], v18, s[4:7], s32 offen
    s_add_u32 s32, s32, 8192
    buffer_load_dwordx4 v[132:135], v18, s[4:7], s32 offen
    s_add_u32 s32, s32, 8192
    buffer_load_dwordx4 v[136:139], v18, s[4:7], s32 offen
    s_add_u32 s32, s32, 8192
    buffer_load_dwordx4 v[140:143], v18, s[4:7], s32 offen
    s_add_u32 s32, s32, 8192
    buffer_load_dwordx4 v[144:147], v18, s[4:7], s32 offen
    s_add_u32 s32, s32, 8192
    buffer_load_dwordx4 v[148:151], v18, s[4:7], s32 offen
    s_add_u32 s32, s32, 8192
    buffer_load_dwordx4 v[152:155], v18, s[4:7], s32 offen
    s_add_u32 s32, s32, 8192
    buffer_load_dwordx4 v[156:159], v18, s[4:7], s32 offen
    s_add_u32 s32, s32, 8192
    buffer_load_dwordx4 v[160:163], v18, s[4:7], s32 offen
    s_add_u32 s32, s32, 8192
    buffer_load_dwordx4 v[164:167], v18, s[4:7], s32 offen
    s_add_u32 s32, s32, 8192
    buffer_load_dwordx4 v[168:171], v18, s[4:7], s32 offen
    s_add_u32 s32, s32, 8192
    buffer_load_dwordx4 v[172:175], v18, s[4:7], s32 offen
    s_add_u32 s32, s32, 8192
    s_mov_b32 s12, s62
    s_mov_b32 s13, s63
    s_mov_b32 s14, 0x400000
    s_mov_b32 s15, 0x20000
    s_mov_b32 s16, s60
    s_mov_b32 s17, s61
    s_mov_b32 s18, 0x100
    s_mov_b32 s19, 0x20000
    v_and_b32 v3, 1, v0
    v_lshlrev_b32 v3, 4, v3
    v_mov_b32 v4, 0xffff
    v_lshlrev_b32 v4, v3, v4
    v_bfe_u32 v3, v0, 1, 2
    v_cmp_eq_u32 vcc, 0, v3
    s_nop 1
    v_cndmask_b32 v20, 0, v4, vcc
    v_cmp_eq_u32 vcc, 1, v3
    s_nop 1
    v_cndmask_b32 v21, 0, v4, vcc
    v_cmp_eq_u32 vcc, 2, v3
    s_nop 1
    v_cndmask_b32 v22, 0, v4, vcc
    v_cmp_eq_u32 vcc, 3, v3
    s_nop 1
    v_cndmask_b32 v23, 0, v4, vcc
    v_mov_b32 v3, 0x0c0c0c0c
    s_mov_b32 s24, 0x01000100
    s_mov_b32 s25, 0x03020302
    v_bfi_b32 v24, v20, s24, v3
    v_bfi_b32 v28, v20, s25, v3
    v_bfi_b32 v25, v21, s24, v3
    v_bfi_b32 v29, v21, s25, v3
    v_bfi_b32 v26, v22, s24, v3
    v_bfi_b32 v30, v22, s25, v3
    v_bfi_b32 v27, v23, s24, v3
    v_bfi_b32 v31, v23, s25, v3
    s_mov_b32 s64, 0x22222222
    s_mov_b32 s65, 0x22222222
    s_mov_b32 s66, 0x44444444
    s_mov_b32 s67, 0x44444444
    s_mov_b32 s68, 0x88888888
    s_mov_b32 s69, 0x88888888
    s_lshl_b32 s24, s3, 8
    s_add_u32 s24, s24, 145408
    v_add_u32 v3, s24, v67
    v_add_u32 v4, s24, v19
    s_waitcnt vmcnt(12)
    ds_write_b128 v3, v[12:15]
    s_waitcnt lgkmcnt(0)
    ds_read_b128 v[32:35], v4 offset:0
    ds_read_b128 v[36:39], v4 offset:16
    ds_read_b128 v[40:43], v4 offset:32
    ds_read_b128 v[44:47], v4 offset:48
    ds_read_b128 v[48:51], v4 offset:2048
    ds_read_b128 v[52:55], v4 offset:2064
    ds_read_b128 v[56:59], v4 offset:2080
    ds_read_b128 v[60:63], v4 offset:2096
    s_waitcnt lgkmcnt(0)
    v_mov_b32 v76, -1
    v_mov_b32 v77, -1
    v_mov_b32 v78, -1
    v_mov_b32 v79, -1
    s_lshl_b32 s71, s72, 2
    s_add_u32 s71, s71, s3
    s_lshl_b32 s71, s71, 10
    s_add_u32 s71, s71, 0x1b0000
    s_cmp_lt_u32 s74, 32
    s_cselect_b32 s71, 0x400000, s71
    v_perm_b32 v8, v32, v32, v24
    v_perm_b32 v9, v32, v32, v25
    v_perm_b32 v10, v32, v32, v26
    v_perm_b32 v11, v32, v32, v27
    v_perm_b32 v4, v48, v48, v24
    v_perm_b32 v5, v48, v48, v25
    v_perm_b32 v6, v48, v48, v26
    v_perm_b32 v7, v48, v48, v27
    s_waitcnt vmcnt(11)
    v_mfma_f32_16x16x32_bf16 v[12:15], v[128:131], v[8:11], 0
    v_mfma_f32_16x16x32_bf16 v[68:71], v[128:131], v[4:7], 0
    buffer_load_dwordx4 v[176:179], v18, s[4:7], s32 offen nt
    s_add_u32 s32, s32, 8192
    v_perm_b32 v8, v32, v32, v28
    v_perm_b32 v9, v32, v32, v29
    v_perm_b32 v10, v32, v32, v30
    v_perm_b32 v11, v32, v32, v31
    v_perm_b32 v4, v48, v48, v28
    v_perm_b32 v5, v48, v48, v29
    v_perm_b32 v6, v48, v48, v30
    v_perm_b32 v7, v48, v48, v31
    s_waitcnt vmcnt(11)
    v_mfma_f32_16x16x32_bf16 v[12:15], v[132:135], v[8:11], v[12:15]
    v_mfma_f32_16x16x32_bf16 v[68:71], v[132:135], v[4:7], v[68:71]
    buffer_load_dwordx4 v[180:183], v18, s[4:7], s32 offen nt
    s_add_u32 s32, s32, 8192
    v_perm_b32 v8, v33, v33, v24
    v_perm_b32 v9, v33, v33, v25
    v_perm_b32 v10, v33, v33, v26
    v_perm_b32 v11, v33, v33, v27
    v_perm_b32 v4, v49, v49, v24
    v_perm_b32 v5, v49, v49, v25
    v_perm_b32 v6, v49, v49, v26
    v_perm_b32 v7, v49, v49, v27
    s_waitcnt vmcnt(11)
    v_mfma_f32_16x16x32_bf16 v[12:15], v[136:139], v[8:11], v[12:15]
    v_mfma_f32_16x16x32_bf16 v[68:71], v[136:139], v[4:7], v[68:71]
    buffer_load_dwordx4 v[184:187], v18, s[4:7], s32 offen nt
    s_add_u32 s32, s32, 8192
    v_perm_b32 v8, v33, v33, v28
    v_perm_b32 v9, v33, v33, v29
    v_perm_b32 v10, v33, v33, v30
    v_perm_b32 v11, v33, v33, v31
    v_perm_b32 v4, v49, v49, v28
    v_perm_b32 v5, v49, v49, v29
    v_perm_b32 v6, v49, v49, v30
    v_perm_b32 v7, v49, v49, v31
    s_waitcnt vmcnt(11)
    v_mfma_f32_16x16x32_bf16 v[12:15], v[140:143], v[8:11], v[12:15]
    v_mfma_f32_16x16x32_bf16 v[68:71], v[140:143], v[4:7], v[68:71]
    buffer_load_dwordx4 v[188:191], v18, s[4:7], s32 offen nt
    s_add_u32 s32, s32, 8192
    v_perm_b32 v8, v34, v34, v24
    v_perm_b32 v9, v34, v34, v25
    v_perm_b32 v10, v34, v34, v26
    v_perm_b32 v11, v34, v34, v27
    v_perm_b32 v4, v50, v50, v24
    v_perm_b32 v5, v50, v50, v25
    v_perm_b32 v6, v50, v50, v26
    v_perm_b32 v7, v50, v50, v27
    s_waitcnt vmcnt(11)
    v_mfma_f32_16x16x32_bf16 v[12:15], v[144:147], v[8:11], v[12:15]
    v_mfma_f32_16x16x32_bf16 v[68:71], v[144:147], v[4:7], v[68:71]
    buffer_load_dwordx4 v[192:195], v18, s[4:7], s32 offen nt
    s_add_u32 s32, s32, 8192
    v_perm_b32 v8, v34, v34, v28
    v_perm_b32 v9, v34, v34, v29
    v_perm_b32 v10, v34, v34, v30
    v_perm_b32 v11, v34, v34, v31
    v_perm_b32 v4, v50, v50, v28
    v_perm_b32 v5, v50, v50, v29
    v_perm_b32 v6, v50, v50, v30
    v_perm_b32 v7, v50, v50, v31
    s_waitcnt vmcnt(11)
    v_mfma_f32_16x16x32_bf16 v[12:15], v[148:151], v[8:11], v[12:15]
    v_mfma_f32_16x16x32_bf16 v[68:71], v[148:151], v[4:7], v[68:71]
    buffer_load_dwordx4 v[196:199], v18, s[4:7], s32 offen nt
    s_add_u32 s32, s32, 8192
    v_perm_b32 v8, v35, v35, v24
    v_perm_b32 v9, v35, v35, v25
    v_perm_b32 v10, v35, v35, v26
    v_perm_b32 v11, v35, v35, v27
    v_perm_b32 v4, v51, v51, v24
    v_perm_b32 v5, v51, v51, v25
    v_perm_b32 v6, v51, v51, v26
    v_perm_b32 v7, v51, v51, v27
    s_waitcnt vmcnt(11)
    v_mfma_f32_16x16x32_bf16 v[12:15], v[152:155], v[8:11], v[12:15]
    v_mfma_f32_16x16x32_bf16 v[68:71], v[152:155], v[4:7], v[68:71]
    buffer_load_dwordx4 v[200:203], v18, s[4:7], s32 offen nt
    s_add_u32 s32, s32, 8192
    v_perm_b32 v8, v35, v35, v28
    v_perm_b32 v9, v35, v35, v29
    v_perm_b32 v10, v35, v35, v30
    v_perm_b32 v11, v35, v35, v31
    v_perm_b32 v4, v51, v51, v28
    v_perm_b32 v5, v51, v51, v29
    v_perm_b32 v6, v51, v51, v30
    v_perm_b32 v7, v51, v51, v31
    s_waitcnt vmcnt(11)
    v_mfma_f32_16x16x32_bf16 v[12:15], v[156:159], v[8:11], v[12:15]
    v_mfma_f32_16x16x32_bf16 v[68:71], v[156:159], v[4:7], v[68:71]
    buffer_load_dwordx4 v[204:207], v18, s[4:7], s32 offen nt
    s_add_u32 s32, s32, 8192
    v_perm_b32 v8, v36, v36, v24
    v_perm_b32 v9, v36, v36, v25
    v_perm_b32 v10, v36, v36, v26
    v_perm_b32 v11, v36, v36, v27
    v_perm_b32 v4, v52, v52, v24
    v_perm_b32 v5, v52, v52, v25
    v_perm_b32 v6, v52, v52, v26
    v_perm_b32 v7, v52, v52, v27
    s_waitcnt vmcnt(11)
    v_mfma_f32_16x16x32_bf16 v[12:15], v[160:163], v[8:11], v[12:15]
    v_mfma_f32_16x16x32_bf16 v[68:71], v[160:163], v[4:7], v[68:71]
    buffer_load_dwordx4 v[208:211], v18, s[4:7], s32 offen nt
    s_add_u32 s32, s32, 8192
    v_perm_b32 v8, v36, v36, v28
    v_perm_b32 v9, v36, v36, v29
    v_perm_b32 v10, v36, v36, v30
    v_perm_b32 v11, v36, v36, v31
    v_perm_b32 v4, v52, v52, v28
    v_perm_b32 v5, v52, v52, v29
    v_perm_b32 v6, v52, v52, v30
    v_perm_b32 v7, v52, v52, v31
    s_waitcnt vmcnt(11)
    v_mfma_f32_16x16x32_bf16 v[12:15], v[164:167], v[8:11], v[12:15]
    v_mfma_f32_16x16x32_bf16 v[68:71], v[164:167], v[4:7], v[68:71]
    buffer_load_dwordx4 v[212:215], v18, s[4:7], s32 offen nt
    s_add_u32 s32, s32, 8192
    v_perm_b32 v8, v37, v37, v24
    v_perm_b32 v9, v37, v37, v25
    v_perm_b32 v10, v37, v37, v26
    v_perm_b32 v11, v37, v37, v27
    v_perm_b32 v4, v53, v53, v24
    v_perm_b32 v5, v53, v53, v25
    v_perm_b32 v6, v53, v53, v26
    v_perm_b32 v7, v53, v53, v27
    s_waitcnt vmcnt(11)
    v_mfma_f32_16x16x32_bf16 v[12:15], v[168:171], v[8:11], v[12:15]
    v_mfma_f32_16x16x32_bf16 v[68:71], v[168:171], v[4:7], v[68:71]
    buffer_load_dwordx4 v[216:219], v18, s[4:7], s32 offen nt
    s_add_u32 s32, s32, 8192
    v_perm_b32 v8, v37, v37, v28
    v_perm_b32 v9, v37, v37, v29
    v_perm_b32 v10, v37, v37, v30
    v_perm_b32 v11, v37, v37, v31
    v_perm_b32 v4, v53, v53, v28
    v_perm_b32 v5, v53, v53, v29
    v_perm_b32 v6, v53, v53, v30
    v_perm_b32 v7, v53, v53, v31
    s_waitcnt vmcnt(11)
    v_mfma_f32_16x16x32_bf16 v[12:15], v[172:175], v[8:11], v[12:15]
    v_mfma_f32_16x16x32_bf16 v[68:71], v[172:175], v[4:7], v[68:71]
    buffer_load_dwordx4 v[220:223], v18, s[4:7], s32 offen nt
    s_add_u32 s32, s32, 8192
    v_perm_b32 v8, v38, v38, v24
    v_perm_b32 v9, v38, v38, v25
    v_perm_b32 v10, v38, v38, v26
    v_perm_b32 v11, v38, v38, v27
    v_perm_b32 v4, v54, v54, v24
    v_perm_b32 v5, v54, v54, v25
    v_perm_b32 v6, v54, v54, v26
    v_perm_b32 v7, v54, v54, v27
    s_waitcnt vmcnt(11)
    v_mfma_f32_16x16x32_bf16 v[12:15], v[176:179], v[8:11], v[12:15]
    v_mfma_f32_16x16x32_bf16 v[68:71], v[176:179], v[4:7], v[68:71]
    buffer_load_dwordx4 v[224:227], v18, s[4:7], s32 offen nt
    s_add_u32 s32, s32, 8192
    v_perm_b32 v8, v38, v38, v28
    v_perm_b32 v9, v38, v38, v29
    v_perm_b32 v10, v38, v38, v30
    v_perm_b32 v11, v38, v38, v31
    v_perm_b32 v4, v54, v54, v28
    v_perm_b32 v5, v54, v54, v29
    v_perm_b32 v6, v54, v54, v30
    v_perm_b32 v7, v54, v54, v31
    s_waitcnt vmcnt(11)
    v_mfma_f32_16x16x32_bf16 v[12:15], v[180:183], v[8:11], v[12:15]
    v_mfma_f32_16x16x32_bf16 v[68:71], v[180:183], v[4:7], v[68:71]
    buffer_load_dwordx4 v[228:231], v18, s[4:7], s32 offen nt
    s_add_u32 s32, s32, 8192
    v_perm_b32 v8, v39, v39, v24
    v_perm_b32 v9, v39, v39, v25
    v_perm_b32 v10, v39, v39, v26
    v_perm_b32 v11, v39, v39, v27
    v_perm_b32 v4, v55, v55, v24
    v_perm_b32 v5, v55, v55, v25
    v_perm_b32 v6, v55, v55, v26
    v_perm_b32 v7, v55, v55, v27
    s_waitcnt vmcnt(11)
    v_mfma_f32_16x16x32_bf16 v[12:15], v[184:187], v[8:11], v[12:15]
    v_mfma_f32_16x16x32_bf16 v[68:71], v[184:187], v[4:7], v[68:71]
    buffer_load_dwordx4 v[232:235], v18, s[4:7], s32 offen nt
    s_add_u32 s32, s32, 8192
    v_perm_b32 v8, v39, v39, v28
    v_perm_b32 v9, v39, v39, v29
    v_perm_b32 v10, v39, v39, v30
    v_perm_b32 v11, v39, v39, v31
    v_perm_b32 v4, v55, v55, v28
    v_perm_b32 v5, v55, v55, v29
    v_perm_b32 v6, v55, v55, v30
    v_perm_b32 v7, v55, v55, v31
    s_waitcnt vmcnt(11)
    v_mfma_f32_16x16x32_bf16 v[12:15], v[188:191], v[8:11], v[12:15]
    v_mfma_f32_16x16x32_bf16 v[68:71], v[188:191], v[4:7], v[68:71]
    buffer_load_dwordx4 v[236:239], v18, s[4:7], s32 offen nt
    s_add_u32 s32, s32, 8192
    v_perm_b32 v8, v40, v40, v24
    v_perm_b32 v9, v40, v40, v25
    v_perm_b32 v10, v40, v40, v26
    v_perm_b32 v11, v40, v40, v27
    v_perm_b32 v4, v56, v56, v24
    v_perm_b32 v5, v56, v56, v25
    v_perm_b32 v6, v56, v56, v26
    v_perm_b32 v7, v56, v56, v27
    s_waitcnt vmcnt(11)
    v_mfma_f32_16x16x32_bf16 v[12:15], v[192:195], v[8:11], v[12:15]
    v_mfma_f32_16x16x32_bf16 v[68:71], v[192:195], v[4:7], v[68:71]
    buffer_load_dwordx4 v[240:243], v18, s[4:7], s32 offen nt
    s_add_u32 s32, s32, 8192
    v_perm_b32 v8, v40, v40, v28
    v_perm_b32 v9, v40, v40, v29
    v_perm_b32 v10, v40, v40, v30
    v_perm_b32 v11, v40, v40, v31
    v_perm_b32 v4, v56, v56, v28
    v_perm_b32 v5, v56, v56, v29
    v_perm_b32 v6, v56, v56, v30
    v_perm_b32 v7, v56, v56, v31
    s_waitcnt vmcnt(11)
    v_mfma_f32_16x16x32_bf16 v[12:15], v[196:199], v[8:11], v[12:15]
    v_mfma_f32_16x16x32_bf16 v[68:71], v[196:199], v[4:7], v[68:71]
    buffer_load_dwordx4 v[244:247], v18, s[4:7], s32 offen nt
    s_add_u32 s32, s32, 8192
    v_perm_b32 v8, v41, v41, v24
    v_perm_b32 v9, v41, v41, v25
    v_perm_b32 v10, v41, v41, v26
    v_perm_b32 v11, v41, v41, v27
    v_perm_b32 v4, v57, v57, v24
    v_perm_b32 v5, v57, v57, v25
    v_perm_b32 v6, v57, v57, v26
    v_perm_b32 v7, v57, v57, v27
    s_waitcnt vmcnt(11)
    v_mfma_f32_16x16x32_bf16 v[12:15], v[200:203], v[8:11], v[12:15]
    v_mfma_f32_16x16x32_bf16 v[68:71], v[200:203], v[4:7], v[68:71]
    buffer_load_dwordx4 v[248:251], v18, s[4:7], s32 offen nt
    s_add_u32 s32, s32, 8192
    v_perm_b32 v8, v41, v41, v28
    v_perm_b32 v9, v41, v41, v29
    v_perm_b32 v10, v41, v41, v30
    v_perm_b32 v11, v41, v41, v31
    v_perm_b32 v4, v57, v57, v28
    v_perm_b32 v5, v57, v57, v29
    v_perm_b32 v6, v57, v57, v30
    v_perm_b32 v7, v57, v57, v31
    s_waitcnt vmcnt(11)
    v_mfma_f32_16x16x32_bf16 v[12:15], v[204:207], v[8:11], v[12:15]
    v_mfma_f32_16x16x32_bf16 v[68:71], v[204:207], v[4:7], v[68:71]
    buffer_load_dwordx4 v[252:255], v18, s[4:7], s32 offen nt
    s_add_u32 s32, s32, 8192
    v_perm_b32 v8, v42, v42, v24
    v_perm_b32 v9, v42, v42, v25
    v_perm_b32 v10, v42, v42, v26
    v_perm_b32 v11, v42, v42, v27
    v_perm_b32 v4, v58, v58, v24
    v_perm_b32 v5, v58, v58, v25
    v_perm_b32 v6, v58, v58, v26
    v_perm_b32 v7, v58, v58, v27
    s_waitcnt vmcnt(11)
    v_mfma_f32_16x16x32_bf16 v[12:15], v[208:211], v[8:11], v[12:15]
    v_mfma_f32_16x16x32_bf16 v[68:71], v[208:211], v[4:7], v[68:71]
    s_lshl_b32 s73, s74, 7
    s_add_u32 s73, s73, 0x170000
    s_cmp_lg_u32 s3, 0
    s_cbranch_scc1 L_A_nofl
    s_mov_b64 exec, 1
    buffer_store_dwordx4 v[76:79], off, s[12:15], s73 sc1
    s_mov_b64 exec, -1
L_A_nofl:
    s_cmp_ge_u32 s71, 0x1bf800
    s_cselect_b32 s71, 0x400000, s71
    buffer_store_dwordx4 v[76:79], v2, s[12:15], s71 offen sc1
    s_add_u32 s71, s71, 0x20000
    s_getpc_b64 s[24:25]
L_pc9:
    s_add_u32 s24, s24, L_A2-L_pc9
    s_addc_u32 s25, s25, 0
    v_lshl_add_u32 v16, v0, 2, s3
    v_lshlrev_b32 v16, 7, v16
    v_min_u32 v16, L_last-L_A2-4, v16
    v_mov_b32 v17, s25
    v_add_co_u32 v16, vcc, s24, v16
    s_nop 1
    v_addc_co_u32 v17, vcc, 0, v17, vcc
    global_load_dword v17, v[16:17], off
    s_mov_b32 s4, s42
    s_mov_b32 s5, s43
    s_mov_b32 s6, s75
    s_mov_b32 s32, s35
    buffer_load_dwordx4 v[128:131], v64, s[4:7], s32 offen nt
    s_add_u32 s32, s32, 8192
    v_perm_b32 v8, v42, v42, v28
    v_perm_b32 v9, v42, v42, v29
    v_perm_b32 v10, v42, v42, v30
    v_perm_b32 v11, v42, v42, v31
    v_perm_b32 v4, v58, v58, v28
    v_perm_b32 v5, v58, v58, v29
    v_perm_b32 v6, v58, v58, v30
    v_perm_b32 v7, v58, v58, v31
    s_waitcnt vmcnt(13)
    v_mfma_f32_16x16x32_bf16 v[12:15], v[212:215], v[8:11], v[12:15]
    v_mfma_f32_16x16x32_bf16 v[68:71], v[212:215], v[4:7], v[68:71]
    buffer_load_dwordx4 v[132:135], v64, s[4:7], s32 offen nt
    s_add_u32 s32, s32, 8192
    v_perm_b32 v8, v43, v43, v24
    v_perm_b32 v9, v43, v43, v25
    v_perm_b32 v10, v43, v43, v26
    v_perm_b32 v11, v43, v43, v27
    v_perm_b32 v4, v59, v59, v24
    v_perm_b32 v5, v59, v59, v25
    v_perm_b32 v6, v59, v59, v26
    v_perm_b32 v7, v59, v59, v27
    s_waitcnt vmcnt(13)
    v_mfma_f32_16x16x32_bf16 v[12:15], v[216:219], v[8:11], v[12:15]
    v_mfma_f32_16x16x32_bf16 v[68:71], v[216:219], v[4:7], v[68:71]
    buffer_load_dwordx4 v[136:139], v64, s[4:7], s32 offen nt
    s_add_u32 s32, s32, 8192
    v_perm_b32 v8, v43, v43, v28
    v_perm_b32 v9, v43, v43, v29
    v_perm_b32 v10, v43, v43, v30
    v_perm_b32 v11, v43, v43, v31
    v_perm_b32 v4, v59, v59, v28
    v_perm_b32 v5, v59, v59, v29
    v_perm_b32 v6, v59, v59, v30
    v_perm_b32 v7, v59, v59, v31
    s_waitcnt vmcnt(13)
    v_mfma_f32_16x16x32_bf16 v[12:15], v[220:223], v[8:11], v[12:15]
    v_mfma_f32_16x16x32_bf16 v[68:71], v[220:223], v[4:7], v[68:71]
    buffer_load_dwordx4 v[140:143], v64, s[4:7], s32 offen nt
    s_add_u32 s32, s32, 8192
    v_perm_b32 v8, v44, v44, v24
    v_perm_b32 v9, v44, v44, v25
    v_perm_b32 v10, v44, v44, v26
    v_perm_b32 v11, v44, v44, v27
    v_perm_b32 v4, v60, v60, v24
    v_perm_b32 v5, v60, v60, v25
    v_perm_b32 v6, v60, v60, v26
    v_perm_b32 v7, v60, v60, v27
    s_waitcnt vmcnt(13)
    v_mfma_f32_16x16x32_bf16 v[12:15], v[224:227], v[8:11], v[12:15]
    v_mfma_f32_16x16x32_bf16 v[68:71], v[224:227], v[4:7], v[68:71]
    buffer_load_dwordx4 v[144:147], v64, s[4:7], s32 offen nt
    s_add_u32 s32, s32, 8192
    v_perm_b32 v8, v44, v44, v28
    v_perm_b32 v9, v44, v44, v29
    v_perm_b32 v10, v44, v44, v30
    v_perm_b32 v11, v44, v44, v31
    v_perm_b32 v4, v60, v60, v28
    v_perm_b32 v5, v60, v60, v29
    v_perm_b32 v6, v60, v60, v30
    v_perm_b32 v7, v60, v60, v31
    s_waitcnt vmcnt(13)
    v_mfma_f32_16x16x32_bf16 v[12:15], v[228:231], v[8:11], v[12:15]
    v_mfma_f32_16x16x32_bf16 v[68:71], v[228:231], v[4:7], v[68:71]
    buffer_load_dwordx4 v[148:151], v64, s[4:7], s32 offen nt
    s_add_u32 s32, s32, 8192
    v_perm_b32 v8, v45, v45, v24
    v_perm_b32 v9, v45, v45, v25
    v_perm_b32 v10, v45, v45, v26
    v_perm_b32 v11, v45, v45, v27
    v_perm_b32 v4, v61, v61, v24
    v_perm_b32 v5, v61, v61, v25
    v_perm_b32 v6, v61, v61, v26
    v_perm_b32 v7, v61, v61, v27
    s_waitcnt vmcnt(13)
    v_mfma_f32_16x16x32_bf16 v[12:15], v[232:235], v[8:11], v[12:15]
    v_mfma_f32_16x16x32_bf16 v[68:71], v[232:235], v[4:7], v[68:71]
    buffer_load_dwordx4 v[152:155], v64, s[4:7], s32 offen nt
    s_add_u32 s32, s32, 8192
    v_perm_b32 v8, v45, v45, v28
    v_perm_b32 v9, v45, v45, v29
    v_perm_b32 v10, v45, v45, v30
    v_perm_b32 v11, v45, v45, v31
    v_perm_b32 v4, v61, v61, v28
    v_perm_b32 v5, v61, v61, v29
    v_perm_b32 v6, v61, v61, v30
    v_perm_b32 v7, v61, v61, v31
    s_waitcnt vmcnt(13)
    v_mfma_f32_16x16x32_bf16 v[12:15], v[236:239], v[8:11], v[12:15]
    v_mfma_f32_16x16x32_bf16 v[68:71], v[236:239], v[4:7], v[68:71]
    buffer_load_dwordx4 v[156:159], v64, s[4:7], s32 offen nt
    s_add_u32 s32, s32, 8192
    v_perm_b32 v8, v46, v46, v24
    v_perm_b32 v9, v46, v46, v25
    v_perm_b32 v10, v46, v46, v26
    v_perm_b32 v11, v46, v46, v27
    v_perm_b32 v4, v62, v62, v24
    v_perm_b32 v5, v62, v62, v25
    v_perm_b32 v6, v62, v62, v26
    v_perm_b32 v7, v62, v62, v27
    s_waitcnt vmcnt(13)
    v_mfma_f32_16x16x32_bf16 v[12:15], v[240:243], v[8:11], v[12:15]
    v_mfma_f32_16x16x32_bf16 v[68:71], v[240:243], v[4:7], v[68:71]
    buffer_load_dwordx4 v[160:163], v64, s[4:7], s32 offen nt
    s_add_u32 s32, s32, 8192
    v_perm_b32 v8, v46, v46, v28
    v_perm_b32 v9, v46, v46, v29
    v_perm_b32 v10, v46, v46, v30
    v_perm_b32 v11, v46, v46, v31
    v_perm_b32 v4, v62, v62, v28
    v_perm_b32 v5, v62, v62, v29
    v_perm_b32 v6, v62, v62, v30
    v_perm_b32 v7, v62, v62, v31
    s_waitcnt vmcnt(13)
    v_mfma_f32_16x16x32_bf16 v[12:15], v[244:247], v[8:11], v[12:15]
    v_mfma_f32_16x16x32_bf16 v[68:71], v[244:247], v[4:7], v[68:71]
    buffer_load_dwordx4 v[164:167], v64, s[4:7], s32 offen nt
    s_add_u32 s32, s32, 8192
    v_perm_b32 v8, v47, v47, v24
    v_perm_b32 v9, v47, v47, v25
    v_perm_b32 v10, v47, v47, v26
    v_perm_b32 v11, v47, v47, v27
    v_perm_b32 v4, v63, v63, v24
    v_perm_b32 v5, v63, v63, v25
    v_perm_b32 v6, v63, v63, v26
    v_perm_b32 v7, v63, v63, v27
    s_waitcnt vmcnt(13)
    v_mfma_f32_16x16x32_bf16 v[12:15], v[248:251], v[8:11], v[12:15]
    v_mfma_f32_16x16x32_bf16 v[68:71], v[248:251], v[4:7], v[68:71]
    buffer_load_dwordx4 v[168:171], v64, s[4:7], s32 offen nt
    s_add_u32 s32, s32, 8192
    v_perm_b32 v8, v47, v47, v28
    v_perm_b32 v9, v47, v47, v29
    v_perm_b32 v10, v47, v47, v30
    v_perm_b32 v11, v47, v47, v31
    v_perm_b32 v4, v63, v63, v28
    v_perm_b32 v5, v63, v63, v29
    v_perm_b32 v6, v63, v63, v30
    v_perm_b32 v7, v63, v63, v31
    s_waitcnt vmcnt(13)
    v_mfma_f32_16x16x32_bf16 v[12:15], v[252:255], v[8:11], v[12:15]
    v_mfma_f32_16x16x32_bf16 v[68:71], v[252:255], v[4:7], v[68:71]
    buffer_load_dwordx4 v[172:175], v64, s[4:7], s32 offen nt
    s_add_u32 s32, s32, 8192
    v_lshrrev_b32 v3, 4, v0
    v_lshlrev_b32 v3, 7, v3
    v_and_b32 v4, 7, v0
    v_lshl_add_u32 v3, v4, 2, v3
    v_bfe_u32 v4, v0, 3, 1
    v_lshl_add_u32 v3, v4, 9, v3
    s_lshl_b32 s24, s3, 11
    s_add_u32 s24, s24, 135168
    v_add_u32 v3, s24, v3
    ds_write_b32 v3, v12 offset:0
    ds_write_b32 v3, v13 offset:32
    ds_write_b32 v3, v14 offset:64
    ds_write_b32 v3, v15 offset:96
    ds_write_b32 v3, v68 offset:1024
    ds_write_b32 v3, v69 offset:1056
    ds_write_b32 v3, v70 offset:1088
    ds_write_b32 v3, v71 offset:1120
    s_waitcnt lgkmcnt(0)
    s_barrier
    ds_read_b128 v[72:75], v65 offset:0
    ds_read_b128 v[76:79], v65 offset:16
    ds_read_b128 v[80:83], v65 offset:2048
    ds_read_b128 v[84:87], v65 offset:2064
    ds_read_b128 v[88:91], v65 offset:4096
    ds_read_b128 v[92:95], v65 offset:4112
    ds_read_b128 v[96:99], v65 offset:6144
    ds_read_b128 v[100:103], v65 offset:6160
    s_waitcnt lgkmcnt(4)
    v_add_f32 v72, v72, v80
    v_add_f32 v73, v73, v81
    v_add_f32 v74, v74, v82
    v_add_f32 v75, v75, v83
    v_add_f32 v76, v76, v84
    v_add_f32 v77, v77, v85
    v_add_f32 v78, v78, v86
    v_add_f32 v79, v79, v87
    s_waitcnt lgkmcnt(2)
    v_add_f32 v72, v72, v88
    v_add_f32 v73, v73, v89
    v_add_f32 v74, v74, v90
    v_add_f32 v75, v75, v91
    v_add_f32 v76, v76, v92
    v_add_f32 v77, v77, v93
    v_add_f32 v78, v78, v94
    v_add_f32 v79, v79, v95
    s_waitcnt lgkmcnt(0)
    v_add_f32 v72, v72, v96
    v_add_f32 v73, v73, v97
    v_add_f32 v74, v74, v98
    v_add_f32 v75, v75, v99
    v_add_f32 v76, v76, v100
    v_add_f32 v77, v77, v101
    v_add_f32 v78, v78, v102
    v_add_f32 v79, v79, v103
    v_cvt_pk_bf16_f32 v8, v72, v73
    v_cvt_pk_bf16_f32 v9, v74, v75
    v_cvt_pk_bf16_f32 v10, v76, v77
    v_cvt_pk_bf16_f32 v11, v78, v79
    s_cmp_ge_u32 s74, 32
    s_cbranch_scc1 L_C
L_A2:
    buffer_load_dwordx4 v[176:179], v64, s[4:7], s32 offen nt
    s_add_u32 s32, s32, 8192
    buffer_load_dwordx4 v[180:183], v64, s[4:7], s32 offen nt
    s_add_u32 s32, s32, 8192
    buffer_load_dwordx4 v[184:187], v64, s[4:7], s32 offen nt
    s_add_u32 s32, s32, 8192
    buffer_load_dwordx4 v[188:191], v64, s[4:7], s32 offen nt
    s_add_u32 s32, s32, 8192
    buffer_load_dwordx4 v[192:195], v64, s[4:7], s32 offen nt
    s_add_u32 s32, s32, 8192
    buffer_load_dwordx4 v[196:199], v64, s[4:7], s32 offen nt
    s_add_u32 s32, s32, 8192
    buffer_load_dwordx4 v[200:203], v64, s[4:7], s32 offen nt
    s_add_u32 s32, s32, 8192
    buffer_load_dwordx4 v[204:207], v64, s[4:7], s32 offen nt
    s_add_u32 s32, s32, 8192
    buffer_load_dwordx4 v[208:211], v64, s[4:7], s32 offen nt
    s_add_u32 s32, s32, 8192
    buffer_load_dwordx4 v[212:215], v64, s[4:7], s32 offen nt
    s_add_u32 s32, s32, 8192
    buffer_load_dwordx4 v[216:219], v64, s[4:7], s32 offen nt
    s_add_u32 s32, s32, 8192
    buffer_load_dwordx4 v[220:223], v64, s[4:7], s32 offen nt
    s_add_u32 s32, s32, 8192
    buffer_load_dwordx4 v[224:227], v64, s[4:7], s32 offen nt
    s_add_u32 s32, s32, 8192
    buffer_load_dwordx4 v[228:231], v64, s[4:7], s32 offen nt
    s_add_u32 s32, s32, 8192
    buffer_load_dwordx4 v[232:235], v64, s[4:7], s32 offen nt
    s_add_u32 s32, s32, 8192
    buffer_load_dwordx4 v[236:239], v64, s[4:7], s32 offen nt
    s_add_u32 s32, s32, 8192
    buffer_load_dwordx4 v[240:243], v64, s[4:7], s32 offen nt
    s_add_u32 s32, s32, 8192
    buffer_load_dwordx4 v[244:247], v64, s[4:7], s32 offen nt
    s_add_u32 s32, s32, 8192
    buffer_load_dwordx4 v[248:251], v64, s[4:7], s32 offen nt
    s_add_u32 s32, s32, 8192
    buffer_load_dwordx4 v[252:255], v64, s[4:7], s32 offen nt
    s_add_u32 s32, s32, 8192
    s_waitcnt vmcnt(31)
    v_mfma_f32_16x16x32_bf16 v[80:83], v[128:131], v[8:11], 0
    s_waitcnt vmcnt(30)
    v_mfma_f32_16x16x32_bf16 v[84:87], v[132:135], v[8:11], 0
    s_waitcnt vmcnt(29)
    v_mfma_f32_16x16x32_bf16 v[88:91], v[136:139], v[8:11], 0
    s_waitcnt vmcnt(28)
    v_mfma_f32_16x16x32_bf16 v[92:95], v[140:143], v[8:11], 0
    s_waitcnt vmcnt(27)
    v_mfma_f32_16x16x32_bf16 v[96:99], v[144:147], v[8:11], 0
    s_waitcnt vmcnt(26)
    v_mfma_f32_16x16x32_bf16 v[100:103], v[148:151], v[8:11], 0
    s_waitcnt vmcnt(25)
    v_mfma_f32_16x16x32_bf16 v[104:107], v[152:155], v[8:11], 0
    s_waitcnt vmcnt(24)
    v_mfma_f32_16x16x32_bf16 v[108:111], v[156:159], v[8:11], 0
    v_add_f32_dpp v72, v81, v80 quad_perm:[1,1,1,1] row_mask:0xf bank_mask:0xf
    v_add_f32_dpp v73, v85, v84 quad_perm:[1,1,1,1] row_mask:0xf bank_mask:0xf
    v_add_f32_dpp v74, v89, v88 quad_perm:[1,1,1,1] row_mask:0xf bank_mask:0xf
    v_add_f32_dpp v75, v93, v92 quad_perm:[1,1,1,1] row_mask:0xf bank_mask:0xf
    v_add_f32_dpp v76, v97, v96 quad_perm:[1,1,1,1] row_mask:0xf bank_mask:0xf
    v_add_f32_dpp v77, v101, v100 quad_perm:[1,1,1,1] row_mask:0xf bank_mask:0xf
    v_add_f32_dpp v78, v105, v104 quad_perm:[1,1,1,1] row_mask:0xf bank_mask:0xf
    s_nop 0
    v_add_f32_dpp v79, v109, v108 quad_perm:[1,1,1,1] row_mask:0xf bank_mask:0xf
    v_add_f32_dpp v72, v82, v72 quad_perm:[2,2,2,2] row_mask:0xf bank_mask:0xf
    v_add_f32_dpp v73, v86, v73 quad_perm:[2,2,2,2] row_mask:0xf bank_mask:0xf
    v_add_f32_dpp v74, v90, v74 quad_perm:[2,2,2,2] row_mask:0xf bank_mask:0xf
    v_add_f32_dpp v75, v94, v75 quad_perm:[2,2,2,2] row_mask:0xf bank_mask:0xf
    v_add_f32_dpp v76, v98, v76 quad_perm:[2,2,2,2] row_mask:0xf bank_mask:0xf
    v_add_f32_dpp v77, v102, v77 quad_perm:[2,2,2,2] row_mask:0xf bank_mask:0xf
    v_add_f32_dpp v78, v106, v78 quad_perm:[2,2,2,2] row_mask:0xf bank_mask:0xf
    v_add_f32_dpp v79, v110, v79 quad_perm:[2,2,2,2] row_mask:0xf bank_mask:0xf
    v_add_f32_dpp v72, v83, v72 quad_perm:[3,3,3,3] row_mask:0xf bank_mask:0xf
    v_add_f32_dpp v73, v87, v73 quad_perm:[3,3,3,3] row_mask:0xf bank_mask:0xf
    v_add_f32_dpp v74, v91, v74 quad_perm:[3,3,3,3] row_mask:0xf bank_mask:0xf
    v_add_f32_dpp v75, v95, v75 quad_perm:[3,3,3,3] row_mask:0xf bank_mask:0xf
    v_add_f32_dpp v76, v99, v76 quad_perm:[3,3,3,3] row_mask:0xf bank_mask:0xf
    v_add_f32_dpp v77, v103, v77 quad_perm:[3,3,3,3] row_mask:0xf bank_mask:0xf
    v_add_f32_dpp v78, v107, v78 quad_perm:[3,3,3,3] row_mask:0xf bank_mask:0xf
    v_add_f32_dpp v79, v111, v79 quad_perm:[3,3,3,3] row_mask:0xf bank_mask:0xf
    s_waitcnt vmcnt(23)
    v_mfma_f32_16x16x32_bf16 v[80:83], v[160:163], v[8:11], 0
    s_waitcnt vmcnt(22)
    v_mfma_f32_16x16x32_bf16 v[84:87], v[164:167], v[8:11], 0
    s_waitcnt vmcnt(21)
    v_mfma_f32_16x16x32_bf16 v[88:91], v[168:171], v[8:11], 0
    s_waitcnt vmcnt(20)
    v_mfma_f32_16x16x32_bf16 v[92:95], v[172:175], v[8:11], 0
    s_waitcnt vmcnt(19)
    v_mfma_f32_16x16x32_bf16 v[96:99], v[176:179], v[8:11], 0
    s_waitcnt vmcnt(18)
    v_mfma_f32_16x16x32_bf16 v[100:103], v[180:183], v[8:11], 0
    s_waitcnt vmcnt(17)
    v_mfma_f32_16x16x32_bf16 v[104:107], v[184:187], v[8:11], 0
    s_waitcnt vmcnt(16)
    v_mfma_f32_16x16x32_bf16 v[108:111], v[188:191], v[8:11], 0
    v_add_f32_dpp v112, v80, v81 quad_perm:[0,0,0,0] row_mask:0xf bank_mask:0xf
    v_add_f32_dpp v113, v84, v85 quad_perm:[0,0,0,0] row_mask:0xf bank_mask:0xf
    v_add_f32_dpp v114, v88, v89 quad_perm:[0,0,0,0] row_mask:0xf bank_mask:0xf
    v_add_f32_dpp v115, v92, v93 quad_perm:[0,0,0,0] row_mask:0xf bank_mask:0xf
    v_add_f32_dpp v116, v96, v97 quad_perm:[0,0,0,0] row_mask:0xf bank_mask:0xf
    v_add_f32_dpp v117, v100, v101 quad_perm:[0,0,0,0] row_mask:0xf bank_mask:0xf
    v_add_f32_dpp v118, v104, v105 quad_perm:[0,0,0,0] row_mask:0xf bank_mask:0xf
    s_nop 0
    v_add_f32_dpp v119, v108, v109 quad_perm:[0,0,0,0] row_mask:0xf bank_mask:0xf
    v_add_f32_dpp v112, v82, v112 quad_perm:[2,2,2,2] row_mask:0xf bank_mask:0xf
    v_add_f32_dpp v113, v86, v113 quad_perm:[2,2,2,2] row_mask:0xf bank_mask:0xf
    v_add_f32_dpp v114, v90, v114 quad_perm:[2,2,2,2] row_mask:0xf bank_mask:0xf
    v_add_f32_dpp v115, v94, v115 quad_perm:[2,2,2,2] row_mask:0xf bank_mask:0xf
    v_add_f32_dpp v116, v98, v116 quad_perm:[2,2,2,2] row_mask:0xf bank_mask:0xf
    v_add_f32_dpp v117, v102, v117 quad_perm:[2,2,2,2] row_mask:0xf bank_mask:0xf
    v_add_f32_dpp v118, v106, v118 quad_perm:[2,2,2,2] row_mask:0xf bank_mask:0xf
    v_add_f32_dpp v119, v110, v119 quad_perm:[2,2,2,2] row_mask:0xf bank_mask:0xf
    v_add_f32_dpp v112, v83, v112 quad_perm:[3,3,3,3] row_mask:0xf bank_mask:0xf
    v_add_f32_dpp v113, v87, v113 quad_perm:[3,3,3,3] row_mask:0xf bank_mask:0xf
    v_add_f32_dpp v114, v91, v114 quad_perm:[3,3,3,3] row_mask:0xf bank_mask:0xf
    v_add_f32_dpp v115, v95, v115 quad_perm:[3,3,3,3] row_mask:0xf bank_mask:0xf
    v_add_f32_dpp v116, v99, v116 quad_perm:[3,3,3,3] row_mask:0xf bank_mask:0xf
    v_add_f32_dpp v117, v103, v117 quad_perm:[3,3,3,3] row_mask:0xf bank_mask:0xf
    v_add_f32_dpp v118, v107, v118 quad_perm:[3,3,3,3] row_mask:0xf bank_mask:0xf
    v_add_f32_dpp v119, v111, v119 quad_perm:[3,3,3,3] row_mask:0xf bank_mask:0xf
    v_cndmask_b32 v72, v72, v112, s[64:65]
    v_cndmask_b32 v73, v73, v113, s[64:65]
    v_cndmask_b32 v74, v74, v114, s[64:65]
    v_cndmask_b32 v75, v75, v115, s[64:65]
    v_cndmask_b32 v76, v76, v116, s[64:65]
    v_cndmask_b32 v77, v77, v117, s[64:65]
    v_cndmask_b32 v78, v78, v118, s[64:65]
    v_cndmask_b32 v79, v79, v119, s[64:65]
    s_waitcnt vmcnt(15)
    v_mfma_f32_16x16x32_bf16 v[80:83], v[192:195], v[8:11], 0
    s_waitcnt vmcnt(14)
    v_mfma_f32_16x16x32_bf16 v[84:87], v[196:199], v[8:11], 0
    s_waitcnt vmcnt(13)
    v_mfma_f32_16x16x32_bf16 v[88:91], v[200:203], v[8:11], 0
    s_waitcnt vmcnt(12)
    v_mfma_f32_16x16x32_bf16 v[92:95], v[204:207], v[8:11], 0
    s_waitcnt vmcnt(11)
    v_mfma_f32_16x16x32_bf16 v[96:99], v[208:211], v[8:11], 0
    s_waitcnt vmcnt(10)
    v_mfma_f32_16x16x32_bf16 v[100:103], v[212:215], v[8:11], 0
    s_waitcnt vmcnt(9)
    v_mfma_f32_16x16x32_bf16 v[104:107], v[216:219], v[8:11], 0
    s_waitcnt vmcnt(8)
    v_mfma_f32_16x16x32_bf16 v[108:111], v[220:223], v[8:11], 0
    v_add_f32_dpp v112, v80, v82 quad_perm:[0,0,0,0] row_mask:0xf bank_mask:0xf
    v_add_f32_dpp v113, v84, v86 quad_perm:[0,0,0,0] row_mask:0xf bank_mask:0xf
    v_add_f32_dpp v114, v88, v90 quad_perm:[0,0,0,0] row_mask:0xf bank_mask:0xf
    v_add_f32_dpp v115, v92, v94 quad_perm:[0,0,0,0] row_mask:0xf bank_mask:0xf
    v_add_f32_dpp v116, v96, v98 quad_perm:[0,0,0,0] row_mask:0xf bank_mask:0xf
    v_add_f32_dpp v117, v100, v102 quad_perm:[0,0,0,0] row_mask:0xf bank_mask:0xf
    v_add_f32_dpp v118, v104, v106 quad_perm:[0,0,0,0] row_mask:0xf bank_mask:0xf
    s_nop 0
    v_add_f32_dpp v119, v108, v110 quad_perm:[0,0,0,0] row_mask:0xf bank_mask:0xf
    v_add_f32_dpp v112, v81, v112 quad_perm:[1,1,1,1] row_mask:0xf bank_mask:0xf
    v_add_f32_dpp v113, v85, v113 quad_perm:[1,1,1,1] row_mask:0xf bank_mask:0xf
    v_add_f32_dpp v114, v89, v114 quad_perm:[1,1,1,1] row_mask:0xf bank_mask:0xf
    v_add_f32_dpp v115, v93, v115 quad_perm:[1,1,1,1] row_mask:0xf bank_mask:0xf
    v_add_f32_dpp v116, v97, v116 quad_perm:[1,1,1,1] row_mask:0xf bank_mask:0xf
    v_add_f32_dpp v117, v101, v117 quad_perm:[1,1,1,1] row_mask:0xf bank_mask:0xf
    v_add_f32_dpp v118, v105, v118 quad_perm:[1,1,1,1] row_mask:0xf bank_mask:0xf
    v_add_f32_dpp v119, v109, v119 quad_perm:[1,1,1,1] row_mask:0xf bank_mask:0xf
    v_add_f32_dpp v112, v83, v112 quad_perm:[3,3,3,3] row_mask:0xf bank_mask:0xf
    v_add_f32_dpp v113, v87, v113 quad_perm:[3,3,3,3] row_mask:0xf bank_mask:0xf
    v_add_f32_dpp v114, v91, v114 quad_perm:[3,3,3,3] row_mask:0xf bank_mask:0xf
    v_add_f32_dpp v115, v95, v115 quad_perm:[3,3,3,3] row_mask:0xf bank_mask:0xf
    v_add_f32_dpp v116, v99, v116 quad_perm:[3,3,3,3] row_mask:0xf bank_mask:0xf
    v_add_f32_dpp v117, v103, v117 quad_perm:[3,3,3,3] row_mask:0xf bank_mask:0xf
    v_add_f32_dpp v118, v107, v118 quad_perm:[3,3,3,3] row_mask:0xf bank_mask:0xf
    v_add_f32_dpp v119, v111, v119 quad_perm:[3,3,3,3] row_mask:0xf bank_mask:0xf
    v_cndmask_b32 v72, v72, v112, s[66:67]
    v_cndmask_b32 v73, v73, v113, s[66:67]
    v_cndmask_b32 v74, v74, v114, s[66:67]
    v_cndmask_b32 v75, v75, v115, s[66:67]
    v_cndmask_b32 v76, v76, v116, s[66:67]
    v_cndmask_b32 v77, v77, v117, s[66:67]
    v_cndmask_b32 v78, v78, v118, s[66:67]
    v_cndmask_b32 v79, v79, v119, s[66:67]
    s_waitcnt vmcnt(7)
    v_mfma_f32_16x16x32_bf16 v[80:83], v[224:227], v[8:11], 0
    s_waitcnt vmcnt(6)
    v_mfma_f32_16x16x32_bf16 v[84:87], v[228:231], v[8:11], 0
    s_waitcnt vmcnt(5)
    v_mfma_f32_16x16x32_bf16 v[88:91], v[232:235], v[8:11], 0
    s_waitcnt vmcnt(4)
    v_mfma_f32_16x16x32_bf16 v[92:95], v[236:239], v[8:11], 0
    s_waitcnt vmcnt(3)
    v_mfma_f32_16x16x32_bf16 v[96:99], v[240:243], v[8:11], 0
    s_waitcnt vmcnt(2)
    v_mfma_f32_16x16x32_bf16 v[100:103], v[244:247], v[8:11], 0
    s_waitcnt vmcnt(1)
    v_mfma_f32_16x16x32_bf16 v[104:107], v[248:251], v[8:11], 0
    s_waitcnt vmcnt(0)
    v_mfma_f32_16x16x32_bf16 v[108:111], v[252:255], v[8:11], 0
    v_add_f32_dpp v112, v80, v83 quad_perm:[0,0,0,0] row_mask:0xf bank_mask:0xf
    v_add_f32_dpp v113, v84, v87 quad_perm:[0,0,0,0] row_mask:0xf bank_mask:0xf
    v_add_f32_dpp v114, v88, v91 quad_perm:[0,0,0,0] row_mask:0xf bank_mask:0xf
    v_add_f32_dpp v115, v92, v95 quad_perm:[0,0,0,0] row_mask:0xf bank_mask:0xf
    v_add_f32_dpp v116, v96, v99 quad_perm:[0,0,0,0] row_mask:0xf bank_mask:0xf
    v_add_f32_dpp v117, v100, v103 quad_perm:[0,0,0,0] row_mask:0xf bank_mask:0xf
    v_add_f32_dpp v118, v104, v107 quad_perm:[0,0,0,0] row_mask:0xf bank_mask:0xf
    s_nop 0
    v_add_f32_dpp v119, v108, v111 quad_perm:[0,0,0,0] row_mask:0xf bank_mask:0xf
    v_add_f32_dpp v112, v81, v112 quad_perm:[1,1,1,1] row_mask:0xf bank_mask:0xf
    v_add_f32_dpp v113, v85, v113 quad_perm:[1,1,1,1] row_mask:0xf bank_mask:0xf
    v_add_f32_dpp v114, v89, v114 quad_perm:[1,1,1,1] row_mask:0xf bank_mask:0xf
    v_add_f32_dpp v115, v93, v115 quad_perm:[1,1,1,1] row_mask:0xf bank_mask:0xf
    v_add_f32_dpp v116, v97, v116 quad_perm:[1,1,1,1] row_mask:0xf bank_mask:0xf
    v_add_f32_dpp v117, v101, v117 quad_perm:[1,1,1,1] row_mask:0xf bank_mask:0xf
    v_add_f32_dpp v118, v105, v118 quad_perm:[1,1,1,1] row_mask:0xf bank_mask:0xf
    v_add_f32_dpp v119, v109, v119 quad_perm:[1,1,1,1] row_mask:0xf bank_mask:0xf
    v_add_f32_dpp v112, v82, v112 quad_perm:[2,2,2,2] row_mask:0xf bank_mask:0xf
    v_add_f32_dpp v113, v86, v113 quad_perm:[2,2,2,2] row_mask:0xf bank_mask:0xf
    v_add_f32_dpp v114, v90, v114 quad_perm:[2,2,2,2] row_mask:0xf bank_mask:0xf
    v_add_f32_dpp v115, v94, v115 quad_perm:[2,2,2,2] row_mask:0xf bank_mask:0xf
    v_add_f32_dpp v116, v98, v116 quad_perm:[2,2,2,2] row_mask:0xf bank_mask:0xf
    v_add_f32_dpp v117, v102, v117 quad_perm:[2,2,2,2] row_mask:0xf bank_mask:0xf
    v_add_f32_dpp v118, v106, v118 quad_perm:[2,2,2,2] row_mask:0xf bank_mask:0xf
    v_add_f32_dpp v119, v110, v119 quad_perm:[2,2,2,2] row_mask:0xf bank_mask:0xf
    v_cndmask_b32 v72, v72, v112, s[68:69]
    v_cndmask_b32 v73, v73, v113, s[68:69]
    v_cndmask_b32 v74, v74, v114, s[68:69]
    v_cndmask_b32 v75, v75, v115, s[68:69]
    v_cndmask_b32 v76, v76, v116, s[68:69]
    v_cndmask_b32 v77, v77, v117, s[68:69]
    v_cndmask_b32 v78, v78, v118, s[68:69]
    v_cndmask_b32 v79, v79, v119, s[68:69]
    s_mov_b32 s71, 0x3e0293ee
    v_mul_f32 v72, s71, v72
    v_mul_f32 v73, s71, v73
    v_mul_f32 v74, s71, v74
    v_mul_f32 v75, s71, v75
    v_mul_f32 v76, s71, v76
    v_mul_f32 v77, s71, v77
    v_mul_f32 v78, s71, v78
    v_mul_f32 v79, s71, v79
    v_cvt_pk_bf16_f32 v4, v72, v73
    v_cvt_pk_bf16_f32 v5, v74, v75
    v_cvt_pk_bf16_f32 v6, v76, v77
    v_cvt_pk_bf16_f32 v7, v78, v79
    s_lshl_b32 s24, s26, 10
    s_lshl_b32 s25, s3, 8
    s_add_u32 s24, s24, s25
    s_add_u32 s24, s24, 0x0
    buffer_store_dwordx4 v[4:7], v66, s[12:15], s24 offen sc1
    s_mov_b32 s8, s56
    s_mov_b32 s9, s57
    s_mov_b32 s10, 0x400000
    s_mov_b32 s11, 0x20000
    s_and_b32 s24, s3, 1
    s_lshl_b32 s24, s24, 1
    s_and_b32 s25, s3, 2
    s_lshl_b32 s25, s25, 3
    s_or_b32 s25, s25, s24
    s_and_b32 s24, s26, 13
    s_or_b32 s25, s25, s24
    s_lshl_b32 s25, s25, 17
    s_lshr_b32 s24, s74, 3
    s_lshl_b32 s24, s24, 7
    s_add_u32 s24, s24, s25
    v_lshrrev_b32 v3, 4, v0
    v_lshlrev_b32 v3, 15, v3
    v_and_b32 v4, 8, v0
    v_lshl_add_u32 v3, v4, 10, v3
    v_and_b32 v4, 0x70, v2
    v_add_u32 v3, v3, v4
    s_mul_i32 m0, s3, 16896
    s_nop 0
    buffer_load_dwordx4 v3, s[8:11], s24 offen nt lds
    s_add_u32 m0, m0, 1056
    s_add_u32 s24, s24, 2048
    buffer_load_dwordx4 v3, s[8:11], s24 offen nt lds
    s_add_u32 m0, m0, 1056
    s_add_u32 s24, s24, 2048
    buffer_load_dwordx4 v3, s[8:11], s24 offen nt lds
    s_add_u32 m0, m0, 1056
    s_add_u32 s24, s24, 2048
    buffer_load_dwordx4 v3, s[8:11], s24 offen nt lds
    s_add_u32 m0, m0, 1056
    s_add_u32 s24, s24, 10240
    buffer_load_dwordx4 v3, s[8:11], s24 offen nt lds
    s_add_u32 m0, m0, 1056
    s_add_u32 s24, s24, 2048
    buffer_load_dwordx4 v3, s[8:11], s24 offen nt lds
    s_add_u32 m0, m0, 1056
    s_add_u32 s24, s24, 2048
    buffer_load_dwordx4 v3, s[8:11], s24 offen nt lds
    s_add_u32 m0, m0, 1056
    s_add_u32 s24, s24, 2048
    buffer_load_dwordx4 v3, s[8:11], s24 offen nt lds
    s_add_u32 m0, m0, 1056
    s_add_u32 s24, s24, -21504
    buffer_load_dwordx4 v3, s[8:11], s24 offen nt lds
    s_add_u32 m0, m0, 1056
    s_add_u32 s24, s24, 2048
    buffer_load_dwordx4 v3, s[8:11], s24 offen nt lds
    s_add_u32 m0, m0, 1056
    s_add_u32 s24, s24, 2048
    buffer_load_dwordx4 v3, s[8:11], s24 offen nt lds
    s_add_u32 m0, m0, 1056
    s_add_u32 s24, s24, 2048
    buffer_load_dwordx4 v3, s[8:11], s24 offen nt lds
    s_add_u32 m0, m0, 1056
    s_add_u32 s24, s24, 10240
    buffer_load_dwordx4 v3, s[8:11], s24 offen nt lds
    s_add_u32 m0, m0, 1056
    s_add_u32 s24, s24, 2048
    buffer_load_dwordx4 v3, s[8:11], s24 offen nt lds
    s_add_u32 m0, m0, 1056
    s_add_u32 s24, s24, 2048
    buffer_load_dwordx4 v3, s[8:11], s24 offen nt lds
    s_add_u32 m0, m0, 1056
    s_add_u32 s24, s24, 2048
    buffer_load_dwordx4 v3, s[8:11], s24 offen nt lds
    s_waitcnt vmcnt(0)
    s_barrier
    s_cmp_lg_u32 s3, 0
    s_cbranch_scc1 L_sig10
    s_mov_b64 exec, 1
    v_mov_b32 v3, 1
    buffer_atomic_add v3, off, s[16:19], 0 offset:0 sc0
    s_waitcnt vmcnt(0)
    v_readfirstlane_b32 s24, v3
    s_mov_b64 exec, -1
    s_and_b32 s24, s24, 63
    s_cmp_lg_u32 s24, 63
    s_cbranch_scc1 L_sig10
    v_lshlrev_b32 v4, 7, v0
    v_mov_b32 v3, 1
    s_mov_b32 s24, 0x170000
    buffer_store_dword v3, v4, s[12:15], s24 offen offset:0 sc1
L_sig10:
    v_lshrrev_b32 v3, 2, v0
    v_mul_u32_u24 v3, 1056, v3
    v_and_b32 v4, 3, v0
    v_lshl_add_u32 v3, v4, 3, v3
    s_lshl_b32 s24, s3, 5
    v_add_u32 v3, s24, v3
    ds_read_b64_tr_b16 a[128:129], v3 offset:0
    ds_read_b64_tr_b16 a[130:131], v3 offset:128
    ds_read_b64_tr_b16 a[132:133], v3 offset:256
    ds_read_b64_tr_b16 a[134:135], v3 offset:384
    ds_read_b64_tr_b16 a[136:137], v3 offset:512
    ds_read_b64_tr_b16 a[138:139], v3 offset:640
    ds_read_b64_tr_b16 a[140:141], v3 offset:768
    ds_read_b64_tr_b16 a[142:143], v3 offset:896
    ds_read_b64_tr_b16 a[144:145], v3 offset:16896
    ds_read_b64_tr_b16 a[146:147], v3 offset:17024
    ds_read_b64_tr_b16 a[148:149], v3 offset:17152
    ds_read_b64_tr_b16 a[150:151], v3 offset:17280
    ds_read_b64_tr_b16 a[152:153], v3 offset:17408
    ds_read_b64_tr_b16 a[154:155], v3 offset:17536
    ds_read_b64_tr_b16 a[156:157], v3 offset:17664
    ds_read_b64_tr_b16 a[158:159], v3 offset:17792
    ds_read_b64_tr_b16 a[160:161], v3 offset:33792
    ds_read_b64_tr_b16 a[162:163], v3 offset:33920
    ds_read_b64_tr_b16 a[164:165], v3 offset:34048
    ds_read_b64_tr_b16 a[166:167], v3 offset:34176
    ds_read_b64_tr_b16 a[168:169], v3 offset:34304
    ds_read_b64_tr_b16 a[170:171], v3 offset:34432
    ds_read_b64_tr_b16 a[172:173], v3 offset:34560
    ds_read_b64_tr_b16 a[174:175], v3 offset:34688
    ds_read_b64_tr_b16 a[176:177], v3 offset:50688
    ds_read_b64_tr_b16 a[178:179], v3 offset:50816
    ds_read_b64_tr_b16 a[180:181], v3 offset:50944
    ds_read_b64_tr_b16 a[182:183], v3 offset:51072
    ds_read_b64_tr_b16 a[184:185], v3 offset:51200
    ds_read_b64_tr_b16 a[186:187], v3 offset:51328
    ds_read_b64_tr_b16 a[188:189], v3 offset:51456
    ds_read_b64_tr_b16 a[190:191], v3 offset:51584
    s_mov_b32 s4, s44
    s_mov_b32 s5, s45
    s_mov_b32 s6, 0x400000
    s_mov_b32 s7, 0x20000
    s_mov_b32 s8, s46
    s_mov_b32 s9, s47
    s_mov_b32 s10, 0x400000
    s_mov_b32 s11, 0x20000
    s_mov_b32 s32, s35
    buffer_load_dwordx4 v[128:131], v18, s[4:7], s32 offen nt
    s_add_u32 s32, s32, 8192
    buffer_load_dwordx4 v[132:135], v18, s[4:7], s32 offen nt
    s_add_u32 s32, s32, 8192
    buffer_load_dwordx4 v[136:139], v18, s[4:7], s32 offen nt
    s_add_u32 s32, s32, 8192
    buffer_load_dwordx4 v[140:143], v18, s[4:7], s32 offen nt
    s_add_u32 s32, s32, 8192
    buffer_load_dwordx4 v[144:147], v18, s[4:7], s32 offen nt
    s_add_u32 s32, s32, 8192
    buffer_load_dwordx4 v[148:151], v18, s[4:7], s32 offen nt
    s_add_u32 s32, s32, 8192
    buffer_load_dwordx4 v[152:155], v18, s[4:7], s32 offen nt
    s_add_u32 s32, s32, 8192
    buffer_load_dwordx4 v[156:159], v18, s[4:7], s32 offen nt
    s_add_u32 s32, s32, 8192
    buffer_load_dwordx4 v[160:163], v18, s[4:7], s32 offen nt
    s_add_u32 s32, s32, 8192
    buffer_load_dwordx4 v[164:167], v18, s[4:7], s32 offen nt
    s_add_u32 s32, s32, 8192
    buffer_load_dwordx4 v[168:171], v18, s[4:7], s32 offen nt
    s_add_u32 s32, s32, 8192
    buffer_load_dwordx4 v[172:175], v18, s[4:7], s32 offen nt
    s_add_u32 s32, s32, 8192
    buffer_load_dwordx4 v[176:179], v18, s[4:7], s32 offen nt
    s_add_u32 s32, s32, 8192
    buffer_load_dwordx4 v[180:183], v18, s[4:7], s32 offen nt
    s_add_u32 s32, s32, 8192
    buffer_load_dwordx4 v[184:187], v18, s[4:7], s32 offen nt
    s_add_u32 s32, s32, 8192
    buffer_load_dwordx4 v[188:191], v18, s[4:7], s32 offen nt
    s_add_u32 s32, s32, 8192
    buffer_load_dwordx4 v[192:195], v18, s[4:7], s32 offen nt
    s_add_u32 s32, s32, 8192
    buffer_load_dwordx4 v[196:199], v18, s[4:7], s32 offen nt
    s_add_u32 s32, s32, 8192
    buffer_load_dwordx4 v[200:203], v18, s[4:7], s32 offen nt
    s_add_u32 s32, s32, 8192
    buffer_load_dwordx4 v[204:207], v18, s[4:7], s32 offen nt
    s_add_u32 s32, s32, 8192
    buffer_load_dwordx4 v[208:211], v18, s[4:7], s32 offen nt
    s_add_u32 s32, s32, 8192
    buffer_load_dwordx4 v[212:215], v18, s[4:7], s32 offen nt
    s_add_u32 s32, s32, 8192
    buffer_load_dwordx4 v[216:219], v18, s[4:7], s32 offen nt
    s_add_u32 s32, s32, 8192
    buffer_load_dwordx4 v[220:223], v18, s[4:7], s32 offen nt
    s_add_u32 s32, s32, 8192
    buffer_load_dwordx4 v[224:227], v18, s[4:7], s32 offen nt
    s_add_u32 s32, s32, 8192
    buffer_load_dwordx4 v[228:231], v18, s[4:7], s32 offen nt
    s_add_u32 s32, s32, 8192
    buffer_load_dwordx4 v[232:235], v18, s[4:7], s32 offen nt
    s_add_u32 s32, s32, 8192
    buffer_load_dwordx4 v[236:239], v18, s[4:7], s32 offen nt
    s_add_u32 s32, s32, 8192
    buffer_load_dwordx4 v[240:243], v18, s[4:7], s32 offen nt
    s_add_u32 s32, s32, 8192
    buffer_load_dwordx4 v[244:247], v18, s[4:7], s32 offen nt
    s_add_u32 s32, s32, 8192
    buffer_load_dwordx4 v[248:251], v18, s[4:7], s32 offen nt
    s_add_u32 s32, s32, 8192
    buffer_load_dwordx4 v[252:255], v18, s[4:7], s32 offen nt
    s_add_u32 s32, s32, 8192
    s_lshl_b32 s33, s26, 17
    s_lshl_b32 s24, s3, 15
    s_add_u32 s33, s33, s24
    s_mul_i32 s34, s3, 33792
    s_waitcnt lgkmcnt(0)
    s_barrier
    s_mov_b32 s70, 0
L_woA:
    s_and_b32 s24, s70, 3
    s_lshl_b32 s24, s24, 1
    s_lshr_b32 s25, s70, 2
    s_or_b32 s24, s24, s25
    s_lshl_b32 s24, s24, 10
    s_add_u32 s24, s24, s33
    s_mul_i32 s25, s70, 4224
    s_add_u32 m0, s25, s34
    s_waitcnt vmcnt(24)
    buffer_load_dwordx4 v2, s[8:11], s24 offen nt lds
    s_add_u32 m0, m0, 1056
    s_add_u32 s24, s24, 8192
    s_waitcnt vmcnt(24)
    buffer_load_dwordx4 v2, s[8:11], s24 offen nt lds
    s_add_u32 m0, m0, 1056
    s_add_u32 s24, s24, 8192
    s_waitcnt vmcnt(24)
    buffer_load_dwordx4 v2, s[8:11], s24 offen nt lds
    s_add_u32 m0, m0, 1056
    s_add_u32 s24, s24, 8192
    s_waitcnt vmcnt(24)
    buffer_load_dwordx4 v2, s[8:11], s24 offen nt lds
    s_add_u32 s70, s70, 1
    s_cmp_lt_u32 s70, 8
    s_cbranch_scc1 L_woA
    s_waitcnt vmcnt(0)
    s_barrier
    v_lshrrev_b32 v3, 2, v0
    v_mul_u32_u24 v3, 1056, v3
    v_and_b32 v4, 3, v0
    v_lshl_add_u32 v3, v4, 3, v3
    s_lshl_b32 s24, s3, 8
    v_add_u32 v3, s24, v3
    v_add_u32 v4, 67584, v3
    ds_read_b64_tr_b16 a[0:1], v3 offset:0
    ds_read_b64_tr_b16 a[2:3], v3 offset:16896
    ds_read_b64_tr_b16 a[4:5], v3 offset:33792
    ds_read_b64_tr_b16 a[6:7], v3 offset:50688
    ds_read_b64_tr_b16 a[8:9], v4 offset:0
    ds_read_b64_tr_b16 a[10:11], v4 offset:16896
    ds_read_b64_tr_b16 a[12:13], v4 offset:33792
    ds_read_b64_tr_b16 a[14:15], v4 offset:50688
    ds_read_b64_tr_b16 a[16:17], v3 offset:32
    ds_read_b64_tr_b16 a[18:19], v3 offset:16928
    ds_read_b64_tr_b16 a[20:21], v3 offset:33824
    ds_read_b64_tr_b16 a[22:23], v3 offset:50720
    ds_read_b64_tr_b16 a[24:25], v4 offset:32
    ds_read_b64_tr_b16 a[26:27], v4 offset:16928
    ds_read_b64_tr_b16 a[28:29], v4 offset:33824
    ds_read_b64_tr_b16 a[30:31], v4 offset:50720
    ds_read_b64_tr_b16 a[32:33], v3 offset:64
    ds_read_b64_tr_b16 a[34:35], v3 offset:16960
    ds_read_b64_tr_b16 a[36:37], v3 offset:33856
    ds_read_b64_tr_b16 a[38:39], v3 offset:50752
    ds_read_b64_tr_b16 a[40:41], v4 offset:64
    ds_read_b64_tr_b16 a[42:43], v4 offset:16960
    ds_read_b64_tr_b16 a[44:45], v4 offset:33856
    ds_read_b64_tr_b16 a[46:47], v4 offset:50752
    ds_read_b64_tr_b16 a[48:49], v3 offset:96
    ds_read_b64_tr_b16 a[50:51], v3 offset:16992
    ds_read_b64_tr_b16 a[52:53], v3 offset:33888
    ds_read_b64_tr_b16 a[54:55], v3 offset:50784
    ds_read_b64_tr_b16 a[56:57], v4 offset:96
    ds_read_b64_tr_b16 a[58:59], v4 offset:16992
    ds_read_b64_tr_b16 a[60:61], v4 offset:33888
    ds_read_b64_tr_b16 a[62:63], v4 offset:50784
    ds_read_b64_tr_b16 a[64:65], v3 offset:128
    ds_read_b64_tr_b16 a[66:67], v3 offset:17024
    ds_read_b64_tr_b16 a[68:69], v3 offset:33920
    ds_read_b64_tr_b16 a[70:71], v3 offset:50816
    ds_read_b64_tr_b16 a[72:73], v4 offset:128
    ds_read_b64_tr_b16 a[74:75], v4 offset:17024
    ds_read_b64_tr_b16 a[76:77], v4 offset:33920
    ds_read_b64_tr_b16 a[78:79], v4 offset:50816
    ds_read_b64_tr_b16 a[80:81], v3 offset:160
    ds_read_b64_tr_b16 a[82:83], v3 offset:17056
    ds_read_b64_tr_b16 a[84:85], v3 offset:33952
    ds_read_b64_tr_b16 a[86:87], v3 offset:50848
    ds_read_b64_tr_b16 a[88:89], v4 offset:160
    ds_read_b64_tr_b16 a[90:91], v4 offset:17056
    ds_read_b64_tr_b16 a[92:93], v4 offset:33952
    ds_read_b64_tr_b16 a[94:95], v4 offset:50848
    ds_read_b64_tr_b16 a[96:97], v3 offset:192
    ds_read_b64_tr_b16 a[98:99], v3 offset:17088
    ds_read_b64_tr_b16 a[100:101], v3 offset:33984
    ds_read_b64_tr_b16 a[102:103], v3 offset:50880
    ds_read_b64_tr_b16 a[104:105], v4 offset:192
    ds_read_b64_tr_b16 a[106:107], v4 offset:17088
    ds_read_b64_tr_b16 a[108:109], v4 offset:33984
    ds_read_b64_tr_b16 a[110:111], v4 offset:50880
    ds_read_b64_tr_b16 a[112:113], v3 offset:224
    ds_read_b64_tr_b16 a[114:115], v3 offset:17120
    ds_read_b64_tr_b16 a[116:117], v3 offset:34016
    ds_read_b64_tr_b16 a[118:119], v3 offset:50912
    ds_read_b64_tr_b16 a[120:121], v4 offset:224
    ds_read_b64_tr_b16 a[122:123], v4 offset:17120
    ds_read_b64_tr_b16 a[124:125], v4 offset:34016
    ds_read_b64_tr_b16 a[126:127], v4 offset:50912
    s_waitcnt lgkmcnt(0)
    s_cmp_lg_u32 s3, 0
    s_cbranch_scc1 L_awx11
    s_mov_b32 s24, 262144
    s_mov_b64 exec, 1
L_aw12:
    buffer_load_dword v1, off, s[12:15], s73 offset:0 sc1
    s_waitcnt vmcnt(0)
    v_readfirstlane_b32 s25, v1
    s_nop 0
    s_cmp_eq_u32 s25, 1
    s_cbranch_scc1 L_awx11
    s_sleep 4
    s_sub_u32 s24, s24, 1
    s_cmp_lg_u32 s24, 0
    s_cbranch_scc1 L_aw12
L_awx11:
    s_mov_b64 exec, -1
    s_barrier
    s_cmp_lg_u32 s3, 0
    s_cbranch_scc1 L_xi13
    s_and_b32 s24, s74, 7
    s_lshl_b32 s24, s24, 5
    s_lshr_b32 s25, s74, 3
    s_add_u32 s24, s24, s25
    s_lshl_b32 s24, s24, 2
    s_add_u32 s24, s24, 0x1b6000
    s_getreg_b32 s25, hwreg(HW_REG_XCC_ID, 0, 4)
    s_mov_b64 exec, 1
    v_mov_b32 v3, s25
    buffer_store_dword v3, off, s[12:15], s24 sc1
    s_mov_b64 exec, -1
L_xi13:
    s_cmp_lg_u32 s3, 0
    s_cbranch_scc1 L_awx14
    s_mov_b32 s24, 262144
    s_mov_b64 exec, 1
L_aw15:
    buffer_load_dword v1, off, s[12:15], s73 offset:4 sc1
    s_waitcnt vmcnt(0)
    v_readfirstlane_b32 s25, v1
    s_nop 0
    s_cmp_eq_u32 s25, 1
    s_cbranch_scc1 L_awx14
    s_sleep 4
    s_sub_u32 s24, s24, 1
    s_cmp_lg_u32 s24, 0
    s_cbranch_scc1 L_aw15
L_awx14:
    s_mov_b64 exec, -1
    s_barrier
    s_lshl_b32 s24, s3, 10
    s_lshl_b32 s25, s26, 3
    s_add_u32 s25, s25, s24
    s_add_u32 s25, s25, 0x120000
    v_and_b32 v3, 3, v0
    v_lshlrev_b32 v3, 8, v3
    buffer_load_dwordx2 v[4:5], v3, s[12:15], s25 offen sc1
    s_lshl_b32 s24, s3, 17
    s_lshl_b32 s25, s26, 10
    s_add_u32 s24, s24, s25
    s_add_u32 s24, s24, 0x20000
    buffer_load_dwordx4 v[72:75], v2, s[12:15], s24 offen sc1 nt
    s_add_u32 s24, s24, 0x8000
    buffer_load_dwordx4 v[76:79], v2, s[12:15], s24 offen sc1 nt
    s_add_u32 s24, s24, 0x8000
    buffer_load_dwordx4 v[80:83], v2, s[12:15], s24 offen sc1 nt
    s_add_u32 s24, s24, 0x8000
    buffer_load_dwordx4 v[84:87], v2, s[12:15], s24 offen sc1 nt
    s_add_u32 s24, s24, 0x8000
    s_waitcnt vmcnt(4)
    v_mov_b32 v6, v4
    s_nop 1
    v_max_f32_dpp v6, v6, v6 row_ror:2 row_mask:0xf bank_mask:0xf
    s_nop 1
    v_max_f32_dpp v6, v6, v6 row_ror:1 row_mask:0xf bank_mask:0xf
    v_sub_f32 v4, v4, v6
    v_exp_f32 v4, v4
    s_nop 0
    v_mul_f32 v5, v4, v5
    s_nop 1
    v_add_f32_dpp v5, v5, v5 row_ror:2 row_mask:0xf bank_mask:0xf
    s_nop 1
    v_add_f32_dpp v5, v5, v5 row_ror:1 row_mask:0xf bank_mask:0xf
    v_rcp_f32 v5, v5
    s_nop 0
    v_mul_f32 v4, v4, v5
    s_nop 0
    v_readlane_b32 s24, v4, 0
    s_waitcnt vmcnt(3)
    v_lshlrev_b32 v5, 16, v72
    v_and_b32 v6, 0xffff0000, v72
    v_mul_f32 v104, s24, v5
    v_mul_f32 v105, s24, v6
    v_lshlrev_b32 v5, 16, v73
    v_and_b32 v6, 0xffff0000, v73
    v_mul_f32 v106, s24, v5
    v_mul_f32 v107, s24, v6
    v_lshlrev_b32 v5, 16, v74
    v_and_b32 v6, 0xffff0000, v74
    v_mul_f32 v108, s24, v5
    v_mul_f32 v109, s24, v6
    v_lshlrev_b32 v5, 16, v75
    v_and_b32 v6, 0xffff0000, v75
    v_mul_f32 v110, s24, v5
    v_mul_f32 v111, s24, v6
    v_readlane_b32 s24, v4, 1
    s_waitcnt vmcnt(2)
    v_lshlrev_b32 v5, 16, v76
    v_and_b32 v6, 0xffff0000, v76
    v_fmac_f32 v104, s24, v5
    v_fmac_f32 v105, s24, v6
    v_lshlrev_b32 v5, 16, v77
    v_and_b32 v6, 0xffff0000, v77
    v_fmac_f32 v106, s24, v5
    v_fmac_f32 v107, s24, v6
    v_lshlrev_b32 v5, 16, v78
    v_and_b32 v6, 0xffff0000, v78
    v_fmac_f32 v108, s24, v5
    v_fmac_f32 v109, s24, v6
    v_lshlrev_b32 v5, 16, v79
    v_and_b32 v6, 0xffff0000, v79
    v_fmac_f32 v110, s24, v5
    v_fmac_f32 v111, s24, v6
    v_readlane_b32 s24, v4, 2
    s_waitcnt vmcnt(1)
    v_lshlrev_b32 v5, 16, v80
    v_and_b32 v6, 0xffff0000, v80
    v_fmac_f32 v104, s24, v5
    v_fmac_f32 v105, s24, v6
    v_lshlrev_b32 v5, 16, v81
    v_and_b32 v6, 0xffff0000, v81
    v_fmac_f32 v106, s24, v5
    v_fmac_f32 v107, s24, v6
    v_lshlrev_b32 v5, 16, v82
    v_and_b32 v6, 0xffff0000, v82
    v_fmac_f32 v108, s24, v5
    v_fmac_f32 v109, s24, v6
    v_lshlrev_b32 v5, 16, v83
    v_and_b32 v6, 0xffff0000, v83
    v_fmac_f32 v110, s24, v5
    v_fmac_f32 v111, s24, v6
    v_readlane_b32 s24, v4, 3
    s_waitcnt vmcnt(0)
    v_lshlrev_b32 v5, 16, v84
    v_and_b32 v6, 0xffff0000, v84
    v_fmac_f32 v104, s24, v5
    v_fmac_f32 v105, s24, v6
    v_lshlrev_b32 v5, 16, v85
    v_and_b32 v6, 0xffff0000, v85
    v_fmac_f32 v106, s24, v5
    v_fmac_f32 v107, s24, v6
    v_lshlrev_b32 v5, 16, v86
    v_and_b32 v6, 0xffff0000, v86
    v_fmac_f32 v108, s24, v5
    v_fmac_f32 v109, s24, v6
    v_lshlrev_b32 v5, 16, v87
    v_and_b32 v6, 0xffff0000, v87
    v_fmac_f32 v110, s24, v5
    v_fmac_f32 v111, s24, v6
    v_cvt_pk_bf16_f32 v4, v104, v105
    v_cvt_pk_bf16_f32 v5, v106, v107
    v_cvt_pk_bf16_f32 v6, v108, v109
    v_cvt_pk_bf16_f32 v7, v110, v111
    s_lshl_b32 s24, s3, 10
    s_add_u32 s24, s24, 145408
    v_add_u32 v3, s24, v2
    ds_write_b128 v3, v[4:7]
    s_lshl_b32 s24, s3, 8
    s_add_u32 s24, s24, 145408
    v_add_u32 v3, s24, v19
    s_waitcnt lgkmcnt(0)
    s_barrier
    ds_read_b128 v[32:35], v3 offset:0
    ds_read_b128 v[36:39], v3 offset:16
    ds_read_b128 v[40:43], v3 offset:32
    ds_read_b128 v[44:47], v3 offset:48
    ds_read_b128 v[48:51], v3 offset:2048
    ds_read_b128 v[52:55], v3 offset:2064
    ds_read_b128 v[56:59], v3 offset:2080
    ds_read_b128 v[60:63], v3 offset:2096
    s_waitcnt lgkmcnt(0)
    v_perm_b32 v8, v32, v32, v24
    v_perm_b32 v9, v32, v32, v25
    v_perm_b32 v10, v32, v32, v26
    v_perm_b32 v11, v32, v32, v27
    v_perm_b32 v4, v48, v48, v24
    v_perm_b32 v5, v48, v48, v25
    v_perm_b32 v6, v48, v48, v26
    v_perm_b32 v7, v48, v48, v27
    v_mfma_f32_16x16x32_bf16 v[12:15], v[128:131], v[8:11], 0
    s_nop 0
    v_mfma_f32_16x16x32_bf16 v[68:71], v[128:131], v[4:7], 0
    v_perm_b32 v8, v32, v32, v28
    v_perm_b32 v9, v32, v32, v29
    v_perm_b32 v10, v32, v32, v30
    v_perm_b32 v11, v32, v32, v31
    v_perm_b32 v4, v48, v48, v28
    v_perm_b32 v5, v48, v48, v29
    v_perm_b32 v6, v48, v48, v30
    v_perm_b32 v7, v48, v48, v31
    v_mfma_f32_16x16x32_bf16 v[12:15], v[132:135], v[8:11], v[12:15]
    s_nop 0
    v_mfma_f32_16x16x32_bf16 v[68:71], v[132:135], v[4:7], v[68:71]
    v_perm_b32 v8, v33, v33, v24
    v_perm_b32 v9, v33, v33, v25
    v_perm_b32 v10, v33, v33, v26
    v_perm_b32 v11, v33, v33, v27
    v_perm_b32 v4, v49, v49, v24
    v_perm_b32 v5, v49, v49, v25
    v_perm_b32 v6, v49, v49, v26
    v_perm_b32 v7, v49, v49, v27
    v_mfma_f32_16x16x32_bf16 v[12:15], v[136:139], v[8:11], v[12:15]
    s_nop 0
    v_mfma_f32_16x16x32_bf16 v[68:71], v[136:139], v[4:7], v[68:71]
    v_perm_b32 v8, v33, v33, v28
    v_perm_b32 v9, v33, v33, v29
    v_perm_b32 v10, v33, v33, v30
    v_perm_b32 v11, v33, v33, v31
    v_perm_b32 v4, v49, v49, v28
    v_perm_b32 v5, v49, v49, v29
    v_perm_b32 v6, v49, v49, v30
    v_perm_b32 v7, v49, v49, v31
    v_mfma_f32_16x16x32_bf16 v[12:15], v[140:143], v[8:11], v[12:15]
    s_nop 0
    v_mfma_f32_16x16x32_bf16 v[68:71], v[140:143], v[4:7], v[68:71]
    v_perm_b32 v8, v34, v34, v24
    v_perm_b32 v9, v34, v34, v25
    v_perm_b32 v10, v34, v34, v26
    v_perm_b32 v11, v34, v34, v27
    v_perm_b32 v4, v50, v50, v24
    v_perm_b32 v5, v50, v50, v25
    v_perm_b32 v6, v50, v50, v26
    v_perm_b32 v7, v50, v50, v27
    v_mfma_f32_16x16x32_bf16 v[12:15], v[144:147], v[8:11], v[12:15]
    s_nop 0
    v_mfma_f32_16x16x32_bf16 v[68:71], v[144:147], v[4:7], v[68:71]
    v_perm_b32 v8, v34, v34, v28
    v_perm_b32 v9, v34, v34, v29
    v_perm_b32 v10, v34, v34, v30
    v_perm_b32 v11, v34, v34, v31
    v_perm_b32 v4, v50, v50, v28
    v_perm_b32 v5, v50, v50, v29
    v_perm_b32 v6, v50, v50, v30
    v_perm_b32 v7, v50, v50, v31
    v_mfma_f32_16x16x32_bf16 v[12:15], v[148:151], v[8:11], v[12:15]
    s_nop 0
    v_mfma_f32_16x16x32_bf16 v[68:71], v[148:151], v[4:7], v[68:71]
    v_perm_b32 v8, v35, v35, v24
    v_perm_b32 v9, v35, v35, v25
    v_perm_b32 v10, v35, v35, v26
    v_perm_b32 v11, v35, v35, v27
    v_perm_b32 v4, v51, v51, v24
    v_perm_b32 v5, v51, v51, v25
    v_perm_b32 v6, v51, v51, v26
    v_perm_b32 v7, v51, v51, v27
    v_mfma_f32_16x16x32_bf16 v[12:15], v[152:155], v[8:11], v[12:15]
    s_nop 0
    v_mfma_f32_16x16x32_bf16 v[68:71], v[152:155], v[4:7], v[68:71]
    v_perm_b32 v8, v35, v35, v28
    v_perm_b32 v9, v35, v35, v29
    v_perm_b32 v10, v35, v35, v30
    v_perm_b32 v11, v35, v35, v31
    v_perm_b32 v4, v51, v51, v28
    v_perm_b32 v5, v51, v51, v29
    v_perm_b32 v6, v51, v51, v30
    v_perm_b32 v7, v51, v51, v31
    v_mfma_f32_16x16x32_bf16 v[12:15], v[156:159], v[8:11], v[12:15]
    s_nop 0
    v_mfma_f32_16x16x32_bf16 v[68:71], v[156:159], v[4:7], v[68:71]
    v_perm_b32 v8, v36, v36, v24
    v_perm_b32 v9, v36, v36, v25
    v_perm_b32 v10, v36, v36, v26
    v_perm_b32 v11, v36, v36, v27
    v_perm_b32 v4, v52, v52, v24
    v_perm_b32 v5, v52, v52, v25
    v_perm_b32 v6, v52, v52, v26
    v_perm_b32 v7, v52, v52, v27
    v_mfma_f32_16x16x32_bf16 v[12:15], v[160:163], v[8:11], v[12:15]
    s_nop 0
    v_mfma_f32_16x16x32_bf16 v[68:71], v[160:163], v[4:7], v[68:71]
    v_perm_b32 v8, v36, v36, v28
    v_perm_b32 v9, v36, v36, v29
    v_perm_b32 v10, v36, v36, v30
    v_perm_b32 v11, v36, v36, v31
    v_perm_b32 v4, v52, v52, v28
    v_perm_b32 v5, v52, v52, v29
    v_perm_b32 v6, v52, v52, v30
    v_perm_b32 v7, v52, v52, v31
    v_mfma_f32_16x16x32_bf16 v[12:15], v[164:167], v[8:11], v[12:15]
    s_nop 0
    v_mfma_f32_16x16x32_bf16 v[68:71], v[164:167], v[4:7], v[68:71]
    v_perm_b32 v8, v37, v37, v24
    v_perm_b32 v9, v37, v37, v25
    v_perm_b32 v10, v37, v37, v26
    v_perm_b32 v11, v37, v37, v27
    v_perm_b32 v4, v53, v53, v24
    v_perm_b32 v5, v53, v53, v25
    v_perm_b32 v6, v53, v53, v26
    v_perm_b32 v7, v53, v53, v27
    v_mfma_f32_16x16x32_bf16 v[12:15], v[168:171], v[8:11], v[12:15]
    s_nop 0
    v_mfma_f32_16x16x32_bf16 v[68:71], v[168:171], v[4:7], v[68:71]
    v_perm_b32 v8, v37, v37, v28
    v_perm_b32 v9, v37, v37, v29
    v_perm_b32 v10, v37, v37, v30
    v_perm_b32 v11, v37, v37, v31
    v_perm_b32 v4, v53, v53, v28
    v_perm_b32 v5, v53, v53, v29
    v_perm_b32 v6, v53, v53, v30
    v_perm_b32 v7, v53, v53, v31
    v_mfma_f32_16x16x32_bf16 v[12:15], v[172:175], v[8:11], v[12:15]
    s_nop 0
    v_mfma_f32_16x16x32_bf16 v[68:71], v[172:175], v[4:7], v[68:71]
    v_perm_b32 v8, v38, v38, v24
    v_perm_b32 v9, v38, v38, v25
    v_perm_b32 v10, v38, v38, v26
    v_perm_b32 v11, v38, v38, v27
    v_perm_b32 v4, v54, v54, v24
    v_perm_b32 v5, v54, v54, v25
    v_perm_b32 v6, v54, v54, v26
    v_perm_b32 v7, v54, v54, v27
    v_mfma_f32_16x16x32_bf16 v[12:15], v[176:179], v[8:11], v[12:15]
    s_nop 0
    v_mfma_f32_16x16x32_bf16 v[68:71], v[176:179], v[4:7], v[68:71]
    v_perm_b32 v8, v38, v38, v28
    v_perm_b32 v9, v38, v38, v29
    v_perm_b32 v10, v38, v38, v30
    v_perm_b32 v11, v38, v38, v31
    v_perm_b32 v4, v54, v54, v28
    v_perm_b32 v5, v54, v54, v29
    v_perm_b32 v6, v54, v54, v30
    v_perm_b32 v7, v54, v54, v31
    v_mfma_f32_16x16x32_bf16 v[12:15], v[180:183], v[8:11], v[12:15]
    s_nop 0
    v_mfma_f32_16x16x32_bf16 v[68:71], v[180:183], v[4:7], v[68:71]
    v_perm_b32 v8, v39, v39, v24
    v_perm_b32 v9, v39, v39, v25
    v_perm_b32 v10, v39, v39, v26
    v_perm_b32 v11, v39, v39, v27
    v_perm_b32 v4, v55, v55, v24
    v_perm_b32 v5, v55, v55, v25
    v_perm_b32 v6, v55, v55, v26
    v_perm_b32 v7, v55, v55, v27
    v_mfma_f32_16x16x32_bf16 v[12:15], v[184:187], v[8:11], v[12:15]
    s_nop 0
    v_mfma_f32_16x16x32_bf16 v[68:71], v[184:187], v[4:7], v[68:71]
    v_perm_b32 v8, v39, v39, v28
    v_perm_b32 v9, v39, v39, v29
    v_perm_b32 v10, v39, v39, v30
    v_perm_b32 v11, v39, v39, v31
    v_perm_b32 v4, v55, v55, v28
    v_perm_b32 v5, v55, v55, v29
    v_perm_b32 v6, v55, v55, v30
    v_perm_b32 v7, v55, v55, v31
    v_mfma_f32_16x16x32_bf16 v[12:15], v[188:191], v[8:11], v[12:15]
    s_nop 0
    v_mfma_f32_16x16x32_bf16 v[68:71], v[188:191], v[4:7], v[68:71]
    v_perm_b32 v8, v40, v40, v24
    v_perm_b32 v9, v40, v40, v25
    v_perm_b32 v10, v40, v40, v26
    v_perm_b32 v11, v40, v40, v27
    v_perm_b32 v4, v56, v56, v24
    v_perm_b32 v5, v56, v56, v25
    v_perm_b32 v6, v56, v56, v26
    v_perm_b32 v7, v56, v56, v27
    v_mfma_f32_16x16x32_bf16 v[12:15], v[192:195], v[8:11], v[12:15]
    s_nop 0
    v_mfma_f32_16x16x32_bf16 v[68:71], v[192:195], v[4:7], v[68:71]
    v_perm_b32 v8, v40, v40, v28
    v_perm_b32 v9, v40, v40, v29
    v_perm_b32 v10, v40, v40, v30
    v_perm_b32 v11, v40, v40, v31
    v_perm_b32 v4, v56, v56, v28
    v_perm_b32 v5, v56, v56, v29
    v_perm_b32 v6, v56, v56, v30
    v_perm_b32 v7, v56, v56, v31
    v_mfma_f32_16x16x32_bf16 v[12:15], v[196:199], v[8:11], v[12:15]
    s_nop 0
    v_mfma_f32_16x16x32_bf16 v[68:71], v[196:199], v[4:7], v[68:71]
    v_perm_b32 v8, v41, v41, v24
    v_perm_b32 v9, v41, v41, v25
    v_perm_b32 v10, v41, v41, v26
    v_perm_b32 v11, v41, v41, v27
    v_perm_b32 v4, v57, v57, v24
    v_perm_b32 v5, v57, v57, v25
    v_perm_b32 v6, v57, v57, v26
    v_perm_b32 v7, v57, v57, v27
    v_mfma_f32_16x16x32_bf16 v[12:15], v[200:203], v[8:11], v[12:15]
    s_nop 0
    v_mfma_f32_16x16x32_bf16 v[68:71], v[200:203], v[4:7], v[68:71]
    v_perm_b32 v8, v41, v41, v28
    v_perm_b32 v9, v41, v41, v29
    v_perm_b32 v10, v41, v41, v30
    v_perm_b32 v11, v41, v41, v31
    v_perm_b32 v4, v57, v57, v28
    v_perm_b32 v5, v57, v57, v29
    v_perm_b32 v6, v57, v57, v30
    v_perm_b32 v7, v57, v57, v31
    v_mfma_f32_16x16x32_bf16 v[12:15], v[204:207], v[8:11], v[12:15]
    s_nop 0
    v_mfma_f32_16x16x32_bf16 v[68:71], v[204:207], v[4:7], v[68:71]
    v_perm_b32 v8, v42, v42, v24
    v_perm_b32 v9, v42, v42, v25
    v_perm_b32 v10, v42, v42, v26
    v_perm_b32 v11, v42, v42, v27
    v_perm_b32 v4, v58, v58, v24
    v_perm_b32 v5, v58, v58, v25
    v_perm_b32 v6, v58, v58, v26
    v_perm_b32 v7, v58, v58, v27
    v_mfma_f32_16x16x32_bf16 v[12:15], v[208:211], v[8:11], v[12:15]
    s_nop 0
    v_mfma_f32_16x16x32_bf16 v[68:71], v[208:211], v[4:7], v[68:71]
    v_perm_b32 v8, v42, v42, v28
    v_perm_b32 v9, v42, v42, v29
    v_perm_b32 v10, v42, v42, v30
    v_perm_b32 v11, v42, v42, v31
    v_perm_b32 v4, v58, v58, v28
    v_perm_b32 v5, v58, v58, v29
    v_perm_b32 v6, v58, v58, v30
    v_perm_b32 v7, v58, v58, v31
    v_mfma_f32_16x16x32_bf16 v[12:15], v[212:215], v[8:11], v[12:15]
    s_nop 0
    v_mfma_f32_16x16x32_bf16 v[68:71], v[212:215], v[4:7], v[68:71]
    v_perm_b32 v8, v43, v43, v24
    v_perm_b32 v9, v43, v43, v25
    v_perm_b32 v10, v43, v43, v26
    v_perm_b32 v11, v43, v43, v27
    v_perm_b32 v4, v59, v59, v24
    v_perm_b32 v5, v59, v59, v25
    v_perm_b32 v6, v59, v59, v26
    v_perm_b32 v7, v59, v59, v27
    v_mfma_f32_16x16x32_bf16 v[12:15], v[216:219], v[8:11], v[12:15]
    s_nop 0
    v_mfma_f32_16x16x32_bf16 v[68:71], v[216:219], v[4:7], v[68:71]
    v_perm_b32 v8, v43, v43, v28
    v_perm_b32 v9, v43, v43, v29
    v_perm_b32 v10, v43, v43, v30
    v_perm_b32 v11, v43, v43, v31
    v_perm_b32 v4, v59, v59, v28
    v_perm_b32 v5, v59, v59, v29
    v_perm_b32 v6, v59, v59, v30
    v_perm_b32 v7, v59, v59, v31
    v_mfma_f32_16x16x32_bf16 v[12:15], v[220:223], v[8:11], v[12:15]
    s_nop 0
    v_mfma_f32_16x16x32_bf16 v[68:71], v[220:223], v[4:7], v[68:71]
    v_perm_b32 v8, v44, v44, v24
    v_perm_b32 v9, v44, v44, v25
    v_perm_b32 v10, v44, v44, v26
    v_perm_b32 v11, v44, v44, v27
    v_perm_b32 v4, v60, v60, v24
    v_perm_b32 v5, v60, v60, v25
    v_perm_b32 v6, v60, v60, v26
    v_perm_b32 v7, v60, v60, v27
    v_mfma_f32_16x16x32_bf16 v[12:15], v[224:227], v[8:11], v[12:15]
    s_nop 0
    v_mfma_f32_16x16x32_bf16 v[68:71], v[224:227], v[4:7], v[68:71]
    v_perm_b32 v8, v44, v44, v28
    v_perm_b32 v9, v44, v44, v29
    v_perm_b32 v10, v44, v44, v30
    v_perm_b32 v11, v44, v44, v31
    v_perm_b32 v4, v60, v60, v28
    v_perm_b32 v5, v60, v60, v29
    v_perm_b32 v6, v60, v60, v30
    v_perm_b32 v7, v60, v60, v31
    v_mfma_f32_16x16x32_bf16 v[12:15], v[228:231], v[8:11], v[12:15]
    s_nop 0
    v_mfma_f32_16x16x32_bf16 v[68:71], v[228:231], v[4:7], v[68:71]
    v_perm_b32 v8, v45, v45, v24
    v_perm_b32 v9, v45, v45, v25
    v_perm_b32 v10, v45, v45, v26
    v_perm_b32 v11, v45, v45, v27
    v_perm_b32 v4, v61, v61, v24
    v_perm_b32 v5, v61, v61, v25
    v_perm_b32 v6, v61, v61, v26
    v_perm_b32 v7, v61, v61, v27
    v_mfma_f32_16x16x32_bf16 v[12:15], v[232:235], v[8:11], v[12:15]
    s_nop 0
    v_mfma_f32_16x16x32_bf16 v[68:71], v[232:235], v[4:7], v[68:71]
    v_perm_b32 v8, v45, v45, v28
    v_perm_b32 v9, v45, v45, v29
    v_perm_b32 v10, v45, v45, v30
    v_perm_b32 v11, v45, v45, v31
    v_perm_b32 v4, v61, v61, v28
    v_perm_b32 v5, v61, v61, v29
    v_perm_b32 v6, v61, v61, v30
    v_perm_b32 v7, v61, v61, v31
    v_mfma_f32_16x16x32_bf16 v[12:15], v[236:239], v[8:11], v[12:15]
    s_nop 0
    v_mfma_f32_16x16x32_bf16 v[68:71], v[236:239], v[4:7], v[68:71]
    v_perm_b32 v8, v46, v46, v24
    v_perm_b32 v9, v46, v46, v25
    v_perm_b32 v10, v46, v46, v26
    v_perm_b32 v11, v46, v46, v27
    v_perm_b32 v4, v62, v62, v24
    v_perm_b32 v5, v62, v62, v25
    v_perm_b32 v6, v62, v62, v26
    v_perm_b32 v7, v62, v62, v27
    v_mfma_f32_16x16x32_bf16 v[12:15], v[240:243], v[8:11], v[12:15]
    s_nop 0
    v_mfma_f32_16x16x32_bf16 v[68:71], v[240:243], v[4:7], v[68:71]
    v_perm_b32 v8, v46, v46, v28
    v_perm_b32 v9, v46, v46, v29
    v_perm_b32 v10, v46, v46, v30
    v_perm_b32 v11, v46, v46, v31
    v_perm_b32 v4, v62, v62, v28
    v_perm_b32 v5, v62, v62, v29
    v_perm_b32 v6, v62, v62, v30
    v_perm_b32 v7, v62, v62, v31
    v_mfma_f32_16x16x32_bf16 v[12:15], v[244:247], v[8:11], v[12:15]
    s_nop 0
    v_mfma_f32_16x16x32_bf16 v[68:71], v[244:247], v[4:7], v[68:71]
    v_perm_b32 v8, v47, v47, v24
    v_perm_b32 v9, v47, v47, v25
    v_perm_b32 v10, v47, v47, v26
    v_perm_b32 v11, v47, v47, v27
    v_perm_b32 v4, v63, v63, v24
    v_perm_b32 v5, v63, v63, v25
    v_perm_b32 v6, v63, v63, v26
    v_perm_b32 v7, v63, v63, v27
    v_mfma_f32_16x16x32_bf16 v[12:15], v[248:251], v[8:11], v[12:15]
    s_nop 0
    v_mfma_f32_16x16x32_bf16 v[68:71], v[248:251], v[4:7], v[68:71]
    v_perm_b32 v8, v47, v47, v28
    v_perm_b32 v9, v47, v47, v29
    v_perm_b32 v10, v47, v47, v30
    v_perm_b32 v11, v47, v47, v31
    v_perm_b32 v4, v63, v63, v28
    v_perm_b32 v5, v63, v63, v29
    v_perm_b32 v6, v63, v63, v30
    v_perm_b32 v7, v63, v63, v31
    v_mfma_f32_16x16x32_bf16 v[12:15], v[252:255], v[8:11], v[12:15]
    s_nop 0
    v_mfma_f32_16x16x32_bf16 v[68:71], v[252:255], v[4:7], v[68:71]
    v_lshrrev_b32 v3, 4, v0
    v_lshlrev_b32 v3, 7, v3
    v_and_b32 v4, 7, v0
    v_lshl_add_u32 v3, v4, 4, v3
    v_bfe_u32 v4, v0, 3, 1
    v_lshl_add_u32 v3, v4, 9, v3
    s_lshl_b32 s24, s3, 11
    s_add_u32 s24, s24, 135168
    v_add_u32 v3, s24, v3
    ds_write_b128 v3, v[12:15]
    ds_write_b128 v3, v[68:71] offset:1024
    s_waitcnt lgkmcnt(0)
    s_barrier
    v_and_b32 v5, 31, v0
    s_lshl_b32 s24, s3, 9
    s_add_u32 s24, s24, 135168
    v_lshl_add_u32 v3, v5, 4, s24
    ds_read_b128 v[72:75], v3 offset:0
    ds_read_b128 v[76:79], v3 offset:2048
    ds_read_b128 v[80:83], v3 offset:4096
    ds_read_b128 v[84:87], v3 offset:6144
    s_mul_i32 s24, s3, 320
    s_add_u32 s24, s24, 143360
    v_lshl_add_u32 v5, v5, 3, s24
    s_waitcnt lgkmcnt(0)
    v_add_f32 v72, v72, v76
    v_add_f32 v73, v73, v77
    v_add_f32 v74, v74, v78
    v_add_f32 v75, v75, v79
    v_add_f32 v72, v72, v80
    v_add_f32 v73, v73, v81
    v_add_f32 v74, v74, v82
    v_add_f32 v75, v75, v83
    v_add_f32 v72, v72, v84
    v_add_f32 v73, v73, v85
    v_add_f32 v74, v74, v86
    v_add_f32 v75, v75, v87
    v_cvt_pk_bf16_f32 v6, v72, v73
    v_cvt_pk_bf16_f32 v7, v74, v75
    ds_write_b64 v5, v[6:7]
    v_lshrrev_b32 v3, 4, v0
    v_and_b32 v4, 3, v0
    v_mul_u32_u24 v5, 320, v4
    v_lshl_add_u32 v5, v3, 4, v5
    v_add_u32 v5, 143360, v5
    s_waitcnt lgkmcnt(0)
    s_barrier
    ds_read_b128 v[32:35], v5 offset:0
    ds_read_b128 v[36:39], v5 offset:64
    ds_read_b128 v[40:43], v5 offset:128
    ds_read_b128 v[44:47], v5 offset:192
    s_waitcnt lgkmcnt(3)
    v_mfma_f32_16x16x32_bf16 v[72:75], v[32:35], a[0:3], 0
    s_waitcnt lgkmcnt(2)
    v_mfma_f32_16x16x32_bf16 v[72:75], v[36:39], a[4:7], v[72:75]
    s_waitcnt lgkmcnt(1)
    v_mfma_f32_16x16x32_bf16 v[72:75], v[40:43], a[8:11], v[72:75]
    s_waitcnt lgkmcnt(0)
    v_mfma_f32_16x16x32_bf16 v[72:75], v[44:47], a[12:15], v[72:75]
    v_mfma_f32_16x16x32_bf16 v[76:79], v[32:35], a[16:19], 0
    v_mfma_f32_16x16x32_bf16 v[76:79], v[36:39], a[20:23], v[76:79]
    v_mfma_f32_16x16x32_bf16 v[76:79], v[40:43], a[24:27], v[76:79]
    v_mfma_f32_16x16x32_bf16 v[76:79], v[44:47], a[28:31], v[76:79]
    v_mfma_f32_16x16x32_bf16 v[80:83], v[32:35], a[32:35], 0
    v_mfma_f32_16x16x32_bf16 v[80:83], v[36:39], a[36:39], v[80:83]
    v_mfma_f32_16x16x32_bf16 v[80:83], v[40:43], a[40:43], v[80:83]
    v_mfma_f32_16x16x32_bf16 v[80:83], v[44:47], a[44:47], v[80:83]
    v_mov_b32_dpp v4, v72 quad_perm:[0,1,2,3] row_mask:0x1 bank_mask:0xf
    v_mov_b32_dpp v5, v73 quad_perm:[0,1,2,3] row_mask:0x1 bank_mask:0xf
    v_mov_b32_dpp v6, v74 quad_perm:[0,1,2,3] row_mask:0x1 bank_mask:0xf
    v_mov_b32_dpp v7, v75 quad_perm:[0,1,2,3] row_mask:0x1 bank_mask:0xf
    v_mfma_f32_16x16x32_bf16 v[84:87], v[32:35], a[48:51], 0
    v_mfma_f32_16x16x32_bf16 v[84:87], v[36:39], a[52:55], v[84:87]
    v_mfma_f32_16x16x32_bf16 v[84:87], v[40:43], a[56:59], v[84:87]
    v_mfma_f32_16x16x32_bf16 v[84:87], v[44:47], a[60:63], v[84:87]
    v_mov_b32_dpp v4, v76 quad_perm:[0,1,2,3] row_mask:0x2 bank_mask:0xf
    v_mov_b32_dpp v5, v77 quad_perm:[0,1,2,3] row_mask:0x2 bank_mask:0xf
    v_mov_b32_dpp v6, v78 quad_perm:[0,1,2,3] row_mask:0x2 bank_mask:0xf
    v_mov_b32_dpp v7, v79 quad_perm:[0,1,2,3] row_mask:0x2 bank_mask:0xf
    v_mfma_f32_16x16x32_bf16 v[88:91], v[32:35], a[64:67], 0
    v_mfma_f32_16x16x32_bf16 v[88:91], v[36:39], a[68:71], v[88:91]
    v_mfma_f32_16x16x32_bf16 v[88:91], v[40:43], a[72:75], v[88:91]
    v_mfma_f32_16x16x32_bf16 v[88:91], v[44:47], a[76:79], v[88:91]
    v_mov_b32_dpp v4, v80 quad_perm:[0,1,2,3] row_mask:0x4 bank_mask:0xf
    v_mov_b32_dpp v5, v81 quad_perm:[0,1,2,3] row_mask:0x4 bank_mask:0xf
    v_mov_b32_dpp v6, v82 quad_perm:[0,1,2,3] row_mask:0x4 bank_mask:0xf
    v_mov_b32_dpp v7, v83 quad_perm:[0,1,2,3] row_mask:0x4 bank_mask:0xf
    v_mfma_f32_16x16x32_bf16 v[92:95], v[32:35], a[80:83], 0
    v_mfma_f32_16x16x32_bf16 v[92:95], v[36:39], a[84:87], v[92:95]
    v_mfma_f32_16x16x32_bf16 v[92:95], v[40:43], a[88:91], v[92:95]
    v_mfma_f32_16x16x32_bf16 v[92:95], v[44:47], a[92:95], v[92:95]
    v_mov_b32_dpp v4, v84 quad_perm:[0,1,2,3] row_mask:0x8 bank_mask:0xf
    v_mov_b32_dpp v5, v85 quad_perm:[0,1,2,3] row_mask:0x8 bank_mask:0xf
    v_mov_b32_dpp v6, v86 quad_perm:[0,1,2,3] row_mask:0x8 bank_mask:0xf
    v_mov_b32_dpp v7, v87 quad_perm:[0,1,2,3] row_mask:0x8 bank_mask:0xf
    v_mfma_f32_16x16x32_bf16 v[96:99], v[32:35], a[96:99], 0
    v_mfma_f32_16x16x32_bf16 v[96:99], v[36:39], a[100:103], v[96:99]
    v_mfma_f32_16x16x32_bf16 v[96:99], v[40:43], a[104:107], v[96:99]
    v_mfma_f32_16x16x32_bf16 v[96:99], v[44:47], a[108:111], v[96:99]
    v_mov_b32_dpp v8, v88 quad_perm:[0,1,2,3] row_mask:0x1 bank_mask:0xf
    v_mov_b32_dpp v9, v89 quad_perm:[0,1,2,3] row_mask:0x1 bank_mask:0xf
    v_mov_b32_dpp v10, v90 quad_perm:[0,1,2,3] row_mask:0x1 bank_mask:0xf
    v_mov_b32_dpp v11, v91 quad_perm:[0,1,2,3] row_mask:0x1 bank_mask:0xf
    v_mfma_f32_16x16x32_bf16 v[100:103], v[32:35], a[112:115], 0
    v_mfma_f32_16x16x32_bf16 v[100:103], v[36:39], a[116:119], v[100:103]
    v_mfma_f32_16x16x32_bf16 v[100:103], v[40:43], a[120:123], v[100:103]
    v_mfma_f32_16x16x32_bf16 v[100:103], v[44:47], a[124:127], v[100:103]
    v_mov_b32_dpp v8, v92 quad_perm:[0,1,2,3] row_mask:0x2 bank_mask:0xf
    v_mov_b32_dpp v9, v93 quad_perm:[0,1,2,3] row_mask:0x2 bank_mask:0xf
    v_mov_b32_dpp v10, v94 quad_perm:[0,1,2,3] row_mask:0x2 bank_mask:0xf
    v_mov_b32_dpp v11, v95 quad_perm:[0,1,2,3] row_mask:0x2 bank_mask:0xf
    v_mov_b32_dpp v8, v96 quad_perm:[0,1,2,3] row_mask:0x4 bank_mask:0xf
    v_mov_b32_dpp v9, v97 quad_perm:[0,1,2,3] row_mask:0x4 bank_mask:0xf
    v_mov_b32_dpp v10, v98 quad_perm:[0,1,2,3] row_mask:0x4 bank_mask:0xf
    v_mov_b32_dpp v11, v99 quad_perm:[0,1,2,3] row_mask:0x4 bank_mask:0xf
    v_mov_b32_dpp v8, v100 quad_perm:[0,1,2,3] row_mask:0x8 bank_mask:0xf
    v_mov_b32_dpp v9, v101 quad_perm:[0,1,2,3] row_mask:0x8 bank_mask:0xf
    v_mov_b32_dpp v10, v102 quad_perm:[0,1,2,3] row_mask:0x8 bank_mask:0xf
    v_mov_b32_dpp v11, v103 quad_perm:[0,1,2,3] row_mask:0x8 bank_mask:0xf
    v_cvt_pk_bf16_f32 v12, v4, v5
    v_cvt_pk_bf16_f32 v13, v6, v7
    v_cvt_pk_bf16_f32 v14, v8, v9
    v_cvt_pk_bf16_f32 v15, v10, v11
    s_mov_b32 s20, s58
    s_mov_b32 s21, s59
    s_mov_b32 s22, 0x2000
    s_mov_b32 s23, 0x20000
    v_and_b32 v3, 3, v0
    v_lshlrev_b32 v80, 4, v3
    v_bfe_u32 v4, v0, 2, 1
    v_lshl_add_u32 v80, v4, 3, v80
    v_lshrrev_b32 v5, 3, v0
    v_lshl_add_u32 v80, v5, 6, v80
    v_lshlrev_b32 v82, 11, v3
    v_lshl_add_u32 v82, v4, 3, v82
    v_lshrrev_b32 v3, 4, v0
    v_lshl_add_u32 v82, v3, 4, v82
    v_and_b32 v5, 1, v5
    v_lshl_add_u32 v82, v5, 6, v82
    v_and_b32 v81, 0xf0, v2
    v_lshl_add_u32 v81, v3, 12, v81
    v_cmp_eq_u32 vcc, 0, v5
    v_mov_b32 v3, 0x3f803f80
    s_nop 0
    v_cndmask_b32 v4, 0, v3, vcc
    v_xor_b32 v5, v3, v4
    v_and_b32 v84, v4, v20
    v_and_b32 v88, v5, v20
    v_and_b32 v85, v4, v21
    v_and_b32 v89, v5, v21
    v_and_b32 v86, v4, v22
    v_and_b32 v90, v5, v22
    v_and_b32 v87, v4, v23
    v_and_b32 v91, v5, v23
    s_lshl_b32 s30, s3, 10
    s_add_u32 s30, s30, 0x124000
    s_lshl_b32 s24, s26, 12
    s_add_u32 s24, s24, s30
    buffer_store_dwordx2 v[12:13], v80, s[12:15], s24 offen sc1
    buffer_store_dwordx2 v[14:15], v80, s[12:15], s24 offen offset:512 sc1
    s_lshl_b32 s24, s3, 7
    s_add_u32 s24, s24, 0x1b6400
    s_waitcnt vmcnt(0)
    s_mov_b64 exec, 1
    v_mov_b32 v83, 64
    buffer_atomic_add v83, off, s[12:15], s24 sc0
    s_mov_b64 exec, -1
    s_waitcnt vmcnt(0)
    v_readfirstlane_b32 s24, v83
    s_nop 0
    s_cmp_lg_u32 s24, 1983
    s_cbranch_scc1 L_W_x
    s_lshl_b32 s31, s3, 8
L_W_f:
    s_mov_b32 s25, 262144
L_fi16:
    s_mov_b32 s24, s30
    buffer_load_dwordx4 v[128:131], v81, s[12:15], s24 offen offset:0 sc1
    buffer_load_dwordx4 v[132:135], v81, s[12:15], s24 offen offset:256 sc1
    s_add_u32 s24, s24, 0x4000
    buffer_load_dwordx4 v[136:139], v81, s[12:15], s24 offen offset:0 sc1
    buffer_load_dwordx4 v[140:143], v81, s[12:15], s24 offen offset:256 sc1
    s_add_u32 s24, s24, 0x4000
    buffer_load_dwordx4 v[144:147], v81, s[12:15], s24 offen offset:0 sc1
    buffer_load_dwordx4 v[148:151], v81, s[12:15], s24 offen offset:256 sc1
    s_add_u32 s24, s24, 0x4000
    buffer_load_dwordx4 v[152:155], v81, s[12:15], s24 offen offset:0 sc1
    buffer_load_dwordx4 v[156:159], v81, s[12:15], s24 offen offset:256 sc1
    s_add_u32 s24, s24, 0x4000
    buffer_load_dwordx4 v[160:163], v81, s[12:15], s24 offen offset:0 sc1
    buffer_load_dwordx4 v[164:167], v81, s[12:15], s24 offen offset:256 sc1
    s_add_u32 s24, s24, 0x4000
    buffer_load_dwordx4 v[168:171], v81, s[12:15], s24 offen offset:0 sc1
    buffer_load_dwordx4 v[172:175], v81, s[12:15], s24 offen offset:256 sc1
    s_add_u32 s24, s24, 0x4000
    buffer_load_dwordx4 v[176:179], v81, s[12:15], s24 offen offset:0 sc1
    buffer_load_dwordx4 v[180:183], v81, s[12:15], s24 offen offset:256 sc1
    s_add_u32 s24, s24, 0x4000
    buffer_load_dwordx4 v[184:187], v81, s[12:15], s24 offen offset:0 sc1
    buffer_load_dwordx4 v[188:191], v81, s[12:15], s24 offen offset:256 sc1
    s_waitcnt vmcnt(15)
    v_mfma_f32_16x16x32_bf16 v[92:95], v[128:131], v[84:87], 0
    s_waitcnt vmcnt(14)
    v_mfma_f32_16x16x32_bf16 v[92:95], v[132:135], v[88:91], v[92:95]
    s_waitcnt vmcnt(13)
    v_mfma_f32_16x16x32_bf16 v[92:95], v[136:139], v[84:87], v[92:95]
    s_waitcnt vmcnt(12)
    v_mfma_f32_16x16x32_bf16 v[92:95], v[140:143], v[88:91], v[92:95]
    s_waitcnt vmcnt(11)
    v_mfma_f32_16x16x32_bf16 v[92:95], v[144:147], v[84:87], v[92:95]
    s_waitcnt vmcnt(10)
    v_mfma_f32_16x16x32_bf16 v[92:95], v[148:151], v[88:91], v[92:95]
    s_waitcnt vmcnt(9)
    v_mfma_f32_16x16x32_bf16 v[92:95], v[152:155], v[84:87], v[92:95]
    s_waitcnt vmcnt(8)
    v_mfma_f32_16x16x32_bf16 v[92:95], v[156:159], v[88:91], v[92:95]
    s_waitcnt vmcnt(7)
    v_mfma_f32_16x16x32_bf16 v[92:95], v[160:163], v[84:87], v[92:95]
    s_waitcnt vmcnt(6)
    v_mfma_f32_16x16x32_bf16 v[92:95], v[164:167], v[88:91], v[92:95]
    s_waitcnt vmcnt(5)
    v_mfma_f32_16x16x32_bf16 v[92:95], v[168:171], v[84:87], v[92:95]
    s_waitcnt vmcnt(4)
    v_mfma_f32_16x16x32_bf16 v[92:95], v[172:175], v[88:91], v[92:95]
    s_waitcnt vmcnt(3)
    v_mfma_f32_16x16x32_bf16 v[92:95], v[176:179], v[84:87], v[92:95]
    s_waitcnt vmcnt(2)
    v_mfma_f32_16x16x32_bf16 v[92:95], v[180:183], v[88:91], v[92:95]
    s_waitcnt vmcnt(1)
    v_mfma_f32_16x16x32_bf16 v[92:95], v[184:187], v[84:87], v[92:95]
    s_waitcnt vmcnt(0)
    v_mfma_f32_16x16x32_bf16 v[92:95], v[188:191], v[88:91], v[92:95]
    s_nop 7
    v_cmp_u_f32 vcc, v92, v93
    v_cmp_u_f32 s[68:69], v94, v95
    v_cvt_pk_bf16_f32 v4, v92, v93
    v_cvt_pk_bf16_f32 v5, v94, v95
    s_or_b64 vcc, vcc, s[68:69]
    s_cbranch_scc0 L_fi16_x
    v_max_u32 v3, v128, v129
    v_max3_u32 v3, v3, v130, v131
    v_max3_u32 v3, v3, v132, v133
    v_max3_u32 v3, v3, v134, v135
    v_max3_u32 v3, v3, v136, v137
    v_max3_u32 v3, v3, v138, v139
    v_max3_u32 v3, v3, v140, v141
    v_max3_u32 v3, v3, v142, v143
    v_max3_u32 v3, v3, v144, v145
    v_max3_u32 v3, v3, v146, v147
    v_max3_u32 v3, v3, v148, v149
    v_max3_u32 v3, v3, v150, v151
    v_max3_u32 v3, v3, v152, v153
    v_max3_u32 v3, v3, v154, v155
    v_max3_u32 v3, v3, v156, v157
    v_max3_u32 v3, v3, v158, v159
    v_max3_u32 v3, v3, v160, v161
    v_max3_u32 v3, v3, v162, v163
    v_max3_u32 v3, v3, v164, v165
    v_max3_u32 v3, v3, v166, v167
    v_max3_u32 v3, v3, v168, v169
    v_max3_u32 v3, v3, v170, v171
    v_max3_u32 v3, v3, v172, v173
    v_max3_u32 v3, v3, v174, v175
    v_max3_u32 v3, v3, v176, v177
    v_max3_u32 v3, v3, v178, v179
    v_max3_u32 v3, v3, v180, v181
    v_max3_u32 v3, v3, v182, v183
    v_max3_u32 v3, v3, v184, v185
    v_max3_u32 v3, v3, v186, v187
    v_max3_u32 v3, v3, v188, v189
    v_max3_u32 v3, v3, v190, v191
    v_cmp_eq_u32 vcc, -1, v3
    s_sub_u32 s25, s25, 1
    s_cmp_eq_u32 s25, 0
    s_cbranch_scc1 L_fi16_x
    s_cmp_lg_u64 vcc, 0
    s_cbranch_scc1 L_fi16
L_fi16_x:
    buffer_store_dwordx2 v[4:5], v82, s[20:23], s31 offen
    s_add_u32 s30, s30, 512
    s_add_u32 s31, s31, 128
    s_bitcmp1_b32 s31, 7
    s_cbranch_scc1 L_W_f
L_W_x:
    s_barrier
L_R:
    s_mov_b32 s20, s58
    s_mov_b32 s21, s59
    s_mov_b32 s22, 0x2000
    s_mov_b32 s23, 0x20000
    v_and_b32 v3, 1, v0
    v_lshlrev_b32 v3, 4, v3
    v_mov_b32 v4, 0xffff
    v_lshlrev_b32 v4, v3, v4
    v_bfe_u32 v3, v0, 1, 2
    v_cmp_eq_u32 vcc, 0, v3
    s_nop 1
    v_cndmask_b32 v20, 0, v4, vcc
    v_cmp_eq_u32 vcc, 1, v3
    s_nop 1
    v_cndmask_b32 v21, 0, v4, vcc
    v_cmp_eq_u32 vcc, 2, v3
    s_nop 1
    v_cndmask_b32 v22, 0, v4, vcc
    v_cmp_eq_u32 vcc, 3, v3
    s_nop 1
    v_cndmask_b32 v23, 0, v4, vcc
    v_lshrrev_b32 v3, 4, v0
    v_and_b32 v4, 7, v0
    v_bfe_u32 v7, v0, 3, 1
    v_lshl_add_u32 v5, v3, 3, v4
    v_mul_u32_u24 v6, 320, v7
    v_lshl_add_u32 v5, v5, 3, v6
    s_mul_i32 s24, s3, 1280
    s_add_u32 s24, s24, 135168
    v_add_u32 v24, s24, v5
    v_and_b32 v5, 3, v0
    v_mul_u32_u24 v25, 320, v5
    v_lshl_add_u32 v25, v3, 4, v25
    v_add_u32 v25, 135168, v25
    v_lshlrev_b32 v26, 4, v4
    v_lshl_add_u32 v26, v7, 3, v26
    v_and_b32 v5, 15, v0
    v_lshlrev_b32 v28, 11, v3
    v_lshl_add_u32 v28, v5, 1, v28
    s_and_b32 s24, s74, 7
    s_lshl_b32 s24, s24, 3
    s_bfm_b64 s[44:45], 8, s24
    s_not_b64 s[44:45], s[44:45]
    v_min_u32 v6, 5, v4
    v_lshrrev_b32 v5, 1, v6
    v_and_b32 v8, 1, v3
    v_mad_u32_u24 v5, v8, 3, v5
    v_lshlrev_b32 v31, 10, v5
    v_and_b32 v6, 1, v6
    v_lshl_add_u32 v6, v7, 1, v6
    v_lshl_add_u32 v31, v6, 4, v31
    s_and_b32 s35, s72, 7
    s_lshl_b32 s35, s35, 7
    s_add_u32 s35, s35, 0x1b0000
    s_lshr_b32 s34, s72, 3
    s_mul_i32 s34, s34, 6
    s_mul_i32 s29, s3, 6144
    s_add_u32 s29, s29, s35
    s_mov_b32 s24, 262144
    s_branch L_pd17_in
L_pd17:
    s_sleep 64
L_pd17_in:
    buffer_load_dwordx2 v[8:9], v31, s[12:15], s29 offen sc1
    s_waitcnt vmcnt(0)
    v_max_u32 v3, v8, v9
    v_cmp_eq_u32 vcc, -1, v3
    s_sub_u32 s24, s24, 1
    s_cmp_eq_u32 s24, 0
    s_cbranch_scc1 L_pd17_x
    s_and_b64 exec, exec, vcc
    s_cbranch_scc1 L_pd17
L_pd17_x:
    s_mov_b64 exec, -1
    v_mov_b32 v6, v8
    s_nop 1
    v_max_f32_dpp v6, v6, v6 quad_perm:[1,0,3,2] row_mask:0xf bank_mask:0xf
    s_nop 1
    v_max_f32_dpp v6, v6, v6 quad_perm:[2,3,0,1] row_mask:0xf bank_mask:0xf
    s_nop 1
    v_max_f32_dpp v6, v6, v6 row_half_mirror row_mask:0xf bank_mask:0xf
    v_sub_f32 v8, v8, v6
    v_exp_f32 v8, v8
    v_cmp_gt_u32 vcc, 6, v4
    s_nop 1
    v_cndmask_b32 v8, 0, v8, vcc
    v_mul_f32 v9, v8, v9
    s_nop 1
    v_add_f32_dpp v9, v9, v9 quad_perm:[1,0,3,2] row_mask:0xf bank_mask:0xf
    s_nop 1
    v_add_f32_dpp v9, v9, v9 quad_perm:[2,3,0,1] row_mask:0xf bank_mask:0xf
    s_nop 1
    v_add_f32_dpp v9, v9, v9 row_half_mirror row_mask:0xf bank_mask:0xf
    v_rcp_f32 v9, v9
    s_nop 0
    v_mul_f32 v8, v8, v9
    v_cvt_pk_bf16_f32 v8, v8, v8
    v_lshrrev_b32 v3, 4, v0
    v_mul_u32_u24 v9, 6, v7
    v_sub_u32 v3, v3, v9
    v_lshlrev_b32 v9, 3, v7
    v_add_u32 v5, 0, v3
    v_min_u32 v5, 6, v5
    v_add_u32 v5, v5, v9
    v_lshlrev_b32 v5, 2, v5
    ds_bpermute_b32 v10, v5, v8
    ds_bpermute_b32 v13, v5, v8 offset:64
    v_add_u32 v5, 4, v3
    v_min_u32 v5, 6, v5
    v_add_u32 v5, v5, v9
    v_lshlrev_b32 v5, 2, v5
    ds_bpermute_b32 v11, v5, v8
    ds_bpermute_b32 v14, v5, v8 offset:64
    v_add_u32 v5, 8, v3
    v_min_u32 v5, 6, v5
    v_add_u32 v5, v5, v9
    v_lshlrev_b32 v5, 2, v5
    ds_bpermute_b32 v12, v5, v8
    ds_bpermute_b32 v15, v5, v8 offset:64
    s_waitcnt lgkmcnt(0)
    v_and_b32 v32, v10, v20
    v_and_b32 v33, v10, v21
    v_and_b32 v34, v10, v22
    v_and_b32 v35, v10, v23
    v_and_b32 v36, v11, v20
    v_and_b32 v37, v11, v21
    v_and_b32 v38, v11, v22
    v_and_b32 v39, v11, v23
    v_and_b32 v40, v12, v20
    v_and_b32 v41, v12, v21
    v_and_b32 v42, v12, v22
    v_and_b32 v43, v12, v23
    v_and_b32 v44, v13, v20
    v_and_b32 v45, v13, v21
    v_and_b32 v46, v13, v22
    v_and_b32 v47, v13, v23
    v_and_b32 v48, v14, v20
    v_and_b32 v49, v14, v21
    v_and_b32 v50, v14, v22
    v_and_b32 v51, v14, v23
    v_and_b32 v52, v15, v20
    v_and_b32 v53, v15, v21
    v_and_b32 v54, v15, v22
    v_and_b32 v55, v15, v23
    s_and_b32 s24, s3, 1
    s_lshl_b32 s24, s24, 1
    s_and_b32 s29, s3, 2
    s_lshl_b32 s29, s29, 3
    s_or_b32 s29, s29, s24
    s_and_b32 s24, s26, 13
    s_or_b32 s29, s29, s24
    s_mul_i32 s29, s29, 6144
    s_add_u32 s29, s29, 0x180000
    s_add_u32 s42, s29, 4096
    s_lshr_b32 s24, s74, 3
    s_lshl_b32 s24, s24, 2
    s_add_u32 s24, s24, s3
    s_lshl_b32 s36, s24, 10
    s_add_u32 s36, s36, 0x1b7800
    s_and_b32 s37, s74, 7
    s_lshl_b32 s37, s37, 7
    s_add_u32 s37, s37, s36
    s_lshl_b32 s38, s24, 7
    s_add_u32 s38, s38, 0x1b6800
    s_lshl_b32 s39, s24, 5
    s_add_u32 s39, s39, 1024
    s_mov_b32 s30, 0x400000
    s_mov_b32 s31, s30
    s_mov_b32 s40, s30
    s_mov_b32 s41, s30
    s_mov_b32 s33, 0
    s_branch L_P_go
L_P:
    s_mov_b64 s[30:31], s[36:37]
    s_mov_b64 s[40:41], s[38:39]
    s_mov_b32 s33, 447
    s_cmp_lg_u32 s3, 0
    s_cbranch_scc1 L_H_x
    s_lshr_b32 s24, s74, 5
    s_mul_i32 s25, s24, 3
    s_add_u32 s34, s34, s25
    s_lshl_b32 s24, s24, 6
    s_add_u32 s24, s24, s26
    s_lshl_b32 s24, s24, 20
    s_add_u32 s4, s52, s24
    s_addc_u32 s5, s53, 0
    s_mov_b32 s6, 0x100000
    s_mov_b32 s7, 0x20000
    s_add_u32 s8, s4, 0x2000000
    s_addc_u32 s9, s5, 0
    s_mov_b32 s10, s6
    s_mov_b32 s11, 0x20000
    v_lshrrev_b32 v3, 4, v0
    v_mul_u32_u24 v16, 6144, v3
    v_and_b32 v3, 15, v0
    v_lshl_add_u32 v16, v3, 7, v16
    v_lshlrev_b32 v17, 10, v0
    v_mov_b32 v18, 0
    s_mov_b32 s27, 43
    s_mov_b32 s28, 43
    s_mov_b32 s32, 43
    s_mov_b32 s75, 1024
L_H:
    s_sub_u32 s75, s75, 1
    s_cmp_eq_u32 s75, 0
    s_cbranch_scc1 L_H_x
    s_mov_b64 exec, 0xffffff
    buffer_load_dword v18, v17, s[12:15], s35 offen offset:64 sc1
    s_mov_b64 exec, -1
    s_waitcnt vmcnt(0)
    v_max_i32 v19, 0, v18
    s_nop 1
    v_add_u32_dpp v3, v19, v19 row_ror:8 row_mask:0xf bank_mask:0xf
    s_nop 1
    v_add_u32_dpp v3, v3, v3 row_ror:4 row_mask:0xf bank_mask:0xf
    s_nop 1
    v_add_u32_dpp v3, v3, v3 row_ror:2 row_mask:0xf bank_mask:0xf
    s_nop 1
    v_add_u32_dpp v3, v3, v3 row_ror:1 row_mask:0xf bank_mask:0xf
    s_nop 0
    v_readlane_b32 s70, v3, 0
    v_readlane_b32 s24, v3, 16
    s_nop 0
    s_add_u32 s70, s70, s24
    s_add_u32 s24, s34, 0
    s_nop 0
    v_readlane_b32 s24, v19, s24
    s_sub_u32 s25, 43, s27
    s_mul_i32 s25, s25, 17
    s_mul_i32 s64, s24, 24
    s_add_u32 s64, s64, s25
    s_add_u32 s24, s24, 8
    s_cmp_gt_u32 s24, s27
    s_cselect_b32 s64, 0xffff, s64
    s_add_u32 s24, s34, 1
    v_readlane_b32 s24, v19, s24
    s_sub_u32 s25, 43, s28
    s_mul_i32 s25, s25, 17
    s_mul_i32 s65, s24, 24
    s_add_u32 s65, s65, s25
    s_add_u32 s24, s24, 8
    s_cmp_gt_u32 s24, s28
    s_cselect_b32 s65, 0xffff, s65
    s_add_u32 s24, s34, 2
    v_readlane_b32 s24, v19, s24
    s_sub_u32 s25, 43, s32
    s_mul_i32 s25, s25, 17
    s_mul_i32 s66, s24, 24
    s_add_u32 s66, s66, s25
    s_add_u32 s24, s24, 8
    s_cmp_gt_u32 s24, s32
    s_cselect_b32 s66, 0xffff, s66
    s_min_u32 s71, s64, s65
    s_min_u32 s71, s71, s66
    s_cmp_eq_u32 s71, 0xffff
    s_cbranch_scc1 L_H_x
    s_add_u32 s24, s71, 36
    s_cmp_lt_i32 s24, s70
    s_cbranch_scc1 L_H_go
    s_sleep 4
    s_branch L_H
L_H_go:
    s_cmp_lg_u32 s71, s64
    s_cbranch_scc1 L_H_n0
    s_sub_u32 s27, s27, 2
    s_mul_i32 s24, s27, 24576
    s_add_u32 s24, s24, 0
    s_branch L_H_ld
L_H_n0:
    s_cmp_lg_u32 s71, s65
    s_cbranch_scc1 L_H_n1
    s_sub_u32 s28, s28, 2
    s_mul_i32 s24, s28, 24576
    s_add_u32 s24, s24, 2048
    s_branch L_H_ld
L_H_n1:
    s_sub_u32 s32, s32, 2
    s_mul_i32 s24, s32, 24576
    s_add_u32 s24, s24, 4096
L_H_ld:
    buffer_load_dword v5, v16, s[4:7], s24 offen
    buffer_load_dword v5, v16, s[8:11], s24 offen
    s_add_u32 s24, s24, 24576
    buffer_load_dword v5, v16, s[4:7], s24 offen
    buffer_load_dword v5, v16, s[8:11], s24 offen
    s_branch L_H
L_H_x:
    s_mov_b32 s24, 262144
L_pd18:
    buffer_load_dwordx4 v[56:59], v2, s[12:15], s29 offen offset:0 sc1
    buffer_load_dwordx4 v[60:63], v2, s[12:15], s29 offen offset:1024 sc1
    buffer_load_dwordx4 v[64:67], v2, s[12:15], s29 offen offset:2048 sc1
    buffer_load_dwordx4 v[68:71], v2, s[12:15], s29 offen offset:3072 sc1
    buffer_load_dwordx4 v[72:75], v2, s[12:15], s42 offen offset:0 sc1
    buffer_load_dwordx4 v[76:79], v2, s[12:15], s42 offen offset:1024 sc1
    s_waitcnt vmcnt(0)
    v_max_u32 v3, v56, v57
    v_max3_u32 v3, v3, v58, v59
    v_max3_u32 v3, v3, v60, v61
    v_max3_u32 v3, v3, v62, v63
    v_max3_u32 v3, v3, v64, v65
    v_max3_u32 v3, v3, v66, v67
    v_max3_u32 v3, v3, v68, v69
    v_max3_u32 v3, v3, v70, v71
    v_max3_u32 v3, v3, v72, v73
    v_max3_u32 v3, v3, v74, v75
    v_max3_u32 v3, v3, v76, v77
    v_max3_u32 v3, v3, v78, v79
    v_cmp_eq_u32 vcc, -1, v3
    s_sub_u32 s24, s24, 1
    s_cmp_eq_u32 s24, 0
    s_cbranch_scc1 L_pd18_x
    s_and_b64 exec, exec, vcc
    s_cbranch_scc1 L_pd18
L_pd18_x:
    s_mov_b64 exec, -1
L_P_go:
    v_mfma_f32_16x16x32_bf16 v[12:15], v[56:59], v[32:35], 0
    v_mfma_f32_16x16x32_bf16 v[16:19], v[68:71], v[44:47], 0
    v_mfma_f32_16x16x32_bf16 v[12:15], v[60:63], v[36:39], v[12:15]
    v_mfma_f32_16x16x32_bf16 v[16:19], v[72:75], v[48:51], v[16:19]
    v_mfma_f32_16x16x32_bf16 v[12:15], v[64:67], v[40:43], v[12:15]
    v_mfma_f32_16x16x32_bf16 v[16:19], v[76:79], v[52:55], v[16:19]
    s_barrier
    s_mov_b64 exec, 1
    v_mov_b32 v83, 64
    buffer_atomic_add v83, off, s[12:15], s40 sc0
    s_mov_b64 exec, -1
    s_nop 1
    v_cvt_pk_bf16_f32 v4, v12, v13
    v_cvt_pk_bf16_f32 v5, v14, v15
    ds_write_b64 v24, v[4:5]
    v_cvt_pk_bf16_f32 v6, v16, v17
    v_cvt_pk_bf16_f32 v7, v18, v19
    ds_write_b64 v24, v[6:7] offset:640
    s_waitcnt lgkmcnt(0)
    s_barrier
    ds_read_b128 v[128:131], v25 offset:0
    ds_read_b128 v[132:135], v25 offset:64
    ds_read_b128 v[136:139], v25 offset:128
    ds_read_b128 v[140:143], v25 offset:192
    ds_read_b128 v[144:147], v25 offset:1280
    ds_read_b128 v[148:151], v25 offset:1344
    ds_read_b128 v[152:155], v25 offset:1408
    ds_read_b128 v[156:159], v25 offset:1472
    ds_read_b128 v[160:163], v25 offset:2560
    s_waitcnt lgkmcnt(8)
    v_mfma_f32_16x16x32_bf16 v[12:15], v[128:131], a[128:131], 0
    ds_read_b128 v[164:167], v25 offset:2624
    s_waitcnt lgkmcnt(8)
    v_mfma_f32_16x16x32_bf16 v[12:15], v[132:135], a[132:135], v[12:15]
    ds_read_b128 v[168:171], v25 offset:2688
    s_waitcnt lgkmcnt(8)
    v_mfma_f32_16x16x32_bf16 v[12:15], v[136:139], a[136:139], v[12:15]
    ds_read_b128 v[172:175], v25 offset:2752
    s_waitcnt lgkmcnt(8)
    v_mfma_f32_16x16x32_bf16 v[12:15], v[140:143], a[140:143], v[12:15]
    ds_read_b128 v[176:179], v25 offset:3840
    s_waitcnt lgkmcnt(8)
    v_mfma_f32_16x16x32_bf16 v[12:15], v[144:147], a[144:147], v[12:15]
    ds_read_b128 v[180:183], v25 offset:3904
    s_waitcnt lgkmcnt(8)
    v_mfma_f32_16x16x32_bf16 v[12:15], v[148:151], a[148:151], v[12:15]
    ds_read_b128 v[184:187], v25 offset:3968
    s_waitcnt lgkmcnt(8)
    v_mfma_f32_16x16x32_bf16 v[12:15], v[152:155], a[152:155], v[12:15]
    ds_read_b128 v[188:191], v25 offset:4032
    s_waitcnt lgkmcnt(8)
    v_mfma_f32_16x16x32_bf16 v[12:15], v[156:159], a[156:159], v[12:15]
    s_waitcnt lgkmcnt(7)
    v_mfma_f32_16x16x32_bf16 v[12:15], v[160:163], a[160:163], v[12:15]
    s_waitcnt lgkmcnt(6)
    v_mfma_f32_16x16x32_bf16 v[12:15], v[164:167], a[164:167], v[12:15]
    s_waitcnt lgkmcnt(5)
    v_mfma_f32_16x16x32_bf16 v[12:15], v[168:171], a[168:171], v[12:15]
    s_waitcnt lgkmcnt(4)
    v_mfma_f32_16x16x32_bf16 v[12:15], v[172:175], a[172:175], v[12:15]
    s_waitcnt lgkmcnt(3)
    v_mfma_f32_16x16x32_bf16 v[12:15], v[176:179], a[176:179], v[12:15]
    s_waitcnt lgkmcnt(2)
    v_mfma_f32_16x16x32_bf16 v[12:15], v[180:183], a[180:183], v[12:15]
    s_waitcnt lgkmcnt(1)
    v_mfma_f32_16x16x32_bf16 v[12:15], v[184:187], a[184:187], v[12:15]
    s_waitcnt lgkmcnt(0)
    v_mfma_f32_16x16x32_bf16 v[12:15], v[188:191], a[188:191], v[12:15]
    s_nop 7
    v_cvt_pk_bf16_f32 v4, v12, v13
    v_cvt_pk_bf16_f32 v5, v14, v15
    s_mov_b64 exec, 0xffff
    buffer_store_dwordx2 v[4:5], v26, s[12:15], s31 offen sc1
    s_mov_b64 exec, -1
    v_mov_b32 v16, v4
    v_mov_b32 v17, v5
    v_mov_b32 v18, v4
    v_mov_b32 v19, v5
    v_mov_b32_dpp v16, v4 row_ror:8 row_mask:0xf bank_mask:0xc
    v_mov_b32_dpp v17, v5 row_ror:8 row_mask:0xf bank_mask:0xc
    v_mov_b32_dpp v18, v4 row_ror:8 row_mask:0xf bank_mask:0x3
    v_mov_b32_dpp v19, v5 row_ror:8 row_mask:0xf bank_mask:0x3
    s_waitcnt vmcnt(1)
    v_readfirstlane_b32 s24, v83
    s_nop 0
    s_cmp_eq_u32 s24, s33
    s_cbranch_scc1 L_P_f
    s_waitcnt vmcnt(0)
    v_readfirstlane_b32 s24, v83
    s_nop 0
    s_cmp_lg_u32 s24, s33
    s_cbranch_scc1 L_P_n
L_P_f:
    s_mov_b64 exec, s[44:45]
    s_mov_b32 s24, 262144
L_pd19:
    buffer_load_dwordx4 v[16:19], v2, s[12:15], s30 offen sc1
    s_waitcnt vmcnt(0)
    v_max_u32 v3, v16, v17
    v_max3_u32 v3, v3, v18, v19
    v_cmp_eq_u32 vcc, -1, v3
    s_sub_u32 s24, s24, 1
    s_cmp_eq_u32 s24, 0
    s_cbranch_scc1 L_pd19_x
    s_and_b64 exec, exec, vcc
    s_cbranch_scc1 L_pd19
L_pd19_x:
    s_mov_b64 exec, -1
    v_lshlrev_b32 v56, 16, v16
    v_and_b32 v57, 0xffff0000, v16
    v_lshlrev_b32 v58, 16, v17
    v_and_b32 v59, 0xffff0000, v17
    v_lshlrev_b32 v60, 16, v18
    v_and_b32 v61, 0xffff0000, v18
    v_lshlrev_b32 v62, 16, v19
    v_and_b32 v63, 0xffff0000, v19
    v_permlane32_swap_b32 v56, v58
    v_permlane32_swap_b32 v57, v59
    v_permlane32_swap_b32 v60, v62
    v_permlane32_swap_b32 v61, v63
    v_add_f32 v56, v56, v58
    v_add_f32 v57, v57, v59
    v_add_f32 v60, v60, v62
    v_add_f32 v61, v61, v63
    v_permlane16_swap_b32 v56, v57
    s_nop 0
    v_permlane16_swap_b32 v60, v61
    v_add_f32 v56, v56, v57
    v_add_f32 v60, v60, v61
    s_nop 0
    v_add_f32_dpp v4, v56, v56 row_ror:8 row_mask:0xf bank_mask:0x3
    s_nop 1
    v_add_f32_dpp v4, v60, v60 row_ror:8 row_mask:0xf bank_mask:0xc
    v_cvt_pk_bf16_f32 v4, v4, v4
    buffer_store_short v4, v28, s[20:23], s41 offen
L_P_n:
    s_cmp_lg_u32 s33, 0
    s_cbranch_scc1 L_P_x
    s_barrier
    s_branch L_P
L_P_x:
L_end:
    s_endpgm
L_C:
    s_cmp_lg_u32 s3, 0
    s_cbranch_scc1 L_C_q
    v_lshrrev_b32 v3, 4, v0
    v_and_b32 v4, 3, v0
    v_lshlrev_b32 v5, 6, v3
    v_lshl_add_u32 v5, v4, 4, v5
    v_bfe_u32 v4, v0, 2, 2
    v_lshl_add_u32 v5, v4, 8, v5
    s_lshl_b32 s24, s26, 10
    s_add_u32 s24, s24, 0x164000
    buffer_store_dwordx4 v[8:11], v5, s[12:15], s24 offen sc1
L_C_q:
    s_waitcnt vmcnt(0)
    s_barrier
    s_cmp_lg_u32 s3, 0
    s_cbranch_scc1 L_sig20
    s_mov_b64 exec, 1
    v_mov_b32 v3, 1
    v_mov_b32 v4, 1
    buffer_atomic_add v4, off, s[16:19], 0 offset:128
    buffer_atomic_add v3, off, s[16:19], 0 offset:0 sc0
    s_waitcnt vmcnt(0)
    v_readfirstlane_b32 s24, v3
    s_mov_b64 exec, -1
    s_and_b32 s24, s24, 63
    s_cmp_lg_u32 s24, 63
    s_cbranch_scc1 L_sig20
    v_lshlrev_b32 v4, 7, v0
    v_mov_b32 v3, 1
    s_mov_b32 s24, 0x170000
    buffer_store_dword v3, v4, s[12:15], s24 offen offset:0 sc1
L_sig20:
    s_mov_b32 s8, s56
    s_mov_b32 s9, s57
    s_mov_b32 s10, 0x400000
    s_mov_b32 s11, 0x20000
    s_and_b32 s24, s3, 1
    s_lshl_b32 s24, s24, 1
    s_and_b32 s25, s3, 2
    s_lshl_b32 s25, s25, 3
    s_or_b32 s25, s25, s24
    s_and_b32 s24, s26, 13
    s_or_b32 s25, s25, s24
    s_lshl_b32 s25, s25, 17
    s_lshr_b32 s24, s74, 3
    s_lshl_b32 s24, s24, 7
    s_add_u32 s24, s24, s25
    v_lshrrev_b32 v3, 4, v0
    v_lshlrev_b32 v3, 15, v3
    v_and_b32 v4, 8, v0
    v_lshl_add_u32 v3, v4, 10, v3
    v_and_b32 v4, 0x70, v2
    v_add_u32 v3, v3, v4
    s_mul_i32 m0, s3, 16896
    s_nop 0
    buffer_load_dwordx4 v3, s[8:11], s24 offen nt lds
    s_add_u32 m0, m0, 1056
    s_add_u32 s24, s24, 2048
    buffer_load_dwordx4 v3, s[8:11], s24 offen nt lds
    s_add_u32 m0, m0, 1056
    s_add_u32 s24, s24, 2048
    buffer_load_dwordx4 v3, s[8:11], s24 offen nt lds
    s_add_u32 m0, m0, 1056
    s_add_u32 s24, s24, 2048
    buffer_load_dwordx4 v3, s[8:11], s24 offen nt lds
    s_add_u32 m0, m0, 1056
    s_add_u32 s24, s24, 10240
    buffer_load_dwordx4 v3, s[8:11], s24 offen nt lds
    s_add_u32 m0, m0, 1056
    s_add_u32 s24, s24, 2048
    buffer_load_dwordx4 v3, s[8:11], s24 offen nt lds
    s_add_u32 m0, m0, 1056
    s_add_u32 s24, s24, 2048
    buffer_load_dwordx4 v3, s[8:11], s24 offen nt lds
    s_add_u32 m0, m0, 1056
    s_add_u32 s24, s24, 2048
    buffer_load_dwordx4 v3, s[8:11], s24 offen nt lds
    s_add_u32 m0, m0, 1056
    s_add_u32 s24, s24, -21504
    buffer_load_dwordx4 v3, s[8:11], s24 offen nt lds
    s_add_u32 m0, m0, 1056
    s_add_u32 s24, s24, 2048
    buffer_load_dwordx4 v3, s[8:11], s24 offen nt lds
    s_add_u32 m0, m0, 1056
    s_add_u32 s24, s24, 2048
    buffer_load_dwordx4 v3, s[8:11], s24 offen nt lds
    s_add_u32 m0, m0, 1056
    s_add_u32 s24, s24, 2048
    buffer_load_dwordx4 v3, s[8:11], s24 offen nt lds
    s_add_u32 m0, m0, 1056
    s_add_u32 s24, s24, 10240
    buffer_load_dwordx4 v3, s[8:11], s24 offen nt lds
    s_add_u32 m0, m0, 1056
    s_add_u32 s24, s24, 2048
    buffer_load_dwordx4 v3, s[8:11], s24 offen nt lds
    s_add_u32 m0, m0, 1056
    s_add_u32 s24, s24, 2048
    buffer_load_dwordx4 v3, s[8:11], s24 offen nt lds
    s_add_u32 m0, m0, 1056
    s_add_u32 s24, s24, 2048
    buffer_load_dwordx4 v3, s[8:11], s24 offen nt lds
    s_waitcnt vmcnt(0)
    s_barrier
    v_lshrrev_b32 v3, 2, v0
    v_mul_u32_u24 v3, 1056, v3
    v_and_b32 v4, 3, v0
    v_lshl_add_u32 v3, v4, 3, v3
    s_lshl_b32 s24, s3, 5
    v_add_u32 v3, s24, v3
    ds_read_b64_tr_b16 a[128:129], v3 offset:0
    ds_read_b64_tr_b16 a[130:131], v3 offset:128
    ds_read_b64_tr_b16 a[132:133], v3 offset:256
    ds_read_b64_tr_b16 a[134:135], v3 offset:384
    ds_read_b64_tr_b16 a[136:137], v3 offset:512
    ds_read_b64_tr_b16 a[138:139], v3 offset:640
    ds_read_b64_tr_b16 a[140:141], v3 offset:768
    ds_read_b64_tr_b16 a[142:143], v3 offset:896
    ds_read_b64_tr_b16 a[144:145], v3 offset:16896
    ds_read_b64_tr_b16 a[146:147], v3 offset:17024
    ds_read_b64_tr_b16 a[148:149], v3 offset:17152
    ds_read_b64_tr_b16 a[150:151], v3 offset:17280
    ds_read_b64_tr_b16 a[152:153], v3 offset:17408
    ds_read_b64_tr_b16 a[154:155], v3 offset:17536
    ds_read_b64_tr_b16 a[156:157], v3 offset:17664
    ds_read_b64_tr_b16 a[158:159], v3 offset:17792
    ds_read_b64_tr_b16 a[160:161], v3 offset:33792
    ds_read_b64_tr_b16 a[162:163], v3 offset:33920
    ds_read_b64_tr_b16 a[164:165], v3 offset:34048
    ds_read_b64_tr_b16 a[166:167], v3 offset:34176
    ds_read_b64_tr_b16 a[168:169], v3 offset:34304
    ds_read_b64_tr_b16 a[170:171], v3 offset:34432
    ds_read_b64_tr_b16 a[172:173], v3 offset:34560
    ds_read_b64_tr_b16 a[174:175], v3 offset:34688
    ds_read_b64_tr_b16 a[176:177], v3 offset:50688
    ds_read_b64_tr_b16 a[178:179], v3 offset:50816
    ds_read_b64_tr_b16 a[180:181], v3 offset:50944
    ds_read_b64_tr_b16 a[182:183], v3 offset:51072
    ds_read_b64_tr_b16 a[184:185], v3 offset:51200
    ds_read_b64_tr_b16 a[186:187], v3 offset:51328
    ds_read_b64_tr_b16 a[188:189], v3 offset:51456
    ds_read_b64_tr_b16 a[190:191], v3 offset:51584
    s_and_b32 s70, s72, 3
    s_lshr_b32 s71, s72, 4
    s_bfe_u32 s24, s72, 0x10002
    s_lshl_b32 s24, s24, 1
    s_add_u32 s71, s71, s24
    s_bfe_u32 s75, s72, 0x10003
    s_lshl_b32 s30, s71, 22
    s_add_u32 s4, s38, s30
    s_addc_u32 s5, s39, 0
    s_mov_b32 s6, 0x400000
    s_mov_b32 s7, 0x20000
    s_mul_i32 s32, s3, 65536
    s_lshl_b32 s24, s70, 10
    s_add_u32 s32, s32, s24
    s_mul_i32 s34, s3, 16896
    s_waitcnt lgkmcnt(0)
    s_barrier
    s_mov_b32 m0, s34
    s_nop 0
    buffer_load_dwordx4 v2, s[4:7], s32 offen lds
    s_add_u32 m0, m0, 1056
    s_add_u32 s32, s32, 4096
    buffer_load_dwordx4 v2, s[4:7], s32 offen lds
    s_add_u32 m0, m0, 1056
    s_add_u32 s32, s32, 4096
    buffer_load_dwordx4 v2, s[4:7], s32 offen lds
    s_add_u32 m0, m0, 1056
    s_add_u32 s32, s32, 4096
    buffer_load_dwordx4 v2, s[4:7], s32 offen lds
    s_add_u32 m0, m0, 1056
    s_add_u32 s32, s32, 4096
    buffer_load_dwordx4 v2, s[4:7], s32 offen lds
    s_add_u32 m0, m0, 1056
    s_add_u32 s32, s32, 4096
    buffer_load_dwordx4 v2, s[4:7], s32 offen lds
    s_add_u32 m0, m0, 1056
    s_add_u32 s32, s32, 4096
    buffer_load_dwordx4 v2, s[4:7], s32 offen lds
    s_add_u32 m0, m0, 1056
    s_add_u32 s32, s32, 4096
    buffer_load_dwordx4 v2, s[4:7], s32 offen lds
    s_add_u32 m0, m0, 1056
    s_add_u32 s32, s32, 4096
    buffer_load_dwordx4 v2, s[4:7], s32 offen lds
    s_add_u32 m0, m0, 1056
    s_add_u32 s32, s32, 4096
    buffer_load_dwordx4 v2, s[4:7], s32 offen lds
    s_add_u32 m0, m0, 1056
    s_add_u32 s32, s32, 4096
    buffer_load_dwordx4 v2, s[4:7], s32 offen lds
    s_add_u32 m0, m0, 1056
    s_add_u32 s32, s32, 4096
    buffer_load_dwordx4 v2, s[4:7], s32 offen lds
    s_add_u32 m0, m0, 1056
    s_add_u32 s32, s32, 4096
    buffer_load_dwordx4 v2, s[4:7], s32 offen lds
    s_add_u32 m0, m0, 1056
    s_add_u32 s32, s32, 4096
    buffer_load_dwordx4 v2, s[4:7], s32 offen lds
    s_add_u32 m0, m0, 1056
    s_add_u32 s32, s32, 4096
    buffer_load_dwordx4 v2, s[4:7], s32 offen lds
    s_add_u32 m0, m0, 1056
    s_add_u32 s32, s32, 4096
    buffer_load_dwordx4 v2, s[4:7], s32 offen lds
    s_add_u32 m0, m0, 1056
    s_add_u32 s32, s32, 200704
    s_lshr_b32 s28, s3, 1
    s_and_b32 s29, s3, 1
    v_and_b32 v3, 15, v0
    v_lshrrev_b32 v4, 4, v0
    v_mul_u32_u24 v19, 1056, v3
    v_lshl_add_u32 v19, v4, 4, v19
    v_lshrrev_b32 v5, 2, v0
    v_mul_u32_u24 v20, 1056, v5
    v_and_b32 v5, 3, v0
    v_lshl_add_u32 v20, v5, 3, v20
    s_lshl_b32 s24, s29, 9
    v_add_u32 v20, s24, v20
    v_and_b32 v3, 15, v0
    v_mul_u32_u24 v18, 1056, v3
    v_lshl_add_u32 v18, v4, 4, v18
    v_add_u32 v18, 101376, v18
    s_mul_i32 s24, s28, 33792
    v_add_u32 v19, s24, v19
    v_add_u32 v20, s24, v20
    v_mov_b32 v128, 0
    v_mov_b32 v129, 0
    v_mov_b32 v130, 0
    v_mov_b32 v131, 0
    v_mov_b32 v132, 0
    v_mov_b32 v133, 0
    v_mov_b32 v134, 0
    v_mov_b32 v135, 0
    v_mov_b32 v136, 0
    v_mov_b32 v137, 0
    v_mov_b32 v138, 0
    v_mov_b32 v139, 0
    v_mov_b32 v140, 0
    v_mov_b32 v141, 0
    v_mov_b32 v142, 0
    v_mov_b32 v143, 0
    v_mov_b32 v144, 0
    v_mov_b32 v145, 0
    v_mov_b32 v146, 0
    v_mov_b32 v147, 0
    v_mov_b32 v148, 0
    v_mov_b32 v149, 0
    v_mov_b32 v150, 0
    v_mov_b32 v151, 0
    v_mov_b32 v152, 0
    v_mov_b32 v153, 0
    v_mov_b32 v154, 0
    v_mov_b32 v155, 0
    v_mov_b32 v156, 0
    v_mov_b32 v157, 0
    v_mov_b32 v158, 0
    v_mov_b32 v159, 0
    v_mov_b32 v160, 0
    v_mov_b32 v161, 0
    v_mov_b32 v162, 0
    v_mov_b32 v163, 0
    v_mov_b32 v164, 0
    v_mov_b32 v165, 0
    v_mov_b32 v166, 0
    v_mov_b32 v167, 0
    v_mov_b32 v168, 0
    v_mov_b32 v169, 0
    v_mov_b32 v170, 0
    v_mov_b32 v171, 0
    v_mov_b32 v172, 0
    v_mov_b32 v173, 0
    v_mov_b32 v174, 0
    v_mov_b32 v175, 0
    v_mov_b32 v176, 0
    v_mov_b32 v177, 0
    v_mov_b32 v178, 0
    v_mov_b32 v179, 0
    v_mov_b32 v180, 0
    v_mov_b32 v181, 0
    v_mov_b32 v182, 0
    v_mov_b32 v183, 0
    v_mov_b32 v184, 0
    v_mov_b32 v185, 0
    v_mov_b32 v186, 0
    v_mov_b32 v187, 0
    v_mov_b32 v188, 0
    v_mov_b32 v189, 0
    v_mov_b32 v190, 0
    v_mov_b32 v191, 0
    v_mov_b32 v22, 0xff800000
    v_mov_b32 v23, 0
    s_cmp_lg_u32 s3, 0
    s_cbranch_scc1 L_awx21
    s_mov_b32 s24, 262144
    s_mov_b64 exec, 1
L_aw22:
    buffer_load_dword v1, off, s[12:15], s73 offset:0 sc1
    s_waitcnt vmcnt(0)
    v_readfirstlane_b32 s25, v1
    s_nop 0
    s_cmp_eq_u32 s25, 1
    s_cbranch_scc1 L_awx21
    s_sleep 4
    s_sub_u32 s24, s24, 1
    s_cmp_lg_u32 s24, 0
    s_cbranch_scc1 L_aw22
L_awx21:
    s_mov_b64 exec, -1
    s_barrier
    s_lshl_b32 s24, s71, 15
    s_mul_i32 s25, s3, 4096
    s_add_u32 s24, s24, s25
    s_add_u32 s24, s24, 0x0
    s_mul_i32 s25, s75, 16384
    s_add_u32 s24, s24, s25
    buffer_load_dwordx4 v[32:35], v2, s[12:15], s24 offen offset:0 sc1
    buffer_load_dwordx4 v[36:39], v2, s[12:15], s24 offen offset:1024 sc1
    buffer_load_dwordx4 v[40:43], v2, s[12:15], s24 offen offset:2048 sc1
    buffer_load_dwordx4 v[44:47], v2, s[12:15], s24 offen offset:3072 sc1
    s_mul_i32 s24, s3, 4224
    s_add_u32 s24, s24, 101376
    v_add_u32 v3, s24, v2
    s_waitcnt vmcnt(3)
    ds_write_b128 v3, v[32:35] offset:0
    s_waitcnt vmcnt(2)
    ds_write_b128 v3, v[36:39] offset:1056
    s_waitcnt vmcnt(1)
    ds_write_b128 v3, v[40:43] offset:2112
    s_waitcnt vmcnt(0)
    ds_write_b128 v3, v[44:47] offset:3168
    s_waitcnt lgkmcnt(0)
    s_barrier
    ds_read_b128 a[0:3], v18 offset:0
    ds_read_b128 a[4:7], v18 offset:64
    ds_read_b128 a[8:11], v18 offset:128
    ds_read_b128 a[12:15], v18 offset:192
    ds_read_b128 a[16:19], v18 offset:256
    ds_read_b128 a[20:23], v18 offset:320
    ds_read_b128 a[24:27], v18 offset:384
    ds_read_b128 a[28:31], v18 offset:448
    ds_read_b128 a[32:35], v18 offset:512
    ds_read_b128 a[36:39], v18 offset:576
    ds_read_b128 a[40:43], v18 offset:640
    ds_read_b128 a[44:47], v18 offset:704
    ds_read_b128 a[48:51], v18 offset:768
    ds_read_b128 a[52:55], v18 offset:832
    ds_read_b128 a[56:59], v18 offset:896
    ds_read_b128 a[60:63], v18 offset:960
    s_cmp_lg_u32 s3, 0
    s_cbranch_scc1 L_xi23
    s_and_b32 s24, s74, 7
    s_lshl_b32 s24, s24, 5
    s_lshr_b32 s25, s74, 3
    s_add_u32 s24, s24, s25
    s_lshl_b32 s24, s24, 2
    s_add_u32 s24, s24, 0x1b6000
    s_getreg_b32 s25, hwreg(HW_REG_XCC_ID, 0, 4)
    s_mov_b64 exec, 1
    v_mov_b32 v3, s25
    buffer_store_dword v3, off, s[12:15], s24 sc1
    s_mov_b64 exec, -1
L_xi23:
    s_mov_b32 s27, 0
    s_mov_b32 s33, 67584
    s_mov_b32 s35, 0
    s_waitcnt lgkmcnt(0)
L_CT:
    s_waitcnt vmcnt(0)
    s_barrier
    v_add_u32 v24, s35, v19
    v_add_u32 v25, s35, v20
    ds_read_b128 v[32:35], v24 offset:0
    ds_read_b128 v[36:39], v24 offset:16896
    ds_read_b128 v[40:43], v24 offset:64
    ds_read_b128 v[44:47], v24 offset:16960
    ds_read_b128 v[48:51], v24 offset:128
    ds_read_b128 v[52:55], v24 offset:17024
    ds_read_b128 v[56:59], v24 offset:192
    s_add_u32 m0, s33, s34
    s_mov_b32 s33, s35
    s_add_u32 s35, s35, 67584
    s_cmp_eq_u32 s35, 135168
    s_cselect_b32 s35, 0, s35
    s_waitcnt lgkmcnt(6)
    v_mfma_f32_16x16x32_bf16 v[64:67], v[32:35], a[0:3], 0
    ds_read_b128 v[60:63], v24 offset:17088
    buffer_load_dwordx4 v2, s[4:7], s32 offen lds
    s_add_u32 m0, m0, 1056
    s_add_u32 s32, s32, 4096
    s_waitcnt lgkmcnt(6)
    v_mfma_f32_16x16x32_bf16 v[68:71], v[36:39], a[0:3], 0
    ds_read_b128 v[32:35], v24 offset:256
    s_waitcnt lgkmcnt(6)
    v_mfma_f32_16x16x32_bf16 v[64:67], v[40:43], a[4:7], v[64:67]
    ds_read_b128 v[36:39], v24 offset:17152
    buffer_load_dwordx4 v2, s[4:7], s32 offen lds
    s_add_u32 m0, m0, 1056
    s_add_u32 s32, s32, 4096
    s_waitcnt lgkmcnt(6)
    v_mfma_f32_16x16x32_bf16 v[68:71], v[44:47], a[4:7], v[68:71]
    ds_read_b128 v[40:43], v24 offset:320
    s_waitcnt lgkmcnt(6)
    v_mfma_f32_16x16x32_bf16 v[64:67], v[48:51], a[8:11], v[64:67]
    ds_read_b128 v[44:47], v24 offset:17216
    buffer_load_dwordx4 v2, s[4:7], s32 offen lds
    s_add_u32 m0, m0, 1056
    s_add_u32 s32, s32, 4096
    s_waitcnt lgkmcnt(6)
    v_mfma_f32_16x16x32_bf16 v[68:71], v[52:55], a[8:11], v[68:71]
    ds_read_b128 v[48:51], v24 offset:384
    s_waitcnt lgkmcnt(6)
    v_mfma_f32_16x16x32_bf16 v[64:67], v[56:59], a[12:15], v[64:67]
    ds_read_b128 v[52:55], v24 offset:17280
    buffer_load_dwordx4 v2, s[4:7], s32 offen lds
    s_add_u32 m0, m0, 1056
    s_add_u32 s32, s32, 4096
    s_waitcnt lgkmcnt(6)
    v_mfma_f32_16x16x32_bf16 v[68:71], v[60:63], a[12:15], v[68:71]
    ds_read_b128 v[56:59], v24 offset:448
    s_waitcnt lgkmcnt(6)
    v_mfma_f32_16x16x32_bf16 v[64:67], v[32:35], a[16:19], v[64:67]
    ds_read_b128 v[60:63], v24 offset:17344
    buffer_load_dwordx4 v2, s[4:7], s32 offen lds
    s_add_u32 m0, m0, 1056
    s_add_u32 s32, s32, 4096
    s_waitcnt lgkmcnt(6)
    v_mfma_f32_16x16x32_bf16 v[68:71], v[36:39], a[16:19], v[68:71]
    ds_read_b128 v[32:35], v24 offset:512
    s_waitcnt lgkmcnt(6)
    v_mfma_f32_16x16x32_bf16 v[64:67], v[40:43], a[20:23], v[64:67]
    ds_read_b128 v[36:39], v24 offset:17408
    buffer_load_dwordx4 v2, s[4:7], s32 offen lds
    s_add_u32 m0, m0, 1056
    s_add_u32 s32, s32, 4096
    s_waitcnt lgkmcnt(6)
    v_mfma_f32_16x16x32_bf16 v[68:71], v[44:47], a[20:23], v[68:71]
    ds_read_b128 v[40:43], v24 offset:576
    s_waitcnt lgkmcnt(6)
    v_mfma_f32_16x16x32_bf16 v[64:67], v[48:51], a[24:27], v[64:67]
    ds_read_b128 v[44:47], v24 offset:17472
    buffer_load_dwordx4 v2, s[4:7], s32 offen lds
    s_add_u32 m0, m0, 1056
    s_add_u32 s32, s32, 4096
    s_waitcnt lgkmcnt(6)
    v_mfma_f32_16x16x32_bf16 v[68:71], v[52:55], a[24:27], v[68:71]
    ds_read_b128 v[48:51], v24 offset:640
    s_waitcnt lgkmcnt(6)
    v_mfma_f32_16x16x32_bf16 v[64:67], v[56:59], a[28:31], v[64:67]
    ds_read_b128 v[52:55], v24 offset:17536
    buffer_load_dwordx4 v2, s[4:7], s32 offen lds
    s_add_u32 m0, m0, 1056
    s_add_u32 s32, s32, 4096
    s_waitcnt lgkmcnt(6)
    v_mfma_f32_16x16x32_bf16 v[68:71], v[60:63], a[28:31], v[68:71]
    ds_read_b128 v[56:59], v24 offset:704
    s_waitcnt lgkmcnt(6)
    v_mfma_f32_16x16x32_bf16 v[64:67], v[32:35], a[32:35], v[64:67]
    ds_read_b128 v[60:63], v24 offset:17600
    buffer_load_dwordx4 v2, s[4:7], s32 offen lds
    s_add_u32 m0, m0, 1056
    s_add_u32 s32, s32, 4096
    s_waitcnt lgkmcnt(6)
    v_mfma_f32_16x16x32_bf16 v[68:71], v[36:39], a[32:35], v[68:71]
    ds_read_b128 v[32:35], v24 offset:768
    s_waitcnt lgkmcnt(6)
    v_mfma_f32_16x16x32_bf16 v[64:67], v[40:43], a[36:39], v[64:67]
    ds_read_b128 v[36:39], v24 offset:17664
    buffer_load_dwordx4 v2, s[4:7], s32 offen lds
    s_add_u32 m0, m0, 1056
    s_add_u32 s32, s32, 4096
    s_waitcnt lgkmcnt(6)
    v_mfma_f32_16x16x32_bf16 v[68:71], v[44:47], a[36:39], v[68:71]
    ds_read_b128 v[40:43], v24 offset:832
    s_waitcnt lgkmcnt(6)
    v_mfma_f32_16x16x32_bf16 v[64:67], v[48:51], a[40:43], v[64:67]
    ds_read_b128 v[44:47], v24 offset:17728
    buffer_load_dwordx4 v2, s[4:7], s32 offen lds
    s_add_u32 m0, m0, 1056
    s_add_u32 s32, s32, 4096
    s_waitcnt lgkmcnt(6)
    v_mfma_f32_16x16x32_bf16 v[68:71], v[52:55], a[40:43], v[68:71]
    ds_read_b128 v[48:51], v24 offset:896
    s_waitcnt lgkmcnt(6)
    v_mfma_f32_16x16x32_bf16 v[64:67], v[56:59], a[44:47], v[64:67]
    ds_read_b128 v[52:55], v24 offset:17792
    buffer_load_dwordx4 v2, s[4:7], s32 offen lds
    s_add_u32 m0, m0, 1056
    s_add_u32 s32, s32, 4096
    s_waitcnt lgkmcnt(6)
    v_mfma_f32_16x16x32_bf16 v[68:71], v[60:63], a[44:47], v[68:71]
    ds_read_b128 v[56:59], v24 offset:960
    s_waitcnt lgkmcnt(6)
    v_mfma_f32_16x16x32_bf16 v[64:67], v[32:35], a[48:51], v[64:67]
    ds_read_b128 v[60:63], v24 offset:17856
    buffer_load_dwordx4 v2, s[4:7], s32 offen lds
    s_add_u32 m0, m0, 1056
    s_add_u32 s32, s32, 4096
    s_waitcnt lgkmcnt(6)
    v_mfma_f32_16x16x32_bf16 v[68:71], v[36:39], a[48:51], v[68:71]
    ds_read_b64_tr_b16 v[192:193], v25 offset:0
    s_waitcnt lgkmcnt(6)
    v_mfma_f32_16x16x32_bf16 v[64:67], v[40:43], a[52:55], v[64:67]
    ds_read_b64_tr_b16 v[194:195], v25 offset:16896
    buffer_load_dwordx4 v2, s[4:7], s32 offen lds
    s_add_u32 m0, m0, 1056
    s_add_u32 s32, s32, 4096
    s_waitcnt lgkmcnt(6)
    v_mfma_f32_16x16x32_bf16 v[68:71], v[44:47], a[52:55], v[68:71]
    ds_read_b64_tr_b16 v[196:197], v25 offset:32
    s_waitcnt lgkmcnt(6)
    v_mfma_f32_16x16x32_bf16 v[64:67], v[48:51], a[56:59], v[64:67]
    ds_read_b64_tr_b16 v[198:199], v25 offset:16928
    buffer_load_dwordx4 v2, s[4:7], s32 offen lds
    s_add_u32 m0, m0, 1056
    s_add_u32 s32, s32, 4096
    s_waitcnt lgkmcnt(6)
    v_mfma_f32_16x16x32_bf16 v[68:71], v[52:55], a[56:59], v[68:71]
    ds_read_b64_tr_b16 v[200:201], v25 offset:64
    s_waitcnt lgkmcnt(6)
    v_mfma_f32_16x16x32_bf16 v[64:67], v[56:59], a[60:63], v[64:67]
    ds_read_b64_tr_b16 v[202:203], v25 offset:16960
    buffer_load_dwordx4 v2, s[4:7], s32 offen lds
    s_add_u32 m0, m0, 1056
    s_add_u32 s32, s32, 200704
    s_waitcnt lgkmcnt(6)
    v_mfma_f32_16x16x32_bf16 v[68:71], v[60:63], a[60:63], v[68:71]
    ds_read_b64_tr_b16 v[204:205], v25 offset:96
    ds_read_b64_tr_b16 v[206:207], v25 offset:16992
    ds_read_b64_tr_b16 v[208:209], v25 offset:128
    ds_read_b64_tr_b16 v[210:211], v25 offset:17024
    ds_read_b64_tr_b16 v[212:213], v25 offset:160
    ds_read_b64_tr_b16 v[214:215], v25 offset:17056
    ds_read_b64_tr_b16 v[216:217], v25 offset:192
    ds_read_b64_tr_b16 v[218:219], v25 offset:17088
    v_max3_f32 v3, v64, v65, v22
    v_max3_f32 v3, v3, v66, v67
    v_max3_f32 v3, v3, v68, v69
    v_max3_f32 v3, v3, v70, v71
    v_mov_b32 v4, v3
    ds_read_b64_tr_b16 v[220:221], v25 offset:224
    s_nop 0
    v_permlane32_swap_b32 v3, v4
    ds_read_b64_tr_b16 v[222:223], v25 offset:17120
    v_max_f32 v3, v3, v4
    ds_read_b64_tr_b16 v[224:225], v25 offset:256
    v_mov_b32 v4, v3
    ds_read_b64_tr_b16 v[226:227], v25 offset:17152
    s_nop 0
    v_permlane16_swap_b32 v3, v4
    ds_read_b64_tr_b16 v[228:229], v25 offset:288
    v_max_f32 v3, v3, v4
    ds_read_b64_tr_b16 v[230:231], v25 offset:17184
    v_sub_f32 v4, v22, v3
    ds_read_b64_tr_b16 v[232:233], v25 offset:320
    v_exp_f32 v4, v4
    ds_read_b64_tr_b16 v[234:235], v25 offset:17216
    v_mov_b32 v22, v3
    ds_read_b64_tr_b16 v[236:237], v25 offset:352
    v_sub_f32 v64, v64, v3
    ds_read_b64_tr_b16 v[238:239], v25 offset:17248
    v_sub_f32 v65, v65, v3
    ds_read_b64_tr_b16 v[240:241], v25 offset:384
    v_sub_f32 v66, v66, v3
    ds_read_b64_tr_b16 v[242:243], v25 offset:17280
    v_sub_f32 v67, v67, v3
    ds_read_b64_tr_b16 v[244:245], v25 offset:416
    v_sub_f32 v68, v68, v3
    ds_read_b64_tr_b16 v[246:247], v25 offset:17312
    v_sub_f32 v69, v69, v3
    ds_read_b64_tr_b16 v[248:249], v25 offset:448
    v_sub_f32 v70, v70, v3
    ds_read_b64_tr_b16 v[250:251], v25 offset:17344
    v_sub_f32 v71, v71, v3
    ds_read_b64_tr_b16 v[252:253], v25 offset:480
    v_exp_f32 v64, v64
    ds_read_b64_tr_b16 v[254:255], v25 offset:17376
    v_exp_f32 v65, v65
    v_exp_f32 v66, v66
    v_exp_f32 v67, v67
    v_exp_f32 v68, v68
    v_exp_f32 v69, v69
    v_exp_f32 v70, v70
    v_exp_f32 v71, v71
    v_cvt_pk_bf16_f32 v72, v64, v65
    v_cvt_pk_bf16_f32 v73, v66, v67
    v_cvt_pk_bf16_f32 v74, v68, v69
    v_cvt_pk_bf16_f32 v75, v70, v71
    v_pk_mul_f32 v[128:129], v[128:129], v[4:5] op_sel_hi:[1,0]
    v_pk_mul_f32 v[130:131], v[130:131], v[4:5] op_sel_hi:[1,0]
    v_pk_mul_f32 v[132:133], v[132:133], v[4:5] op_sel_hi:[1,0]
    v_pk_mul_f32 v[134:135], v[134:135], v[4:5] op_sel_hi:[1,0]
    s_waitcnt lgkmcnt(0)
    v_mfma_f32_16x16x32_bf16 v[128:131], v[192:195], v[72:75], v[128:131]
    v_pk_mul_f32 v[136:137], v[136:137], v[4:5] op_sel_hi:[1,0]
    v_pk_mul_f32 v[138:139], v[138:139], v[4:5] op_sel_hi:[1,0]
    v_mfma_f32_16x16x32_bf16 v[132:135], v[196:199], v[72:75], v[132:135]
    v_pk_mul_f32 v[140:141], v[140:141], v[4:5] op_sel_hi:[1,0]
    v_pk_mul_f32 v[142:143], v[142:143], v[4:5] op_sel_hi:[1,0]
    v_mfma_f32_16x16x32_bf16 v[136:139], v[200:203], v[72:75], v[136:139]
    v_pk_mul_f32 v[144:145], v[144:145], v[4:5] op_sel_hi:[1,0]
    v_pk_mul_f32 v[146:147], v[146:147], v[4:5] op_sel_hi:[1,0]
    v_mfma_f32_16x16x32_bf16 v[140:143], v[204:207], v[72:75], v[140:143]
    v_pk_mul_f32 v[148:149], v[148:149], v[4:5] op_sel_hi:[1,0]
    v_pk_mul_f32 v[150:151], v[150:151], v[4:5] op_sel_hi:[1,0]
    v_mfma_f32_16x16x32_bf16 v[144:147], v[208:211], v[72:75], v[144:147]
    v_pk_mul_f32 v[152:153], v[152:153], v[4:5] op_sel_hi:[1,0]
    v_pk_mul_f32 v[154:155], v[154:155], v[4:5] op_sel_hi:[1,0]
    v_mfma_f32_16x16x32_bf16 v[148:151], v[212:215], v[72:75], v[148:151]
    v_pk_mul_f32 v[156:157], v[156:157], v[4:5] op_sel_hi:[1,0]
    v_pk_mul_f32 v[158:159], v[158:159], v[4:5] op_sel_hi:[1,0]
    v_mfma_f32_16x16x32_bf16 v[152:155], v[216:219], v[72:75], v[152:155]
    v_pk_mul_f32 v[160:161], v[160:161], v[4:5] op_sel_hi:[1,0]
    v_pk_mul_f32 v[162:163], v[162:163], v[4:5] op_sel_hi:[1,0]
    v_mfma_f32_16x16x32_bf16 v[156:159], v[220:223], v[72:75], v[156:159]
    v_pk_mul_f32 v[164:165], v[164:165], v[4:5] op_sel_hi:[1,0]
    v_pk_mul_f32 v[166:167], v[166:167], v[4:5] op_sel_hi:[1,0]
    v_mfma_f32_16x16x32_bf16 v[160:163], v[224:227], v[72:75], v[160:163]
    v_pk_mul_f32 v[168:169], v[168:169], v[4:5] op_sel_hi:[1,0]
    v_pk_mul_f32 v[170:171], v[170:171], v[4:5] op_sel_hi:[1,0]
    v_mfma_f32_16x16x32_bf16 v[164:167], v[228:231], v[72:75], v[164:167]
    v_pk_mul_f32 v[172:173], v[172:173], v[4:5] op_sel_hi:[1,0]
    v_pk_mul_f32 v[174:175], v[174:175], v[4:5] op_sel_hi:[1,0]
    v_mfma_f32_16x16x32_bf16 v[168:171], v[232:235], v[72:75], v[168:171]
    v_pk_mul_f32 v[176:177], v[176:177], v[4:5] op_sel_hi:[1,0]
    v_pk_mul_f32 v[178:179], v[178:179], v[4:5] op_sel_hi:[1,0]
    v_mfma_f32_16x16x32_bf16 v[172:175], v[236:239], v[72:75], v[172:175]
    v_pk_mul_f32 v[180:181], v[180:181], v[4:5] op_sel_hi:[1,0]
    v_pk_mul_f32 v[182:183], v[182:183], v[4:5] op_sel_hi:[1,0]
    v_mfma_f32_16x16x32_bf16 v[176:179], v[240:243], v[72:75], v[176:179]
    v_pk_mul_f32 v[184:185], v[184:185], v[4:5] op_sel_hi:[1,0]
    v_pk_mul_f32 v[186:187], v[186:187], v[4:5] op_sel_hi:[1,0]
    v_mfma_f32_16x16x32_bf16 v[180:183], v[244:247], v[72:75], v[180:183]
    v_pk_mul_f32 v[188:189], v[188:189], v[4:5] op_sel_hi:[1,0]
    v_pk_mul_f32 v[190:191], v[190:191], v[4:5] op_sel_hi:[1,0]
    v_mfma_f32_16x16x32_bf16 v[184:187], v[248:251], v[72:75], v[184:187]
    s_nop 0
    v_mfma_f32_16x16x32_bf16 v[188:191], v[252:255], v[72:75], v[188:191]
    v_fma_f32 v23, v23, v4, v64
    v_add_f32 v23, v23, v65
    v_add_f32 v23, v23, v66
    v_add_f32 v23, v23, v67
    v_add_f32 v23, v23, v68
    v_add_f32 v23, v23, v69
    v_add_f32 v23, v23, v70
    v_add_f32 v23, v23, v71
    s_add_u32 s27, s27, 1
    s_cmp_lt_u32 s27, 16
    s_cbranch_scc1 L_CT
    s_waitcnt vmcnt(0)
    s_barrier
    v_mov_b32 v4, v23
    s_nop 1
    v_permlane32_swap_b32 v23, v4
    v_add_f32 v23, v23, v4
    v_mov_b32 v4, v23
    s_nop 1
    v_permlane16_swap_b32 v23, v4
    v_add_f32 v23, v23, v4
    s_lshl_b32 s24, s3, 9
    v_lshl_add_u32 v3, v0, 3, s24
    ds_write_b64 v3, v[22:23] offset:0
    v_xor_b32 v3, 0x400, v3
    s_waitcnt lgkmcnt(0)
    s_barrier
    ds_read_b64 v[6:7], v3 offset:0
    s_waitcnt lgkmcnt(0)
    v_max_f32 v3, v22, v6
    v_sub_f32 v4, v22, v3
    v_sub_f32 v6, v6, v3
    v_exp_f32 v4, v4
    v_exp_f32 v6, v6
    v_mov_b32 v22, v3
    v_mul_f32 v23, v23, v4
    v_fmac_f32 v23, v7, v6
    v_and_b32 v3, 15, v0
    v_lshlrev_b32 v5, 3, v3
    s_lshl_b32 s24, s71, 2
    s_add_u32 s31, s24, s70
    s_lshl_b32 s24, s31, 8
    s_mul_i32 s25, s75, 128
    s_add_u32 s24, s24, s25
    s_add_u32 s24, s24, 0x120000
    s_cmp_lg_u32 s3, 0
    s_cbranch_scc1 L_C_ml
    s_mov_b64 exec, 0xffff
    buffer_store_dwordx2 v[22:23], v5, s[12:15], s24 offen sc1
    s_mov_b64 exec, -1
L_C_ml:
    v_pk_mul_f32 v[128:129], v[128:129], v[4:5] op_sel_hi:[1,0]
    v_pk_mul_f32 v[130:131], v[130:131], v[4:5] op_sel_hi:[1,0]
    v_pk_mul_f32 v[132:133], v[132:133], v[4:5] op_sel_hi:[1,0]
    v_pk_mul_f32 v[134:135], v[134:135], v[4:5] op_sel_hi:[1,0]
    v_pk_mul_f32 v[136:137], v[136:137], v[4:5] op_sel_hi:[1,0]
    v_pk_mul_f32 v[138:139], v[138:139], v[4:5] op_sel_hi:[1,0]
    v_pk_mul_f32 v[140:141], v[140:141], v[4:5] op_sel_hi:[1,0]
    v_pk_mul_f32 v[142:143], v[142:143], v[4:5] op_sel_hi:[1,0]
    v_pk_mul_f32 v[144:145], v[144:145], v[4:5] op_sel_hi:[1,0]
    v_pk_mul_f32 v[146:147], v[146:147], v[4:5] op_sel_hi:[1,0]
    v_pk_mul_f32 v[148:149], v[148:149], v[4:5] op_sel_hi:[1,0]
    v_pk_mul_f32 v[150:151], v[150:151], v[4:5] op_sel_hi:[1,0]
    v_pk_mul_f32 v[152:153], v[152:153], v[4:5] op_sel_hi:[1,0]
    v_pk_mul_f32 v[154:155], v[154:155], v[4:5] op_sel_hi:[1,0]
    v_pk_mul_f32 v[156:157], v[156:157], v[4:5] op_sel_hi:[1,0]
    v_pk_mul_f32 v[158:159], v[158:159], v[4:5] op_sel_hi:[1,0]
    v_pk_mul_f32 v[160:161], v[160:161], v[4:5] op_sel_hi:[1,0]
    v_pk_mul_f32 v[162:163], v[162:163], v[4:5] op_sel_hi:[1,0]
    v_pk_mul_f32 v[164:165], v[164:165], v[4:5] op_sel_hi:[1,0]
    v_pk_mul_f32 v[166:167], v[166:167], v[4:5] op_sel_hi:[1,0]
    v_pk_mul_f32 v[168:169], v[168:169], v[4:5] op_sel_hi:[1,0]
    v_pk_mul_f32 v[170:171], v[170:171], v[4:5] op_sel_hi:[1,0]
    v_pk_mul_f32 v[172:173], v[172:173], v[4:5] op_sel_hi:[1,0]
    v_pk_mul_f32 v[174:175], v[174:175], v[4:5] op_sel_hi:[1,0]
    v_pk_mul_f32 v[176:177], v[176:177], v[4:5] op_sel_hi:[1,0]
    v_pk_mul_f32 v[178:179], v[178:179], v[4:5] op_sel_hi:[1,0]
    v_pk_mul_f32 v[180:181], v[180:181], v[4:5] op_sel_hi:[1,0]
    v_pk_mul_f32 v[182:183], v[182:183], v[4:5] op_sel_hi:[1,0]
    v_pk_mul_f32 v[184:185], v[184:185], v[4:5] op_sel_hi:[1,0]
    v_pk_mul_f32 v[186:187], v[186:187], v[4:5] op_sel_hi:[1,0]
    v_pk_mul_f32 v[188:189], v[188:189], v[4:5] op_sel_hi:[1,0]
    v_pk_mul_f32 v[190:191], v[190:191], v[4:5] op_sel_hi:[1,0]
    s_lshl_b32 s24, s3, 13
    s_add_u32 s24, s24, 4096
    v_add_u32 v6, s24, v2
    s_xor_b32 s24, s3, 2
    s_lshl_b32 s24, s24, 13
    s_add_u32 s24, s24, 4096
    v_add_u32 v7, s24, v2
    s_cmp_lg_u32 s28, 0
    s_cbranch_scc1 L_C_x1
    ds_write_b128 v6, v[160:163] offset:0
    ds_write_b128 v6, v[164:167] offset:1024
    ds_write_b128 v6, v[168:171] offset:2048
    ds_write_b128 v6, v[172:175] offset:3072
    ds_write_b128 v6, v[176:179] offset:4096
    ds_write_b128 v6, v[180:183] offset:5120
    ds_write_b128 v6, v[184:187] offset:6144
    ds_write_b128 v6, v[188:191] offset:7168
    s_branch L_C_x2
L_C_x1:
    ds_write_b128 v6, v[128:131] offset:0
    ds_write_b128 v6, v[132:135] offset:1024
    ds_write_b128 v6, v[136:139] offset:2048
    ds_write_b128 v6, v[140:143] offset:3072
    ds_write_b128 v6, v[144:147] offset:4096
    ds_write_b128 v6, v[148:151] offset:5120
    ds_write_b128 v6, v[152:155] offset:6144
    ds_write_b128 v6, v[156:159] offset:7168
    s_waitcnt lgkmcnt(0)
    v_mov_b32 v128, v160
    v_mov_b32 v129, v161
    v_mov_b32 v130, v162
    v_mov_b32 v131, v163
    v_mov_b32 v132, v164
    v_mov_b32 v133, v165
    v_mov_b32 v134, v166
    v_mov_b32 v135, v167
    v_mov_b32 v136, v168
    v_mov_b32 v137, v169
    v_mov_b32 v138, v170
    v_mov_b32 v139, v171
    v_mov_b32 v140, v172
    v_mov_b32 v141, v173
    v_mov_b32 v142, v174
    v_mov_b32 v143, v175
    v_mov_b32 v144, v176
    v_mov_b32 v145, v177
    v_mov_b32 v146, v178
    v_mov_b32 v147, v179
    v_mov_b32 v148, v180
    v_mov_b32 v149, v181
    v_mov_b32 v150, v182
    v_mov_b32 v151, v183
    v_mov_b32 v152, v184
    v_mov_b32 v153, v185
    v_mov_b32 v154, v186
    v_mov_b32 v155, v187
    v_mov_b32 v156, v188
    v_mov_b32 v157, v189
    v_mov_b32 v158, v190
    v_mov_b32 v159, v191
L_C_x2:
    s_waitcnt lgkmcnt(0)
    s_barrier
    ds_read_b128 v[192:195], v7 offset:0
    ds_read_b128 v[196:199], v7 offset:1024
    ds_read_b128 v[200:203], v7 offset:2048
    ds_read_b128 v[204:207], v7 offset:3072
    ds_read_b128 v[208:211], v7 offset:4096
    ds_read_b128 v[212:215], v7 offset:5120
    ds_read_b128 v[216:219], v7 offset:6144
    ds_read_b128 v[220:223], v7 offset:7168
    v_lshrrev_b32 v4, 4, v0
    v_mul_u32_u24 v3, 272, v3
    v_lshl_add_u32 v3, v4, 3, v3
    s_mul_i32 s24, s3, 4352
    s_add_u32 s24, s24, 40960
    v_add_u32 v3, s24, v3
    s_waitcnt lgkmcnt(7)
    v_add_f32 v128, v128, v192
    v_add_f32 v129, v129, v193
    v_add_f32 v130, v130, v194
    v_add_f32 v131, v131, v195
    v_cvt_pk_bf16_f32 v32, v128, v129
    v_cvt_pk_bf16_f32 v33, v130, v131
    ds_write_b64 v3, v[32:33] offset:0
    s_waitcnt lgkmcnt(7)
    v_add_f32 v132, v132, v196
    v_add_f32 v133, v133, v197
    v_add_f32 v134, v134, v198
    v_add_f32 v135, v135, v199
    v_cvt_pk_bf16_f32 v34, v132, v133
    v_cvt_pk_bf16_f32 v35, v134, v135
    ds_write_b64 v3, v[34:35] offset:32
    s_waitcnt lgkmcnt(7)
    v_add_f32 v136, v136, v200
    v_add_f32 v137, v137, v201
    v_add_f32 v138, v138, v202
    v_add_f32 v139, v139, v203
    v_cvt_pk_bf16_f32 v36, v136, v137
    v_cvt_pk_bf16_f32 v37, v138, v139
    ds_write_b64 v3, v[36:37] offset:64
    s_waitcnt lgkmcnt(7)
    v_add_f32 v140, v140, v204
    v_add_f32 v141, v141, v205
    v_add_f32 v142, v142, v206
    v_add_f32 v143, v143, v207
    v_cvt_pk_bf16_f32 v38, v140, v141
    v_cvt_pk_bf16_f32 v39, v142, v143
    ds_write_b64 v3, v[38:39] offset:96
    s_waitcnt lgkmcnt(7)
    v_add_f32 v144, v144, v208
    v_add_f32 v145, v145, v209
    v_add_f32 v146, v146, v210
    v_add_f32 v147, v147, v211
    v_cvt_pk_bf16_f32 v40, v144, v145
    v_cvt_pk_bf16_f32 v41, v146, v147
    ds_write_b64 v3, v[40:41] offset:128
    s_waitcnt lgkmcnt(7)
    v_add_f32 v148, v148, v212
    v_add_f32 v149, v149, v213
    v_add_f32 v150, v150, v214
    v_add_f32 v151, v151, v215
    v_cvt_pk_bf16_f32 v42, v148, v149
    v_cvt_pk_bf16_f32 v43, v150, v151
    ds_write_b64 v3, v[42:43] offset:160
    s_waitcnt lgkmcnt(7)
    v_add_f32 v152, v152, v216
    v_add_f32 v153, v153, v217
    v_add_f32 v154, v154, v218
    v_add_f32 v155, v155, v219
    v_cvt_pk_bf16_f32 v44, v152, v153
    v_cvt_pk_bf16_f32 v45, v154, v155
    ds_write_b64 v3, v[44:45] offset:192
    s_waitcnt lgkmcnt(7)
    v_add_f32 v156, v156, v220
    v_add_f32 v157, v157, v221
    v_add_f32 v158, v158, v222
    v_add_f32 v159, v159, v223
    v_cvt_pk_bf16_f32 v46, v156, v157
    v_cvt_pk_bf16_f32 v47, v158, v159
    ds_write_b64 v3, v[46:47] offset:224
    v_and_b32 v5, 15, v0
    v_mul_u32_u24 v3, 272, v4
    v_lshl_add_u32 v3, v5, 4, v3
    v_add_u32 v3, s24, v3
    v_lshlrev_b32 v4, 10, v4
    v_lshl_add_u32 v4, v5, 4, v4
    s_waitcnt lgkmcnt(0)
    ds_read_b128 v[64:67], v3 offset:0
    ds_read_b128 v[68:71], v3 offset:1088
    ds_read_b128 v[72:75], v3 offset:2176
    ds_read_b128 v[76:79], v3 offset:3264
    s_lshl_b32 s24, s31, 15
    s_lshl_b32 s25, s29, 9
    s_add_u32 s24, s24, s25
    s_lshl_b32 s25, s28, 8
    s_add_u32 s24, s24, s25
    s_mul_i32 s25, s75, 16384
    s_add_u32 s24, s24, s25
    s_add_u32 s24, s24, 0x20000
    s_waitcnt lgkmcnt(3)
    buffer_store_dwordx4 v[64:67], v4, s[12:15], s24 offen sc1 nt
    s_add_u32 s24, s24, 4096
    s_waitcnt lgkmcnt(2)
    buffer_store_dwordx4 v[68:71], v4, s[12:15], s24 offen sc1 nt
    s_add_u32 s24, s24, 4096
    s_waitcnt lgkmcnt(1)
    buffer_store_dwordx4 v[72:75], v4, s[12:15], s24 offen sc1 nt
    s_add_u32 s24, s24, 4096
    s_waitcnt lgkmcnt(0)
    buffer_store_dwordx4 v[76:79], v4, s[12:15], s24 offen sc1 nt
    s_add_u32 s24, s24, 4096
    s_waitcnt vmcnt(0)
    s_barrier
    s_cmp_lg_u32 s3, 0
    s_cbranch_scc1 L_sig24
    s_mov_b64 exec, 1
    v_mov_b32 v3, 1
    buffer_atomic_add v3, off, s[16:19], 0 offset:4 sc0
    s_waitcnt vmcnt(0)
    v_readfirstlane_b32 s24, v3
    s_mov_b64 exec, -1
    s_and_b32 s24, s24, 31
    s_cmp_lg_u32 s24, 31
    s_cbranch_scc1 L_sig24
    v_lshlrev_b32 v4, 7, v0
    v_mov_b32 v3, 1
    s_mov_b32 s24, 0x170000
    s_mov_b32 exec_hi, 0
    buffer_store_dword v3, v4, s[12:15], s24 offen offset:4 sc1
    s_mov_b64 exec, -1
L_sig24:
    s_branch L_R
L_last:
    s_endpgm
.section .rodata,"a"
.p2align 6
.amdhsa_kernel concat_heads__compressed_kv_cla__mha_block_cached__decode_kernel
  .amdhsa_next_free_vgpr 448
  .amdhsa_next_free_sgpr 102
  .amdhsa_accum_offset 256
  .amdhsa_group_segment_fixed_size 0
  .amdhsa_kernarg_size 112
  .amdhsa_user_sgpr_count 2
  .amdhsa_user_sgpr_kernarg_segment_ptr 1
  .amdhsa_system_sgpr_workgroup_id_x 1
  .amdhsa_float_denorm_mode_32 3
.end_amdhsa_kernel
```

```asm
; @launch grid=(256,1,1) block=(256,1,1) lds=149504
.amdgcn_target "amdgcn-amd-amdhsa--gfx950"
.text
.globl concat_heads__compressed_kv_cla__mha_block_cached__decode_kernel
.p2align 8
.type concat_heads__compressed_kv_cla__mha_block_cached__decode_kernel,@function
concat_heads__compressed_kv_cla__mha_block_cached__decode_kernel:
    s_load_dwordx16 s[36:51], s[0:1], 0
    s_load_dwordx8 s[52:59], s[0:1], 64
    s_load_dwordx4 s[60:63], s[0:1], 96
    s_cmp_ge_u32 s2, 256
    s_cbranch_scc1 L_end
    s_cmp_lt_u32 s2, 64
    s_getpc_b64 s[24:25]
L_pc0:
    s_cselect_b32 s20, L_A-L_pc0, 0
    v_lshlrev_b32 v16, 7, v0
    v_min_u32 v16, L_A-L_pc0-4, v16
    v_add_u32 v16, s20, v16
    v_add_co_u32 v16, vcc, s24, v16
    v_mov_b32 v17, s25
    s_nop 0
    v_addc_co_u32 v17, vcc, 0, v17, vcc
    global_load_dword v17, v[16:17], off
    s_cbranch_scc1 L_A
L_B:
    s_and_b32 s70, s2, 6
    s_and_b32 s25, s2, 7
    s_add_u32 s70, s70, s25
    s_lshl_b32 s25, s70, 8
    v_and_b32 v6, 15, v0
    v_lshl_add_u32 v24, v6, 4, s25
    v_and_b32 v4, 16, v0
    v_lshl_add_u32 v24, v4, 5, v24
    v_lshrrev_b32 v4, 5, v0
    v_lshl_add_u32 v24, v4, 12, v24
    s_lshr_b32 s74, s2, 3
    s_lshl_b32 s74, s74, 2
    s_addk_i32 s74, -32
    s_mov_b32 s10, 0x400000
    s_mov_b32 s11, 0x20000
    s_waitcnt lgkmcnt(0)
    s_mov_b64 s[8:9], s[54:55]
L_pfb:
    s_lshl_b32 s24, s74, 13
    buffer_load_dwordx4 v[28:31], v24, s[8:11], s24 offen
    s_addk_i32 s74, 96
    s_cmpk_lt_u32 s74, 512
    s_cbranch_scc1 L_pfb
    s_addk_i32 s74, -512
    s_mov_b64 s[8:9], s[40:41]
L_pfq:
    s_lshl_b32 s24, s74, 13
    buffer_load_dwordx4 v[28:31], v24, s[8:11], s24 offen
    s_addk_i32 s74, 96
    s_cmpk_lt_u32 s74, 512
    s_cbranch_scc1 L_pfq
    s_addk_i32 s74, -512
    s_mov_b64 s[8:9], s[42:43]
L_pfk:
    s_lshl_b32 s24, s74, 13
    buffer_load_dwordx4 v[28:31], v24, s[8:11], s24 offen
    s_addk_i32 s74, 96
    s_cmpk_lt_u32 s74, 512
    s_cbranch_scc1 L_pfk
    s_addk_i32 s74, -512
    v_lshrrev_b32 v1, 6, v0
    v_and_b32 v0, 63, v0
    v_readfirstlane_b32 s3, v1
    v_lshlrev_b32 v2, 4, v0
    s_lshr_b32 s24, s2, 3
    s_sub_u32 s24, s24, 8
    s_mul_i32 s26, s24, 43
    s_lshr_b32 s26, s26, 8
    s_mul_i32 s27, s26, 6
    s_sub_u32 s27, s24, s27
    s_and_b32 s25, s26, 1
    s_lshl_b32 s25, s25, 1
    s_and_b32 s26, s26, 2
    s_lshl_b32 s26, s26, 3
    s_or_b32 s26, s26, s25
    s_or_b32 s26, s26, s70
    s_lshl_b32 s25, s70, 17
    s_lshl_b32 s24, s3, 8
    s_add_u32 s25, s25, s24
    v_lshl_add_u32 v25, v6, 4, s25
    v_and_b32 v4, 16, v0
    v_lshl_add_u32 v25, v4, 14, v25
    v_and_b32 v4, 32, v0
    v_lshl_add_u32 v25, v4, 16, v25
    s_and_b32 s25, s2, 3
    s_lshl_b32 s25, s25, 10
    s_lshl_b32 s24, s3, 12
    s_add_u32 s25, s25, s24
    s_bfe_u32 s24, s2, 0x10002
    s_lshl_b32 s24, s24, 23
    s_add_u32 s25, s25, s24
    v_add_u32 v26, s25, v2
    s_cmp_ge_u32 s27, 3
    s_cselect_b32 s28, 1, 0
    s_mul_i32 s29, s28, 3
    s_sub_u32 s29, s27, s29
    s_lshr_b32 s72, s3, 1
    s_lshl_b32 s24, s28, 1
    s_add_u32 s72, s72, s24
    s_and_b32 s31, s3, 1
    s_lshl_b32 s24, s29, 1
    s_add_u32 s31, s31, s24
    s_lshl_b32 s30, s72, 5
    s_add_u32 s30, s30, s26
    s_lshl_b32 s30, s30, 20
    v_lshrrev_b32 v3, 4, v0
    v_and_b32 v4, 3, v0
    v_lshlrev_b32 v5, 6, v3
    v_lshl_add_u32 v5, v4, 4, v5
    v_bfe_u32 v1, v0, 2, 2
    v_lshl_add_u32 v1, v1, 8, v5
    s_mul_i32 s35, s31, 1024
    s_add_u32 s32, s35, 983040
    s_mul_i32 s28, s31, 1024
    s_add_u32 s28, s28, 1044480
    s_mov_b32 s6, 0x100000
    s_mov_b32 s7, 0x20000
    s_add_u32 s4, s50, s30
    s_addc_u32 s5, s51, 0
    s_mov_b32 s12, s62
    s_mov_b32 s13, s63
    s_mov_b32 s14, 0x600000
    s_mov_b32 s15, 0x20000
    s_mov_b32 s16, s60
    s_mov_b32 s17, s61
    s_mov_b32 s18, 0x100
    s_mov_b32 s19, 0x20000
    v_and_b32 v3, 1, v0
    v_lshlrev_b32 v3, 4, v3
    v_mov_b32 v4, 0xffff
    v_lshlrev_b32 v4, v3, v4
    v_bfe_u32 v3, v0, 1, 2
    v_cmp_eq_u32 vcc, 0, v3
    s_nop 1
    v_cndmask_b32 v20, 0, v4, vcc
    v_cmp_eq_u32 vcc, 1, v3
    s_nop 1
    v_cndmask_b32 v21, 0, v4, vcc
    v_cmp_eq_u32 vcc, 2, v3
    s_nop 1
    v_cndmask_b32 v22, 0, v4, vcc
    v_cmp_eq_u32 vcc, 3, v3
    s_nop 1
    v_cndmask_b32 v23, 0, v4, vcc
    s_mov_b32 s64, 0x22222222
    s_mov_b32 s65, 0x22222222
    s_mov_b32 s66, 0x44444444
    s_mov_b32 s67, 0x44444444
    s_mov_b32 s68, 0x88888888
    s_mov_b32 s69, 0x88888888
    v_mov_b32 v32, 0
    v_mov_b32 v33, 0
    v_mov_b32 v34, 0
    v_mov_b32 v35, 0
    v_mov_b32 v36, 0
    v_mov_b32 v37, 0
    v_mov_b32 v38, 0
    v_mov_b32 v39, 0
    v_mov_b32 v40, 0
    v_mov_b32 v41, 0
    v_mov_b32 v42, 0
    v_mov_b32 v43, 0
    v_mov_b32 v44, 0
    v_mov_b32 v45, 0
    v_mov_b32 v46, 0
    v_mov_b32 v47, 0
    v_lshrrev_b32 v3, 4, v0
    v_lshlrev_b32 v60, 6, v3
    v_and_b32 v4, 7, v0
    v_lshl_add_u32 v60, v4, 3, v60
    s_lshl_b32 s33, s26, 2
    s_add_u32 s33, s33, s72
    s_lshl_b32 s34, s33, 8
    s_add_u32 s34, s34, 0x164000
    s_mul_i32 s73, s33, 6
    s_add_u32 s73, s73, s31
    s_lshl_b32 s73, s73, 8
    s_add_u32 s73, s73, 0x180000
    s_mov_b64 s[8:9], s[56:57]
L_pfo:
    s_lshl_b32 s24, s74, 8
    s_waitcnt vmcnt(6)
    buffer_load_dwordx4 v[28:31], v25, s[8:11], s24 offen
    s_addk_i32 s74, 96
    s_cmpk_lt_u32 s74, 512
    s_cbranch_scc1 L_pfo
    s_addk_i32 s74, -512
    s_mov_b64 s[8:9], s[44:45]
L_pfu:
    s_lshl_b32 s24, s74, 13
    s_waitcnt vmcnt(6)
    buffer_load_dwordx4 v[28:31], v24, s[8:11], s24 offen
    s_addk_i32 s74, 96
    s_cmpk_lt_u32 s74, 512
    s_cbranch_scc1 L_pfu
    s_addk_i32 s74, -512
    s_mov_b64 s[8:9], s[46:47]
L_pfv:
    s_lshl_b32 s24, s74, 8
    s_waitcnt vmcnt(6)
    buffer_load_dwordx4 v[28:31], v25, s[8:11], s24 offen
    s_addk_i32 s74, 96
    s_cmpk_lt_u32 s74, 512
    s_cbranch_scc1 L_pfv
    s_addk_i32 s74, -512
    s_mov_b64 s[8:9], s[38:39]
    s_mov_b32 s10, 0x1000000
L_pfc:
    s_lshl_b32 s24, s74, 12
    s_waitcnt vmcnt(6)
    buffer_load_dwordx4 v[28:31], v26, s[8:11], s24 offen
    s_addk_i32 s74, 96
    s_cmpk_lt_u32 s74, 2048
    s_cbranch_scc1 L_pfc
    s_addk_i32 s74, -2048
    s_mov_b32 s10, 0x400000
    s_waitcnt vmcnt(15)
    buffer_load_dwordx4 a[0:3], v1, s[4:7], s32 offen offset:0 nt
    s_add_u32 s32, s32, 6144
    s_waitcnt vmcnt(15)
    buffer_load_dwordx4 a[4:7], v1, s[4:7], s32 offen offset:0 nt
    s_add_u32 s32, s32, 6144
    s_waitcnt vmcnt(15)
    buffer_load_dwordx4 a[8:11], v1, s[4:7], s32 offen offset:0 nt
    s_add_u32 s32, s32, 6144
    s_waitcnt vmcnt(15)
    buffer_load_dwordx4 a[12:15], v1, s[4:7], s32 offen offset:0 nt
    s_add_u32 s32, s32, 6144
    s_waitcnt vmcnt(15)
    buffer_load_dwordx4 a[16:19], v1, s[4:7], s32 offen offset:0 nt
    s_add_u32 s32, s32, 6144
    s_waitcnt vmcnt(15)
    buffer_load_dwordx4 a[20:23], v1, s[4:7], s32 offen offset:0 nt
    s_add_u32 s32, s32, 6144
    s_waitcnt vmcnt(15)
    buffer_load_dwordx4 a[24:27], v1, s[4:7], s32 offen offset:0 nt
    s_add_u32 s32, s32, 6144
    s_waitcnt vmcnt(15)
    buffer_load_dwordx4 a[28:31], v1, s[4:7], s32 offen offset:0 nt
    s_add_u32 s32, s32, 6144
    s_waitcnt vmcnt(15)
    buffer_load_dwordx4 a[32:35], v1, s[4:7], s32 offen offset:0 nt
    s_add_u32 s32, s32, 6144
    s_waitcnt vmcnt(15)
    buffer_load_dwordx4 a[36:39], v1, s[4:7], s32 offen offset:0 nt
    s_add_u32 s32, s32, 6144
    s_waitcnt vmcnt(15)
    buffer_load_dwordx4 a[40:43], v1, s[4:7], s28 offen offset:0 nt
    s_waitcnt vmcnt(15)
    s_mov_b32 s32, s35
    buffer_load_dwordx4 a[64:67], v1, s[4:7], s32 offen offset:0 nt
    s_add_u32 s32, s32, 6144
    s_waitcnt vmcnt(15)
    buffer_load_dwordx4 a[68:71], v1, s[4:7], s32 offen offset:0 nt
    s_add_u32 s32, s32, 6144
    s_waitcnt vmcnt(15)
    buffer_load_dwordx4 a[72:75], v1, s[4:7], s32 offen offset:0 nt
    s_add_u32 s32, s32, 6144
    s_waitcnt vmcnt(15)
    buffer_load_dwordx4 a[76:79], v1, s[4:7], s32 offen offset:0 nt
    s_add_u32 s32, s32, 6144
    s_waitcnt vmcnt(15)
    buffer_load_dwordx4 a[80:83], v1, s[4:7], s32 offen offset:0 nt
    s_add_u32 s32, s32, 6144
    s_mov_b64 exec, 1
    buffer_load_dword v61, off, s[16:19], 0 offset:128 sc1
    s_mov_b64 exec, -1
    s_waitcnt vmcnt(15)
    buffer_load_dwordx4 a[84:87], v1, s[4:7], s32 offen offset:0 nt
    s_add_u32 s32, s32, 6144
    s_waitcnt vmcnt(15)
    buffer_load_dwordx4 a[88:91], v1, s[4:7], s32 offen offset:0 nt
    s_add_u32 s32, s32, 6144
    s_waitcnt vmcnt(15)
    buffer_load_dwordx4 a[92:95], v1, s[4:7], s32 offen offset:0 nt
    s_add_u32 s32, s32, 6144
    s_waitcnt vmcnt(15)
    buffer_load_dwordx4 a[96:99], v1, s[4:7], s32 offen offset:0 nt
    s_add_u32 s32, s32, 6144
    s_waitcnt vmcnt(15)
    buffer_load_dwordx4 a[100:103], v1, s[4:7], s32 offen offset:0 nt
    s_add_u32 s32, s32, 6144
    s_waitcnt vmcnt(15)
    buffer_load_dwordx4 a[104:107], v1, s[4:7], s32 offen offset:0 nt
    s_add_u32 s32, s32, 6144
    s_waitcnt vmcnt(15)
    buffer_load_dwordx4 a[108:111], v1, s[4:7], s32 offen offset:0 nt
    s_add_u32 s32, s32, 6144
    s_waitcnt vmcnt(15)
    buffer_load_dwordx4 a[112:115], v1, s[4:7], s32 offen offset:0 nt
    s_add_u32 s32, s32, 6144
    s_waitcnt vmcnt(15)
    buffer_load_dwordx4 a[116:119], v1, s[4:7], s32 offen offset:0 nt
    s_add_u32 s32, s32, 6144
    s_waitcnt vmcnt(15)
    buffer_load_dwordx4 a[120:123], v1, s[4:7], s32 offen offset:0 nt
    s_add_u32 s32, s32, 6144
    s_waitcnt vmcnt(15)
    buffer_load_dwordx4 a[124:127], v1, s[4:7], s32 offen offset:0 nt
    s_add_u32 s32, s32, 6144
    s_waitcnt vmcnt(15)
    buffer_load_dwordx4 v[64:67], v1, s[4:7], s32 offen offset:0 nt
    s_add_u32 s32, s32, 6144
    s_waitcnt vmcnt(12)
    v_readfirstlane_b32 s25, v61
    s_nop 0
    s_cmp_ge_u32 s25, 32
    s_cbranch_scc1 L_B_q
    s_mov_b32 s24, 262144
    s_mov_b64 exec, 1
L_aw1:
    buffer_load_dword v61, off, s[16:19], 0 offset:128 sc1
    s_waitcnt vmcnt(0)
    v_readfirstlane_b32 s25, v61
    s_nop 0
    s_cmp_ge_u32 s25, 32
    s_cbranch_scc1 L_B_q
    s_sleep 16
    s_sub_u32 s24, s24, 1
    s_cmp_lg_u32 s24, 0
    s_cbranch_scc1 L_aw1
L_B_q:
    s_mov_b64 exec, -1
    buffer_load_dwordx4 v[8:11], v5, s[12:15], s34 offen sc1
    s_waitcnt vmcnt(15)
    buffer_load_dwordx4 v[68:71], v1, s[4:7], s32 offen offset:0 nt
    s_add_u32 s32, s32, 6144
    s_waitcnt vmcnt(15)
    buffer_load_dwordx4 v[72:75], v1, s[4:7], s32 offen offset:0 nt
    s_add_u32 s32, s32, 6144
    s_waitcnt vmcnt(15)
    buffer_load_dwordx4 v[76:79], v1, s[4:7], s32 offen offset:0 nt
    s_add_u32 s32, s32, 6144
    s_waitcnt vmcnt(15)
    buffer_load_dwordx4 v[80:83], v1, s[4:7], s32 offen offset:0 nt
    s_add_u32 s32, s32, 6144
    s_waitcnt vmcnt(15)
    buffer_load_dwordx4 v[84:87], v1, s[4:7], s32 offen offset:0 nt
    s_add_u32 s32, s32, 6144
    s_waitcnt vmcnt(15)
    buffer_load_dwordx4 v[88:91], v1, s[4:7], s32 offen offset:0 nt
    s_add_u32 s32, s32, 6144
    s_waitcnt vmcnt(15)
    buffer_load_dwordx4 v[92:95], v1, s[4:7], s32 offen offset:0 nt
    s_add_u32 s32, s32, 6144
    s_waitcnt vmcnt(15)
    buffer_load_dwordx4 v[96:99], v1, s[4:7], s32 offen offset:0 nt
    s_add_u32 s32, s32, 6144
    s_waitcnt vmcnt(15)
    buffer_load_dwordx4 v[100:103], v1, s[4:7], s32 offen offset:0 nt
    s_add_u32 s32, s32, 6144
    s_waitcnt vmcnt(15)
    buffer_load_dwordx4 v[104:107], v1, s[4:7], s32 offen offset:0 nt
    s_add_u32 s32, s32, 6144
    s_waitcnt vmcnt(15)
    buffer_load_dwordx4 v[108:111], v1, s[4:7], s32 offen offset:0 nt
    s_add_u32 s32, s32, 6144
    s_waitcnt vmcnt(15)
    buffer_load_dwordx4 v[112:115], v1, s[4:7], s32 offen offset:0 nt
    s_add_u32 s32, s32, 6144
    s_waitcnt vmcnt(15)
    buffer_load_dwordx4 v[116:119], v1, s[4:7], s32 offen offset:0 nt
    s_add_u32 s32, s32, 6144
    s_waitcnt vmcnt(15)
    buffer_load_dwordx4 v[120:123], v1, s[4:7], s32 offen offset:0 nt
    s_add_u32 s32, s32, 6144
    s_waitcnt vmcnt(15)
    buffer_load_dwordx4 v[124:127], v1, s[4:7], s32 offen offset:0 nt
    s_add_u32 s32, s32, 6144
    s_waitcnt vmcnt(15)
    v_mov_b32_dpp v32, v8 quad_perm:[0,1,2,3] row_mask:0xf bank_mask:0x1
    v_mov_b32_dpp v33, v9 quad_perm:[0,1,2,3] row_mask:0xf bank_mask:0x1
    v_mov_b32_dpp v34, v10 quad_perm:[0,1,2,3] row_mask:0xf bank_mask:0x1
    v_mov_b32_dpp v35, v11 quad_perm:[0,1,2,3] row_mask:0xf bank_mask:0x1
    v_mov_b32_dpp v36, v8 quad_perm:[0,1,2,3] row_mask:0xf bank_mask:0x2
    v_mov_b32_dpp v37, v9 quad_perm:[0,1,2,3] row_mask:0xf bank_mask:0x2
    v_mov_b32_dpp v38, v10 quad_perm:[0,1,2,3] row_mask:0xf bank_mask:0x2
    v_mov_b32_dpp v39, v11 quad_perm:[0,1,2,3] row_mask:0xf bank_mask:0x2
    v_mov_b32_dpp v40, v8 quad_perm:[0,1,2,3] row_mask:0xf bank_mask:0x4
    v_mov_b32_dpp v41, v9 quad_perm:[0,1,2,3] row_mask:0xf bank_mask:0x4
    v_mov_b32_dpp v42, v10 quad_perm:[0,1,2,3] row_mask:0xf bank_mask:0x4
    v_mov_b32_dpp v43, v11 quad_perm:[0,1,2,3] row_mask:0xf bank_mask:0x4
    v_mov_b32_dpp v44, v8 quad_perm:[0,1,2,3] row_mask:0xf bank_mask:0x8
    v_mov_b32_dpp v45, v9 quad_perm:[0,1,2,3] row_mask:0xf bank_mask:0x8
    v_mov_b32_dpp v46, v10 quad_perm:[0,1,2,3] row_mask:0xf bank_mask:0x8
    v_mov_b32_dpp v47, v11 quad_perm:[0,1,2,3] row_mask:0xf bank_mask:0x8
    s_mov_b32 s27, 1
L_BK:
    s_cmp_lg_u32 s27, 9
    s_cbranch_scc1 L_BK_a
    s_add_u32 s4, s52, s30
    s_addc_u32 s5, s53, 0
    s_mov_b32 s32, s35
    v_mov_b32 v1, v2
L_BK_a:
    s_barrier
    s_cmp_lg_u32 s27, 7
    s_cbranch_scc1 L_BK_x0
    s_and_b32 s24, s2, 7
    s_lshl_b32 s24, s24, 7
    s_add_u32 s24, s24, 0x1b6000
    v_and_b32 v63, 7, v0
    v_lshlrev_b32 v63, 2, v63
    buffer_load_dword v62, v63, s[12:15], s24 offen sc1
L_BK_x0:
    s_cmp_lg_u32 s27, 8
    s_cbranch_scc1 L_BK_x1
    s_getreg_b32 s24, hwreg(HW_REG_XCC_ID, 0, 4)
    v_cmp_ne_u32 vcc, s24, v62
    s_nop 0
    s_or_b32 s75, vcc_lo, vcc_hi
    v_mov_b32 v28, -1
    v_mov_b32 v29, -1
    v_mov_b32 v30, -1
    v_mov_b32 v31, -1
    s_mov_b64 exec, 0xffff
    s_cbranch_scc1 L_far2
    buffer_store_dwordx4 v[28:31], v2, s[12:15], s73 offen
    s_branch L_near2
L_far2:
    buffer_store_dwordx4 v[28:31], v2, s[12:15], s73 offen sc1
L_near2:
    s_mov_b64 exec, -1
L_BK_x1:
    v_mov_b32 v49, v50
    v_mov_b32 v50, v51
    v_mov_b32 v51, v52
    v_mov_b32 v52, v53
    v_mov_b32 v53, v54
    v_mov_b32 v54, v55
    v_mov_b32 v55, v56
    v_mov_b32 v56, v57
    s_waitcnt vmcnt(15)
    v_mfma_f32_16x16x32_bf16 v[12:15], v[64:67], v[32:35], 0
    buffer_load_dwordx4 v[64:67], v1, s[4:7], s32 offen offset:0 nt
    s_add_u32 s32, s32, 6144
    s_waitcnt vmcnt(15)
    v_mfma_f32_16x16x32_bf16 v[12:15], v[68:71], v[36:39], v[12:15]
    buffer_load_dwordx4 v[68:71], v1, s[4:7], s32 offen offset:0 nt
    s_add_u32 s32, s32, 6144
    s_waitcnt vmcnt(15)
    v_mfma_f32_16x16x32_bf16 v[12:15], v[72:75], v[40:43], v[12:15]
    buffer_load_dwordx4 v[72:75], v1, s[4:7], s32 offen offset:0 nt
    s_add_u32 s32, s32, 6144
    s_waitcnt vmcnt(15)
    v_mfma_f32_16x16x32_bf16 v[12:15], v[76:79], v[44:47], v[12:15]
    buffer_load_dwordx4 v[76:79], v1, s[4:7], s32 offen offset:0 nt
    s_add_u32 s32, s32, 6144
    s_nop 5
    v_add_f32_dpp v57, v13, v12 quad_perm:[1,1,1,1] row_mask:0xf bank_mask:0xf
    s_nop 1
    v_add_f32_dpp v57, v14, v57 quad_perm:[2,2,2,2] row_mask:0xf bank_mask:0xf
    s_nop 1
    v_add_f32_dpp v57, v15, v57 quad_perm:[3,3,3,3] row_mask:0xf bank_mask:0xf
    s_waitcnt vmcnt(15)
    v_mfma_f32_16x16x32_bf16 v[16:19], v[80:83], v[32:35], 0
    buffer_load_dwordx4 v[80:83], v1, s[4:7], s32 offen offset:0 nt
    s_add_u32 s32, s32, 6144
    s_waitcnt vmcnt(15)
    v_mfma_f32_16x16x32_bf16 v[16:19], v[84:87], v[36:39], v[16:19]
    buffer_load_dwordx4 v[84:87], v1, s[4:7], s32 offen offset:0 nt
    s_add_u32 s32, s32, 6144
    s_waitcnt vmcnt(15)
    v_mfma_f32_16x16x32_bf16 v[16:19], v[88:91], v[40:43], v[16:19]
    buffer_load_dwordx4 v[88:91], v1, s[4:7], s32 offen offset:0 nt
    s_add_u32 s32, s32, 6144
    s_waitcnt vmcnt(15)
    v_mfma_f32_16x16x32_bf16 v[16:19], v[92:95], v[44:47], v[16:19]
    buffer_load_dwordx4 v[92:95], v1, s[4:7], s32 offen offset:0 nt
    s_add_u32 s32, s32, 6144
    s_nop 5
    v_add_f32_dpp v3, v16, v17 quad_perm:[0,0,0,0] row_mask:0xf bank_mask:0xf
    s_nop 1
    v_add_f32_dpp v3, v18, v3 quad_perm:[2,2,2,2] row_mask:0xf bank_mask:0xf
    s_nop 1
    v_add_f32_dpp v3, v19, v3 quad_perm:[3,3,3,3] row_mask:0xf bank_mask:0xf
    v_cndmask_b32 v57, v57, v3, s[64:65]
    s_waitcnt vmcnt(15)
    v_mfma_f32_16x16x32_bf16 v[12:15], v[96:99], v[32:35], 0
    buffer_load_dwordx4 v[96:99], v1, s[4:7], s32 offen offset:0 nt
    s_add_u32 s32, s32, 6144
    s_waitcnt vmcnt(15)
    v_mfma_f32_16x16x32_bf16 v[12:15], v[100:103], v[36:39], v[12:15]
    buffer_load_dwordx4 v[100:103], v1, s[4:7], s32 offen offset:0 nt
    s_add_u32 s32, s32, 6144
    s_waitcnt vmcnt(15)
    v_mfma_f32_16x16x32_bf16 v[12:15], v[104:107], v[40:43], v[12:15]
    buffer_load_dwordx4 v[104:107], v1, s[4:7], s32 offen offset:0 nt
    s_add_u32 s32, s32, 6144
    s_waitcnt vmcnt(15)
    v_mfma_f32_16x16x32_bf16 v[12:15], v[108:111], v[44:47], v[12:15]
    buffer_load_dwordx4 v[108:111], v1, s[4:7], s32 offen offset:0 nt
    s_add_u32 s32, s32, 6144
    s_nop 5
    v_add_f32_dpp v3, v12, v14 quad_perm:[0,0,0,0] row_mask:0xf bank_mask:0xf
    s_nop 1
    v_add_f32_dpp v3, v13, v3 quad_perm:[1,1,1,1] row_mask:0xf bank_mask:0xf
    s_nop 1
    v_add_f32_dpp v3, v15, v3 quad_perm:[3,3,3,3] row_mask:0xf bank_mask:0xf
    v_cndmask_b32 v57, v57, v3, s[66:67]
    s_waitcnt vmcnt(15)
    v_mfma_f32_16x16x32_bf16 v[16:19], v[112:115], v[32:35], 0
    buffer_load_dwordx4 v[112:115], v1, s[4:7], s32 offen offset:0 nt
    s_add_u32 s32, s32, 6144
    s_waitcnt vmcnt(15)
    v_mfma_f32_16x16x32_bf16 v[16:19], v[116:119], v[36:39], v[16:19]
    buffer_load_dwordx4 v[116:119], v1, s[4:7], s32 offen offset:0 nt
    s_add_u32 s32, s32, 6144
    s_waitcnt vmcnt(15)
    v_mfma_f32_16x16x32_bf16 v[16:19], v[120:123], v[40:43], v[16:19]
    buffer_load_dwordx4 v[120:123], v1, s[4:7], s32 offen offset:0 nt
    s_add_u32 s32, s32, 6144
    s_waitcnt vmcnt(15)
    v_mfma_f32_16x16x32_bf16 v[16:19], v[124:127], v[44:47], v[16:19]
    buffer_load_dwordx4 v[124:127], v1, s[4:7], s32 offen offset:0 nt
    s_add_u32 s32, s32, 6144
    s_nop 5
    v_add_f32_dpp v3, v16, v19 quad_perm:[0,0,0,0] row_mask:0xf bank_mask:0xf
    s_nop 1
    v_add_f32_dpp v3, v17, v3 quad_perm:[1,1,1,1] row_mask:0xf bank_mask:0xf
    s_nop 1
    v_add_f32_dpp v3, v18, v3 quad_perm:[2,2,2,2] row_mask:0xf bank_mask:0xf
    v_cndmask_b32 v57, v57, v3, s[68:69]
    s_cmp_lg_u32 s27, 3
    s_cbranch_scc1 L_BK_c0
    v_mfma_f32_16x16x32_bf16 v[12:15], a[64:67], v[32:35], 0
    v_mfma_f32_16x16x32_bf16 v[12:15], a[68:71], v[36:39], v[12:15]
    v_mfma_f32_16x16x32_bf16 v[12:15], a[72:75], v[40:43], v[12:15]
    v_mfma_f32_16x16x32_bf16 v[12:15], a[76:79], v[44:47], v[12:15]
    s_nop 7
    v_add_f32_dpp v48, v13, v12 quad_perm:[1,1,1,1] row_mask:0xf bank_mask:0xf
    s_nop 1
    v_add_f32_dpp v48, v14, v48 quad_perm:[2,2,2,2] row_mask:0xf bank_mask:0xf
    s_nop 1
    v_add_f32_dpp v48, v15, v48 quad_perm:[3,3,3,3] row_mask:0xf bank_mask:0xf
    v_mfma_f32_16x16x32_bf16 v[16:19], a[80:83], v[32:35], 0
    v_mfma_f32_16x16x32_bf16 v[16:19], a[84:87], v[36:39], v[16:19]
    v_mfma_f32_16x16x32_bf16 v[16:19], a[88:91], v[40:43], v[16:19]
    v_mfma_f32_16x16x32_bf16 v[16:19], a[92:95], v[44:47], v[16:19]
    s_nop 7
    v_add_f32_dpp v3, v16, v17 quad_perm:[0,0,0,0] row_mask:0xf bank_mask:0xf
    s_nop 1
    v_add_f32_dpp v3, v18, v3 quad_perm:[2,2,2,2] row_mask:0xf bank_mask:0xf
    s_nop 1
    v_add_f32_dpp v3, v19, v3 quad_perm:[3,3,3,3] row_mask:0xf bank_mask:0xf
    v_cndmask_b32 v48, v48, v3, s[64:65]
    v_mfma_f32_16x16x32_bf16 v[12:15], a[96:99], v[32:35], 0
    v_mfma_f32_16x16x32_bf16 v[12:15], a[100:103], v[36:39], v[12:15]
    v_mfma_f32_16x16x32_bf16 v[12:15], a[104:107], v[40:43], v[12:15]
    v_mfma_f32_16x16x32_bf16 v[12:15], a[108:111], v[44:47], v[12:15]
    s_nop 7
    v_add_f32_dpp v3, v12, v14 quad_perm:[0,0,0,0] row_mask:0xf bank_mask:0xf
    s_nop 1
    v_add_f32_dpp v3, v13, v3 quad_perm:[1,1,1,1] row_mask:0xf bank_mask:0xf
    s_nop 1
    v_add_f32_dpp v3, v15, v3 quad_perm:[3,3,3,3] row_mask:0xf bank_mask:0xf
    v_cndmask_b32 v48, v48, v3, s[66:67]
    v_mfma_f32_16x16x32_bf16 v[16:19], a[112:115], v[32:35], 0
    v_mfma_f32_16x16x32_bf16 v[16:19], a[116:119], v[36:39], v[16:19]
    v_mfma_f32_16x16x32_bf16 v[16:19], a[120:123], v[40:43], v[16:19]
    v_mfma_f32_16x16x32_bf16 v[16:19], a[124:127], v[44:47], v[16:19]
    s_nop 7
    v_add_f32_dpp v3, v16, v19 quad_perm:[0,0,0,0] row_mask:0xf bank_mask:0xf
    s_nop 1
    v_add_f32_dpp v3, v17, v3 quad_perm:[1,1,1,1] row_mask:0xf bank_mask:0xf
    s_nop 1
    v_add_f32_dpp v3, v18, v3 quad_perm:[2,2,2,2] row_mask:0xf bank_mask:0xf
    v_cndmask_b32 v48, v48, v3, s[68:69]
L_BK_c0:
    s_cmp_lg_u32 s27, 2
    s_cbranch_scc1 L_BK_b
    v_mfma_f32_16x16x32_bf16 v[12:15], a[0:3], v[32:35], 0
    v_mfma_f32_16x16x32_bf16 v[12:15], a[4:7], v[36:39], v[12:15]
    v_mfma_f32_16x16x32_bf16 v[12:15], a[8:11], v[40:43], v[12:15]
    v_mfma_f32_16x16x32_bf16 v[12:15], a[12:15], v[44:47], v[12:15]
    s_nop 7
    v_add_f32_dpp v58, v13, v12 quad_perm:[1,1,1,1] row_mask:0xf bank_mask:0xf
    s_nop 1
    v_add_f32_dpp v58, v14, v58 quad_perm:[2,2,2,2] row_mask:0xf bank_mask:0xf
    s_nop 1
    v_add_f32_dpp v58, v15, v58 quad_perm:[3,3,3,3] row_mask:0xf bank_mask:0xf
    v_mfma_f32_16x16x32_bf16 v[16:19], a[16:19], v[32:35], 0
    v_mfma_f32_16x16x32_bf16 v[16:19], a[20:23], v[36:39], v[16:19]
    v_mfma_f32_16x16x32_bf16 v[16:19], a[24:27], v[40:43], v[16:19]
    v_mfma_f32_16x16x32_bf16 v[16:19], a[28:31], v[44:47], v[16:19]
    s_nop 7
    v_add_f32_dpp v3, v16, v17 quad_perm:[0,0,0,0] row_mask:0xf bank_mask:0xf
    s_nop 1
    v_add_f32_dpp v3, v18, v3 quad_perm:[2,2,2,2] row_mask:0xf bank_mask:0xf
    s_nop 1
    v_add_f32_dpp v3, v19, v3 quad_perm:[3,3,3,3] row_mask:0xf bank_mask:0xf
    v_cndmask_b32 v58, v58, v3, s[64:65]
    v_mfma_f32_16x16x32_bf16 v[12:15], a[32:35], v[32:35], 0
    v_mfma_f32_16x16x32_bf16 v[12:15], a[36:39], v[36:39], v[12:15]
    v_mfma_f32_16x16x32_bf16 v[12:15], a[40:43], v[40:43], v[12:15]
    s_nop 7
    v_add_f32_dpp v3, v12, v14 quad_perm:[0,0,0,0] row_mask:0xf bank_mask:0xf
    s_nop 1
    v_add_f32_dpp v3, v13, v3 quad_perm:[1,1,1,1] row_mask:0xf bank_mask:0xf
    s_nop 1
    v_add_f32_dpp v3, v15, v3 quad_perm:[3,3,3,3] row_mask:0xf bank_mask:0xf
    v_cndmask_b32 v58, v58, v3, s[66:67]
    s_mul_i32 s24, s31, 1
    s_sub_i32 s24, 4, s24
    s_max_i32 s24, s24, 0
    s_min_i32 s24, s24, 1
    s_add_u32 s24, s24, 10
    v_and_b32 v3, 3, v0
    v_bfe_u32 v4, v0, 2, 2
    v_lshl_add_u32 v3, v3, 2, v4
    v_mov_b32 v4, 0xff800000
    v_cmp_gt_u32 vcc, s24, v3
    s_nop 1
    v_cndmask_b32 v58, v4, v58, vcc
    v_mov_b32 v61, 0x3e0293ee
    v_mov_b32 v7, 0
    s_lshl_b32 s34, s2, 7
    s_add_u32 s34, s34, 0x1ae000
L_BK_b:
    s_add_u32 s27, s27, 1
    s_cmp_lt_u32 s27, 10
    s_cbranch_scc1 L_BK
    v_max3_f32 v3, v48, v49, v50
    v_max3_f32 v3, v3, v51, v52
    v_max3_f32 v3, v3, v53, v54
    v_max3_f32 v3, v3, v55, v56
    v_max3_f32 v3, v3, v57, v58
    s_nop 1
    v_max_f32_dpp v3, v3, v3 row_ror:8 row_mask:0xf bank_mask:0xf
    s_nop 1
    v_max_f32_dpp v3, v3, v3 row_ror:4 row_mask:0xf bank_mask:0xf
    s_nop 1
    v_max_f32_dpp v3, v3, v3 row_ror:2 row_mask:0xf bank_mask:0xf
    s_nop 1
    v_max_f32_dpp v3, v3, v3 row_ror:1 row_mask:0xf bank_mask:0xf
    s_nop 1
    v_max_f32_dpp v3, v3, v3 row_bcast:15 row_mask:0xa bank_mask:0xf
    s_nop 1
    v_max_f32_dpp v3, v3, v3 row_bcast:31 row_mask:0xc bank_mask:0xf
    s_nop 0
    v_readlane_b32 s24, v3, 63
    s_nop 1
    v_mul_f32 v6, s24, v61
    v_mov_b32 v12, 0
    v_mov_b32 v13, 0
    v_mov_b32 v14, 0
    v_mov_b32 v15, 0
    v_fma_f32 v48, v48, v61, -v6
    v_exp_f32 v48, v48
    s_nop 0
    v_add_f32 v7, v7, v48
    v_cvt_pk_bf16_f32 v48, v48, v48
    s_mov_b32 s27, 0
L_BV:
    s_barrier
    s_cmp_ge_u32 s27, 1
    s_cselect_b32 s71, s3, 4
    s_cmp_lg_u32 s71, 0
    s_cbranch_scc1 L_BV_p0
    s_lshl_b32 s24, s27, 2
    s_add_u32 s24, s24, 0
    s_mov_b64 exec, 1
    v_mov_b32 v63, s24
    s_cmp_lg_u32 s75, 0
    s_cbranch_scc1 L_far3
    buffer_store_dword v63, off, s[12:15], s34 offset:64
    s_branch L_near3
L_far3:
    buffer_store_dword v63, off, s[12:15], s34 offset:64 sc1
L_near3:
    s_mov_b64 exec, -1
L_BV_p0:
    v_and_b32_dpp v8, v48, v20 row_newbcast:0 row_mask:0xf bank_mask:0xf
    v_and_b32_dpp v9, v48, v21 row_newbcast:0 row_mask:0xf bank_mask:0xf
    v_and_b32_dpp v10, v48, v22 row_newbcast:0 row_mask:0xf bank_mask:0xf
    v_and_b32_dpp v11, v48, v23 row_newbcast:0 row_mask:0xf bank_mask:0xf
    s_waitcnt vmcnt(15)
    s_nop 0
    v_mfma_f32_16x16x32_bf16 v[12:15], v[64:67], v[8:11], v[12:15]
    buffer_load_dwordx4 v[64:67], v1, s[4:7], s32 offen offset:0 nt
    s_add_u32 s32, s32, 6144
    v_and_b32_dpp v8, v48, v20 row_newbcast:4 row_mask:0xf bank_mask:0xf
    v_and_b32_dpp v9, v48, v21 row_newbcast:4 row_mask:0xf bank_mask:0xf
    v_and_b32_dpp v10, v48, v22 row_newbcast:4 row_mask:0xf bank_mask:0xf
    v_and_b32_dpp v11, v48, v23 row_newbcast:4 row_mask:0xf bank_mask:0xf
    s_waitcnt vmcnt(15)
    s_nop 0
    v_mfma_f32_16x16x32_bf16 v[12:15], v[68:71], v[8:11], v[12:15]
    buffer_load_dwordx4 v[68:71], v1, s[4:7], s32 offen offset:0 nt
    s_add_u32 s32, s32, 6144
    v_and_b32_dpp v8, v48, v20 row_newbcast:8 row_mask:0xf bank_mask:0xf
    v_and_b32_dpp v9, v48, v21 row_newbcast:8 row_mask:0xf bank_mask:0xf
    v_and_b32_dpp v10, v48, v22 row_newbcast:8 row_mask:0xf bank_mask:0xf
    v_and_b32_dpp v11, v48, v23 row_newbcast:8 row_mask:0xf bank_mask:0xf
    s_waitcnt vmcnt(15)
    s_nop 0
    v_mfma_f32_16x16x32_bf16 v[12:15], v[72:75], v[8:11], v[12:15]
    buffer_load_dwordx4 v[72:75], v1, s[4:7], s32 offen offset:0 nt
    s_add_u32 s32, s32, 6144
    v_and_b32_dpp v8, v48, v20 row_newbcast:12 row_mask:0xf bank_mask:0xf
    v_and_b32_dpp v9, v48, v21 row_newbcast:12 row_mask:0xf bank_mask:0xf
    v_and_b32_dpp v10, v48, v22 row_newbcast:12 row_mask:0xf bank_mask:0xf
    v_and_b32_dpp v11, v48, v23 row_newbcast:12 row_mask:0xf bank_mask:0xf
    s_waitcnt vmcnt(15)
    s_nop 0
    v_mfma_f32_16x16x32_bf16 v[12:15], v[76:79], v[8:11], v[12:15]
    buffer_load_dwordx4 v[76:79], v1, s[4:7], s32 offen offset:0 nt
    s_add_u32 s32, s32, 6144
    s_cmp_lg_u32 s71, 1
    s_cbranch_scc1 L_BV_p1
    s_lshl_b32 s24, s27, 2
    s_add_u32 s24, s24, 1
    s_mov_b64 exec, 1
    v_mov_b32 v63, s24
    s_cmp_lg_u32 s75, 0
    s_cbranch_scc1 L_far4
    buffer_store_dword v63, off, s[12:15], s34 offset:64
    s_branch L_near4
L_far4:
    buffer_store_dword v63, off, s[12:15], s34 offset:64 sc1
L_near4:
    s_mov_b64 exec, -1
L_BV_p1:
    v_and_b32_dpp v8, v48, v20 row_newbcast:1 row_mask:0xf bank_mask:0xf
    v_and_b32_dpp v9, v48, v21 row_newbcast:1 row_mask:0xf bank_mask:0xf
    v_and_b32_dpp v10, v48, v22 row_newbcast:1 row_mask:0xf bank_mask:0xf
    v_and_b32_dpp v11, v48, v23 row_newbcast:1 row_mask:0xf bank_mask:0xf
    s_waitcnt vmcnt(15)
    s_nop 0
    v_mfma_f32_16x16x32_bf16 v[12:15], v[80:83], v[8:11], v[12:15]
    buffer_load_dwordx4 v[80:83], v1, s[4:7], s32 offen offset:0 nt
    s_add_u32 s32, s32, 6144
    v_and_b32_dpp v8, v48, v20 row_newbcast:5 row_mask:0xf bank_mask:0xf
    v_and_b32_dpp v9, v48, v21 row_newbcast:5 row_mask:0xf bank_mask:0xf
    v_and_b32_dpp v10, v48, v22 row_newbcast:5 row_mask:0xf bank_mask:0xf
    v_and_b32_dpp v11, v48, v23 row_newbcast:5 row_mask:0xf bank_mask:0xf
    s_waitcnt vmcnt(15)
    s_nop 0
    v_mfma_f32_16x16x32_bf16 v[12:15], v[84:87], v[8:11], v[12:15]
    buffer_load_dwordx4 v[84:87], v1, s[4:7], s32 offen offset:0 nt
    s_add_u32 s32, s32, 6144
    v_and_b32_dpp v8, v48, v20 row_newbcast:9 row_mask:0xf bank_mask:0xf
    v_and_b32_dpp v9, v48, v21 row_newbcast:9 row_mask:0xf bank_mask:0xf
    v_and_b32_dpp v10, v48, v22 row_newbcast:9 row_mask:0xf bank_mask:0xf
    v_and_b32_dpp v11, v48, v23 row_newbcast:9 row_mask:0xf bank_mask:0xf
    s_waitcnt vmcnt(15)
    s_nop 0
    v_mfma_f32_16x16x32_bf16 v[12:15], v[88:91], v[8:11], v[12:15]
    buffer_load_dwordx4 v[88:91], v1, s[4:7], s32 offen offset:0 nt
    s_add_u32 s32, s32, 6144
    v_and_b32_dpp v8, v48, v20 row_newbcast:13 row_mask:0xf bank_mask:0xf
    v_and_b32_dpp v9, v48, v21 row_newbcast:13 row_mask:0xf bank_mask:0xf
    v_and_b32_dpp v10, v48, v22 row_newbcast:13 row_mask:0xf bank_mask:0xf
    v_and_b32_dpp v11, v48, v23 row_newbcast:13 row_mask:0xf bank_mask:0xf
    s_waitcnt vmcnt(15)
    s_nop 0
    v_mfma_f32_16x16x32_bf16 v[12:15], v[92:95], v[8:11], v[12:15]
    buffer_load_dwordx4 v[92:95], v1, s[4:7], s32 offen offset:0 nt
    s_add_u32 s32, s32, 6144
    s_cmp_lg_u32 s71, 2
    s_cbranch_scc1 L_BV_p2
    s_lshl_b32 s24, s27, 2
    s_add_u32 s24, s24, 2
    s_mov_b64 exec, 1
    v_mov_b32 v63, s24
    s_cmp_lg_u32 s75, 0
    s_cbranch_scc1 L_far5
    buffer_store_dword v63, off, s[12:15], s34 offset:64
    s_branch L_near5
L_far5:
    buffer_store_dword v63, off, s[12:15], s34 offset:64 sc1
L_near5:
    s_mov_b64 exec, -1
L_BV_p2:
    v_and_b32_dpp v8, v48, v20 row_newbcast:2 row_mask:0xf bank_mask:0xf
    v_and_b32_dpp v9, v48, v21 row_newbcast:2 row_mask:0xf bank_mask:0xf
    v_and_b32_dpp v10, v48, v22 row_newbcast:2 row_mask:0xf bank_mask:0xf
    v_and_b32_dpp v11, v48, v23 row_newbcast:2 row_mask:0xf bank_mask:0xf
    s_waitcnt vmcnt(15)
    s_nop 0
    v_mfma_f32_16x16x32_bf16 v[12:15], v[96:99], v[8:11], v[12:15]
    buffer_load_dwordx4 v[96:99], v1, s[4:7], s32 offen offset:0 nt
    s_add_u32 s32, s32, 6144
    v_and_b32_dpp v8, v48, v20 row_newbcast:6 row_mask:0xf bank_mask:0xf
    v_and_b32_dpp v9, v48, v21 row_newbcast:6 row_mask:0xf bank_mask:0xf
    v_and_b32_dpp v10, v48, v22 row_newbcast:6 row_mask:0xf bank_mask:0xf
    v_and_b32_dpp v11, v48, v23 row_newbcast:6 row_mask:0xf bank_mask:0xf
    s_waitcnt vmcnt(15)
    s_nop 0
    v_mfma_f32_16x16x32_bf16 v[12:15], v[100:103], v[8:11], v[12:15]
    buffer_load_dwordx4 v[100:103], v1, s[4:7], s32 offen offset:0 nt
    s_add_u32 s32, s32, 6144
    s_cmp_eq_u32 s27, 9
    s_cbranch_scc1 L_BT
    v_and_b32_dpp v8, v48, v20 row_newbcast:10 row_mask:0xf bank_mask:0xf
    v_and_b32_dpp v9, v48, v21 row_newbcast:10 row_mask:0xf bank_mask:0xf
    v_and_b32_dpp v10, v48, v22 row_newbcast:10 row_mask:0xf bank_mask:0xf
    v_and_b32_dpp v11, v48, v23 row_newbcast:10 row_mask:0xf bank_mask:0xf
    s_waitcnt vmcnt(15)
    s_nop 0
    v_mfma_f32_16x16x32_bf16 v[12:15], v[104:107], v[8:11], v[12:15]
    buffer_load_dwordx4 v[104:107], v1, s[4:7], s32 offen offset:0 nt
    s_add_u32 s32, s32, 6144
    v_and_b32_dpp v8, v48, v20 row_newbcast:14 row_mask:0xf bank_mask:0xf
    v_and_b32_dpp v9, v48, v21 row_newbcast:14 row_mask:0xf bank_mask:0xf
    v_and_b32_dpp v10, v48, v22 row_newbcast:14 row_mask:0xf bank_mask:0xf
    v_and_b32_dpp v11, v48, v23 row_newbcast:14 row_mask:0xf bank_mask:0xf
    s_waitcnt vmcnt(15)
    s_nop 0
    v_mfma_f32_16x16x32_bf16 v[12:15], v[108:111], v[8:11], v[12:15]
    buffer_load_dwordx4 v[108:111], v1, s[4:7], s32 offen offset:0 nt
    s_add_u32 s32, s32, 6144
    s_cmp_lg_u32 s71, 3
    s_cbranch_scc1 L_BV_p3
    s_lshl_b32 s24, s27, 2
    s_add_u32 s24, s24, 3
    s_mov_b64 exec, 1
    v_mov_b32 v63, s24
    s_cmp_lg_u32 s75, 0
    s_cbranch_scc1 L_far6
    buffer_store_dword v63, off, s[12:15], s34 offset:64
    s_branch L_near6
L_far6:
    buffer_store_dword v63, off, s[12:15], s34 offset:64 sc1
L_near6:
    s_mov_b64 exec, -1
L_BV_p3:
    v_and_b32_dpp v8, v48, v20 row_newbcast:3 row_mask:0xf bank_mask:0xf
    v_and_b32_dpp v9, v48, v21 row_newbcast:3 row_mask:0xf bank_mask:0xf
    v_and_b32_dpp v10, v48, v22 row_newbcast:3 row_mask:0xf bank_mask:0xf
    v_and_b32_dpp v11, v48, v23 row_newbcast:3 row_mask:0xf bank_mask:0xf
    s_waitcnt vmcnt(15)
    s_nop 0
    v_mfma_f32_16x16x32_bf16 v[12:15], v[112:115], v[8:11], v[12:15]
    buffer_load_dwordx4 v[112:115], v1, s[4:7], s32 offen offset:0 nt
    s_add_u32 s32, s32, 6144
    s_cmp_lg_u32 s27, 0
    s_cbranch_scc1 L_BV_d
    v_fma_f32 v49, v49, v61, -v6
    v_fma_f32 v50, v50, v61, -v6
    v_fma_f32 v51, v51, v61, -v6
    v_fma_f32 v52, v52, v61, -v6
    v_fma_f32 v53, v53, v61, -v6
    v_fma_f32 v54, v54, v61, -v6
    v_fma_f32 v55, v55, v61, -v6
    v_fma_f32 v56, v56, v61, -v6
    v_fma_f32 v57, v57, v61, -v6
    v_fma_f32 v58, v58, v61, -v6
    v_exp_f32 v49, v49
    v_exp_f32 v50, v50
    v_exp_f32 v51, v51
    v_exp_f32 v52, v52
    v_exp_f32 v53, v53
    v_exp_f32 v54, v54
    v_exp_f32 v55, v55
    v_exp_f32 v56, v56
    v_exp_f32 v57, v57
    v_exp_f32 v58, v58
    v_add_f32 v7, v7, v49
    v_add_f32 v7, v7, v50
    v_add_f32 v7, v7, v51
    v_add_f32 v7, v7, v52
    v_add_f32 v7, v7, v53
    v_add_f32 v7, v7, v54
    v_add_f32 v7, v7, v55
    v_add_f32 v7, v7, v56
    v_add_f32 v7, v7, v57
    v_add_f32 v7, v7, v58
    v_cvt_pk_bf16_f32 v49, v49, v49
    v_cvt_pk_bf16_f32 v50, v50, v50
    v_cvt_pk_bf16_f32 v51, v51, v51
    v_cvt_pk_bf16_f32 v52, v52, v52
    v_cvt_pk_bf16_f32 v53, v53, v53
    v_cvt_pk_bf16_f32 v54, v54, v54
    v_cvt_pk_bf16_f32 v55, v55, v55
    v_cvt_pk_bf16_f32 v56, v56, v56
    v_cvt_pk_bf16_f32 v57, v57, v57
    v_cvt_pk_bf16_f32 v58, v58, v58
    v_add_f32_dpp v7, v7, v7 row_ror:8 row_mask:0xf bank_mask:0xf
    s_nop 1
    v_add_f32_dpp v7, v7, v7 row_ror:4 row_mask:0xf bank_mask:0xf
    s_nop 1
    v_add_f32_dpp v7, v7, v7 row_ror:2 row_mask:0xf bank_mask:0xf
    s_nop 1
    v_add_f32_dpp v7, v7, v7 row_ror:1 row_mask:0xf bank_mask:0xf
    s_nop 1
    v_add_f32_dpp v7, v7, v7 row_bcast:15 row_mask:0xa bank_mask:0xf
    s_nop 1
    v_add_f32_dpp v7, v7, v7 row_bcast:31 row_mask:0xc bank_mask:0xf
    s_nop 0
    v_readlane_b32 s70, v7, 63
    s_lshl_b32 s25, s3, 4
    s_add_u32 s25, s25, s34
    s_mov_b64 exec, 1
    v_mov_b32 v7, s70
    s_cmp_lg_u32 s75, 0
    s_cbranch_scc1 L_far7
    buffer_store_dwordx2 v[6:7], off, s[12:15], s25
    s_branch L_near7
L_far7:
    buffer_store_dwordx2 v[6:7], off, s[12:15], s25 sc1
L_near7:
    s_mov_b64 exec, -1
L_BV_d:
    v_and_b32_dpp v8, v48, v20 row_newbcast:7 row_mask:0xf bank_mask:0xf
    v_and_b32_dpp v9, v48, v21 row_newbcast:7 row_mask:0xf bank_mask:0xf
    v_and_b32_dpp v10, v48, v22 row_newbcast:7 row_mask:0xf bank_mask:0xf
    v_and_b32_dpp v11, v48, v23 row_newbcast:7 row_mask:0xf bank_mask:0xf
    s_waitcnt vmcnt(15)
    s_nop 0
    v_mfma_f32_16x16x32_bf16 v[12:15], v[116:119], v[8:11], v[12:15]
    buffer_load_dwordx4 v[116:119], v1, s[4:7], s32 offen offset:0 nt
    s_add_u32 s32, s32, 6144
    v_and_b32_dpp v8, v48, v20 row_newbcast:11 row_mask:0xf bank_mask:0xf
    v_and_b32_dpp v9, v48, v21 row_newbcast:11 row_mask:0xf bank_mask:0xf
    v_and_b32_dpp v10, v48, v22 row_newbcast:11 row_mask:0xf bank_mask:0xf
    v_and_b32_dpp v11, v48, v23 row_newbcast:11 row_mask:0xf bank_mask:0xf
    s_waitcnt vmcnt(15)
    s_nop 0
    v_mfma_f32_16x16x32_bf16 v[12:15], v[120:123], v[8:11], v[12:15]
    buffer_load_dwordx4 v[120:123], v1, s[4:7], s32 offen offset:0 nt
    s_add_u32 s32, s32, 6144
    v_and_b32_dpp v8, v48, v20 row_newbcast:15 row_mask:0xf bank_mask:0xf
    v_and_b32_dpp v9, v48, v21 row_newbcast:15 row_mask:0xf bank_mask:0xf
    v_and_b32_dpp v10, v48, v22 row_newbcast:15 row_mask:0xf bank_mask:0xf
    v_and_b32_dpp v11, v48, v23 row_newbcast:15 row_mask:0xf bank_mask:0xf
    s_waitcnt vmcnt(15)
    s_nop 0
    v_mfma_f32_16x16x32_bf16 v[12:15], v[124:127], v[8:11], v[12:15]
    buffer_load_dwordx4 v[124:127], v1, s[4:7], s32 offen offset:0 nt
    s_add_u32 s32, s32, 6144
    v_mov_b32 v48, v49
    v_mov_b32 v49, v50
    v_mov_b32 v50, v51
    v_mov_b32 v51, v52
    v_mov_b32 v52, v53
    v_mov_b32 v53, v54
    v_mov_b32 v54, v55
    v_mov_b32 v55, v56
    v_mov_b32 v56, v57
    v_mov_b32 v57, v58
    s_add_u32 s27, s27, 1
    s_branch L_BV
L_BT:
    v_and_b32_dpp v8, v48, v20 row_newbcast:10 row_mask:0xf bank_mask:0xf
    v_and_b32_dpp v9, v48, v21 row_newbcast:10 row_mask:0xf bank_mask:0xf
    v_and_b32_dpp v10, v48, v22 row_newbcast:10 row_mask:0xf bank_mask:0xf
    v_and_b32_dpp v11, v48, v23 row_newbcast:10 row_mask:0xf bank_mask:0xf
    s_waitcnt vmcnt(15)
    s_nop 0
    v_mfma_f32_16x16x32_bf16 v[12:15], v[104:107], v[8:11], v[12:15]
    buffer_load_dwordx4 v[104:107], v1, s[4:7], s28 offen offset:0 nt
    v_and_b32_dpp v8, v48, v20 row_newbcast:14 row_mask:0xf bank_mask:0xf
    v_and_b32_dpp v9, v48, v21 row_newbcast:14 row_mask:0xf bank_mask:0xf
    v_and_b32_dpp v10, v48, v22 row_newbcast:14 row_mask:0xf bank_mask:0xf
    v_and_b32_dpp v11, v48, v23 row_newbcast:14 row_mask:0xf bank_mask:0xf
    s_waitcnt vmcnt(15)
    s_nop 0
    v_mfma_f32_16x16x32_bf16 v[12:15], v[108:111], v[8:11], v[12:15]
    v_and_b32_dpp v8, v48, v20 row_newbcast:3 row_mask:0xf bank_mask:0xf
    v_and_b32_dpp v9, v48, v21 row_newbcast:3 row_mask:0xf bank_mask:0xf
    v_and_b32_dpp v10, v48, v22 row_newbcast:3 row_mask:0xf bank_mask:0xf
    v_and_b32_dpp v11, v48, v23 row_newbcast:3 row_mask:0xf bank_mask:0xf
    s_waitcnt vmcnt(14)
    s_nop 0
    v_mfma_f32_16x16x32_bf16 v[12:15], v[112:115], v[8:11], v[12:15]
    v_and_b32_dpp v8, v48, v20 row_newbcast:7 row_mask:0xf bank_mask:0xf
    v_and_b32_dpp v9, v48, v21 row_newbcast:7 row_mask:0xf bank_mask:0xf
    v_and_b32_dpp v10, v48, v22 row_newbcast:7 row_mask:0xf bank_mask:0xf
    v_and_b32_dpp v11, v48, v23 row_newbcast:7 row_mask:0xf bank_mask:0xf
    s_waitcnt vmcnt(13)
    s_nop 0
    v_mfma_f32_16x16x32_bf16 v[12:15], v[116:119], v[8:11], v[12:15]
    v_and_b32_dpp v8, v48, v20 row_newbcast:11 row_mask:0xf bank_mask:0xf
    v_and_b32_dpp v9, v48, v21 row_newbcast:11 row_mask:0xf bank_mask:0xf
    v_and_b32_dpp v10, v48, v22 row_newbcast:11 row_mask:0xf bank_mask:0xf
    v_and_b32_dpp v11, v48, v23 row_newbcast:11 row_mask:0xf bank_mask:0xf
    s_waitcnt vmcnt(12)
    s_nop 0
    v_mfma_f32_16x16x32_bf16 v[12:15], v[120:123], v[8:11], v[12:15]
    v_and_b32_dpp v8, v48, v20 row_newbcast:15 row_mask:0xf bank_mask:0xf
    v_and_b32_dpp v9, v48, v21 row_newbcast:15 row_mask:0xf bank_mask:0xf
    v_and_b32_dpp v10, v48, v22 row_newbcast:15 row_mask:0xf bank_mask:0xf
    v_and_b32_dpp v11, v48, v23 row_newbcast:15 row_mask:0xf bank_mask:0xf
    s_waitcnt vmcnt(11)
    s_nop 0
    v_mfma_f32_16x16x32_bf16 v[12:15], v[124:127], v[8:11], v[12:15]
    v_and_b32_dpp v8, v49, v20 row_newbcast:0 row_mask:0xf bank_mask:0xf
    v_and_b32_dpp v9, v49, v21 row_newbcast:0 row_mask:0xf bank_mask:0xf
    v_and_b32_dpp v10, v49, v22 row_newbcast:0 row_mask:0xf bank_mask:0xf
    v_and_b32_dpp v11, v49, v23 row_newbcast:0 row_mask:0xf bank_mask:0xf
    s_waitcnt vmcnt(10)
    s_nop 0
    v_mfma_f32_16x16x32_bf16 v[12:15], v[64:67], v[8:11], v[12:15]
    v_and_b32_dpp v8, v49, v20 row_newbcast:4 row_mask:0xf bank_mask:0xf
    v_and_b32_dpp v9, v49, v21 row_newbcast:4 row_mask:0xf bank_mask:0xf
    v_and_b32_dpp v10, v49, v22 row_newbcast:4 row_mask:0xf bank_mask:0xf
    v_and_b32_dpp v11, v49, v23 row_newbcast:4 row_mask:0xf bank_mask:0xf
    s_waitcnt vmcnt(9)
    s_nop 0
    v_mfma_f32_16x16x32_bf16 v[12:15], v[68:71], v[8:11], v[12:15]
    v_and_b32_dpp v8, v49, v20 row_newbcast:8 row_mask:0xf bank_mask:0xf
    v_and_b32_dpp v9, v49, v21 row_newbcast:8 row_mask:0xf bank_mask:0xf
    v_and_b32_dpp v10, v49, v22 row_newbcast:8 row_mask:0xf bank_mask:0xf
    v_and_b32_dpp v11, v49, v23 row_newbcast:8 row_mask:0xf bank_mask:0xf
    s_waitcnt vmcnt(8)
    s_nop 0
    v_mfma_f32_16x16x32_bf16 v[12:15], v[72:75], v[8:11], v[12:15]
    v_and_b32_dpp v8, v49, v20 row_newbcast:12 row_mask:0xf bank_mask:0xf
    v_and_b32_dpp v9, v49, v21 row_newbcast:12 row_mask:0xf bank_mask:0xf
    v_and_b32_dpp v10, v49, v22 row_newbcast:12 row_mask:0xf bank_mask:0xf
    v_and_b32_dpp v11, v49, v23 row_newbcast:12 row_mask:0xf bank_mask:0xf
    s_waitcnt vmcnt(7)
    s_nop 0
    v_mfma_f32_16x16x32_bf16 v[12:15], v[76:79], v[8:11], v[12:15]
    v_and_b32_dpp v8, v49, v20 row_newbcast:1 row_mask:0xf bank_mask:0xf
    v_and_b32_dpp v9, v49, v21 row_newbcast:1 row_mask:0xf bank_mask:0xf
    v_and_b32_dpp v10, v49, v22 row_newbcast:1 row_mask:0xf bank_mask:0xf
    v_and_b32_dpp v11, v49, v23 row_newbcast:1 row_mask:0xf bank_mask:0xf
    s_waitcnt vmcnt(6)
    s_nop 0
    v_mfma_f32_16x16x32_bf16 v[12:15], v[80:83], v[8:11], v[12:15]
    v_and_b32_dpp v8, v49, v20 row_newbcast:5 row_mask:0xf bank_mask:0xf
    v_and_b32_dpp v9, v49, v21 row_newbcast:5 row_mask:0xf bank_mask:0xf
    v_and_b32_dpp v10, v49, v22 row_newbcast:5 row_mask:0xf bank_mask:0xf
    v_and_b32_dpp v11, v49, v23 row_newbcast:5 row_mask:0xf bank_mask:0xf
    s_waitcnt vmcnt(5)
    s_nop 0
    v_mfma_f32_16x16x32_bf16 v[12:15], v[84:87], v[8:11], v[12:15]
    v_and_b32_dpp v8, v49, v20 row_newbcast:9 row_mask:0xf bank_mask:0xf
    v_and_b32_dpp v9, v49, v21 row_newbcast:9 row_mask:0xf bank_mask:0xf
    v_and_b32_dpp v10, v49, v22 row_newbcast:9 row_mask:0xf bank_mask:0xf
    v_and_b32_dpp v11, v49, v23 row_newbcast:9 row_mask:0xf bank_mask:0xf
    s_waitcnt vmcnt(4)
    s_nop 0
    v_mfma_f32_16x16x32_bf16 v[12:15], v[88:91], v[8:11], v[12:15]
    v_and_b32_dpp v8, v49, v20 row_newbcast:13 row_mask:0xf bank_mask:0xf
    v_and_b32_dpp v9, v49, v21 row_newbcast:13 row_mask:0xf bank_mask:0xf
    v_and_b32_dpp v10, v49, v22 row_newbcast:13 row_mask:0xf bank_mask:0xf
    v_and_b32_dpp v11, v49, v23 row_newbcast:13 row_mask:0xf bank_mask:0xf
    s_waitcnt vmcnt(3)
    s_nop 0
    v_mfma_f32_16x16x32_bf16 v[12:15], v[92:95], v[8:11], v[12:15]
    v_and_b32_dpp v8, v49, v20 row_newbcast:2 row_mask:0xf bank_mask:0xf
    v_and_b32_dpp v9, v49, v21 row_newbcast:2 row_mask:0xf bank_mask:0xf
    v_and_b32_dpp v10, v49, v22 row_newbcast:2 row_mask:0xf bank_mask:0xf
    v_and_b32_dpp v11, v49, v23 row_newbcast:2 row_mask:0xf bank_mask:0xf
    s_waitcnt vmcnt(2)
    s_nop 0
    v_mfma_f32_16x16x32_bf16 v[12:15], v[96:99], v[8:11], v[12:15]
    v_and_b32_dpp v8, v49, v20 row_newbcast:6 row_mask:0xf bank_mask:0xf
    v_and_b32_dpp v9, v49, v21 row_newbcast:6 row_mask:0xf bank_mask:0xf
    v_and_b32_dpp v10, v49, v22 row_newbcast:6 row_mask:0xf bank_mask:0xf
    v_and_b32_dpp v11, v49, v23 row_newbcast:6 row_mask:0xf bank_mask:0xf
    s_waitcnt vmcnt(1)
    s_nop 0
    v_mfma_f32_16x16x32_bf16 v[12:15], v[100:103], v[8:11], v[12:15]
    v_and_b32_dpp v8, v49, v20 row_newbcast:10 row_mask:0xf bank_mask:0xf
    v_and_b32_dpp v9, v49, v21 row_newbcast:10 row_mask:0xf bank_mask:0xf
    v_and_b32_dpp v10, v49, v22 row_newbcast:10 row_mask:0xf bank_mask:0xf
    v_and_b32_dpp v11, v49, v23 row_newbcast:10 row_mask:0xf bank_mask:0xf
    s_waitcnt vmcnt(0)
    s_nop 0
    v_mfma_f32_16x16x32_bf16 v[12:15], v[104:107], v[8:11], v[12:15]
    s_mov_b32 exec_lo, 0x00ff00ff
    s_mov_b32 exec_hi, 0x00ff00ff
    s_cmp_lg_u32 s75, 0
    s_nop 4
    v_cvt_pk_bf16_f32 v4, v12, v13
    v_cvt_pk_bf16_f32 v5, v14, v15
    s_cbranch_scc1 L_far8
    buffer_store_dwordx2 v[4:5], v60, s[12:15], s73 offen
    s_branch L_near8
L_far8:
    buffer_store_dwordx2 v[4:5], v60, s[12:15], s73 offen sc1
L_near8:
    s_endpgm
L_A:
    v_lshrrev_b32 v1, 6, v0
    v_and_b32 v0, 63, v0
    v_readfirstlane_b32 s3, v1
    v_lshlrev_b32 v2, 4, v0
    s_mov_b32 s74, s2
    s_and_b32 s72, s2, 31
    s_and_b32 s70, s2, 6
    s_and_b32 s25, s2, 7
    s_add_u32 s70, s70, s25
    s_lshr_b32 s26, s72, 3
    s_and_b32 s25, s26, 1
    s_lshl_b32 s25, s25, 1
    s_and_b32 s26, s26, 2
    s_lshl_b32 s26, s26, 3
    s_or_b32 s26, s26, s25
    s_or_b32 s26, s26, s70
    v_lshrrev_b32 v3, 4, v0
    v_and_b32 v4, 15, v0
    v_lshlrev_b32 v18, 18, v3
    v_lshl_add_u32 v18, v4, 4, v18
    v_lshrrev_b32 v6, 3, v4
    v_lshlrev_b32 v6, 10, v6
    v_lshl_add_u32 v19, v3, 6, v6
    v_bfe_u32 v1, v0, 2, 2
    v_lshlrev_b32 v64, 18, v1
    v_lshl_add_u32 v64, v3, 6, v64
    v_and_b32 v4, 3, v0
    v_lshl_add_u32 v64, v4, 4, v64
    v_lshlrev_b32 v65, 9, v1
    v_lshl_add_u32 v65, v3, 7, v65
    v_lshl_add_u32 v65, v4, 5, v65
    v_add_u32 v65, 135168, v65
    v_lshlrev_b32 v66, 17, v1
    v_lshl_add_u32 v66, v3, 6, v66
    v_lshl_add_u32 v66, v4, 4, v66
    v_and_b32 v4, 15, v0
    v_lshlrev_b32 v67, 10, v3
    v_lshl_add_u32 v67, v4, 4, v67
    s_lshl_b32 s35, s3, 20
    s_lshl_b32 s24, s26, 8
    s_add_u32 s35, s35, s24
    s_waitcnt lgkmcnt(0)
    s_cmp_lt_u32 s74, 32
    s_cselect_b64 s[4:5], s[40:41], s[54:55]
    s_mov_b32 s6, 0x400000
    s_mov_b32 s7, 0x20000
    s_cselect_b64 s[20:21], s[36:37], s[48:49]
    s_mov_b32 s22, 4096
    s_mov_b32 s23, 0x20000
    s_cselect_b32 s75, 0x400000, 0
    s_lshl_b32 s24, s3, 8
    s_mov_b32 s32, s35
    buffer_load_dwordx4 v[12:15], v67, s[20:23], s24 offen
    buffer_load_dwordx4 v[128:131], v18, s[4:7], s32 offen
    s_add_u32 s32, s32, 8192
    buffer_load_dwordx4 v[132:135], v18, s[4:7], s32 offen
    s_add_u32 s32, s32, 8192
    buffer_load_dwordx4 v[136:139], v18, s[4:7], s32 offen
    s_add_u32 s32, s32, 8192
    buffer_load_dwordx4 v[140:143], v18, s[4:7], s32 offen
    s_add_u32 s32, s32, 8192
    buffer_load_dwordx4 v[144:147], v18, s[4:7], s32 offen
    s_add_u32 s32, s32, 8192
    buffer_load_dwordx4 v[148:151], v18, s[4:7], s32 offen
    s_add_u32 s32, s32, 8192
    buffer_load_dwordx4 v[152:155], v18, s[4:7], s32 offen
    s_add_u32 s32, s32, 8192
    buffer_load_dwordx4 v[156:159], v18, s[4:7], s32 offen
    s_add_u32 s32, s32, 8192
    buffer_load_dwordx4 v[160:163], v18, s[4:7], s32 offen
    s_add_u32 s32, s32, 8192
    buffer_load_dwordx4 v[164:167], v18, s[4:7], s32 offen
    s_add_u32 s32, s32, 8192
    buffer_load_dwordx4 v[168:171], v18, s[4:7], s32 offen
    s_add_u32 s32, s32, 8192
    buffer_load_dwordx4 v[172:175], v18, s[4:7], s32 offen
    s_add_u32 s32, s32, 8192
    s_mov_b32 s12, s62
    s_mov_b32 s13, s63
    s_mov_b32 s14, 0x600000
    s_mov_b32 s15, 0x20000
    s_mov_b32 s16, s60
    s_mov_b32 s17, s61
    s_mov_b32 s18, 0x100
    s_mov_b32 s19, 0x20000
    v_and_b32 v3, 1, v0
    v_lshlrev_b32 v3, 4, v3
    v_mov_b32 v4, 0xffff
    v_lshlrev_b32 v4, v3, v4
    v_bfe_u32 v3, v0, 1, 2
    v_cmp_eq_u32 vcc, 0, v3
    s_nop 1
    v_cndmask_b32 v20, 0, v4, vcc
    v_cmp_eq_u32 vcc, 1, v3
    s_nop 1
    v_cndmask_b32 v21, 0, v4, vcc
    v_cmp_eq_u32 vcc, 2, v3
    s_nop 1
    v_cndmask_b32 v22, 0, v4, vcc
    v_cmp_eq_u32 vcc, 3, v3
    s_nop 1
    v_cndmask_b32 v23, 0, v4, vcc
    v_mov_b32 v3, 0x0c0c0c0c
    s_mov_b32 s24, 0x01000100
    s_mov_b32 s25, 0x03020302
    v_bfi_b32 v24, v20, s24, v3
    v_bfi_b32 v28, v20, s25, v3
    v_bfi_b32 v25, v21, s24, v3
    v_bfi_b32 v29, v21, s25, v3
    v_bfi_b32 v26, v22, s24, v3
    v_bfi_b32 v30, v22, s25, v3
    v_bfi_b32 v27, v23, s24, v3
    v_bfi_b32 v31, v23, s25, v3
    s_mov_b32 s64, 0x22222222
    s_mov_b32 s65, 0x22222222
    s_mov_b32 s66, 0x44444444
    s_mov_b32 s67, 0x44444444
    s_mov_b32 s68, 0x88888888
    s_mov_b32 s69, 0x88888888
    s_lshl_b32 s24, s3, 8
    s_add_u32 s24, s24, 145408
    v_add_u32 v3, s24, v67
    v_add_u32 v4, s24, v19
    s_waitcnt vmcnt(12)
    ds_write_b128 v3, v[12:15]
    s_waitcnt lgkmcnt(0)
    ds_read_b128 v[32:35], v4 offset:0
    ds_read_b128 v[36:39], v4 offset:16
    ds_read_b128 v[40:43], v4 offset:32
    ds_read_b128 v[44:47], v4 offset:48
    ds_read_b128 v[48:51], v4 offset:2048
    ds_read_b128 v[52:55], v4 offset:2064
    ds_read_b128 v[56:59], v4 offset:2080
    ds_read_b128 v[60:63], v4 offset:2096
    s_waitcnt lgkmcnt(0)
    v_mov_b32 v76, -1
    v_mov_b32 v77, -1
    v_mov_b32 v78, -1
    v_mov_b32 v79, -1
    s_lshl_b32 s71, s72, 2
    s_add_u32 s71, s71, s3
    s_lshl_b32 s71, s71, 10
    s_add_u32 s71, s71, 0x1b0000
    s_cmp_lt_u32 s74, 32
    s_cselect_b32 s71, 0x600000, s71
    v_perm_b32 v8, v32, v32, v24
    v_perm_b32 v9, v32, v32, v25
    v_perm_b32 v10, v32, v32, v26
    v_perm_b32 v11, v32, v32, v27
    v_perm_b32 v4, v48, v48, v24
    v_perm_b32 v5, v48, v48, v25
    v_perm_b32 v6, v48, v48, v26
    v_perm_b32 v7, v48, v48, v27
    s_waitcnt vmcnt(11)
    v_mfma_f32_16x16x32_bf16 v[12:15], v[128:131], v[8:11], 0
    v_mfma_f32_16x16x32_bf16 v[68:71], v[128:131], v[4:7], 0
    buffer_load_dwordx4 v[176:179], v18, s[4:7], s32 offen nt
    s_add_u32 s32, s32, 8192
    v_perm_b32 v8, v32, v32, v28
    v_perm_b32 v9, v32, v32, v29
    v_perm_b32 v10, v32, v32, v30
    v_perm_b32 v11, v32, v32, v31
    v_perm_b32 v4, v48, v48, v28
    v_perm_b32 v5, v48, v48, v29
    v_perm_b32 v6, v48, v48, v30
    v_perm_b32 v7, v48, v48, v31
    s_waitcnt vmcnt(11)
    v_mfma_f32_16x16x32_bf16 v[12:15], v[132:135], v[8:11], v[12:15]
    v_mfma_f32_16x16x32_bf16 v[68:71], v[132:135], v[4:7], v[68:71]
    buffer_load_dwordx4 v[180:183], v18, s[4:7], s32 offen nt
    s_add_u32 s32, s32, 8192
    v_perm_b32 v8, v33, v33, v24
    v_perm_b32 v9, v33, v33, v25
    v_perm_b32 v10, v33, v33, v26
    v_perm_b32 v11, v33, v33, v27
    v_perm_b32 v4, v49, v49, v24
    v_perm_b32 v5, v49, v49, v25
    v_perm_b32 v6, v49, v49, v26
    v_perm_b32 v7, v49, v49, v27
    s_waitcnt vmcnt(11)
    v_mfma_f32_16x16x32_bf16 v[12:15], v[136:139], v[8:11], v[12:15]
    v_mfma_f32_16x16x32_bf16 v[68:71], v[136:139], v[4:7], v[68:71]
    buffer_load_dwordx4 v[184:187], v18, s[4:7], s32 offen nt
    s_add_u32 s32, s32, 8192
    v_perm_b32 v8, v33, v33, v28
    v_perm_b32 v9, v33, v33, v29
    v_perm_b32 v10, v33, v33, v30
    v_perm_b32 v11, v33, v33, v31
    v_perm_b32 v4, v49, v49, v28
    v_perm_b32 v5, v49, v49, v29
    v_perm_b32 v6, v49, v49, v30
    v_perm_b32 v7, v49, v49, v31
    s_waitcnt vmcnt(11)
    v_mfma_f32_16x16x32_bf16 v[12:15], v[140:143], v[8:11], v[12:15]
    v_mfma_f32_16x16x32_bf16 v[68:71], v[140:143], v[4:7], v[68:71]
    buffer_load_dwordx4 v[188:191], v18, s[4:7], s32 offen nt
    s_add_u32 s32, s32, 8192
    v_perm_b32 v8, v34, v34, v24
    v_perm_b32 v9, v34, v34, v25
    v_perm_b32 v10, v34, v34, v26
    v_perm_b32 v11, v34, v34, v27
    v_perm_b32 v4, v50, v50, v24
    v_perm_b32 v5, v50, v50, v25
    v_perm_b32 v6, v50, v50, v26
    v_perm_b32 v7, v50, v50, v27
    s_waitcnt vmcnt(11)
    v_mfma_f32_16x16x32_bf16 v[12:15], v[144:147], v[8:11], v[12:15]
    v_mfma_f32_16x16x32_bf16 v[68:71], v[144:147], v[4:7], v[68:71]
    buffer_load_dwordx4 v[192:195], v18, s[4:7], s32 offen nt
    s_add_u32 s32, s32, 8192
    v_perm_b32 v8, v34, v34, v28
    v_perm_b32 v9, v34, v34, v29
    v_perm_b32 v10, v34, v34, v30
    v_perm_b32 v11, v34, v34, v31
    v_perm_b32 v4, v50, v50, v28
    v_perm_b32 v5, v50, v50, v29
    v_perm_b32 v6, v50, v50, v30
    v_perm_b32 v7, v50, v50, v31
    s_waitcnt vmcnt(11)
    v_mfma_f32_16x16x32_bf16 v[12:15], v[148:151], v[8:11], v[12:15]
    v_mfma_f32_16x16x32_bf16 v[68:71], v[148:151], v[4:7], v[68:71]
    buffer_load_dwordx4 v[196:199], v18, s[4:7], s32 offen nt
    s_add_u32 s32, s32, 8192
    v_perm_b32 v8, v35, v35, v24
    v_perm_b32 v9, v35, v35, v25
    v_perm_b32 v10, v35, v35, v26
    v_perm_b32 v11, v35, v35, v27
    v_perm_b32 v4, v51, v51, v24
    v_perm_b32 v5, v51, v51, v25
    v_perm_b32 v6, v51, v51, v26
    v_perm_b32 v7, v51, v51, v27
    s_waitcnt vmcnt(11)
    v_mfma_f32_16x16x32_bf16 v[12:15], v[152:155], v[8:11], v[12:15]
    v_mfma_f32_16x16x32_bf16 v[68:71], v[152:155], v[4:7], v[68:71]
    buffer_load_dwordx4 v[200:203], v18, s[4:7], s32 offen nt
    s_add_u32 s32, s32, 8192
    v_perm_b32 v8, v35, v35, v28
    v_perm_b32 v9, v35, v35, v29
    v_perm_b32 v10, v35, v35, v30
    v_perm_b32 v11, v35, v35, v31
    v_perm_b32 v4, v51, v51, v28
    v_perm_b32 v5, v51, v51, v29
    v_perm_b32 v6, v51, v51, v30
    v_perm_b32 v7, v51, v51, v31
    s_waitcnt vmcnt(11)
    v_mfma_f32_16x16x32_bf16 v[12:15], v[156:159], v[8:11], v[12:15]
    v_mfma_f32_16x16x32_bf16 v[68:71], v[156:159], v[4:7], v[68:71]
    buffer_load_dwordx4 v[204:207], v18, s[4:7], s32 offen nt
    s_add_u32 s32, s32, 8192
    v_perm_b32 v8, v36, v36, v24
    v_perm_b32 v9, v36, v36, v25
    v_perm_b32 v10, v36, v36, v26
    v_perm_b32 v11, v36, v36, v27
    v_perm_b32 v4, v52, v52, v24
    v_perm_b32 v5, v52, v52, v25
    v_perm_b32 v6, v52, v52, v26
    v_perm_b32 v7, v52, v52, v27
    s_waitcnt vmcnt(11)
    v_mfma_f32_16x16x32_bf16 v[12:15], v[160:163], v[8:11], v[12:15]
    v_mfma_f32_16x16x32_bf16 v[68:71], v[160:163], v[4:7], v[68:71]
    buffer_load_dwordx4 v[208:211], v18, s[4:7], s32 offen nt
    s_add_u32 s32, s32, 8192
    v_perm_b32 v8, v36, v36, v28
    v_perm_b32 v9, v36, v36, v29
    v_perm_b32 v10, v36, v36, v30
    v_perm_b32 v11, v36, v36, v31
    v_perm_b32 v4, v52, v52, v28
    v_perm_b32 v5, v52, v52, v29
    v_perm_b32 v6, v52, v52, v30
    v_perm_b32 v7, v52, v52, v31
    s_waitcnt vmcnt(11)
    v_mfma_f32_16x16x32_bf16 v[12:15], v[164:167], v[8:11], v[12:15]
    v_mfma_f32_16x16x32_bf16 v[68:71], v[164:167], v[4:7], v[68:71]
    buffer_load_dwordx4 v[212:215], v18, s[4:7], s32 offen nt
    s_add_u32 s32, s32, 8192
    v_perm_b32 v8, v37, v37, v24
    v_perm_b32 v9, v37, v37, v25
    v_perm_b32 v10, v37, v37, v26
    v_perm_b32 v11, v37, v37, v27
    v_perm_b32 v4, v53, v53, v24
    v_perm_b32 v5, v53, v53, v25
    v_perm_b32 v6, v53, v53, v26
    v_perm_b32 v7, v53, v53, v27
    s_waitcnt vmcnt(11)
    v_mfma_f32_16x16x32_bf16 v[12:15], v[168:171], v[8:11], v[12:15]
    v_mfma_f32_16x16x32_bf16 v[68:71], v[168:171], v[4:7], v[68:71]
    buffer_load_dwordx4 v[216:219], v18, s[4:7], s32 offen nt
    s_add_u32 s32, s32, 8192
    v_perm_b32 v8, v37, v37, v28
    v_perm_b32 v9, v37, v37, v29
    v_perm_b32 v10, v37, v37, v30
    v_perm_b32 v11, v37, v37, v31
    v_perm_b32 v4, v53, v53, v28
    v_perm_b32 v5, v53, v53, v29
    v_perm_b32 v6, v53, v53, v30
    v_perm_b32 v7, v53, v53, v31
    s_waitcnt vmcnt(11)
    v_mfma_f32_16x16x32_bf16 v[12:15], v[172:175], v[8:11], v[12:15]
    v_mfma_f32_16x16x32_bf16 v[68:71], v[172:175], v[4:7], v[68:71]
    buffer_load_dwordx4 v[220:223], v18, s[4:7], s32 offen nt
    s_add_u32 s32, s32, 8192
    v_perm_b32 v8, v38, v38, v24
    v_perm_b32 v9, v38, v38, v25
    v_perm_b32 v10, v38, v38, v26
    v_perm_b32 v11, v38, v38, v27
    v_perm_b32 v4, v54, v54, v24
    v_perm_b32 v5, v54, v54, v25
    v_perm_b32 v6, v54, v54, v26
    v_perm_b32 v7, v54, v54, v27
    s_waitcnt vmcnt(11)
    v_mfma_f32_16x16x32_bf16 v[12:15], v[176:179], v[8:11], v[12:15]
    v_mfma_f32_16x16x32_bf16 v[68:71], v[176:179], v[4:7], v[68:71]
    buffer_load_dwordx4 v[224:227], v18, s[4:7], s32 offen nt
    s_add_u32 s32, s32, 8192
    v_perm_b32 v8, v38, v38, v28
    v_perm_b32 v9, v38, v38, v29
    v_perm_b32 v10, v38, v38, v30
    v_perm_b32 v11, v38, v38, v31
    v_perm_b32 v4, v54, v54, v28
    v_perm_b32 v5, v54, v54, v29
    v_perm_b32 v6, v54, v54, v30
    v_perm_b32 v7, v54, v54, v31
    s_waitcnt vmcnt(11)
    v_mfma_f32_16x16x32_bf16 v[12:15], v[180:183], v[8:11], v[12:15]
    v_mfma_f32_16x16x32_bf16 v[68:71], v[180:183], v[4:7], v[68:71]
    buffer_load_dwordx4 v[228:231], v18, s[4:7], s32 offen nt
    s_add_u32 s32, s32, 8192
    v_perm_b32 v8, v39, v39, v24
    v_perm_b32 v9, v39, v39, v25
    v_perm_b32 v10, v39, v39, v26
    v_perm_b32 v11, v39, v39, v27
    v_perm_b32 v4, v55, v55, v24
    v_perm_b32 v5, v55, v55, v25
    v_perm_b32 v6, v55, v55, v26
    v_perm_b32 v7, v55, v55, v27
    s_waitcnt vmcnt(11)
    v_mfma_f32_16x16x32_bf16 v[12:15], v[184:187], v[8:11], v[12:15]
    v_mfma_f32_16x16x32_bf16 v[68:71], v[184:187], v[4:7], v[68:71]
    buffer_load_dwordx4 v[232:235], v18, s[4:7], s32 offen nt
    s_add_u32 s32, s32, 8192
    v_perm_b32 v8, v39, v39, v28
    v_perm_b32 v9, v39, v39, v29
    v_perm_b32 v10, v39, v39, v30
    v_perm_b32 v11, v39, v39, v31
    v_perm_b32 v4, v55, v55, v28
    v_perm_b32 v5, v55, v55, v29
    v_perm_b32 v6, v55, v55, v30
    v_perm_b32 v7, v55, v55, v31
    s_waitcnt vmcnt(11)
    v_mfma_f32_16x16x32_bf16 v[12:15], v[188:191], v[8:11], v[12:15]
    v_mfma_f32_16x16x32_bf16 v[68:71], v[188:191], v[4:7], v[68:71]
    buffer_load_dwordx4 v[236:239], v18, s[4:7], s32 offen nt
    s_add_u32 s32, s32, 8192
    v_perm_b32 v8, v40, v40, v24
    v_perm_b32 v9, v40, v40, v25
    v_perm_b32 v10, v40, v40, v26
    v_perm_b32 v11, v40, v40, v27
    v_perm_b32 v4, v56, v56, v24
    v_perm_b32 v5, v56, v56, v25
    v_perm_b32 v6, v56, v56, v26
    v_perm_b32 v7, v56, v56, v27
    s_waitcnt vmcnt(11)
    v_mfma_f32_16x16x32_bf16 v[12:15], v[192:195], v[8:11], v[12:15]
    v_mfma_f32_16x16x32_bf16 v[68:71], v[192:195], v[4:7], v[68:71]
    buffer_load_dwordx4 v[240:243], v18, s[4:7], s32 offen nt
    s_add_u32 s32, s32, 8192
    v_perm_b32 v8, v40, v40, v28
    v_perm_b32 v9, v40, v40, v29
    v_perm_b32 v10, v40, v40, v30
    v_perm_b32 v11, v40, v40, v31
    v_perm_b32 v4, v56, v56, v28
    v_perm_b32 v5, v56, v56, v29
    v_perm_b32 v6, v56, v56, v30
    v_perm_b32 v7, v56, v56, v31
    s_waitcnt vmcnt(11)
    v_mfma_f32_16x16x32_bf16 v[12:15], v[196:199], v[8:11], v[12:15]
    v_mfma_f32_16x16x32_bf16 v[68:71], v[196:199], v[4:7], v[68:71]
    buffer_load_dwordx4 v[244:247], v18, s[4:7], s32 offen nt
    s_add_u32 s32, s32, 8192
    v_perm_b32 v8, v41, v41, v24
    v_perm_b32 v9, v41, v41, v25
    v_perm_b32 v10, v41, v41, v26
    v_perm_b32 v11, v41, v41, v27
    v_perm_b32 v4, v57, v57, v24
    v_perm_b32 v5, v57, v57, v25
    v_perm_b32 v6, v57, v57, v26
    v_perm_b32 v7, v57, v57, v27
    s_waitcnt vmcnt(11)
    v_mfma_f32_16x16x32_bf16 v[12:15], v[200:203], v[8:11], v[12:15]
    v_mfma_f32_16x16x32_bf16 v[68:71], v[200:203], v[4:7], v[68:71]
    buffer_load_dwordx4 v[248:251], v18, s[4:7], s32 offen nt
    s_add_u32 s32, s32, 8192
    v_perm_b32 v8, v41, v41, v28
    v_perm_b32 v9, v41, v41, v29
    v_perm_b32 v10, v41, v41, v30
    v_perm_b32 v11, v41, v41, v31
    v_perm_b32 v4, v57, v57, v28
    v_perm_b32 v5, v57, v57, v29
    v_perm_b32 v6, v57, v57, v30
    v_perm_b32 v7, v57, v57, v31
    s_waitcnt vmcnt(11)
    v_mfma_f32_16x16x32_bf16 v[12:15], v[204:207], v[8:11], v[12:15]
    v_mfma_f32_16x16x32_bf16 v[68:71], v[204:207], v[4:7], v[68:71]
    buffer_load_dwordx4 v[252:255], v18, s[4:7], s32 offen nt
    s_add_u32 s32, s32, 8192
    v_perm_b32 v8, v42, v42, v24
    v_perm_b32 v9, v42, v42, v25
    v_perm_b32 v10, v42, v42, v26
    v_perm_b32 v11, v42, v42, v27
    v_perm_b32 v4, v58, v58, v24
    v_perm_b32 v5, v58, v58, v25
    v_perm_b32 v6, v58, v58, v26
    v_perm_b32 v7, v58, v58, v27
    s_waitcnt vmcnt(11)
    v_mfma_f32_16x16x32_bf16 v[12:15], v[208:211], v[8:11], v[12:15]
    v_mfma_f32_16x16x32_bf16 v[68:71], v[208:211], v[4:7], v[68:71]
    s_lshl_b32 s73, s74, 7
    s_add_u32 s73, s73, 0x170000
    s_cmp_lg_u32 s3, 0
    s_cbranch_scc1 L_A_nofl
    s_mov_b64 exec, 1
    buffer_store_dwordx4 v[76:79], off, s[12:15], s73 sc1
    s_mov_b64 exec, -1
L_A_nofl:
    s_cmp_ge_u32 s71, 0x1bf800
    s_cselect_b32 s71, 0x600000, s71
    buffer_store_dwordx4 v[76:79], v2, s[12:15], s71 offen sc1
    s_add_u32 s71, s71, 0x20000
    s_getpc_b64 s[24:25]
L_pc9:
    s_add_u32 s24, s24, L_A2-L_pc9
    s_addc_u32 s25, s25, 0
    v_lshl_add_u32 v16, v0, 2, s3
    v_lshlrev_b32 v16, 7, v16
    v_min_u32 v16, L_last-L_A2-4, v16
    v_mov_b32 v17, s25
    v_add_co_u32 v16, vcc, s24, v16
    s_nop 1
    v_addc_co_u32 v17, vcc, 0, v17, vcc
    global_load_dword v17, v[16:17], off
    s_mov_b32 s4, s42
    s_mov_b32 s5, s43
    s_mov_b32 s6, s75
    s_mov_b32 s32, s35
    buffer_load_dwordx4 v[128:131], v64, s[4:7], s32 offen nt
    s_add_u32 s32, s32, 8192
    v_perm_b32 v8, v42, v42, v28
    v_perm_b32 v9, v42, v42, v29
    v_perm_b32 v10, v42, v42, v30
    v_perm_b32 v11, v42, v42, v31
    v_perm_b32 v4, v58, v58, v28
    v_perm_b32 v5, v58, v58, v29
    v_perm_b32 v6, v58, v58, v30
    v_perm_b32 v7, v58, v58, v31
    s_waitcnt vmcnt(13)
    v_mfma_f32_16x16x32_bf16 v[12:15], v[212:215], v[8:11], v[12:15]
    v_mfma_f32_16x16x32_bf16 v[68:71], v[212:215], v[4:7], v[68:71]
    buffer_load_dwordx4 v[132:135], v64, s[4:7], s32 offen nt
    s_add_u32 s32, s32, 8192
    v_perm_b32 v8, v43, v43, v24
    v_perm_b32 v9, v43, v43, v25
    v_perm_b32 v10, v43, v43, v26
    v_perm_b32 v11, v43, v43, v27
    v_perm_b32 v4, v59, v59, v24
    v_perm_b32 v5, v59, v59, v25
    v_perm_b32 v6, v59, v59, v26
    v_perm_b32 v7, v59, v59, v27
    s_waitcnt vmcnt(13)
    v_mfma_f32_16x16x32_bf16 v[12:15], v[216:219], v[8:11], v[12:15]
    v_mfma_f32_16x16x32_bf16 v[68:71], v[216:219], v[4:7], v[68:71]
    buffer_load_dwordx4 v[136:139], v64, s[4:7], s32 offen nt
    s_add_u32 s32, s32, 8192
    v_perm_b32 v8, v43, v43, v28
    v_perm_b32 v9, v43, v43, v29
    v_perm_b32 v10, v43, v43, v30
    v_perm_b32 v11, v43, v43, v31
    v_perm_b32 v4, v59, v59, v28
    v_perm_b32 v5, v59, v59, v29
    v_perm_b32 v6, v59, v59, v30
    v_perm_b32 v7, v59, v59, v31
    s_waitcnt vmcnt(13)
    v_mfma_f32_16x16x32_bf16 v[12:15], v[220:223], v[8:11], v[12:15]
    v_mfma_f32_16x16x32_bf16 v[68:71], v[220:223], v[4:7], v[68:71]
    buffer_load_dwordx4 v[140:143], v64, s[4:7], s32 offen nt
    s_add_u32 s32, s32, 8192
    v_perm_b32 v8, v44, v44, v24
    v_perm_b32 v9, v44, v44, v25
    v_perm_b32 v10, v44, v44, v26
    v_perm_b32 v11, v44, v44, v27
    v_perm_b32 v4, v60, v60, v24
    v_perm_b32 v5, v60, v60, v25
    v_perm_b32 v6, v60, v60, v26
    v_perm_b32 v7, v60, v60, v27
    s_waitcnt vmcnt(13)
    v_mfma_f32_16x16x32_bf16 v[12:15], v[224:227], v[8:11], v[12:15]
    v_mfma_f32_16x16x32_bf16 v[68:71], v[224:227], v[4:7], v[68:71]
    buffer_load_dwordx4 v[144:147], v64, s[4:7], s32 offen nt
    s_add_u32 s32, s32, 8192
    v_perm_b32 v8, v44, v44, v28
    v_perm_b32 v9, v44, v44, v29
    v_perm_b32 v10, v44, v44, v30
    v_perm_b32 v11, v44, v44, v31
    v_perm_b32 v4, v60, v60, v28
    v_perm_b32 v5, v60, v60, v29
    v_perm_b32 v6, v60, v60, v30
    v_perm_b32 v7, v60, v60, v31
    s_waitcnt vmcnt(13)
    v_mfma_f32_16x16x32_bf16 v[12:15], v[228:231], v[8:11], v[12:15]
    v_mfma_f32_16x16x32_bf16 v[68:71], v[228:231], v[4:7], v[68:71]
    buffer_load_dwordx4 v[148:151], v64, s[4:7], s32 offen nt
    s_add_u32 s32, s32, 8192
    v_perm_b32 v8, v45, v45, v24
    v_perm_b32 v9, v45, v45, v25
    v_perm_b32 v10, v45, v45, v26
    v_perm_b32 v11, v45, v45, v27
    v_perm_b32 v4, v61, v61, v24
    v_perm_b32 v5, v61, v61, v25
    v_perm_b32 v6, v61, v61, v26
    v_perm_b32 v7, v61, v61, v27
    s_waitcnt vmcnt(13)
    v_mfma_f32_16x16x32_bf16 v[12:15], v[232:235], v[8:11], v[12:15]
    v_mfma_f32_16x16x32_bf16 v[68:71], v[232:235], v[4:7], v[68:71]
    buffer_load_dwordx4 v[152:155], v64, s[4:7], s32 offen nt
    s_add_u32 s32, s32, 8192
    v_perm_b32 v8, v45, v45, v28
    v_perm_b32 v9, v45, v45, v29
    v_perm_b32 v10, v45, v45, v30
    v_perm_b32 v11, v45, v45, v31
    v_perm_b32 v4, v61, v61, v28
    v_perm_b32 v5, v61, v61, v29
    v_perm_b32 v6, v61, v61, v30
    v_perm_b32 v7, v61, v61, v31
    s_waitcnt vmcnt(13)
    v_mfma_f32_16x16x32_bf16 v[12:15], v[236:239], v[8:11], v[12:15]
    v_mfma_f32_16x16x32_bf16 v[68:71], v[236:239], v[4:7], v[68:71]
    buffer_load_dwordx4 v[156:159], v64, s[4:7], s32 offen nt
    s_add_u32 s32, s32, 8192
    v_perm_b32 v8, v46, v46, v24
    v_perm_b32 v9, v46, v46, v25
    v_perm_b32 v10, v46, v46, v26
    v_perm_b32 v11, v46, v46, v27
    v_perm_b32 v4, v62, v62, v24
    v_perm_b32 v5, v62, v62, v25
    v_perm_b32 v6, v62, v62, v26
    v_perm_b32 v7, v62, v62, v27
    s_waitcnt vmcnt(13)
    v_mfma_f32_16x16x32_bf16 v[12:15], v[240:243], v[8:11], v[12:15]
    v_mfma_f32_16x16x32_bf16 v[68:71], v[240:243], v[4:7], v[68:71]
    buffer_load_dwordx4 v[160:163], v64, s[4:7], s32 offen nt
    s_add_u32 s32, s32, 8192
    v_perm_b32 v8, v46, v46, v28
    v_perm_b32 v9, v46, v46, v29
    v_perm_b32 v10, v46, v46, v30
    v_perm_b32 v11, v46, v46, v31
    v_perm_b32 v4, v62, v62, v28
    v_perm_b32 v5, v62, v62, v29
    v_perm_b32 v6, v62, v62, v30
    v_perm_b32 v7, v62, v62, v31
    s_waitcnt vmcnt(13)
    v_mfma_f32_16x16x32_bf16 v[12:15], v[244:247], v[8:11], v[12:15]
    v_mfma_f32_16x16x32_bf16 v[68:71], v[244:247], v[4:7], v[68:71]
    buffer_load_dwordx4 v[164:167], v64, s[4:7], s32 offen nt
    s_add_u32 s32, s32, 8192
    v_perm_b32 v8, v47, v47, v24
    v_perm_b32 v9, v47, v47, v25
    v_perm_b32 v10, v47, v47, v26
    v_perm_b32 v11, v47, v47, v27
    v_perm_b32 v4, v63, v63, v24
    v_perm_b32 v5, v63, v63, v25
    v_perm_b32 v6, v63, v63, v26
    v_perm_b32 v7, v63, v63, v27
    s_waitcnt vmcnt(13)
    v_mfma_f32_16x16x32_bf16 v[12:15], v[248:251], v[8:11], v[12:15]
    v_mfma_f32_16x16x32_bf16 v[68:71], v[248:251], v[4:7], v[68:71]
    buffer_load_dwordx4 v[168:171], v64, s[4:7], s32 offen nt
    s_add_u32 s32, s32, 8192
    v_perm_b32 v8, v47, v47, v28
    v_perm_b32 v9, v47, v47, v29
    v_perm_b32 v10, v47, v47, v30
    v_perm_b32 v11, v47, v47, v31
    v_perm_b32 v4, v63, v63, v28
    v_perm_b32 v5, v63, v63, v29
    v_perm_b32 v6, v63, v63, v30
    v_perm_b32 v7, v63, v63, v31
    s_waitcnt vmcnt(13)
    v_mfma_f32_16x16x32_bf16 v[12:15], v[252:255], v[8:11], v[12:15]
    v_mfma_f32_16x16x32_bf16 v[68:71], v[252:255], v[4:7], v[68:71]
    buffer_load_dwordx4 v[172:175], v64, s[4:7], s32 offen nt
    s_add_u32 s32, s32, 8192
    v_lshrrev_b32 v3, 4, v0
    v_lshlrev_b32 v3, 7, v3
    v_and_b32 v4, 7, v0
    v_lshl_add_u32 v3, v4, 2, v3
    v_bfe_u32 v4, v0, 3, 1
    v_lshl_add_u32 v3, v4, 9, v3
    s_lshl_b32 s24, s3, 11
    s_add_u32 s24, s24, 135168
    v_add_u32 v3, s24, v3
    ds_write_b32 v3, v12 offset:0
    ds_write_b32 v3, v13 offset:32
    ds_write_b32 v3, v14 offset:64
    ds_write_b32 v3, v15 offset:96
    ds_write_b32 v3, v68 offset:1024
    ds_write_b32 v3, v69 offset:1056
    ds_write_b32 v3, v70 offset:1088
    ds_write_b32 v3, v71 offset:1120
    s_waitcnt lgkmcnt(0)
    s_barrier
    ds_read_b128 v[72:75], v65 offset:0
    ds_read_b128 v[76:79], v65 offset:16
    ds_read_b128 v[80:83], v65 offset:2048
    ds_read_b128 v[84:87], v65 offset:2064
    ds_read_b128 v[88:91], v65 offset:4096
    ds_read_b128 v[92:95], v65 offset:4112
    ds_read_b128 v[96:99], v65 offset:6144
    ds_read_b128 v[100:103], v65 offset:6160
    s_waitcnt lgkmcnt(4)
    v_add_f32 v72, v72, v80
    v_add_f32 v73, v73, v81
    v_add_f32 v74, v74, v82
    v_add_f32 v75, v75, v83
    v_add_f32 v76, v76, v84
    v_add_f32 v77, v77, v85
    v_add_f32 v78, v78, v86
    v_add_f32 v79, v79, v87
    s_waitcnt lgkmcnt(2)
    v_add_f32 v72, v72, v88
    v_add_f32 v73, v73, v89
    v_add_f32 v74, v74, v90
    v_add_f32 v75, v75, v91
    v_add_f32 v76, v76, v92
    v_add_f32 v77, v77, v93
    v_add_f32 v78, v78, v94
    v_add_f32 v79, v79, v95
    s_waitcnt lgkmcnt(0)
    v_add_f32 v72, v72, v96
    v_add_f32 v73, v73, v97
    v_add_f32 v74, v74, v98
    v_add_f32 v75, v75, v99
    v_add_f32 v76, v76, v100
    v_add_f32 v77, v77, v101
    v_add_f32 v78, v78, v102
    v_add_f32 v79, v79, v103
    v_cvt_pk_bf16_f32 v8, v72, v73
    v_cvt_pk_bf16_f32 v9, v74, v75
    v_cvt_pk_bf16_f32 v10, v76, v77
    v_cvt_pk_bf16_f32 v11, v78, v79
    s_cmp_ge_u32 s74, 32
    s_cbranch_scc1 L_C
L_A2:
    buffer_load_dwordx4 v[176:179], v64, s[4:7], s32 offen nt
    s_add_u32 s32, s32, 8192
    buffer_load_dwordx4 v[180:183], v64, s[4:7], s32 offen nt
    s_add_u32 s32, s32, 8192
    buffer_load_dwordx4 v[184:187], v64, s[4:7], s32 offen nt
    s_add_u32 s32, s32, 8192
    buffer_load_dwordx4 v[188:191], v64, s[4:7], s32 offen nt
    s_add_u32 s32, s32, 8192
    buffer_load_dwordx4 v[192:195], v64, s[4:7], s32 offen nt
    s_add_u32 s32, s32, 8192
    buffer_load_dwordx4 v[196:199], v64, s[4:7], s32 offen nt
    s_add_u32 s32, s32, 8192
    buffer_load_dwordx4 v[200:203], v64, s[4:7], s32 offen nt
    s_add_u32 s32, s32, 8192
    buffer_load_dwordx4 v[204:207], v64, s[4:7], s32 offen nt
    s_add_u32 s32, s32, 8192
    buffer_load_dwordx4 v[208:211], v64, s[4:7], s32 offen nt
    s_add_u32 s32, s32, 8192
    buffer_load_dwordx4 v[212:215], v64, s[4:7], s32 offen nt
    s_add_u32 s32, s32, 8192
    buffer_load_dwordx4 v[216:219], v64, s[4:7], s32 offen nt
    s_add_u32 s32, s32, 8192
    buffer_load_dwordx4 v[220:223], v64, s[4:7], s32 offen nt
    s_add_u32 s32, s32, 8192
    buffer_load_dwordx4 v[224:227], v64, s[4:7], s32 offen nt
    s_add_u32 s32, s32, 8192
    buffer_load_dwordx4 v[228:231], v64, s[4:7], s32 offen nt
    s_add_u32 s32, s32, 8192
    buffer_load_dwordx4 v[232:235], v64, s[4:7], s32 offen nt
    s_add_u32 s32, s32, 8192
    buffer_load_dwordx4 v[236:239], v64, s[4:7], s32 offen nt
    s_add_u32 s32, s32, 8192
    buffer_load_dwordx4 v[240:243], v64, s[4:7], s32 offen nt
    s_add_u32 s32, s32, 8192
    buffer_load_dwordx4 v[244:247], v64, s[4:7], s32 offen nt
    s_add_u32 s32, s32, 8192
    buffer_load_dwordx4 v[248:251], v64, s[4:7], s32 offen nt
    s_add_u32 s32, s32, 8192
    buffer_load_dwordx4 v[252:255], v64, s[4:7], s32 offen nt
    s_add_u32 s32, s32, 8192
    s_waitcnt vmcnt(31)
    v_mfma_f32_16x16x32_bf16 v[80:83], v[128:131], v[8:11], 0
    s_waitcnt vmcnt(30)
    v_mfma_f32_16x16x32_bf16 v[84:87], v[132:135], v[8:11], 0
    s_waitcnt vmcnt(29)
    v_mfma_f32_16x16x32_bf16 v[88:91], v[136:139], v[8:11], 0
    s_waitcnt vmcnt(28)
    v_mfma_f32_16x16x32_bf16 v[92:95], v[140:143], v[8:11], 0
    s_waitcnt vmcnt(27)
    v_mfma_f32_16x16x32_bf16 v[96:99], v[144:147], v[8:11], 0
    s_waitcnt vmcnt(26)
    v_mfma_f32_16x16x32_bf16 v[100:103], v[148:151], v[8:11], 0
    s_waitcnt vmcnt(25)
    v_mfma_f32_16x16x32_bf16 v[104:107], v[152:155], v[8:11], 0
    s_waitcnt vmcnt(24)
    v_mfma_f32_16x16x32_bf16 v[108:111], v[156:159], v[8:11], 0
    v_add_f32_dpp v72, v81, v80 quad_perm:[1,1,1,1] row_mask:0xf bank_mask:0xf
    v_add_f32_dpp v73, v85, v84 quad_perm:[1,1,1,1] row_mask:0xf bank_mask:0xf
    v_add_f32_dpp v74, v89, v88 quad_perm:[1,1,1,1] row_mask:0xf bank_mask:0xf
    v_add_f32_dpp v75, v93, v92 quad_perm:[1,1,1,1] row_mask:0xf bank_mask:0xf
    v_add_f32_dpp v76, v97, v96 quad_perm:[1,1,1,1] row_mask:0xf bank_mask:0xf
    v_add_f32_dpp v77, v101, v100 quad_perm:[1,1,1,1] row_mask:0xf bank_mask:0xf
    v_add_f32_dpp v78, v105, v104 quad_perm:[1,1,1,1] row_mask:0xf bank_mask:0xf
    s_nop 0
    v_add_f32_dpp v79, v109, v108 quad_perm:[1,1,1,1] row_mask:0xf bank_mask:0xf
    v_add_f32_dpp v72, v82, v72 quad_perm:[2,2,2,2] row_mask:0xf bank_mask:0xf
    v_add_f32_dpp v73, v86, v73 quad_perm:[2,2,2,2] row_mask:0xf bank_mask:0xf
    v_add_f32_dpp v74, v90, v74 quad_perm:[2,2,2,2] row_mask:0xf bank_mask:0xf
    v_add_f32_dpp v75, v94, v75 quad_perm:[2,2,2,2] row_mask:0xf bank_mask:0xf
    v_add_f32_dpp v76, v98, v76 quad_perm:[2,2,2,2] row_mask:0xf bank_mask:0xf
    v_add_f32_dpp v77, v102, v77 quad_perm:[2,2,2,2] row_mask:0xf bank_mask:0xf
    v_add_f32_dpp v78, v106, v78 quad_perm:[2,2,2,2] row_mask:0xf bank_mask:0xf
    v_add_f32_dpp v79, v110, v79 quad_perm:[2,2,2,2] row_mask:0xf bank_mask:0xf
    v_add_f32_dpp v72, v83, v72 quad_perm:[3,3,3,3] row_mask:0xf bank_mask:0xf
    v_add_f32_dpp v73, v87, v73 quad_perm:[3,3,3,3] row_mask:0xf bank_mask:0xf
    v_add_f32_dpp v74, v91, v74 quad_perm:[3,3,3,3] row_mask:0xf bank_mask:0xf
    v_add_f32_dpp v75, v95, v75 quad_perm:[3,3,3,3] row_mask:0xf bank_mask:0xf
    v_add_f32_dpp v76, v99, v76 quad_perm:[3,3,3,3] row_mask:0xf bank_mask:0xf
    v_add_f32_dpp v77, v103, v77 quad_perm:[3,3,3,3] row_mask:0xf bank_mask:0xf
    v_add_f32_dpp v78, v107, v78 quad_perm:[3,3,3,3] row_mask:0xf bank_mask:0xf
    v_add_f32_dpp v79, v111, v79 quad_perm:[3,3,3,3] row_mask:0xf bank_mask:0xf
    s_waitcnt vmcnt(23)
    v_mfma_f32_16x16x32_bf16 v[80:83], v[160:163], v[8:11], 0
    s_waitcnt vmcnt(22)
    v_mfma_f32_16x16x32_bf16 v[84:87], v[164:167], v[8:11], 0
    s_waitcnt vmcnt(21)
    v_mfma_f32_16x16x32_bf16 v[88:91], v[168:171], v[8:11], 0
    s_waitcnt vmcnt(20)
    v_mfma_f32_16x16x32_bf16 v[92:95], v[172:175], v[8:11], 0
    s_waitcnt vmcnt(19)
    v_mfma_f32_16x16x32_bf16 v[96:99], v[176:179], v[8:11], 0
    s_waitcnt vmcnt(18)
    v_mfma_f32_16x16x32_bf16 v[100:103], v[180:183], v[8:11], 0
    s_waitcnt vmcnt(17)
    v_mfma_f32_16x16x32_bf16 v[104:107], v[184:187], v[8:11], 0
    s_waitcnt vmcnt(16)
    v_mfma_f32_16x16x32_bf16 v[108:111], v[188:191], v[8:11], 0
    v_add_f32_dpp v112, v80, v81 quad_perm:[0,0,0,0] row_mask:0xf bank_mask:0xf
    v_add_f32_dpp v113, v84, v85 quad_perm:[0,0,0,0] row_mask:0xf bank_mask:0xf
    v_add_f32_dpp v114, v88, v89 quad_perm:[0,0,0,0] row_mask:0xf bank_mask:0xf
    v_add_f32_dpp v115, v92, v93 quad_perm:[0,0,0,0] row_mask:0xf bank_mask:0xf
    v_add_f32_dpp v116, v96, v97 quad_perm:[0,0,0,0] row_mask:0xf bank_mask:0xf
    v_add_f32_dpp v117, v100, v101 quad_perm:[0,0,0,0] row_mask:0xf bank_mask:0xf
    v_add_f32_dpp v118, v104, v105 quad_perm:[0,0,0,0] row_mask:0xf bank_mask:0xf
    s_nop 0
    v_add_f32_dpp v119, v108, v109 quad_perm:[0,0,0,0] row_mask:0xf bank_mask:0xf
    v_add_f32_dpp v112, v82, v112 quad_perm:[2,2,2,2] row_mask:0xf bank_mask:0xf
    v_add_f32_dpp v113, v86, v113 quad_perm:[2,2,2,2] row_mask:0xf bank_mask:0xf
    v_add_f32_dpp v114, v90, v114 quad_perm:[2,2,2,2] row_mask:0xf bank_mask:0xf
    v_add_f32_dpp v115, v94, v115 quad_perm:[2,2,2,2] row_mask:0xf bank_mask:0xf
    v_add_f32_dpp v116, v98, v116 quad_perm:[2,2,2,2] row_mask:0xf bank_mask:0xf
    v_add_f32_dpp v117, v102, v117 quad_perm:[2,2,2,2] row_mask:0xf bank_mask:0xf
    v_add_f32_dpp v118, v106, v118 quad_perm:[2,2,2,2] row_mask:0xf bank_mask:0xf
    v_add_f32_dpp v119, v110, v119 quad_perm:[2,2,2,2] row_mask:0xf bank_mask:0xf
    v_add_f32_dpp v112, v83, v112 quad_perm:[3,3,3,3] row_mask:0xf bank_mask:0xf
    v_add_f32_dpp v113, v87, v113 quad_perm:[3,3,3,3] row_mask:0xf bank_mask:0xf
    v_add_f32_dpp v114, v91, v114 quad_perm:[3,3,3,3] row_mask:0xf bank_mask:0xf
    v_add_f32_dpp v115, v95, v115 quad_perm:[3,3,3,3] row_mask:0xf bank_mask:0xf
    v_add_f32_dpp v116, v99, v116 quad_perm:[3,3,3,3] row_mask:0xf bank_mask:0xf
    v_add_f32_dpp v117, v103, v117 quad_perm:[3,3,3,3] row_mask:0xf bank_mask:0xf
    v_add_f32_dpp v118, v107, v118 quad_perm:[3,3,3,3] row_mask:0xf bank_mask:0xf
    v_add_f32_dpp v119, v111, v119 quad_perm:[3,3,3,3] row_mask:0xf bank_mask:0xf
    v_cndmask_b32 v72, v72, v112, s[64:65]
    v_cndmask_b32 v73, v73, v113, s[64:65]
    v_cndmask_b32 v74, v74, v114, s[64:65]
    v_cndmask_b32 v75, v75, v115, s[64:65]
    v_cndmask_b32 v76, v76, v116, s[64:65]
    v_cndmask_b32 v77, v77, v117, s[64:65]
    v_cndmask_b32 v78, v78, v118, s[64:65]
    v_cndmask_b32 v79, v79, v119, s[64:65]
    s_waitcnt vmcnt(15)
    v_mfma_f32_16x16x32_bf16 v[80:83], v[192:195], v[8:11], 0
    s_waitcnt vmcnt(14)
    v_mfma_f32_16x16x32_bf16 v[84:87], v[196:199], v[8:11], 0
    s_waitcnt vmcnt(13)
    v_mfma_f32_16x16x32_bf16 v[88:91], v[200:203], v[8:11], 0
    s_waitcnt vmcnt(12)
    v_mfma_f32_16x16x32_bf16 v[92:95], v[204:207], v[8:11], 0
    s_waitcnt vmcnt(11)
    v_mfma_f32_16x16x32_bf16 v[96:99], v[208:211], v[8:11], 0
    s_waitcnt vmcnt(10)
    v_mfma_f32_16x16x32_bf16 v[100:103], v[212:215], v[8:11], 0
    s_waitcnt vmcnt(9)
    v_mfma_f32_16x16x32_bf16 v[104:107], v[216:219], v[8:11], 0
    s_waitcnt vmcnt(8)
    v_mfma_f32_16x16x32_bf16 v[108:111], v[220:223], v[8:11], 0
    v_add_f32_dpp v112, v80, v82 quad_perm:[0,0,0,0] row_mask:0xf bank_mask:0xf
    v_add_f32_dpp v113, v84, v86 quad_perm:[0,0,0,0] row_mask:0xf bank_mask:0xf
    v_add_f32_dpp v114, v88, v90 quad_perm:[0,0,0,0] row_mask:0xf bank_mask:0xf
    v_add_f32_dpp v115, v92, v94 quad_perm:[0,0,0,0] row_mask:0xf bank_mask:0xf
    v_add_f32_dpp v116, v96, v98 quad_perm:[0,0,0,0] row_mask:0xf bank_mask:0xf
    v_add_f32_dpp v117, v100, v102 quad_perm:[0,0,0,0] row_mask:0xf bank_mask:0xf
    v_add_f32_dpp v118, v104, v106 quad_perm:[0,0,0,0] row_mask:0xf bank_mask:0xf
    s_nop 0
    v_add_f32_dpp v119, v108, v110 quad_perm:[0,0,0,0] row_mask:0xf bank_mask:0xf
    v_add_f32_dpp v112, v81, v112 quad_perm:[1,1,1,1] row_mask:0xf bank_mask:0xf
    v_add_f32_dpp v113, v85, v113 quad_perm:[1,1,1,1] row_mask:0xf bank_mask:0xf
    v_add_f32_dpp v114, v89, v114 quad_perm:[1,1,1,1] row_mask:0xf bank_mask:0xf
    v_add_f32_dpp v115, v93, v115 quad_perm:[1,1,1,1] row_mask:0xf bank_mask:0xf
    v_add_f32_dpp v116, v97, v116 quad_perm:[1,1,1,1] row_mask:0xf bank_mask:0xf
    v_add_f32_dpp v117, v101, v117 quad_perm:[1,1,1,1] row_mask:0xf bank_mask:0xf
    v_add_f32_dpp v118, v105, v118 quad_perm:[1,1,1,1] row_mask:0xf bank_mask:0xf
    v_add_f32_dpp v119, v109, v119 quad_perm:[1,1,1,1] row_mask:0xf bank_mask:0xf
    v_add_f32_dpp v112, v83, v112 quad_perm:[3,3,3,3] row_mask:0xf bank_mask:0xf
    v_add_f32_dpp v113, v87, v113 quad_perm:[3,3,3,3] row_mask:0xf bank_mask:0xf
    v_add_f32_dpp v114, v91, v114 quad_perm:[3,3,3,3] row_mask:0xf bank_mask:0xf
    v_add_f32_dpp v115, v95, v115 quad_perm:[3,3,3,3] row_mask:0xf bank_mask:0xf
    v_add_f32_dpp v116, v99, v116 quad_perm:[3,3,3,3] row_mask:0xf bank_mask:0xf
    v_add_f32_dpp v117, v103, v117 quad_perm:[3,3,3,3] row_mask:0xf bank_mask:0xf
    v_add_f32_dpp v118, v107, v118 quad_perm:[3,3,3,3] row_mask:0xf bank_mask:0xf
    v_add_f32_dpp v119, v111, v119 quad_perm:[3,3,3,3] row_mask:0xf bank_mask:0xf
    v_cndmask_b32 v72, v72, v112, s[66:67]
    v_cndmask_b32 v73, v73, v113, s[66:67]
    v_cndmask_b32 v74, v74, v114, s[66:67]
    v_cndmask_b32 v75, v75, v115, s[66:67]
    v_cndmask_b32 v76, v76, v116, s[66:67]
    v_cndmask_b32 v77, v77, v117, s[66:67]
    v_cndmask_b32 v78, v78, v118, s[66:67]
    v_cndmask_b32 v79, v79, v119, s[66:67]
    s_waitcnt vmcnt(7)
    v_mfma_f32_16x16x32_bf16 v[80:83], v[224:227], v[8:11], 0
    s_waitcnt vmcnt(6)
    v_mfma_f32_16x16x32_bf16 v[84:87], v[228:231], v[8:11], 0
    s_waitcnt vmcnt(5)
    v_mfma_f32_16x16x32_bf16 v[88:91], v[232:235], v[8:11], 0
    s_waitcnt vmcnt(4)
    v_mfma_f32_16x16x32_bf16 v[92:95], v[236:239], v[8:11], 0
    s_waitcnt vmcnt(3)
    v_mfma_f32_16x16x32_bf16 v[96:99], v[240:243], v[8:11], 0
    s_waitcnt vmcnt(2)
    v_mfma_f32_16x16x32_bf16 v[100:103], v[244:247], v[8:11], 0
    s_waitcnt vmcnt(1)
    v_mfma_f32_16x16x32_bf16 v[104:107], v[248:251], v[8:11], 0
    s_waitcnt vmcnt(0)
    v_mfma_f32_16x16x32_bf16 v[108:111], v[252:255], v[8:11], 0
    v_add_f32_dpp v112, v80, v83 quad_perm:[0,0,0,0] row_mask:0xf bank_mask:0xf
    v_add_f32_dpp v113, v84, v87 quad_perm:[0,0,0,0] row_mask:0xf bank_mask:0xf
    v_add_f32_dpp v114, v88, v91 quad_perm:[0,0,0,0] row_mask:0xf bank_mask:0xf
    v_add_f32_dpp v115, v92, v95 quad_perm:[0,0,0,0] row_mask:0xf bank_mask:0xf
    v_add_f32_dpp v116, v96, v99 quad_perm:[0,0,0,0] row_mask:0xf bank_mask:0xf
    v_add_f32_dpp v117, v100, v103 quad_perm:[0,0,0,0] row_mask:0xf bank_mask:0xf
    v_add_f32_dpp v118, v104, v107 quad_perm:[0,0,0,0] row_mask:0xf bank_mask:0xf
    s_nop 0
    v_add_f32_dpp v119, v108, v111 quad_perm:[0,0,0,0] row_mask:0xf bank_mask:0xf
    v_add_f32_dpp v112, v81, v112 quad_perm:[1,1,1,1] row_mask:0xf bank_mask:0xf
    v_add_f32_dpp v113, v85, v113 quad_perm:[1,1,1,1] row_mask:0xf bank_mask:0xf
    v_add_f32_dpp v114, v89, v114 quad_perm:[1,1,1,1] row_mask:0xf bank_mask:0xf
    v_add_f32_dpp v115, v93, v115 quad_perm:[1,1,1,1] row_mask:0xf bank_mask:0xf
    v_add_f32_dpp v116, v97, v116 quad_perm:[1,1,1,1] row_mask:0xf bank_mask:0xf
    v_add_f32_dpp v117, v101, v117 quad_perm:[1,1,1,1] row_mask:0xf bank_mask:0xf
    v_add_f32_dpp v118, v105, v118 quad_perm:[1,1,1,1] row_mask:0xf bank_mask:0xf
    v_add_f32_dpp v119, v109, v119 quad_perm:[1,1,1,1] row_mask:0xf bank_mask:0xf
    v_add_f32_dpp v112, v82, v112 quad_perm:[2,2,2,2] row_mask:0xf bank_mask:0xf
    v_add_f32_dpp v113, v86, v113 quad_perm:[2,2,2,2] row_mask:0xf bank_mask:0xf
    v_add_f32_dpp v114, v90, v114 quad_perm:[2,2,2,2] row_mask:0xf bank_mask:0xf
    v_add_f32_dpp v115, v94, v115 quad_perm:[2,2,2,2] row_mask:0xf bank_mask:0xf
    v_add_f32_dpp v116, v98, v116 quad_perm:[2,2,2,2] row_mask:0xf bank_mask:0xf
    v_add_f32_dpp v117, v102, v117 quad_perm:[2,2,2,2] row_mask:0xf bank_mask:0xf
    v_add_f32_dpp v118, v106, v118 quad_perm:[2,2,2,2] row_mask:0xf bank_mask:0xf
    v_add_f32_dpp v119, v110, v119 quad_perm:[2,2,2,2] row_mask:0xf bank_mask:0xf
    v_cndmask_b32 v72, v72, v112, s[68:69]
    v_cndmask_b32 v73, v73, v113, s[68:69]
    v_cndmask_b32 v74, v74, v114, s[68:69]
    v_cndmask_b32 v75, v75, v115, s[68:69]
    v_cndmask_b32 v76, v76, v116, s[68:69]
    v_cndmask_b32 v77, v77, v117, s[68:69]
    v_cndmask_b32 v78, v78, v118, s[68:69]
    v_cndmask_b32 v79, v79, v119, s[68:69]
    s_mov_b32 s71, 0x3e0293ee
    v_mul_f32 v72, s71, v72
    v_mul_f32 v73, s71, v73
    v_mul_f32 v74, s71, v74
    v_mul_f32 v75, s71, v75
    v_mul_f32 v76, s71, v76
    v_mul_f32 v77, s71, v77
    v_mul_f32 v78, s71, v78
    v_mul_f32 v79, s71, v79
    v_cvt_pk_bf16_f32 v4, v72, v73
    v_cvt_pk_bf16_f32 v5, v74, v75
    v_cvt_pk_bf16_f32 v6, v76, v77
    v_cvt_pk_bf16_f32 v7, v78, v79
    s_lshl_b32 s24, s26, 12
    s_lshl_b32 s25, s3, 8
    s_add_u32 s24, s24, s25
    s_add_u32 s24, s24, 0x0
    buffer_store_dwordx4 v[4:7], v66, s[12:15], s24 offen sc1
    s_mov_b32 s8, s56
    s_mov_b32 s9, s57
    s_mov_b32 s10, 0x400000
    s_mov_b32 s11, 0x20000
    s_and_b32 s24, s3, 1
    s_lshl_b32 s24, s24, 1
    s_and_b32 s25, s3, 2
    s_lshl_b32 s25, s25, 3
    s_or_b32 s25, s25, s24
    s_and_b32 s24, s26, 13
    s_or_b32 s25, s25, s24
    s_lshl_b32 s25, s25, 17
    s_lshr_b32 s24, s74, 3
    s_lshl_b32 s24, s24, 7
    s_add_u32 s24, s24, s25
    v_lshrrev_b32 v3, 4, v0
    v_lshlrev_b32 v3, 15, v3
    v_and_b32 v4, 8, v0
    v_lshl_add_u32 v3, v4, 10, v3
    v_and_b32 v4, 0x70, v2
    v_add_u32 v3, v3, v4
    s_mul_i32 m0, s3, 16896
    s_nop 0
    buffer_load_dwordx4 v3, s[8:11], s24 offen nt lds
    s_add_u32 m0, m0, 1056
    s_add_u32 s24, s24, 2048
    buffer_load_dwordx4 v3, s[8:11], s24 offen nt lds
    s_add_u32 m0, m0, 1056
    s_add_u32 s24, s24, 2048
    buffer_load_dwordx4 v3, s[8:11], s24 offen nt lds
    s_add_u32 m0, m0, 1056
    s_add_u32 s24, s24, 2048
    buffer_load_dwordx4 v3, s[8:11], s24 offen nt lds
    s_add_u32 m0, m0, 1056
    s_add_u32 s24, s24, 10240
    buffer_load_dwordx4 v3, s[8:11], s24 offen nt lds
    s_add_u32 m0, m0, 1056
    s_add_u32 s24, s24, 2048
    buffer_load_dwordx4 v3, s[8:11], s24 offen nt lds
    s_add_u32 m0, m0, 1056
    s_add_u32 s24, s24, 2048
    buffer_load_dwordx4 v3, s[8:11], s24 offen nt lds
    s_add_u32 m0, m0, 1056
    s_add_u32 s24, s24, 2048
    buffer_load_dwordx4 v3, s[8:11], s24 offen nt lds
    s_add_u32 m0, m0, 1056
    s_add_u32 s24, s24, -21504
    buffer_load_dwordx4 v3, s[8:11], s24 offen nt lds
    s_add_u32 m0, m0, 1056
    s_add_u32 s24, s24, 2048
    buffer_load_dwordx4 v3, s[8:11], s24 offen nt lds
    s_add_u32 m0, m0, 1056
    s_add_u32 s24, s24, 2048
    buffer_load_dwordx4 v3, s[8:11], s24 offen nt lds
    s_add_u32 m0, m0, 1056
    s_add_u32 s24, s24, 2048
    buffer_load_dwordx4 v3, s[8:11], s24 offen nt lds
    s_add_u32 m0, m0, 1056
    s_add_u32 s24, s24, 10240
    buffer_load_dwordx4 v3, s[8:11], s24 offen nt lds
    s_add_u32 m0, m0, 1056
    s_add_u32 s24, s24, 2048
    buffer_load_dwordx4 v3, s[8:11], s24 offen nt lds
    s_add_u32 m0, m0, 1056
    s_add_u32 s24, s24, 2048
    buffer_load_dwordx4 v3, s[8:11], s24 offen nt lds
    s_add_u32 m0, m0, 1056
    s_add_u32 s24, s24, 2048
    buffer_load_dwordx4 v3, s[8:11], s24 offen nt lds
    s_waitcnt vmcnt(0)
    s_barrier
    s_cmp_lg_u32 s3, 0
    s_cbranch_scc1 L_sig10
    s_mov_b64 exec, 1
    v_mov_b32 v3, 1
    buffer_atomic_add v3, off, s[16:19], 0 offset:0 sc0
    s_waitcnt vmcnt(0)
    v_readfirstlane_b32 s24, v3
    s_mov_b64 exec, -1
    s_and_b32 s24, s24, 63
    s_cmp_lg_u32 s24, 63
    s_cbranch_scc1 L_sig10
    v_lshlrev_b32 v4, 7, v0
    v_mov_b32 v3, 1
    s_mov_b32 s24, 0x170000
    buffer_store_dword v3, v4, s[12:15], s24 offen offset:0 sc1
L_sig10:
    v_lshrrev_b32 v3, 2, v0
    v_mul_u32_u24 v3, 1056, v3
    v_and_b32 v4, 3, v0
    v_lshl_add_u32 v3, v4, 3, v3
    s_lshl_b32 s24, s3, 5
    v_add_u32 v3, s24, v3
    ds_read_b64_tr_b16 a[128:129], v3 offset:0
    ds_read_b64_tr_b16 a[130:131], v3 offset:128
    ds_read_b64_tr_b16 a[132:133], v3 offset:256
    ds_read_b64_tr_b16 a[134:135], v3 offset:384
    ds_read_b64_tr_b16 a[136:137], v3 offset:512
    ds_read_b64_tr_b16 a[138:139], v3 offset:640
    ds_read_b64_tr_b16 a[140:141], v3 offset:768
    ds_read_b64_tr_b16 a[142:143], v3 offset:896
    ds_read_b64_tr_b16 a[144:145], v3 offset:16896
    ds_read_b64_tr_b16 a[146:147], v3 offset:17024
    ds_read_b64_tr_b16 a[148:149], v3 offset:17152
    ds_read_b64_tr_b16 a[150:151], v3 offset:17280
    ds_read_b64_tr_b16 a[152:153], v3 offset:17408
    ds_read_b64_tr_b16 a[154:155], v3 offset:17536
    ds_read_b64_tr_b16 a[156:157], v3 offset:17664
    ds_read_b64_tr_b16 a[158:159], v3 offset:17792
    ds_read_b64_tr_b16 a[160:161], v3 offset:33792
    ds_read_b64_tr_b16 a[162:163], v3 offset:33920
    ds_read_b64_tr_b16 a[164:165], v3 offset:34048
    ds_read_b64_tr_b16 a[166:167], v3 offset:34176
    ds_read_b64_tr_b16 a[168:169], v3 offset:34304
    ds_read_b64_tr_b16 a[170:171], v3 offset:34432
    ds_read_b64_tr_b16 a[172:173], v3 offset:34560
    ds_read_b64_tr_b16 a[174:175], v3 offset:34688
    ds_read_b64_tr_b16 a[176:177], v3 offset:50688
    ds_read_b64_tr_b16 a[178:179], v3 offset:50816
    ds_read_b64_tr_b16 a[180:181], v3 offset:50944
    ds_read_b64_tr_b16 a[182:183], v3 offset:51072
    ds_read_b64_tr_b16 a[184:185], v3 offset:51200
    ds_read_b64_tr_b16 a[186:187], v3 offset:51328
    ds_read_b64_tr_b16 a[188:189], v3 offset:51456
    ds_read_b64_tr_b16 a[190:191], v3 offset:51584
    s_mov_b32 s4, s44
    s_mov_b32 s5, s45
    s_mov_b32 s6, 0x400000
    s_mov_b32 s7, 0x20000
    s_mov_b32 s8, s46
    s_mov_b32 s9, s47
    s_mov_b32 s10, 0x400000
    s_mov_b32 s11, 0x20000
    s_mov_b32 s32, s35
    buffer_load_dwordx4 v[128:131], v18, s[4:7], s32 offen nt
    s_add_u32 s32, s32, 8192
    buffer_load_dwordx4 v[132:135], v18, s[4:7], s32 offen nt
    s_add_u32 s32, s32, 8192
    buffer_load_dwordx4 v[136:139], v18, s[4:7], s32 offen nt
    s_add_u32 s32, s32, 8192
    buffer_load_dwordx4 v[140:143], v18, s[4:7], s32 offen nt
    s_add_u32 s32, s32, 8192
    buffer_load_dwordx4 v[144:147], v18, s[4:7], s32 offen nt
    s_add_u32 s32, s32, 8192
    buffer_load_dwordx4 v[148:151], v18, s[4:7], s32 offen nt
    s_add_u32 s32, s32, 8192
    buffer_load_dwordx4 v[152:155], v18, s[4:7], s32 offen nt
    s_add_u32 s32, s32, 8192
    buffer_load_dwordx4 v[156:159], v18, s[4:7], s32 offen nt
    s_add_u32 s32, s32, 8192
    buffer_load_dwordx4 v[160:163], v18, s[4:7], s32 offen nt
    s_add_u32 s32, s32, 8192
    buffer_load_dwordx4 v[164:167], v18, s[4:7], s32 offen nt
    s_add_u32 s32, s32, 8192
    buffer_load_dwordx4 v[168:171], v18, s[4:7], s32 offen nt
    s_add_u32 s32, s32, 8192
    buffer_load_dwordx4 v[172:175], v18, s[4:7], s32 offen nt
    s_add_u32 s32, s32, 8192
    buffer_load_dwordx4 v[176:179], v18, s[4:7], s32 offen nt
    s_add_u32 s32, s32, 8192
    buffer_load_dwordx4 v[180:183], v18, s[4:7], s32 offen nt
    s_add_u32 s32, s32, 8192
    buffer_load_dwordx4 v[184:187], v18, s[4:7], s32 offen nt
    s_add_u32 s32, s32, 8192
    buffer_load_dwordx4 v[188:191], v18, s[4:7], s32 offen nt
    s_add_u32 s32, s32, 8192
    buffer_load_dwordx4 v[192:195], v18, s[4:7], s32 offen nt
    s_add_u32 s32, s32, 8192
    buffer_load_dwordx4 v[196:199], v18, s[4:7], s32 offen nt
    s_add_u32 s32, s32, 8192
    buffer_load_dwordx4 v[200:203], v18, s[4:7], s32 offen nt
    s_add_u32 s32, s32, 8192
    buffer_load_dwordx4 v[204:207], v18, s[4:7], s32 offen nt
    s_add_u32 s32, s32, 8192
    buffer_load_dwordx4 v[208:211], v18, s[4:7], s32 offen nt
    s_add_u32 s32, s32, 8192
    buffer_load_dwordx4 v[212:215], v18, s[4:7], s32 offen nt
    s_add_u32 s32, s32, 8192
    buffer_load_dwordx4 v[216:219], v18, s[4:7], s32 offen nt
    s_add_u32 s32, s32, 8192
    buffer_load_dwordx4 v[220:223], v18, s[4:7], s32 offen nt
    s_add_u32 s32, s32, 8192
    buffer_load_dwordx4 v[224:227], v18, s[4:7], s32 offen nt
    s_add_u32 s32, s32, 8192
    buffer_load_dwordx4 v[228:231], v18, s[4:7], s32 offen nt
    s_add_u32 s32, s32, 8192
    buffer_load_dwordx4 v[232:235], v18, s[4:7], s32 offen nt
    s_add_u32 s32, s32, 8192
    buffer_load_dwordx4 v[236:239], v18, s[4:7], s32 offen nt
    s_add_u32 s32, s32, 8192
    buffer_load_dwordx4 v[240:243], v18, s[4:7], s32 offen nt
    s_add_u32 s32, s32, 8192
    buffer_load_dwordx4 v[244:247], v18, s[4:7], s32 offen nt
    s_add_u32 s32, s32, 8192
    buffer_load_dwordx4 v[248:251], v18, s[4:7], s32 offen nt
    s_add_u32 s32, s32, 8192
    buffer_load_dwordx4 v[252:255], v18, s[4:7], s32 offen nt
    s_add_u32 s32, s32, 8192
    s_lshl_b32 s33, s26, 17
    s_lshl_b32 s24, s3, 15
    s_add_u32 s33, s33, s24
    s_mul_i32 s34, s3, 33792
    s_waitcnt lgkmcnt(0)
    s_barrier
    s_mov_b32 s70, 0
L_woA:
    s_and_b32 s24, s70, 3
    s_lshl_b32 s24, s24, 1
    s_lshr_b32 s25, s70, 2
    s_or_b32 s24, s24, s25
    s_lshl_b32 s24, s24, 10
    s_add_u32 s24, s24, s33
    s_mul_i32 s25, s70, 4224
    s_add_u32 m0, s25, s34
    s_waitcnt vmcnt(24)
    buffer_load_dwordx4 v2, s[8:11], s24 offen nt lds
    s_add_u32 m0, m0, 1056
    s_add_u32 s24, s24, 8192
    s_waitcnt vmcnt(24)
    buffer_load_dwordx4 v2, s[8:11], s24 offen nt lds
    s_add_u32 m0, m0, 1056
    s_add_u32 s24, s24, 8192
    s_waitcnt vmcnt(24)
    buffer_load_dwordx4 v2, s[8:11], s24 offen nt lds
    s_add_u32 m0, m0, 1056
    s_add_u32 s24, s24, 8192
    s_waitcnt vmcnt(24)
    buffer_load_dwordx4 v2, s[8:11], s24 offen nt lds
    s_add_u32 s70, s70, 1
    s_cmp_lt_u32 s70, 8
    s_cbranch_scc1 L_woA
    s_waitcnt vmcnt(0)
    s_barrier
    v_lshrrev_b32 v3, 2, v0
    v_mul_u32_u24 v3, 1056, v3
    v_and_b32 v4, 3, v0
    v_lshl_add_u32 v3, v4, 3, v3
    s_lshl_b32 s24, s3, 8
    v_add_u32 v3, s24, v3
    v_add_u32 v4, 67584, v3
    ds_read_b64_tr_b16 a[0:1], v3 offset:0
    ds_read_b64_tr_b16 a[2:3], v3 offset:16896
    ds_read_b64_tr_b16 a[4:5], v3 offset:33792
    ds_read_b64_tr_b16 a[6:7], v3 offset:50688
    ds_read_b64_tr_b16 a[8:9], v4 offset:0
    ds_read_b64_tr_b16 a[10:11], v4 offset:16896
    ds_read_b64_tr_b16 a[12:13], v4 offset:33792
    ds_read_b64_tr_b16 a[14:15], v4 offset:50688
    ds_read_b64_tr_b16 a[16:17], v3 offset:32
    ds_read_b64_tr_b16 a[18:19], v3 offset:16928
    ds_read_b64_tr_b16 a[20:21], v3 offset:33824
    ds_read_b64_tr_b16 a[22:23], v3 offset:50720
    ds_read_b64_tr_b16 a[24:25], v4 offset:32
    ds_read_b64_tr_b16 a[26:27], v4 offset:16928
    ds_read_b64_tr_b16 a[28:29], v4 offset:33824
    ds_read_b64_tr_b16 a[30:31], v4 offset:50720
    ds_read_b64_tr_b16 a[32:33], v3 offset:64
    ds_read_b64_tr_b16 a[34:35], v3 offset:16960
    ds_read_b64_tr_b16 a[36:37], v3 offset:33856
    ds_read_b64_tr_b16 a[38:39], v3 offset:50752
    ds_read_b64_tr_b16 a[40:41], v4 offset:64
    ds_read_b64_tr_b16 a[42:43], v4 offset:16960
    ds_read_b64_tr_b16 a[44:45], v4 offset:33856
    ds_read_b64_tr_b16 a[46:47], v4 offset:50752
    ds_read_b64_tr_b16 a[48:49], v3 offset:96
    ds_read_b64_tr_b16 a[50:51], v3 offset:16992
    ds_read_b64_tr_b16 a[52:53], v3 offset:33888
    ds_read_b64_tr_b16 a[54:55], v3 offset:50784
    ds_read_b64_tr_b16 a[56:57], v4 offset:96
    ds_read_b64_tr_b16 a[58:59], v4 offset:16992
    ds_read_b64_tr_b16 a[60:61], v4 offset:33888
    ds_read_b64_tr_b16 a[62:63], v4 offset:50784
    ds_read_b64_tr_b16 a[64:65], v3 offset:128
    ds_read_b64_tr_b16 a[66:67], v3 offset:17024
    ds_read_b64_tr_b16 a[68:69], v3 offset:33920
    ds_read_b64_tr_b16 a[70:71], v3 offset:50816
    ds_read_b64_tr_b16 a[72:73], v4 offset:128
    ds_read_b64_tr_b16 a[74:75], v4 offset:17024
    ds_read_b64_tr_b16 a[76:77], v4 offset:33920
    ds_read_b64_tr_b16 a[78:79], v4 offset:50816
    ds_read_b64_tr_b16 a[80:81], v3 offset:160
    ds_read_b64_tr_b16 a[82:83], v3 offset:17056
    ds_read_b64_tr_b16 a[84:85], v3 offset:33952
    ds_read_b64_tr_b16 a[86:87], v3 offset:50848
    ds_read_b64_tr_b16 a[88:89], v4 offset:160
    ds_read_b64_tr_b16 a[90:91], v4 offset:17056
    ds_read_b64_tr_b16 a[92:93], v4 offset:33952
    ds_read_b64_tr_b16 a[94:95], v4 offset:50848
    ds_read_b64_tr_b16 a[96:97], v3 offset:192
    ds_read_b64_tr_b16 a[98:99], v3 offset:17088
    ds_read_b64_tr_b16 a[100:101], v3 offset:33984
    ds_read_b64_tr_b16 a[102:103], v3 offset:50880
    ds_read_b64_tr_b16 a[104:105], v4 offset:192
    ds_read_b64_tr_b16 a[106:107], v4 offset:17088
    ds_read_b64_tr_b16 a[108:109], v4 offset:33984
    ds_read_b64_tr_b16 a[110:111], v4 offset:50880
    ds_read_b64_tr_b16 a[112:113], v3 offset:224
    ds_read_b64_tr_b16 a[114:115], v3 offset:17120
    ds_read_b64_tr_b16 a[116:117], v3 offset:34016
    ds_read_b64_tr_b16 a[118:119], v3 offset:50912
    ds_read_b64_tr_b16 a[120:121], v4 offset:224
    ds_read_b64_tr_b16 a[122:123], v4 offset:17120
    ds_read_b64_tr_b16 a[124:125], v4 offset:34016
    ds_read_b64_tr_b16 a[126:127], v4 offset:50912
    s_waitcnt lgkmcnt(0)
    s_cmp_lg_u32 s3, 0
    s_cbranch_scc1 L_awx11
    s_mov_b32 s24, 262144
    s_mov_b64 exec, 1
L_aw12:
    buffer_load_dword v1, off, s[12:15], s73 offset:0 sc1
    s_waitcnt vmcnt(0)
    v_readfirstlane_b32 s25, v1
    s_nop 0
    s_cmp_eq_u32 s25, 1
    s_cbranch_scc1 L_awx11
    s_sleep 4
    s_sub_u32 s24, s24, 1
    s_cmp_lg_u32 s24, 0
    s_cbranch_scc1 L_aw12
L_awx11:
    s_mov_b64 exec, -1
    s_barrier
    s_cmp_lg_u32 s3, 0
    s_cbranch_scc1 L_xi13
    s_and_b32 s24, s74, 7
    s_lshl_b32 s24, s24, 5
    s_lshr_b32 s25, s74, 3
    s_add_u32 s24, s24, s25
    s_lshl_b32 s24, s24, 2
    s_add_u32 s24, s24, 0x1b6000
    s_getreg_b32 s25, hwreg(HW_REG_XCC_ID, 0, 4)
    s_mov_b64 exec, 1
    v_mov_b32 v3, s25
    buffer_store_dword v3, off, s[12:15], s24 sc1
    s_mov_b64 exec, -1
L_xi13:
    s_cmp_lg_u32 s3, 0
    s_cbranch_scc1 L_awx14
    s_mov_b32 s24, 262144
    s_mov_b64 exec, 1
L_aw15:
    buffer_load_dword v1, off, s[12:15], s73 offset:4 sc1
    s_waitcnt vmcnt(0)
    v_readfirstlane_b32 s25, v1
    s_nop 0
    s_cmp_eq_u32 s25, 1
    s_cbranch_scc1 L_awx14
    s_sleep 4
    s_sub_u32 s24, s24, 1
    s_cmp_lg_u32 s24, 0
    s_cbranch_scc1 L_aw15
L_awx14:
    s_mov_b64 exec, -1
    s_barrier
    s_lshl_b32 s24, s3, 10
    s_lshl_b32 s25, s26, 3
    s_add_u32 s25, s25, s24
    s_add_u32 s25, s25, 0x120000
    v_and_b32 v3, 3, v0
    v_lshlrev_b32 v3, 8, v3
    buffer_load_dwordx2 v[4:5], v3, s[12:15], s25 offen sc1
    s_lshl_b32 s24, s3, 18
    s_lshl_b32 s25, s26, 11
    s_add_u32 s24, s24, s25
    s_add_u32 s24, s24, 0x400000
    buffer_load_dwordx4 v[72:75], v2, s[12:15], s24 offen sc1 nt
    s_add_u32 s24, s24, 65536
    buffer_load_dwordx4 v[76:79], v2, s[12:15], s24 offen sc1 nt
    s_add_u32 s24, s24, 65536
    buffer_load_dwordx4 v[80:83], v2, s[12:15], s24 offen sc1 nt
    s_add_u32 s24, s24, 65536
    buffer_load_dwordx4 v[84:87], v2, s[12:15], s24 offen sc1 nt
    s_add_u32 s24, s24, 65536
    s_waitcnt vmcnt(4)
    v_mov_b32 v6, v4
    s_nop 1
    v_max_f32_dpp v6, v6, v6 row_ror:2 row_mask:0xf bank_mask:0xf
    s_nop 1
    v_max_f32_dpp v6, v6, v6 row_ror:1 row_mask:0xf bank_mask:0xf
    v_sub_f32 v4, v4, v6
    v_exp_f32 v4, v4
    s_nop 0
    v_mul_f32 v5, v4, v5
    s_nop 1
    v_add_f32_dpp v5, v5, v5 row_ror:2 row_mask:0xf bank_mask:0xf
    s_nop 1
    v_add_f32_dpp v5, v5, v5 row_ror:1 row_mask:0xf bank_mask:0xf
    v_rcp_f32 v5, v5
    s_nop 0
    v_mul_f32 v4, v4, v5
    s_nop 0
    v_readlane_b32 s24, v4, 0
    s_waitcnt vmcnt(3)
    v_lshlrev_b32 v5, 16, v72
    v_and_b32 v6, 0xffff0000, v72
    v_mul_f32 v104, s24, v5
    v_mul_f32 v105, s24, v6
    v_lshlrev_b32 v5, 16, v73
    v_and_b32 v6, 0xffff0000, v73
    v_mul_f32 v106, s24, v5
    v_mul_f32 v107, s24, v6
    v_lshlrev_b32 v5, 16, v74
    v_and_b32 v6, 0xffff0000, v74
    v_mul_f32 v108, s24, v5
    v_mul_f32 v109, s24, v6
    v_lshlrev_b32 v5, 16, v75
    v_and_b32 v6, 0xffff0000, v75
    v_mul_f32 v110, s24, v5
    v_mul_f32 v111, s24, v6
    v_readlane_b32 s24, v4, 1
    s_waitcnt vmcnt(2)
    v_lshlrev_b32 v5, 16, v76
    v_and_b32 v6, 0xffff0000, v76
    v_fmac_f32 v104, s24, v5
    v_fmac_f32 v105, s24, v6
    v_lshlrev_b32 v5, 16, v77
    v_and_b32 v6, 0xffff0000, v77
    v_fmac_f32 v106, s24, v5
    v_fmac_f32 v107, s24, v6
    v_lshlrev_b32 v5, 16, v78
    v_and_b32 v6, 0xffff0000, v78
    v_fmac_f32 v108, s24, v5
    v_fmac_f32 v109, s24, v6
    v_lshlrev_b32 v5, 16, v79
    v_and_b32 v6, 0xffff0000, v79
    v_fmac_f32 v110, s24, v5
    v_fmac_f32 v111, s24, v6
    v_readlane_b32 s24, v4, 2
    s_waitcnt vmcnt(1)
    v_lshlrev_b32 v5, 16, v80
    v_and_b32 v6, 0xffff0000, v80
    v_fmac_f32 v104, s24, v5
    v_fmac_f32 v105, s24, v6
    v_lshlrev_b32 v5, 16, v81
    v_and_b32 v6, 0xffff0000, v81
    v_fmac_f32 v106, s24, v5
    v_fmac_f32 v107, s24, v6
    v_lshlrev_b32 v5, 16, v82
    v_and_b32 v6, 0xffff0000, v82
    v_fmac_f32 v108, s24, v5
    v_fmac_f32 v109, s24, v6
    v_lshlrev_b32 v5, 16, v83
    v_and_b32 v6, 0xffff0000, v83
    v_fmac_f32 v110, s24, v5
    v_fmac_f32 v111, s24, v6
    v_readlane_b32 s24, v4, 3
    s_waitcnt vmcnt(0)
    v_lshlrev_b32 v5, 16, v84
    v_and_b32 v6, 0xffff0000, v84
    v_fmac_f32 v104, s24, v5
    v_fmac_f32 v105, s24, v6
    v_lshlrev_b32 v5, 16, v85
    v_and_b32 v6, 0xffff0000, v85
    v_fmac_f32 v106, s24, v5
    v_fmac_f32 v107, s24, v6
    v_lshlrev_b32 v5, 16, v86
    v_and_b32 v6, 0xffff0000, v86
    v_fmac_f32 v108, s24, v5
    v_fmac_f32 v109, s24, v6
    v_lshlrev_b32 v5, 16, v87
    v_and_b32 v6, 0xffff0000, v87
    v_fmac_f32 v110, s24, v5
    v_fmac_f32 v111, s24, v6
    v_cvt_pk_bf16_f32 v4, v104, v105
    v_cvt_pk_bf16_f32 v5, v106, v107
    v_cvt_pk_bf16_f32 v6, v108, v109
    v_cvt_pk_bf16_f32 v7, v110, v111
    s_lshl_b32 s24, s3, 10
    s_add_u32 s24, s24, 145408
    v_add_u32 v3, s24, v2
    ds_write_b128 v3, v[4:7]
    s_lshl_b32 s24, s3, 8
    s_add_u32 s24, s24, 145408
    v_add_u32 v3, s24, v19
    s_waitcnt lgkmcnt(0)
    s_barrier
    ds_read_b128 v[32:35], v3 offset:0
    ds_read_b128 v[36:39], v3 offset:16
    ds_read_b128 v[40:43], v3 offset:32
    ds_read_b128 v[44:47], v3 offset:48
    ds_read_b128 v[48:51], v3 offset:2048
    ds_read_b128 v[52:55], v3 offset:2064
    ds_read_b128 v[56:59], v3 offset:2080
    ds_read_b128 v[60:63], v3 offset:2096
    s_waitcnt lgkmcnt(0)
    v_perm_b32 v8, v32, v32, v24
    v_perm_b32 v9, v32, v32, v25
    v_perm_b32 v10, v32, v32, v26
    v_perm_b32 v11, v32, v32, v27
    v_perm_b32 v4, v48, v48, v24
    v_perm_b32 v5, v48, v48, v25
    v_perm_b32 v6, v48, v48, v26
    v_perm_b32 v7, v48, v48, v27
    v_mfma_f32_16x16x32_bf16 v[12:15], v[128:131], v[8:11], 0
    s_nop 0
    v_mfma_f32_16x16x32_bf16 v[68:71], v[128:131], v[4:7], 0
    v_perm_b32 v8, v32, v32, v28
    v_perm_b32 v9, v32, v32, v29
    v_perm_b32 v10, v32, v32, v30
    v_perm_b32 v11, v32, v32, v31
    v_perm_b32 v4, v48, v48, v28
    v_perm_b32 v5, v48, v48, v29
    v_perm_b32 v6, v48, v48, v30
    v_perm_b32 v7, v48, v48, v31
    v_mfma_f32_16x16x32_bf16 v[12:15], v[132:135], v[8:11], v[12:15]
    s_nop 0
    v_mfma_f32_16x16x32_bf16 v[68:71], v[132:135], v[4:7], v[68:71]
    v_perm_b32 v8, v33, v33, v24
    v_perm_b32 v9, v33, v33, v25
    v_perm_b32 v10, v33, v33, v26
    v_perm_b32 v11, v33, v33, v27
    v_perm_b32 v4, v49, v49, v24
    v_perm_b32 v5, v49, v49, v25
    v_perm_b32 v6, v49, v49, v26
    v_perm_b32 v7, v49, v49, v27
    v_mfma_f32_16x16x32_bf16 v[12:15], v[136:139], v[8:11], v[12:15]
    s_nop 0
    v_mfma_f32_16x16x32_bf16 v[68:71], v[136:139], v[4:7], v[68:71]
    v_perm_b32 v8, v33, v33, v28
    v_perm_b32 v9, v33, v33, v29
    v_perm_b32 v10, v33, v33, v30
    v_perm_b32 v11, v33, v33, v31
    v_perm_b32 v4, v49, v49, v28
    v_perm_b32 v5, v49, v49, v29
    v_perm_b32 v6, v49, v49, v30
    v_perm_b32 v7, v49, v49, v31
    v_mfma_f32_16x16x32_bf16 v[12:15], v[140:143], v[8:11], v[12:15]
    s_nop 0
    v_mfma_f32_16x16x32_bf16 v[68:71], v[140:143], v[4:7], v[68:71]
    v_perm_b32 v8, v34, v34, v24
    v_perm_b32 v9, v34, v34, v25
    v_perm_b32 v10, v34, v34, v26
    v_perm_b32 v11, v34, v34, v27
    v_perm_b32 v4, v50, v50, v24
    v_perm_b32 v5, v50, v50, v25
    v_perm_b32 v6, v50, v50, v26
    v_perm_b32 v7, v50, v50, v27
    v_mfma_f32_16x16x32_bf16 v[12:15], v[144:147], v[8:11], v[12:15]
    s_nop 0
    v_mfma_f32_16x16x32_bf16 v[68:71], v[144:147], v[4:7], v[68:71]
    v_perm_b32 v8, v34, v34, v28
    v_perm_b32 v9, v34, v34, v29
    v_perm_b32 v10, v34, v34, v30
    v_perm_b32 v11, v34, v34, v31
    v_perm_b32 v4, v50, v50, v28
    v_perm_b32 v5, v50, v50, v29
    v_perm_b32 v6, v50, v50, v30
    v_perm_b32 v7, v50, v50, v31
    v_mfma_f32_16x16x32_bf16 v[12:15], v[148:151], v[8:11], v[12:15]
    s_nop 0
    v_mfma_f32_16x16x32_bf16 v[68:71], v[148:151], v[4:7], v[68:71]
    v_perm_b32 v8, v35, v35, v24
    v_perm_b32 v9, v35, v35, v25
    v_perm_b32 v10, v35, v35, v26
    v_perm_b32 v11, v35, v35, v27
    v_perm_b32 v4, v51, v51, v24
    v_perm_b32 v5, v51, v51, v25
    v_perm_b32 v6, v51, v51, v26
    v_perm_b32 v7, v51, v51, v27
    v_mfma_f32_16x16x32_bf16 v[12:15], v[152:155], v[8:11], v[12:15]
    s_nop 0
    v_mfma_f32_16x16x32_bf16 v[68:71], v[152:155], v[4:7], v[68:71]
    v_perm_b32 v8, v35, v35, v28
    v_perm_b32 v9, v35, v35, v29
    v_perm_b32 v10, v35, v35, v30
    v_perm_b32 v11, v35, v35, v31
    v_perm_b32 v4, v51, v51, v28
    v_perm_b32 v5, v51, v51, v29
    v_perm_b32 v6, v51, v51, v30
    v_perm_b32 v7, v51, v51, v31
    v_mfma_f32_16x16x32_bf16 v[12:15], v[156:159], v[8:11], v[12:15]
    s_nop 0
    v_mfma_f32_16x16x32_bf16 v[68:71], v[156:159], v[4:7], v[68:71]
    v_perm_b32 v8, v36, v36, v24
    v_perm_b32 v9, v36, v36, v25
    v_perm_b32 v10, v36, v36, v26
    v_perm_b32 v11, v36, v36, v27
    v_perm_b32 v4, v52, v52, v24
    v_perm_b32 v5, v52, v52, v25
    v_perm_b32 v6, v52, v52, v26
    v_perm_b32 v7, v52, v52, v27
    v_mfma_f32_16x16x32_bf16 v[12:15], v[160:163], v[8:11], v[12:15]
    s_nop 0
    v_mfma_f32_16x16x32_bf16 v[68:71], v[160:163], v[4:7], v[68:71]
    v_perm_b32 v8, v36, v36, v28
    v_perm_b32 v9, v36, v36, v29
    v_perm_b32 v10, v36, v36, v30
    v_perm_b32 v11, v36, v36, v31
    v_perm_b32 v4, v52, v52, v28
    v_perm_b32 v5, v52, v52, v29
    v_perm_b32 v6, v52, v52, v30
    v_perm_b32 v7, v52, v52, v31
    v_mfma_f32_16x16x32_bf16 v[12:15], v[164:167], v[8:11], v[12:15]
    s_nop 0
    v_mfma_f32_16x16x32_bf16 v[68:71], v[164:167], v[4:7], v[68:71]
    v_perm_b32 v8, v37, v37, v24
    v_perm_b32 v9, v37, v37, v25
    v_perm_b32 v10, v37, v37, v26
    v_perm_b32 v11, v37, v37, v27
    v_perm_b32 v4, v53, v53, v24
    v_perm_b32 v5, v53, v53, v25
    v_perm_b32 v6, v53, v53, v26
    v_perm_b32 v7, v53, v53, v27
    v_mfma_f32_16x16x32_bf16 v[12:15], v[168:171], v[8:11], v[12:15]
    s_nop 0
    v_mfma_f32_16x16x32_bf16 v[68:71], v[168:171], v[4:7], v[68:71]
    v_perm_b32 v8, v37, v37, v28
    v_perm_b32 v9, v37, v37, v29
    v_perm_b32 v10, v37, v37, v30
    v_perm_b32 v11, v37, v37, v31
    v_perm_b32 v4, v53, v53, v28
    v_perm_b32 v5, v53, v53, v29
    v_perm_b32 v6, v53, v53, v30
    v_perm_b32 v7, v53, v53, v31
    v_mfma_f32_16x16x32_bf16 v[12:15], v[172:175], v[8:11], v[12:15]
    s_nop 0
    v_mfma_f32_16x16x32_bf16 v[68:71], v[172:175], v[4:7], v[68:71]
    v_perm_b32 v8, v38, v38, v24
    v_perm_b32 v9, v38, v38, v25
    v_perm_b32 v10, v38, v38, v26
    v_perm_b32 v11, v38, v38, v27
    v_perm_b32 v4, v54, v54, v24
    v_perm_b32 v5, v54, v54, v25
    v_perm_b32 v6, v54, v54, v26
    v_perm_b32 v7, v54, v54, v27
    v_mfma_f32_16x16x32_bf16 v[12:15], v[176:179], v[8:11], v[12:15]
    s_nop 0
    v_mfma_f32_16x16x32_bf16 v[68:71], v[176:179], v[4:7], v[68:71]
    v_perm_b32 v8, v38, v38, v28
    v_perm_b32 v9, v38, v38, v29
    v_perm_b32 v10, v38, v38, v30
    v_perm_b32 v11, v38, v38, v31
    v_perm_b32 v4, v54, v54, v28
    v_perm_b32 v5, v54, v54, v29
    v_perm_b32 v6, v54, v54, v30
    v_perm_b32 v7, v54, v54, v31
    v_mfma_f32_16x16x32_bf16 v[12:15], v[180:183], v[8:11], v[12:15]
    s_nop 0
    v_mfma_f32_16x16x32_bf16 v[68:71], v[180:183], v[4:7], v[68:71]
    v_perm_b32 v8, v39, v39, v24
    v_perm_b32 v9, v39, v39, v25
    v_perm_b32 v10, v39, v39, v26
    v_perm_b32 v11, v39, v39, v27
    v_perm_b32 v4, v55, v55, v24
    v_perm_b32 v5, v55, v55, v25
    v_perm_b32 v6, v55, v55, v26
    v_perm_b32 v7, v55, v55, v27
    v_mfma_f32_16x16x32_bf16 v[12:15], v[184:187], v[8:11], v[12:15]
    s_nop 0
    v_mfma_f32_16x16x32_bf16 v[68:71], v[184:187], v[4:7], v[68:71]
    v_perm_b32 v8, v39, v39, v28
    v_perm_b32 v9, v39, v39, v29
    v_perm_b32 v10, v39, v39, v30
    v_perm_b32 v11, v39, v39, v31
    v_perm_b32 v4, v55, v55, v28
    v_perm_b32 v5, v55, v55, v29
    v_perm_b32 v6, v55, v55, v30
    v_perm_b32 v7, v55, v55, v31
    v_mfma_f32_16x16x32_bf16 v[12:15], v[188:191], v[8:11], v[12:15]
    s_nop 0
    v_mfma_f32_16x16x32_bf16 v[68:71], v[188:191], v[4:7], v[68:71]
    v_perm_b32 v8, v40, v40, v24
    v_perm_b32 v9, v40, v40, v25
    v_perm_b32 v10, v40, v40, v26
    v_perm_b32 v11, v40, v40, v27
    v_perm_b32 v4, v56, v56, v24
    v_perm_b32 v5, v56, v56, v25
    v_perm_b32 v6, v56, v56, v26
    v_perm_b32 v7, v56, v56, v27
    v_mfma_f32_16x16x32_bf16 v[12:15], v[192:195], v[8:11], v[12:15]
    s_nop 0
    v_mfma_f32_16x16x32_bf16 v[68:71], v[192:195], v[4:7], v[68:71]
    v_perm_b32 v8, v40, v40, v28
    v_perm_b32 v9, v40, v40, v29
    v_perm_b32 v10, v40, v40, v30
    v_perm_b32 v11, v40, v40, v31
    v_perm_b32 v4, v56, v56, v28
    v_perm_b32 v5, v56, v56, v29
    v_perm_b32 v6, v56, v56, v30
    v_perm_b32 v7, v56, v56, v31
    v_mfma_f32_16x16x32_bf16 v[12:15], v[196:199], v[8:11], v[12:15]
    s_nop 0
    v_mfma_f32_16x16x32_bf16 v[68:71], v[196:199], v[4:7], v[68:71]
    v_perm_b32 v8, v41, v41, v24
    v_perm_b32 v9, v41, v41, v25
    v_perm_b32 v10, v41, v41, v26
    v_perm_b32 v11, v41, v41, v27
    v_perm_b32 v4, v57, v57, v24
    v_perm_b32 v5, v57, v57, v25
    v_perm_b32 v6, v57, v57, v26
    v_perm_b32 v7, v57, v57, v27
    v_mfma_f32_16x16x32_bf16 v[12:15], v[200:203], v[8:11], v[12:15]
    s_nop 0
    v_mfma_f32_16x16x32_bf16 v[68:71], v[200:203], v[4:7], v[68:71]
    v_perm_b32 v8, v41, v41, v28
    v_perm_b32 v9, v41, v41, v29
    v_perm_b32 v10, v41, v41, v30
    v_perm_b32 v11, v41, v41, v31
    v_perm_b32 v4, v57, v57, v28
    v_perm_b32 v5, v57, v57, v29
    v_perm_b32 v6, v57, v57, v30
    v_perm_b32 v7, v57, v57, v31
    v_mfma_f32_16x16x32_bf16 v[12:15], v[204:207], v[8:11], v[12:15]
    s_nop 0
    v_mfma_f32_16x16x32_bf16 v[68:71], v[204:207], v[4:7], v[68:71]
    v_perm_b32 v8, v42, v42, v24
    v_perm_b32 v9, v42, v42, v25
    v_perm_b32 v10, v42, v42, v26
    v_perm_b32 v11, v42, v42, v27
    v_perm_b32 v4, v58, v58, v24
    v_perm_b32 v5, v58, v58, v25
    v_perm_b32 v6, v58, v58, v26
    v_perm_b32 v7, v58, v58, v27
    v_mfma_f32_16x16x32_bf16 v[12:15], v[208:211], v[8:11], v[12:15]
    s_nop 0
    v_mfma_f32_16x16x32_bf16 v[68:71], v[208:211], v[4:7], v[68:71]
    v_perm_b32 v8, v42, v42, v28
    v_perm_b32 v9, v42, v42, v29
    v_perm_b32 v10, v42, v42, v30
    v_perm_b32 v11, v42, v42, v31
    v_perm_b32 v4, v58, v58, v28
    v_perm_b32 v5, v58, v58, v29
    v_perm_b32 v6, v58, v58, v30
    v_perm_b32 v7, v58, v58, v31
    v_mfma_f32_16x16x32_bf16 v[12:15], v[212:215], v[8:11], v[12:15]
    s_nop 0
    v_mfma_f32_16x16x32_bf16 v[68:71], v[212:215], v[4:7], v[68:71]
    v_perm_b32 v8, v43, v43, v24
    v_perm_b32 v9, v43, v43, v25
    v_perm_b32 v10, v43, v43, v26
    v_perm_b32 v11, v43, v43, v27
    v_perm_b32 v4, v59, v59, v24
    v_perm_b32 v5, v59, v59, v25
    v_perm_b32 v6, v59, v59, v26
    v_perm_b32 v7, v59, v59, v27
    v_mfma_f32_16x16x32_bf16 v[12:15], v[216:219], v[8:11], v[12:15]
    s_nop 0
    v_mfma_f32_16x16x32_bf16 v[68:71], v[216:219], v[4:7], v[68:71]
    v_perm_b32 v8, v43, v43, v28
    v_perm_b32 v9, v43, v43, v29
    v_perm_b32 v10, v43, v43, v30
    v_perm_b32 v11, v43, v43, v31
    v_perm_b32 v4, v59, v59, v28
    v_perm_b32 v5, v59, v59, v29
    v_perm_b32 v6, v59, v59, v30
    v_perm_b32 v7, v59, v59, v31
    v_mfma_f32_16x16x32_bf16 v[12:15], v[220:223], v[8:11], v[12:15]
    s_nop 0
    v_mfma_f32_16x16x32_bf16 v[68:71], v[220:223], v[4:7], v[68:71]
    v_perm_b32 v8, v44, v44, v24
    v_perm_b32 v9, v44, v44, v25
    v_perm_b32 v10, v44, v44, v26
    v_perm_b32 v11, v44, v44, v27
    v_perm_b32 v4, v60, v60, v24
    v_perm_b32 v5, v60, v60, v25
    v_perm_b32 v6, v60, v60, v26
    v_perm_b32 v7, v60, v60, v27
    v_mfma_f32_16x16x32_bf16 v[12:15], v[224:227], v[8:11], v[12:15]
    s_nop 0
    v_mfma_f32_16x16x32_bf16 v[68:71], v[224:227], v[4:7], v[68:71]
    v_perm_b32 v8, v44, v44, v28
    v_perm_b32 v9, v44, v44, v29
    v_perm_b32 v10, v44, v44, v30
    v_perm_b32 v11, v44, v44, v31
    v_perm_b32 v4, v60, v60, v28
    v_perm_b32 v5, v60, v60, v29
    v_perm_b32 v6, v60, v60, v30
    v_perm_b32 v7, v60, v60, v31
    v_mfma_f32_16x16x32_bf16 v[12:15], v[228:231], v[8:11], v[12:15]
    s_nop 0
    v_mfma_f32_16x16x32_bf16 v[68:71], v[228:231], v[4:7], v[68:71]
    v_perm_b32 v8, v45, v45, v24
    v_perm_b32 v9, v45, v45, v25
    v_perm_b32 v10, v45, v45, v26
    v_perm_b32 v11, v45, v45, v27
    v_perm_b32 v4, v61, v61, v24
    v_perm_b32 v5, v61, v61, v25
    v_perm_b32 v6, v61, v61, v26
    v_perm_b32 v7, v61, v61, v27
    v_mfma_f32_16x16x32_bf16 v[12:15], v[232:235], v[8:11], v[12:15]
    s_nop 0
    v_mfma_f32_16x16x32_bf16 v[68:71], v[232:235], v[4:7], v[68:71]
    v_perm_b32 v8, v45, v45, v28
    v_perm_b32 v9, v45, v45, v29
    v_perm_b32 v10, v45, v45, v30
    v_perm_b32 v11, v45, v45, v31
    v_perm_b32 v4, v61, v61, v28
    v_perm_b32 v5, v61, v61, v29
    v_perm_b32 v6, v61, v61, v30
    v_perm_b32 v7, v61, v61, v31
    v_mfma_f32_16x16x32_bf16 v[12:15], v[236:239], v[8:11], v[12:15]
    s_nop 0
    v_mfma_f32_16x16x32_bf16 v[68:71], v[236:239], v[4:7], v[68:71]
    v_perm_b32 v8, v46, v46, v24
    v_perm_b32 v9, v46, v46, v25
    v_perm_b32 v10, v46, v46, v26
    v_perm_b32 v11, v46, v46, v27
    v_perm_b32 v4, v62, v62, v24
    v_perm_b32 v5, v62, v62, v25
    v_perm_b32 v6, v62, v62, v26
    v_perm_b32 v7, v62, v62, v27
    v_mfma_f32_16x16x32_bf16 v[12:15], v[240:243], v[8:11], v[12:15]
    s_nop 0
    v_mfma_f32_16x16x32_bf16 v[68:71], v[240:243], v[4:7], v[68:71]
    v_perm_b32 v8, v46, v46, v28
    v_perm_b32 v9, v46, v46, v29
    v_perm_b32 v10, v46, v46, v30
    v_perm_b32 v11, v46, v46, v31
    v_perm_b32 v4, v62, v62, v28
    v_perm_b32 v5, v62, v62, v29
    v_perm_b32 v6, v62, v62, v30
    v_perm_b32 v7, v62, v62, v31
    v_mfma_f32_16x16x32_bf16 v[12:15], v[244:247], v[8:11], v[12:15]
    s_nop 0
    v_mfma_f32_16x16x32_bf16 v[68:71], v[244:247], v[4:7], v[68:71]
    v_perm_b32 v8, v47, v47, v24
    v_perm_b32 v9, v47, v47, v25
    v_perm_b32 v10, v47, v47, v26
    v_perm_b32 v11, v47, v47, v27
    v_perm_b32 v4, v63, v63, v24
    v_perm_b32 v5, v63, v63, v25
    v_perm_b32 v6, v63, v63, v26
    v_perm_b32 v7, v63, v63, v27
    v_mfma_f32_16x16x32_bf16 v[12:15], v[248:251], v[8:11], v[12:15]
    s_nop 0
    v_mfma_f32_16x16x32_bf16 v[68:71], v[248:251], v[4:7], v[68:71]
    v_perm_b32 v8, v47, v47, v28
    v_perm_b32 v9, v47, v47, v29
    v_perm_b32 v10, v47, v47, v30
    v_perm_b32 v11, v47, v47, v31
    v_perm_b32 v4, v63, v63, v28
    v_perm_b32 v5, v63, v63, v29
    v_perm_b32 v6, v63, v63, v30
    v_perm_b32 v7, v63, v63, v31
    v_mfma_f32_16x16x32_bf16 v[12:15], v[252:255], v[8:11], v[12:15]
    s_nop 0
    v_mfma_f32_16x16x32_bf16 v[68:71], v[252:255], v[4:7], v[68:71]
    v_lshrrev_b32 v3, 4, v0
    v_lshlrev_b32 v3, 7, v3
    v_and_b32 v4, 7, v0
    v_lshl_add_u32 v3, v4, 4, v3
    v_bfe_u32 v4, v0, 3, 1
    v_lshl_add_u32 v3, v4, 9, v3
    s_lshl_b32 s24, s3, 11
    s_add_u32 s24, s24, 135168
    v_add_u32 v3, s24, v3
    ds_write_b128 v3, v[12:15]
    ds_write_b128 v3, v[68:71] offset:1024
    s_waitcnt lgkmcnt(0)
    s_barrier
    v_and_b32 v5, 31, v0
    s_lshl_b32 s24, s3, 9
    s_add_u32 s24, s24, 135168
    v_lshl_add_u32 v3, v5, 4, s24
    ds_read_b128 v[72:75], v3 offset:0
    ds_read_b128 v[76:79], v3 offset:2048
    ds_read_b128 v[80:83], v3 offset:4096
    ds_read_b128 v[84:87], v3 offset:6144
    s_mul_i32 s24, s3, 320
    s_add_u32 s24, s24, 143360
    v_lshl_add_u32 v5, v5, 3, s24
    s_waitcnt lgkmcnt(0)
    v_add_f32 v72, v72, v76
    v_add_f32 v73, v73, v77
    v_add_f32 v74, v74, v78
    v_add_f32 v75, v75, v79
    v_add_f32 v72, v72, v80
    v_add_f32 v73, v73, v81
    v_add_f32 v74, v74, v82
    v_add_f32 v75, v75, v83
    v_add_f32 v72, v72, v84
    v_add_f32 v73, v73, v85
    v_add_f32 v74, v74, v86
    v_add_f32 v75, v75, v87
    v_cvt_pk_bf16_f32 v6, v72, v73
    v_cvt_pk_bf16_f32 v7, v74, v75
    ds_write_b64 v5, v[6:7]
    v_lshrrev_b32 v3, 4, v0
    v_and_b32 v4, 3, v0
    v_mul_u32_u24 v5, 320, v4
    v_lshl_add_u32 v5, v3, 4, v5
    v_add_u32 v5, 143360, v5
    s_waitcnt lgkmcnt(0)
    s_barrier
    ds_read_b128 v[32:35], v5 offset:0
    ds_read_b128 v[36:39], v5 offset:64
    ds_read_b128 v[40:43], v5 offset:128
    ds_read_b128 v[44:47], v5 offset:192
    s_waitcnt lgkmcnt(3)
    v_mfma_f32_16x16x32_bf16 v[72:75], v[32:35], a[0:3], 0
    s_waitcnt lgkmcnt(2)
    v_mfma_f32_16x16x32_bf16 v[72:75], v[36:39], a[4:7], v[72:75]
    s_waitcnt lgkmcnt(1)
    v_mfma_f32_16x16x32_bf16 v[72:75], v[40:43], a[8:11], v[72:75]
    s_waitcnt lgkmcnt(0)
    v_mfma_f32_16x16x32_bf16 v[72:75], v[44:47], a[12:15], v[72:75]
    v_mfma_f32_16x16x32_bf16 v[76:79], v[32:35], a[16:19], 0
    v_mfma_f32_16x16x32_bf16 v[76:79], v[36:39], a[20:23], v[76:79]
    v_mfma_f32_16x16x32_bf16 v[76:79], v[40:43], a[24:27], v[76:79]
    v_mfma_f32_16x16x32_bf16 v[76:79], v[44:47], a[28:31], v[76:79]
    v_mfma_f32_16x16x32_bf16 v[80:83], v[32:35], a[32:35], 0
    v_mfma_f32_16x16x32_bf16 v[80:83], v[36:39], a[36:39], v[80:83]
    v_mfma_f32_16x16x32_bf16 v[80:83], v[40:43], a[40:43], v[80:83]
    v_mfma_f32_16x16x32_bf16 v[80:83], v[44:47], a[44:47], v[80:83]
    v_mov_b32_dpp v4, v72 quad_perm:[0,1,2,3] row_mask:0x1 bank_mask:0xf
    v_mov_b32_dpp v5, v73 quad_perm:[0,1,2,3] row_mask:0x1 bank_mask:0xf
    v_mov_b32_dpp v6, v74 quad_perm:[0,1,2,3] row_mask:0x1 bank_mask:0xf
    v_mov_b32_dpp v7, v75 quad_perm:[0,1,2,3] row_mask:0x1 bank_mask:0xf
    v_mfma_f32_16x16x32_bf16 v[84:87], v[32:35], a[48:51], 0
    v_mfma_f32_16x16x32_bf16 v[84:87], v[36:39], a[52:55], v[84:87]
    v_mfma_f32_16x16x32_bf16 v[84:87], v[40:43], a[56:59], v[84:87]
    v_mfma_f32_16x16x32_bf16 v[84:87], v[44:47], a[60:63], v[84:87]
    v_mov_b32_dpp v4, v76 quad_perm:[0,1,2,3] row_mask:0x2 bank_mask:0xf
    v_mov_b32_dpp v5, v77 quad_perm:[0,1,2,3] row_mask:0x2 bank_mask:0xf
    v_mov_b32_dpp v6, v78 quad_perm:[0,1,2,3] row_mask:0x2 bank_mask:0xf
    v_mov_b32_dpp v7, v79 quad_perm:[0,1,2,3] row_mask:0x2 bank_mask:0xf
    v_mfma_f32_16x16x32_bf16 v[88:91], v[32:35], a[64:67], 0
    v_mfma_f32_16x16x32_bf16 v[88:91], v[36:39], a[68:71], v[88:91]
    v_mfma_f32_16x16x32_bf16 v[88:91], v[40:43], a[72:75], v[88:91]
    v_mfma_f32_16x16x32_bf16 v[88:91], v[44:47], a[76:79], v[88:91]
    v_mov_b32_dpp v4, v80 quad_perm:[0,1,2,3] row_mask:0x4 bank_mask:0xf
    v_mov_b32_dpp v5, v81 quad_perm:[0,1,2,3] row_mask:0x4 bank_mask:0xf
    v_mov_b32_dpp v6, v82 quad_perm:[0,1,2,3] row_mask:0x4 bank_mask:0xf
    v_mov_b32_dpp v7, v83 quad_perm:[0,1,2,3] row_mask:0x4 bank_mask:0xf
    v_mfma_f32_16x16x32_bf16 v[92:95], v[32:35], a[80:83], 0
    v_mfma_f32_16x16x32_bf16 v[92:95], v[36:39], a[84:87], v[92:95]
    v_mfma_f32_16x16x32_bf16 v[92:95], v[40:43], a[88:91], v[92:95]
    v_mfma_f32_16x16x32_bf16 v[92:95], v[44:47], a[92:95], v[92:95]
    v_mov_b32_dpp v4, v84 quad_perm:[0,1,2,3] row_mask:0x8 bank_mask:0xf
    v_mov_b32_dpp v5, v85 quad_perm:[0,1,2,3] row_mask:0x8 bank_mask:0xf
    v_mov_b32_dpp v6, v86 quad_perm:[0,1,2,3] row_mask:0x8 bank_mask:0xf
    v_mov_b32_dpp v7, v87 quad_perm:[0,1,2,3] row_mask:0x8 bank_mask:0xf
    v_mfma_f32_16x16x32_bf16 v[96:99], v[32:35], a[96:99], 0
    v_mfma_f32_16x16x32_bf16 v[96:99], v[36:39], a[100:103], v[96:99]
    v_mfma_f32_16x16x32_bf16 v[96:99], v[40:43], a[104:107], v[96:99]
    v_mfma_f32_16x16x32_bf16 v[96:99], v[44:47], a[108:111], v[96:99]
    v_mov_b32_dpp v8, v88 quad_perm:[0,1,2,3] row_mask:0x1 bank_mask:0xf
    v_mov_b32_dpp v9, v89 quad_perm:[0,1,2,3] row_mask:0x1 bank_mask:0xf
    v_mov_b32_dpp v10, v90 quad_perm:[0,1,2,3] row_mask:0x1 bank_mask:0xf
    v_mov_b32_dpp v11, v91 quad_perm:[0,1,2,3] row_mask:0x1 bank_mask:0xf
    v_mfma_f32_16x16x32_bf16 v[100:103], v[32:35], a[112:115], 0
    v_mfma_f32_16x16x32_bf16 v[100:103], v[36:39], a[116:119], v[100:103]
    v_mfma_f32_16x16x32_bf16 v[100:103], v[40:43], a[120:123], v[100:103]
    v_mfma_f32_16x16x32_bf16 v[100:103], v[44:47], a[124:127], v[100:103]
    v_mov_b32_dpp v8, v92 quad_perm:[0,1,2,3] row_mask:0x2 bank_mask:0xf
    v_mov_b32_dpp v9, v93 quad_perm:[0,1,2,3] row_mask:0x2 bank_mask:0xf
    v_mov_b32_dpp v10, v94 quad_perm:[0,1,2,3] row_mask:0x2 bank_mask:0xf
    v_mov_b32_dpp v11, v95 quad_perm:[0,1,2,3] row_mask:0x2 bank_mask:0xf
    v_mov_b32_dpp v8, v96 quad_perm:[0,1,2,3] row_mask:0x4 bank_mask:0xf
    v_mov_b32_dpp v9, v97 quad_perm:[0,1,2,3] row_mask:0x4 bank_mask:0xf
    v_mov_b32_dpp v10, v98 quad_perm:[0,1,2,3] row_mask:0x4 bank_mask:0xf
    v_mov_b32_dpp v11, v99 quad_perm:[0,1,2,3] row_mask:0x4 bank_mask:0xf
    v_mov_b32_dpp v8, v100 quad_perm:[0,1,2,3] row_mask:0x8 bank_mask:0xf
    v_mov_b32_dpp v9, v101 quad_perm:[0,1,2,3] row_mask:0x8 bank_mask:0xf
    v_mov_b32_dpp v10, v102 quad_perm:[0,1,2,3] row_mask:0x8 bank_mask:0xf
    v_mov_b32_dpp v11, v103 quad_perm:[0,1,2,3] row_mask:0x8 bank_mask:0xf
    v_cvt_pk_bf16_f32 v12, v4, v5
    v_cvt_pk_bf16_f32 v13, v6, v7
    v_cvt_pk_bf16_f32 v14, v8, v9
    v_cvt_pk_bf16_f32 v15, v10, v11
    s_mov_b32 s20, s58
    s_mov_b32 s21, s59
    s_mov_b32 s22, 0x2000
    s_mov_b32 s23, 0x20000
    v_and_b32 v3, 3, v0
    v_lshlrev_b32 v80, 4, v3
    v_bfe_u32 v4, v0, 2, 1
    v_lshl_add_u32 v80, v4, 3, v80
    v_lshrrev_b32 v5, 3, v0
    v_lshl_add_u32 v80, v5, 6, v80
    v_lshlrev_b32 v82, 11, v3
    v_lshl_add_u32 v82, v4, 3, v82
    v_lshrrev_b32 v3, 4, v0
    v_lshl_add_u32 v82, v3, 4, v82
    v_and_b32 v5, 1, v5
    v_lshl_add_u32 v82, v5, 6, v82
    v_and_b32 v81, 0xf0, v2
    v_lshl_add_u32 v81, v3, 14, v81
    v_cmp_eq_u32 vcc, 0, v5
    v_mov_b32 v3, 0x3f803f80
    s_nop 0
    v_cndmask_b32 v4, 0, v3, vcc
    v_xor_b32 v5, v3, v4
    v_and_b32 v84, v4, v20
    v_and_b32 v88, v5, v20
    v_and_b32 v85, v4, v21
    v_and_b32 v89, v5, v21
    v_and_b32 v86, v4, v22
    v_and_b32 v90, v5, v22
    v_and_b32 v87, v4, v23
    v_and_b32 v91, v5, v23
    s_lshl_b32 s30, s3, 12
    s_add_u32 s30, s30, 0x80000
    s_lshl_b32 s24, s26, 14
    s_add_u32 s24, s24, s30
    buffer_store_dwordx2 v[12:13], v80, s[12:15], s24 offen sc1 nt
    buffer_store_dwordx2 v[14:15], v80, s[12:15], s24 offen offset:512 sc1 nt
    s_lshl_b32 s24, s3, 7
    s_add_u32 s24, s24, 0x1b6400
    s_waitcnt vmcnt(0)
    s_mov_b64 exec, 1
    v_mov_b32 v83, 64
    buffer_atomic_add v83, off, s[12:15], s24 sc0
    s_mov_b64 exec, -1
    s_waitcnt vmcnt(0)
    v_readfirstlane_b32 s24, v83
    s_nop 0
    s_cmp_lg_u32 s24, 1983
    s_cbranch_scc1 L_W_x
    s_lshl_b32 s31, s3, 8
L_W_f:
    s_mov_b32 s25, 262144
L_fi16:
    s_mov_b32 s24, s30
    buffer_load_dwordx4 v[128:131], v81, s[12:15], s24 offen offset:0 sc1 nt
    buffer_load_dwordx4 v[132:135], v81, s[12:15], s24 offen offset:256 sc1 nt
    s_add_u32 s24, s24, 65536
    buffer_load_dwordx4 v[136:139], v81, s[12:15], s24 offen offset:0 sc1 nt
    buffer_load_dwordx4 v[140:143], v81, s[12:15], s24 offen offset:256 sc1 nt
    s_add_u32 s24, s24, 65536
    buffer_load_dwordx4 v[144:147], v81, s[12:15], s24 offen offset:0 sc1 nt
    buffer_load_dwordx4 v[148:151], v81, s[12:15], s24 offen offset:256 sc1 nt
    s_add_u32 s24, s24, 65536
    buffer_load_dwordx4 v[152:155], v81, s[12:15], s24 offen offset:0 sc1 nt
    buffer_load_dwordx4 v[156:159], v81, s[12:15], s24 offen offset:256 sc1 nt
    s_add_u32 s24, s24, 65536
    buffer_load_dwordx4 v[160:163], v81, s[12:15], s24 offen offset:0 sc1 nt
    buffer_load_dwordx4 v[164:167], v81, s[12:15], s24 offen offset:256 sc1 nt
    s_add_u32 s24, s24, 65536
    buffer_load_dwordx4 v[168:171], v81, s[12:15], s24 offen offset:0 sc1 nt
    buffer_load_dwordx4 v[172:175], v81, s[12:15], s24 offen offset:256 sc1 nt
    s_add_u32 s24, s24, 65536
    buffer_load_dwordx4 v[176:179], v81, s[12:15], s24 offen offset:0 sc1 nt
    buffer_load_dwordx4 v[180:183], v81, s[12:15], s24 offen offset:256 sc1 nt
    s_add_u32 s24, s24, 65536
    buffer_load_dwordx4 v[184:187], v81, s[12:15], s24 offen offset:0 sc1 nt
    buffer_load_dwordx4 v[188:191], v81, s[12:15], s24 offen offset:256 sc1 nt
    s_waitcnt vmcnt(15)
    v_mfma_f32_16x16x32_bf16 v[92:95], v[128:131], v[84:87], 0
    s_waitcnt vmcnt(14)
    v_mfma_f32_16x16x32_bf16 v[92:95], v[132:135], v[88:91], v[92:95]
    s_waitcnt vmcnt(13)
    v_mfma_f32_16x16x32_bf16 v[92:95], v[136:139], v[84:87], v[92:95]
    s_waitcnt vmcnt(12)
    v_mfma_f32_16x16x32_bf16 v[92:95], v[140:143], v[88:91], v[92:95]
    s_waitcnt vmcnt(11)
    v_mfma_f32_16x16x32_bf16 v[92:95], v[144:147], v[84:87], v[92:95]
    s_waitcnt vmcnt(10)
    v_mfma_f32_16x16x32_bf16 v[92:95], v[148:151], v[88:91], v[92:95]
    s_waitcnt vmcnt(9)
    v_mfma_f32_16x16x32_bf16 v[92:95], v[152:155], v[84:87], v[92:95]
    s_waitcnt vmcnt(8)
    v_mfma_f32_16x16x32_bf16 v[92:95], v[156:159], v[88:91], v[92:95]
    s_waitcnt vmcnt(7)
    v_mfma_f32_16x16x32_bf16 v[92:95], v[160:163], v[84:87], v[92:95]
    s_waitcnt vmcnt(6)
    v_mfma_f32_16x16x32_bf16 v[92:95], v[164:167], v[88:91], v[92:95]
    s_waitcnt vmcnt(5)
    v_mfma_f32_16x16x32_bf16 v[92:95], v[168:171], v[84:87], v[92:95]
    s_waitcnt vmcnt(4)
    v_mfma_f32_16x16x32_bf16 v[92:95], v[172:175], v[88:91], v[92:95]
    s_waitcnt vmcnt(3)
    v_mfma_f32_16x16x32_bf16 v[92:95], v[176:179], v[84:87], v[92:95]
    s_waitcnt vmcnt(2)
    v_mfma_f32_16x16x32_bf16 v[92:95], v[180:183], v[88:91], v[92:95]
    s_waitcnt vmcnt(1)
    v_mfma_f32_16x16x32_bf16 v[92:95], v[184:187], v[84:87], v[92:95]
    s_waitcnt vmcnt(0)
    v_mfma_f32_16x16x32_bf16 v[92:95], v[188:191], v[88:91], v[92:95]
    s_nop 7
    v_cmp_u_f32 vcc, v92, v93
    v_cmp_u_f32 s[68:69], v94, v95
    v_cvt_pk_bf16_f32 v4, v92, v93
    v_cvt_pk_bf16_f32 v5, v94, v95
    s_or_b64 vcc, vcc, s[68:69]
    s_cbranch_scc0 L_fi16_x
    v_max_u32 v3, v128, v129
    v_max3_u32 v3, v3, v130, v131
    v_max3_u32 v3, v3, v132, v133
    v_max3_u32 v3, v3, v134, v135
    v_max3_u32 v3, v3, v136, v137
    v_max3_u32 v3, v3, v138, v139
    v_max3_u32 v3, v3, v140, v141
    v_max3_u32 v3, v3, v142, v143
    v_max3_u32 v3, v3, v144, v145
    v_max3_u32 v3, v3, v146, v147
    v_max3_u32 v3, v3, v148, v149
    v_max3_u32 v3, v3, v150, v151
    v_max3_u32 v3, v3, v152, v153
    v_max3_u32 v3, v3, v154, v155
    v_max3_u32 v3, v3, v156, v157
    v_max3_u32 v3, v3, v158, v159
    v_max3_u32 v3, v3, v160, v161
    v_max3_u32 v3, v3, v162, v163
    v_max3_u32 v3, v3, v164, v165
    v_max3_u32 v3, v3, v166, v167
    v_max3_u32 v3, v3, v168, v169
    v_max3_u32 v3, v3, v170, v171
    v_max3_u32 v3, v3, v172, v173
    v_max3_u32 v3, v3, v174, v175
    v_max3_u32 v3, v3, v176, v177
    v_max3_u32 v3, v3, v178, v179
    v_max3_u32 v3, v3, v180, v181
    v_max3_u32 v3, v3, v182, v183
    v_max3_u32 v3, v3, v184, v185
    v_max3_u32 v3, v3, v186, v187
    v_max3_u32 v3, v3, v188, v189
    v_max3_u32 v3, v3, v190, v191
    v_cmp_eq_u32 vcc, -1, v3
    s_sub_u32 s25, s25, 1
    s_cmp_eq_u32 s25, 0
    s_cbranch_scc1 L_fi16_x
    s_cmp_lg_u64 vcc, 0
    s_cbranch_scc1 L_fi16
L_fi16_x:
    buffer_store_dwordx2 v[4:5], v82, s[20:23], s31 offen
    s_add_u32 s30, s30, 512
    s_add_u32 s31, s31, 128
    s_bitcmp1_b32 s31, 7
    s_cbranch_scc1 L_W_f
L_W_x:
    s_barrier
L_R:
    s_mov_b32 s20, s58
    s_mov_b32 s21, s59
    s_mov_b32 s22, 0x2000
    s_mov_b32 s23, 0x20000
    v_and_b32 v3, 1, v0
    v_lshlrev_b32 v3, 4, v3
    v_mov_b32 v4, 0xffff
    v_lshlrev_b32 v4, v3, v4
    v_bfe_u32 v3, v0, 1, 2
    v_cmp_eq_u32 vcc, 0, v3
    s_nop 1
    v_cndmask_b32 v20, 0, v4, vcc
    v_cmp_eq_u32 vcc, 1, v3
    s_nop 1
    v_cndmask_b32 v21, 0, v4, vcc
    v_cmp_eq_u32 vcc, 2, v3
    s_nop 1
    v_cndmask_b32 v22, 0, v4, vcc
    v_cmp_eq_u32 vcc, 3, v3
    s_nop 1
    v_cndmask_b32 v23, 0, v4, vcc
    v_lshrrev_b32 v3, 4, v0
    v_and_b32 v4, 7, v0
    v_bfe_u32 v7, v0, 3, 1
    v_lshl_add_u32 v5, v3, 3, v4
    v_mul_u32_u24 v6, 320, v7
    v_lshl_add_u32 v5, v5, 3, v6
    s_mul_i32 s24, s3, 1280
    s_add_u32 s24, s24, 135168
    v_add_u32 v24, s24, v5
    v_and_b32 v5, 3, v0
    v_mul_u32_u24 v25, 320, v5
    v_lshl_add_u32 v25, v3, 4, v25
    v_add_u32 v25, 135168, v25
    v_lshlrev_b32 v26, 4, v4
    v_lshl_add_u32 v26, v7, 3, v26
    v_and_b32 v5, 15, v0
    v_lshlrev_b32 v28, 11, v3
    v_lshl_add_u32 v28, v5, 1, v28
    s_and_b32 s24, s74, 7
    s_lshl_b32 s24, s24, 3
    s_bfm_b64 s[44:45], 8, s24
    s_not_b64 s[44:45], s[44:45]
    v_min_u32 v6, 5, v4
    v_lshrrev_b32 v5, 1, v6
    v_and_b32 v8, 1, v3
    v_mad_u32_u24 v5, v8, 3, v5
    v_lshlrev_b32 v31, 10, v5
    v_and_b32 v6, 1, v6
    v_lshl_add_u32 v6, v7, 1, v6
    v_lshl_add_u32 v31, v6, 4, v31
    s_and_b32 s35, s72, 7
    s_lshl_b32 s35, s35, 7
    s_add_u32 s35, s35, 0x1b0000
    s_lshr_b32 s34, s72, 3
    s_mul_i32 s34, s34, 6
    s_mul_i32 s29, s3, 6144
    s_add_u32 s29, s29, s35
    s_mov_b32 s24, 262144
    s_branch L_pd17_in
L_pd17:
    s_sleep 64
L_pd17_in:
    buffer_load_dwordx2 v[8:9], v31, s[12:15], s29 offen sc1
    s_waitcnt vmcnt(0)
    v_max_u32 v3, v8, v9
    v_cmp_eq_u32 vcc, -1, v3
    s_sub_u32 s24, s24, 1
    s_cmp_eq_u32 s24, 0
    s_cbranch_scc1 L_pd17_x
    s_and_b64 exec, exec, vcc
    s_cbranch_scc1 L_pd17
L_pd17_x:
    s_mov_b64 exec, -1
    v_mov_b32 v6, v8
    s_nop 1
    v_max_f32_dpp v6, v6, v6 quad_perm:[1,0,3,2] row_mask:0xf bank_mask:0xf
    s_nop 1
    v_max_f32_dpp v6, v6, v6 quad_perm:[2,3,0,1] row_mask:0xf bank_mask:0xf
    s_nop 1
    v_max_f32_dpp v6, v6, v6 row_half_mirror row_mask:0xf bank_mask:0xf
    v_sub_f32 v8, v8, v6
    v_exp_f32 v8, v8
    v_cmp_gt_u32 vcc, 6, v4
    s_nop 1
    v_cndmask_b32 v8, 0, v8, vcc
    v_mul_f32 v9, v8, v9
    s_nop 1
    v_add_f32_dpp v9, v9, v9 quad_perm:[1,0,3,2] row_mask:0xf bank_mask:0xf
    s_nop 1
    v_add_f32_dpp v9, v9, v9 quad_perm:[2,3,0,1] row_mask:0xf bank_mask:0xf
    s_nop 1
    v_add_f32_dpp v9, v9, v9 row_half_mirror row_mask:0xf bank_mask:0xf
    v_rcp_f32 v9, v9
    s_nop 0
    v_mul_f32 v8, v8, v9
    v_cvt_pk_bf16_f32 v8, v8, v8
    v_lshrrev_b32 v3, 4, v0
    v_mul_u32_u24 v9, 6, v7
    v_sub_u32 v3, v3, v9
    v_lshlrev_b32 v9, 3, v7
    v_add_u32 v5, 0, v3
    v_min_u32 v5, 6, v5
    v_add_u32 v5, v5, v9
    v_lshlrev_b32 v5, 2, v5
    ds_bpermute_b32 v10, v5, v8
    ds_bpermute_b32 v13, v5, v8 offset:64
    v_add_u32 v5, 4, v3
    v_min_u32 v5, 6, v5
    v_add_u32 v5, v5, v9
    v_lshlrev_b32 v5, 2, v5
    ds_bpermute_b32 v11, v5, v8
    ds_bpermute_b32 v14, v5, v8 offset:64
    v_add_u32 v5, 8, v3
    v_min_u32 v5, 6, v5
    v_add_u32 v5, v5, v9
    v_lshlrev_b32 v5, 2, v5
    ds_bpermute_b32 v12, v5, v8
    ds_bpermute_b32 v15, v5, v8 offset:64
    s_waitcnt lgkmcnt(0)
    v_and_b32 v32, v10, v20
    v_and_b32 v33, v10, v21
    v_and_b32 v34, v10, v22
    v_and_b32 v35, v10, v23
    v_and_b32 v36, v11, v20
    v_and_b32 v37, v11, v21
    v_and_b32 v38, v11, v22
    v_and_b32 v39, v11, v23
    v_and_b32 v40, v12, v20
    v_and_b32 v41, v12, v21
    v_and_b32 v42, v12, v22
    v_and_b32 v43, v12, v23
    v_and_b32 v44, v13, v20
    v_and_b32 v45, v13, v21
    v_and_b32 v46, v13, v22
    v_and_b32 v47, v13, v23
    v_and_b32 v48, v14, v20
    v_and_b32 v49, v14, v21
    v_and_b32 v50, v14, v22
    v_and_b32 v51, v14, v23
    v_and_b32 v52, v15, v20
    v_and_b32 v53, v15, v21
    v_and_b32 v54, v15, v22
    v_and_b32 v55, v15, v23
    s_and_b32 s24, s3, 1
    s_lshl_b32 s24, s24, 1
    s_and_b32 s29, s3, 2
    s_lshl_b32 s29, s29, 3
    s_or_b32 s29, s29, s24
    s_and_b32 s24, s26, 13
    s_or_b32 s29, s29, s24
    s_mul_i32 s29, s29, 6144
    s_add_u32 s29, s29, 0x180000
    s_add_u32 s42, s29, 4096
    s_lshr_b32 s24, s74, 3
    s_lshl_b32 s24, s24, 2
    s_add_u32 s24, s24, s3
    s_lshl_b32 s36, s24, 10
    s_add_u32 s36, s36, 0x1b7800
    s_and_b32 s37, s74, 7
    s_lshl_b32 s37, s37, 7
    s_add_u32 s37, s37, s36
    s_lshl_b32 s38, s24, 7
    s_add_u32 s38, s38, 0x1b6800
    s_lshl_b32 s39, s24, 5
    s_add_u32 s39, s39, 1024
    s_mov_b32 s30, 0x600000
    s_mov_b32 s31, s30
    s_mov_b32 s40, s30
    s_mov_b32 s41, s30
    s_mov_b32 s33, 0
    s_branch L_P_go
L_P:
    s_mov_b64 s[30:31], s[36:37]
    s_mov_b64 s[40:41], s[38:39]
    s_mov_b32 s33, 447
    s_cmp_lg_u32 s3, 0
    s_cbranch_scc1 L_H_x
    s_lshr_b32 s24, s74, 5
    s_mul_i32 s25, s24, 3
    s_add_u32 s34, s34, s25
    s_lshl_b32 s24, s24, 6
    s_add_u32 s24, s24, s26
    s_lshl_b32 s24, s24, 20
    s_add_u32 s4, s52, s24
    s_addc_u32 s5, s53, 0
    s_mov_b32 s6, 0x100000
    s_mov_b32 s7, 0x20000
    s_add_u32 s8, s4, 0x2000000
    s_addc_u32 s9, s5, 0
    s_mov_b32 s10, s6
    s_mov_b32 s11, 0x20000
    v_lshrrev_b32 v3, 4, v0
    v_mul_u32_u24 v16, 6144, v3
    v_and_b32 v3, 15, v0
    v_lshl_add_u32 v16, v3, 7, v16
    v_lshlrev_b32 v17, 10, v0
    v_mov_b32 v18, 0
    s_mov_b32 s27, 43
    s_mov_b32 s28, 43
    s_mov_b32 s32, 43
    s_mov_b32 s75, 1024
L_H:
    s_sub_u32 s75, s75, 1
    s_cmp_eq_u32 s75, 0
    s_cbranch_scc1 L_H_x
    s_mov_b64 exec, 0xffffff
    buffer_load_dword v18, v17, s[12:15], s35 offen offset:64 sc1
    s_mov_b64 exec, -1
    s_waitcnt vmcnt(0)
    v_max_i32 v19, 0, v18
    s_nop 1
    v_add_u32_dpp v3, v19, v19 row_ror:8 row_mask:0xf bank_mask:0xf
    s_nop 1
    v_add_u32_dpp v3, v3, v3 row_ror:4 row_mask:0xf bank_mask:0xf
    s_nop 1
    v_add_u32_dpp v3, v3, v3 row_ror:2 row_mask:0xf bank_mask:0xf
    s_nop 1
    v_add_u32_dpp v3, v3, v3 row_ror:1 row_mask:0xf bank_mask:0xf
    s_nop 0
    v_readlane_b32 s70, v3, 0
    v_readlane_b32 s24, v3, 16
    s_nop 0
    s_add_u32 s70, s70, s24
    s_add_u32 s24, s34, 0
    s_nop 0
    v_readlane_b32 s24, v19, s24
    s_sub_u32 s25, 43, s27
    s_mul_i32 s25, s25, 17
    s_mul_i32 s64, s24, 24
    s_add_u32 s64, s64, s25
    s_add_u32 s24, s24, 8
    s_cmp_gt_u32 s24, s27
    s_cselect_b32 s64, 0xffff, s64
    s_add_u32 s24, s34, 1
    v_readlane_b32 s24, v19, s24
    s_sub_u32 s25, 43, s28
    s_mul_i32 s25, s25, 17
    s_mul_i32 s65, s24, 24
    s_add_u32 s65, s65, s25
    s_add_u32 s24, s24, 8
    s_cmp_gt_u32 s24, s28
    s_cselect_b32 s65, 0xffff, s65
    s_add_u32 s24, s34, 2
    v_readlane_b32 s24, v19, s24
    s_sub_u32 s25, 43, s32
    s_mul_i32 s25, s25, 17
    s_mul_i32 s66, s24, 24
    s_add_u32 s66, s66, s25
    s_add_u32 s24, s24, 8
    s_cmp_gt_u32 s24, s32
    s_cselect_b32 s66, 0xffff, s66
    s_min_u32 s71, s64, s65
    s_min_u32 s71, s71, s66
    s_cmp_eq_u32 s71, 0xffff
    s_cbranch_scc1 L_H_x
    s_add_u32 s24, s71, 36
    s_cmp_lt_i32 s24, s70
    s_cbranch_scc1 L_H_go
    s_sleep 4
    s_branch L_H
L_H_go:
    s_cmp_lg_u32 s71, s64
    s_cbranch_scc1 L_H_n0
    s_sub_u32 s27, s27, 2
    s_mul_i32 s24, s27, 24576
    s_add_u32 s24, s24, 0
    s_branch L_H_ld
L_H_n0:
    s_cmp_lg_u32 s71, s65
    s_cbranch_scc1 L_H_n1
    s_sub_u32 s28, s28, 2
    s_mul_i32 s24, s28, 24576
    s_add_u32 s24, s24, 2048
    s_branch L_H_ld
L_H_n1:
    s_sub_u32 s32, s32, 2
    s_mul_i32 s24, s32, 24576
    s_add_u32 s24, s24, 4096
L_H_ld:
    buffer_load_dword v5, v16, s[4:7], s24 offen
    buffer_load_dword v5, v16, s[8:11], s24 offen
    s_add_u32 s24, s24, 24576
    buffer_load_dword v5, v16, s[4:7], s24 offen
    buffer_load_dword v5, v16, s[8:11], s24 offen
    s_branch L_H
L_H_x:
    s_barrier
    s_mov_b32 s24, 262144
L_pd18:
    buffer_load_dwordx4 v[56:59], v2, s[12:15], s29 offen offset:0 sc1
    buffer_load_dwordx4 v[60:63], v2, s[12:15], s29 offen offset:1024 sc1
    buffer_load_dwordx4 v[64:67], v2, s[12:15], s29 offen offset:2048 sc1
    buffer_load_dwordx4 v[68:71], v2, s[12:15], s29 offen offset:3072 sc1
    buffer_load_dwordx4 v[72:75], v2, s[12:15], s42 offen offset:0 sc1
    buffer_load_dwordx4 v[76:79], v2, s[12:15], s42 offen offset:1024 sc1
    s_waitcnt vmcnt(0)
    v_max_u32 v3, v56, v57
    v_max3_u32 v3, v3, v58, v59
    v_max3_u32 v3, v3, v60, v61
    v_max3_u32 v3, v3, v62, v63
    v_max3_u32 v3, v3, v64, v65
    v_max3_u32 v3, v3, v66, v67
    v_max3_u32 v3, v3, v68, v69
    v_max3_u32 v3, v3, v70, v71
    v_max3_u32 v3, v3, v72, v73
    v_max3_u32 v3, v3, v74, v75
    v_max3_u32 v3, v3, v76, v77
    v_max3_u32 v3, v3, v78, v79
    v_cmp_eq_u32 vcc, -1, v3
    s_sub_u32 s24, s24, 1
    s_cmp_eq_u32 s24, 0
    s_cbranch_scc1 L_pd18_x
    s_and_b64 exec, exec, vcc
    s_cbranch_scc1 L_pd18
L_pd18_x:
    s_mov_b64 exec, -1
L_P_go:
    v_mfma_f32_16x16x32_bf16 v[12:15], v[56:59], v[32:35], 0
    v_mfma_f32_16x16x32_bf16 v[16:19], v[68:71], v[44:47], 0
    v_mfma_f32_16x16x32_bf16 v[12:15], v[60:63], v[36:39], v[12:15]
    v_mfma_f32_16x16x32_bf16 v[16:19], v[72:75], v[48:51], v[16:19]
    v_mfma_f32_16x16x32_bf16 v[12:15], v[64:67], v[40:43], v[12:15]
    v_mfma_f32_16x16x32_bf16 v[16:19], v[76:79], v[52:55], v[16:19]
    s_barrier
    s_mov_b64 exec, 1
    v_mov_b32 v83, 64
    buffer_atomic_add v83, off, s[12:15], s40 sc0
    s_mov_b64 exec, -1
    s_nop 1
    v_cvt_pk_bf16_f32 v4, v12, v13
    v_cvt_pk_bf16_f32 v5, v14, v15
    ds_write_b64 v24, v[4:5]
    v_cvt_pk_bf16_f32 v6, v16, v17
    v_cvt_pk_bf16_f32 v7, v18, v19
    ds_write_b64 v24, v[6:7] offset:640
    s_waitcnt lgkmcnt(0)
    s_barrier
    ds_read_b128 v[128:131], v25 offset:0
    ds_read_b128 v[132:135], v25 offset:64
    ds_read_b128 v[136:139], v25 offset:128
    ds_read_b128 v[140:143], v25 offset:192
    ds_read_b128 v[144:147], v25 offset:1280
    ds_read_b128 v[148:151], v25 offset:1344
    ds_read_b128 v[152:155], v25 offset:1408
    ds_read_b128 v[156:159], v25 offset:1472
    ds_read_b128 v[160:163], v25 offset:2560
    s_waitcnt lgkmcnt(8)
    v_mfma_f32_16x16x32_bf16 v[12:15], v[128:131], a[128:131], 0
    ds_read_b128 v[164:167], v25 offset:2624
    s_waitcnt lgkmcnt(8)
    v_mfma_f32_16x16x32_bf16 v[12:15], v[132:135], a[132:135], v[12:15]
    ds_read_b128 v[168:171], v25 offset:2688
    s_waitcnt lgkmcnt(8)
    v_mfma_f32_16x16x32_bf16 v[12:15], v[136:139], a[136:139], v[12:15]
    ds_read_b128 v[172:175], v25 offset:2752
    s_waitcnt lgkmcnt(8)
    v_mfma_f32_16x16x32_bf16 v[12:15], v[140:143], a[140:143], v[12:15]
    ds_read_b128 v[176:179], v25 offset:3840
    s_waitcnt lgkmcnt(8)
    v_mfma_f32_16x16x32_bf16 v[12:15], v[144:147], a[144:147], v[12:15]
    ds_read_b128 v[180:183], v25 offset:3904
    s_waitcnt lgkmcnt(8)
    v_mfma_f32_16x16x32_bf16 v[12:15], v[148:151], a[148:151], v[12:15]
    ds_read_b128 v[184:187], v25 offset:3968
    s_waitcnt lgkmcnt(8)
    v_mfma_f32_16x16x32_bf16 v[12:15], v[152:155], a[152:155], v[12:15]
    ds_read_b128 v[188:191], v25 offset:4032
    s_waitcnt lgkmcnt(8)
    v_mfma_f32_16x16x32_bf16 v[12:15], v[156:159], a[156:159], v[12:15]
    s_waitcnt lgkmcnt(7)
    v_mfma_f32_16x16x32_bf16 v[12:15], v[160:163], a[160:163], v[12:15]
    s_waitcnt lgkmcnt(6)
    v_mfma_f32_16x16x32_bf16 v[12:15], v[164:167], a[164:167], v[12:15]
    s_waitcnt lgkmcnt(5)
    v_mfma_f32_16x16x32_bf16 v[12:15], v[168:171], a[168:171], v[12:15]
    s_waitcnt lgkmcnt(4)
    v_mfma_f32_16x16x32_bf16 v[12:15], v[172:175], a[172:175], v[12:15]
    s_waitcnt lgkmcnt(3)
    v_mfma_f32_16x16x32_bf16 v[12:15], v[176:179], a[176:179], v[12:15]
    s_waitcnt lgkmcnt(2)
    v_mfma_f32_16x16x32_bf16 v[12:15], v[180:183], a[180:183], v[12:15]
    s_waitcnt lgkmcnt(1)
    v_mfma_f32_16x16x32_bf16 v[12:15], v[184:187], a[184:187], v[12:15]
    s_waitcnt lgkmcnt(0)
    v_mfma_f32_16x16x32_bf16 v[12:15], v[188:191], a[188:191], v[12:15]
    s_nop 7
    v_cvt_pk_bf16_f32 v4, v12, v13
    v_cvt_pk_bf16_f32 v5, v14, v15
    s_mov_b64 exec, 0xffff
    buffer_store_dwordx2 v[4:5], v26, s[12:15], s31 offen sc1
    s_mov_b64 exec, -1
    v_mov_b32 v16, v4
    v_mov_b32 v17, v5
    v_mov_b32 v18, v4
    v_mov_b32 v19, v5
    v_mov_b32_dpp v16, v4 row_ror:8 row_mask:0xf bank_mask:0xc
    v_mov_b32_dpp v17, v5 row_ror:8 row_mask:0xf bank_mask:0xc
    v_mov_b32_dpp v18, v4 row_ror:8 row_mask:0xf bank_mask:0x3
    v_mov_b32_dpp v19, v5 row_ror:8 row_mask:0xf bank_mask:0x3
    s_waitcnt vmcnt(1)
    v_readfirstlane_b32 s24, v83
    s_nop 0
    s_cmp_eq_u32 s24, s33
    s_cbranch_scc1 L_P_f
    s_waitcnt vmcnt(0)
    v_readfirstlane_b32 s24, v83
    s_nop 0
    s_cmp_lg_u32 s24, s33
    s_cbranch_scc1 L_P_n
L_P_f:
    s_mov_b64 exec, s[44:45]
    s_mov_b32 s24, 262144
L_pd19:
    buffer_load_dwordx4 v[16:19], v2, s[12:15], s30 offen sc1
    s_waitcnt vmcnt(0)
    v_max_u32 v3, v16, v17
    v_max3_u32 v3, v3, v18, v19
    v_cmp_eq_u32 vcc, -1, v3
    s_sub_u32 s24, s24, 1
    s_cmp_eq_u32 s24, 0
    s_cbranch_scc1 L_pd19_x
    s_and_b64 exec, exec, vcc
    s_cbranch_scc1 L_pd19
L_pd19_x:
    s_mov_b64 exec, -1
    v_lshlrev_b32 v56, 16, v16
    v_and_b32 v57, 0xffff0000, v16
    v_lshlrev_b32 v58, 16, v17
    v_and_b32 v59, 0xffff0000, v17
    v_lshlrev_b32 v60, 16, v18
    v_and_b32 v61, 0xffff0000, v18
    v_lshlrev_b32 v62, 16, v19
    v_and_b32 v63, 0xffff0000, v19
    v_permlane32_swap_b32 v56, v58
    v_permlane32_swap_b32 v57, v59
    v_permlane32_swap_b32 v60, v62
    v_permlane32_swap_b32 v61, v63
    v_add_f32 v56, v56, v58
    v_add_f32 v57, v57, v59
    v_add_f32 v60, v60, v62
    v_add_f32 v61, v61, v63
    v_permlane16_swap_b32 v56, v57
    s_nop 0
    v_permlane16_swap_b32 v60, v61
    v_add_f32 v56, v56, v57
    v_add_f32 v60, v60, v61
    s_nop 0
    v_add_f32_dpp v4, v56, v56 row_ror:8 row_mask:0xf bank_mask:0x3
    s_nop 1
    v_add_f32_dpp v4, v60, v60 row_ror:8 row_mask:0xf bank_mask:0xc
    v_cvt_pk_bf16_f32 v4, v4, v4
    buffer_store_short v4, v28, s[20:23], s41 offen
L_P_n:
    s_cmp_lg_u32 s33, 0
    s_cbranch_scc1 L_P_x
    s_barrier
    s_branch L_P
L_P_x:
L_end:
    s_endpgm
L_C:
    s_cmp_lg_u32 s3, 0
    s_cbranch_scc1 L_C_q
    v_lshrrev_b32 v3, 4, v0
    v_and_b32 v4, 3, v0
    v_lshlrev_b32 v5, 6, v3
    v_lshl_add_u32 v5, v4, 4, v5
    v_bfe_u32 v4, v0, 2, 2
    v_lshl_add_u32 v5, v4, 8, v5
    s_lshl_b32 s24, s26, 10
    s_add_u32 s24, s24, 0x164000
    buffer_store_dwordx4 v[8:11], v5, s[12:15], s24 offen sc1
L_C_q:
    s_waitcnt vmcnt(0)
    s_barrier
    s_cmp_lg_u32 s3, 0
    s_cbranch_scc1 L_sig20
    s_mov_b64 exec, 1
    v_mov_b32 v3, 1
    v_mov_b32 v4, 1
    buffer_atomic_add v4, off, s[16:19], 0 offset:128
    buffer_atomic_add v3, off, s[16:19], 0 offset:0 sc0
    s_waitcnt vmcnt(0)
    v_readfirstlane_b32 s24, v3
    s_mov_b64 exec, -1
    s_and_b32 s24, s24, 63
    s_cmp_lg_u32 s24, 63
    s_cbranch_scc1 L_sig20
    v_lshlrev_b32 v4, 7, v0
    v_mov_b32 v3, 1
    s_mov_b32 s24, 0x170000
    buffer_store_dword v3, v4, s[12:15], s24 offen offset:0 sc1
L_sig20:
    s_mov_b32 s8, s56
    s_mov_b32 s9, s57
    s_mov_b32 s10, 0x400000
    s_mov_b32 s11, 0x20000
    s_and_b32 s24, s3, 1
    s_lshl_b32 s24, s24, 1
    s_and_b32 s25, s3, 2
    s_lshl_b32 s25, s25, 3
    s_or_b32 s25, s25, s24
    s_and_b32 s24, s26, 13
    s_or_b32 s25, s25, s24
    s_lshl_b32 s25, s25, 17
    s_lshr_b32 s24, s74, 3
    s_lshl_b32 s24, s24, 7
    s_add_u32 s24, s24, s25
    v_lshrrev_b32 v3, 4, v0
    v_lshlrev_b32 v3, 15, v3
    v_and_b32 v4, 8, v0
    v_lshl_add_u32 v3, v4, 10, v3
    v_and_b32 v4, 0x70, v2
    v_add_u32 v3, v3, v4
    s_mul_i32 m0, s3, 16896
    s_nop 0
    buffer_load_dwordx4 v3, s[8:11], s24 offen nt lds
    s_add_u32 m0, m0, 1056
    s_add_u32 s24, s24, 2048
    buffer_load_dwordx4 v3, s[8:11], s24 offen nt lds
    s_add_u32 m0, m0, 1056
    s_add_u32 s24, s24, 2048
    buffer_load_dwordx4 v3, s[8:11], s24 offen nt lds
    s_add_u32 m0, m0, 1056
    s_add_u32 s24, s24, 2048
    buffer_load_dwordx4 v3, s[8:11], s24 offen nt lds
    s_add_u32 m0, m0, 1056
    s_add_u32 s24, s24, 10240
    buffer_load_dwordx4 v3, s[8:11], s24 offen nt lds
    s_add_u32 m0, m0, 1056
    s_add_u32 s24, s24, 2048
    buffer_load_dwordx4 v3, s[8:11], s24 offen nt lds
    s_add_u32 m0, m0, 1056
    s_add_u32 s24, s24, 2048
    buffer_load_dwordx4 v3, s[8:11], s24 offen nt lds
    s_add_u32 m0, m0, 1056
    s_add_u32 s24, s24, 2048
    buffer_load_dwordx4 v3, s[8:11], s24 offen nt lds
    s_add_u32 m0, m0, 1056
    s_add_u32 s24, s24, -21504
    buffer_load_dwordx4 v3, s[8:11], s24 offen nt lds
    s_add_u32 m0, m0, 1056
    s_add_u32 s24, s24, 2048
    buffer_load_dwordx4 v3, s[8:11], s24 offen nt lds
    s_add_u32 m0, m0, 1056
    s_add_u32 s24, s24, 2048
    buffer_load_dwordx4 v3, s[8:11], s24 offen nt lds
    s_add_u32 m0, m0, 1056
    s_add_u32 s24, s24, 2048
    buffer_load_dwordx4 v3, s[8:11], s24 offen nt lds
    s_add_u32 m0, m0, 1056
    s_add_u32 s24, s24, 10240
    buffer_load_dwordx4 v3, s[8:11], s24 offen nt lds
    s_add_u32 m0, m0, 1056
    s_add_u32 s24, s24, 2048
    buffer_load_dwordx4 v3, s[8:11], s24 offen nt lds
    s_add_u32 m0, m0, 1056
    s_add_u32 s24, s24, 2048
    buffer_load_dwordx4 v3, s[8:11], s24 offen nt lds
    s_add_u32 m0, m0, 1056
    s_add_u32 s24, s24, 2048
    buffer_load_dwordx4 v3, s[8:11], s24 offen nt lds
    s_waitcnt vmcnt(0)
    s_barrier
    v_lshrrev_b32 v3, 2, v0
    v_mul_u32_u24 v3, 1056, v3
    v_and_b32 v4, 3, v0
    v_lshl_add_u32 v3, v4, 3, v3
    s_lshl_b32 s24, s3, 5
    v_add_u32 v3, s24, v3
    ds_read_b64_tr_b16 a[128:129], v3 offset:0
    ds_read_b64_tr_b16 a[130:131], v3 offset:128
    ds_read_b64_tr_b16 a[132:133], v3 offset:256
    ds_read_b64_tr_b16 a[134:135], v3 offset:384
    ds_read_b64_tr_b16 a[136:137], v3 offset:512
    ds_read_b64_tr_b16 a[138:139], v3 offset:640
    ds_read_b64_tr_b16 a[140:141], v3 offset:768
    ds_read_b64_tr_b16 a[142:143], v3 offset:896
    ds_read_b64_tr_b16 a[144:145], v3 offset:16896
    ds_read_b64_tr_b16 a[146:147], v3 offset:17024
    ds_read_b64_tr_b16 a[148:149], v3 offset:17152
    ds_read_b64_tr_b16 a[150:151], v3 offset:17280
    ds_read_b64_tr_b16 a[152:153], v3 offset:17408
    ds_read_b64_tr_b16 a[154:155], v3 offset:17536
    ds_read_b64_tr_b16 a[156:157], v3 offset:17664
    ds_read_b64_tr_b16 a[158:159], v3 offset:17792
    ds_read_b64_tr_b16 a[160:161], v3 offset:33792
    ds_read_b64_tr_b16 a[162:163], v3 offset:33920
    ds_read_b64_tr_b16 a[164:165], v3 offset:34048
    ds_read_b64_tr_b16 a[166:167], v3 offset:34176
    ds_read_b64_tr_b16 a[168:169], v3 offset:34304
    ds_read_b64_tr_b16 a[170:171], v3 offset:34432
    ds_read_b64_tr_b16 a[172:173], v3 offset:34560
    ds_read_b64_tr_b16 a[174:175], v3 offset:34688
    ds_read_b64_tr_b16 a[176:177], v3 offset:50688
    ds_read_b64_tr_b16 a[178:179], v3 offset:50816
    ds_read_b64_tr_b16 a[180:181], v3 offset:50944
    ds_read_b64_tr_b16 a[182:183], v3 offset:51072
    ds_read_b64_tr_b16 a[184:185], v3 offset:51200
    ds_read_b64_tr_b16 a[186:187], v3 offset:51328
    ds_read_b64_tr_b16 a[188:189], v3 offset:51456
    ds_read_b64_tr_b16 a[190:191], v3 offset:51584
    s_and_b32 s70, s72, 3
    s_lshr_b32 s71, s72, 4
    s_bfe_u32 s24, s72, 0x10002
    s_lshl_b32 s24, s24, 1
    s_add_u32 s71, s71, s24
    s_bfe_u32 s75, s72, 0x10003
    s_lshl_b32 s30, s71, 22
    s_add_u32 s4, s38, s30
    s_addc_u32 s5, s39, 0
    s_mov_b32 s6, 0x400000
    s_mov_b32 s7, 0x20000
    s_mul_i32 s32, s3, 65536
    s_lshl_b32 s24, s70, 10
    s_add_u32 s32, s32, s24
    s_mul_i32 s34, s3, 16896
    s_waitcnt lgkmcnt(0)
    s_barrier
    s_mov_b32 m0, s34
    s_nop 0
    buffer_load_dwordx4 v2, s[4:7], s32 offen lds
    s_add_u32 m0, m0, 1056
    s_add_u32 s32, s32, 4096
    buffer_load_dwordx4 v2, s[4:7], s32 offen lds
    s_add_u32 m0, m0, 1056
    s_add_u32 s32, s32, 4096
    buffer_load_dwordx4 v2, s[4:7], s32 offen lds
    s_add_u32 m0, m0, 1056
    s_add_u32 s32, s32, 4096
    buffer_load_dwordx4 v2, s[4:7], s32 offen lds
    s_add_u32 m0, m0, 1056
    s_add_u32 s32, s32, 4096
    buffer_load_dwordx4 v2, s[4:7], s32 offen lds
    s_add_u32 m0, m0, 1056
    s_add_u32 s32, s32, 4096
    buffer_load_dwordx4 v2, s[4:7], s32 offen lds
    s_add_u32 m0, m0, 1056
    s_add_u32 s32, s32, 4096
    buffer_load_dwordx4 v2, s[4:7], s32 offen lds
    s_add_u32 m0, m0, 1056
    s_add_u32 s32, s32, 4096
    buffer_load_dwordx4 v2, s[4:7], s32 offen lds
    s_add_u32 m0, m0, 1056
    s_add_u32 s32, s32, 4096
    buffer_load_dwordx4 v2, s[4:7], s32 offen lds
    s_add_u32 m0, m0, 1056
    s_add_u32 s32, s32, 4096
    buffer_load_dwordx4 v2, s[4:7], s32 offen lds
    s_add_u32 m0, m0, 1056
    s_add_u32 s32, s32, 4096
    buffer_load_dwordx4 v2, s[4:7], s32 offen lds
    s_add_u32 m0, m0, 1056
    s_add_u32 s32, s32, 4096
    buffer_load_dwordx4 v2, s[4:7], s32 offen lds
    s_add_u32 m0, m0, 1056
    s_add_u32 s32, s32, 4096
    buffer_load_dwordx4 v2, s[4:7], s32 offen lds
    s_add_u32 m0, m0, 1056
    s_add_u32 s32, s32, 4096
    buffer_load_dwordx4 v2, s[4:7], s32 offen lds
    s_add_u32 m0, m0, 1056
    s_add_u32 s32, s32, 4096
    buffer_load_dwordx4 v2, s[4:7], s32 offen lds
    s_add_u32 m0, m0, 1056
    s_add_u32 s32, s32, 4096
    buffer_load_dwordx4 v2, s[4:7], s32 offen lds
    s_add_u32 m0, m0, 1056
    s_add_u32 s32, s32, 200704
    s_lshr_b32 s28, s3, 1
    s_and_b32 s29, s3, 1
    v_and_b32 v3, 15, v0
    v_lshrrev_b32 v4, 4, v0
    v_mul_u32_u24 v19, 1056, v3
    v_lshl_add_u32 v19, v4, 4, v19
    v_lshrrev_b32 v5, 2, v0
    v_mul_u32_u24 v20, 1056, v5
    v_and_b32 v5, 3, v0
    v_lshl_add_u32 v20, v5, 3, v20
    s_lshl_b32 s24, s29, 9
    v_add_u32 v20, s24, v20
    v_and_b32 v3, 15, v0
    v_mul_u32_u24 v18, 1056, v3
    v_lshl_add_u32 v18, v4, 4, v18
    v_add_u32 v18, 101376, v18
    s_mul_i32 s24, s28, 33792
    v_add_u32 v19, s24, v19
    v_add_u32 v20, s24, v20
    v_mov_b32 v128, 0
    v_mov_b32 v129, 0
    v_mov_b32 v130, 0
    v_mov_b32 v131, 0
    v_mov_b32 v132, 0
    v_mov_b32 v133, 0
    v_mov_b32 v134, 0
    v_mov_b32 v135, 0
    v_mov_b32 v136, 0
    v_mov_b32 v137, 0
    v_mov_b32 v138, 0
    v_mov_b32 v139, 0
    v_mov_b32 v140, 0
    v_mov_b32 v141, 0
    v_mov_b32 v142, 0
    v_mov_b32 v143, 0
    v_mov_b32 v144, 0
    v_mov_b32 v145, 0
    v_mov_b32 v146, 0
    v_mov_b32 v147, 0
    v_mov_b32 v148, 0
    v_mov_b32 v149, 0
    v_mov_b32 v150, 0
    v_mov_b32 v151, 0
    v_mov_b32 v152, 0
    v_mov_b32 v153, 0
    v_mov_b32 v154, 0
    v_mov_b32 v155, 0
    v_mov_b32 v156, 0
    v_mov_b32 v157, 0
    v_mov_b32 v158, 0
    v_mov_b32 v159, 0
    v_mov_b32 v160, 0
    v_mov_b32 v161, 0
    v_mov_b32 v162, 0
    v_mov_b32 v163, 0
    v_mov_b32 v164, 0
    v_mov_b32 v165, 0
    v_mov_b32 v166, 0
    v_mov_b32 v167, 0
    v_mov_b32 v168, 0
    v_mov_b32 v169, 0
    v_mov_b32 v170, 0
    v_mov_b32 v171, 0
    v_mov_b32 v172, 0
    v_mov_b32 v173, 0
    v_mov_b32 v174, 0
    v_mov_b32 v175, 0
    v_mov_b32 v176, 0
    v_mov_b32 v177, 0
    v_mov_b32 v178, 0
    v_mov_b32 v179, 0
    v_mov_b32 v180, 0
    v_mov_b32 v181, 0
    v_mov_b32 v182, 0
    v_mov_b32 v183, 0
    v_mov_b32 v184, 0
    v_mov_b32 v185, 0
    v_mov_b32 v186, 0
    v_mov_b32 v187, 0
    v_mov_b32 v188, 0
    v_mov_b32 v189, 0
    v_mov_b32 v190, 0
    v_mov_b32 v191, 0
    v_mov_b32 v22, 0xff800000
    v_mov_b32 v23, 0
    s_cmp_lg_u32 s3, 0
    s_cbranch_scc1 L_awx21
    s_mov_b32 s24, 262144
    s_mov_b64 exec, 1
L_aw22:
    buffer_load_dword v1, off, s[12:15], s73 offset:0 sc1
    s_waitcnt vmcnt(0)
    v_readfirstlane_b32 s25, v1
    s_nop 0
    s_cmp_eq_u32 s25, 1
    s_cbranch_scc1 L_awx21
    s_sleep 4
    s_sub_u32 s24, s24, 1
    s_cmp_lg_u32 s24, 0
    s_cbranch_scc1 L_aw22
L_awx21:
    s_mov_b64 exec, -1
    s_barrier
    s_lshl_b32 s24, s71, 17
    s_mul_i32 s25, s3, 16384
    s_add_u32 s24, s24, s25
    s_add_u32 s24, s24, 0x0
    s_mul_i32 s25, s75, 65536
    s_add_u32 s24, s24, s25
    buffer_load_dwordx4 v[32:35], v2, s[12:15], s24 offen sc1
    s_add_u32 s24, s24, 4096
    buffer_load_dwordx4 v[36:39], v2, s[12:15], s24 offen sc1
    s_add_u32 s24, s24, 4096
    buffer_load_dwordx4 v[40:43], v2, s[12:15], s24 offen sc1
    s_add_u32 s24, s24, 4096
    buffer_load_dwordx4 v[44:47], v2, s[12:15], s24 offen sc1
    s_add_u32 s24, s24, 4096
    s_mul_i32 s24, s3, 4224
    s_add_u32 s24, s24, 101376
    v_add_u32 v3, s24, v2
    s_waitcnt vmcnt(3)
    ds_write_b128 v3, v[32:35] offset:0
    s_waitcnt vmcnt(2)
    ds_write_b128 v3, v[36:39] offset:1056
    s_waitcnt vmcnt(1)
    ds_write_b128 v3, v[40:43] offset:2112
    s_waitcnt vmcnt(0)
    ds_write_b128 v3, v[44:47] offset:3168
    s_waitcnt lgkmcnt(0)
    s_barrier
    ds_read_b128 a[0:3], v18 offset:0
    ds_read_b128 a[4:7], v18 offset:64
    ds_read_b128 a[8:11], v18 offset:128
    ds_read_b128 a[12:15], v18 offset:192
    ds_read_b128 a[16:19], v18 offset:256
    ds_read_b128 a[20:23], v18 offset:320
    ds_read_b128 a[24:27], v18 offset:384
    ds_read_b128 a[28:31], v18 offset:448
    ds_read_b128 a[32:35], v18 offset:512
    ds_read_b128 a[36:39], v18 offset:576
    ds_read_b128 a[40:43], v18 offset:640
    ds_read_b128 a[44:47], v18 offset:704
    ds_read_b128 a[48:51], v18 offset:768
    ds_read_b128 a[52:55], v18 offset:832
    ds_read_b128 a[56:59], v18 offset:896
    ds_read_b128 a[60:63], v18 offset:960
    s_cmp_lg_u32 s3, 0
    s_cbranch_scc1 L_xi23
    s_and_b32 s24, s74, 7
    s_lshl_b32 s24, s24, 5
    s_lshr_b32 s25, s74, 3
    s_add_u32 s24, s24, s25
    s_lshl_b32 s24, s24, 2
    s_add_u32 s24, s24, 0x1b6000
    s_getreg_b32 s25, hwreg(HW_REG_XCC_ID, 0, 4)
    s_mov_b64 exec, 1
    v_mov_b32 v3, s25
    buffer_store_dword v3, off, s[12:15], s24 sc1
    s_mov_b64 exec, -1
L_xi23:
    s_mov_b32 s27, 0
    s_mov_b32 s33, 67584
    s_mov_b32 s35, 0
    s_waitcnt lgkmcnt(0)
L_CT:
    s_waitcnt vmcnt(0)
    s_barrier
    v_add_u32 v24, s35, v19
    v_add_u32 v25, s35, v20
    ds_read_b128 v[32:35], v24 offset:0
    ds_read_b128 v[36:39], v24 offset:16896
    ds_read_b128 v[40:43], v24 offset:64
    ds_read_b128 v[44:47], v24 offset:16960
    ds_read_b128 v[48:51], v24 offset:128
    ds_read_b128 v[52:55], v24 offset:17024
    ds_read_b128 v[56:59], v24 offset:192
    s_add_u32 m0, s33, s34
    s_mov_b32 s33, s35
    s_add_u32 s35, s35, 67584
    s_cmp_eq_u32 s35, 135168
    s_cselect_b32 s35, 0, s35
    s_waitcnt lgkmcnt(6)
    v_mfma_f32_16x16x32_bf16 v[64:67], v[32:35], a[0:3], 0
    ds_read_b128 v[60:63], v24 offset:17088
    buffer_load_dwordx4 v2, s[4:7], s32 offen lds
    s_add_u32 m0, m0, 1056
    s_add_u32 s32, s32, 4096
    s_waitcnt lgkmcnt(6)
    v_mfma_f32_16x16x32_bf16 v[68:71], v[36:39], a[0:3], 0
    ds_read_b128 v[32:35], v24 offset:256
    s_waitcnt lgkmcnt(6)
    v_mfma_f32_16x16x32_bf16 v[64:67], v[40:43], a[4:7], v[64:67]
    ds_read_b128 v[36:39], v24 offset:17152
    buffer_load_dwordx4 v2, s[4:7], s32 offen lds
    s_add_u32 m0, m0, 1056
    s_add_u32 s32, s32, 4096
    s_waitcnt lgkmcnt(6)
    v_mfma_f32_16x16x32_bf16 v[68:71], v[44:47], a[4:7], v[68:71]
    ds_read_b128 v[40:43], v24 offset:320
    s_waitcnt lgkmcnt(6)
    v_mfma_f32_16x16x32_bf16 v[64:67], v[48:51], a[8:11], v[64:67]
    ds_read_b128 v[44:47], v24 offset:17216
    buffer_load_dwordx4 v2, s[4:7], s32 offen lds
    s_add_u32 m0, m0, 1056
    s_add_u32 s32, s32, 4096
    s_waitcnt lgkmcnt(6)
    v_mfma_f32_16x16x32_bf16 v[68:71], v[52:55], a[8:11], v[68:71]
    ds_read_b128 v[48:51], v24 offset:384
    s_waitcnt lgkmcnt(6)
    v_mfma_f32_16x16x32_bf16 v[64:67], v[56:59], a[12:15], v[64:67]
    ds_read_b128 v[52:55], v24 offset:17280
    buffer_load_dwordx4 v2, s[4:7], s32 offen lds
    s_add_u32 m0, m0, 1056
    s_add_u32 s32, s32, 4096
    s_waitcnt lgkmcnt(6)
    v_mfma_f32_16x16x32_bf16 v[68:71], v[60:63], a[12:15], v[68:71]
    ds_read_b128 v[56:59], v24 offset:448
    s_waitcnt lgkmcnt(6)
    v_mfma_f32_16x16x32_bf16 v[64:67], v[32:35], a[16:19], v[64:67]
    ds_read_b128 v[60:63], v24 offset:17344
    buffer_load_dwordx4 v2, s[4:7], s32 offen lds
    s_add_u32 m0, m0, 1056
    s_add_u32 s32, s32, 4096
    s_waitcnt lgkmcnt(6)
    v_mfma_f32_16x16x32_bf16 v[68:71], v[36:39], a[16:19], v[68:71]
    ds_read_b128 v[32:35], v24 offset:512
    s_waitcnt lgkmcnt(6)
    v_mfma_f32_16x16x32_bf16 v[64:67], v[40:43], a[20:23], v[64:67]
    ds_read_b128 v[36:39], v24 offset:17408
    buffer_load_dwordx4 v2, s[4:7], s32 offen lds
    s_add_u32 m0, m0, 1056
    s_add_u32 s32, s32, 4096
    s_waitcnt lgkmcnt(6)
    v_mfma_f32_16x16x32_bf16 v[68:71], v[44:47], a[20:23], v[68:71]
    ds_read_b128 v[40:43], v24 offset:576
    s_waitcnt lgkmcnt(6)
    v_mfma_f32_16x16x32_bf16 v[64:67], v[48:51], a[24:27], v[64:67]
    ds_read_b128 v[44:47], v24 offset:17472
    buffer_load_dwordx4 v2, s[4:7], s32 offen lds
    s_add_u32 m0, m0, 1056
    s_add_u32 s32, s32, 4096
    s_waitcnt lgkmcnt(6)
    v_mfma_f32_16x16x32_bf16 v[68:71], v[52:55], a[24:27], v[68:71]
    ds_read_b128 v[48:51], v24 offset:640
    s_waitcnt lgkmcnt(6)
    v_mfma_f32_16x16x32_bf16 v[64:67], v[56:59], a[28:31], v[64:67]
    ds_read_b128 v[52:55], v24 offset:17536
    buffer_load_dwordx4 v2, s[4:7], s32 offen lds
    s_add_u32 m0, m0, 1056
    s_add_u32 s32, s32, 4096
    s_waitcnt lgkmcnt(6)
    v_mfma_f32_16x16x32_bf16 v[68:71], v[60:63], a[28:31], v[68:71]
    ds_read_b128 v[56:59], v24 offset:704
    s_waitcnt lgkmcnt(6)
    v_mfma_f32_16x16x32_bf16 v[64:67], v[32:35], a[32:35], v[64:67]
    ds_read_b128 v[60:63], v24 offset:17600
    buffer_load_dwordx4 v2, s[4:7], s32 offen lds
    s_add_u32 m0, m0, 1056
    s_add_u32 s32, s32, 4096
    s_waitcnt lgkmcnt(6)
    v_mfma_f32_16x16x32_bf16 v[68:71], v[36:39], a[32:35], v[68:71]
    ds_read_b128 v[32:35], v24 offset:768
    s_waitcnt lgkmcnt(6)
    v_mfma_f32_16x16x32_bf16 v[64:67], v[40:43], a[36:39], v[64:67]
    ds_read_b128 v[36:39], v24 offset:17664
    buffer_load_dwordx4 v2, s[4:7], s32 offen lds
    s_add_u32 m0, m0, 1056
    s_add_u32 s32, s32, 4096
    s_waitcnt lgkmcnt(6)
    v_mfma_f32_16x16x32_bf16 v[68:71], v[44:47], a[36:39], v[68:71]
    ds_read_b128 v[40:43], v24 offset:832
    s_waitcnt lgkmcnt(6)
    v_mfma_f32_16x16x32_bf16 v[64:67], v[48:51], a[40:43], v[64:67]
    ds_read_b128 v[44:47], v24 offset:17728
    buffer_load_dwordx4 v2, s[4:7], s32 offen lds
    s_add_u32 m0, m0, 1056
    s_add_u32 s32, s32, 4096
    s_waitcnt lgkmcnt(6)
    v_mfma_f32_16x16x32_bf16 v[68:71], v[52:55], a[40:43], v[68:71]
    ds_read_b128 v[48:51], v24 offset:896
    s_waitcnt lgkmcnt(6)
    v_mfma_f32_16x16x32_bf16 v[64:67], v[56:59], a[44:47], v[64:67]
    ds_read_b128 v[52:55], v24 offset:17792
    buffer_load_dwordx4 v2, s[4:7], s32 offen lds
    s_add_u32 m0, m0, 1056
    s_add_u32 s32, s32, 4096
    s_waitcnt lgkmcnt(6)
    v_mfma_f32_16x16x32_bf16 v[68:71], v[60:63], a[44:47], v[68:71]
    ds_read_b128 v[56:59], v24 offset:960
    s_waitcnt lgkmcnt(6)
    v_mfma_f32_16x16x32_bf16 v[64:67], v[32:35], a[48:51], v[64:67]
    ds_read_b128 v[60:63], v24 offset:17856
    buffer_load_dwordx4 v2, s[4:7], s32 offen lds
    s_add_u32 m0, m0, 1056
    s_add_u32 s32, s32, 4096
    s_waitcnt lgkmcnt(6)
    v_mfma_f32_16x16x32_bf16 v[68:71], v[36:39], a[48:51], v[68:71]
    ds_read_b64_tr_b16 v[192:193], v25 offset:0
    s_waitcnt lgkmcnt(6)
    v_mfma_f32_16x16x32_bf16 v[64:67], v[40:43], a[52:55], v[64:67]
    ds_read_b64_tr_b16 v[194:195], v25 offset:16896
    buffer_load_dwordx4 v2, s[4:7], s32 offen lds
    s_add_u32 m0, m0, 1056
    s_add_u32 s32, s32, 4096
    s_waitcnt lgkmcnt(6)
    v_mfma_f32_16x16x32_bf16 v[68:71], v[44:47], a[52:55], v[68:71]
    ds_read_b64_tr_b16 v[196:197], v25 offset:32
    s_waitcnt lgkmcnt(6)
    v_mfma_f32_16x16x32_bf16 v[64:67], v[48:51], a[56:59], v[64:67]
    ds_read_b64_tr_b16 v[198:199], v25 offset:16928
    buffer_load_dwordx4 v2, s[4:7], s32 offen lds
    s_add_u32 m0, m0, 1056
    s_add_u32 s32, s32, 4096
    s_waitcnt lgkmcnt(6)
    v_mfma_f32_16x16x32_bf16 v[68:71], v[52:55], a[56:59], v[68:71]
    ds_read_b64_tr_b16 v[200:201], v25 offset:64
    s_waitcnt lgkmcnt(6)
    v_mfma_f32_16x16x32_bf16 v[64:67], v[56:59], a[60:63], v[64:67]
    ds_read_b64_tr_b16 v[202:203], v25 offset:16960
    buffer_load_dwordx4 v2, s[4:7], s32 offen lds
    s_add_u32 m0, m0, 1056
    s_add_u32 s32, s32, 200704
    s_waitcnt lgkmcnt(6)
    v_mfma_f32_16x16x32_bf16 v[68:71], v[60:63], a[60:63], v[68:71]
    ds_read_b64_tr_b16 v[204:205], v25 offset:96
    ds_read_b64_tr_b16 v[206:207], v25 offset:16992
    ds_read_b64_tr_b16 v[208:209], v25 offset:128
    ds_read_b64_tr_b16 v[210:211], v25 offset:17024
    ds_read_b64_tr_b16 v[212:213], v25 offset:160
    ds_read_b64_tr_b16 v[214:215], v25 offset:17056
    ds_read_b64_tr_b16 v[216:217], v25 offset:192
    ds_read_b64_tr_b16 v[218:219], v25 offset:17088
    v_max3_f32 v3, v64, v65, v22
    v_max3_f32 v3, v3, v66, v67
    v_max3_f32 v3, v3, v68, v69
    v_max3_f32 v3, v3, v70, v71
    v_mov_b32 v4, v3
    ds_read_b64_tr_b16 v[220:221], v25 offset:224
    s_nop 0
    v_permlane32_swap_b32 v3, v4
    ds_read_b64_tr_b16 v[222:223], v25 offset:17120
    v_max_f32 v3, v3, v4
    ds_read_b64_tr_b16 v[224:225], v25 offset:256
    v_mov_b32 v4, v3
    ds_read_b64_tr_b16 v[226:227], v25 offset:17152
    s_nop 0
    v_permlane16_swap_b32 v3, v4
    ds_read_b64_tr_b16 v[228:229], v25 offset:288
    v_max_f32 v3, v3, v4
    ds_read_b64_tr_b16 v[230:231], v25 offset:17184
    v_sub_f32 v4, v22, v3
    ds_read_b64_tr_b16 v[232:233], v25 offset:320
    v_exp_f32 v4, v4
    ds_read_b64_tr_b16 v[234:235], v25 offset:17216
    v_mov_b32 v22, v3
    ds_read_b64_tr_b16 v[236:237], v25 offset:352
    v_sub_f32 v64, v64, v3
    ds_read_b64_tr_b16 v[238:239], v25 offset:17248
    v_sub_f32 v65, v65, v3
    ds_read_b64_tr_b16 v[240:241], v25 offset:384
    v_sub_f32 v66, v66, v3
    ds_read_b64_tr_b16 v[242:243], v25 offset:17280
    v_sub_f32 v67, v67, v3
    ds_read_b64_tr_b16 v[244:245], v25 offset:416
    v_sub_f32 v68, v68, v3
    ds_read_b64_tr_b16 v[246:247], v25 offset:17312
    v_sub_f32 v69, v69, v3
    ds_read_b64_tr_b16 v[248:249], v25 offset:448
    v_sub_f32 v70, v70, v3
    ds_read_b64_tr_b16 v[250:251], v25 offset:17344
    v_sub_f32 v71, v71, v3
    ds_read_b64_tr_b16 v[252:253], v25 offset:480
    v_exp_f32 v64, v64
    ds_read_b64_tr_b16 v[254:255], v25 offset:17376
    v_exp_f32 v65, v65
    v_exp_f32 v66, v66
    v_exp_f32 v67, v67
    v_exp_f32 v68, v68
    v_exp_f32 v69, v69
    v_exp_f32 v70, v70
    v_exp_f32 v71, v71
    v_cvt_pk_bf16_f32 v72, v64, v65
    v_cvt_pk_bf16_f32 v73, v66, v67
    v_cvt_pk_bf16_f32 v74, v68, v69
    v_cvt_pk_bf16_f32 v75, v70, v71
    v_pk_mul_f32 v[128:129], v[128:129], v[4:5] op_sel_hi:[1,0]
    v_pk_mul_f32 v[130:131], v[130:131], v[4:5] op_sel_hi:[1,0]
    v_pk_mul_f32 v[132:133], v[132:133], v[4:5] op_sel_hi:[1,0]
    v_pk_mul_f32 v[134:135], v[134:135], v[4:5] op_sel_hi:[1,0]
    s_waitcnt lgkmcnt(0)
    v_mfma_f32_16x16x32_bf16 v[128:131], v[192:195], v[72:75], v[128:131]
    v_pk_mul_f32 v[136:137], v[136:137], v[4:5] op_sel_hi:[1,0]
    v_pk_mul_f32 v[138:139], v[138:139], v[4:5] op_sel_hi:[1,0]
    v_mfma_f32_16x16x32_bf16 v[132:135], v[196:199], v[72:75], v[132:135]
    v_pk_mul_f32 v[140:141], v[140:141], v[4:5] op_sel_hi:[1,0]
    v_pk_mul_f32 v[142:143], v[142:143], v[4:5] op_sel_hi:[1,0]
    v_mfma_f32_16x16x32_bf16 v[136:139], v[200:203], v[72:75], v[136:139]
    v_pk_mul_f32 v[144:145], v[144:145], v[4:5] op_sel_hi:[1,0]
    v_pk_mul_f32 v[146:147], v[146:147], v[4:5] op_sel_hi:[1,0]
    v_mfma_f32_16x16x32_bf16 v[140:143], v[204:207], v[72:75], v[140:143]
    v_pk_mul_f32 v[148:149], v[148:149], v[4:5] op_sel_hi:[1,0]
    v_pk_mul_f32 v[150:151], v[150:151], v[4:5] op_sel_hi:[1,0]
    v_mfma_f32_16x16x32_bf16 v[144:147], v[208:211], v[72:75], v[144:147]
    v_pk_mul_f32 v[152:153], v[152:153], v[4:5] op_sel_hi:[1,0]
    v_pk_mul_f32 v[154:155], v[154:155], v[4:5] op_sel_hi:[1,0]
    v_mfma_f32_16x16x32_bf16 v[148:151], v[212:215], v[72:75], v[148:151]
    v_pk_mul_f32 v[156:157], v[156:157], v[4:5] op_sel_hi:[1,0]
    v_pk_mul_f32 v[158:159], v[158:159], v[4:5] op_sel_hi:[1,0]
    v_mfma_f32_16x16x32_bf16 v[152:155], v[216:219], v[72:75], v[152:155]
    v_pk_mul_f32 v[160:161], v[160:161], v[4:5] op_sel_hi:[1,0]
    v_pk_mul_f32 v[162:163], v[162:163], v[4:5] op_sel_hi:[1,0]
    v_mfma_f32_16x16x32_bf16 v[156:159], v[220:223], v[72:75], v[156:159]
    v_pk_mul_f32 v[164:165], v[164:165], v[4:5] op_sel_hi:[1,0]
    v_pk_mul_f32 v[166:167], v[166:167], v[4:5] op_sel_hi:[1,0]
    v_mfma_f32_16x16x32_bf16 v[160:163], v[224:227], v[72:75], v[160:163]
    v_pk_mul_f32 v[168:169], v[168:169], v[4:5] op_sel_hi:[1,0]
    v_pk_mul_f32 v[170:171], v[170:171], v[4:5] op_sel_hi:[1,0]
    v_mfma_f32_16x16x32_bf16 v[164:167], v[228:231], v[72:75], v[164:167]
    v_pk_mul_f32 v[172:173], v[172:173], v[4:5] op_sel_hi:[1,0]
    v_pk_mul_f32 v[174:175], v[174:175], v[4:5] op_sel_hi:[1,0]
    v_mfma_f32_16x16x32_bf16 v[168:171], v[232:235], v[72:75], v[168:171]
    v_pk_mul_f32 v[176:177], v[176:177], v[4:5] op_sel_hi:[1,0]
    v_pk_mul_f32 v[178:179], v[178:179], v[4:5] op_sel_hi:[1,0]
    v_mfma_f32_16x16x32_bf16 v[172:175], v[236:239], v[72:75], v[172:175]
    v_pk_mul_f32 v[180:181], v[180:181], v[4:5] op_sel_hi:[1,0]
    v_pk_mul_f32 v[182:183], v[182:183], v[4:5] op_sel_hi:[1,0]
    v_mfma_f32_16x16x32_bf16 v[176:179], v[240:243], v[72:75], v[176:179]
    v_pk_mul_f32 v[184:185], v[184:185], v[4:5] op_sel_hi:[1,0]
    v_pk_mul_f32 v[186:187], v[186:187], v[4:5] op_sel_hi:[1,0]
    v_mfma_f32_16x16x32_bf16 v[180:183], v[244:247], v[72:75], v[180:183]
    v_pk_mul_f32 v[188:189], v[188:189], v[4:5] op_sel_hi:[1,0]
    v_pk_mul_f32 v[190:191], v[190:191], v[4:5] op_sel_hi:[1,0]
    v_mfma_f32_16x16x32_bf16 v[184:187], v[248:251], v[72:75], v[184:187]
    s_nop 0
    v_mfma_f32_16x16x32_bf16 v[188:191], v[252:255], v[72:75], v[188:191]
    v_fma_f32 v23, v23, v4, v64
    v_add_f32 v23, v23, v65
    v_add_f32 v23, v23, v66
    v_add_f32 v23, v23, v67
    v_add_f32 v23, v23, v68
    v_add_f32 v23, v23, v69
    v_add_f32 v23, v23, v70
    v_add_f32 v23, v23, v71
    s_add_u32 s27, s27, 1
    s_cmp_lt_u32 s27, 16
    s_cbranch_scc1 L_CT
    s_waitcnt vmcnt(0)
    s_barrier
    v_mov_b32 v4, v23
    s_nop 1
    v_permlane32_swap_b32 v23, v4
    v_add_f32 v23, v23, v4
    v_mov_b32 v4, v23
    s_nop 1
    v_permlane16_swap_b32 v23, v4
    v_add_f32 v23, v23, v4
    s_lshl_b32 s24, s3, 9
    v_lshl_add_u32 v3, v0, 3, s24
    ds_write_b64 v3, v[22:23] offset:0
    v_xor_b32 v3, 0x400, v3
    s_waitcnt lgkmcnt(0)
    s_barrier
    ds_read_b64 v[6:7], v3 offset:0
    s_waitcnt lgkmcnt(0)
    v_max_f32 v3, v22, v6
    v_sub_f32 v4, v22, v3
    v_sub_f32 v6, v6, v3
    v_exp_f32 v4, v4
    v_exp_f32 v6, v6
    v_mov_b32 v22, v3
    v_mul_f32 v23, v23, v4
    v_fmac_f32 v23, v7, v6
    v_and_b32 v3, 15, v0
    v_lshlrev_b32 v5, 3, v3
    s_lshl_b32 s24, s71, 2
    s_add_u32 s31, s24, s70
    s_lshl_b32 s24, s31, 8
    s_mul_i32 s25, s75, 128
    s_add_u32 s24, s24, s25
    s_add_u32 s24, s24, 0x120000
    s_cmp_lg_u32 s3, 0
    s_cbranch_scc1 L_C_ml
    s_mov_b64 exec, 0xffff
    buffer_store_dwordx2 v[22:23], v5, s[12:15], s24 offen sc1
    s_mov_b64 exec, -1
L_C_ml:
    v_pk_mul_f32 v[128:129], v[128:129], v[4:5] op_sel_hi:[1,0]
    v_pk_mul_f32 v[130:131], v[130:131], v[4:5] op_sel_hi:[1,0]
    v_pk_mul_f32 v[132:133], v[132:133], v[4:5] op_sel_hi:[1,0]
    v_pk_mul_f32 v[134:135], v[134:135], v[4:5] op_sel_hi:[1,0]
    v_pk_mul_f32 v[136:137], v[136:137], v[4:5] op_sel_hi:[1,0]
    v_pk_mul_f32 v[138:139], v[138:139], v[4:5] op_sel_hi:[1,0]
    v_pk_mul_f32 v[140:141], v[140:141], v[4:5] op_sel_hi:[1,0]
    v_pk_mul_f32 v[142:143], v[142:143], v[4:5] op_sel_hi:[1,0]
    v_pk_mul_f32 v[144:145], v[144:145], v[4:5] op_sel_hi:[1,0]
    v_pk_mul_f32 v[146:147], v[146:147], v[4:5] op_sel_hi:[1,0]
    v_pk_mul_f32 v[148:149], v[148:149], v[4:5] op_sel_hi:[1,0]
    v_pk_mul_f32 v[150:151], v[150:151], v[4:5] op_sel_hi:[1,0]
    v_pk_mul_f32 v[152:153], v[152:153], v[4:5] op_sel_hi:[1,0]
    v_pk_mul_f32 v[154:155], v[154:155], v[4:5] op_sel_hi:[1,0]
    v_pk_mul_f32 v[156:157], v[156:157], v[4:5] op_sel_hi:[1,0]
    v_pk_mul_f32 v[158:159], v[158:159], v[4:5] op_sel_hi:[1,0]
    v_pk_mul_f32 v[160:161], v[160:161], v[4:5] op_sel_hi:[1,0]
    v_pk_mul_f32 v[162:163], v[162:163], v[4:5] op_sel_hi:[1,0]
    v_pk_mul_f32 v[164:165], v[164:165], v[4:5] op_sel_hi:[1,0]
    v_pk_mul_f32 v[166:167], v[166:167], v[4:5] op_sel_hi:[1,0]
    v_pk_mul_f32 v[168:169], v[168:169], v[4:5] op_sel_hi:[1,0]
    v_pk_mul_f32 v[170:171], v[170:171], v[4:5] op_sel_hi:[1,0]
    v_pk_mul_f32 v[172:173], v[172:173], v[4:5] op_sel_hi:[1,0]
    v_pk_mul_f32 v[174:175], v[174:175], v[4:5] op_sel_hi:[1,0]
    v_pk_mul_f32 v[176:177], v[176:177], v[4:5] op_sel_hi:[1,0]
    v_pk_mul_f32 v[178:179], v[178:179], v[4:5] op_sel_hi:[1,0]
    v_pk_mul_f32 v[180:181], v[180:181], v[4:5] op_sel_hi:[1,0]
    v_pk_mul_f32 v[182:183], v[182:183], v[4:5] op_sel_hi:[1,0]
    v_pk_mul_f32 v[184:185], v[184:185], v[4:5] op_sel_hi:[1,0]
    v_pk_mul_f32 v[186:187], v[186:187], v[4:5] op_sel_hi:[1,0]
    v_pk_mul_f32 v[188:189], v[188:189], v[4:5] op_sel_hi:[1,0]
    v_pk_mul_f32 v[190:191], v[190:191], v[4:5] op_sel_hi:[1,0]
    s_lshl_b32 s24, s3, 13
    s_add_u32 s24, s24, 4096
    v_add_u32 v6, s24, v2
    s_xor_b32 s24, s3, 2
    s_lshl_b32 s24, s24, 13
    s_add_u32 s24, s24, 4096
    v_add_u32 v7, s24, v2
    s_cmp_lg_u32 s28, 0
    s_cbranch_scc1 L_C_x1
    ds_write_b128 v6, v[160:163] offset:0
    ds_write_b128 v6, v[164:167] offset:1024
    ds_write_b128 v6, v[168:171] offset:2048
    ds_write_b128 v6, v[172:175] offset:3072
    ds_write_b128 v6, v[176:179] offset:4096
    ds_write_b128 v6, v[180:183] offset:5120
    ds_write_b128 v6, v[184:187] offset:6144
    ds_write_b128 v6, v[188:191] offset:7168
    s_branch L_C_x2
L_C_x1:
    ds_write_b128 v6, v[128:131] offset:0
    ds_write_b128 v6, v[132:135] offset:1024
    ds_write_b128 v6, v[136:139] offset:2048
    ds_write_b128 v6, v[140:143] offset:3072
    ds_write_b128 v6, v[144:147] offset:4096
    ds_write_b128 v6, v[148:151] offset:5120
    ds_write_b128 v6, v[152:155] offset:6144
    ds_write_b128 v6, v[156:159] offset:7168
    s_waitcnt lgkmcnt(0)
    v_mov_b32 v128, v160
    v_mov_b32 v129, v161
    v_mov_b32 v130, v162
    v_mov_b32 v131, v163
    v_mov_b32 v132, v164
    v_mov_b32 v133, v165
    v_mov_b32 v134, v166
    v_mov_b32 v135, v167
    v_mov_b32 v136, v168
    v_mov_b32 v137, v169
    v_mov_b32 v138, v170
    v_mov_b32 v139, v171
    v_mov_b32 v140, v172
    v_mov_b32 v141, v173
    v_mov_b32 v142, v174
    v_mov_b32 v143, v175
    v_mov_b32 v144, v176
    v_mov_b32 v145, v177
    v_mov_b32 v146, v178
    v_mov_b32 v147, v179
    v_mov_b32 v148, v180
    v_mov_b32 v149, v181
    v_mov_b32 v150, v182
    v_mov_b32 v151, v183
    v_mov_b32 v152, v184
    v_mov_b32 v153, v185
    v_mov_b32 v154, v186
    v_mov_b32 v155, v187
    v_mov_b32 v156, v188
    v_mov_b32 v157, v189
    v_mov_b32 v158, v190
    v_mov_b32 v159, v191
L_C_x2:
    s_waitcnt lgkmcnt(0)
    s_barrier
    ds_read_b128 v[192:195], v7 offset:0
    ds_read_b128 v[196:199], v7 offset:1024
    ds_read_b128 v[200:203], v7 offset:2048
    ds_read_b128 v[204:207], v7 offset:3072
    ds_read_b128 v[208:211], v7 offset:4096
    ds_read_b128 v[212:215], v7 offset:5120
    ds_read_b128 v[216:219], v7 offset:6144
    ds_read_b128 v[220:223], v7 offset:7168
    v_lshrrev_b32 v4, 4, v0
    v_mul_u32_u24 v3, 272, v3
    v_lshl_add_u32 v3, v4, 3, v3
    s_mul_i32 s24, s3, 4352
    s_add_u32 s24, s24, 40960
    v_add_u32 v3, s24, v3
    s_waitcnt lgkmcnt(7)
    v_add_f32 v128, v128, v192
    v_add_f32 v129, v129, v193
    v_add_f32 v130, v130, v194
    v_add_f32 v131, v131, v195
    v_cvt_pk_bf16_f32 v32, v128, v129
    v_cvt_pk_bf16_f32 v33, v130, v131
    ds_write_b64 v3, v[32:33] offset:0
    s_waitcnt lgkmcnt(7)
    v_add_f32 v132, v132, v196
    v_add_f32 v133, v133, v197
    v_add_f32 v134, v134, v198
    v_add_f32 v135, v135, v199
    v_cvt_pk_bf16_f32 v34, v132, v133
    v_cvt_pk_bf16_f32 v35, v134, v135
    ds_write_b64 v3, v[34:35] offset:32
    s_waitcnt lgkmcnt(7)
    v_add_f32 v136, v136, v200
    v_add_f32 v137, v137, v201
    v_add_f32 v138, v138, v202
    v_add_f32 v139, v139, v203
    v_cvt_pk_bf16_f32 v36, v136, v137
    v_cvt_pk_bf16_f32 v37, v138, v139
    ds_write_b64 v3, v[36:37] offset:64
    s_waitcnt lgkmcnt(7)
    v_add_f32 v140, v140, v204
    v_add_f32 v141, v141, v205
    v_add_f32 v142, v142, v206
    v_add_f32 v143, v143, v207
    v_cvt_pk_bf16_f32 v38, v140, v141
    v_cvt_pk_bf16_f32 v39, v142, v143
    ds_write_b64 v3, v[38:39] offset:96
    s_waitcnt lgkmcnt(7)
    v_add_f32 v144, v144, v208
    v_add_f32 v145, v145, v209
    v_add_f32 v146, v146, v210
    v_add_f32 v147, v147, v211
    v_cvt_pk_bf16_f32 v40, v144, v145
    v_cvt_pk_bf16_f32 v41, v146, v147
    ds_write_b64 v3, v[40:41] offset:128
    s_waitcnt lgkmcnt(7)
    v_add_f32 v148, v148, v212
    v_add_f32 v149, v149, v213
    v_add_f32 v150, v150, v214
    v_add_f32 v151, v151, v215
    v_cvt_pk_bf16_f32 v42, v148, v149
    v_cvt_pk_bf16_f32 v43, v150, v151
    ds_write_b64 v3, v[42:43] offset:160
    s_waitcnt lgkmcnt(7)
    v_add_f32 v152, v152, v216
    v_add_f32 v153, v153, v217
    v_add_f32 v154, v154, v218
    v_add_f32 v155, v155, v219
    v_cvt_pk_bf16_f32 v44, v152, v153
    v_cvt_pk_bf16_f32 v45, v154, v155
    ds_write_b64 v3, v[44:45] offset:192
    s_waitcnt lgkmcnt(7)
    v_add_f32 v156, v156, v220
    v_add_f32 v157, v157, v221
    v_add_f32 v158, v158, v222
    v_add_f32 v159, v159, v223
    v_cvt_pk_bf16_f32 v46, v156, v157
    v_cvt_pk_bf16_f32 v47, v158, v159
    ds_write_b64 v3, v[46:47] offset:224
    v_and_b32 v5, 15, v0
    v_mul_u32_u24 v3, 272, v4
    v_lshl_add_u32 v3, v5, 4, v3
    v_add_u32 v3, s24, v3
    v_lshlrev_b32 v4, 11, v4
    v_lshl_add_u32 v4, v5, 4, v4
    s_waitcnt lgkmcnt(0)
    ds_read_b128 v[64:67], v3 offset:0
    ds_read_b128 v[68:71], v3 offset:1088
    ds_read_b128 v[72:75], v3 offset:2176
    ds_read_b128 v[76:79], v3 offset:3264
    s_lshl_b32 s24, s31, 16
    s_lshl_b32 s25, s29, 9
    s_add_u32 s24, s24, s25
    s_lshl_b32 s25, s28, 8
    s_add_u32 s24, s24, s25
    s_mul_i32 s25, s75, 32768
    s_add_u32 s24, s24, s25
    s_add_u32 s24, s24, 0x400000
    s_waitcnt lgkmcnt(3)
    buffer_store_dwordx4 v[64:67], v4, s[12:15], s24 offen sc1 nt
    s_add_u32 s24, s24, 8192
    s_waitcnt lgkmcnt(2)
    buffer_store_dwordx4 v[68:71], v4, s[12:15], s24 offen sc1 nt
    s_add_u32 s24, s24, 8192
    s_waitcnt lgkmcnt(1)
    buffer_store_dwordx4 v[72:75], v4, s[12:15], s24 offen sc1 nt
    s_add_u32 s24, s24, 8192
    s_waitcnt lgkmcnt(0)
    buffer_store_dwordx4 v[76:79], v4, s[12:15], s24 offen sc1 nt
    s_add_u32 s24, s24, 8192
    s_waitcnt vmcnt(0)
    s_barrier
    s_cmp_lg_u32 s3, 0
    s_cbranch_scc1 L_sig24
    s_mov_b64 exec, 1
    v_mov_b32 v3, 1
    buffer_atomic_add v3, off, s[16:19], 0 offset:4 sc0
    s_waitcnt vmcnt(0)
    v_readfirstlane_b32 s24, v3
    s_mov_b64 exec, -1
    s_and_b32 s24, s24, 31
    s_cmp_lg_u32 s24, 31
    s_cbranch_scc1 L_sig24
    v_lshlrev_b32 v4, 7, v0
    v_mov_b32 v3, 1
    s_mov_b32 s24, 0x170000
    s_mov_b32 exec_hi, 0
    buffer_store_dword v3, v4, s[12:15], s24 offen offset:4 sc1
    s_mov_b64 exec, -1
L_sig24:
    s_branch L_R
L_last:
    s_endpgm
.section .rodata,"a"
.p2align 6
.amdhsa_kernel concat_heads__compressed_kv_cla__mha_block_cached__decode_kernel
  .amdhsa_next_free_vgpr 448
  .amdhsa_next_free_sgpr 102
  .amdhsa_accum_offset 256
  .amdhsa_group_segment_fixed_size 0
  .amdhsa_kernarg_size 112
  .amdhsa_user_sgpr_count 2
  .amdhsa_user_sgpr_kernarg_segment_ptr 1
  .amdhsa_system_sgpr_workgroup_id_x 1
  .amdhsa_float_denorm_mode_32 3
.end_amdhsa_kernel
```

```asm
; @launch grid=(256,1,1) block=(256,1,1) lds=149504
.amdgcn_target "amdgcn-amd-amdhsa--gfx950"
.text
.globl concat_heads__compressed_kv_cla__mha_block_cached__decode_kernel
.p2align 8
.type concat_heads__compressed_kv_cla__mha_block_cached__decode_kernel,@function
concat_heads__compressed_kv_cla__mha_block_cached__decode_kernel:
    s_load_dwordx16 s[36:51], s[0:1], 0
    s_load_dwordx8 s[52:59], s[0:1], 64
    s_load_dwordx4 s[60:63], s[0:1], 96
    s_cmp_ge_u32 s2, 256
    s_cbranch_scc1 L_end
    s_cmp_lt_u32 s2, 64
    s_getpc_b64 s[24:25]
L_pc0:
    s_cselect_b32 s20, L_A-L_pc0, 0
    v_lshlrev_b32 v16, 7, v0
    v_min_u32 v16, L_A-L_pc0-4, v16
    v_add_u32 v16, s20, v16
    v_add_co_u32 v16, vcc, s24, v16
    v_mov_b32 v17, s25
    s_nop 0
    v_addc_co_u32 v17, vcc, 0, v17, vcc
    global_load_dword v17, v[16:17], off
    s_cbranch_scc1 L_A
L_B:
    s_and_b32 s70, s2, 6
    s_and_b32 s25, s2, 7
    s_add_u32 s70, s70, s25
    s_lshl_b32 s25, s70, 8
    v_and_b32 v6, 15, v0
    v_lshl_add_u32 v24, v6, 4, s25
    v_and_b32 v4, 16, v0
    v_lshl_add_u32 v24, v4, 5, v24
    v_lshrrev_b32 v4, 5, v0
    v_lshl_add_u32 v24, v4, 12, v24
    s_lshr_b32 s74, s2, 3
    s_lshl_b32 s74, s74, 2
    s_addk_i32 s74, -32
    s_mov_b32 s10, 0x400000
    s_mov_b32 s11, 0x20000
    s_waitcnt lgkmcnt(0)
    s_mov_b64 s[8:9], s[54:55]
L_pfb:
    s_lshl_b32 s24, s74, 13
    buffer_load_dwordx4 v[28:31], v24, s[8:11], s24 offen
    s_addk_i32 s74, 96
    s_cmpk_lt_u32 s74, 512
    s_cbranch_scc1 L_pfb
    s_addk_i32 s74, -512
    s_mov_b64 s[8:9], s[40:41]
L_pfq:
    s_lshl_b32 s24, s74, 13
    buffer_load_dwordx4 v[28:31], v24, s[8:11], s24 offen
    s_addk_i32 s74, 96
    s_cmpk_lt_u32 s74, 512
    s_cbranch_scc1 L_pfq
    s_addk_i32 s74, -512
    s_mov_b64 s[8:9], s[42:43]
L_pfk:
    s_lshl_b32 s24, s74, 13
    buffer_load_dwordx4 v[28:31], v24, s[8:11], s24 offen
    s_addk_i32 s74, 96
    s_cmpk_lt_u32 s74, 512
    s_cbranch_scc1 L_pfk
    s_addk_i32 s74, -512
    v_lshrrev_b32 v1, 6, v0
    v_and_b32 v0, 63, v0
    v_readfirstlane_b32 s3, v1
    v_lshlrev_b32 v2, 4, v0
    s_lshr_b32 s24, s2, 3
    s_sub_u32 s24, s24, 8
    s_mul_i32 s26, s24, 43
    s_lshr_b32 s26, s26, 8
    s_mul_i32 s27, s26, 6
    s_sub_u32 s27, s24, s27
    s_and_b32 s25, s26, 1
    s_lshl_b32 s25, s25, 1
    s_and_b32 s26, s26, 2
    s_lshl_b32 s26, s26, 3
    s_or_b32 s26, s26, s25
    s_or_b32 s26, s26, s70
    s_lshl_b32 s25, s70, 17
    s_lshl_b32 s24, s3, 8
    s_add_u32 s25, s25, s24
    v_lshl_add_u32 v25, v6, 4, s25
    v_and_b32 v4, 16, v0
    v_lshl_add_u32 v25, v4, 14, v25
    v_and_b32 v4, 32, v0
    v_lshl_add_u32 v25, v4, 16, v25
    s_and_b32 s25, s2, 3
    s_lshl_b32 s25, s25, 10
    s_lshl_b32 s24, s3, 12
    s_add_u32 s25, s25, s24
    s_bfe_u32 s24, s2, 0x10002
    s_lshl_b32 s24, s24, 23
    s_add_u32 s25, s25, s24
    v_add_u32 v26, s25, v2
    s_cmp_ge_u32 s27, 3
    s_cselect_b32 s28, 1, 0
    s_mul_i32 s29, s28, 3
    s_sub_u32 s29, s27, s29
    s_lshr_b32 s72, s3, 1
    s_lshl_b32 s24, s28, 1
    s_add_u32 s72, s72, s24
    s_and_b32 s31, s3, 1
    s_lshl_b32 s24, s29, 1
    s_add_u32 s31, s31, s24
    s_lshl_b32 s30, s72, 5
    s_add_u32 s30, s30, s26
    s_lshl_b32 s30, s30, 20
    v_lshrrev_b32 v3, 4, v0
    v_and_b32 v4, 3, v0
    v_lshlrev_b32 v5, 6, v3
    v_lshl_add_u32 v5, v4, 4, v5
    v_bfe_u32 v1, v0, 2, 2
    v_lshl_add_u32 v1, v1, 8, v5
    s_mul_i32 s35, s31, 1024
    s_add_u32 s32, s35, 983040
    s_mul_i32 s28, s31, 1024
    s_add_u32 s28, s28, 1044480
    s_mov_b32 s6, 0x100000
    s_mov_b32 s7, 0x20000
    s_add_u32 s4, s50, s30
    s_addc_u32 s5, s51, 0
    s_mov_b32 s12, s62
    s_mov_b32 s13, s63
    s_mov_b32 s14, 0x600000
    s_mov_b32 s15, 0x20000
    s_mov_b32 s16, s60
    s_mov_b32 s17, s61
    s_mov_b32 s18, 0x100
    s_mov_b32 s19, 0x20000
    v_and_b32 v3, 1, v0
    v_lshlrev_b32 v3, 4, v3
    v_mov_b32 v4, 0xffff
    v_lshlrev_b32 v4, v3, v4
    v_bfe_u32 v3, v0, 1, 2
    v_cmp_eq_u32 vcc, 0, v3
    s_nop 1
    v_cndmask_b32 v20, 0, v4, vcc
    v_cmp_eq_u32 vcc, 1, v3
    s_nop 1
    v_cndmask_b32 v21, 0, v4, vcc
    v_cmp_eq_u32 vcc, 2, v3
    s_nop 1
    v_cndmask_b32 v22, 0, v4, vcc
    v_cmp_eq_u32 vcc, 3, v3
    s_nop 1
    v_cndmask_b32 v23, 0, v4, vcc
    s_mov_b32 s64, 0x22222222
    s_mov_b32 s65, 0x22222222
    s_mov_b32 s66, 0x44444444
    s_mov_b32 s67, 0x44444444
    s_mov_b32 s68, 0x88888888
    s_mov_b32 s69, 0x88888888
    v_mov_b32 v32, 0
    v_mov_b32 v33, 0
    v_mov_b32 v34, 0
    v_mov_b32 v35, 0
    v_mov_b32 v36, 0
    v_mov_b32 v37, 0
    v_mov_b32 v38, 0
    v_mov_b32 v39, 0
    v_mov_b32 v40, 0
    v_mov_b32 v41, 0
    v_mov_b32 v42, 0
    v_mov_b32 v43, 0
    v_mov_b32 v44, 0
    v_mov_b32 v45, 0
    v_mov_b32 v46, 0
    v_mov_b32 v47, 0
    v_lshrrev_b32 v3, 4, v0
    v_lshlrev_b32 v60, 6, v3
    v_and_b32 v4, 7, v0
    v_lshl_add_u32 v60, v4, 3, v60
    s_lshl_b32 s33, s26, 2
    s_add_u32 s33, s33, s72
    s_lshl_b32 s34, s26, 12
    s_lshl_b32 s24, s72, 8
    s_add_u32 s34, s34, s24
    s_add_u32 s34, s34, 0x140000
    s_mul_i32 s73, s33, 6
    s_add_u32 s73, s73, s31
    s_lshl_b32 s73, s73, 8
    s_add_u32 s73, s73, 0x180000
    s_mov_b64 s[8:9], s[56:57]
L_pfo:
    s_lshl_b32 s24, s74, 8
    s_waitcnt vmcnt(6)
    buffer_load_dwordx4 v[28:31], v25, s[8:11], s24 offen
    s_addk_i32 s74, 96
    s_cmpk_lt_u32 s74, 512
    s_cbranch_scc1 L_pfo
    s_addk_i32 s74, -512
    s_mov_b64 s[8:9], s[44:45]
L_pfu:
    s_lshl_b32 s24, s74, 13
    s_waitcnt vmcnt(6)
    buffer_load_dwordx4 v[28:31], v24, s[8:11], s24 offen
    s_addk_i32 s74, 96
    s_cmpk_lt_u32 s74, 512
    s_cbranch_scc1 L_pfu
    s_addk_i32 s74, -512
    s_mov_b64 s[8:9], s[46:47]
L_pfv:
    s_lshl_b32 s24, s74, 8
    s_waitcnt vmcnt(6)
    buffer_load_dwordx4 v[28:31], v25, s[8:11], s24 offen
    s_addk_i32 s74, 96
    s_cmpk_lt_u32 s74, 512
    s_cbranch_scc1 L_pfv
    s_addk_i32 s74, -512
    s_mov_b64 s[8:9], s[38:39]
    s_mov_b32 s10, 0x1000000
L_pfc:
    s_lshl_b32 s24, s74, 12
    s_waitcnt vmcnt(6)
    buffer_load_dwordx4 v[28:31], v26, s[8:11], s24 offen
    s_addk_i32 s74, 96
    s_cmpk_lt_u32 s74, 2048
    s_cbranch_scc1 L_pfc
    s_addk_i32 s74, -2048
    s_mov_b32 s10, 0x400000
    s_waitcnt vmcnt(15)
    buffer_load_dwordx4 a[0:3], v1, s[4:7], s32 offen offset:0 nt
    s_add_u32 s32, s32, 6144
    s_waitcnt vmcnt(15)
    buffer_load_dwordx4 a[4:7], v1, s[4:7], s32 offen offset:0 nt
    s_add_u32 s32, s32, 6144
    s_waitcnt vmcnt(15)
    buffer_load_dwordx4 a[8:11], v1, s[4:7], s32 offen offset:0 nt
    s_add_u32 s32, s32, 6144
    s_waitcnt vmcnt(15)
    buffer_load_dwordx4 a[12:15], v1, s[4:7], s32 offen offset:0 nt
    s_add_u32 s32, s32, 6144
    s_waitcnt vmcnt(15)
    buffer_load_dwordx4 a[16:19], v1, s[4:7], s32 offen offset:0 nt
    s_add_u32 s32, s32, 6144
    s_waitcnt vmcnt(15)
    buffer_load_dwordx4 a[20:23], v1, s[4:7], s32 offen offset:0 nt
    s_add_u32 s32, s32, 6144
    s_waitcnt vmcnt(15)
    buffer_load_dwordx4 a[24:27], v1, s[4:7], s32 offen offset:0 nt
    s_add_u32 s32, s32, 6144
    s_waitcnt vmcnt(15)
    buffer_load_dwordx4 a[28:31], v1, s[4:7], s32 offen offset:0 nt
    s_add_u32 s32, s32, 6144
    s_waitcnt vmcnt(15)
    buffer_load_dwordx4 a[32:35], v1, s[4:7], s32 offen offset:0 nt
    s_add_u32 s32, s32, 6144
    s_waitcnt vmcnt(15)
    buffer_load_dwordx4 a[36:39], v1, s[4:7], s32 offen offset:0 nt
    s_add_u32 s32, s32, 6144
    s_waitcnt vmcnt(15)
    buffer_load_dwordx4 a[40:43], v1, s[4:7], s28 offen offset:0 nt
    s_waitcnt vmcnt(15)
    s_mov_b32 s32, s35
    buffer_load_dwordx4 a[64:67], v1, s[4:7], s32 offen offset:0 nt
    s_add_u32 s32, s32, 6144
    s_waitcnt vmcnt(15)
    buffer_load_dwordx4 a[68:71], v1, s[4:7], s32 offen offset:0 nt
    s_add_u32 s32, s32, 6144
    s_waitcnt vmcnt(15)
    buffer_load_dwordx4 a[72:75], v1, s[4:7], s32 offen offset:0 nt
    s_add_u32 s32, s32, 6144
    s_waitcnt vmcnt(15)
    buffer_load_dwordx4 a[76:79], v1, s[4:7], s32 offen offset:0 nt
    s_add_u32 s32, s32, 6144
    s_waitcnt vmcnt(15)
    buffer_load_dwordx4 a[80:83], v1, s[4:7], s32 offen offset:0 nt
    s_add_u32 s32, s32, 6144
    s_mov_b64 exec, 1
    buffer_load_dword v61, off, s[16:19], 0 offset:128 sc1
    s_mov_b64 exec, -1
    s_waitcnt vmcnt(15)
    buffer_load_dwordx4 a[84:87], v1, s[4:7], s32 offen offset:0 nt
    s_add_u32 s32, s32, 6144
    s_waitcnt vmcnt(15)
    buffer_load_dwordx4 a[88:91], v1, s[4:7], s32 offen offset:0 nt
    s_add_u32 s32, s32, 6144
    s_waitcnt vmcnt(15)
    buffer_load_dwordx4 a[92:95], v1, s[4:7], s32 offen offset:0 nt
    s_add_u32 s32, s32, 6144
    s_waitcnt vmcnt(15)
    buffer_load_dwordx4 a[96:99], v1, s[4:7], s32 offen offset:0 nt
    s_add_u32 s32, s32, 6144
    s_waitcnt vmcnt(15)
    buffer_load_dwordx4 a[100:103], v1, s[4:7], s32 offen offset:0 nt
    s_add_u32 s32, s32, 6144
    s_waitcnt vmcnt(15)
    buffer_load_dwordx4 a[104:107], v1, s[4:7], s32 offen offset:0 nt
    s_add_u32 s32, s32, 6144
    s_waitcnt vmcnt(15)
    buffer_load_dwordx4 a[108:111], v1, s[4:7], s32 offen offset:0 nt
    s_add_u32 s32, s32, 6144
    s_waitcnt vmcnt(15)
    buffer_load_dwordx4 a[112:115], v1, s[4:7], s32 offen offset:0 nt
    s_add_u32 s32, s32, 6144
    s_waitcnt vmcnt(15)
    buffer_load_dwordx4 a[116:119], v1, s[4:7], s32 offen offset:0 nt
    s_add_u32 s32, s32, 6144
    s_waitcnt vmcnt(15)
    buffer_load_dwordx4 a[120:123], v1, s[4:7], s32 offen offset:0 nt
    s_add_u32 s32, s32, 6144
    s_waitcnt vmcnt(15)
    buffer_load_dwordx4 a[124:127], v1, s[4:7], s32 offen offset:0 nt
    s_add_u32 s32, s32, 6144
    s_waitcnt vmcnt(15)
    buffer_load_dwordx4 v[64:67], v1, s[4:7], s32 offen offset:0 nt
    s_add_u32 s32, s32, 6144
    s_waitcnt vmcnt(12)
    v_readfirstlane_b32 s25, v61
    s_nop 0
    s_cmp_ge_u32 s25, 32
    s_cbranch_scc1 L_B_q
    s_mov_b32 s24, 262144
    s_mov_b64 exec, 1
L_aw1:
    buffer_load_dword v61, off, s[16:19], 0 offset:128 sc1
    s_waitcnt vmcnt(0)
    v_readfirstlane_b32 s25, v61
    s_nop 0
    s_cmp_ge_u32 s25, 32
    s_cbranch_scc1 L_B_q
    s_sleep 16
    s_sub_u32 s24, s24, 1
    s_cmp_lg_u32 s24, 0
    s_cbranch_scc1 L_aw1
L_B_q:
    s_mov_b64 exec, -1
    buffer_load_dwordx4 v[8:11], v5, s[12:15], s34 offen sc1
    s_waitcnt vmcnt(15)
    buffer_load_dwordx4 v[68:71], v1, s[4:7], s32 offen offset:0 nt
    s_add_u32 s32, s32, 6144
    s_waitcnt vmcnt(15)
    buffer_load_dwordx4 v[72:75], v1, s[4:7], s32 offen offset:0 nt
    s_add_u32 s32, s32, 6144
    s_waitcnt vmcnt(15)
    buffer_load_dwordx4 v[76:79], v1, s[4:7], s32 offen offset:0 nt
    s_add_u32 s32, s32, 6144
    s_waitcnt vmcnt(15)
    buffer_load_dwordx4 v[80:83], v1, s[4:7], s32 offen offset:0 nt
    s_add_u32 s32, s32, 6144
    s_waitcnt vmcnt(15)
    buffer_load_dwordx4 v[84:87], v1, s[4:7], s32 offen offset:0 nt
    s_add_u32 s32, s32, 6144
    s_waitcnt vmcnt(15)
    buffer_load_dwordx4 v[88:91], v1, s[4:7], s32 offen offset:0 nt
    s_add_u32 s32, s32, 6144
    s_waitcnt vmcnt(15)
    buffer_load_dwordx4 v[92:95], v1, s[4:7], s32 offen offset:0 nt
    s_add_u32 s32, s32, 6144
    s_waitcnt vmcnt(15)
    buffer_load_dwordx4 v[96:99], v1, s[4:7], s32 offen offset:0 nt
    s_add_u32 s32, s32, 6144
    s_waitcnt vmcnt(15)
    buffer_load_dwordx4 v[100:103], v1, s[4:7], s32 offen offset:0 nt
    s_add_u32 s32, s32, 6144
    s_waitcnt vmcnt(15)
    buffer_load_dwordx4 v[104:107], v1, s[4:7], s32 offen offset:0 nt
    s_add_u32 s32, s32, 6144
    s_waitcnt vmcnt(15)
    buffer_load_dwordx4 v[108:111], v1, s[4:7], s32 offen offset:0 nt
    s_add_u32 s32, s32, 6144
    s_waitcnt vmcnt(15)
    buffer_load_dwordx4 v[112:115], v1, s[4:7], s32 offen offset:0 nt
    s_add_u32 s32, s32, 6144
    s_waitcnt vmcnt(15)
    buffer_load_dwordx4 v[116:119], v1, s[4:7], s32 offen offset:0 nt
    s_add_u32 s32, s32, 6144
    s_waitcnt vmcnt(15)
    buffer_load_dwordx4 v[120:123], v1, s[4:7], s32 offen offset:0 nt
    s_add_u32 s32, s32, 6144
    s_waitcnt vmcnt(15)
    buffer_load_dwordx4 v[124:127], v1, s[4:7], s32 offen offset:0 nt
    s_add_u32 s32, s32, 6144
    s_waitcnt vmcnt(15)
    v_mov_b32_dpp v32, v8 quad_perm:[0,1,2,3] row_mask:0xf bank_mask:0x1
    v_mov_b32_dpp v33, v9 quad_perm:[0,1,2,3] row_mask:0xf bank_mask:0x1
    v_mov_b32_dpp v34, v10 quad_perm:[0,1,2,3] row_mask:0xf bank_mask:0x1
    v_mov_b32_dpp v35, v11 quad_perm:[0,1,2,3] row_mask:0xf bank_mask:0x1
    v_mov_b32_dpp v36, v8 quad_perm:[0,1,2,3] row_mask:0xf bank_mask:0x2
    v_mov_b32_dpp v37, v9 quad_perm:[0,1,2,3] row_mask:0xf bank_mask:0x2
    v_mov_b32_dpp v38, v10 quad_perm:[0,1,2,3] row_mask:0xf bank_mask:0x2
    v_mov_b32_dpp v39, v11 quad_perm:[0,1,2,3] row_mask:0xf bank_mask:0x2
    v_mov_b32_dpp v40, v8 quad_perm:[0,1,2,3] row_mask:0xf bank_mask:0x4
    v_mov_b32_dpp v41, v9 quad_perm:[0,1,2,3] row_mask:0xf bank_mask:0x4
    v_mov_b32_dpp v42, v10 quad_perm:[0,1,2,3] row_mask:0xf bank_mask:0x4
    v_mov_b32_dpp v43, v11 quad_perm:[0,1,2,3] row_mask:0xf bank_mask:0x4
    v_mov_b32_dpp v44, v8 quad_perm:[0,1,2,3] row_mask:0xf bank_mask:0x8
    v_mov_b32_dpp v45, v9 quad_perm:[0,1,2,3] row_mask:0xf bank_mask:0x8
    v_mov_b32_dpp v46, v10 quad_perm:[0,1,2,3] row_mask:0xf bank_mask:0x8
    v_mov_b32_dpp v47, v11 quad_perm:[0,1,2,3] row_mask:0xf bank_mask:0x8
    s_mov_b32 s27, 1
L_BK:
    s_cmp_lg_u32 s27, 9
    s_cbranch_scc1 L_BK_a
    s_add_u32 s4, s52, s30
    s_addc_u32 s5, s53, 0
    s_mov_b32 s32, s35
    v_mov_b32 v1, v2
L_BK_a:
    s_barrier
    s_cmp_lg_u32 s27, 7
    s_cbranch_scc1 L_BK_x0
    s_and_b32 s24, s2, 7
    s_lshl_b32 s24, s24, 7
    s_add_u32 s24, s24, 0x1d8000
    v_and_b32 v63, 7, v0
    v_lshlrev_b32 v63, 2, v63
    buffer_load_dword v62, v63, s[12:15], s24 offen sc1
L_BK_x0:
    s_cmp_lg_u32 s27, 8
    s_cbranch_scc1 L_BK_x1
    s_getreg_b32 s24, hwreg(HW_REG_XCC_ID, 0, 4)
    v_cmp_ne_u32 vcc, s24, v62
    s_nop 0
    s_or_b32 s75, vcc_lo, vcc_hi
    v_mov_b32 v28, -1
    v_mov_b32 v29, -1
    v_mov_b32 v30, -1
    v_mov_b32 v31, -1
    s_mov_b64 exec, 0xffff
    s_cbranch_scc1 L_far2
    buffer_store_dwordx4 v[28:31], v2, s[12:15], s73 offen
    s_branch L_near2
L_far2:
    buffer_store_dwordx4 v[28:31], v2, s[12:15], s73 offen sc1
L_near2:
    s_mov_b64 exec, -1
L_BK_x1:
    v_mov_b32 v49, v50
    v_mov_b32 v50, v51
    v_mov_b32 v51, v52
    v_mov_b32 v52, v53
    v_mov_b32 v53, v54
    v_mov_b32 v54, v55
    v_mov_b32 v55, v56
    v_mov_b32 v56, v57
    s_waitcnt vmcnt(15)
    v_mfma_f32_16x16x32_bf16 v[12:15], v[64:67], v[32:35], 0
    buffer_load_dwordx4 v[64:67], v1, s[4:7], s32 offen offset:0 nt
    s_add_u32 s32, s32, 6144
    s_waitcnt vmcnt(15)
    v_mfma_f32_16x16x32_bf16 v[12:15], v[68:71], v[36:39], v[12:15]
    buffer_load_dwordx4 v[68:71], v1, s[4:7], s32 offen offset:0 nt
    s_add_u32 s32, s32, 6144
    s_waitcnt vmcnt(15)
    v_mfma_f32_16x16x32_bf16 v[12:15], v[72:75], v[40:43], v[12:15]
    buffer_load_dwordx4 v[72:75], v1, s[4:7], s32 offen offset:0 nt
    s_add_u32 s32, s32, 6144
    s_waitcnt vmcnt(15)
    v_mfma_f32_16x16x32_bf16 v[12:15], v[76:79], v[44:47], v[12:15]
    buffer_load_dwordx4 v[76:79], v1, s[4:7], s32 offen offset:0 nt
    s_add_u32 s32, s32, 6144
    s_nop 5
    v_add_f32_dpp v57, v13, v12 quad_perm:[1,1,1,1] row_mask:0xf bank_mask:0xf
    s_nop 1
    v_add_f32_dpp v57, v14, v57 quad_perm:[2,2,2,2] row_mask:0xf bank_mask:0xf
    s_nop 1
    v_add_f32_dpp v57, v15, v57 quad_perm:[3,3,3,3] row_mask:0xf bank_mask:0xf
    s_waitcnt vmcnt(15)
    v_mfma_f32_16x16x32_bf16 v[16:19], v[80:83], v[32:35], 0
    buffer_load_dwordx4 v[80:83], v1, s[4:7], s32 offen offset:0 nt
    s_add_u32 s32, s32, 6144
    s_waitcnt vmcnt(15)
    v_mfma_f32_16x16x32_bf16 v[16:19], v[84:87], v[36:39], v[16:19]
    buffer_load_dwordx4 v[84:87], v1, s[4:7], s32 offen offset:0 nt
    s_add_u32 s32, s32, 6144
    s_waitcnt vmcnt(15)
    v_mfma_f32_16x16x32_bf16 v[16:19], v[88:91], v[40:43], v[16:19]
    buffer_load_dwordx4 v[88:91], v1, s[4:7], s32 offen offset:0 nt
    s_add_u32 s32, s32, 6144
    s_waitcnt vmcnt(15)
    v_mfma_f32_16x16x32_bf16 v[16:19], v[92:95], v[44:47], v[16:19]
    buffer_load_dwordx4 v[92:95], v1, s[4:7], s32 offen offset:0 nt
    s_add_u32 s32, s32, 6144
    s_nop 5
    v_add_f32_dpp v3, v16, v17 quad_perm:[0,0,0,0] row_mask:0xf bank_mask:0xf
    s_nop 1
    v_add_f32_dpp v3, v18, v3 quad_perm:[2,2,2,2] row_mask:0xf bank_mask:0xf
    s_nop 1
    v_add_f32_dpp v3, v19, v3 quad_perm:[3,3,3,3] row_mask:0xf bank_mask:0xf
    v_cndmask_b32 v57, v57, v3, s[64:65]
    s_waitcnt vmcnt(15)
    v_mfma_f32_16x16x32_bf16 v[12:15], v[96:99], v[32:35], 0
    buffer_load_dwordx4 v[96:99], v1, s[4:7], s32 offen offset:0 nt
    s_add_u32 s32, s32, 6144
    s_waitcnt vmcnt(15)
    v_mfma_f32_16x16x32_bf16 v[12:15], v[100:103], v[36:39], v[12:15]
    buffer_load_dwordx4 v[100:103], v1, s[4:7], s32 offen offset:0 nt
    s_add_u32 s32, s32, 6144
    s_waitcnt vmcnt(15)
    v_mfma_f32_16x16x32_bf16 v[12:15], v[104:107], v[40:43], v[12:15]
    buffer_load_dwordx4 v[104:107], v1, s[4:7], s32 offen offset:0 nt
    s_add_u32 s32, s32, 6144
    s_waitcnt vmcnt(15)
    v_mfma_f32_16x16x32_bf16 v[12:15], v[108:111], v[44:47], v[12:15]
    buffer_load_dwordx4 v[108:111], v1, s[4:7], s32 offen offset:0 nt
    s_add_u32 s32, s32, 6144
    s_nop 5
    v_add_f32_dpp v3, v12, v14 quad_perm:[0,0,0,0] row_mask:0xf bank_mask:0xf
    s_nop 1
    v_add_f32_dpp v3, v13, v3 quad_perm:[1,1,1,1] row_mask:0xf bank_mask:0xf
    s_nop 1
    v_add_f32_dpp v3, v15, v3 quad_perm:[3,3,3,3] row_mask:0xf bank_mask:0xf
    v_cndmask_b32 v57, v57, v3, s[66:67]
    s_waitcnt vmcnt(15)
    v_mfma_f32_16x16x32_bf16 v[16:19], v[112:115], v[32:35], 0
    buffer_load_dwordx4 v[112:115], v1, s[4:7], s32 offen offset:0 nt
    s_add_u32 s32, s32, 6144
    s_waitcnt vmcnt(15)
    v_mfma_f32_16x16x32_bf16 v[16:19], v[116:119], v[36:39], v[16:19]
    buffer_load_dwordx4 v[116:119], v1, s[4:7], s32 offen offset:0 nt
    s_add_u32 s32, s32, 6144
    s_waitcnt vmcnt(15)
    v_mfma_f32_16x16x32_bf16 v[16:19], v[120:123], v[40:43], v[16:19]
    buffer_load_dwordx4 v[120:123], v1, s[4:7], s32 offen offset:0 nt
    s_add_u32 s32, s32, 6144
    s_waitcnt vmcnt(15)
    v_mfma_f32_16x16x32_bf16 v[16:19], v[124:127], v[44:47], v[16:19]
    buffer_load_dwordx4 v[124:127], v1, s[4:7], s32 offen offset:0 nt
    s_add_u32 s32, s32, 6144
    s_nop 5
    v_add_f32_dpp v3, v16, v19 quad_perm:[0,0,0,0] row_mask:0xf bank_mask:0xf
    s_nop 1
    v_add_f32_dpp v3, v17, v3 quad_perm:[1,1,1,1] row_mask:0xf bank_mask:0xf
    s_nop 1
    v_add_f32_dpp v3, v18, v3 quad_perm:[2,2,2,2] row_mask:0xf bank_mask:0xf
    v_cndmask_b32 v57, v57, v3, s[68:69]
    s_cmp_lg_u32 s27, 3
    s_cbranch_scc1 L_BK_c0
    v_mfma_f32_16x16x32_bf16 v[12:15], a[64:67], v[32:35], 0
    v_mfma_f32_16x16x32_bf16 v[12:15], a[68:71], v[36:39], v[12:15]
    v_mfma_f32_16x16x32_bf16 v[12:15], a[72:75], v[40:43], v[12:15]
    v_mfma_f32_16x16x32_bf16 v[12:15], a[76:79], v[44:47], v[12:15]
    s_nop 7
    v_add_f32_dpp v48, v13, v12 quad_perm:[1,1,1,1] row_mask:0xf bank_mask:0xf
    s_nop 1
    v_add_f32_dpp v48, v14, v48 quad_perm:[2,2,2,2] row_mask:0xf bank_mask:0xf
    s_nop 1
    v_add_f32_dpp v48, v15, v48 quad_perm:[3,3,3,3] row_mask:0xf bank_mask:0xf
    v_mfma_f32_16x16x32_bf16 v[16:19], a[80:83], v[32:35], 0
    v_mfma_f32_16x16x32_bf16 v[16:19], a[84:87], v[36:39], v[16:19]
    v_mfma_f32_16x16x32_bf16 v[16:19], a[88:91], v[40:43], v[16:19]
    v_mfma_f32_16x16x32_bf16 v[16:19], a[92:95], v[44:47], v[16:19]
    s_nop 7
    v_add_f32_dpp v3, v16, v17 quad_perm:[0,0,0,0] row_mask:0xf bank_mask:0xf
    s_nop 1
    v_add_f32_dpp v3, v18, v3 quad_perm:[2,2,2,2] row_mask:0xf bank_mask:0xf
    s_nop 1
    v_add_f32_dpp v3, v19, v3 quad_perm:[3,3,3,3] row_mask:0xf bank_mask:0xf
    v_cndmask_b32 v48, v48, v3, s[64:65]
    v_mfma_f32_16x16x32_bf16 v[12:15], a[96:99], v[32:35], 0
    v_mfma_f32_16x16x32_bf16 v[12:15], a[100:103], v[36:39], v[12:15]
    v_mfma_f32_16x16x32_bf16 v[12:15], a[104:107], v[40:43], v[12:15]
    v_mfma_f32_16x16x32_bf16 v[12:15], a[108:111], v[44:47], v[12:15]
    s_nop 7
    v_add_f32_dpp v3, v12, v14 quad_perm:[0,0,0,0] row_mask:0xf bank_mask:0xf
    s_nop 1
    v_add_f32_dpp v3, v13, v3 quad_perm:[1,1,1,1] row_mask:0xf bank_mask:0xf
    s_nop 1
    v_add_f32_dpp v3, v15, v3 quad_perm:[3,3,3,3] row_mask:0xf bank_mask:0xf
    v_cndmask_b32 v48, v48, v3, s[66:67]
    v_mfma_f32_16x16x32_bf16 v[16:19], a[112:115], v[32:35], 0
    v_mfma_f32_16x16x32_bf16 v[16:19], a[116:119], v[36:39], v[16:19]
    v_mfma_f32_16x16x32_bf16 v[16:19], a[120:123], v[40:43], v[16:19]
    v_mfma_f32_16x16x32_bf16 v[16:19], a[124:127], v[44:47], v[16:19]
    s_nop 7
    v_add_f32_dpp v3, v16, v19 quad_perm:[0,0,0,0] row_mask:0xf bank_mask:0xf
    s_nop 1
    v_add_f32_dpp v3, v17, v3 quad_perm:[1,1,1,1] row_mask:0xf bank_mask:0xf
    s_nop 1
    v_add_f32_dpp v3, v18, v3 quad_perm:[2,2,2,2] row_mask:0xf bank_mask:0xf
    v_cndmask_b32 v48, v48, v3, s[68:69]
L_BK_c0:
    s_cmp_lg_u32 s27, 2
    s_cbranch_scc1 L_BK_b
    v_mfma_f32_16x16x32_bf16 v[12:15], a[0:3], v[32:35], 0
    v_mfma_f32_16x16x32_bf16 v[12:15], a[4:7], v[36:39], v[12:15]
    v_mfma_f32_16x16x32_bf16 v[12:15], a[8:11], v[40:43], v[12:15]
    v_mfma_f32_16x16x32_bf16 v[12:15], a[12:15], v[44:47], v[12:15]
    s_nop 7
    v_add_f32_dpp v58, v13, v12 quad_perm:[1,1,1,1] row_mask:0xf bank_mask:0xf
    s_nop 1
    v_add_f32_dpp v58, v14, v58 quad_perm:[2,2,2,2] row_mask:0xf bank_mask:0xf
    s_nop 1
    v_add_f32_dpp v58, v15, v58 quad_perm:[3,3,3,3] row_mask:0xf bank_mask:0xf
    v_mfma_f32_16x16x32_bf16 v[16:19], a[16:19], v[32:35], 0
    v_mfma_f32_16x16x32_bf16 v[16:19], a[20:23], v[36:39], v[16:19]
    v_mfma_f32_16x16x32_bf16 v[16:19], a[24:27], v[40:43], v[16:19]
    v_mfma_f32_16x16x32_bf16 v[16:19], a[28:31], v[44:47], v[16:19]
    s_nop 7
    v_add_f32_dpp v3, v16, v17 quad_perm:[0,0,0,0] row_mask:0xf bank_mask:0xf
    s_nop 1
    v_add_f32_dpp v3, v18, v3 quad_perm:[2,2,2,2] row_mask:0xf bank_mask:0xf
    s_nop 1
    v_add_f32_dpp v3, v19, v3 quad_perm:[3,3,3,3] row_mask:0xf bank_mask:0xf
    v_cndmask_b32 v58, v58, v3, s[64:65]
    v_mfma_f32_16x16x32_bf16 v[12:15], a[32:35], v[32:35], 0
    v_mfma_f32_16x16x32_bf16 v[12:15], a[36:39], v[36:39], v[12:15]
    v_mfma_f32_16x16x32_bf16 v[12:15], a[40:43], v[40:43], v[12:15]
    s_nop 7
    v_add_f32_dpp v3, v12, v14 quad_perm:[0,0,0,0] row_mask:0xf bank_mask:0xf
    s_nop 1
    v_add_f32_dpp v3, v13, v3 quad_perm:[1,1,1,1] row_mask:0xf bank_mask:0xf
    s_nop 1
    v_add_f32_dpp v3, v15, v3 quad_perm:[3,3,3,3] row_mask:0xf bank_mask:0xf
    v_cndmask_b32 v58, v58, v3, s[66:67]
    s_mul_i32 s24, s31, 1
    s_sub_i32 s24, 4, s24
    s_max_i32 s24, s24, 0
    s_min_i32 s24, s24, 1
    s_add_u32 s24, s24, 10
    v_and_b32 v3, 3, v0
    v_bfe_u32 v4, v0, 2, 2
    v_lshl_add_u32 v3, v3, 2, v4
    v_mov_b32 v4, 0xff800000
    v_cmp_gt_u32 vcc, s24, v3
    s_nop 1
    v_cndmask_b32 v58, v4, v58, vcc
    v_mov_b32 v61, 0x3e0293ee
    v_mov_b32 v7, 0
    s_lshr_b32 s34, s2, 3
    s_lshl_b32 s34, s34, 12
    s_and_b32 s24, s2, 7
    s_lshl_b32 s24, s24, 7
    s_add_u32 s34, s34, s24
    s_add_u32 s34, s34, 0x1b8000
L_BK_b:
    s_add_u32 s27, s27, 1
    s_cmp_lt_u32 s27, 10
    s_cbranch_scc1 L_BK
    v_max3_f32 v3, v48, v49, v50
    v_max3_f32 v3, v3, v51, v52
    v_max3_f32 v3, v3, v53, v54
    v_max3_f32 v3, v3, v55, v56
    v_max3_f32 v3, v3, v57, v58
    s_nop 1
    v_max_f32_dpp v3, v3, v3 row_ror:8 row_mask:0xf bank_mask:0xf
    s_nop 1
    v_max_f32_dpp v3, v3, v3 row_ror:4 row_mask:0xf bank_mask:0xf
    s_nop 1
    v_max_f32_dpp v3, v3, v3 row_ror:2 row_mask:0xf bank_mask:0xf
    s_nop 1
    v_max_f32_dpp v3, v3, v3 row_ror:1 row_mask:0xf bank_mask:0xf
    s_nop 1
    v_max_f32_dpp v3, v3, v3 row_bcast:15 row_mask:0xa bank_mask:0xf
    s_nop 1
    v_max_f32_dpp v3, v3, v3 row_bcast:31 row_mask:0xc bank_mask:0xf
    s_nop 0
    v_readlane_b32 s24, v3, 63
    s_nop 1
    v_mul_f32 v6, s24, v61
    v_mov_b32 v12, 0
    v_mov_b32 v13, 0
    v_mov_b32 v14, 0
    v_mov_b32 v15, 0
    v_fma_f32 v48, v48, v61, -v6
    v_exp_f32 v48, v48
    s_nop 0
    v_add_f32 v7, v7, v48
    v_cvt_pk_bf16_f32 v48, v48, v48
    s_mov_b32 s27, 0
L_BV:
    s_barrier
    s_cmp_ge_u32 s27, 1
    s_cselect_b32 s71, s3, 4
    s_cmp_lg_u32 s71, 0
    s_cbranch_scc1 L_BV_p0
    s_lshl_b32 s24, s27, 2
    s_add_u32 s24, s24, 0
    s_mov_b64 exec, 1
    v_mov_b32 v63, s24
    s_cmp_lg_u32 s75, 0
    s_cbranch_scc1 L_far3
    buffer_store_dword v63, off, s[12:15], s34 offset:64
    s_branch L_near3
L_far3:
    buffer_store_dword v63, off, s[12:15], s34 offset:64 sc1
L_near3:
    s_mov_b64 exec, -1
L_BV_p0:
    v_and_b32_dpp v8, v48, v20 row_newbcast:0 row_mask:0xf bank_mask:0xf
    v_and_b32_dpp v9, v48, v21 row_newbcast:0 row_mask:0xf bank_mask:0xf
    v_and_b32_dpp v10, v48, v22 row_newbcast:0 row_mask:0xf bank_mask:0xf
    v_and_b32_dpp v11, v48, v23 row_newbcast:0 row_mask:0xf bank_mask:0xf
    s_waitcnt vmcnt(15)
    s_nop 0
    v_mfma_f32_16x16x32_bf16 v[12:15], v[64:67], v[8:11], v[12:15]
    buffer_load_dwordx4 v[64:67], v1, s[4:7], s32 offen offset:0 nt
    s_add_u32 s32, s32, 6144
    v_and_b32_dpp v8, v48, v20 row_newbcast:4 row_mask:0xf bank_mask:0xf
    v_and_b32_dpp v9, v48, v21 row_newbcast:4 row_mask:0xf bank_mask:0xf
    v_and_b32_dpp v10, v48, v22 row_newbcast:4 row_mask:0xf bank_mask:0xf
    v_and_b32_dpp v11, v48, v23 row_newbcast:4 row_mask:0xf bank_mask:0xf
    s_waitcnt vmcnt(15)
    s_nop 0
    v_mfma_f32_16x16x32_bf16 v[12:15], v[68:71], v[8:11], v[12:15]
    buffer_load_dwordx4 v[68:71], v1, s[4:7], s32 offen offset:0 nt
    s_add_u32 s32, s32, 6144
    v_and_b32_dpp v8, v48, v20 row_newbcast:8 row_mask:0xf bank_mask:0xf
    v_and_b32_dpp v9, v48, v21 row_newbcast:8 row_mask:0xf bank_mask:0xf
    v_and_b32_dpp v10, v48, v22 row_newbcast:8 row_mask:0xf bank_mask:0xf
    v_and_b32_dpp v11, v48, v23 row_newbcast:8 row_mask:0xf bank_mask:0xf
    s_waitcnt vmcnt(15)
    s_nop 0
    v_mfma_f32_16x16x32_bf16 v[12:15], v[72:75], v[8:11], v[12:15]
    buffer_load_dwordx4 v[72:75], v1, s[4:7], s32 offen offset:0 nt
    s_add_u32 s32, s32, 6144
    v_and_b32_dpp v8, v48, v20 row_newbcast:12 row_mask:0xf bank_mask:0xf
    v_and_b32_dpp v9, v48, v21 row_newbcast:12 row_mask:0xf bank_mask:0xf
    v_and_b32_dpp v10, v48, v22 row_newbcast:12 row_mask:0xf bank_mask:0xf
    v_and_b32_dpp v11, v48, v23 row_newbcast:12 row_mask:0xf bank_mask:0xf
    s_waitcnt vmcnt(15)
    s_nop 0
    v_mfma_f32_16x16x32_bf16 v[12:15], v[76:79], v[8:11], v[12:15]
    buffer_load_dwordx4 v[76:79], v1, s[4:7], s32 offen offset:0 nt
    s_add_u32 s32, s32, 6144
    s_cmp_lg_u32 s71, 1
    s_cbranch_scc1 L_BV_p1
    s_lshl_b32 s24, s27, 2
    s_add_u32 s24, s24, 1
    s_mov_b64 exec, 1
    v_mov_b32 v63, s24
    s_cmp_lg_u32 s75, 0
    s_cbranch_scc1 L_far4
    buffer_store_dword v63, off, s[12:15], s34 offset:64
    s_branch L_near4
L_far4:
    buffer_store_dword v63, off, s[12:15], s34 offset:64 sc1
L_near4:
    s_mov_b64 exec, -1
L_BV_p1:
    v_and_b32_dpp v8, v48, v20 row_newbcast:1 row_mask:0xf bank_mask:0xf
    v_and_b32_dpp v9, v48, v21 row_newbcast:1 row_mask:0xf bank_mask:0xf
    v_and_b32_dpp v10, v48, v22 row_newbcast:1 row_mask:0xf bank_mask:0xf
    v_and_b32_dpp v11, v48, v23 row_newbcast:1 row_mask:0xf bank_mask:0xf
    s_waitcnt vmcnt(15)
    s_nop 0
    v_mfma_f32_16x16x32_bf16 v[12:15], v[80:83], v[8:11], v[12:15]
    buffer_load_dwordx4 v[80:83], v1, s[4:7], s32 offen offset:0 nt
    s_add_u32 s32, s32, 6144
    v_and_b32_dpp v8, v48, v20 row_newbcast:5 row_mask:0xf bank_mask:0xf
    v_and_b32_dpp v9, v48, v21 row_newbcast:5 row_mask:0xf bank_mask:0xf
    v_and_b32_dpp v10, v48, v22 row_newbcast:5 row_mask:0xf bank_mask:0xf
    v_and_b32_dpp v11, v48, v23 row_newbcast:5 row_mask:0xf bank_mask:0xf
    s_waitcnt vmcnt(15)
    s_nop 0
    v_mfma_f32_16x16x32_bf16 v[12:15], v[84:87], v[8:11], v[12:15]
    buffer_load_dwordx4 v[84:87], v1, s[4:7], s32 offen offset:0 nt
    s_add_u32 s32, s32, 6144
    v_and_b32_dpp v8, v48, v20 row_newbcast:9 row_mask:0xf bank_mask:0xf
    v_and_b32_dpp v9, v48, v21 row_newbcast:9 row_mask:0xf bank_mask:0xf
    v_and_b32_dpp v10, v48, v22 row_newbcast:9 row_mask:0xf bank_mask:0xf
    v_and_b32_dpp v11, v48, v23 row_newbcast:9 row_mask:0xf bank_mask:0xf
    s_waitcnt vmcnt(15)
    s_nop 0
    v_mfma_f32_16x16x32_bf16 v[12:15], v[88:91], v[8:11], v[12:15]
    buffer_load_dwordx4 v[88:91], v1, s[4:7], s32 offen offset:0 nt
    s_add_u32 s32, s32, 6144
    v_and_b32_dpp v8, v48, v20 row_newbcast:13 row_mask:0xf bank_mask:0xf
    v_and_b32_dpp v9, v48, v21 row_newbcast:13 row_mask:0xf bank_mask:0xf
    v_and_b32_dpp v10, v48, v22 row_newbcast:13 row_mask:0xf bank_mask:0xf
    v_and_b32_dpp v11, v48, v23 row_newbcast:13 row_mask:0xf bank_mask:0xf
    s_waitcnt vmcnt(15)
    s_nop 0
    v_mfma_f32_16x16x32_bf16 v[12:15], v[92:95], v[8:11], v[12:15]
    buffer_load_dwordx4 v[92:95], v1, s[4:7], s32 offen offset:0 nt
    s_add_u32 s32, s32, 6144
    s_cmp_lg_u32 s71, 2
    s_cbranch_scc1 L_BV_p2
    s_lshl_b32 s24, s27, 2
    s_add_u32 s24, s24, 2
    s_mov_b64 exec, 1
    v_mov_b32 v63, s24
    s_cmp_lg_u32 s75, 0
    s_cbranch_scc1 L_far5
    buffer_store_dword v63, off, s[12:15], s34 offset:64
    s_branch L_near5
L_far5:
    buffer_store_dword v63, off, s[12:15], s34 offset:64 sc1
L_near5:
    s_mov_b64 exec, -1
L_BV_p2:
    v_and_b32_dpp v8, v48, v20 row_newbcast:2 row_mask:0xf bank_mask:0xf
    v_and_b32_dpp v9, v48, v21 row_newbcast:2 row_mask:0xf bank_mask:0xf
    v_and_b32_dpp v10, v48, v22 row_newbcast:2 row_mask:0xf bank_mask:0xf
    v_and_b32_dpp v11, v48, v23 row_newbcast:2 row_mask:0xf bank_mask:0xf
    s_waitcnt vmcnt(15)
    s_nop 0
    v_mfma_f32_16x16x32_bf16 v[12:15], v[96:99], v[8:11], v[12:15]
    buffer_load_dwordx4 v[96:99], v1, s[4:7], s32 offen offset:0 nt
    s_add_u32 s32, s32, 6144
    v_and_b32_dpp v8, v48, v20 row_newbcast:6 row_mask:0xf bank_mask:0xf
    v_and_b32_dpp v9, v48, v21 row_newbcast:6 row_mask:0xf bank_mask:0xf
    v_and_b32_dpp v10, v48, v22 row_newbcast:6 row_mask:0xf bank_mask:0xf
    v_and_b32_dpp v11, v48, v23 row_newbcast:6 row_mask:0xf bank_mask:0xf
    s_waitcnt vmcnt(15)
    s_nop 0
    v_mfma_f32_16x16x32_bf16 v[12:15], v[100:103], v[8:11], v[12:15]
    buffer_load_dwordx4 v[100:103], v1, s[4:7], s32 offen offset:0 nt
    s_add_u32 s32, s32, 6144
    s_cmp_eq_u32 s27, 9
    s_cbranch_scc1 L_BT
    v_and_b32_dpp v8, v48, v20 row_newbcast:10 row_mask:0xf bank_mask:0xf
    v_and_b32_dpp v9, v48, v21 row_newbcast:10 row_mask:0xf bank_mask:0xf
    v_and_b32_dpp v10, v48, v22 row_newbcast:10 row_mask:0xf bank_mask:0xf
    v_and_b32_dpp v11, v48, v23 row_newbcast:10 row_mask:0xf bank_mask:0xf
    s_waitcnt vmcnt(15)
    s_nop 0
    v_mfma_f32_16x16x32_bf16 v[12:15], v[104:107], v[8:11], v[12:15]
    buffer_load_dwordx4 v[104:107], v1, s[4:7], s32 offen offset:0 nt
    s_add_u32 s32, s32, 6144
    v_and_b32_dpp v8, v48, v20 row_newbcast:14 row_mask:0xf bank_mask:0xf
    v_and_b32_dpp v9, v48, v21 row_newbcast:14 row_mask:0xf bank_mask:0xf
    v_and_b32_dpp v10, v48, v22 row_newbcast:14 row_mask:0xf bank_mask:0xf
    v_and_b32_dpp v11, v48, v23 row_newbcast:14 row_mask:0xf bank_mask:0xf
    s_waitcnt vmcnt(15)
    s_nop 0
    v_mfma_f32_16x16x32_bf16 v[12:15], v[108:111], v[8:11], v[12:15]
    buffer_load_dwordx4 v[108:111], v1, s[4:7], s32 offen offset:0 nt
    s_add_u32 s32, s32, 6144
    s_cmp_lg_u32 s71, 3
    s_cbranch_scc1 L_BV_p3
    s_lshl_b32 s24, s27, 2
    s_add_u32 s24, s24, 3
    s_mov_b64 exec, 1
    v_mov_b32 v63, s24
    s_cmp_lg_u32 s75, 0
    s_cbranch_scc1 L_far6
    buffer_store_dword v63, off, s[12:15], s34 offset:64
    s_branch L_near6
L_far6:
    buffer_store_dword v63, off, s[12:15], s34 offset:64 sc1
L_near6:
    s_mov_b64 exec, -1
L_BV_p3:
    v_and_b32_dpp v8, v48, v20 row_newbcast:3 row_mask:0xf bank_mask:0xf
    v_and_b32_dpp v9, v48, v21 row_newbcast:3 row_mask:0xf bank_mask:0xf
    v_and_b32_dpp v10, v48, v22 row_newbcast:3 row_mask:0xf bank_mask:0xf
    v_and_b32_dpp v11, v48, v23 row_newbcast:3 row_mask:0xf bank_mask:0xf
    s_waitcnt vmcnt(15)
    s_nop 0
    v_mfma_f32_16x16x32_bf16 v[12:15], v[112:115], v[8:11], v[12:15]
    buffer_load_dwordx4 v[112:115], v1, s[4:7], s32 offen offset:0 nt
    s_add_u32 s32, s32, 6144
    s_cmp_lg_u32 s27, 0
    s_cbranch_scc1 L_BV_d
    v_fma_f32 v49, v49, v61, -v6
    v_fma_f32 v50, v50, v61, -v6
    v_fma_f32 v51, v51, v61, -v6
    v_fma_f32 v52, v52, v61, -v6
    v_fma_f32 v53, v53, v61, -v6
    v_fma_f32 v54, v54, v61, -v6
    v_fma_f32 v55, v55, v61, -v6
    v_fma_f32 v56, v56, v61, -v6
    v_fma_f32 v57, v57, v61, -v6
    v_fma_f32 v58, v58, v61, -v6
    v_exp_f32 v49, v49
    v_exp_f32 v50, v50
    v_exp_f32 v51, v51
    v_exp_f32 v52, v52
    v_exp_f32 v53, v53
    v_exp_f32 v54, v54
    v_exp_f32 v55, v55
    v_exp_f32 v56, v56
    v_exp_f32 v57, v57
    v_exp_f32 v58, v58
    v_add_f32 v7, v7, v49
    v_add_f32 v7, v7, v50
    v_add_f32 v7, v7, v51
    v_add_f32 v7, v7, v52
    v_add_f32 v7, v7, v53
    v_add_f32 v7, v7, v54
    v_add_f32 v7, v7, v55
    v_add_f32 v7, v7, v56
    v_add_f32 v7, v7, v57
    v_add_f32 v7, v7, v58
    v_cvt_pk_bf16_f32 v49, v49, v49
    v_cvt_pk_bf16_f32 v50, v50, v50
    v_cvt_pk_bf16_f32 v51, v51, v51
    v_cvt_pk_bf16_f32 v52, v52, v52
    v_cvt_pk_bf16_f32 v53, v53, v53
    v_cvt_pk_bf16_f32 v54, v54, v54
    v_cvt_pk_bf16_f32 v55, v55, v55
    v_cvt_pk_bf16_f32 v56, v56, v56
    v_cvt_pk_bf16_f32 v57, v57, v57
    v_cvt_pk_bf16_f32 v58, v58, v58
    v_add_f32_dpp v7, v7, v7 row_ror:8 row_mask:0xf bank_mask:0xf
    s_nop 1
    v_add_f32_dpp v7, v7, v7 row_ror:4 row_mask:0xf bank_mask:0xf
    s_nop 1
    v_add_f32_dpp v7, v7, v7 row_ror:2 row_mask:0xf bank_mask:0xf
    s_nop 1
    v_add_f32_dpp v7, v7, v7 row_ror:1 row_mask:0xf bank_mask:0xf
    s_nop 1
    v_add_f32_dpp v7, v7, v7 row_bcast:15 row_mask:0xa bank_mask:0xf
    s_nop 1
    v_add_f32_dpp v7, v7, v7 row_bcast:31 row_mask:0xc bank_mask:0xf
    s_nop 0
    v_readlane_b32 s70, v7, 63
    s_lshl_b32 s25, s3, 4
    s_add_u32 s25, s25, s34
    s_mov_b64 exec, 1
    v_mov_b32 v7, s70
    s_cmp_lg_u32 s75, 0
    s_cbranch_scc1 L_far7
    buffer_store_dwordx2 v[6:7], off, s[12:15], s25
    s_branch L_near7
L_far7:
    buffer_store_dwordx2 v[6:7], off, s[12:15], s25 sc1
L_near7:
    s_mov_b64 exec, -1
L_BV_d:
    v_and_b32_dpp v8, v48, v20 row_newbcast:7 row_mask:0xf bank_mask:0xf
    v_and_b32_dpp v9, v48, v21 row_newbcast:7 row_mask:0xf bank_mask:0xf
    v_and_b32_dpp v10, v48, v22 row_newbcast:7 row_mask:0xf bank_mask:0xf
    v_and_b32_dpp v11, v48, v23 row_newbcast:7 row_mask:0xf bank_mask:0xf
    s_waitcnt vmcnt(15)
    s_nop 0
    v_mfma_f32_16x16x32_bf16 v[12:15], v[116:119], v[8:11], v[12:15]
    buffer_load_dwordx4 v[116:119], v1, s[4:7], s32 offen offset:0 nt
    s_add_u32 s32, s32, 6144
    v_and_b32_dpp v8, v48, v20 row_newbcast:11 row_mask:0xf bank_mask:0xf
    v_and_b32_dpp v9, v48, v21 row_newbcast:11 row_mask:0xf bank_mask:0xf
    v_and_b32_dpp v10, v48, v22 row_newbcast:11 row_mask:0xf bank_mask:0xf
    v_and_b32_dpp v11, v48, v23 row_newbcast:11 row_mask:0xf bank_mask:0xf
    s_waitcnt vmcnt(15)
    s_nop 0
    v_mfma_f32_16x16x32_bf16 v[12:15], v[120:123], v[8:11], v[12:15]
    buffer_load_dwordx4 v[120:123], v1, s[4:7], s32 offen offset:0 nt
    s_add_u32 s32, s32, 6144
    v_and_b32_dpp v8, v48, v20 row_newbcast:15 row_mask:0xf bank_mask:0xf
    v_and_b32_dpp v9, v48, v21 row_newbcast:15 row_mask:0xf bank_mask:0xf
    v_and_b32_dpp v10, v48, v22 row_newbcast:15 row_mask:0xf bank_mask:0xf
    v_and_b32_dpp v11, v48, v23 row_newbcast:15 row_mask:0xf bank_mask:0xf
    s_waitcnt vmcnt(15)
    s_nop 0
    v_mfma_f32_16x16x32_bf16 v[12:15], v[124:127], v[8:11], v[12:15]
    buffer_load_dwordx4 v[124:127], v1, s[4:7], s32 offen offset:0 nt
    s_add_u32 s32, s32, 6144
    v_mov_b32 v48, v49
    v_mov_b32 v49, v50
    v_mov_b32 v50, v51
    v_mov_b32 v51, v52
    v_mov_b32 v52, v53
    v_mov_b32 v53, v54
    v_mov_b32 v54, v55
    v_mov_b32 v55, v56
    v_mov_b32 v56, v57
    v_mov_b32 v57, v58
    s_add_u32 s27, s27, 1
    s_branch L_BV
L_BT:
    v_and_b32_dpp v8, v48, v20 row_newbcast:10 row_mask:0xf bank_mask:0xf
    v_and_b32_dpp v9, v48, v21 row_newbcast:10 row_mask:0xf bank_mask:0xf
    v_and_b32_dpp v10, v48, v22 row_newbcast:10 row_mask:0xf bank_mask:0xf
    v_and_b32_dpp v11, v48, v23 row_newbcast:10 row_mask:0xf bank_mask:0xf
    s_waitcnt vmcnt(15)
    s_nop 0
    v_mfma_f32_16x16x32_bf16 v[12:15], v[104:107], v[8:11], v[12:15]
    buffer_load_dwordx4 v[104:107], v1, s[4:7], s28 offen offset:0 nt
    v_and_b32_dpp v8, v48, v20 row_newbcast:14 row_mask:0xf bank_mask:0xf
    v_and_b32_dpp v9, v48, v21 row_newbcast:14 row_mask:0xf bank_mask:0xf
    v_and_b32_dpp v10, v48, v22 row_newbcast:14 row_mask:0xf bank_mask:0xf
    v_and_b32_dpp v11, v48, v23 row_newbcast:14 row_mask:0xf bank_mask:0xf
    s_waitcnt vmcnt(15)
    s_nop 0
    v_mfma_f32_16x16x32_bf16 v[12:15], v[108:111], v[8:11], v[12:15]
    v_and_b32_dpp v8, v48, v20 row_newbcast:3 row_mask:0xf bank_mask:0xf
    v_and_b32_dpp v9, v48, v21 row_newbcast:3 row_mask:0xf bank_mask:0xf
    v_and_b32_dpp v10, v48, v22 row_newbcast:3 row_mask:0xf bank_mask:0xf
    v_and_b32_dpp v11, v48, v23 row_newbcast:3 row_mask:0xf bank_mask:0xf
    s_waitcnt vmcnt(14)
    s_nop 0
    v_mfma_f32_16x16x32_bf16 v[12:15], v[112:115], v[8:11], v[12:15]
    v_and_b32_dpp v8, v48, v20 row_newbcast:7 row_mask:0xf bank_mask:0xf
    v_and_b32_dpp v9, v48, v21 row_newbcast:7 row_mask:0xf bank_mask:0xf
    v_and_b32_dpp v10, v48, v22 row_newbcast:7 row_mask:0xf bank_mask:0xf
    v_and_b32_dpp v11, v48, v23 row_newbcast:7 row_mask:0xf bank_mask:0xf
    s_waitcnt vmcnt(13)
    s_nop 0
    v_mfma_f32_16x16x32_bf16 v[12:15], v[116:119], v[8:11], v[12:15]
    v_and_b32_dpp v8, v48, v20 row_newbcast:11 row_mask:0xf bank_mask:0xf
    v_and_b32_dpp v9, v48, v21 row_newbcast:11 row_mask:0xf bank_mask:0xf
    v_and_b32_dpp v10, v48, v22 row_newbcast:11 row_mask:0xf bank_mask:0xf
    v_and_b32_dpp v11, v48, v23 row_newbcast:11 row_mask:0xf bank_mask:0xf
    s_waitcnt vmcnt(12)
    s_nop 0
    v_mfma_f32_16x16x32_bf16 v[12:15], v[120:123], v[8:11], v[12:15]
    v_and_b32_dpp v8, v48, v20 row_newbcast:15 row_mask:0xf bank_mask:0xf
    v_and_b32_dpp v9, v48, v21 row_newbcast:15 row_mask:0xf bank_mask:0xf
    v_and_b32_dpp v10, v48, v22 row_newbcast:15 row_mask:0xf bank_mask:0xf
    v_and_b32_dpp v11, v48, v23 row_newbcast:15 row_mask:0xf bank_mask:0xf
    s_waitcnt vmcnt(11)
    s_nop 0
    v_mfma_f32_16x16x32_bf16 v[12:15], v[124:127], v[8:11], v[12:15]
    v_and_b32_dpp v8, v49, v20 row_newbcast:0 row_mask:0xf bank_mask:0xf
    v_and_b32_dpp v9, v49, v21 row_newbcast:0 row_mask:0xf bank_mask:0xf
    v_and_b32_dpp v10, v49, v22 row_newbcast:0 row_mask:0xf bank_mask:0xf
    v_and_b32_dpp v11, v49, v23 row_newbcast:0 row_mask:0xf bank_mask:0xf
    s_waitcnt vmcnt(10)
    s_nop 0
    v_mfma_f32_16x16x32_bf16 v[12:15], v[64:67], v[8:11], v[12:15]
    v_and_b32_dpp v8, v49, v20 row_newbcast:4 row_mask:0xf bank_mask:0xf
    v_and_b32_dpp v9, v49, v21 row_newbcast:4 row_mask:0xf bank_mask:0xf
    v_and_b32_dpp v10, v49, v22 row_newbcast:4 row_mask:0xf bank_mask:0xf
    v_and_b32_dpp v11, v49, v23 row_newbcast:4 row_mask:0xf bank_mask:0xf
    s_waitcnt vmcnt(9)
    s_nop 0
    v_mfma_f32_16x16x32_bf16 v[12:15], v[68:71], v[8:11], v[12:15]
    v_and_b32_dpp v8, v49, v20 row_newbcast:8 row_mask:0xf bank_mask:0xf
    v_and_b32_dpp v9, v49, v21 row_newbcast:8 row_mask:0xf bank_mask:0xf
    v_and_b32_dpp v10, v49, v22 row_newbcast:8 row_mask:0xf bank_mask:0xf
    v_and_b32_dpp v11, v49, v23 row_newbcast:8 row_mask:0xf bank_mask:0xf
    s_waitcnt vmcnt(8)
    s_nop 0
    v_mfma_f32_16x16x32_bf16 v[12:15], v[72:75], v[8:11], v[12:15]
    v_and_b32_dpp v8, v49, v20 row_newbcast:12 row_mask:0xf bank_mask:0xf
    v_and_b32_dpp v9, v49, v21 row_newbcast:12 row_mask:0xf bank_mask:0xf
    v_and_b32_dpp v10, v49, v22 row_newbcast:12 row_mask:0xf bank_mask:0xf
    v_and_b32_dpp v11, v49, v23 row_newbcast:12 row_mask:0xf bank_mask:0xf
    s_waitcnt vmcnt(7)
    s_nop 0
    v_mfma_f32_16x16x32_bf16 v[12:15], v[76:79], v[8:11], v[12:15]
    v_and_b32_dpp v8, v49, v20 row_newbcast:1 row_mask:0xf bank_mask:0xf
    v_and_b32_dpp v9, v49, v21 row_newbcast:1 row_mask:0xf bank_mask:0xf
    v_and_b32_dpp v10, v49, v22 row_newbcast:1 row_mask:0xf bank_mask:0xf
    v_and_b32_dpp v11, v49, v23 row_newbcast:1 row_mask:0xf bank_mask:0xf
    s_waitcnt vmcnt(6)
    s_nop 0
    v_mfma_f32_16x16x32_bf16 v[12:15], v[80:83], v[8:11], v[12:15]
    v_and_b32_dpp v8, v49, v20 row_newbcast:5 row_mask:0xf bank_mask:0xf
    v_and_b32_dpp v9, v49, v21 row_newbcast:5 row_mask:0xf bank_mask:0xf
    v_and_b32_dpp v10, v49, v22 row_newbcast:5 row_mask:0xf bank_mask:0xf
    v_and_b32_dpp v11, v49, v23 row_newbcast:5 row_mask:0xf bank_mask:0xf
    s_waitcnt vmcnt(5)
    s_nop 0
    v_mfma_f32_16x16x32_bf16 v[12:15], v[84:87], v[8:11], v[12:15]
    v_and_b32_dpp v8, v49, v20 row_newbcast:9 row_mask:0xf bank_mask:0xf
    v_and_b32_dpp v9, v49, v21 row_newbcast:9 row_mask:0xf bank_mask:0xf
    v_and_b32_dpp v10, v49, v22 row_newbcast:9 row_mask:0xf bank_mask:0xf
    v_and_b32_dpp v11, v49, v23 row_newbcast:9 row_mask:0xf bank_mask:0xf
    s_waitcnt vmcnt(4)
    s_nop 0
    v_mfma_f32_16x16x32_bf16 v[12:15], v[88:91], v[8:11], v[12:15]
    v_and_b32_dpp v8, v49, v20 row_newbcast:13 row_mask:0xf bank_mask:0xf
    v_and_b32_dpp v9, v49, v21 row_newbcast:13 row_mask:0xf bank_mask:0xf
    v_and_b32_dpp v10, v49, v22 row_newbcast:13 row_mask:0xf bank_mask:0xf
    v_and_b32_dpp v11, v49, v23 row_newbcast:13 row_mask:0xf bank_mask:0xf
    s_waitcnt vmcnt(3)
    s_nop 0
    v_mfma_f32_16x16x32_bf16 v[12:15], v[92:95], v[8:11], v[12:15]
    v_and_b32_dpp v8, v49, v20 row_newbcast:2 row_mask:0xf bank_mask:0xf
    v_and_b32_dpp v9, v49, v21 row_newbcast:2 row_mask:0xf bank_mask:0xf
    v_and_b32_dpp v10, v49, v22 row_newbcast:2 row_mask:0xf bank_mask:0xf
    v_and_b32_dpp v11, v49, v23 row_newbcast:2 row_mask:0xf bank_mask:0xf
    s_waitcnt vmcnt(2)
    s_nop 0
    v_mfma_f32_16x16x32_bf16 v[12:15], v[96:99], v[8:11], v[12:15]
    v_and_b32_dpp v8, v49, v20 row_newbcast:6 row_mask:0xf bank_mask:0xf
    v_and_b32_dpp v9, v49, v21 row_newbcast:6 row_mask:0xf bank_mask:0xf
    v_and_b32_dpp v10, v49, v22 row_newbcast:6 row_mask:0xf bank_mask:0xf
    v_and_b32_dpp v11, v49, v23 row_newbcast:6 row_mask:0xf bank_mask:0xf
    s_waitcnt vmcnt(1)
    s_nop 0
    v_mfma_f32_16x16x32_bf16 v[12:15], v[100:103], v[8:11], v[12:15]
    v_and_b32_dpp v8, v49, v20 row_newbcast:10 row_mask:0xf bank_mask:0xf
    v_and_b32_dpp v9, v49, v21 row_newbcast:10 row_mask:0xf bank_mask:0xf
    v_and_b32_dpp v10, v49, v22 row_newbcast:10 row_mask:0xf bank_mask:0xf
    v_and_b32_dpp v11, v49, v23 row_newbcast:10 row_mask:0xf bank_mask:0xf
    s_waitcnt vmcnt(0)
    s_nop 0
    v_mfma_f32_16x16x32_bf16 v[12:15], v[104:107], v[8:11], v[12:15]
    s_mov_b32 exec_lo, 0x00ff00ff
    s_mov_b32 exec_hi, 0x00ff00ff
    s_cmp_lg_u32 s75, 0
    s_nop 4
    v_cvt_pk_bf16_f32 v4, v12, v13
    v_cvt_pk_bf16_f32 v5, v14, v15
    s_cbranch_scc1 L_far8
    buffer_store_dwordx2 v[4:5], v60, s[12:15], s73 offen
    s_branch L_near8
L_far8:
    buffer_store_dwordx2 v[4:5], v60, s[12:15], s73 offen sc1
L_near8:
    s_endpgm
L_A:
    v_lshrrev_b32 v1, 6, v0
    v_and_b32 v0, 63, v0
    v_readfirstlane_b32 s3, v1
    v_lshlrev_b32 v2, 4, v0
    s_mov_b32 s74, s2
    s_and_b32 s72, s2, 31
    s_and_b32 s70, s2, 6
    s_and_b32 s25, s2, 7
    s_add_u32 s70, s70, s25
    s_lshr_b32 s26, s72, 3
    s_and_b32 s25, s26, 1
    s_lshl_b32 s25, s25, 1
    s_and_b32 s26, s26, 2
    s_lshl_b32 s26, s26, 3
    s_or_b32 s26, s26, s25
    s_or_b32 s26, s26, s70
    v_lshrrev_b32 v3, 4, v0
    v_and_b32 v4, 15, v0
    v_lshlrev_b32 v18, 18, v3
    v_lshl_add_u32 v18, v4, 4, v18
    v_lshrrev_b32 v6, 3, v4
    v_lshlrev_b32 v6, 10, v6
    v_lshl_add_u32 v19, v3, 6, v6
    v_bfe_u32 v1, v0, 2, 2
    v_lshlrev_b32 v64, 18, v1
    v_lshl_add_u32 v64, v3, 6, v64
    v_and_b32 v4, 3, v0
    v_lshl_add_u32 v64, v4, 4, v64
    v_lshlrev_b32 v65, 9, v1
    v_lshl_add_u32 v65, v3, 7, v65
    v_lshl_add_u32 v65, v4, 5, v65
    v_add_u32 v65, 135168, v65
    v_lshlrev_b32 v66, 17, v1
    v_lshl_add_u32 v66, v3, 6, v66
    v_lshl_add_u32 v66, v4, 4, v66
    v_and_b32 v4, 15, v0
    v_lshlrev_b32 v67, 10, v3
    v_lshl_add_u32 v67, v4, 4, v67
    s_lshl_b32 s35, s3, 20
    s_lshl_b32 s24, s26, 8
    s_add_u32 s35, s35, s24
    s_waitcnt lgkmcnt(0)
    s_cmp_lt_u32 s74, 32
    s_cselect_b64 s[4:5], s[40:41], s[54:55]
    s_mov_b32 s6, 0x400000
    s_mov_b32 s7, 0x20000
    s_cselect_b64 s[20:21], s[36:37], s[48:49]
    s_mov_b32 s22, 4096
    s_mov_b32 s23, 0x20000
    s_cselect_b32 s75, 0x400000, 0
    s_lshl_b32 s24, s3, 8
    s_mov_b32 s32, s35
    buffer_load_dwordx4 v[12:15], v67, s[20:23], s24 offen
    buffer_load_dwordx4 v[128:131], v18, s[4:7], s32 offen
    s_add_u32 s32, s32, 8192
    buffer_load_dwordx4 v[132:135], v18, s[4:7], s32 offen
    s_add_u32 s32, s32, 8192
    buffer_load_dwordx4 v[136:139], v18, s[4:7], s32 offen
    s_add_u32 s32, s32, 8192
    buffer_load_dwordx4 v[140:143], v18, s[4:7], s32 offen
    s_add_u32 s32, s32, 8192
    buffer_load_dwordx4 v[144:147], v18, s[4:7], s32 offen
    s_add_u32 s32, s32, 8192
    buffer_load_dwordx4 v[148:151], v18, s[4:7], s32 offen
    s_add_u32 s32, s32, 8192
    buffer_load_dwordx4 v[152:155], v18, s[4:7], s32 offen
    s_add_u32 s32, s32, 8192
    buffer_load_dwordx4 v[156:159], v18, s[4:7], s32 offen
    s_add_u32 s32, s32, 8192
    buffer_load_dwordx4 v[160:163], v18, s[4:7], s32 offen
    s_add_u32 s32, s32, 8192
    buffer_load_dwordx4 v[164:167], v18, s[4:7], s32 offen
    s_add_u32 s32, s32, 8192
    buffer_load_dwordx4 v[168:171], v18, s[4:7], s32 offen
    s_add_u32 s32, s32, 8192
    buffer_load_dwordx4 v[172:175], v18, s[4:7], s32 offen
    s_add_u32 s32, s32, 8192
    s_mov_b32 s12, s62
    s_mov_b32 s13, s63
    s_mov_b32 s14, 0x600000
    s_mov_b32 s15, 0x20000
    s_mov_b32 s16, s60
    s_mov_b32 s17, s61
    s_mov_b32 s18, 0x100
    s_mov_b32 s19, 0x20000
    v_and_b32 v3, 1, v0
    v_lshlrev_b32 v3, 4, v3
    v_mov_b32 v4, 0xffff
    v_lshlrev_b32 v4, v3, v4
    v_bfe_u32 v3, v0, 1, 2
    v_cmp_eq_u32 vcc, 0, v3
    s_nop 1
    v_cndmask_b32 v20, 0, v4, vcc
    v_cmp_eq_u32 vcc, 1, v3
    s_nop 1
    v_cndmask_b32 v21, 0, v4, vcc
    v_cmp_eq_u32 vcc, 2, v3
    s_nop 1
    v_cndmask_b32 v22, 0, v4, vcc
    v_cmp_eq_u32 vcc, 3, v3
    s_nop 1
    v_cndmask_b32 v23, 0, v4, vcc
    v_mov_b32 v3, 0x0c0c0c0c
    s_mov_b32 s24, 0x01000100
    s_mov_b32 s25, 0x03020302
    v_bfi_b32 v24, v20, s24, v3
    v_bfi_b32 v28, v20, s25, v3
    v_bfi_b32 v25, v21, s24, v3
    v_bfi_b32 v29, v21, s25, v3
    v_bfi_b32 v26, v22, s24, v3
    v_bfi_b32 v30, v22, s25, v3
    v_bfi_b32 v27, v23, s24, v3
    v_bfi_b32 v31, v23, s25, v3
    s_mov_b32 s64, 0x22222222
    s_mov_b32 s65, 0x22222222
    s_mov_b32 s66, 0x44444444
    s_mov_b32 s67, 0x44444444
    s_mov_b32 s68, 0x88888888
    s_mov_b32 s69, 0x88888888
    s_lshl_b32 s24, s3, 8
    s_add_u32 s24, s24, 145408
    v_add_u32 v3, s24, v67
    v_add_u32 v4, s24, v19
    s_waitcnt vmcnt(12)
    ds_write_b128 v3, v[12:15]
    s_waitcnt lgkmcnt(0)
    ds_read_b128 v[32:35], v4 offset:0
    ds_read_b128 v[36:39], v4 offset:16
    ds_read_b128 v[40:43], v4 offset:32
    ds_read_b128 v[44:47], v4 offset:48
    ds_read_b128 v[48:51], v4 offset:2048
    ds_read_b128 v[52:55], v4 offset:2064
    ds_read_b128 v[56:59], v4 offset:2080
    ds_read_b128 v[60:63], v4 offset:2096
    s_waitcnt lgkmcnt(0)
    v_mov_b32 v76, -1
    v_mov_b32 v77, -1
    v_mov_b32 v78, -1
    v_mov_b32 v79, -1
    s_lshl_b32 s71, s72, 2
    s_add_u32 s71, s71, s3
    s_lshl_b32 s71, s71, 12
    s_add_u32 s71, s71, 0x1c0000
    s_cmp_lt_u32 s74, 32
    s_cselect_b32 s71, 0x600000, s71
    v_perm_b32 v8, v32, v32, v24
    v_perm_b32 v9, v32, v32, v25
    v_perm_b32 v10, v32, v32, v26
    v_perm_b32 v11, v32, v32, v27
    v_perm_b32 v4, v48, v48, v24
    v_perm_b32 v5, v48, v48, v25
    v_perm_b32 v6, v48, v48, v26
    v_perm_b32 v7, v48, v48, v27
    s_waitcnt vmcnt(11)
    v_mfma_f32_16x16x32_bf16 v[12:15], v[128:131], v[8:11], 0
    v_mfma_f32_16x16x32_bf16 v[68:71], v[128:131], v[4:7], 0
    buffer_load_dwordx4 v[176:179], v18, s[4:7], s32 offen nt
    s_add_u32 s32, s32, 8192
    v_perm_b32 v8, v32, v32, v28
    v_perm_b32 v9, v32, v32, v29
    v_perm_b32 v10, v32, v32, v30
    v_perm_b32 v11, v32, v32, v31
    v_perm_b32 v4, v48, v48, v28
    v_perm_b32 v5, v48, v48, v29
    v_perm_b32 v6, v48, v48, v30
    v_perm_b32 v7, v48, v48, v31
    s_waitcnt vmcnt(11)
    v_mfma_f32_16x16x32_bf16 v[12:15], v[132:135], v[8:11], v[12:15]
    v_mfma_f32_16x16x32_bf16 v[68:71], v[132:135], v[4:7], v[68:71]
    buffer_load_dwordx4 v[180:183], v18, s[4:7], s32 offen nt
    s_add_u32 s32, s32, 8192
    v_perm_b32 v8, v33, v33, v24
    v_perm_b32 v9, v33, v33, v25
    v_perm_b32 v10, v33, v33, v26
    v_perm_b32 v11, v33, v33, v27
    v_perm_b32 v4, v49, v49, v24
    v_perm_b32 v5, v49, v49, v25
    v_perm_b32 v6, v49, v49, v26
    v_perm_b32 v7, v49, v49, v27
    s_waitcnt vmcnt(11)
    v_mfma_f32_16x16x32_bf16 v[12:15], v[136:139], v[8:11], v[12:15]
    v_mfma_f32_16x16x32_bf16 v[68:71], v[136:139], v[4:7], v[68:71]
    buffer_load_dwordx4 v[184:187], v18, s[4:7], s32 offen nt
    s_add_u32 s32, s32, 8192
    v_perm_b32 v8, v33, v33, v28
    v_perm_b32 v9, v33, v33, v29
    v_perm_b32 v10, v33, v33, v30
    v_perm_b32 v11, v33, v33, v31
    v_perm_b32 v4, v49, v49, v28
    v_perm_b32 v5, v49, v49, v29
    v_perm_b32 v6, v49, v49, v30
    v_perm_b32 v7, v49, v49, v31
    s_waitcnt vmcnt(11)
    v_mfma_f32_16x16x32_bf16 v[12:15], v[140:143], v[8:11], v[12:15]
    v_mfma_f32_16x16x32_bf16 v[68:71], v[140:143], v[4:7], v[68:71]
    buffer_load_dwordx4 v[188:191], v18, s[4:7], s32 offen nt
    s_add_u32 s32, s32, 8192
    v_perm_b32 v8, v34, v34, v24
    v_perm_b32 v9, v34, v34, v25
    v_perm_b32 v10, v34, v34, v26
    v_perm_b32 v11, v34, v34, v27
    v_perm_b32 v4, v50, v50, v24
    v_perm_b32 v5, v50, v50, v25
    v_perm_b32 v6, v50, v50, v26
    v_perm_b32 v7, v50, v50, v27
    s_waitcnt vmcnt(11)
    v_mfma_f32_16x16x32_bf16 v[12:15], v[144:147], v[8:11], v[12:15]
    v_mfma_f32_16x16x32_bf16 v[68:71], v[144:147], v[4:7], v[68:71]
    buffer_load_dwordx4 v[192:195], v18, s[4:7], s32 offen nt
    s_add_u32 s32, s32, 8192
    v_perm_b32 v8, v34, v34, v28
    v_perm_b32 v9, v34, v34, v29
    v_perm_b32 v10, v34, v34, v30
    v_perm_b32 v11, v34, v34, v31
    v_perm_b32 v4, v50, v50, v28
    v_perm_b32 v5, v50, v50, v29
    v_perm_b32 v6, v50, v50, v30
    v_perm_b32 v7, v50, v50, v31
    s_waitcnt vmcnt(11)
    v_mfma_f32_16x16x32_bf16 v[12:15], v[148:151], v[8:11], v[12:15]
    v_mfma_f32_16x16x32_bf16 v[68:71], v[148:151], v[4:7], v[68:71]
    buffer_load_dwordx4 v[196:199], v18, s[4:7], s32 offen nt
    s_add_u32 s32, s32, 8192
    v_perm_b32 v8, v35, v35, v24
    v_perm_b32 v9, v35, v35, v25
    v_perm_b32 v10, v35, v35, v26
    v_perm_b32 v11, v35, v35, v27
    v_perm_b32 v4, v51, v51, v24
    v_perm_b32 v5, v51, v51, v25
    v_perm_b32 v6, v51, v51, v26
    v_perm_b32 v7, v51, v51, v27
    s_waitcnt vmcnt(11)
    v_mfma_f32_16x16x32_bf16 v[12:15], v[152:155], v[8:11], v[12:15]
    v_mfma_f32_16x16x32_bf16 v[68:71], v[152:155], v[4:7], v[68:71]
    buffer_load_dwordx4 v[200:203], v18, s[4:7], s32 offen nt
    s_add_u32 s32, s32, 8192
    v_perm_b32 v8, v35, v35, v28
    v_perm_b32 v9, v35, v35, v29
    v_perm_b32 v10, v35, v35, v30
    v_perm_b32 v11, v35, v35, v31
    v_perm_b32 v4, v51, v51, v28
    v_perm_b32 v5, v51, v51, v29
    v_perm_b32 v6, v51, v51, v30
    v_perm_b32 v7, v51, v51, v31
    s_waitcnt vmcnt(11)
    v_mfma_f32_16x16x32_bf16 v[12:15], v[156:159], v[8:11], v[12:15]
    v_mfma_f32_16x16x32_bf16 v[68:71], v[156:159], v[4:7], v[68:71]
    buffer_load_dwordx4 v[204:207], v18, s[4:7], s32 offen nt
    s_add_u32 s32, s32, 8192
    v_perm_b32 v8, v36, v36, v24
    v_perm_b32 v9, v36, v36, v25
    v_perm_b32 v10, v36, v36, v26
    v_perm_b32 v11, v36, v36, v27
    v_perm_b32 v4, v52, v52, v24
    v_perm_b32 v5, v52, v52, v25
    v_perm_b32 v6, v52, v52, v26
    v_perm_b32 v7, v52, v52, v27
    s_waitcnt vmcnt(11)
    v_mfma_f32_16x16x32_bf16 v[12:15], v[160:163], v[8:11], v[12:15]
    v_mfma_f32_16x16x32_bf16 v[68:71], v[160:163], v[4:7], v[68:71]
    buffer_load_dwordx4 v[208:211], v18, s[4:7], s32 offen nt
    s_add_u32 s32, s32, 8192
    v_perm_b32 v8, v36, v36, v28
    v_perm_b32 v9, v36, v36, v29
    v_perm_b32 v10, v36, v36, v30
    v_perm_b32 v11, v36, v36, v31
    v_perm_b32 v4, v52, v52, v28
    v_perm_b32 v5, v52, v52, v29
    v_perm_b32 v6, v52, v52, v30
    v_perm_b32 v7, v52, v52, v31
    s_waitcnt vmcnt(11)
    v_mfma_f32_16x16x32_bf16 v[12:15], v[164:167], v[8:11], v[12:15]
    v_mfma_f32_16x16x32_bf16 v[68:71], v[164:167], v[4:7], v[68:71]
    buffer_load_dwordx4 v[212:215], v18, s[4:7], s32 offen nt
    s_add_u32 s32, s32, 8192
    v_perm_b32 v8, v37, v37, v24
    v_perm_b32 v9, v37, v37, v25
    v_perm_b32 v10, v37, v37, v26
    v_perm_b32 v11, v37, v37, v27
    v_perm_b32 v4, v53, v53, v24
    v_perm_b32 v5, v53, v53, v25
    v_perm_b32 v6, v53, v53, v26
    v_perm_b32 v7, v53, v53, v27
    s_waitcnt vmcnt(11)
    v_mfma_f32_16x16x32_bf16 v[12:15], v[168:171], v[8:11], v[12:15]
    v_mfma_f32_16x16x32_bf16 v[68:71], v[168:171], v[4:7], v[68:71]
    buffer_load_dwordx4 v[216:219], v18, s[4:7], s32 offen nt
    s_add_u32 s32, s32, 8192
    v_perm_b32 v8, v37, v37, v28
    v_perm_b32 v9, v37, v37, v29
    v_perm_b32 v10, v37, v37, v30
    v_perm_b32 v11, v37, v37, v31
    v_perm_b32 v4, v53, v53, v28
    v_perm_b32 v5, v53, v53, v29
    v_perm_b32 v6, v53, v53, v30
    v_perm_b32 v7, v53, v53, v31
    s_waitcnt vmcnt(11)
    v_mfma_f32_16x16x32_bf16 v[12:15], v[172:175], v[8:11], v[12:15]
    v_mfma_f32_16x16x32_bf16 v[68:71], v[172:175], v[4:7], v[68:71]
    buffer_load_dwordx4 v[220:223], v18, s[4:7], s32 offen nt
    s_add_u32 s32, s32, 8192
    v_perm_b32 v8, v38, v38, v24
    v_perm_b32 v9, v38, v38, v25
    v_perm_b32 v10, v38, v38, v26
    v_perm_b32 v11, v38, v38, v27
    v_perm_b32 v4, v54, v54, v24
    v_perm_b32 v5, v54, v54, v25
    v_perm_b32 v6, v54, v54, v26
    v_perm_b32 v7, v54, v54, v27
    s_waitcnt vmcnt(11)
    v_mfma_f32_16x16x32_bf16 v[12:15], v[176:179], v[8:11], v[12:15]
    v_mfma_f32_16x16x32_bf16 v[68:71], v[176:179], v[4:7], v[68:71]
    buffer_load_dwordx4 v[224:227], v18, s[4:7], s32 offen nt
    s_add_u32 s32, s32, 8192
    v_perm_b32 v8, v38, v38, v28
    v_perm_b32 v9, v38, v38, v29
    v_perm_b32 v10, v38, v38, v30
    v_perm_b32 v11, v38, v38, v31
    v_perm_b32 v4, v54, v54, v28
    v_perm_b32 v5, v54, v54, v29
    v_perm_b32 v6, v54, v54, v30
    v_perm_b32 v7, v54, v54, v31
    s_waitcnt vmcnt(11)
    v_mfma_f32_16x16x32_bf16 v[12:15], v[180:183], v[8:11], v[12:15]
    v_mfma_f32_16x16x32_bf16 v[68:71], v[180:183], v[4:7], v[68:71]
    buffer_load_dwordx4 v[228:231], v18, s[4:7], s32 offen nt
    s_add_u32 s32, s32, 8192
    v_perm_b32 v8, v39, v39, v24
    v_perm_b32 v9, v39, v39, v25
    v_perm_b32 v10, v39, v39, v26
    v_perm_b32 v11, v39, v39, v27
    v_perm_b32 v4, v55, v55, v24
    v_perm_b32 v5, v55, v55, v25
    v_perm_b32 v6, v55, v55, v26
    v_perm_b32 v7, v55, v55, v27
    s_waitcnt vmcnt(11)
    v_mfma_f32_16x16x32_bf16 v[12:15], v[184:187], v[8:11], v[12:15]
    v_mfma_f32_16x16x32_bf16 v[68:71], v[184:187], v[4:7], v[68:71]
    buffer_load_dwordx4 v[232:235], v18, s[4:7], s32 offen nt
    s_add_u32 s32, s32, 8192
    v_perm_b32 v8, v39, v39, v28
    v_perm_b32 v9, v39, v39, v29
    v_perm_b32 v10, v39, v39, v30
    v_perm_b32 v11, v39, v39, v31
    v_perm_b32 v4, v55, v55, v28
    v_perm_b32 v5, v55, v55, v29
    v_perm_b32 v6, v55, v55, v30
    v_perm_b32 v7, v55, v55, v31
    s_waitcnt vmcnt(11)
    v_mfma_f32_16x16x32_bf16 v[12:15], v[188:191], v[8:11], v[12:15]
    v_mfma_f32_16x16x32_bf16 v[68:71], v[188:191], v[4:7], v[68:71]
    buffer_load_dwordx4 v[236:239], v18, s[4:7], s32 offen nt
    s_add_u32 s32, s32, 8192
    v_perm_b32 v8, v40, v40, v24
    v_perm_b32 v9, v40, v40, v25
    v_perm_b32 v10, v40, v40, v26
    v_perm_b32 v11, v40, v40, v27
    v_perm_b32 v4, v56, v56, v24
    v_perm_b32 v5, v56, v56, v25
    v_perm_b32 v6, v56, v56, v26
    v_perm_b32 v7, v56, v56, v27
    s_waitcnt vmcnt(11)
    v_mfma_f32_16x16x32_bf16 v[12:15], v[192:195], v[8:11], v[12:15]
    v_mfma_f32_16x16x32_bf16 v[68:71], v[192:195], v[4:7], v[68:71]
    buffer_load_dwordx4 v[240:243], v18, s[4:7], s32 offen nt
    s_add_u32 s32, s32, 8192
    v_perm_b32 v8, v40, v40, v28
    v_perm_b32 v9, v40, v40, v29
    v_perm_b32 v10, v40, v40, v30
    v_perm_b32 v11, v40, v40, v31
    v_perm_b32 v4, v56, v56, v28
    v_perm_b32 v5, v56, v56, v29
    v_perm_b32 v6, v56, v56, v30
    v_perm_b32 v7, v56, v56, v31
    s_waitcnt vmcnt(11)
    v_mfma_f32_16x16x32_bf16 v[12:15], v[196:199], v[8:11], v[12:15]
    v_mfma_f32_16x16x32_bf16 v[68:71], v[196:199], v[4:7], v[68:71]
    buffer_load_dwordx4 v[244:247], v18, s[4:7], s32 offen nt
    s_add_u32 s32, s32, 8192
    v_perm_b32 v8, v41, v41, v24
    v_perm_b32 v9, v41, v41, v25
    v_perm_b32 v10, v41, v41, v26
    v_perm_b32 v11, v41, v41, v27
    v_perm_b32 v4, v57, v57, v24
    v_perm_b32 v5, v57, v57, v25
    v_perm_b32 v6, v57, v57, v26
    v_perm_b32 v7, v57, v57, v27
    s_waitcnt vmcnt(11)
    v_mfma_f32_16x16x32_bf16 v[12:15], v[200:203], v[8:11], v[12:15]
    v_mfma_f32_16x16x32_bf16 v[68:71], v[200:203], v[4:7], v[68:71]
    buffer_load_dwordx4 v[248:251], v18, s[4:7], s32 offen nt
    s_add_u32 s32, s32, 8192
    v_perm_b32 v8, v41, v41, v28
    v_perm_b32 v9, v41, v41, v29
    v_perm_b32 v10, v41, v41, v30
    v_perm_b32 v11, v41, v41, v31
    v_perm_b32 v4, v57, v57, v28
    v_perm_b32 v5, v57, v57, v29
    v_perm_b32 v6, v57, v57, v30
    v_perm_b32 v7, v57, v57, v31
    s_waitcnt vmcnt(11)
    v_mfma_f32_16x16x32_bf16 v[12:15], v[204:207], v[8:11], v[12:15]
    v_mfma_f32_16x16x32_bf16 v[68:71], v[204:207], v[4:7], v[68:71]
    buffer_load_dwordx4 v[252:255], v18, s[4:7], s32 offen nt
    s_add_u32 s32, s32, 8192
    v_perm_b32 v8, v42, v42, v24
    v_perm_b32 v9, v42, v42, v25
    v_perm_b32 v10, v42, v42, v26
    v_perm_b32 v11, v42, v42, v27
    v_perm_b32 v4, v58, v58, v24
    v_perm_b32 v5, v58, v58, v25
    v_perm_b32 v6, v58, v58, v26
    v_perm_b32 v7, v58, v58, v27
    s_waitcnt vmcnt(11)
    v_mfma_f32_16x16x32_bf16 v[12:15], v[208:211], v[8:11], v[12:15]
    v_mfma_f32_16x16x32_bf16 v[68:71], v[208:211], v[4:7], v[68:71]
    s_lshl_b32 s73, s74, 7
    s_add_u32 s73, s73, 0x170000
    s_cmp_lg_u32 s3, 0
    s_cbranch_scc1 L_A_nofl
    s_mov_b64 exec, 1
    buffer_store_dwordx4 v[76:79], off, s[12:15], s73 sc1
    s_mov_b64 exec, -1
L_A_nofl:
    s_cmp_ge_u32 s71, 0x1fe000
    s_cselect_b32 s71, 0x600000, s71
    buffer_store_dwordx4 v[76:79], v2, s[12:15], s71 offen sc1
    s_add_u32 s71, s71, 0x20000
    s_getpc_b64 s[24:25]
L_pc9:
    s_add_u32 s24, s24, L_A2-L_pc9
    s_addc_u32 s25, s25, 0
    v_lshl_add_u32 v16, v0, 2, s3
    v_lshlrev_b32 v16, 7, v16
    v_min_u32 v16, L_last-L_A2-4, v16
    v_mov_b32 v17, s25
    v_add_co_u32 v16, vcc, s24, v16
    s_nop 1
    v_addc_co_u32 v17, vcc, 0, v17, vcc
    global_load_dword v17, v[16:17], off
    s_mov_b32 s4, s42
    s_mov_b32 s5, s43
    s_mov_b32 s6, s75
    s_mov_b32 s32, s35
    buffer_load_dwordx4 v[128:131], v64, s[4:7], s32 offen nt
    s_add_u32 s32, s32, 8192
    v_perm_b32 v8, v42, v42, v28
    v_perm_b32 v9, v42, v42, v29
    v_perm_b32 v10, v42, v42, v30
    v_perm_b32 v11, v42, v42, v31
    v_perm_b32 v4, v58, v58, v28
    v_perm_b32 v5, v58, v58, v29
    v_perm_b32 v6, v58, v58, v30
    v_perm_b32 v7, v58, v58, v31
    s_waitcnt vmcnt(13)
    v_mfma_f32_16x16x32_bf16 v[12:15], v[212:215], v[8:11], v[12:15]
    v_mfma_f32_16x16x32_bf16 v[68:71], v[212:215], v[4:7], v[68:71]
    buffer_load_dwordx4 v[132:135], v64, s[4:7], s32 offen nt
    s_add_u32 s32, s32, 8192
    v_perm_b32 v8, v43, v43, v24
    v_perm_b32 v9, v43, v43, v25
    v_perm_b32 v10, v43, v43, v26
    v_perm_b32 v11, v43, v43, v27
    v_perm_b32 v4, v59, v59, v24
    v_perm_b32 v5, v59, v59, v25
    v_perm_b32 v6, v59, v59, v26
    v_perm_b32 v7, v59, v59, v27
    s_waitcnt vmcnt(13)
    v_mfma_f32_16x16x32_bf16 v[12:15], v[216:219], v[8:11], v[12:15]
    v_mfma_f32_16x16x32_bf16 v[68:71], v[216:219], v[4:7], v[68:71]
    buffer_load_dwordx4 v[136:139], v64, s[4:7], s32 offen nt
    s_add_u32 s32, s32, 8192
    v_perm_b32 v8, v43, v43, v28
    v_perm_b32 v9, v43, v43, v29
    v_perm_b32 v10, v43, v43, v30
    v_perm_b32 v11, v43, v43, v31
    v_perm_b32 v4, v59, v59, v28
    v_perm_b32 v5, v59, v59, v29
    v_perm_b32 v6, v59, v59, v30
    v_perm_b32 v7, v59, v59, v31
    s_waitcnt vmcnt(13)
    v_mfma_f32_16x16x32_bf16 v[12:15], v[220:223], v[8:11], v[12:15]
    v_mfma_f32_16x16x32_bf16 v[68:71], v[220:223], v[4:7], v[68:71]
    buffer_load_dwordx4 v[140:143], v64, s[4:7], s32 offen nt
    s_add_u32 s32, s32, 8192
    v_perm_b32 v8, v44, v44, v24
    v_perm_b32 v9, v44, v44, v25
    v_perm_b32 v10, v44, v44, v26
    v_perm_b32 v11, v44, v44, v27
    v_perm_b32 v4, v60, v60, v24
    v_perm_b32 v5, v60, v60, v25
    v_perm_b32 v6, v60, v60, v26
    v_perm_b32 v7, v60, v60, v27
    s_waitcnt vmcnt(13)
    v_mfma_f32_16x16x32_bf16 v[12:15], v[224:227], v[8:11], v[12:15]
    v_mfma_f32_16x16x32_bf16 v[68:71], v[224:227], v[4:7], v[68:71]
    buffer_load_dwordx4 v[144:147], v64, s[4:7], s32 offen nt
    s_add_u32 s32, s32, 8192
    v_perm_b32 v8, v44, v44, v28
    v_perm_b32 v9, v44, v44, v29
    v_perm_b32 v10, v44, v44, v30
    v_perm_b32 v11, v44, v44, v31
    v_perm_b32 v4, v60, v60, v28
    v_perm_b32 v5, v60, v60, v29
    v_perm_b32 v6, v60, v60, v30
    v_perm_b32 v7, v60, v60, v31
    s_waitcnt vmcnt(13)
    v_mfma_f32_16x16x32_bf16 v[12:15], v[228:231], v[8:11], v[12:15]
    v_mfma_f32_16x16x32_bf16 v[68:71], v[228:231], v[4:7], v[68:71]
    buffer_load_dwordx4 v[148:151], v64, s[4:7], s32 offen nt
    s_add_u32 s32, s32, 8192
    v_perm_b32 v8, v45, v45, v24
    v_perm_b32 v9, v45, v45, v25
    v_perm_b32 v10, v45, v45, v26
    v_perm_b32 v11, v45, v45, v27
    v_perm_b32 v4, v61, v61, v24
    v_perm_b32 v5, v61, v61, v25
    v_perm_b32 v6, v61, v61, v26
    v_perm_b32 v7, v61, v61, v27
    s_waitcnt vmcnt(13)
    v_mfma_f32_16x16x32_bf16 v[12:15], v[232:235], v[8:11], v[12:15]
    v_mfma_f32_16x16x32_bf16 v[68:71], v[232:235], v[4:7], v[68:71]
    buffer_load_dwordx4 v[152:155], v64, s[4:7], s32 offen nt
    s_add_u32 s32, s32, 8192
    v_perm_b32 v8, v45, v45, v28
    v_perm_b32 v9, v45, v45, v29
    v_perm_b32 v10, v45, v45, v30
    v_perm_b32 v11, v45, v45, v31
    v_perm_b32 v4, v61, v61, v28
    v_perm_b32 v5, v61, v61, v29
    v_perm_b32 v6, v61, v61, v30
    v_perm_b32 v7, v61, v61, v31
    s_waitcnt vmcnt(13)
    v_mfma_f32_16x16x32_bf16 v[12:15], v[236:239], v[8:11], v[12:15]
    v_mfma_f32_16x16x32_bf16 v[68:71], v[236:239], v[4:7], v[68:71]
    buffer_load_dwordx4 v[156:159], v64, s[4:7], s32 offen nt
    s_add_u32 s32, s32, 8192
    v_perm_b32 v8, v46, v46, v24
    v_perm_b32 v9, v46, v46, v25
    v_perm_b32 v10, v46, v46, v26
    v_perm_b32 v11, v46, v46, v27
    v_perm_b32 v4, v62, v62, v24
    v_perm_b32 v5, v62, v62, v25
    v_perm_b32 v6, v62, v62, v26
    v_perm_b32 v7, v62, v62, v27
    s_waitcnt vmcnt(13)
    v_mfma_f32_16x16x32_bf16 v[12:15], v[240:243], v[8:11], v[12:15]
    v_mfma_f32_16x16x32_bf16 v[68:71], v[240:243], v[4:7], v[68:71]
    buffer_load_dwordx4 v[160:163], v64, s[4:7], s32 offen nt
    s_add_u32 s32, s32, 8192
    v_perm_b32 v8, v46, v46, v28
    v_perm_b32 v9, v46, v46, v29
    v_perm_b32 v10, v46, v46, v30
    v_perm_b32 v11, v46, v46, v31
    v_perm_b32 v4, v62, v62, v28
    v_perm_b32 v5, v62, v62, v29
    v_perm_b32 v6, v62, v62, v30
    v_perm_b32 v7, v62, v62, v31
    s_waitcnt vmcnt(13)
    v_mfma_f32_16x16x32_bf16 v[12:15], v[244:247], v[8:11], v[12:15]
    v_mfma_f32_16x16x32_bf16 v[68:71], v[244:247], v[4:7], v[68:71]
    buffer_load_dwordx4 v[164:167], v64, s[4:7], s32 offen nt
    s_add_u32 s32, s32, 8192
    v_perm_b32 v8, v47, v47, v24
    v_perm_b32 v9, v47, v47, v25
    v_perm_b32 v10, v47, v47, v26
    v_perm_b32 v11, v47, v47, v27
    v_perm_b32 v4, v63, v63, v24
    v_perm_b32 v5, v63, v63, v25
    v_perm_b32 v6, v63, v63, v26
    v_perm_b32 v7, v63, v63, v27
    s_waitcnt vmcnt(13)
    v_mfma_f32_16x16x32_bf16 v[12:15], v[248:251], v[8:11], v[12:15]
    v_mfma_f32_16x16x32_bf16 v[68:71], v[248:251], v[4:7], v[68:71]
    buffer_load_dwordx4 v[168:171], v64, s[4:7], s32 offen nt
    s_add_u32 s32, s32, 8192
    v_perm_b32 v8, v47, v47, v28
    v_perm_b32 v9, v47, v47, v29
    v_perm_b32 v10, v47, v47, v30
    v_perm_b32 v11, v47, v47, v31
    v_perm_b32 v4, v63, v63, v28
    v_perm_b32 v5, v63, v63, v29
    v_perm_b32 v6, v63, v63, v30
    v_perm_b32 v7, v63, v63, v31
    s_waitcnt vmcnt(13)
    v_mfma_f32_16x16x32_bf16 v[12:15], v[252:255], v[8:11], v[12:15]
    v_mfma_f32_16x16x32_bf16 v[68:71], v[252:255], v[4:7], v[68:71]
    buffer_load_dwordx4 v[172:175], v64, s[4:7], s32 offen nt
    s_add_u32 s32, s32, 8192
    v_lshrrev_b32 v3, 4, v0
    v_lshlrev_b32 v3, 7, v3
    v_and_b32 v4, 7, v0
    v_lshl_add_u32 v3, v4, 2, v3
    v_bfe_u32 v4, v0, 3, 1
    v_lshl_add_u32 v3, v4, 9, v3
    s_lshl_b32 s24, s3, 11
    s_add_u32 s24, s24, 135168
    v_add_u32 v3, s24, v3
    ds_write_b32 v3, v12 offset:0
    ds_write_b32 v3, v13 offset:32
    ds_write_b32 v3, v14 offset:64
    ds_write_b32 v3, v15 offset:96
    ds_write_b32 v3, v68 offset:1024
    ds_write_b32 v3, v69 offset:1056
    ds_write_b32 v3, v70 offset:1088
    ds_write_b32 v3, v71 offset:1120
    s_waitcnt lgkmcnt(0)
    s_barrier
    ds_read_b128 v[72:75], v65 offset:0
    ds_read_b128 v[76:79], v65 offset:16
    ds_read_b128 v[80:83], v65 offset:2048
    ds_read_b128 v[84:87], v65 offset:2064
    ds_read_b128 v[88:91], v65 offset:4096
    ds_read_b128 v[92:95], v65 offset:4112
    ds_read_b128 v[96:99], v65 offset:6144
    ds_read_b128 v[100:103], v65 offset:6160
    s_waitcnt lgkmcnt(4)
    v_add_f32 v72, v72, v80
    v_add_f32 v73, v73, v81
    v_add_f32 v74, v74, v82
    v_add_f32 v75, v75, v83
    v_add_f32 v76, v76, v84
    v_add_f32 v77, v77, v85
    v_add_f32 v78, v78, v86
    v_add_f32 v79, v79, v87
    s_waitcnt lgkmcnt(2)
    v_add_f32 v72, v72, v88
    v_add_f32 v73, v73, v89
    v_add_f32 v74, v74, v90
    v_add_f32 v75, v75, v91
    v_add_f32 v76, v76, v92
    v_add_f32 v77, v77, v93
    v_add_f32 v78, v78, v94
    v_add_f32 v79, v79, v95
    s_waitcnt lgkmcnt(0)
    v_add_f32 v72, v72, v96
    v_add_f32 v73, v73, v97
    v_add_f32 v74, v74, v98
    v_add_f32 v75, v75, v99
    v_add_f32 v76, v76, v100
    v_add_f32 v77, v77, v101
    v_add_f32 v78, v78, v102
    v_add_f32 v79, v79, v103
    v_cvt_pk_bf16_f32 v8, v72, v73
    v_cvt_pk_bf16_f32 v9, v74, v75
    v_cvt_pk_bf16_f32 v10, v76, v77
    v_cvt_pk_bf16_f32 v11, v78, v79
    s_cmp_ge_u32 s74, 32
    s_cbranch_scc1 L_C
L_A2:
    buffer_load_dwordx4 v[176:179], v64, s[4:7], s32 offen nt
    s_add_u32 s32, s32, 8192
    buffer_load_dwordx4 v[180:183], v64, s[4:7], s32 offen nt
    s_add_u32 s32, s32, 8192
    buffer_load_dwordx4 v[184:187], v64, s[4:7], s32 offen nt
    s_add_u32 s32, s32, 8192
    buffer_load_dwordx4 v[188:191], v64, s[4:7], s32 offen nt
    s_add_u32 s32, s32, 8192
    buffer_load_dwordx4 v[192:195], v64, s[4:7], s32 offen nt
    s_add_u32 s32, s32, 8192
    buffer_load_dwordx4 v[196:199], v64, s[4:7], s32 offen nt
    s_add_u32 s32, s32, 8192
    buffer_load_dwordx4 v[200:203], v64, s[4:7], s32 offen nt
    s_add_u32 s32, s32, 8192
    buffer_load_dwordx4 v[204:207], v64, s[4:7], s32 offen nt
    s_add_u32 s32, s32, 8192
    buffer_load_dwordx4 v[208:211], v64, s[4:7], s32 offen nt
    s_add_u32 s32, s32, 8192
    buffer_load_dwordx4 v[212:215], v64, s[4:7], s32 offen nt
    s_add_u32 s32, s32, 8192
    buffer_load_dwordx4 v[216:219], v64, s[4:7], s32 offen nt
    s_add_u32 s32, s32, 8192
    buffer_load_dwordx4 v[220:223], v64, s[4:7], s32 offen nt
    s_add_u32 s32, s32, 8192
    buffer_load_dwordx4 v[224:227], v64, s[4:7], s32 offen nt
    s_add_u32 s32, s32, 8192
    buffer_load_dwordx4 v[228:231], v64, s[4:7], s32 offen nt
    s_add_u32 s32, s32, 8192
    buffer_load_dwordx4 v[232:235], v64, s[4:7], s32 offen nt
    s_add_u32 s32, s32, 8192
    buffer_load_dwordx4 v[236:239], v64, s[4:7], s32 offen nt
    s_add_u32 s32, s32, 8192
    buffer_load_dwordx4 v[240:243], v64, s[4:7], s32 offen nt
    s_add_u32 s32, s32, 8192
    buffer_load_dwordx4 v[244:247], v64, s[4:7], s32 offen nt
    s_add_u32 s32, s32, 8192
    buffer_load_dwordx4 v[248:251], v64, s[4:7], s32 offen nt
    s_add_u32 s32, s32, 8192
    buffer_load_dwordx4 v[252:255], v64, s[4:7], s32 offen nt
    s_add_u32 s32, s32, 8192
    s_waitcnt vmcnt(31)
    v_mfma_f32_16x16x32_bf16 v[80:83], v[128:131], v[8:11], 0
    s_waitcnt vmcnt(30)
    v_mfma_f32_16x16x32_bf16 v[84:87], v[132:135], v[8:11], 0
    s_waitcnt vmcnt(29)
    v_mfma_f32_16x16x32_bf16 v[88:91], v[136:139], v[8:11], 0
    s_waitcnt vmcnt(28)
    v_mfma_f32_16x16x32_bf16 v[92:95], v[140:143], v[8:11], 0
    s_waitcnt vmcnt(27)
    v_mfma_f32_16x16x32_bf16 v[96:99], v[144:147], v[8:11], 0
    s_waitcnt vmcnt(26)
    v_mfma_f32_16x16x32_bf16 v[100:103], v[148:151], v[8:11], 0
    s_waitcnt vmcnt(25)
    v_mfma_f32_16x16x32_bf16 v[104:107], v[152:155], v[8:11], 0
    s_waitcnt vmcnt(24)
    v_mfma_f32_16x16x32_bf16 v[108:111], v[156:159], v[8:11], 0
    v_add_f32_dpp v72, v81, v80 quad_perm:[1,1,1,1] row_mask:0xf bank_mask:0xf
    v_add_f32_dpp v73, v85, v84 quad_perm:[1,1,1,1] row_mask:0xf bank_mask:0xf
    v_add_f32_dpp v74, v89, v88 quad_perm:[1,1,1,1] row_mask:0xf bank_mask:0xf
    v_add_f32_dpp v75, v93, v92 quad_perm:[1,1,1,1] row_mask:0xf bank_mask:0xf
    v_add_f32_dpp v76, v97, v96 quad_perm:[1,1,1,1] row_mask:0xf bank_mask:0xf
    v_add_f32_dpp v77, v101, v100 quad_perm:[1,1,1,1] row_mask:0xf bank_mask:0xf
    v_add_f32_dpp v78, v105, v104 quad_perm:[1,1,1,1] row_mask:0xf bank_mask:0xf
    s_nop 0
    v_add_f32_dpp v79, v109, v108 quad_perm:[1,1,1,1] row_mask:0xf bank_mask:0xf
    v_add_f32_dpp v72, v82, v72 quad_perm:[2,2,2,2] row_mask:0xf bank_mask:0xf
    v_add_f32_dpp v73, v86, v73 quad_perm:[2,2,2,2] row_mask:0xf bank_mask:0xf
    v_add_f32_dpp v74, v90, v74 quad_perm:[2,2,2,2] row_mask:0xf bank_mask:0xf
    v_add_f32_dpp v75, v94, v75 quad_perm:[2,2,2,2] row_mask:0xf bank_mask:0xf
    v_add_f32_dpp v76, v98, v76 quad_perm:[2,2,2,2] row_mask:0xf bank_mask:0xf
    v_add_f32_dpp v77, v102, v77 quad_perm:[2,2,2,2] row_mask:0xf bank_mask:0xf
    v_add_f32_dpp v78, v106, v78 quad_perm:[2,2,2,2] row_mask:0xf bank_mask:0xf
    v_add_f32_dpp v79, v110, v79 quad_perm:[2,2,2,2] row_mask:0xf bank_mask:0xf
    v_add_f32_dpp v72, v83, v72 quad_perm:[3,3,3,3] row_mask:0xf bank_mask:0xf
    v_add_f32_dpp v73, v87, v73 quad_perm:[3,3,3,3] row_mask:0xf bank_mask:0xf
    v_add_f32_dpp v74, v91, v74 quad_perm:[3,3,3,3] row_mask:0xf bank_mask:0xf
    v_add_f32_dpp v75, v95, v75 quad_perm:[3,3,3,3] row_mask:0xf bank_mask:0xf
    v_add_f32_dpp v76, v99, v76 quad_perm:[3,3,3,3] row_mask:0xf bank_mask:0xf
    v_add_f32_dpp v77, v103, v77 quad_perm:[3,3,3,3] row_mask:0xf bank_mask:0xf
    v_add_f32_dpp v78, v107, v78 quad_perm:[3,3,3,3] row_mask:0xf bank_mask:0xf
    v_add_f32_dpp v79, v111, v79 quad_perm:[3,3,3,3] row_mask:0xf bank_mask:0xf
    s_waitcnt vmcnt(23)
    v_mfma_f32_16x16x32_bf16 v[80:83], v[160:163], v[8:11], 0
    s_waitcnt vmcnt(22)
    v_mfma_f32_16x16x32_bf16 v[84:87], v[164:167], v[8:11], 0
    s_waitcnt vmcnt(21)
    v_mfma_f32_16x16x32_bf16 v[88:91], v[168:171], v[8:11], 0
    s_waitcnt vmcnt(20)
    v_mfma_f32_16x16x32_bf16 v[92:95], v[172:175], v[8:11], 0
    s_waitcnt vmcnt(19)
    v_mfma_f32_16x16x32_bf16 v[96:99], v[176:179], v[8:11], 0
    s_waitcnt vmcnt(18)
    v_mfma_f32_16x16x32_bf16 v[100:103], v[180:183], v[8:11], 0
    s_waitcnt vmcnt(17)
    v_mfma_f32_16x16x32_bf16 v[104:107], v[184:187], v[8:11], 0
    s_waitcnt vmcnt(16)
    v_mfma_f32_16x16x32_bf16 v[108:111], v[188:191], v[8:11], 0
    v_add_f32_dpp v112, v80, v81 quad_perm:[0,0,0,0] row_mask:0xf bank_mask:0xf
    v_add_f32_dpp v113, v84, v85 quad_perm:[0,0,0,0] row_mask:0xf bank_mask:0xf
    v_add_f32_dpp v114, v88, v89 quad_perm:[0,0,0,0] row_mask:0xf bank_mask:0xf
    v_add_f32_dpp v115, v92, v93 quad_perm:[0,0,0,0] row_mask:0xf bank_mask:0xf
    v_add_f32_dpp v116, v96, v97 quad_perm:[0,0,0,0] row_mask:0xf bank_mask:0xf
    v_add_f32_dpp v117, v100, v101 quad_perm:[0,0,0,0] row_mask:0xf bank_mask:0xf
    v_add_f32_dpp v118, v104, v105 quad_perm:[0,0,0,0] row_mask:0xf bank_mask:0xf
    s_nop 0
    v_add_f32_dpp v119, v108, v109 quad_perm:[0,0,0,0] row_mask:0xf bank_mask:0xf
    v_add_f32_dpp v112, v82, v112 quad_perm:[2,2,2,2] row_mask:0xf bank_mask:0xf
    v_add_f32_dpp v113, v86, v113 quad_perm:[2,2,2,2] row_mask:0xf bank_mask:0xf
    v_add_f32_dpp v114, v90, v114 quad_perm:[2,2,2,2] row_mask:0xf bank_mask:0xf
    v_add_f32_dpp v115, v94, v115 quad_perm:[2,2,2,2] row_mask:0xf bank_mask:0xf
    v_add_f32_dpp v116, v98, v116 quad_perm:[2,2,2,2] row_mask:0xf bank_mask:0xf
    v_add_f32_dpp v117, v102, v117 quad_perm:[2,2,2,2] row_mask:0xf bank_mask:0xf
    v_add_f32_dpp v118, v106, v118 quad_perm:[2,2,2,2] row_mask:0xf bank_mask:0xf
    v_add_f32_dpp v119, v110, v119 quad_perm:[2,2,2,2] row_mask:0xf bank_mask:0xf
    v_add_f32_dpp v112, v83, v112 quad_perm:[3,3,3,3] row_mask:0xf bank_mask:0xf
    v_add_f32_dpp v113, v87, v113 quad_perm:[3,3,3,3] row_mask:0xf bank_mask:0xf
    v_add_f32_dpp v114, v91, v114 quad_perm:[3,3,3,3] row_mask:0xf bank_mask:0xf
    v_add_f32_dpp v115, v95, v115 quad_perm:[3,3,3,3] row_mask:0xf bank_mask:0xf
    v_add_f32_dpp v116, v99, v116 quad_perm:[3,3,3,3] row_mask:0xf bank_mask:0xf
    v_add_f32_dpp v117, v103, v117 quad_perm:[3,3,3,3] row_mask:0xf bank_mask:0xf
    v_add_f32_dpp v118, v107, v118 quad_perm:[3,3,3,3] row_mask:0xf bank_mask:0xf
    v_add_f32_dpp v119, v111, v119 quad_perm:[3,3,3,3] row_mask:0xf bank_mask:0xf
    v_cndmask_b32 v72, v72, v112, s[64:65]
    v_cndmask_b32 v73, v73, v113, s[64:65]
    v_cndmask_b32 v74, v74, v114, s[64:65]
    v_cndmask_b32 v75, v75, v115, s[64:65]
    v_cndmask_b32 v76, v76, v116, s[64:65]
    v_cndmask_b32 v77, v77, v117, s[64:65]
    v_cndmask_b32 v78, v78, v118, s[64:65]
    v_cndmask_b32 v79, v79, v119, s[64:65]
    s_waitcnt vmcnt(15)
    v_mfma_f32_16x16x32_bf16 v[80:83], v[192:195], v[8:11], 0
    s_waitcnt vmcnt(14)
    v_mfma_f32_16x16x32_bf16 v[84:87], v[196:199], v[8:11], 0
    s_waitcnt vmcnt(13)
    v_mfma_f32_16x16x32_bf16 v[88:91], v[200:203], v[8:11], 0
    s_waitcnt vmcnt(12)
    v_mfma_f32_16x16x32_bf16 v[92:95], v[204:207], v[8:11], 0
    s_waitcnt vmcnt(11)
    v_mfma_f32_16x16x32_bf16 v[96:99], v[208:211], v[8:11], 0
    s_waitcnt vmcnt(10)
    v_mfma_f32_16x16x32_bf16 v[100:103], v[212:215], v[8:11], 0
    s_waitcnt vmcnt(9)
    v_mfma_f32_16x16x32_bf16 v[104:107], v[216:219], v[8:11], 0
    s_waitcnt vmcnt(8)
    v_mfma_f32_16x16x32_bf16 v[108:111], v[220:223], v[8:11], 0
    v_add_f32_dpp v112, v80, v82 quad_perm:[0,0,0,0] row_mask:0xf bank_mask:0xf
    v_add_f32_dpp v113, v84, v86 quad_perm:[0,0,0,0] row_mask:0xf bank_mask:0xf
    v_add_f32_dpp v114, v88, v90 quad_perm:[0,0,0,0] row_mask:0xf bank_mask:0xf
    v_add_f32_dpp v115, v92, v94 quad_perm:[0,0,0,0] row_mask:0xf bank_mask:0xf
    v_add_f32_dpp v116, v96, v98 quad_perm:[0,0,0,0] row_mask:0xf bank_mask:0xf
    v_add_f32_dpp v117, v100, v102 quad_perm:[0,0,0,0] row_mask:0xf bank_mask:0xf
    v_add_f32_dpp v118, v104, v106 quad_perm:[0,0,0,0] row_mask:0xf bank_mask:0xf
    s_nop 0
    v_add_f32_dpp v119, v108, v110 quad_perm:[0,0,0,0] row_mask:0xf bank_mask:0xf
    v_add_f32_dpp v112, v81, v112 quad_perm:[1,1,1,1] row_mask:0xf bank_mask:0xf
    v_add_f32_dpp v113, v85, v113 quad_perm:[1,1,1,1] row_mask:0xf bank_mask:0xf
    v_add_f32_dpp v114, v89, v114 quad_perm:[1,1,1,1] row_mask:0xf bank_mask:0xf
    v_add_f32_dpp v115, v93, v115 quad_perm:[1,1,1,1] row_mask:0xf bank_mask:0xf
    v_add_f32_dpp v116, v97, v116 quad_perm:[1,1,1,1] row_mask:0xf bank_mask:0xf
    v_add_f32_dpp v117, v101, v117 quad_perm:[1,1,1,1] row_mask:0xf bank_mask:0xf
    v_add_f32_dpp v118, v105, v118 quad_perm:[1,1,1,1] row_mask:0xf bank_mask:0xf
    v_add_f32_dpp v119, v109, v119 quad_perm:[1,1,1,1] row_mask:0xf bank_mask:0xf
    v_add_f32_dpp v112, v83, v112 quad_perm:[3,3,3,3] row_mask:0xf bank_mask:0xf
    v_add_f32_dpp v113, v87, v113 quad_perm:[3,3,3,3] row_mask:0xf bank_mask:0xf
    v_add_f32_dpp v114, v91, v114 quad_perm:[3,3,3,3] row_mask:0xf bank_mask:0xf
    v_add_f32_dpp v115, v95, v115 quad_perm:[3,3,3,3] row_mask:0xf bank_mask:0xf
    v_add_f32_dpp v116, v99, v116 quad_perm:[3,3,3,3] row_mask:0xf bank_mask:0xf
    v_add_f32_dpp v117, v103, v117 quad_perm:[3,3,3,3] row_mask:0xf bank_mask:0xf
    v_add_f32_dpp v118, v107, v118 quad_perm:[3,3,3,3] row_mask:0xf bank_mask:0xf
    v_add_f32_dpp v119, v111, v119 quad_perm:[3,3,3,3] row_mask:0xf bank_mask:0xf
    v_cndmask_b32 v72, v72, v112, s[66:67]
    v_cndmask_b32 v73, v73, v113, s[66:67]
    v_cndmask_b32 v74, v74, v114, s[66:67]
    v_cndmask_b32 v75, v75, v115, s[66:67]
    v_cndmask_b32 v76, v76, v116, s[66:67]
    v_cndmask_b32 v77, v77, v117, s[66:67]
    v_cndmask_b32 v78, v78, v118, s[66:67]
    v_cndmask_b32 v79, v79, v119, s[66:67]
    s_waitcnt vmcnt(7)
    v_mfma_f32_16x16x32_bf16 v[80:83], v[224:227], v[8:11], 0
    s_waitcnt vmcnt(6)
    v_mfma_f32_16x16x32_bf16 v[84:87], v[228:231], v[8:11], 0
    s_waitcnt vmcnt(5)
    v_mfma_f32_16x16x32_bf16 v[88:91], v[232:235], v[8:11], 0
    s_waitcnt vmcnt(4)
    v_mfma_f32_16x16x32_bf16 v[92:95], v[236:239], v[8:11], 0
    s_waitcnt vmcnt(3)
    v_mfma_f32_16x16x32_bf16 v[96:99], v[240:243], v[8:11], 0
    s_waitcnt vmcnt(2)
    v_mfma_f32_16x16x32_bf16 v[100:103], v[244:247], v[8:11], 0
    s_waitcnt vmcnt(1)
    v_mfma_f32_16x16x32_bf16 v[104:107], v[248:251], v[8:11], 0
    s_waitcnt vmcnt(0)
    v_mfma_f32_16x16x32_bf16 v[108:111], v[252:255], v[8:11], 0
    v_add_f32_dpp v112, v80, v83 quad_perm:[0,0,0,0] row_mask:0xf bank_mask:0xf
    v_add_f32_dpp v113, v84, v87 quad_perm:[0,0,0,0] row_mask:0xf bank_mask:0xf
    v_add_f32_dpp v114, v88, v91 quad_perm:[0,0,0,0] row_mask:0xf bank_mask:0xf
    v_add_f32_dpp v115, v92, v95 quad_perm:[0,0,0,0] row_mask:0xf bank_mask:0xf
    v_add_f32_dpp v116, v96, v99 quad_perm:[0,0,0,0] row_mask:0xf bank_mask:0xf
    v_add_f32_dpp v117, v100, v103 quad_perm:[0,0,0,0] row_mask:0xf bank_mask:0xf
    v_add_f32_dpp v118, v104, v107 quad_perm:[0,0,0,0] row_mask:0xf bank_mask:0xf
    s_nop 0
    v_add_f32_dpp v119, v108, v111 quad_perm:[0,0,0,0] row_mask:0xf bank_mask:0xf
    v_add_f32_dpp v112, v81, v112 quad_perm:[1,1,1,1] row_mask:0xf bank_mask:0xf
    v_add_f32_dpp v113, v85, v113 quad_perm:[1,1,1,1] row_mask:0xf bank_mask:0xf
    v_add_f32_dpp v114, v89, v114 quad_perm:[1,1,1,1] row_mask:0xf bank_mask:0xf
    v_add_f32_dpp v115, v93, v115 quad_perm:[1,1,1,1] row_mask:0xf bank_mask:0xf
    v_add_f32_dpp v116, v97, v116 quad_perm:[1,1,1,1] row_mask:0xf bank_mask:0xf
    v_add_f32_dpp v117, v101, v117 quad_perm:[1,1,1,1] row_mask:0xf bank_mask:0xf
    v_add_f32_dpp v118, v105, v118 quad_perm:[1,1,1,1] row_mask:0xf bank_mask:0xf
    v_add_f32_dpp v119, v109, v119 quad_perm:[1,1,1,1] row_mask:0xf bank_mask:0xf
    v_add_f32_dpp v112, v82, v112 quad_perm:[2,2,2,2] row_mask:0xf bank_mask:0xf
    v_add_f32_dpp v113, v86, v113 quad_perm:[2,2,2,2] row_mask:0xf bank_mask:0xf
    v_add_f32_dpp v114, v90, v114 quad_perm:[2,2,2,2] row_mask:0xf bank_mask:0xf
    v_add_f32_dpp v115, v94, v115 quad_perm:[2,2,2,2] row_mask:0xf bank_mask:0xf
    v_add_f32_dpp v116, v98, v116 quad_perm:[2,2,2,2] row_mask:0xf bank_mask:0xf
    v_add_f32_dpp v117, v102, v117 quad_perm:[2,2,2,2] row_mask:0xf bank_mask:0xf
    v_add_f32_dpp v118, v106, v118 quad_perm:[2,2,2,2] row_mask:0xf bank_mask:0xf
    v_add_f32_dpp v119, v110, v119 quad_perm:[2,2,2,2] row_mask:0xf bank_mask:0xf
    v_cndmask_b32 v72, v72, v112, s[68:69]
    v_cndmask_b32 v73, v73, v113, s[68:69]
    v_cndmask_b32 v74, v74, v114, s[68:69]
    v_cndmask_b32 v75, v75, v115, s[68:69]
    v_cndmask_b32 v76, v76, v116, s[68:69]
    v_cndmask_b32 v77, v77, v117, s[68:69]
    v_cndmask_b32 v78, v78, v118, s[68:69]
    v_cndmask_b32 v79, v79, v119, s[68:69]
    s_mov_b32 s71, 0x3e0293ee
    v_mul_f32 v72, s71, v72
    v_mul_f32 v73, s71, v73
    v_mul_f32 v74, s71, v74
    v_mul_f32 v75, s71, v75
    v_mul_f32 v76, s71, v76
    v_mul_f32 v77, s71, v77
    v_mul_f32 v78, s71, v78
    v_mul_f32 v79, s71, v79
    v_cvt_pk_bf16_f32 v4, v72, v73
    v_cvt_pk_bf16_f32 v5, v74, v75
    v_cvt_pk_bf16_f32 v6, v76, v77
    v_cvt_pk_bf16_f32 v7, v78, v79
    s_lshl_b32 s24, s26, 12
    s_lshl_b32 s25, s3, 8
    s_add_u32 s24, s24, s25
    s_add_u32 s24, s24, 0x0
    buffer_store_dwordx4 v[4:7], v66, s[12:15], s24 offen sc1
    s_mov_b32 s8, s56
    s_mov_b32 s9, s57
    s_mov_b32 s10, 0x400000
    s_mov_b32 s11, 0x20000
    s_and_b32 s24, s3, 1
    s_lshl_b32 s24, s24, 1
    s_and_b32 s25, s3, 2
    s_lshl_b32 s25, s25, 3
    s_or_b32 s25, s25, s24
    s_and_b32 s24, s26, 13
    s_or_b32 s25, s25, s24
    s_lshl_b32 s25, s25, 17
    s_lshr_b32 s24, s74, 3
    s_lshl_b32 s24, s24, 7
    s_add_u32 s24, s24, s25
    v_lshrrev_b32 v3, 4, v0
    v_lshlrev_b32 v3, 15, v3
    v_and_b32 v4, 8, v0
    v_lshl_add_u32 v3, v4, 10, v3
    v_and_b32 v4, 0x70, v2
    v_add_u32 v3, v3, v4
    s_mul_i32 m0, s3, 16896
    s_nop 0
    buffer_load_dwordx4 v3, s[8:11], s24 offen nt lds
    s_add_u32 m0, m0, 1056
    s_add_u32 s24, s24, 2048
    buffer_load_dwordx4 v3, s[8:11], s24 offen nt lds
    s_add_u32 m0, m0, 1056
    s_add_u32 s24, s24, 2048
    buffer_load_dwordx4 v3, s[8:11], s24 offen nt lds
    s_add_u32 m0, m0, 1056
    s_add_u32 s24, s24, 2048
    buffer_load_dwordx4 v3, s[8:11], s24 offen nt lds
    s_add_u32 m0, m0, 1056
    s_add_u32 s24, s24, 10240
    buffer_load_dwordx4 v3, s[8:11], s24 offen nt lds
    s_add_u32 m0, m0, 1056
    s_add_u32 s24, s24, 2048
    buffer_load_dwordx4 v3, s[8:11], s24 offen nt lds
    s_add_u32 m0, m0, 1056
    s_add_u32 s24, s24, 2048
    buffer_load_dwordx4 v3, s[8:11], s24 offen nt lds
    s_add_u32 m0, m0, 1056
    s_add_u32 s24, s24, 2048
    buffer_load_dwordx4 v3, s[8:11], s24 offen nt lds
    s_add_u32 m0, m0, 1056
    s_add_u32 s24, s24, -21504
    buffer_load_dwordx4 v3, s[8:11], s24 offen nt lds
    s_add_u32 m0, m0, 1056
    s_add_u32 s24, s24, 2048
    buffer_load_dwordx4 v3, s[8:11], s24 offen nt lds
    s_add_u32 m0, m0, 1056
    s_add_u32 s24, s24, 2048
    buffer_load_dwordx4 v3, s[8:11], s24 offen nt lds
    s_add_u32 m0, m0, 1056
    s_add_u32 s24, s24, 2048
    buffer_load_dwordx4 v3, s[8:11], s24 offen nt lds
    s_add_u32 m0, m0, 1056
    s_add_u32 s24, s24, 10240
    buffer_load_dwordx4 v3, s[8:11], s24 offen nt lds
    s_add_u32 m0, m0, 1056
    s_add_u32 s24, s24, 2048
    buffer_load_dwordx4 v3, s[8:11], s24 offen nt lds
    s_add_u32 m0, m0, 1056
    s_add_u32 s24, s24, 2048
    buffer_load_dwordx4 v3, s[8:11], s24 offen nt lds
    s_add_u32 m0, m0, 1056
    s_add_u32 s24, s24, 2048
    buffer_load_dwordx4 v3, s[8:11], s24 offen nt lds
    s_waitcnt vmcnt(0)
    s_barrier
    s_cmp_lg_u32 s3, 0
    s_cbranch_scc1 L_sig10
    s_mov_b64 exec, 1
    v_mov_b32 v3, 1
    buffer_atomic_add v3, off, s[16:19], 0 offset:0 sc0
    s_waitcnt vmcnt(0)
    v_readfirstlane_b32 s24, v3
    s_mov_b64 exec, -1
    s_and_b32 s24, s24, 63
    s_cmp_lg_u32 s24, 63
    s_cbranch_scc1 L_sig10
    v_lshlrev_b32 v4, 7, v0
    v_mov_b32 v3, 1
    s_mov_b32 s24, 0x170000
    buffer_store_dword v3, v4, s[12:15], s24 offen offset:0 sc1
L_sig10:
    v_lshrrev_b32 v3, 2, v0
    v_mul_u32_u24 v3, 1056, v3
    v_and_b32 v4, 3, v0
    v_lshl_add_u32 v3, v4, 3, v3
    s_lshl_b32 s24, s3, 5
    v_add_u32 v3, s24, v3
    ds_read_b64_tr_b16 a[128:129], v3 offset:0
    ds_read_b64_tr_b16 a[130:131], v3 offset:128
    ds_read_b64_tr_b16 a[132:133], v3 offset:256
    ds_read_b64_tr_b16 a[134:135], v3 offset:384
    ds_read_b64_tr_b16 a[136:137], v3 offset:512
    ds_read_b64_tr_b16 a[138:139], v3 offset:640
    ds_read_b64_tr_b16 a[140:141], v3 offset:768
    ds_read_b64_tr_b16 a[142:143], v3 offset:896
    ds_read_b64_tr_b16 a[144:145], v3 offset:16896
    ds_read_b64_tr_b16 a[146:147], v3 offset:17024
    ds_read_b64_tr_b16 a[148:149], v3 offset:17152
    ds_read_b64_tr_b16 a[150:151], v3 offset:17280
    ds_read_b64_tr_b16 a[152:153], v3 offset:17408
    ds_read_b64_tr_b16 a[154:155], v3 offset:17536
    ds_read_b64_tr_b16 a[156:157], v3 offset:17664
    ds_read_b64_tr_b16 a[158:159], v3 offset:17792
    ds_read_b64_tr_b16 a[160:161], v3 offset:33792
    ds_read_b64_tr_b16 a[162:163], v3 offset:33920
    ds_read_b64_tr_b16 a[164:165], v3 offset:34048
    ds_read_b64_tr_b16 a[166:167], v3 offset:34176
    ds_read_b64_tr_b16 a[168:169], v3 offset:34304
    ds_read_b64_tr_b16 a[170:171], v3 offset:34432
    ds_read_b64_tr_b16 a[172:173], v3 offset:34560
    ds_read_b64_tr_b16 a[174:175], v3 offset:34688
    ds_read_b64_tr_b16 a[176:177], v3 offset:50688
    ds_read_b64_tr_b16 a[178:179], v3 offset:50816
    ds_read_b64_tr_b16 a[180:181], v3 offset:50944
    ds_read_b64_tr_b16 a[182:183], v3 offset:51072
    ds_read_b64_tr_b16 a[184:185], v3 offset:51200
    ds_read_b64_tr_b16 a[186:187], v3 offset:51328
    ds_read_b64_tr_b16 a[188:189], v3 offset:51456
    ds_read_b64_tr_b16 a[190:191], v3 offset:51584
    s_mov_b32 s4, s44
    s_mov_b32 s5, s45
    s_mov_b32 s6, 0x400000
    s_mov_b32 s7, 0x20000
    s_mov_b32 s8, s46
    s_mov_b32 s9, s47
    s_mov_b32 s10, 0x400000
    s_mov_b32 s11, 0x20000
    s_mov_b32 s32, s35
    buffer_load_dwordx4 v[128:131], v18, s[4:7], s32 offen nt
    s_add_u32 s32, s32, 8192
    buffer_load_dwordx4 v[132:135], v18, s[4:7], s32 offen nt
    s_add_u32 s32, s32, 8192
    buffer_load_dwordx4 v[136:139], v18, s[4:7], s32 offen nt
    s_add_u32 s32, s32, 8192
    buffer_load_dwordx4 v[140:143], v18, s[4:7], s32 offen nt
    s_add_u32 s32, s32, 8192
    buffer_load_dwordx4 v[144:147], v18, s[4:7], s32 offen nt
    s_add_u32 s32, s32, 8192
    buffer_load_dwordx4 v[148:151], v18, s[4:7], s32 offen nt
    s_add_u32 s32, s32, 8192
    buffer_load_dwordx4 v[152:155], v18, s[4:7], s32 offen nt
    s_add_u32 s32, s32, 8192
    buffer_load_dwordx4 v[156:159], v18, s[4:7], s32 offen nt
    s_add_u32 s32, s32, 8192
    buffer_load_dwordx4 v[160:163], v18, s[4:7], s32 offen nt
    s_add_u32 s32, s32, 8192
    buffer_load_dwordx4 v[164:167], v18, s[4:7], s32 offen nt
    s_add_u32 s32, s32, 8192
    buffer_load_dwordx4 v[168:171], v18, s[4:7], s32 offen nt
    s_add_u32 s32, s32, 8192
    buffer_load_dwordx4 v[172:175], v18, s[4:7], s32 offen nt
    s_add_u32 s32, s32, 8192
    buffer_load_dwordx4 v[176:179], v18, s[4:7], s32 offen nt
    s_add_u32 s32, s32, 8192
    buffer_load_dwordx4 v[180:183], v18, s[4:7], s32 offen nt
    s_add_u32 s32, s32, 8192
    buffer_load_dwordx4 v[184:187], v18, s[4:7], s32 offen nt
    s_add_u32 s32, s32, 8192
    buffer_load_dwordx4 v[188:191], v18, s[4:7], s32 offen nt
    s_add_u32 s32, s32, 8192
    buffer_load_dwordx4 v[192:195], v18, s[4:7], s32 offen nt
    s_add_u32 s32, s32, 8192
    buffer_load_dwordx4 v[196:199], v18, s[4:7], s32 offen nt
    s_add_u32 s32, s32, 8192
    buffer_load_dwordx4 v[200:203], v18, s[4:7], s32 offen nt
    s_add_u32 s32, s32, 8192
    buffer_load_dwordx4 v[204:207], v18, s[4:7], s32 offen nt
    s_add_u32 s32, s32, 8192
    buffer_load_dwordx4 v[208:211], v18, s[4:7], s32 offen nt
    s_add_u32 s32, s32, 8192
    buffer_load_dwordx4 v[212:215], v18, s[4:7], s32 offen nt
    s_add_u32 s32, s32, 8192
    buffer_load_dwordx4 v[216:219], v18, s[4:7], s32 offen nt
    s_add_u32 s32, s32, 8192
    buffer_load_dwordx4 v[220:223], v18, s[4:7], s32 offen nt
    s_add_u32 s32, s32, 8192
    buffer_load_dwordx4 v[224:227], v18, s[4:7], s32 offen nt
    s_add_u32 s32, s32, 8192
    buffer_load_dwordx4 v[228:231], v18, s[4:7], s32 offen nt
    s_add_u32 s32, s32, 8192
    buffer_load_dwordx4 v[232:235], v18, s[4:7], s32 offen nt
    s_add_u32 s32, s32, 8192
    buffer_load_dwordx4 v[236:239], v18, s[4:7], s32 offen nt
    s_add_u32 s32, s32, 8192
    buffer_load_dwordx4 v[240:243], v18, s[4:7], s32 offen nt
    s_add_u32 s32, s32, 8192
    buffer_load_dwordx4 v[244:247], v18, s[4:7], s32 offen nt
    s_add_u32 s32, s32, 8192
    buffer_load_dwordx4 v[248:251], v18, s[4:7], s32 offen nt
    s_add_u32 s32, s32, 8192
    buffer_load_dwordx4 v[252:255], v18, s[4:7], s32 offen nt
    s_add_u32 s32, s32, 8192
    s_lshl_b32 s33, s26, 17
    s_lshl_b32 s24, s3, 15
    s_add_u32 s33, s33, s24
    s_mul_i32 s34, s3, 33792
    s_waitcnt lgkmcnt(0)
    s_barrier
    s_mov_b32 s70, 0
L_woA:
    s_and_b32 s24, s70, 3
    s_lshl_b32 s24, s24, 1
    s_lshr_b32 s25, s70, 2
    s_or_b32 s24, s24, s25
    s_lshl_b32 s24, s24, 10
    s_add_u32 s24, s24, s33
    s_mul_i32 s25, s70, 4224
    s_add_u32 m0, s25, s34
    s_waitcnt vmcnt(24)
    buffer_load_dwordx4 v2, s[8:11], s24 offen nt lds
    s_add_u32 m0, m0, 1056
    s_add_u32 s24, s24, 8192
    s_waitcnt vmcnt(24)
    buffer_load_dwordx4 v2, s[8:11], s24 offen nt lds
    s_add_u32 m0, m0, 1056
    s_add_u32 s24, s24, 8192
    s_waitcnt vmcnt(24)
    buffer_load_dwordx4 v2, s[8:11], s24 offen nt lds
    s_add_u32 m0, m0, 1056
    s_add_u32 s24, s24, 8192
    s_waitcnt vmcnt(24)
    buffer_load_dwordx4 v2, s[8:11], s24 offen nt lds
    s_add_u32 s70, s70, 1
    s_cmp_lt_u32 s70, 8
    s_cbranch_scc1 L_woA
    s_waitcnt vmcnt(0)
    s_barrier
    v_lshrrev_b32 v3, 2, v0
    v_mul_u32_u24 v3, 1056, v3
    v_and_b32 v4, 3, v0
    v_lshl_add_u32 v3, v4, 3, v3
    s_lshl_b32 s24, s3, 8
    v_add_u32 v3, s24, v3
    v_add_u32 v4, 67584, v3
    ds_read_b64_tr_b16 a[0:1], v3 offset:0
    ds_read_b64_tr_b16 a[2:3], v3 offset:16896
    ds_read_b64_tr_b16 a[4:5], v3 offset:33792
    ds_read_b64_tr_b16 a[6:7], v3 offset:50688
    ds_read_b64_tr_b16 a[8:9], v4 offset:0
    ds_read_b64_tr_b16 a[10:11], v4 offset:16896
    ds_read_b64_tr_b16 a[12:13], v4 offset:33792
    ds_read_b64_tr_b16 a[14:15], v4 offset:50688
    ds_read_b64_tr_b16 a[16:17], v3 offset:32
    ds_read_b64_tr_b16 a[18:19], v3 offset:16928
    ds_read_b64_tr_b16 a[20:21], v3 offset:33824
    ds_read_b64_tr_b16 a[22:23], v3 offset:50720
    ds_read_b64_tr_b16 a[24:25], v4 offset:32
    ds_read_b64_tr_b16 a[26:27], v4 offset:16928
    ds_read_b64_tr_b16 a[28:29], v4 offset:33824
    ds_read_b64_tr_b16 a[30:31], v4 offset:50720
    ds_read_b64_tr_b16 a[32:33], v3 offset:64
    ds_read_b64_tr_b16 a[34:35], v3 offset:16960
    ds_read_b64_tr_b16 a[36:37], v3 offset:33856
    ds_read_b64_tr_b16 a[38:39], v3 offset:50752
    ds_read_b64_tr_b16 a[40:41], v4 offset:64
    ds_read_b64_tr_b16 a[42:43], v4 offset:16960
    ds_read_b64_tr_b16 a[44:45], v4 offset:33856
    ds_read_b64_tr_b16 a[46:47], v4 offset:50752
    ds_read_b64_tr_b16 a[48:49], v3 offset:96
    ds_read_b64_tr_b16 a[50:51], v3 offset:16992
    ds_read_b64_tr_b16 a[52:53], v3 offset:33888
    ds_read_b64_tr_b16 a[54:55], v3 offset:50784
    ds_read_b64_tr_b16 a[56:57], v4 offset:96
    ds_read_b64_tr_b16 a[58:59], v4 offset:16992
    ds_read_b64_tr_b16 a[60:61], v4 offset:33888
    ds_read_b64_tr_b16 a[62:63], v4 offset:50784
    ds_read_b64_tr_b16 a[64:65], v3 offset:128
    ds_read_b64_tr_b16 a[66:67], v3 offset:17024
    ds_read_b64_tr_b16 a[68:69], v3 offset:33920
    ds_read_b64_tr_b16 a[70:71], v3 offset:50816
    ds_read_b64_tr_b16 a[72:73], v4 offset:128
    ds_read_b64_tr_b16 a[74:75], v4 offset:17024
    ds_read_b64_tr_b16 a[76:77], v4 offset:33920
    ds_read_b64_tr_b16 a[78:79], v4 offset:50816
    ds_read_b64_tr_b16 a[80:81], v3 offset:160
    ds_read_b64_tr_b16 a[82:83], v3 offset:17056
    ds_read_b64_tr_b16 a[84:85], v3 offset:33952
    ds_read_b64_tr_b16 a[86:87], v3 offset:50848
    ds_read_b64_tr_b16 a[88:89], v4 offset:160
    ds_read_b64_tr_b16 a[90:91], v4 offset:17056
    ds_read_b64_tr_b16 a[92:93], v4 offset:33952
    ds_read_b64_tr_b16 a[94:95], v4 offset:50848
    ds_read_b64_tr_b16 a[96:97], v3 offset:192
    ds_read_b64_tr_b16 a[98:99], v3 offset:17088
    ds_read_b64_tr_b16 a[100:101], v3 offset:33984
    ds_read_b64_tr_b16 a[102:103], v3 offset:50880
    ds_read_b64_tr_b16 a[104:105], v4 offset:192
    ds_read_b64_tr_b16 a[106:107], v4 offset:17088
    ds_read_b64_tr_b16 a[108:109], v4 offset:33984
    ds_read_b64_tr_b16 a[110:111], v4 offset:50880
    ds_read_b64_tr_b16 a[112:113], v3 offset:224
    ds_read_b64_tr_b16 a[114:115], v3 offset:17120
    ds_read_b64_tr_b16 a[116:117], v3 offset:34016
    ds_read_b64_tr_b16 a[118:119], v3 offset:50912
    ds_read_b64_tr_b16 a[120:121], v4 offset:224
    ds_read_b64_tr_b16 a[122:123], v4 offset:17120
    ds_read_b64_tr_b16 a[124:125], v4 offset:34016
    ds_read_b64_tr_b16 a[126:127], v4 offset:50912
    s_waitcnt lgkmcnt(0)
    s_cmp_lg_u32 s3, 0
    s_cbranch_scc1 L_awx11
    s_mov_b32 s24, 262144
    s_mov_b64 exec, 1
L_aw12:
    buffer_load_dword v1, off, s[12:15], s73 offset:0 sc1
    s_waitcnt vmcnt(0)
    v_readfirstlane_b32 s25, v1
    s_nop 0
    s_cmp_eq_u32 s25, 1
    s_cbranch_scc1 L_awx11
    s_sleep 4
    s_sub_u32 s24, s24, 1
    s_cmp_lg_u32 s24, 0
    s_cbranch_scc1 L_aw12
L_awx11:
    s_mov_b64 exec, -1
    s_barrier
    s_cmp_lg_u32 s3, 0
    s_cbranch_scc1 L_xi13
    s_and_b32 s24, s74, 7
    s_lshl_b32 s24, s24, 5
    s_lshr_b32 s25, s74, 3
    s_add_u32 s24, s24, s25
    s_lshl_b32 s24, s24, 2
    s_add_u32 s24, s24, 0x1d8000
    s_getreg_b32 s25, hwreg(HW_REG_XCC_ID, 0, 4)
    s_mov_b64 exec, 1
    v_mov_b32 v3, s25
    buffer_store_dword v3, off, s[12:15], s24 sc1
    s_mov_b64 exec, -1
L_xi13:
    s_cmp_lg_u32 s3, 0
    s_cbranch_scc1 L_awx14
    s_mov_b32 s24, 262144
    s_mov_b64 exec, 1
L_aw15:
    buffer_load_dword v1, off, s[12:15], s73 offset:4 sc1
    s_waitcnt vmcnt(0)
    v_readfirstlane_b32 s25, v1
    s_nop 0
    s_cmp_eq_u32 s25, 1
    s_cbranch_scc1 L_awx14
    s_sleep 4
    s_sub_u32 s24, s24, 1
    s_cmp_lg_u32 s24, 0
    s_cbranch_scc1 L_aw15
L_awx14:
    s_mov_b64 exec, -1
    s_barrier
    s_lshl_b32 s24, s3, 10
    s_lshl_b32 s25, s26, 3
    s_add_u32 s25, s25, s24
    s_add_u32 s25, s25, 0x120000
    v_and_b32 v3, 3, v0
    v_lshlrev_b32 v3, 8, v3
    buffer_load_dwordx2 v[4:5], v3, s[12:15], s25 offen sc1
    s_lshl_b32 s24, s3, 18
    s_lshl_b32 s25, s26, 11
    s_add_u32 s24, s24, s25
    s_add_u32 s24, s24, 0x400000
    buffer_load_dwordx4 v[72:75], v2, s[12:15], s24 offen sc1 nt
    s_add_u32 s24, s24, 65536
    buffer_load_dwordx4 v[76:79], v2, s[12:15], s24 offen sc1 nt
    s_add_u32 s24, s24, 65536
    buffer_load_dwordx4 v[80:83], v2, s[12:15], s24 offen sc1 nt
    s_add_u32 s24, s24, 65536
    buffer_load_dwordx4 v[84:87], v2, s[12:15], s24 offen sc1 nt
    s_add_u32 s24, s24, 65536
    s_waitcnt vmcnt(4)
    v_mov_b32 v6, v4
    s_nop 1
    v_max_f32_dpp v6, v6, v6 row_ror:2 row_mask:0xf bank_mask:0xf
    s_nop 1
    v_max_f32_dpp v6, v6, v6 row_ror:1 row_mask:0xf bank_mask:0xf
    v_sub_f32 v4, v4, v6
    v_exp_f32 v4, v4
    s_nop 0
    v_mul_f32 v5, v4, v5
    s_nop 1
    v_add_f32_dpp v5, v5, v5 row_ror:2 row_mask:0xf bank_mask:0xf
    s_nop 1
    v_add_f32_dpp v5, v5, v5 row_ror:1 row_mask:0xf bank_mask:0xf
    v_rcp_f32 v5, v5
    s_nop 0
    v_mul_f32 v4, v4, v5
    s_nop 0
    v_readlane_b32 s24, v4, 0
    s_waitcnt vmcnt(3)
    v_lshlrev_b32 v5, 16, v72
    v_and_b32 v6, 0xffff0000, v72
    v_mul_f32 v104, s24, v5
    v_mul_f32 v105, s24, v6
    v_lshlrev_b32 v5, 16, v73
    v_and_b32 v6, 0xffff0000, v73
    v_mul_f32 v106, s24, v5
    v_mul_f32 v107, s24, v6
    v_lshlrev_b32 v5, 16, v74
    v_and_b32 v6, 0xffff0000, v74
    v_mul_f32 v108, s24, v5
    v_mul_f32 v109, s24, v6
    v_lshlrev_b32 v5, 16, v75
    v_and_b32 v6, 0xffff0000, v75
    v_mul_f32 v110, s24, v5
    v_mul_f32 v111, s24, v6
    v_readlane_b32 s24, v4, 1
    s_waitcnt vmcnt(2)
    v_lshlrev_b32 v5, 16, v76
    v_and_b32 v6, 0xffff0000, v76
    v_fmac_f32 v104, s24, v5
    v_fmac_f32 v105, s24, v6
    v_lshlrev_b32 v5, 16, v77
    v_and_b32 v6, 0xffff0000, v77
    v_fmac_f32 v106, s24, v5
    v_fmac_f32 v107, s24, v6
    v_lshlrev_b32 v5, 16, v78
    v_and_b32 v6, 0xffff0000, v78
    v_fmac_f32 v108, s24, v5
    v_fmac_f32 v109, s24, v6
    v_lshlrev_b32 v5, 16, v79
    v_and_b32 v6, 0xffff0000, v79
    v_fmac_f32 v110, s24, v5
    v_fmac_f32 v111, s24, v6
    v_readlane_b32 s24, v4, 2
    s_waitcnt vmcnt(1)
    v_lshlrev_b32 v5, 16, v80
    v_and_b32 v6, 0xffff0000, v80
    v_fmac_f32 v104, s24, v5
    v_fmac_f32 v105, s24, v6
    v_lshlrev_b32 v5, 16, v81
    v_and_b32 v6, 0xffff0000, v81
    v_fmac_f32 v106, s24, v5
    v_fmac_f32 v107, s24, v6
    v_lshlrev_b32 v5, 16, v82
    v_and_b32 v6, 0xffff0000, v82
    v_fmac_f32 v108, s24, v5
    v_fmac_f32 v109, s24, v6
    v_lshlrev_b32 v5, 16, v83
    v_and_b32 v6, 0xffff0000, v83
    v_fmac_f32 v110, s24, v5
    v_fmac_f32 v111, s24, v6
    v_readlane_b32 s24, v4, 3
    s_waitcnt vmcnt(0)
    v_lshlrev_b32 v5, 16, v84
    v_and_b32 v6, 0xffff0000, v84
    v_fmac_f32 v104, s24, v5
    v_fmac_f32 v105, s24, v6
    v_lshlrev_b32 v5, 16, v85
    v_and_b32 v6, 0xffff0000, v85
    v_fmac_f32 v106, s24, v5
    v_fmac_f32 v107, s24, v6
    v_lshlrev_b32 v5, 16, v86
    v_and_b32 v6, 0xffff0000, v86
    v_fmac_f32 v108, s24, v5
    v_fmac_f32 v109, s24, v6
    v_lshlrev_b32 v5, 16, v87
    v_and_b32 v6, 0xffff0000, v87
    v_fmac_f32 v110, s24, v5
    v_fmac_f32 v111, s24, v6
    v_cvt_pk_bf16_f32 v4, v104, v105
    v_cvt_pk_bf16_f32 v5, v106, v107
    v_cvt_pk_bf16_f32 v6, v108, v109
    v_cvt_pk_bf16_f32 v7, v110, v111
    s_lshl_b32 s24, s3, 10
    s_add_u32 s24, s24, 145408
    v_add_u32 v3, s24, v2
    ds_write_b128 v3, v[4:7]
    s_lshl_b32 s24, s3, 8
    s_add_u32 s24, s24, 145408
    v_add_u32 v3, s24, v19
    s_waitcnt lgkmcnt(0)
    s_barrier
    ds_read_b128 v[32:35], v3 offset:0
    ds_read_b128 v[36:39], v3 offset:16
    ds_read_b128 v[40:43], v3 offset:32
    ds_read_b128 v[44:47], v3 offset:48
    ds_read_b128 v[48:51], v3 offset:2048
    ds_read_b128 v[52:55], v3 offset:2064
    ds_read_b128 v[56:59], v3 offset:2080
    ds_read_b128 v[60:63], v3 offset:2096
    s_waitcnt lgkmcnt(0)
    v_perm_b32 v8, v32, v32, v24
    v_perm_b32 v9, v32, v32, v25
    v_perm_b32 v10, v32, v32, v26
    v_perm_b32 v11, v32, v32, v27
    v_perm_b32 v4, v48, v48, v24
    v_perm_b32 v5, v48, v48, v25
    v_perm_b32 v6, v48, v48, v26
    v_perm_b32 v7, v48, v48, v27
    v_mfma_f32_16x16x32_bf16 v[12:15], v[128:131], v[8:11], 0
    s_nop 0
    v_mfma_f32_16x16x32_bf16 v[68:71], v[128:131], v[4:7], 0
    v_perm_b32 v8, v32, v32, v28
    v_perm_b32 v9, v32, v32, v29
    v_perm_b32 v10, v32, v32, v30
    v_perm_b32 v11, v32, v32, v31
    v_perm_b32 v4, v48, v48, v28
    v_perm_b32 v5, v48, v48, v29
    v_perm_b32 v6, v48, v48, v30
    v_perm_b32 v7, v48, v48, v31
    v_mfma_f32_16x16x32_bf16 v[12:15], v[132:135], v[8:11], v[12:15]
    s_nop 0
    v_mfma_f32_16x16x32_bf16 v[68:71], v[132:135], v[4:7], v[68:71]
    v_perm_b32 v8, v33, v33, v24
    v_perm_b32 v9, v33, v33, v25
    v_perm_b32 v10, v33, v33, v26
    v_perm_b32 v11, v33, v33, v27
    v_perm_b32 v4, v49, v49, v24
    v_perm_b32 v5, v49, v49, v25
    v_perm_b32 v6, v49, v49, v26
    v_perm_b32 v7, v49, v49, v27
    v_mfma_f32_16x16x32_bf16 v[12:15], v[136:139], v[8:11], v[12:15]
    s_nop 0
    v_mfma_f32_16x16x32_bf16 v[68:71], v[136:139], v[4:7], v[68:71]
    v_perm_b32 v8, v33, v33, v28
    v_perm_b32 v9, v33, v33, v29
    v_perm_b32 v10, v33, v33, v30
    v_perm_b32 v11, v33, v33, v31
    v_perm_b32 v4, v49, v49, v28
    v_perm_b32 v5, v49, v49, v29
    v_perm_b32 v6, v49, v49, v30
    v_perm_b32 v7, v49, v49, v31
    v_mfma_f32_16x16x32_bf16 v[12:15], v[140:143], v[8:11], v[12:15]
    s_nop 0
    v_mfma_f32_16x16x32_bf16 v[68:71], v[140:143], v[4:7], v[68:71]
    v_perm_b32 v8, v34, v34, v24
    v_perm_b32 v9, v34, v34, v25
    v_perm_b32 v10, v34, v34, v26
    v_perm_b32 v11, v34, v34, v27
    v_perm_b32 v4, v50, v50, v24
    v_perm_b32 v5, v50, v50, v25
    v_perm_b32 v6, v50, v50, v26
    v_perm_b32 v7, v50, v50, v27
    v_mfma_f32_16x16x32_bf16 v[12:15], v[144:147], v[8:11], v[12:15]
    s_nop 0
    v_mfma_f32_16x16x32_bf16 v[68:71], v[144:147], v[4:7], v[68:71]
    v_perm_b32 v8, v34, v34, v28
    v_perm_b32 v9, v34, v34, v29
    v_perm_b32 v10, v34, v34, v30
    v_perm_b32 v11, v34, v34, v31
    v_perm_b32 v4, v50, v50, v28
    v_perm_b32 v5, v50, v50, v29
    v_perm_b32 v6, v50, v50, v30
    v_perm_b32 v7, v50, v50, v31
    v_mfma_f32_16x16x32_bf16 v[12:15], v[148:151], v[8:11], v[12:15]
    s_nop 0
    v_mfma_f32_16x16x32_bf16 v[68:71], v[148:151], v[4:7], v[68:71]
    v_perm_b32 v8, v35, v35, v24
    v_perm_b32 v9, v35, v35, v25
    v_perm_b32 v10, v35, v35, v26
    v_perm_b32 v11, v35, v35, v27
    v_perm_b32 v4, v51, v51, v24
    v_perm_b32 v5, v51, v51, v25
    v_perm_b32 v6, v51, v51, v26
    v_perm_b32 v7, v51, v51, v27
    v_mfma_f32_16x16x32_bf16 v[12:15], v[152:155], v[8:11], v[12:15]
    s_nop 0
    v_mfma_f32_16x16x32_bf16 v[68:71], v[152:155], v[4:7], v[68:71]
    v_perm_b32 v8, v35, v35, v28
    v_perm_b32 v9, v35, v35, v29
    v_perm_b32 v10, v35, v35, v30
    v_perm_b32 v11, v35, v35, v31
    v_perm_b32 v4, v51, v51, v28
    v_perm_b32 v5, v51, v51, v29
    v_perm_b32 v6, v51, v51, v30
    v_perm_b32 v7, v51, v51, v31
    v_mfma_f32_16x16x32_bf16 v[12:15], v[156:159], v[8:11], v[12:15]
    s_nop 0
    v_mfma_f32_16x16x32_bf16 v[68:71], v[156:159], v[4:7], v[68:71]
    v_perm_b32 v8, v36, v36, v24
    v_perm_b32 v9, v36, v36, v25
    v_perm_b32 v10, v36, v36, v26
    v_perm_b32 v11, v36, v36, v27
    v_perm_b32 v4, v52, v52, v24
    v_perm_b32 v5, v52, v52, v25
    v_perm_b32 v6, v52, v52, v26
    v_perm_b32 v7, v52, v52, v27
    v_mfma_f32_16x16x32_bf16 v[12:15], v[160:163], v[8:11], v[12:15]
    s_nop 0
    v_mfma_f32_16x16x32_bf16 v[68:71], v[160:163], v[4:7], v[68:71]
    v_perm_b32 v8, v36, v36, v28
    v_perm_b32 v9, v36, v36, v29
    v_perm_b32 v10, v36, v36, v30
    v_perm_b32 v11, v36, v36, v31
    v_perm_b32 v4, v52, v52, v28
    v_perm_b32 v5, v52, v52, v29
    v_perm_b32 v6, v52, v52, v30
    v_perm_b32 v7, v52, v52, v31
    v_mfma_f32_16x16x32_bf16 v[12:15], v[164:167], v[8:11], v[12:15]
    s_nop 0
    v_mfma_f32_16x16x32_bf16 v[68:71], v[164:167], v[4:7], v[68:71]
    v_perm_b32 v8, v37, v37, v24
    v_perm_b32 v9, v37, v37, v25
    v_perm_b32 v10, v37, v37, v26
    v_perm_b32 v11, v37, v37, v27
    v_perm_b32 v4, v53, v53, v24
    v_perm_b32 v5, v53, v53, v25
    v_perm_b32 v6, v53, v53, v26
    v_perm_b32 v7, v53, v53, v27
    v_mfma_f32_16x16x32_bf16 v[12:15], v[168:171], v[8:11], v[12:15]
    s_nop 0
    v_mfma_f32_16x16x32_bf16 v[68:71], v[168:171], v[4:7], v[68:71]
    v_perm_b32 v8, v37, v37, v28
    v_perm_b32 v9, v37, v37, v29
    v_perm_b32 v10, v37, v37, v30
    v_perm_b32 v11, v37, v37, v31
    v_perm_b32 v4, v53, v53, v28
    v_perm_b32 v5, v53, v53, v29
    v_perm_b32 v6, v53, v53, v30
    v_perm_b32 v7, v53, v53, v31
    v_mfma_f32_16x16x32_bf16 v[12:15], v[172:175], v[8:11], v[12:15]
    s_nop 0
    v_mfma_f32_16x16x32_bf16 v[68:71], v[172:175], v[4:7], v[68:71]
    v_perm_b32 v8, v38, v38, v24
    v_perm_b32 v9, v38, v38, v25
    v_perm_b32 v10, v38, v38, v26
    v_perm_b32 v11, v38, v38, v27
    v_perm_b32 v4, v54, v54, v24
    v_perm_b32 v5, v54, v54, v25
    v_perm_b32 v6, v54, v54, v26
    v_perm_b32 v7, v54, v54, v27
    v_mfma_f32_16x16x32_bf16 v[12:15], v[176:179], v[8:11], v[12:15]
    s_nop 0
    v_mfma_f32_16x16x32_bf16 v[68:71], v[176:179], v[4:7], v[68:71]
    v_perm_b32 v8, v38, v38, v28
    v_perm_b32 v9, v38, v38, v29
    v_perm_b32 v10, v38, v38, v30
    v_perm_b32 v11, v38, v38, v31
    v_perm_b32 v4, v54, v54, v28
    v_perm_b32 v5, v54, v54, v29
    v_perm_b32 v6, v54, v54, v30
    v_perm_b32 v7, v54, v54, v31
    v_mfma_f32_16x16x32_bf16 v[12:15], v[180:183], v[8:11], v[12:15]
    s_nop 0
    v_mfma_f32_16x16x32_bf16 v[68:71], v[180:183], v[4:7], v[68:71]
    v_perm_b32 v8, v39, v39, v24
    v_perm_b32 v9, v39, v39, v25
    v_perm_b32 v10, v39, v39, v26
    v_perm_b32 v11, v39, v39, v27
    v_perm_b32 v4, v55, v55, v24
    v_perm_b32 v5, v55, v55, v25
    v_perm_b32 v6, v55, v55, v26
    v_perm_b32 v7, v55, v55, v27
    v_mfma_f32_16x16x32_bf16 v[12:15], v[184:187], v[8:11], v[12:15]
    s_nop 0
    v_mfma_f32_16x16x32_bf16 v[68:71], v[184:187], v[4:7], v[68:71]
    v_perm_b32 v8, v39, v39, v28
    v_perm_b32 v9, v39, v39, v29
    v_perm_b32 v10, v39, v39, v30
    v_perm_b32 v11, v39, v39, v31
    v_perm_b32 v4, v55, v55, v28
    v_perm_b32 v5, v55, v55, v29
    v_perm_b32 v6, v55, v55, v30
    v_perm_b32 v7, v55, v55, v31
    v_mfma_f32_16x16x32_bf16 v[12:15], v[188:191], v[8:11], v[12:15]
    s_nop 0
    v_mfma_f32_16x16x32_bf16 v[68:71], v[188:191], v[4:7], v[68:71]
    v_perm_b32 v8, v40, v40, v24
    v_perm_b32 v9, v40, v40, v25
    v_perm_b32 v10, v40, v40, v26
    v_perm_b32 v11, v40, v40, v27
    v_perm_b32 v4, v56, v56, v24
    v_perm_b32 v5, v56, v56, v25
    v_perm_b32 v6, v56, v56, v26
    v_perm_b32 v7, v56, v56, v27
    v_mfma_f32_16x16x32_bf16 v[12:15], v[192:195], v[8:11], v[12:15]
    s_nop 0
    v_mfma_f32_16x16x32_bf16 v[68:71], v[192:195], v[4:7], v[68:71]
    v_perm_b32 v8, v40, v40, v28
    v_perm_b32 v9, v40, v40, v29
    v_perm_b32 v10, v40, v40, v30
    v_perm_b32 v11, v40, v40, v31
    v_perm_b32 v4, v56, v56, v28
    v_perm_b32 v5, v56, v56, v29
    v_perm_b32 v6, v56, v56, v30
    v_perm_b32 v7, v56, v56, v31
    v_mfma_f32_16x16x32_bf16 v[12:15], v[196:199], v[8:11], v[12:15]
    s_nop 0
    v_mfma_f32_16x16x32_bf16 v[68:71], v[196:199], v[4:7], v[68:71]
    v_perm_b32 v8, v41, v41, v24
    v_perm_b32 v9, v41, v41, v25
    v_perm_b32 v10, v41, v41, v26
    v_perm_b32 v11, v41, v41, v27
    v_perm_b32 v4, v57, v57, v24
    v_perm_b32 v5, v57, v57, v25
    v_perm_b32 v6, v57, v57, v26
    v_perm_b32 v7, v57, v57, v27
    v_mfma_f32_16x16x32_bf16 v[12:15], v[200:203], v[8:11], v[12:15]
    s_nop 0
    v_mfma_f32_16x16x32_bf16 v[68:71], v[200:203], v[4:7], v[68:71]
    v_perm_b32 v8, v41, v41, v28
    v_perm_b32 v9, v41, v41, v29
    v_perm_b32 v10, v41, v41, v30
    v_perm_b32 v11, v41, v41, v31
    v_perm_b32 v4, v57, v57, v28
    v_perm_b32 v5, v57, v57, v29
    v_perm_b32 v6, v57, v57, v30
    v_perm_b32 v7, v57, v57, v31
    v_mfma_f32_16x16x32_bf16 v[12:15], v[204:207], v[8:11], v[12:15]
    s_nop 0
    v_mfma_f32_16x16x32_bf16 v[68:71], v[204:207], v[4:7], v[68:71]
    v_perm_b32 v8, v42, v42, v24
    v_perm_b32 v9, v42, v42, v25
    v_perm_b32 v10, v42, v42, v26
    v_perm_b32 v11, v42, v42, v27
    v_perm_b32 v4, v58, v58, v24
    v_perm_b32 v5, v58, v58, v25
    v_perm_b32 v6, v58, v58, v26
    v_perm_b32 v7, v58, v58, v27
    v_mfma_f32_16x16x32_bf16 v[12:15], v[208:211], v[8:11], v[12:15]
    s_nop 0
    v_mfma_f32_16x16x32_bf16 v[68:71], v[208:211], v[4:7], v[68:71]
    v_perm_b32 v8, v42, v42, v28
    v_perm_b32 v9, v42, v42, v29
    v_perm_b32 v10, v42, v42, v30
    v_perm_b32 v11, v42, v42, v31
    v_perm_b32 v4, v58, v58, v28
    v_perm_b32 v5, v58, v58, v29
    v_perm_b32 v6, v58, v58, v30
    v_perm_b32 v7, v58, v58, v31
    v_mfma_f32_16x16x32_bf16 v[12:15], v[212:215], v[8:11], v[12:15]
    s_nop 0
    v_mfma_f32_16x16x32_bf16 v[68:71], v[212:215], v[4:7], v[68:71]
    v_perm_b32 v8, v43, v43, v24
    v_perm_b32 v9, v43, v43, v25
    v_perm_b32 v10, v43, v43, v26
    v_perm_b32 v11, v43, v43, v27
    v_perm_b32 v4, v59, v59, v24
    v_perm_b32 v5, v59, v59, v25
    v_perm_b32 v6, v59, v59, v26
    v_perm_b32 v7, v59, v59, v27
    v_mfma_f32_16x16x32_bf16 v[12:15], v[216:219], v[8:11], v[12:15]
    s_nop 0
    v_mfma_f32_16x16x32_bf16 v[68:71], v[216:219], v[4:7], v[68:71]
    v_perm_b32 v8, v43, v43, v28
    v_perm_b32 v9, v43, v43, v29
    v_perm_b32 v10, v43, v43, v30
    v_perm_b32 v11, v43, v43, v31
    v_perm_b32 v4, v59, v59, v28
    v_perm_b32 v5, v59, v59, v29
    v_perm_b32 v6, v59, v59, v30
    v_perm_b32 v7, v59, v59, v31
    v_mfma_f32_16x16x32_bf16 v[12:15], v[220:223], v[8:11], v[12:15]
    s_nop 0
    v_mfma_f32_16x16x32_bf16 v[68:71], v[220:223], v[4:7], v[68:71]
    v_perm_b32 v8, v44, v44, v24
    v_perm_b32 v9, v44, v44, v25
    v_perm_b32 v10, v44, v44, v26
    v_perm_b32 v11, v44, v44, v27
    v_perm_b32 v4, v60, v60, v24
    v_perm_b32 v5, v60, v60, v25
    v_perm_b32 v6, v60, v60, v26
    v_perm_b32 v7, v60, v60, v27
    v_mfma_f32_16x16x32_bf16 v[12:15], v[224:227], v[8:11], v[12:15]
    s_nop 0
    v_mfma_f32_16x16x32_bf16 v[68:71], v[224:227], v[4:7], v[68:71]
    v_perm_b32 v8, v44, v44, v28
    v_perm_b32 v9, v44, v44, v29
    v_perm_b32 v10, v44, v44, v30
    v_perm_b32 v11, v44, v44, v31
    v_perm_b32 v4, v60, v60, v28
    v_perm_b32 v5, v60, v60, v29
    v_perm_b32 v6, v60, v60, v30
    v_perm_b32 v7, v60, v60, v31
    v_mfma_f32_16x16x32_bf16 v[12:15], v[228:231], v[8:11], v[12:15]
    s_nop 0
    v_mfma_f32_16x16x32_bf16 v[68:71], v[228:231], v[4:7], v[68:71]
    v_perm_b32 v8, v45, v45, v24
    v_perm_b32 v9, v45, v45, v25
    v_perm_b32 v10, v45, v45, v26
    v_perm_b32 v11, v45, v45, v27
    v_perm_b32 v4, v61, v61, v24
    v_perm_b32 v5, v61, v61, v25
    v_perm_b32 v6, v61, v61, v26
    v_perm_b32 v7, v61, v61, v27
    v_mfma_f32_16x16x32_bf16 v[12:15], v[232:235], v[8:11], v[12:15]
    s_nop 0
    v_mfma_f32_16x16x32_bf16 v[68:71], v[232:235], v[4:7], v[68:71]
    v_perm_b32 v8, v45, v45, v28
    v_perm_b32 v9, v45, v45, v29
    v_perm_b32 v10, v45, v45, v30
    v_perm_b32 v11, v45, v45, v31
    v_perm_b32 v4, v61, v61, v28
    v_perm_b32 v5, v61, v61, v29
    v_perm_b32 v6, v61, v61, v30
    v_perm_b32 v7, v61, v61, v31
    v_mfma_f32_16x16x32_bf16 v[12:15], v[236:239], v[8:11], v[12:15]
    s_nop 0
    v_mfma_f32_16x16x32_bf16 v[68:71], v[236:239], v[4:7], v[68:71]
    v_perm_b32 v8, v46, v46, v24
    v_perm_b32 v9, v46, v46, v25
    v_perm_b32 v10, v46, v46, v26
    v_perm_b32 v11, v46, v46, v27
    v_perm_b32 v4, v62, v62, v24
    v_perm_b32 v5, v62, v62, v25
    v_perm_b32 v6, v62, v62, v26
    v_perm_b32 v7, v62, v62, v27
    v_mfma_f32_16x16x32_bf16 v[12:15], v[240:243], v[8:11], v[12:15]
    s_nop 0
    v_mfma_f32_16x16x32_bf16 v[68:71], v[240:243], v[4:7], v[68:71]
    v_perm_b32 v8, v46, v46, v28
    v_perm_b32 v9, v46, v46, v29
    v_perm_b32 v10, v46, v46, v30
    v_perm_b32 v11, v46, v46, v31
    v_perm_b32 v4, v62, v62, v28
    v_perm_b32 v5, v62, v62, v29
    v_perm_b32 v6, v62, v62, v30
    v_perm_b32 v7, v62, v62, v31
    v_mfma_f32_16x16x32_bf16 v[12:15], v[244:247], v[8:11], v[12:15]
    s_nop 0
    v_mfma_f32_16x16x32_bf16 v[68:71], v[244:247], v[4:7], v[68:71]
    v_perm_b32 v8, v47, v47, v24
    v_perm_b32 v9, v47, v47, v25
    v_perm_b32 v10, v47, v47, v26
    v_perm_b32 v11, v47, v47, v27
    v_perm_b32 v4, v63, v63, v24
    v_perm_b32 v5, v63, v63, v25
    v_perm_b32 v6, v63, v63, v26
    v_perm_b32 v7, v63, v63, v27
    v_mfma_f32_16x16x32_bf16 v[12:15], v[248:251], v[8:11], v[12:15]
    s_nop 0
    v_mfma_f32_16x16x32_bf16 v[68:71], v[248:251], v[4:7], v[68:71]
    v_perm_b32 v8, v47, v47, v28
    v_perm_b32 v9, v47, v47, v29
    v_perm_b32 v10, v47, v47, v30
    v_perm_b32 v11, v47, v47, v31
    v_perm_b32 v4, v63, v63, v28
    v_perm_b32 v5, v63, v63, v29
    v_perm_b32 v6, v63, v63, v30
    v_perm_b32 v7, v63, v63, v31
    v_mfma_f32_16x16x32_bf16 v[12:15], v[252:255], v[8:11], v[12:15]
    s_nop 0
    v_mfma_f32_16x16x32_bf16 v[68:71], v[252:255], v[4:7], v[68:71]
    v_lshrrev_b32 v3, 4, v0
    v_lshlrev_b32 v3, 7, v3
    v_and_b32 v4, 7, v0
    v_lshl_add_u32 v3, v4, 4, v3
    v_bfe_u32 v4, v0, 3, 1
    v_lshl_add_u32 v3, v4, 9, v3
    s_lshl_b32 s24, s3, 11
    s_add_u32 s24, s24, 135168
    v_add_u32 v3, s24, v3
    ds_write_b128 v3, v[12:15]
    ds_write_b128 v3, v[68:71] offset:1024
    s_waitcnt lgkmcnt(0)
    s_barrier
    v_and_b32 v5, 31, v0
    s_lshl_b32 s24, s3, 9
    s_add_u32 s24, s24, 135168
    v_lshl_add_u32 v3, v5, 4, s24
    ds_read_b128 v[72:75], v3 offset:0
    ds_read_b128 v[76:79], v3 offset:2048
    ds_read_b128 v[80:83], v3 offset:4096
    ds_read_b128 v[84:87], v3 offset:6144
    s_mul_i32 s24, s3, 320
    s_add_u32 s24, s24, 143360
    v_lshl_add_u32 v5, v5, 3, s24
    s_waitcnt lgkmcnt(0)
    v_add_f32 v72, v72, v76
    v_add_f32 v73, v73, v77
    v_add_f32 v74, v74, v78
    v_add_f32 v75, v75, v79
    v_add_f32 v72, v72, v80
    v_add_f32 v73, v73, v81
    v_add_f32 v74, v74, v82
    v_add_f32 v75, v75, v83
    v_add_f32 v72, v72, v84
    v_add_f32 v73, v73, v85
    v_add_f32 v74, v74, v86
    v_add_f32 v75, v75, v87
    v_cvt_pk_bf16_f32 v6, v72, v73
    v_cvt_pk_bf16_f32 v7, v74, v75
    ds_write_b64 v5, v[6:7]
    v_lshrrev_b32 v3, 4, v0
    v_and_b32 v4, 3, v0
    v_mul_u32_u24 v5, 320, v4
    v_lshl_add_u32 v5, v3, 4, v5
    v_add_u32 v5, 143360, v5
    s_waitcnt lgkmcnt(0)
    s_barrier
    ds_read_b128 v[32:35], v5 offset:0
    ds_read_b128 v[36:39], v5 offset:64
    ds_read_b128 v[40:43], v5 offset:128
    ds_read_b128 v[44:47], v5 offset:192
    s_waitcnt lgkmcnt(3)
    v_mfma_f32_16x16x32_bf16 v[72:75], v[32:35], a[0:3], 0
    s_waitcnt lgkmcnt(2)
    v_mfma_f32_16x16x32_bf16 v[72:75], v[36:39], a[4:7], v[72:75]
    s_waitcnt lgkmcnt(1)
    v_mfma_f32_16x16x32_bf16 v[72:75], v[40:43], a[8:11], v[72:75]
    s_waitcnt lgkmcnt(0)
    v_mfma_f32_16x16x32_bf16 v[72:75], v[44:47], a[12:15], v[72:75]
    v_mfma_f32_16x16x32_bf16 v[76:79], v[32:35], a[16:19], 0
    v_mfma_f32_16x16x32_bf16 v[76:79], v[36:39], a[20:23], v[76:79]
    v_mfma_f32_16x16x32_bf16 v[76:79], v[40:43], a[24:27], v[76:79]
    v_mfma_f32_16x16x32_bf16 v[76:79], v[44:47], a[28:31], v[76:79]
    v_mfma_f32_16x16x32_bf16 v[80:83], v[32:35], a[32:35], 0
    v_mfma_f32_16x16x32_bf16 v[80:83], v[36:39], a[36:39], v[80:83]
    v_mfma_f32_16x16x32_bf16 v[80:83], v[40:43], a[40:43], v[80:83]
    v_mfma_f32_16x16x32_bf16 v[80:83], v[44:47], a[44:47], v[80:83]
    v_mov_b32_dpp v4, v72 quad_perm:[0,1,2,3] row_mask:0x1 bank_mask:0xf
    v_mov_b32_dpp v5, v73 quad_perm:[0,1,2,3] row_mask:0x1 bank_mask:0xf
    v_mov_b32_dpp v6, v74 quad_perm:[0,1,2,3] row_mask:0x1 bank_mask:0xf
    v_mov_b32_dpp v7, v75 quad_perm:[0,1,2,3] row_mask:0x1 bank_mask:0xf
    v_mfma_f32_16x16x32_bf16 v[84:87], v[32:35], a[48:51], 0
    v_mfma_f32_16x16x32_bf16 v[84:87], v[36:39], a[52:55], v[84:87]
    v_mfma_f32_16x16x32_bf16 v[84:87], v[40:43], a[56:59], v[84:87]
    v_mfma_f32_16x16x32_bf16 v[84:87], v[44:47], a[60:63], v[84:87]
    v_mov_b32_dpp v4, v76 quad_perm:[0,1,2,3] row_mask:0x2 bank_mask:0xf
    v_mov_b32_dpp v5, v77 quad_perm:[0,1,2,3] row_mask:0x2 bank_mask:0xf
    v_mov_b32_dpp v6, v78 quad_perm:[0,1,2,3] row_mask:0x2 bank_mask:0xf
    v_mov_b32_dpp v7, v79 quad_perm:[0,1,2,3] row_mask:0x2 bank_mask:0xf
    v_mfma_f32_16x16x32_bf16 v[88:91], v[32:35], a[64:67], 0
    v_mfma_f32_16x16x32_bf16 v[88:91], v[36:39], a[68:71], v[88:91]
    v_mfma_f32_16x16x32_bf16 v[88:91], v[40:43], a[72:75], v[88:91]
    v_mfma_f32_16x16x32_bf16 v[88:91], v[44:47], a[76:79], v[88:91]
    v_mov_b32_dpp v4, v80 quad_perm:[0,1,2,3] row_mask:0x4 bank_mask:0xf
    v_mov_b32_dpp v5, v81 quad_perm:[0,1,2,3] row_mask:0x4 bank_mask:0xf
    v_mov_b32_dpp v6, v82 quad_perm:[0,1,2,3] row_mask:0x4 bank_mask:0xf
    v_mov_b32_dpp v7, v83 quad_perm:[0,1,2,3] row_mask:0x4 bank_mask:0xf
    v_mfma_f32_16x16x32_bf16 v[92:95], v[32:35], a[80:83], 0
    v_mfma_f32_16x16x32_bf16 v[92:95], v[36:39], a[84:87], v[92:95]
    v_mfma_f32_16x16x32_bf16 v[92:95], v[40:43], a[88:91], v[92:95]
    v_mfma_f32_16x16x32_bf16 v[92:95], v[44:47], a[92:95], v[92:95]
    v_mov_b32_dpp v4, v84 quad_perm:[0,1,2,3] row_mask:0x8 bank_mask:0xf
    v_mov_b32_dpp v5, v85 quad_perm:[0,1,2,3] row_mask:0x8 bank_mask:0xf
    v_mov_b32_dpp v6, v86 quad_perm:[0,1,2,3] row_mask:0x8 bank_mask:0xf
    v_mov_b32_dpp v7, v87 quad_perm:[0,1,2,3] row_mask:0x8 bank_mask:0xf
    v_mfma_f32_16x16x32_bf16 v[96:99], v[32:35], a[96:99], 0
    v_mfma_f32_16x16x32_bf16 v[96:99], v[36:39], a[100:103], v[96:99]
    v_mfma_f32_16x16x32_bf16 v[96:99], v[40:43], a[104:107], v[96:99]
    v_mfma_f32_16x16x32_bf16 v[96:99], v[44:47], a[108:111], v[96:99]
    v_mov_b32_dpp v8, v88 quad_perm:[0,1,2,3] row_mask:0x1 bank_mask:0xf
    v_mov_b32_dpp v9, v89 quad_perm:[0,1,2,3] row_mask:0x1 bank_mask:0xf
    v_mov_b32_dpp v10, v90 quad_perm:[0,1,2,3] row_mask:0x1 bank_mask:0xf
    v_mov_b32_dpp v11, v91 quad_perm:[0,1,2,3] row_mask:0x1 bank_mask:0xf
    v_mfma_f32_16x16x32_bf16 v[100:103], v[32:35], a[112:115], 0
    v_mfma_f32_16x16x32_bf16 v[100:103], v[36:39], a[116:119], v[100:103]
    v_mfma_f32_16x16x32_bf16 v[100:103], v[40:43], a[120:123], v[100:103]
    v_mfma_f32_16x16x32_bf16 v[100:103], v[44:47], a[124:127], v[100:103]
    v_mov_b32_dpp v8, v92 quad_perm:[0,1,2,3] row_mask:0x2 bank_mask:0xf
    v_mov_b32_dpp v9, v93 quad_perm:[0,1,2,3] row_mask:0x2 bank_mask:0xf
    v_mov_b32_dpp v10, v94 quad_perm:[0,1,2,3] row_mask:0x2 bank_mask:0xf
    v_mov_b32_dpp v11, v95 quad_perm:[0,1,2,3] row_mask:0x2 bank_mask:0xf
    v_mov_b32_dpp v8, v96 quad_perm:[0,1,2,3] row_mask:0x4 bank_mask:0xf
    v_mov_b32_dpp v9, v97 quad_perm:[0,1,2,3] row_mask:0x4 bank_mask:0xf
    v_mov_b32_dpp v10, v98 quad_perm:[0,1,2,3] row_mask:0x4 bank_mask:0xf
    v_mov_b32_dpp v11, v99 quad_perm:[0,1,2,3] row_mask:0x4 bank_mask:0xf
    v_mov_b32_dpp v8, v100 quad_perm:[0,1,2,3] row_mask:0x8 bank_mask:0xf
    v_mov_b32_dpp v9, v101 quad_perm:[0,1,2,3] row_mask:0x8 bank_mask:0xf
    v_mov_b32_dpp v10, v102 quad_perm:[0,1,2,3] row_mask:0x8 bank_mask:0xf
    v_mov_b32_dpp v11, v103 quad_perm:[0,1,2,3] row_mask:0x8 bank_mask:0xf
    v_cvt_pk_bf16_f32 v12, v4, v5
    v_cvt_pk_bf16_f32 v13, v6, v7
    v_cvt_pk_bf16_f32 v14, v8, v9
    v_cvt_pk_bf16_f32 v15, v10, v11
    s_mov_b32 s20, s58
    s_mov_b32 s21, s59
    s_mov_b32 s22, 0x2000
    s_mov_b32 s23, 0x20000
    v_and_b32 v3, 3, v0
    v_lshlrev_b32 v80, 4, v3
    v_bfe_u32 v4, v0, 2, 1
    v_lshl_add_u32 v80, v4, 3, v80
    v_lshrrev_b32 v5, 3, v0
    v_lshl_add_u32 v80, v5, 6, v80
    v_lshlrev_b32 v82, 11, v3
    v_lshl_add_u32 v82, v4, 3, v82
    v_lshrrev_b32 v3, 4, v0
    v_lshl_add_u32 v82, v3, 4, v82
    v_and_b32 v5, 1, v5
    v_lshl_add_u32 v82, v5, 6, v82
    v_and_b32 v81, 0xf0, v2
    v_lshl_add_u32 v81, v3, 14, v81
    v_cmp_eq_u32 vcc, 0, v5
    v_mov_b32 v3, 0x3f803f80
    s_nop 0
    v_cndmask_b32 v4, 0, v3, vcc
    v_xor_b32 v5, v3, v4
    v_and_b32 v84, v4, v20
    v_and_b32 v88, v5, v20
    v_and_b32 v85, v4, v21
    v_and_b32 v89, v5, v21
    v_and_b32 v86, v4, v22
    v_and_b32 v90, v5, v22
    v_and_b32 v87, v4, v23
    v_and_b32 v91, v5, v23
    s_lshl_b32 s30, s3, 12
    s_add_u32 s30, s30, 0x80000
    s_lshl_b32 s24, s26, 14
    s_add_u32 s24, s24, s30
    buffer_store_dwordx2 v[12:13], v80, s[12:15], s24 offen sc1 nt
    buffer_store_dwordx2 v[14:15], v80, s[12:15], s24 offen offset:512 sc1 nt
    s_lshl_b32 s24, s3, 7
    s_add_u32 s24, s24, 0x1d9000
    s_waitcnt vmcnt(0)
    s_mov_b64 exec, 1
    v_mov_b32 v83, 64
    buffer_atomic_add v83, off, s[12:15], s24 sc0
    s_mov_b64 exec, -1
    s_waitcnt vmcnt(0)
    v_readfirstlane_b32 s24, v83
    s_nop 0
    s_cmp_lg_u32 s24, 1983
    s_cbranch_scc1 L_W_x
    s_lshl_b32 s31, s3, 8
L_W_f:
    s_mov_b32 s25, 262144
L_fi16:
    s_mov_b32 s24, s30
    buffer_load_dwordx4 v[128:131], v81, s[12:15], s24 offen offset:0 sc1 nt
    buffer_load_dwordx4 v[132:135], v81, s[12:15], s24 offen offset:256 sc1 nt
    s_add_u32 s24, s24, 65536
    buffer_load_dwordx4 v[136:139], v81, s[12:15], s24 offen offset:0 sc1 nt
    buffer_load_dwordx4 v[140:143], v81, s[12:15], s24 offen offset:256 sc1 nt
    s_add_u32 s24, s24, 65536
    buffer_load_dwordx4 v[144:147], v81, s[12:15], s24 offen offset:0 sc1 nt
    buffer_load_dwordx4 v[148:151], v81, s[12:15], s24 offen offset:256 sc1 nt
    s_add_u32 s24, s24, 65536
    buffer_load_dwordx4 v[152:155], v81, s[12:15], s24 offen offset:0 sc1 nt
    buffer_load_dwordx4 v[156:159], v81, s[12:15], s24 offen offset:256 sc1 nt
    s_add_u32 s24, s24, 65536
    buffer_load_dwordx4 v[160:163], v81, s[12:15], s24 offen offset:0 sc1 nt
    buffer_load_dwordx4 v[164:167], v81, s[12:15], s24 offen offset:256 sc1 nt
    s_add_u32 s24, s24, 65536
    buffer_load_dwordx4 v[168:171], v81, s[12:15], s24 offen offset:0 sc1 nt
    buffer_load_dwordx4 v[172:175], v81, s[12:15], s24 offen offset:256 sc1 nt
    s_add_u32 s24, s24, 65536
    buffer_load_dwordx4 v[176:179], v81, s[12:15], s24 offen offset:0 sc1 nt
    buffer_load_dwordx4 v[180:183], v81, s[12:15], s24 offen offset:256 sc1 nt
    s_add_u32 s24, s24, 65536
    buffer_load_dwordx4 v[184:187], v81, s[12:15], s24 offen offset:0 sc1 nt
    buffer_load_dwordx4 v[188:191], v81, s[12:15], s24 offen offset:256 sc1 nt
    s_waitcnt vmcnt(15)
    v_mfma_f32_16x16x32_bf16 v[92:95], v[128:131], v[84:87], 0
    s_waitcnt vmcnt(14)
    v_mfma_f32_16x16x32_bf16 v[92:95], v[132:135], v[88:91], v[92:95]
    s_waitcnt vmcnt(13)
    v_mfma_f32_16x16x32_bf16 v[92:95], v[136:139], v[84:87], v[92:95]
    s_waitcnt vmcnt(12)
    v_mfma_f32_16x16x32_bf16 v[92:95], v[140:143], v[88:91], v[92:95]
    s_waitcnt vmcnt(11)
    v_mfma_f32_16x16x32_bf16 v[92:95], v[144:147], v[84:87], v[92:95]
    s_waitcnt vmcnt(10)
    v_mfma_f32_16x16x32_bf16 v[92:95], v[148:151], v[88:91], v[92:95]
    s_waitcnt vmcnt(9)
    v_mfma_f32_16x16x32_bf16 v[92:95], v[152:155], v[84:87], v[92:95]
    s_waitcnt vmcnt(8)
    v_mfma_f32_16x16x32_bf16 v[92:95], v[156:159], v[88:91], v[92:95]
    s_waitcnt vmcnt(7)
    v_mfma_f32_16x16x32_bf16 v[92:95], v[160:163], v[84:87], v[92:95]
    s_waitcnt vmcnt(6)
    v_mfma_f32_16x16x32_bf16 v[92:95], v[164:167], v[88:91], v[92:95]
    s_waitcnt vmcnt(5)
    v_mfma_f32_16x16x32_bf16 v[92:95], v[168:171], v[84:87], v[92:95]
    s_waitcnt vmcnt(4)
    v_mfma_f32_16x16x32_bf16 v[92:95], v[172:175], v[88:91], v[92:95]
    s_waitcnt vmcnt(3)
    v_mfma_f32_16x16x32_bf16 v[92:95], v[176:179], v[84:87], v[92:95]
    s_waitcnt vmcnt(2)
    v_mfma_f32_16x16x32_bf16 v[92:95], v[180:183], v[88:91], v[92:95]
    s_waitcnt vmcnt(1)
    v_mfma_f32_16x16x32_bf16 v[92:95], v[184:187], v[84:87], v[92:95]
    s_waitcnt vmcnt(0)
    v_mfma_f32_16x16x32_bf16 v[92:95], v[188:191], v[88:91], v[92:95]
    s_nop 7
    v_cmp_u_f32 vcc, v92, v93
    v_cmp_u_f32 s[68:69], v94, v95
    v_cvt_pk_bf16_f32 v4, v92, v93
    v_cvt_pk_bf16_f32 v5, v94, v95
    s_or_b64 vcc, vcc, s[68:69]
    s_cbranch_scc0 L_fi16_x
    v_max_u32 v3, v128, v129
    v_max3_u32 v3, v3, v130, v131
    v_max3_u32 v3, v3, v132, v133
    v_max3_u32 v3, v3, v134, v135
    v_max3_u32 v3, v3, v136, v137
    v_max3_u32 v3, v3, v138, v139
    v_max3_u32 v3, v3, v140, v141
    v_max3_u32 v3, v3, v142, v143
    v_max3_u32 v3, v3, v144, v145
    v_max3_u32 v3, v3, v146, v147
    v_max3_u32 v3, v3, v148, v149
    v_max3_u32 v3, v3, v150, v151
    v_max3_u32 v3, v3, v152, v153
    v_max3_u32 v3, v3, v154, v155
    v_max3_u32 v3, v3, v156, v157
    v_max3_u32 v3, v3, v158, v159
    v_max3_u32 v3, v3, v160, v161
    v_max3_u32 v3, v3, v162, v163
    v_max3_u32 v3, v3, v164, v165
    v_max3_u32 v3, v3, v166, v167
    v_max3_u32 v3, v3, v168, v169
    v_max3_u32 v3, v3, v170, v171
    v_max3_u32 v3, v3, v172, v173
    v_max3_u32 v3, v3, v174, v175
    v_max3_u32 v3, v3, v176, v177
    v_max3_u32 v3, v3, v178, v179
    v_max3_u32 v3, v3, v180, v181
    v_max3_u32 v3, v3, v182, v183
    v_max3_u32 v3, v3, v184, v185
    v_max3_u32 v3, v3, v186, v187
    v_max3_u32 v3, v3, v188, v189
    v_max3_u32 v3, v3, v190, v191
    v_cmp_eq_u32 vcc, -1, v3
    s_sub_u32 s25, s25, 1
    s_cmp_eq_u32 s25, 0
    s_cbranch_scc1 L_fi16_x
    s_cmp_lg_u64 vcc, 0
    s_cbranch_scc1 L_fi16
L_fi16_x:
    buffer_store_dwordx2 v[4:5], v82, s[20:23], s31 offen
    s_add_u32 s30, s30, 512
    s_add_u32 s31, s31, 128
    s_bitcmp1_b32 s31, 7
    s_cbranch_scc1 L_W_f
L_W_x:
    s_barrier
L_R:
    s_mov_b32 s20, s58
    s_mov_b32 s21, s59
    s_mov_b32 s22, 0x2000
    s_mov_b32 s23, 0x20000
    v_and_b32 v3, 1, v0
    v_lshlrev_b32 v3, 4, v3
    v_mov_b32 v4, 0xffff
    v_lshlrev_b32 v4, v3, v4
    v_bfe_u32 v3, v0, 1, 2
    v_cmp_eq_u32 vcc, 0, v3
    s_nop 1
    v_cndmask_b32 v20, 0, v4, vcc
    v_cmp_eq_u32 vcc, 1, v3
    s_nop 1
    v_cndmask_b32 v21, 0, v4, vcc
    v_cmp_eq_u32 vcc, 2, v3
    s_nop 1
    v_cndmask_b32 v22, 0, v4, vcc
    v_cmp_eq_u32 vcc, 3, v3
    s_nop 1
    v_cndmask_b32 v23, 0, v4, vcc
    v_lshrrev_b32 v3, 4, v0
    v_and_b32 v4, 7, v0
    v_bfe_u32 v7, v0, 3, 1
    v_lshl_add_u32 v5, v3, 3, v4
    v_mul_u32_u24 v6, 320, v7
    v_lshl_add_u32 v5, v5, 3, v6
    s_mul_i32 s24, s3, 1280
    s_add_u32 s24, s24, 135168
    v_add_u32 v24, s24, v5
    v_and_b32 v5, 3, v0
    v_mul_u32_u24 v25, 320, v5
    v_lshl_add_u32 v25, v3, 4, v25
    v_add_u32 v25, 135168, v25
    v_lshlrev_b32 v26, 4, v4
    v_lshl_add_u32 v26, v7, 3, v26
    v_and_b32 v5, 15, v0
    v_lshlrev_b32 v28, 11, v3
    v_lshl_add_u32 v28, v5, 1, v28
    s_and_b32 s24, s74, 7
    s_lshl_b32 s24, s24, 3
    s_bfm_b64 s[44:45], 8, s24
    s_not_b64 s[44:45], s[44:45]
    v_min_u32 v6, 5, v4
    v_lshrrev_b32 v5, 1, v6
    v_and_b32 v8, 1, v3
    v_mad_u32_u24 v5, v8, 3, v5
    v_lshlrev_b32 v31, 12, v5
    v_and_b32 v6, 1, v6
    v_lshl_add_u32 v6, v7, 1, v6
    v_lshl_add_u32 v31, v6, 4, v31
    s_and_b32 s35, s72, 7
    s_lshl_b32 s35, s35, 7
    s_add_u32 s35, s35, 0x1c0000
    s_lshr_b32 s34, s72, 3
    s_mul_i32 s34, s34, 6
    s_mul_i32 s29, s3, 24576
    s_add_u32 s29, s29, s35
    s_mov_b32 s24, 262144
    s_branch L_pd17_in
L_pd17:
    s_sleep 64
L_pd17_in:
    buffer_load_dwordx2 v[8:9], v31, s[12:15], s29 offen sc1
    s_waitcnt vmcnt(0)
    v_max_u32 v3, v8, v9
    v_cmp_eq_u32 vcc, -1, v3
    s_sub_u32 s24, s24, 1
    s_cmp_eq_u32 s24, 0
    s_cbranch_scc1 L_pd17_x
    s_and_b64 exec, exec, vcc
    s_cbranch_scc1 L_pd17
L_pd17_x:
    s_mov_b64 exec, -1
    v_mov_b32 v6, v8
    s_nop 1
    v_max_f32_dpp v6, v6, v6 quad_perm:[1,0,3,2] row_mask:0xf bank_mask:0xf
    s_nop 1
    v_max_f32_dpp v6, v6, v6 quad_perm:[2,3,0,1] row_mask:0xf bank_mask:0xf
    s_nop 1
    v_max_f32_dpp v6, v6, v6 row_half_mirror row_mask:0xf bank_mask:0xf
    v_sub_f32 v8, v8, v6
    v_exp_f32 v8, v8
    v_cmp_gt_u32 vcc, 6, v4
    s_nop 1
    v_cndmask_b32 v8, 0, v8, vcc
    v_mul_f32 v9, v8, v9
    s_nop 1
    v_add_f32_dpp v9, v9, v9 quad_perm:[1,0,3,2] row_mask:0xf bank_mask:0xf
    s_nop 1
    v_add_f32_dpp v9, v9, v9 quad_perm:[2,3,0,1] row_mask:0xf bank_mask:0xf
    s_nop 1
    v_add_f32_dpp v9, v9, v9 row_half_mirror row_mask:0xf bank_mask:0xf
    v_rcp_f32 v9, v9
    s_nop 0
    v_mul_f32 v8, v8, v9
    v_cvt_pk_bf16_f32 v8, v8, v8
    v_lshrrev_b32 v3, 4, v0
    v_mul_u32_u24 v9, 6, v7
    v_sub_u32 v3, v3, v9
    v_lshlrev_b32 v9, 3, v7
    v_add_u32 v5, 0, v3
    v_min_u32 v5, 6, v5
    v_add_u32 v5, v5, v9
    v_lshlrev_b32 v5, 2, v5
    ds_bpermute_b32 v10, v5, v8
    ds_bpermute_b32 v13, v5, v8 offset:64
    v_add_u32 v5, 4, v3
    v_min_u32 v5, 6, v5
    v_add_u32 v5, v5, v9
    v_lshlrev_b32 v5, 2, v5
    ds_bpermute_b32 v11, v5, v8
    ds_bpermute_b32 v14, v5, v8 offset:64
    v_add_u32 v5, 8, v3
    v_min_u32 v5, 6, v5
    v_add_u32 v5, v5, v9
    v_lshlrev_b32 v5, 2, v5
    ds_bpermute_b32 v12, v5, v8
    ds_bpermute_b32 v15, v5, v8 offset:64
    s_waitcnt lgkmcnt(0)
    v_and_b32 v32, v10, v20
    v_and_b32 v33, v10, v21
    v_and_b32 v34, v10, v22
    v_and_b32 v35, v10, v23
    v_and_b32 v36, v11, v20
    v_and_b32 v37, v11, v21
    v_and_b32 v38, v11, v22
    v_and_b32 v39, v11, v23
    v_and_b32 v40, v12, v20
    v_and_b32 v41, v12, v21
    v_and_b32 v42, v12, v22
    v_and_b32 v43, v12, v23
    v_and_b32 v44, v13, v20
    v_and_b32 v45, v13, v21
    v_and_b32 v46, v13, v22
    v_and_b32 v47, v13, v23
    v_and_b32 v48, v14, v20
    v_and_b32 v49, v14, v21
    v_and_b32 v50, v14, v22
    v_and_b32 v51, v14, v23
    v_and_b32 v52, v15, v20
    v_and_b32 v53, v15, v21
    v_and_b32 v54, v15, v22
    v_and_b32 v55, v15, v23
    s_and_b32 s24, s3, 1
    s_lshl_b32 s24, s24, 1
    s_and_b32 s29, s3, 2
    s_lshl_b32 s29, s29, 3
    s_or_b32 s29, s29, s24
    s_and_b32 s24, s26, 13
    s_or_b32 s29, s29, s24
    s_mul_i32 s29, s29, 6144
    s_add_u32 s29, s29, 0x180000
    s_add_u32 s42, s29, 4096
    s_lshr_b32 s24, s74, 3
    s_lshl_b32 s24, s24, 2
    s_add_u32 s24, s24, s3
    s_lshl_b32 s36, s24, 12
    s_add_u32 s36, s36, 0x1de000
    s_and_b32 s37, s74, 7
    s_lshl_b32 s37, s37, 7
    s_add_u32 s37, s37, s36
    s_lshl_b32 s38, s3, 12
    s_andn2_b32 s25, s74, 7
    s_lshl_b32 s25, s25, 4
    s_add_u32 s38, s38, s25
    s_add_u32 s38, s38, 0x1da000
    s_lshl_b32 s39, s24, 5
    s_add_u32 s39, s39, 1024
    s_mov_b32 s30, 0x600000
    s_mov_b32 s31, s30
    s_mov_b32 s40, s30
    s_mov_b32 s41, s30
    s_mov_b32 s33, 0
    s_branch L_P_go
L_P:
    s_mov_b64 s[30:31], s[36:37]
    s_mov_b64 s[40:41], s[38:39]
    s_mov_b32 s33, 447
    s_cmp_lg_u32 s3, 0
    s_cbranch_scc1 L_H_x
    s_lshr_b32 s24, s74, 5
    s_mul_i32 s25, s24, 3
    s_add_u32 s34, s34, s25
    s_lshl_b32 s24, s24, 6
    s_add_u32 s24, s24, s26
    s_lshl_b32 s24, s24, 20
    s_add_u32 s4, s52, s24
    s_addc_u32 s5, s53, 0
    s_mov_b32 s6, 0x100000
    s_mov_b32 s7, 0x20000
    s_add_u32 s8, s4, 0x2000000
    s_addc_u32 s9, s5, 0
    s_mov_b32 s10, s6
    s_mov_b32 s11, 0x20000
    v_lshrrev_b32 v3, 4, v0
    v_mul_u32_u24 v16, 6144, v3
    v_and_b32 v3, 15, v0
    v_lshl_add_u32 v16, v3, 7, v16
    v_lshlrev_b32 v17, 12, v0
    v_mov_b32 v18, 0
    s_mov_b32 s27, 43
    s_mov_b32 s28, 43
    s_mov_b32 s32, 43
    s_mov_b32 s75, 1024
L_H:
    s_sub_u32 s75, s75, 1
    s_cmp_eq_u32 s75, 0
    s_cbranch_scc1 L_H_x
    s_mov_b64 exec, 0xffffff
    buffer_load_dword v18, v17, s[12:15], s35 offen offset:64 sc1
    s_mov_b64 exec, -1
    s_waitcnt vmcnt(0)
    v_max_i32 v19, 0, v18
    s_nop 1
    v_add_u32_dpp v3, v19, v19 row_ror:8 row_mask:0xf bank_mask:0xf
    s_nop 1
    v_add_u32_dpp v3, v3, v3 row_ror:4 row_mask:0xf bank_mask:0xf
    s_nop 1
    v_add_u32_dpp v3, v3, v3 row_ror:2 row_mask:0xf bank_mask:0xf
    s_nop 1
    v_add_u32_dpp v3, v3, v3 row_ror:1 row_mask:0xf bank_mask:0xf
    s_nop 0
    v_readlane_b32 s70, v3, 0
    v_readlane_b32 s24, v3, 16
    s_nop 0
    s_add_u32 s70, s70, s24
    s_add_u32 s24, s34, 0
    s_nop 0
    v_readlane_b32 s24, v19, s24
    s_sub_u32 s25, 43, s27
    s_mul_i32 s25, s25, 17
    s_mul_i32 s64, s24, 24
    s_add_u32 s64, s64, s25
    s_add_u32 s24, s24, 8
    s_cmp_gt_u32 s24, s27
    s_cselect_b32 s64, 0xffff, s64
    s_add_u32 s24, s34, 1
    v_readlane_b32 s24, v19, s24
    s_sub_u32 s25, 43, s28
    s_mul_i32 s25, s25, 17
    s_mul_i32 s65, s24, 24
    s_add_u32 s65, s65, s25
    s_add_u32 s24, s24, 8
    s_cmp_gt_u32 s24, s28
    s_cselect_b32 s65, 0xffff, s65
    s_add_u32 s24, s34, 2
    v_readlane_b32 s24, v19, s24
    s_sub_u32 s25, 43, s32
    s_mul_i32 s25, s25, 17
    s_mul_i32 s66, s24, 24
    s_add_u32 s66, s66, s25
    s_add_u32 s24, s24, 8
    s_cmp_gt_u32 s24, s32
    s_cselect_b32 s66, 0xffff, s66
    s_min_u32 s71, s64, s65
    s_min_u32 s71, s71, s66
    s_cmp_eq_u32 s71, 0xffff
    s_cbranch_scc1 L_H_x
    s_add_u32 s24, s71, 36
    s_cmp_lt_i32 s24, s70
    s_cbranch_scc1 L_H_go
    s_sleep 4
    s_branch L_H
L_H_go:
    s_cmp_lg_u32 s71, s64
    s_cbranch_scc1 L_H_n0
    s_sub_u32 s27, s27, 2
    s_mul_i32 s24, s27, 24576
    s_add_u32 s24, s24, 0
    s_branch L_H_ld
L_H_n0:
    s_cmp_lg_u32 s71, s65
    s_cbranch_scc1 L_H_n1
    s_sub_u32 s28, s28, 2
    s_mul_i32 s24, s28, 24576
    s_add_u32 s24, s24, 2048
    s_branch L_H_ld
L_H_n1:
    s_sub_u32 s32, s32, 2
    s_mul_i32 s24, s32, 24576
    s_add_u32 s24, s24, 4096
L_H_ld:
    buffer_load_dword v5, v16, s[4:7], s24 offen
    buffer_load_dword v5, v16, s[8:11], s24 offen
    s_add_u32 s24, s24, 24576
    buffer_load_dword v5, v16, s[4:7], s24 offen
    buffer_load_dword v5, v16, s[8:11], s24 offen
    s_branch L_H
L_H_x:
    s_barrier
    s_mov_b32 s24, 262144
L_pd18:
    buffer_load_dwordx4 v[56:59], v2, s[12:15], s29 offen offset:0 sc1
    buffer_load_dwordx4 v[60:63], v2, s[12:15], s29 offen offset:1024 sc1
    buffer_load_dwordx4 v[64:67], v2, s[12:15], s29 offen offset:2048 sc1
    buffer_load_dwordx4 v[68:71], v2, s[12:15], s29 offen offset:3072 sc1
    buffer_load_dwordx4 v[72:75], v2, s[12:15], s42 offen offset:0 sc1
    buffer_load_dwordx4 v[76:79], v2, s[12:15], s42 offen offset:1024 sc1
    s_waitcnt vmcnt(0)
    v_max_u32 v3, v56, v57
    v_max3_u32 v3, v3, v58, v59
    v_max3_u32 v3, v3, v60, v61
    v_max3_u32 v3, v3, v62, v63
    v_max3_u32 v3, v3, v64, v65
    v_max3_u32 v3, v3, v66, v67
    v_max3_u32 v3, v3, v68, v69
    v_max3_u32 v3, v3, v70, v71
    v_max3_u32 v3, v3, v72, v73
    v_max3_u32 v3, v3, v74, v75
    v_max3_u32 v3, v3, v76, v77
    v_max3_u32 v3, v3, v78, v79
    v_cmp_eq_u32 vcc, -1, v3
    s_sub_u32 s24, s24, 1
    s_cmp_eq_u32 s24, 0
    s_cbranch_scc1 L_pd18_x
    s_and_b64 exec, exec, vcc
    s_cbranch_scc1 L_pd18
L_pd18_x:
    s_mov_b64 exec, -1
L_P_go:
    v_mfma_f32_16x16x32_bf16 v[12:15], v[56:59], v[32:35], 0
    v_mfma_f32_16x16x32_bf16 v[16:19], v[68:71], v[44:47], 0
    v_mfma_f32_16x16x32_bf16 v[12:15], v[60:63], v[36:39], v[12:15]
    v_mfma_f32_16x16x32_bf16 v[16:19], v[72:75], v[48:51], v[16:19]
    v_mfma_f32_16x16x32_bf16 v[12:15], v[64:67], v[40:43], v[12:15]
    v_mfma_f32_16x16x32_bf16 v[16:19], v[76:79], v[52:55], v[16:19]
    s_barrier
    s_mov_b64 exec, 1
    v_mov_b32 v83, 64
    buffer_atomic_add v83, off, s[12:15], s40 sc0
    s_mov_b64 exec, -1
    s_nop 1
    v_cvt_pk_bf16_f32 v4, v12, v13
    v_cvt_pk_bf16_f32 v5, v14, v15
    ds_write_b64 v24, v[4:5]
    v_cvt_pk_bf16_f32 v6, v16, v17
    v_cvt_pk_bf16_f32 v7, v18, v19
    ds_write_b64 v24, v[6:7] offset:640
    s_waitcnt lgkmcnt(0)
    s_barrier
    ds_read_b128 v[128:131], v25 offset:0
    ds_read_b128 v[132:135], v25 offset:64
    ds_read_b128 v[136:139], v25 offset:128
    ds_read_b128 v[140:143], v25 offset:192
    ds_read_b128 v[144:147], v25 offset:1280
    ds_read_b128 v[148:151], v25 offset:1344
    ds_read_b128 v[152:155], v25 offset:1408
    ds_read_b128 v[156:159], v25 offset:1472
    ds_read_b128 v[160:163], v25 offset:2560
    s_waitcnt lgkmcnt(8)
    v_mfma_f32_16x16x32_bf16 v[12:15], v[128:131], a[128:131], 0
    ds_read_b128 v[164:167], v25 offset:2624
    s_waitcnt lgkmcnt(8)
    v_mfma_f32_16x16x32_bf16 v[12:15], v[132:135], a[132:135], v[12:15]
    ds_read_b128 v[168:171], v25 offset:2688
    s_waitcnt lgkmcnt(8)
    v_mfma_f32_16x16x32_bf16 v[12:15], v[136:139], a[136:139], v[12:15]
    ds_read_b128 v[172:175], v25 offset:2752
    s_waitcnt lgkmcnt(8)
    v_mfma_f32_16x16x32_bf16 v[12:15], v[140:143], a[140:143], v[12:15]
    ds_read_b128 v[176:179], v25 offset:3840
    s_waitcnt lgkmcnt(8)
    v_mfma_f32_16x16x32_bf16 v[12:15], v[144:147], a[144:147], v[12:15]
    ds_read_b128 v[180:183], v25 offset:3904
    s_waitcnt lgkmcnt(8)
    v_mfma_f32_16x16x32_bf16 v[12:15], v[148:151], a[148:151], v[12:15]
    ds_read_b128 v[184:187], v25 offset:3968
    s_waitcnt lgkmcnt(8)
    v_mfma_f32_16x16x32_bf16 v[12:15], v[152:155], a[152:155], v[12:15]
    ds_read_b128 v[188:191], v25 offset:4032
    s_waitcnt lgkmcnt(8)
    v_mfma_f32_16x16x32_bf16 v[12:15], v[156:159], a[156:159], v[12:15]
    s_waitcnt lgkmcnt(7)
    v_mfma_f32_16x16x32_bf16 v[12:15], v[160:163], a[160:163], v[12:15]
    s_waitcnt lgkmcnt(6)
    v_mfma_f32_16x16x32_bf16 v[12:15], v[164:167], a[164:167], v[12:15]
    s_waitcnt lgkmcnt(5)
    v_mfma_f32_16x16x32_bf16 v[12:15], v[168:171], a[168:171], v[12:15]
    s_waitcnt lgkmcnt(4)
    v_mfma_f32_16x16x32_bf16 v[12:15], v[172:175], a[172:175], v[12:15]
    s_waitcnt lgkmcnt(3)
    v_mfma_f32_16x16x32_bf16 v[12:15], v[176:179], a[176:179], v[12:15]
    s_waitcnt lgkmcnt(2)
    v_mfma_f32_16x16x32_bf16 v[12:15], v[180:183], a[180:183], v[12:15]
    s_waitcnt lgkmcnt(1)
    v_mfma_f32_16x16x32_bf16 v[12:15], v[184:187], a[184:187], v[12:15]
    s_waitcnt lgkmcnt(0)
    v_mfma_f32_16x16x32_bf16 v[12:15], v[188:191], a[188:191], v[12:15]
    s_nop 7
    v_cvt_pk_bf16_f32 v4, v12, v13
    v_cvt_pk_bf16_f32 v5, v14, v15
    s_mov_b64 exec, 0xffff
    buffer_store_dwordx2 v[4:5], v26, s[12:15], s31 offen sc1
    s_mov_b64 exec, -1
    v_mov_b32 v16, v4
    v_mov_b32 v17, v5
    v_mov_b32 v18, v4
    v_mov_b32 v19, v5
    v_mov_b32_dpp v16, v4 row_ror:8 row_mask:0xf bank_mask:0xc
    v_mov_b32_dpp v17, v5 row_ror:8 row_mask:0xf bank_mask:0xc
    v_mov_b32_dpp v18, v4 row_ror:8 row_mask:0xf bank_mask:0x3
    v_mov_b32_dpp v19, v5 row_ror:8 row_mask:0xf bank_mask:0x3
    s_waitcnt vmcnt(1)
    v_readfirstlane_b32 s24, v83
    s_nop 0
    s_cmp_eq_u32 s24, s33
    s_cbranch_scc1 L_P_f
    s_waitcnt vmcnt(0)
    v_readfirstlane_b32 s24, v83
    s_nop 0
    s_cmp_lg_u32 s24, s33
    s_cbranch_scc1 L_P_n
L_P_f:
    s_mov_b64 exec, s[44:45]
    s_mov_b32 s24, 262144
L_pd19:
    buffer_load_dwordx4 v[16:19], v2, s[12:15], s30 offen sc1
    s_waitcnt vmcnt(0)
    v_max_u32 v3, v16, v17
    v_max3_u32 v3, v3, v18, v19
    v_cmp_eq_u32 vcc, -1, v3
    s_sub_u32 s24, s24, 1
    s_cmp_eq_u32 s24, 0
    s_cbranch_scc1 L_pd19_x
    s_and_b64 exec, exec, vcc
    s_cbranch_scc1 L_pd19
L_pd19_x:
    s_mov_b64 exec, -1
    v_lshlrev_b32 v56, 16, v16
    v_and_b32 v57, 0xffff0000, v16
    v_lshlrev_b32 v58, 16, v17
    v_and_b32 v59, 0xffff0000, v17
    v_lshlrev_b32 v60, 16, v18
    v_and_b32 v61, 0xffff0000, v18
    v_lshlrev_b32 v62, 16, v19
    v_and_b32 v63, 0xffff0000, v19
    v_permlane32_swap_b32 v56, v58
    v_permlane32_swap_b32 v57, v59
    v_permlane32_swap_b32 v60, v62
    v_permlane32_swap_b32 v61, v63
    v_add_f32 v56, v56, v58
    v_add_f32 v57, v57, v59
    v_add_f32 v60, v60, v62
    v_add_f32 v61, v61, v63
    v_permlane16_swap_b32 v56, v57
    s_nop 0
    v_permlane16_swap_b32 v60, v61
    v_add_f32 v56, v56, v57
    v_add_f32 v60, v60, v61
    s_nop 0
    v_add_f32_dpp v4, v56, v56 row_ror:8 row_mask:0xf bank_mask:0x3
    s_nop 1
    v_add_f32_dpp v4, v60, v60 row_ror:8 row_mask:0xf bank_mask:0xc
    v_cvt_pk_bf16_f32 v4, v4, v4
    buffer_store_short v4, v28, s[20:23], s41 offen
L_P_n:
    s_cmp_lg_u32 s33, 0
    s_cbranch_scc1 L_P_x
    s_barrier
    s_branch L_P
L_P_x:
L_end:
    s_endpgm
L_C:
    s_cmp_lg_u32 s3, 0
    s_cbranch_scc1 L_C_q
    v_lshrrev_b32 v3, 4, v0
    v_and_b32 v4, 3, v0
    v_lshlrev_b32 v5, 6, v3
    v_lshl_add_u32 v5, v4, 4, v5
    v_bfe_u32 v4, v0, 2, 2
    v_lshl_add_u32 v5, v4, 8, v5
    s_lshl_b32 s24, s26, 12
    s_add_u32 s24, s24, 0x140000
    buffer_store_dwordx4 v[8:11], v5, s[12:15], s24 offen sc1
L_C_q:
    s_waitcnt vmcnt(0)
    s_barrier
    s_cmp_lg_u32 s3, 0
    s_cbranch_scc1 L_sig20
    s_mov_b64 exec, 1
    v_mov_b32 v3, 1
    v_mov_b32 v4, 1
    buffer_atomic_add v4, off, s[16:19], 0 offset:128
    buffer_atomic_add v3, off, s[16:19], 0 offset:0 sc0
    s_waitcnt vmcnt(0)
    v_readfirstlane_b32 s24, v3
    s_mov_b64 exec, -1
    s_and_b32 s24, s24, 63
    s_cmp_lg_u32 s24, 63
    s_cbranch_scc1 L_sig20
    v_lshlrev_b32 v4, 7, v0
    v_mov_b32 v3, 1
    s_mov_b32 s24, 0x170000
    buffer_store_dword v3, v4, s[12:15], s24 offen offset:0 sc1
L_sig20:
    s_mov_b32 s8, s56
    s_mov_b32 s9, s57
    s_mov_b32 s10, 0x400000
    s_mov_b32 s11, 0x20000
    s_and_b32 s24, s3, 1
    s_lshl_b32 s24, s24, 1
    s_and_b32 s25, s3, 2
    s_lshl_b32 s25, s25, 3
    s_or_b32 s25, s25, s24
    s_and_b32 s24, s26, 13
    s_or_b32 s25, s25, s24
    s_lshl_b32 s25, s25, 17
    s_lshr_b32 s24, s74, 3
    s_lshl_b32 s24, s24, 7
    s_add_u32 s24, s24, s25
    v_lshrrev_b32 v3, 4, v0
    v_lshlrev_b32 v3, 15, v3
    v_and_b32 v4, 8, v0
    v_lshl_add_u32 v3, v4, 10, v3
    v_and_b32 v4, 0x70, v2
    v_add_u32 v3, v3, v4
    s_mul_i32 m0, s3, 16896
    s_nop 0
    buffer_load_dwordx4 v3, s[8:11], s24 offen nt lds
    s_add_u32 m0, m0, 1056
    s_add_u32 s24, s24, 2048
    buffer_load_dwordx4 v3, s[8:11], s24 offen nt lds
    s_add_u32 m0, m0, 1056
    s_add_u32 s24, s24, 2048
    buffer_load_dwordx4 v3, s[8:11], s24 offen nt lds
    s_add_u32 m0, m0, 1056
    s_add_u32 s24, s24, 2048
    buffer_load_dwordx4 v3, s[8:11], s24 offen nt lds
    s_add_u32 m0, m0, 1056
    s_add_u32 s24, s24, 10240
    buffer_load_dwordx4 v3, s[8:11], s24 offen nt lds
    s_add_u32 m0, m0, 1056
    s_add_u32 s24, s24, 2048
    buffer_load_dwordx4 v3, s[8:11], s24 offen nt lds
    s_add_u32 m0, m0, 1056
    s_add_u32 s24, s24, 2048
    buffer_load_dwordx4 v3, s[8:11], s24 offen nt lds
    s_add_u32 m0, m0, 1056
    s_add_u32 s24, s24, 2048
    buffer_load_dwordx4 v3, s[8:11], s24 offen nt lds
    s_add_u32 m0, m0, 1056
    s_add_u32 s24, s24, -21504
    buffer_load_dwordx4 v3, s[8:11], s24 offen nt lds
    s_add_u32 m0, m0, 1056
    s_add_u32 s24, s24, 2048
    buffer_load_dwordx4 v3, s[8:11], s24 offen nt lds
    s_add_u32 m0, m0, 1056
    s_add_u32 s24, s24, 2048
    buffer_load_dwordx4 v3, s[8:11], s24 offen nt lds
    s_add_u32 m0, m0, 1056
    s_add_u32 s24, s24, 2048
    buffer_load_dwordx4 v3, s[8:11], s24 offen nt lds
    s_add_u32 m0, m0, 1056
    s_add_u32 s24, s24, 10240
    buffer_load_dwordx4 v3, s[8:11], s24 offen nt lds
    s_add_u32 m0, m0, 1056
    s_add_u32 s24, s24, 2048
    buffer_load_dwordx4 v3, s[8:11], s24 offen nt lds
    s_add_u32 m0, m0, 1056
    s_add_u32 s24, s24, 2048
    buffer_load_dwordx4 v3, s[8:11], s24 offen nt lds
    s_add_u32 m0, m0, 1056
    s_add_u32 s24, s24, 2048
    buffer_load_dwordx4 v3, s[8:11], s24 offen nt lds
    s_waitcnt vmcnt(0)
    s_barrier
    v_lshrrev_b32 v3, 2, v0
    v_mul_u32_u24 v3, 1056, v3
    v_and_b32 v4, 3, v0
    v_lshl_add_u32 v3, v4, 3, v3
    s_lshl_b32 s24, s3, 5
    v_add_u32 v3, s24, v3
    ds_read_b64_tr_b16 a[128:129], v3 offset:0
    ds_read_b64_tr_b16 a[130:131], v3 offset:128
    ds_read_b64_tr_b16 a[132:133], v3 offset:256
    ds_read_b64_tr_b16 a[134:135], v3 offset:384
    ds_read_b64_tr_b16 a[136:137], v3 offset:512
    ds_read_b64_tr_b16 a[138:139], v3 offset:640
    ds_read_b64_tr_b16 a[140:141], v3 offset:768
    ds_read_b64_tr_b16 a[142:143], v3 offset:896
    ds_read_b64_tr_b16 a[144:145], v3 offset:16896
    ds_read_b64_tr_b16 a[146:147], v3 offset:17024
    ds_read_b64_tr_b16 a[148:149], v3 offset:17152
    ds_read_b64_tr_b16 a[150:151], v3 offset:17280
    ds_read_b64_tr_b16 a[152:153], v3 offset:17408
    ds_read_b64_tr_b16 a[154:155], v3 offset:17536
    ds_read_b64_tr_b16 a[156:157], v3 offset:17664
    ds_read_b64_tr_b16 a[158:159], v3 offset:17792
    ds_read_b64_tr_b16 a[160:161], v3 offset:33792
    ds_read_b64_tr_b16 a[162:163], v3 offset:33920
    ds_read_b64_tr_b16 a[164:165], v3 offset:34048
    ds_read_b64_tr_b16 a[166:167], v3 offset:34176
    ds_read_b64_tr_b16 a[168:169], v3 offset:34304
    ds_read_b64_tr_b16 a[170:171], v3 offset:34432
    ds_read_b64_tr_b16 a[172:173], v3 offset:34560
    ds_read_b64_tr_b16 a[174:175], v3 offset:34688
    ds_read_b64_tr_b16 a[176:177], v3 offset:50688
    ds_read_b64_tr_b16 a[178:179], v3 offset:50816
    ds_read_b64_tr_b16 a[180:181], v3 offset:50944
    ds_read_b64_tr_b16 a[182:183], v3 offset:51072
    ds_read_b64_tr_b16 a[184:185], v3 offset:51200
    ds_read_b64_tr_b16 a[186:187], v3 offset:51328
    ds_read_b64_tr_b16 a[188:189], v3 offset:51456
    ds_read_b64_tr_b16 a[190:191], v3 offset:51584
    s_and_b32 s70, s72, 3
    s_lshr_b32 s71, s72, 4
    s_bfe_u32 s24, s72, 0x10002
    s_lshl_b32 s24, s24, 1
    s_add_u32 s71, s71, s24
    s_bfe_u32 s75, s72, 0x10003
    s_lshl_b32 s30, s71, 22
    s_add_u32 s4, s38, s30
    s_addc_u32 s5, s39, 0
    s_mov_b32 s6, 0x400000
    s_mov_b32 s7, 0x20000
    s_mul_i32 s32, s3, 65536
    s_lshl_b32 s24, s70, 10
    s_add_u32 s32, s32, s24
    s_mul_i32 s34, s3, 16896
    s_waitcnt lgkmcnt(0)
    s_barrier
    s_mov_b32 m0, s34
    s_nop 0
    buffer_load_dwordx4 v2, s[4:7], s32 offen lds
    s_add_u32 m0, m0, 1056
    s_add_u32 s32, s32, 4096
    buffer_load_dwordx4 v2, s[4:7], s32 offen lds
    s_add_u32 m0, m0, 1056
    s_add_u32 s32, s32, 4096
    buffer_load_dwordx4 v2, s[4:7], s32 offen lds
    s_add_u32 m0, m0, 1056
    s_add_u32 s32, s32, 4096
    buffer_load_dwordx4 v2, s[4:7], s32 offen lds
    s_add_u32 m0, m0, 1056
    s_add_u32 s32, s32, 4096
    buffer_load_dwordx4 v2, s[4:7], s32 offen lds
    s_add_u32 m0, m0, 1056
    s_add_u32 s32, s32, 4096
    buffer_load_dwordx4 v2, s[4:7], s32 offen lds
    s_add_u32 m0, m0, 1056
    s_add_u32 s32, s32, 4096
    buffer_load_dwordx4 v2, s[4:7], s32 offen lds
    s_add_u32 m0, m0, 1056
    s_add_u32 s32, s32, 4096
    buffer_load_dwordx4 v2, s[4:7], s32 offen lds
    s_add_u32 m0, m0, 1056
    s_add_u32 s32, s32, 4096
    buffer_load_dwordx4 v2, s[4:7], s32 offen lds
    s_add_u32 m0, m0, 1056
    s_add_u32 s32, s32, 4096
    buffer_load_dwordx4 v2, s[4:7], s32 offen lds
    s_add_u32 m0, m0, 1056
    s_add_u32 s32, s32, 4096
    buffer_load_dwordx4 v2, s[4:7], s32 offen lds
    s_add_u32 m0, m0, 1056
    s_add_u32 s32, s32, 4096
    buffer_load_dwordx4 v2, s[4:7], s32 offen lds
    s_add_u32 m0, m0, 1056
    s_add_u32 s32, s32, 4096
    buffer_load_dwordx4 v2, s[4:7], s32 offen lds
    s_add_u32 m0, m0, 1056
    s_add_u32 s32, s32, 4096
    buffer_load_dwordx4 v2, s[4:7], s32 offen lds
    s_add_u32 m0, m0, 1056
    s_add_u32 s32, s32, 4096
    buffer_load_dwordx4 v2, s[4:7], s32 offen lds
    s_add_u32 m0, m0, 1056
    s_add_u32 s32, s32, 4096
    buffer_load_dwordx4 v2, s[4:7], s32 offen lds
    s_add_u32 m0, m0, 1056
    s_add_u32 s32, s32, 200704
    s_lshr_b32 s28, s3, 1
    s_and_b32 s29, s3, 1
    v_and_b32 v3, 15, v0
    v_lshrrev_b32 v4, 4, v0
    v_mul_u32_u24 v19, 1056, v3
    v_lshl_add_u32 v19, v4, 4, v19
    v_lshrrev_b32 v5, 2, v0
    v_mul_u32_u24 v20, 1056, v5
    v_and_b32 v5, 3, v0
    v_lshl_add_u32 v20, v5, 3, v20
    s_lshl_b32 s24, s29, 9
    v_add_u32 v20, s24, v20
    v_and_b32 v3, 15, v0
    v_mul_u32_u24 v18, 1056, v3
    v_lshl_add_u32 v18, v4, 4, v18
    v_add_u32 v18, 101376, v18
    s_mul_i32 s24, s28, 33792
    v_add_u32 v19, s24, v19
    v_add_u32 v20, s24, v20
    v_mov_b32 v128, 0
    v_mov_b32 v129, 0
    v_mov_b32 v130, 0
    v_mov_b32 v131, 0
    v_mov_b32 v132, 0
    v_mov_b32 v133, 0
    v_mov_b32 v134, 0
    v_mov_b32 v135, 0
    v_mov_b32 v136, 0
    v_mov_b32 v137, 0
    v_mov_b32 v138, 0
    v_mov_b32 v139, 0
    v_mov_b32 v140, 0
    v_mov_b32 v141, 0
    v_mov_b32 v142, 0
    v_mov_b32 v143, 0
    v_mov_b32 v144, 0
    v_mov_b32 v145, 0
    v_mov_b32 v146, 0
    v_mov_b32 v147, 0
    v_mov_b32 v148, 0
    v_mov_b32 v149, 0
    v_mov_b32 v150, 0
    v_mov_b32 v151, 0
    v_mov_b32 v152, 0
    v_mov_b32 v153, 0
    v_mov_b32 v154, 0
    v_mov_b32 v155, 0
    v_mov_b32 v156, 0
    v_mov_b32 v157, 0
    v_mov_b32 v158, 0
    v_mov_b32 v159, 0
    v_mov_b32 v160, 0
    v_mov_b32 v161, 0
    v_mov_b32 v162, 0
    v_mov_b32 v163, 0
    v_mov_b32 v164, 0
    v_mov_b32 v165, 0
    v_mov_b32 v166, 0
    v_mov_b32 v167, 0
    v_mov_b32 v168, 0
    v_mov_b32 v169, 0
    v_mov_b32 v170, 0
    v_mov_b32 v171, 0
    v_mov_b32 v172, 0
    v_mov_b32 v173, 0
    v_mov_b32 v174, 0
    v_mov_b32 v175, 0
    v_mov_b32 v176, 0
    v_mov_b32 v177, 0
    v_mov_b32 v178, 0
    v_mov_b32 v179, 0
    v_mov_b32 v180, 0
    v_mov_b32 v181, 0
    v_mov_b32 v182, 0
    v_mov_b32 v183, 0
    v_mov_b32 v184, 0
    v_mov_b32 v185, 0
    v_mov_b32 v186, 0
    v_mov_b32 v187, 0
    v_mov_b32 v188, 0
    v_mov_b32 v189, 0
    v_mov_b32 v190, 0
    v_mov_b32 v191, 0
    v_mov_b32 v22, 0xff800000
    v_mov_b32 v23, 0
    s_cmp_lg_u32 s3, 0
    s_cbranch_scc1 L_awx21
    s_mov_b32 s24, 262144
    s_mov_b64 exec, 1
L_aw22:
    buffer_load_dword v1, off, s[12:15], s73 offset:0 sc1
    s_waitcnt vmcnt(0)
    v_readfirstlane_b32 s25, v1
    s_nop 0
    s_cmp_eq_u32 s25, 1
    s_cbranch_scc1 L_awx21
    s_sleep 4
    s_sub_u32 s24, s24, 1
    s_cmp_lg_u32 s24, 0
    s_cbranch_scc1 L_aw22
L_awx21:
    s_mov_b64 exec, -1
    s_barrier
    s_lshl_b32 s24, s71, 17
    s_mul_i32 s25, s3, 16384
    s_add_u32 s24, s24, s25
    s_add_u32 s24, s24, 0x0
    s_mul_i32 s25, s75, 65536
    s_add_u32 s24, s24, s25
    buffer_load_dwordx4 v[32:35], v2, s[12:15], s24 offen sc1
    s_add_u32 s24, s24, 4096
    buffer_load_dwordx4 v[36:39], v2, s[12:15], s24 offen sc1
    s_add_u32 s24, s24, 4096
    buffer_load_dwordx4 v[40:43], v2, s[12:15], s24 offen sc1
    s_add_u32 s24, s24, 4096
    buffer_load_dwordx4 v[44:47], v2, s[12:15], s24 offen sc1
    s_add_u32 s24, s24, 4096
    s_mul_i32 s24, s3, 4224
    s_add_u32 s24, s24, 101376
    v_add_u32 v3, s24, v2
    s_waitcnt vmcnt(3)
    ds_write_b128 v3, v[32:35] offset:0
    s_waitcnt vmcnt(2)
    ds_write_b128 v3, v[36:39] offset:1056
    s_waitcnt vmcnt(1)
    ds_write_b128 v3, v[40:43] offset:2112
    s_waitcnt vmcnt(0)
    ds_write_b128 v3, v[44:47] offset:3168
    s_waitcnt lgkmcnt(0)
    s_barrier
    ds_read_b128 a[0:3], v18 offset:0
    ds_read_b128 a[4:7], v18 offset:64
    ds_read_b128 a[8:11], v18 offset:128
    ds_read_b128 a[12:15], v18 offset:192
    ds_read_b128 a[16:19], v18 offset:256
    ds_read_b128 a[20:23], v18 offset:320
    ds_read_b128 a[24:27], v18 offset:384
    ds_read_b128 a[28:31], v18 offset:448
    ds_read_b128 a[32:35], v18 offset:512
    ds_read_b128 a[36:39], v18 offset:576
    ds_read_b128 a[40:43], v18 offset:640
    ds_read_b128 a[44:47], v18 offset:704
    ds_read_b128 a[48:51], v18 offset:768
    ds_read_b128 a[52:55], v18 offset:832
    ds_read_b128 a[56:59], v18 offset:896
    ds_read_b128 a[60:63], v18 offset:960
    s_cmp_lg_u32 s3, 0
    s_cbranch_scc1 L_xi23
    s_and_b32 s24, s74, 7
    s_lshl_b32 s24, s24, 5
    s_lshr_b32 s25, s74, 3
    s_add_u32 s24, s24, s25
    s_lshl_b32 s24, s24, 2
    s_add_u32 s24, s24, 0x1d8000
    s_getreg_b32 s25, hwreg(HW_REG_XCC_ID, 0, 4)
    s_mov_b64 exec, 1
    v_mov_b32 v3, s25
    buffer_store_dword v3, off, s[12:15], s24 sc1
    s_mov_b64 exec, -1
L_xi23:
    s_mov_b32 s27, 0
    s_mov_b32 s33, 67584
    s_mov_b32 s35, 0
    s_waitcnt lgkmcnt(0)
L_CT:
    s_waitcnt vmcnt(0)
    s_barrier
    v_add_u32 v24, s35, v19
    v_add_u32 v25, s35, v20
    ds_read_b128 v[32:35], v24 offset:0
    ds_read_b128 v[36:39], v24 offset:16896
    ds_read_b128 v[40:43], v24 offset:64
    ds_read_b128 v[44:47], v24 offset:16960
    ds_read_b128 v[48:51], v24 offset:128
    ds_read_b128 v[52:55], v24 offset:17024
    ds_read_b128 v[56:59], v24 offset:192
    s_add_u32 m0, s33, s34
    s_mov_b32 s33, s35
    s_add_u32 s35, s35, 67584
    s_cmp_eq_u32 s35, 135168
    s_cselect_b32 s35, 0, s35
    s_waitcnt lgkmcnt(6)
    v_mfma_f32_16x16x32_bf16 v[64:67], v[32:35], a[0:3], 0
    ds_read_b128 v[60:63], v24 offset:17088
    buffer_load_dwordx4 v2, s[4:7], s32 offen lds
    s_add_u32 m0, m0, 1056
    s_add_u32 s32, s32, 4096
    s_waitcnt lgkmcnt(6)
    v_mfma_f32_16x16x32_bf16 v[68:71], v[36:39], a[0:3], 0
    ds_read_b128 v[32:35], v24 offset:256
    s_waitcnt lgkmcnt(6)
    v_mfma_f32_16x16x32_bf16 v[64:67], v[40:43], a[4:7], v[64:67]
    ds_read_b128 v[36:39], v24 offset:17152
    buffer_load_dwordx4 v2, s[4:7], s32 offen lds
    s_add_u32 m0, m0, 1056
    s_add_u32 s32, s32, 4096
    s_waitcnt lgkmcnt(6)
    v_mfma_f32_16x16x32_bf16 v[68:71], v[44:47], a[4:7], v[68:71]
    ds_read_b128 v[40:43], v24 offset:320
    s_waitcnt lgkmcnt(6)
    v_mfma_f32_16x16x32_bf16 v[64:67], v[48:51], a[8:11], v[64:67]
    ds_read_b128 v[44:47], v24 offset:17216
    buffer_load_dwordx4 v2, s[4:7], s32 offen lds
    s_add_u32 m0, m0, 1056
    s_add_u32 s32, s32, 4096
    s_waitcnt lgkmcnt(6)
    v_mfma_f32_16x16x32_bf16 v[68:71], v[52:55], a[8:11], v[68:71]
    ds_read_b128 v[48:51], v24 offset:384
    s_waitcnt lgkmcnt(6)
    v_mfma_f32_16x16x32_bf16 v[64:67], v[56:59], a[12:15], v[64:67]
    ds_read_b128 v[52:55], v24 offset:17280
    buffer_load_dwordx4 v2, s[4:7], s32 offen lds
    s_add_u32 m0, m0, 1056
    s_add_u32 s32, s32, 4096
    s_waitcnt lgkmcnt(6)
    v_mfma_f32_16x16x32_bf16 v[68:71], v[60:63], a[12:15], v[68:71]
    ds_read_b128 v[56:59], v24 offset:448
    s_waitcnt lgkmcnt(6)
    v_mfma_f32_16x16x32_bf16 v[64:67], v[32:35], a[16:19], v[64:67]
    ds_read_b128 v[60:63], v24 offset:17344
    buffer_load_dwordx4 v2, s[4:7], s32 offen lds
    s_add_u32 m0, m0, 1056
    s_add_u32 s32, s32, 4096
    s_waitcnt lgkmcnt(6)
    v_mfma_f32_16x16x32_bf16 v[68:71], v[36:39], a[16:19], v[68:71]
    ds_read_b128 v[32:35], v24 offset:512
    s_waitcnt lgkmcnt(6)
    v_mfma_f32_16x16x32_bf16 v[64:67], v[40:43], a[20:23], v[64:67]
    ds_read_b128 v[36:39], v24 offset:17408
    buffer_load_dwordx4 v2, s[4:7], s32 offen lds
    s_add_u32 m0, m0, 1056
    s_add_u32 s32, s32, 4096
    s_waitcnt lgkmcnt(6)
    v_mfma_f32_16x16x32_bf16 v[68:71], v[44:47], a[20:23], v[68:71]
    ds_read_b128 v[40:43], v24 offset:576
    s_waitcnt lgkmcnt(6)
    v_mfma_f32_16x16x32_bf16 v[64:67], v[48:51], a[24:27], v[64:67]
    ds_read_b128 v[44:47], v24 offset:17472
    buffer_load_dwordx4 v2, s[4:7], s32 offen lds
    s_add_u32 m0, m0, 1056
    s_add_u32 s32, s32, 4096
    s_waitcnt lgkmcnt(6)
    v_mfma_f32_16x16x32_bf16 v[68:71], v[52:55], a[24:27], v[68:71]
    ds_read_b128 v[48:51], v24 offset:640
    s_waitcnt lgkmcnt(6)
    v_mfma_f32_16x16x32_bf16 v[64:67], v[56:59], a[28:31], v[64:67]
    ds_read_b128 v[52:55], v24 offset:17536
    buffer_load_dwordx4 v2, s[4:7], s32 offen lds
    s_add_u32 m0, m0, 1056
    s_add_u32 s32, s32, 4096
    s_waitcnt lgkmcnt(6)
    v_mfma_f32_16x16x32_bf16 v[68:71], v[60:63], a[28:31], v[68:71]
    ds_read_b128 v[56:59], v24 offset:704
    s_waitcnt lgkmcnt(6)
    v_mfma_f32_16x16x32_bf16 v[64:67], v[32:35], a[32:35], v[64:67]
    ds_read_b128 v[60:63], v24 offset:17600
    buffer_load_dwordx4 v2, s[4:7], s32 offen lds
    s_add_u32 m0, m0, 1056
    s_add_u32 s32, s32, 4096
    s_waitcnt lgkmcnt(6)
    v_mfma_f32_16x16x32_bf16 v[68:71], v[36:39], a[32:35], v[68:71]
    ds_read_b128 v[32:35], v24 offset:768
    s_waitcnt lgkmcnt(6)
    v_mfma_f32_16x16x32_bf16 v[64:67], v[40:43], a[36:39], v[64:67]
    ds_read_b128 v[36:39], v24 offset:17664
    buffer_load_dwordx4 v2, s[4:7], s32 offen lds
    s_add_u32 m0, m0, 1056
    s_add_u32 s32, s32, 4096
    s_waitcnt lgkmcnt(6)
    v_mfma_f32_16x16x32_bf16 v[68:71], v[44:47], a[36:39], v[68:71]
    ds_read_b128 v[40:43], v24 offset:832
    s_waitcnt lgkmcnt(6)
    v_mfma_f32_16x16x32_bf16 v[64:67], v[48:51], a[40:43], v[64:67]
    ds_read_b128 v[44:47], v24 offset:17728
    buffer_load_dwordx4 v2, s[4:7], s32 offen lds
    s_add_u32 m0, m0, 1056
    s_add_u32 s32, s32, 4096
    s_waitcnt lgkmcnt(6)
    v_mfma_f32_16x16x32_bf16 v[68:71], v[52:55], a[40:43], v[68:71]
    ds_read_b128 v[48:51], v24 offset:896
    s_waitcnt lgkmcnt(6)
    v_mfma_f32_16x16x32_bf16 v[64:67], v[56:59], a[44:47], v[64:67]
    ds_read_b128 v[52:55], v24 offset:17792
    buffer_load_dwordx4 v2, s[4:7], s32 offen lds
    s_add_u32 m0, m0, 1056
    s_add_u32 s32, s32, 4096
    s_waitcnt lgkmcnt(6)
    v_mfma_f32_16x16x32_bf16 v[68:71], v[60:63], a[44:47], v[68:71]
    ds_read_b128 v[56:59], v24 offset:960
    s_waitcnt lgkmcnt(6)
    v_mfma_f32_16x16x32_bf16 v[64:67], v[32:35], a[48:51], v[64:67]
    ds_read_b128 v[60:63], v24 offset:17856
    buffer_load_dwordx4 v2, s[4:7], s32 offen lds
    s_add_u32 m0, m0, 1056
    s_add_u32 s32, s32, 4096
    s_waitcnt lgkmcnt(6)
    v_mfma_f32_16x16x32_bf16 v[68:71], v[36:39], a[48:51], v[68:71]
    ds_read_b64_tr_b16 v[192:193], v25 offset:0
    s_waitcnt lgkmcnt(6)
    v_mfma_f32_16x16x32_bf16 v[64:67], v[40:43], a[52:55], v[64:67]
    ds_read_b64_tr_b16 v[194:195], v25 offset:16896
    buffer_load_dwordx4 v2, s[4:7], s32 offen lds
    s_add_u32 m0, m0, 1056
    s_add_u32 s32, s32, 4096
    s_waitcnt lgkmcnt(6)
    v_mfma_f32_16x16x32_bf16 v[68:71], v[44:47], a[52:55], v[68:71]
    ds_read_b64_tr_b16 v[196:197], v25 offset:32
    s_waitcnt lgkmcnt(6)
    v_mfma_f32_16x16x32_bf16 v[64:67], v[48:51], a[56:59], v[64:67]
    ds_read_b64_tr_b16 v[198:199], v25 offset:16928
    buffer_load_dwordx4 v2, s[4:7], s32 offen lds
    s_add_u32 m0, m0, 1056
    s_add_u32 s32, s32, 4096
    s_waitcnt lgkmcnt(6)
    v_mfma_f32_16x16x32_bf16 v[68:71], v[52:55], a[56:59], v[68:71]
    ds_read_b64_tr_b16 v[200:201], v25 offset:64
    s_waitcnt lgkmcnt(6)
    v_mfma_f32_16x16x32_bf16 v[64:67], v[56:59], a[60:63], v[64:67]
    ds_read_b64_tr_b16 v[202:203], v25 offset:16960
    buffer_load_dwordx4 v2, s[4:7], s32 offen lds
    s_add_u32 m0, m0, 1056
    s_add_u32 s32, s32, 200704
    s_waitcnt lgkmcnt(6)
    v_mfma_f32_16x16x32_bf16 v[68:71], v[60:63], a[60:63], v[68:71]
    ds_read_b64_tr_b16 v[204:205], v25 offset:96
    ds_read_b64_tr_b16 v[206:207], v25 offset:16992
    ds_read_b64_tr_b16 v[208:209], v25 offset:128
    ds_read_b64_tr_b16 v[210:211], v25 offset:17024
    ds_read_b64_tr_b16 v[212:213], v25 offset:160
    ds_read_b64_tr_b16 v[214:215], v25 offset:17056
    ds_read_b64_tr_b16 v[216:217], v25 offset:192
    ds_read_b64_tr_b16 v[218:219], v25 offset:17088
    v_max3_f32 v3, v64, v65, v22
    v_max3_f32 v3, v3, v66, v67
    v_max3_f32 v3, v3, v68, v69
    v_max3_f32 v3, v3, v70, v71
    v_mov_b32 v4, v3
    ds_read_b64_tr_b16 v[220:221], v25 offset:224
    s_nop 0
    v_permlane32_swap_b32 v3, v4
    ds_read_b64_tr_b16 v[222:223], v25 offset:17120
    v_max_f32 v3, v3, v4
    ds_read_b64_tr_b16 v[224:225], v25 offset:256
    v_mov_b32 v4, v3
    ds_read_b64_tr_b16 v[226:227], v25 offset:17152
    s_nop 0
    v_permlane16_swap_b32 v3, v4
    ds_read_b64_tr_b16 v[228:229], v25 offset:288
    v_max_f32 v3, v3, v4
    ds_read_b64_tr_b16 v[230:231], v25 offset:17184
    v_sub_f32 v4, v22, v3
    ds_read_b64_tr_b16 v[232:233], v25 offset:320
    v_exp_f32 v4, v4
    ds_read_b64_tr_b16 v[234:235], v25 offset:17216
    v_mov_b32 v22, v3
    ds_read_b64_tr_b16 v[236:237], v25 offset:352
    v_sub_f32 v64, v64, v3
    ds_read_b64_tr_b16 v[238:239], v25 offset:17248
    v_sub_f32 v65, v65, v3
    ds_read_b64_tr_b16 v[240:241], v25 offset:384
    v_sub_f32 v66, v66, v3
    ds_read_b64_tr_b16 v[242:243], v25 offset:17280
    v_sub_f32 v67, v67, v3
    ds_read_b64_tr_b16 v[244:245], v25 offset:416
    v_sub_f32 v68, v68, v3
    ds_read_b64_tr_b16 v[246:247], v25 offset:17312
    v_sub_f32 v69, v69, v3
    ds_read_b64_tr_b16 v[248:249], v25 offset:448
    v_sub_f32 v70, v70, v3
    ds_read_b64_tr_b16 v[250:251], v25 offset:17344
    v_sub_f32 v71, v71, v3
    ds_read_b64_tr_b16 v[252:253], v25 offset:480
    v_exp_f32 v64, v64
    ds_read_b64_tr_b16 v[254:255], v25 offset:17376
    v_exp_f32 v65, v65
    v_exp_f32 v66, v66
    v_exp_f32 v67, v67
    v_exp_f32 v68, v68
    v_exp_f32 v69, v69
    v_exp_f32 v70, v70
    v_exp_f32 v71, v71
    v_cvt_pk_bf16_f32 v72, v64, v65
    v_cvt_pk_bf16_f32 v73, v66, v67
    v_cvt_pk_bf16_f32 v74, v68, v69
    v_cvt_pk_bf16_f32 v75, v70, v71
    v_pk_mul_f32 v[128:129], v[128:129], v[4:5] op_sel_hi:[1,0]
    v_pk_mul_f32 v[130:131], v[130:131], v[4:5] op_sel_hi:[1,0]
    v_pk_mul_f32 v[132:133], v[132:133], v[4:5] op_sel_hi:[1,0]
    v_pk_mul_f32 v[134:135], v[134:135], v[4:5] op_sel_hi:[1,0]
    s_waitcnt lgkmcnt(0)
    v_mfma_f32_16x16x32_bf16 v[128:131], v[192:195], v[72:75], v[128:131]
    v_pk_mul_f32 v[136:137], v[136:137], v[4:5] op_sel_hi:[1,0]
    v_pk_mul_f32 v[138:139], v[138:139], v[4:5] op_sel_hi:[1,0]
    v_mfma_f32_16x16x32_bf16 v[132:135], v[196:199], v[72:75], v[132:135]
    v_pk_mul_f32 v[140:141], v[140:141], v[4:5] op_sel_hi:[1,0]
    v_pk_mul_f32 v[142:143], v[142:143], v[4:5] op_sel_hi:[1,0]
    v_mfma_f32_16x16x32_bf16 v[136:139], v[200:203], v[72:75], v[136:139]
    v_pk_mul_f32 v[144:145], v[144:145], v[4:5] op_sel_hi:[1,0]
    v_pk_mul_f32 v[146:147], v[146:147], v[4:5] op_sel_hi:[1,0]
    v_mfma_f32_16x16x32_bf16 v[140:143], v[204:207], v[72:75], v[140:143]
    v_pk_mul_f32 v[148:149], v[148:149], v[4:5] op_sel_hi:[1,0]
    v_pk_mul_f32 v[150:151], v[150:151], v[4:5] op_sel_hi:[1,0]
    v_mfma_f32_16x16x32_bf16 v[144:147], v[208:211], v[72:75], v[144:147]
    v_pk_mul_f32 v[152:153], v[152:153], v[4:5] op_sel_hi:[1,0]
    v_pk_mul_f32 v[154:155], v[154:155], v[4:5] op_sel_hi:[1,0]
    v_mfma_f32_16x16x32_bf16 v[148:151], v[212:215], v[72:75], v[148:151]
    v_pk_mul_f32 v[156:157], v[156:157], v[4:5] op_sel_hi:[1,0]
    v_pk_mul_f32 v[158:159], v[158:159], v[4:5] op_sel_hi:[1,0]
    v_mfma_f32_16x16x32_bf16 v[152:155], v[216:219], v[72:75], v[152:155]
    v_pk_mul_f32 v[160:161], v[160:161], v[4:5] op_sel_hi:[1,0]
    v_pk_mul_f32 v[162:163], v[162:163], v[4:5] op_sel_hi:[1,0]
    v_mfma_f32_16x16x32_bf16 v[156:159], v[220:223], v[72:75], v[156:159]
    v_pk_mul_f32 v[164:165], v[164:165], v[4:5] op_sel_hi:[1,0]
    v_pk_mul_f32 v[166:167], v[166:167], v[4:5] op_sel_hi:[1,0]
    v_mfma_f32_16x16x32_bf16 v[160:163], v[224:227], v[72:75], v[160:163]
    v_pk_mul_f32 v[168:169], v[168:169], v[4:5] op_sel_hi:[1,0]
    v_pk_mul_f32 v[170:171], v[170:171], v[4:5] op_sel_hi:[1,0]
    v_mfma_f32_16x16x32_bf16 v[164:167], v[228:231], v[72:75], v[164:167]
    v_pk_mul_f32 v[172:173], v[172:173], v[4:5] op_sel_hi:[1,0]
    v_pk_mul_f32 v[174:175], v[174:175], v[4:5] op_sel_hi:[1,0]
    v_mfma_f32_16x16x32_bf16 v[168:171], v[232:235], v[72:75], v[168:171]
    v_pk_mul_f32 v[176:177], v[176:177], v[4:5] op_sel_hi:[1,0]
    v_pk_mul_f32 v[178:179], v[178:179], v[4:5] op_sel_hi:[1,0]
    v_mfma_f32_16x16x32_bf16 v[172:175], v[236:239], v[72:75], v[172:175]
    v_pk_mul_f32 v[180:181], v[180:181], v[4:5] op_sel_hi:[1,0]
    v_pk_mul_f32 v[182:183], v[182:183], v[4:5] op_sel_hi:[1,0]
    v_mfma_f32_16x16x32_bf16 v[176:179], v[240:243], v[72:75], v[176:179]
    v_pk_mul_f32 v[184:185], v[184:185], v[4:5] op_sel_hi:[1,0]
    v_pk_mul_f32 v[186:187], v[186:187], v[4:5] op_sel_hi:[1,0]
    v_mfma_f32_16x16x32_bf16 v[180:183], v[244:247], v[72:75], v[180:183]
    v_pk_mul_f32 v[188:189], v[188:189], v[4:5] op_sel_hi:[1,0]
    v_pk_mul_f32 v[190:191], v[190:191], v[4:5] op_sel_hi:[1,0]
    v_mfma_f32_16x16x32_bf16 v[184:187], v[248:251], v[72:75], v[184:187]
    s_nop 0
    v_mfma_f32_16x16x32_bf16 v[188:191], v[252:255], v[72:75], v[188:191]
    v_fma_f32 v23, v23, v4, v64
    v_add_f32 v23, v23, v65
    v_add_f32 v23, v23, v66
    v_add_f32 v23, v23, v67
    v_add_f32 v23, v23, v68
    v_add_f32 v23, v23, v69
    v_add_f32 v23, v23, v70
    v_add_f32 v23, v23, v71
    s_add_u32 s27, s27, 1
    s_cmp_lt_u32 s27, 16
    s_cbranch_scc1 L_CT
    s_waitcnt vmcnt(0)
    s_barrier
    v_mov_b32 v4, v23
    s_nop 1
    v_permlane32_swap_b32 v23, v4
    v_add_f32 v23, v23, v4
    v_mov_b32 v4, v23
    s_nop 1
    v_permlane16_swap_b32 v23, v4
    v_add_f32 v23, v23, v4
    s_lshl_b32 s24, s3, 9
    v_lshl_add_u32 v3, v0, 3, s24
    ds_write_b64 v3, v[22:23] offset:0
    v_xor_b32 v3, 0x400, v3
    s_waitcnt lgkmcnt(0)
    s_barrier
    ds_read_b64 v[6:7], v3 offset:0
    s_waitcnt lgkmcnt(0)
    v_max_f32 v3, v22, v6
    v_sub_f32 v4, v22, v3
    v_sub_f32 v6, v6, v3
    v_exp_f32 v4, v4
    v_exp_f32 v6, v6
    v_mov_b32 v22, v3
    v_mul_f32 v23, v23, v4
    v_fmac_f32 v23, v7, v6
    v_and_b32 v3, 15, v0
    v_lshlrev_b32 v5, 3, v3
    s_lshl_b32 s24, s71, 2
    s_add_u32 s31, s24, s70
    s_lshl_b32 s24, s31, 8
    s_mul_i32 s25, s75, 128
    s_add_u32 s24, s24, s25
    s_add_u32 s24, s24, 0x120000
    s_cmp_lg_u32 s3, 0
    s_cbranch_scc1 L_C_ml
    s_mov_b64 exec, 0xffff
    buffer_store_dwordx2 v[22:23], v5, s[12:15], s24 offen sc1
    s_mov_b64 exec, -1
L_C_ml:
    v_pk_mul_f32 v[128:129], v[128:129], v[4:5] op_sel_hi:[1,0]
    v_pk_mul_f32 v[130:131], v[130:131], v[4:5] op_sel_hi:[1,0]
    v_pk_mul_f32 v[132:133], v[132:133], v[4:5] op_sel_hi:[1,0]
    v_pk_mul_f32 v[134:135], v[134:135], v[4:5] op_sel_hi:[1,0]
    v_pk_mul_f32 v[136:137], v[136:137], v[4:5] op_sel_hi:[1,0]
    v_pk_mul_f32 v[138:139], v[138:139], v[4:5] op_sel_hi:[1,0]
    v_pk_mul_f32 v[140:141], v[140:141], v[4:5] op_sel_hi:[1,0]
    v_pk_mul_f32 v[142:143], v[142:143], v[4:5] op_sel_hi:[1,0]
    v_pk_mul_f32 v[144:145], v[144:145], v[4:5] op_sel_hi:[1,0]
    v_pk_mul_f32 v[146:147], v[146:147], v[4:5] op_sel_hi:[1,0]
    v_pk_mul_f32 v[148:149], v[148:149], v[4:5] op_sel_hi:[1,0]
    v_pk_mul_f32 v[150:151], v[150:151], v[4:5] op_sel_hi:[1,0]
    v_pk_mul_f32 v[152:153], v[152:153], v[4:5] op_sel_hi:[1,0]
    v_pk_mul_f32 v[154:155], v[154:155], v[4:5] op_sel_hi:[1,0]
    v_pk_mul_f32 v[156:157], v[156:157], v[4:5] op_sel_hi:[1,0]
    v_pk_mul_f32 v[158:159], v[158:159], v[4:5] op_sel_hi:[1,0]
    v_pk_mul_f32 v[160:161], v[160:161], v[4:5] op_sel_hi:[1,0]
    v_pk_mul_f32 v[162:163], v[162:163], v[4:5] op_sel_hi:[1,0]
    v_pk_mul_f32 v[164:165], v[164:165], v[4:5] op_sel_hi:[1,0]
    v_pk_mul_f32 v[166:167], v[166:167], v[4:5] op_sel_hi:[1,0]
    v_pk_mul_f32 v[168:169], v[168:169], v[4:5] op_sel_hi:[1,0]
    v_pk_mul_f32 v[170:171], v[170:171], v[4:5] op_sel_hi:[1,0]
    v_pk_mul_f32 v[172:173], v[172:173], v[4:5] op_sel_hi:[1,0]
    v_pk_mul_f32 v[174:175], v[174:175], v[4:5] op_sel_hi:[1,0]
    v_pk_mul_f32 v[176:177], v[176:177], v[4:5] op_sel_hi:[1,0]
    v_pk_mul_f32 v[178:179], v[178:179], v[4:5] op_sel_hi:[1,0]
    v_pk_mul_f32 v[180:181], v[180:181], v[4:5] op_sel_hi:[1,0]
    v_pk_mul_f32 v[182:183], v[182:183], v[4:5] op_sel_hi:[1,0]
    v_pk_mul_f32 v[184:185], v[184:185], v[4:5] op_sel_hi:[1,0]
    v_pk_mul_f32 v[186:187], v[186:187], v[4:5] op_sel_hi:[1,0]
    v_pk_mul_f32 v[188:189], v[188:189], v[4:5] op_sel_hi:[1,0]
    v_pk_mul_f32 v[190:191], v[190:191], v[4:5] op_sel_hi:[1,0]
    s_lshl_b32 s24, s3, 13
    s_add_u32 s24, s24, 4096
    v_add_u32 v6, s24, v2
    s_xor_b32 s24, s3, 2
    s_lshl_b32 s24, s24, 13
    s_add_u32 s24, s24, 4096
    v_add_u32 v7, s24, v2
    s_cmp_lg_u32 s28, 0
    s_cbranch_scc1 L_C_x1
    ds_write_b128 v6, v[160:163] offset:0
    ds_write_b128 v6, v[164:167] offset:1024
    ds_write_b128 v6, v[168:171] offset:2048
    ds_write_b128 v6, v[172:175] offset:3072
    ds_write_b128 v6, v[176:179] offset:4096
    ds_write_b128 v6, v[180:183] offset:5120
    ds_write_b128 v6, v[184:187] offset:6144
    ds_write_b128 v6, v[188:191] offset:7168
    s_branch L_C_x2
L_C_x1:
    ds_write_b128 v6, v[128:131] offset:0
    ds_write_b128 v6, v[132:135] offset:1024
    ds_write_b128 v6, v[136:139] offset:2048
    ds_write_b128 v6, v[140:143] offset:3072
    ds_write_b128 v6, v[144:147] offset:4096
    ds_write_b128 v6, v[148:151] offset:5120
    ds_write_b128 v6, v[152:155] offset:6144
    ds_write_b128 v6, v[156:159] offset:7168
    s_waitcnt lgkmcnt(0)
    v_mov_b32 v128, v160
    v_mov_b32 v129, v161
    v_mov_b32 v130, v162
    v_mov_b32 v131, v163
    v_mov_b32 v132, v164
    v_mov_b32 v133, v165
    v_mov_b32 v134, v166
    v_mov_b32 v135, v167
    v_mov_b32 v136, v168
    v_mov_b32 v137, v169
    v_mov_b32 v138, v170
    v_mov_b32 v139, v171
    v_mov_b32 v140, v172
    v_mov_b32 v141, v173
    v_mov_b32 v142, v174
    v_mov_b32 v143, v175
    v_mov_b32 v144, v176
    v_mov_b32 v145, v177
    v_mov_b32 v146, v178
    v_mov_b32 v147, v179
    v_mov_b32 v148, v180
    v_mov_b32 v149, v181
    v_mov_b32 v150, v182
    v_mov_b32 v151, v183
    v_mov_b32 v152, v184
    v_mov_b32 v153, v185
    v_mov_b32 v154, v186
    v_mov_b32 v155, v187
    v_mov_b32 v156, v188
    v_mov_b32 v157, v189
    v_mov_b32 v158, v190
    v_mov_b32 v159, v191
L_C_x2:
    s_waitcnt lgkmcnt(0)
    s_barrier
    ds_read_b128 v[192:195], v7 offset:0
    ds_read_b128 v[196:199], v7 offset:1024
    ds_read_b128 v[200:203], v7 offset:2048
    ds_read_b128 v[204:207], v7 offset:3072
    ds_read_b128 v[208:211], v7 offset:4096
    ds_read_b128 v[212:215], v7 offset:5120
    ds_read_b128 v[216:219], v7 offset:6144
    ds_read_b128 v[220:223], v7 offset:7168
    v_lshrrev_b32 v4, 4, v0
    v_mul_u32_u24 v3, 272, v3
    v_lshl_add_u32 v3, v4, 3, v3
    s_mul_i32 s24, s3, 4352
    s_add_u32 s24, s24, 40960
    v_add_u32 v3, s24, v3
    s_waitcnt lgkmcnt(7)
    v_add_f32 v128, v128, v192
    v_add_f32 v129, v129, v193
    v_add_f32 v130, v130, v194
    v_add_f32 v131, v131, v195
    v_cvt_pk_bf16_f32 v32, v128, v129
    v_cvt_pk_bf16_f32 v33, v130, v131
    ds_write_b64 v3, v[32:33] offset:0
    s_waitcnt lgkmcnt(7)
    v_add_f32 v132, v132, v196
    v_add_f32 v133, v133, v197
    v_add_f32 v134, v134, v198
    v_add_f32 v135, v135, v199
    v_cvt_pk_bf16_f32 v34, v132, v133
    v_cvt_pk_bf16_f32 v35, v134, v135
    ds_write_b64 v3, v[34:35] offset:32
    s_waitcnt lgkmcnt(7)
    v_add_f32 v136, v136, v200
    v_add_f32 v137, v137, v201
    v_add_f32 v138, v138, v202
    v_add_f32 v139, v139, v203
    v_cvt_pk_bf16_f32 v36, v136, v137
    v_cvt_pk_bf16_f32 v37, v138, v139
    ds_write_b64 v3, v[36:37] offset:64
    s_waitcnt lgkmcnt(7)
    v_add_f32 v140, v140, v204
    v_add_f32 v141, v141, v205
    v_add_f32 v142, v142, v206
    v_add_f32 v143, v143, v207
    v_cvt_pk_bf16_f32 v38, v140, v141
    v_cvt_pk_bf16_f32 v39, v142, v143
    ds_write_b64 v3, v[38:39] offset:96
    s_waitcnt lgkmcnt(7)
    v_add_f32 v144, v144, v208
    v_add_f32 v145, v145, v209
    v_add_f32 v146, v146, v210
    v_add_f32 v147, v147, v211
    v_cvt_pk_bf16_f32 v40, v144, v145
    v_cvt_pk_bf16_f32 v41, v146, v147
    ds_write_b64 v3, v[40:41] offset:128
    s_waitcnt lgkmcnt(7)
    v_add_f32 v148, v148, v212
    v_add_f32 v149, v149, v213
    v_add_f32 v150, v150, v214
    v_add_f32 v151, v151, v215
    v_cvt_pk_bf16_f32 v42, v148, v149
    v_cvt_pk_bf16_f32 v43, v150, v151
    ds_write_b64 v3, v[42:43] offset:160
    s_waitcnt lgkmcnt(7)
    v_add_f32 v152, v152, v216
    v_add_f32 v153, v153, v217
    v_add_f32 v154, v154, v218
    v_add_f32 v155, v155, v219
    v_cvt_pk_bf16_f32 v44, v152, v153
    v_cvt_pk_bf16_f32 v45, v154, v155
    ds_write_b64 v3, v[44:45] offset:192
    s_waitcnt lgkmcnt(7)
    v_add_f32 v156, v156, v220
    v_add_f32 v157, v157, v221
    v_add_f32 v158, v158, v222
    v_add_f32 v159, v159, v223
    v_cvt_pk_bf16_f32 v46, v156, v157
    v_cvt_pk_bf16_f32 v47, v158, v159
    ds_write_b64 v3, v[46:47] offset:224
    v_and_b32 v5, 15, v0
    v_mul_u32_u24 v3, 272, v4
    v_lshl_add_u32 v3, v5, 4, v3
    v_add_u32 v3, s24, v3
    v_lshlrev_b32 v4, 11, v4
    v_lshl_add_u32 v4, v5, 4, v4
    s_waitcnt lgkmcnt(0)
    ds_read_b128 v[64:67], v3 offset:0
    ds_read_b128 v[68:71], v3 offset:1088
    ds_read_b128 v[72:75], v3 offset:2176
    ds_read_b128 v[76:79], v3 offset:3264
    s_lshl_b32 s24, s31, 16
    s_lshl_b32 s25, s29, 9
    s_add_u32 s24, s24, s25
    s_lshl_b32 s25, s28, 8
    s_add_u32 s24, s24, s25
    s_mul_i32 s25, s75, 32768
    s_add_u32 s24, s24, s25
    s_add_u32 s24, s24, 0x400000
    s_waitcnt lgkmcnt(3)
    buffer_store_dwordx4 v[64:67], v4, s[12:15], s24 offen sc1 nt
    s_add_u32 s24, s24, 8192
    s_waitcnt lgkmcnt(2)
    buffer_store_dwordx4 v[68:71], v4, s[12:15], s24 offen sc1 nt
    s_add_u32 s24, s24, 8192
    s_waitcnt lgkmcnt(1)
    buffer_store_dwordx4 v[72:75], v4, s[12:15], s24 offen sc1 nt
    s_add_u32 s24, s24, 8192
    s_waitcnt lgkmcnt(0)
    buffer_store_dwordx4 v[76:79], v4, s[12:15], s24 offen sc1 nt
    s_add_u32 s24, s24, 8192
    s_waitcnt vmcnt(0)
    s_barrier
    s_cmp_lg_u32 s3, 0
    s_cbranch_scc1 L_sig24
    s_mov_b64 exec, 1
    v_mov_b32 v3, 1
    buffer_atomic_add v3, off, s[16:19], 0 offset:4 sc0
    s_waitcnt vmcnt(0)
    v_readfirstlane_b32 s24, v3
    s_mov_b64 exec, -1
    s_and_b32 s24, s24, 31
    s_cmp_lg_u32 s24, 31
    s_cbranch_scc1 L_sig24
    v_lshlrev_b32 v4, 7, v0
    v_mov_b32 v3, 1
    s_mov_b32 s24, 0x170000
    s_mov_b32 exec_hi, 0
    buffer_store_dword v3, v4, s[12:15], s24 offen offset:4 sc1
    s_mov_b64 exec, -1
L_sig24:
    s_branch L_R
L_last:
    s_endpgm
.section .rodata,"a"
.p2align 6
.amdhsa_kernel concat_heads__compressed_kv_cla__mha_block_cached__decode_kernel
  .amdhsa_next_free_vgpr 448
  .amdhsa_next_free_sgpr 102
  .amdhsa_accum_offset 256
  .amdhsa_group_segment_fixed_size 0
  .amdhsa_kernarg_size 112
  .amdhsa_user_sgpr_count 2
  .amdhsa_user_sgpr_kernarg_segment_ptr 1
  .amdhsa_system_sgpr_workgroup_id_x 1
  .amdhsa_float_denorm_mode_32 3
.end_amdhsa_kernel
```

```asm
; @launch grid=(256,1,1) block=(256,1,1) lds=149504
.amdgcn_target "amdgcn-amd-amdhsa--gfx950"
.text
.globl concat_heads__compressed_kv_cla__mha_block_cached__decode_kernel
.p2align 8
.type concat_heads__compressed_kv_cla__mha_block_cached__decode_kernel,@function
concat_heads__compressed_kv_cla__mha_block_cached__decode_kernel:
    s_load_dwordx16 s[36:51], s[0:1], 0
    s_load_dwordx8 s[52:59], s[0:1], 64
    s_load_dwordx4 s[60:63], s[0:1], 96
    s_cmp_ge_u32 s2, 256
    s_cbranch_scc1 L_end
    s_cmp_lt_u32 s2, 64
    s_getpc_b64 s[24:25]
L_pc0:
    s_cselect_b32 s20, L_A-L_pc0, 0
    v_lshlrev_b32 v16, 7, v0
    v_min_u32 v16, L_A-L_pc0-4, v16
    v_add_u32 v16, s20, v16
    v_add_co_u32 v16, vcc, s24, v16
    v_mov_b32 v17, s25
    s_nop 0
    v_addc_co_u32 v17, vcc, 0, v17, vcc
    global_load_dword v17, v[16:17], off
    s_cbranch_scc1 L_A
L_B:
    s_and_b32 s70, s2, 6
    s_and_b32 s25, s2, 7
    s_add_u32 s70, s70, s25
    s_lshl_b32 s25, s70, 8
    v_and_b32 v6, 15, v0
    v_lshl_add_u32 v24, v6, 4, s25
    v_and_b32 v4, 16, v0
    v_lshl_add_u32 v24, v4, 5, v24
    v_lshrrev_b32 v4, 5, v0
    v_lshl_add_u32 v24, v4, 12, v24
    s_lshr_b32 s74, s2, 3
    s_lshl_b32 s74, s74, 2
    s_addk_i32 s74, -32
    s_mov_b32 s10, 0x400000
    s_mov_b32 s11, 0x20000
    s_waitcnt lgkmcnt(0)
    s_mov_b64 s[8:9], s[54:55]
L_pfb:
    s_lshl_b32 s24, s74, 13
    buffer_load_dwordx4 v[28:31], v24, s[8:11], s24 offen
    s_addk_i32 s74, 96
    s_cmpk_lt_u32 s74, 512
    s_cbranch_scc1 L_pfb
    s_addk_i32 s74, -512
    s_mov_b64 s[8:9], s[40:41]
L_pfq:
    s_lshl_b32 s24, s74, 13
    buffer_load_dwordx4 v[28:31], v24, s[8:11], s24 offen
    s_addk_i32 s74, 96
    s_cmpk_lt_u32 s74, 512
    s_cbranch_scc1 L_pfq
    s_addk_i32 s74, -512
    s_mov_b64 s[8:9], s[42:43]
L_pfk:
    s_lshl_b32 s24, s74, 13
    buffer_load_dwordx4 v[28:31], v24, s[8:11], s24 offen
    s_addk_i32 s74, 96
    s_cmpk_lt_u32 s74, 512
    s_cbranch_scc1 L_pfk
    s_addk_i32 s74, -512
    v_lshrrev_b32 v1, 6, v0
    v_and_b32 v0, 63, v0
    v_readfirstlane_b32 s3, v1
    v_lshlrev_b32 v2, 4, v0
    s_lshr_b32 s24, s2, 3
    s_sub_u32 s24, s24, 8
    s_mul_i32 s26, s24, 43
    s_lshr_b32 s26, s26, 8
    s_mul_i32 s27, s26, 6
    s_sub_u32 s27, s24, s27
    s_and_b32 s25, s26, 1
    s_lshl_b32 s25, s25, 1
    s_and_b32 s26, s26, 2
    s_lshl_b32 s26, s26, 3
    s_or_b32 s26, s26, s25
    s_or_b32 s26, s26, s70
    s_lshl_b32 s25, s70, 17
    s_lshl_b32 s24, s3, 8
    s_add_u32 s25, s25, s24
    v_lshl_add_u32 v25, v6, 4, s25
    v_and_b32 v4, 16, v0
    v_lshl_add_u32 v25, v4, 14, v25
    v_and_b32 v4, 32, v0
    v_lshl_add_u32 v25, v4, 16, v25
    s_and_b32 s25, s2, 3
    s_lshl_b32 s25, s25, 10
    s_lshl_b32 s24, s3, 12
    s_add_u32 s25, s25, s24
    s_bfe_u32 s24, s2, 0x10002
    s_lshl_b32 s24, s24, 23
    s_add_u32 s25, s25, s24
    v_add_u32 v26, s25, v2
    s_cmp_ge_u32 s27, 3
    s_cselect_b32 s28, 1, 0
    s_mul_i32 s29, s28, 3
    s_sub_u32 s29, s27, s29
    s_lshr_b32 s72, s3, 1
    s_lshl_b32 s24, s28, 1
    s_add_u32 s72, s72, s24
    s_and_b32 s31, s3, 1
    s_lshl_b32 s24, s29, 1
    s_add_u32 s31, s31, s24
    s_lshl_b32 s30, s72, 5
    s_add_u32 s30, s30, s26
    s_lshl_b32 s30, s30, 20
    v_lshrrev_b32 v3, 4, v0
    v_and_b32 v4, 3, v0
    v_lshlrev_b32 v5, 6, v3
    v_lshl_add_u32 v5, v4, 4, v5
    v_bfe_u32 v1, v0, 2, 2
    v_lshl_add_u32 v1, v1, 8, v5
    s_mul_i32 s35, s31, 1024
    s_add_u32 s32, s35, 983040
    s_mul_i32 s28, s31, 1024
    s_add_u32 s28, s28, 1044480
    s_mov_b32 s6, 0x100000
    s_mov_b32 s7, 0x20000
    s_add_u32 s4, s50, s30
    s_addc_u32 s5, s51, 0
    s_mov_b32 s12, s62
    s_mov_b32 s13, s63
    s_mov_b32 s14, 0x600000
    s_mov_b32 s15, 0x20000
    s_mov_b32 s16, s60
    s_mov_b32 s17, s61
    s_mov_b32 s18, 0x100
    s_mov_b32 s19, 0x20000
    v_and_b32 v3, 1, v0
    v_lshlrev_b32 v3, 4, v3
    v_mov_b32 v4, 0xffff
    v_lshlrev_b32 v4, v3, v4
    v_bfe_u32 v3, v0, 1, 2
    v_cmp_eq_u32 vcc, 0, v3
    s_nop 1
    v_cndmask_b32 v20, 0, v4, vcc
    v_cmp_eq_u32 vcc, 1, v3
    s_nop 1
    v_cndmask_b32 v21, 0, v4, vcc
    v_cmp_eq_u32 vcc, 2, v3
    s_nop 1
    v_cndmask_b32 v22, 0, v4, vcc
    v_cmp_eq_u32 vcc, 3, v3
    s_nop 1
    v_cndmask_b32 v23, 0, v4, vcc
    s_mov_b32 s64, 0x22222222
    s_mov_b32 s65, 0x22222222
    s_mov_b32 s66, 0x44444444
    s_mov_b32 s67, 0x44444444
    s_mov_b32 s68, 0x88888888
    s_mov_b32 s69, 0x88888888
    v_mov_b32 v32, 0
    v_mov_b32 v33, 0
    v_mov_b32 v34, 0
    v_mov_b32 v35, 0
    v_mov_b32 v36, 0
    v_mov_b32 v37, 0
    v_mov_b32 v38, 0
    v_mov_b32 v39, 0
    v_mov_b32 v40, 0
    v_mov_b32 v41, 0
    v_mov_b32 v42, 0
    v_mov_b32 v43, 0
    v_mov_b32 v44, 0
    v_mov_b32 v45, 0
    v_mov_b32 v46, 0
    v_mov_b32 v47, 0
    v_lshrrev_b32 v3, 4, v0
    v_lshlrev_b32 v60, 6, v3
    v_and_b32 v4, 7, v0
    v_lshl_add_u32 v60, v4, 3, v60
    s_lshl_b32 s33, s26, 2
    s_add_u32 s33, s33, s72
    s_lshl_b32 s34, s26, 12
    s_lshl_b32 s24, s72, 8
    s_add_u32 s34, s34, s24
    s_add_u32 s34, s34, 0x140000
    s_mul_i32 s73, s33, 6
    s_add_u32 s73, s73, s31
    s_lshl_b32 s73, s73, 8
    s_add_u32 s73, s73, 0x180000
    s_mov_b64 s[8:9], s[56:57]
L_pfo:
    s_lshl_b32 s24, s74, 8
    s_waitcnt vmcnt(6)
    buffer_load_dwordx4 v[28:31], v25, s[8:11], s24 offen
    s_addk_i32 s74, 96
    s_cmpk_lt_u32 s74, 512
    s_cbranch_scc1 L_pfo
    s_addk_i32 s74, -512
    s_mov_b64 s[8:9], s[44:45]
L_pfu:
    s_lshl_b32 s24, s74, 13
    s_waitcnt vmcnt(6)
    buffer_load_dwordx4 v[28:31], v24, s[8:11], s24 offen
    s_addk_i32 s74, 96
    s_cmpk_lt_u32 s74, 512
    s_cbranch_scc1 L_pfu
    s_addk_i32 s74, -512
    s_mov_b64 s[8:9], s[46:47]
L_pfv:
    s_lshl_b32 s24, s74, 8
    s_waitcnt vmcnt(6)
    buffer_load_dwordx4 v[28:31], v25, s[8:11], s24 offen
    s_addk_i32 s74, 96
    s_cmpk_lt_u32 s74, 512
    s_cbranch_scc1 L_pfv
    s_addk_i32 s74, -512
    s_mov_b64 s[8:9], s[38:39]
    s_mov_b32 s10, 0x1000000
L_pfc:
    s_lshl_b32 s24, s74, 12
    s_waitcnt vmcnt(6)
    buffer_load_dwordx4 v[28:31], v26, s[8:11], s24 offen
    s_addk_i32 s74, 96
    s_cmpk_lt_u32 s74, 2048
    s_cbranch_scc1 L_pfc
    s_addk_i32 s74, -2048
    s_mov_b32 s10, 0x400000
    s_waitcnt vmcnt(15)
    buffer_load_dwordx4 a[0:3], v1, s[4:7], s32 offen offset:0 nt
    s_add_u32 s32, s32, 6144
    s_waitcnt vmcnt(15)
    buffer_load_dwordx4 a[4:7], v1, s[4:7], s32 offen offset:0 nt
    s_add_u32 s32, s32, 6144
    s_waitcnt vmcnt(15)
    buffer_load_dwordx4 a[8:11], v1, s[4:7], s32 offen offset:0 nt
    s_add_u32 s32, s32, 6144
    s_waitcnt vmcnt(15)
    buffer_load_dwordx4 a[12:15], v1, s[4:7], s32 offen offset:0 nt
    s_add_u32 s32, s32, 6144
    s_waitcnt vmcnt(15)
    buffer_load_dwordx4 a[16:19], v1, s[4:7], s32 offen offset:0 nt
    s_add_u32 s32, s32, 6144
    s_waitcnt vmcnt(15)
    buffer_load_dwordx4 a[20:23], v1, s[4:7], s32 offen offset:0 nt
    s_add_u32 s32, s32, 6144
    s_waitcnt vmcnt(15)
    buffer_load_dwordx4 a[24:27], v1, s[4:7], s32 offen offset:0 nt
    s_add_u32 s32, s32, 6144
    s_waitcnt vmcnt(15)
    buffer_load_dwordx4 a[28:31], v1, s[4:7], s32 offen offset:0 nt
    s_add_u32 s32, s32, 6144
    s_waitcnt vmcnt(15)
    buffer_load_dwordx4 a[32:35], v1, s[4:7], s32 offen offset:0 nt
    s_add_u32 s32, s32, 6144
    s_waitcnt vmcnt(15)
    buffer_load_dwordx4 a[36:39], v1, s[4:7], s32 offen offset:0 nt
    s_add_u32 s32, s32, 6144
    s_waitcnt vmcnt(15)
    buffer_load_dwordx4 a[40:43], v1, s[4:7], s28 offen offset:0 nt
    s_waitcnt vmcnt(15)
    s_mov_b32 s32, s35
    buffer_load_dwordx4 a[64:67], v1, s[4:7], s32 offen offset:0 nt
    s_add_u32 s32, s32, 6144
    s_waitcnt vmcnt(15)
    buffer_load_dwordx4 a[68:71], v1, s[4:7], s32 offen offset:0 nt
    s_add_u32 s32, s32, 6144
    s_waitcnt vmcnt(15)
    buffer_load_dwordx4 a[72:75], v1, s[4:7], s32 offen offset:0 nt
    s_add_u32 s32, s32, 6144
    s_waitcnt vmcnt(15)
    buffer_load_dwordx4 a[76:79], v1, s[4:7], s32 offen offset:0 nt
    s_add_u32 s32, s32, 6144
    s_waitcnt vmcnt(15)
    buffer_load_dwordx4 a[80:83], v1, s[4:7], s32 offen offset:0 nt
    s_add_u32 s32, s32, 6144
    s_mov_b64 exec, 1
    buffer_load_dword v61, off, s[16:19], 0 offset:128 sc1
    s_mov_b64 exec, -1
    s_waitcnt vmcnt(15)
    buffer_load_dwordx4 a[84:87], v1, s[4:7], s32 offen offset:0 nt
    s_add_u32 s32, s32, 6144
    s_waitcnt vmcnt(15)
    buffer_load_dwordx4 a[88:91], v1, s[4:7], s32 offen offset:0 nt
    s_add_u32 s32, s32, 6144
    s_waitcnt vmcnt(15)
    buffer_load_dwordx4 a[92:95], v1, s[4:7], s32 offen offset:0 nt
    s_add_u32 s32, s32, 6144
    s_waitcnt vmcnt(15)
    buffer_load_dwordx4 a[96:99], v1, s[4:7], s32 offen offset:0 nt
    s_add_u32 s32, s32, 6144
    s_waitcnt vmcnt(15)
    buffer_load_dwordx4 a[100:103], v1, s[4:7], s32 offen offset:0 nt
    s_add_u32 s32, s32, 6144
    s_waitcnt vmcnt(15)
    buffer_load_dwordx4 a[104:107], v1, s[4:7], s32 offen offset:0 nt
    s_add_u32 s32, s32, 6144
    s_waitcnt vmcnt(15)
    buffer_load_dwordx4 a[108:111], v1, s[4:7], s32 offen offset:0 nt
    s_add_u32 s32, s32, 6144
    s_waitcnt vmcnt(15)
    buffer_load_dwordx4 a[112:115], v1, s[4:7], s32 offen offset:0 nt
    s_add_u32 s32, s32, 6144
    s_waitcnt vmcnt(15)
    buffer_load_dwordx4 a[116:119], v1, s[4:7], s32 offen offset:0 nt
    s_add_u32 s32, s32, 6144
    s_waitcnt vmcnt(15)
    buffer_load_dwordx4 a[120:123], v1, s[4:7], s32 offen offset:0 nt
    s_add_u32 s32, s32, 6144
    s_waitcnt vmcnt(15)
    buffer_load_dwordx4 a[124:127], v1, s[4:7], s32 offen offset:0 nt
    s_add_u32 s32, s32, 6144
    s_waitcnt vmcnt(15)
    buffer_load_dwordx4 v[64:67], v1, s[4:7], s32 offen offset:0 nt
    s_add_u32 s32, s32, 6144
    s_waitcnt vmcnt(12)
    v_readfirstlane_b32 s25, v61
    s_nop 0
    s_cmp_ge_u32 s25, 32
    s_cbranch_scc1 L_B_q
    s_mov_b32 s24, 262144
    s_mov_b64 exec, 1
L_aw1:
    buffer_load_dword v61, off, s[16:19], 0 offset:128 sc1
    s_waitcnt vmcnt(0)
    v_readfirstlane_b32 s25, v61
    s_nop 0
    s_cmp_ge_u32 s25, 32
    s_cbranch_scc1 L_B_q
    s_sleep 16
    s_sub_u32 s24, s24, 1
    s_cmp_lg_u32 s24, 0
    s_cbranch_scc1 L_aw1
L_B_q:
    s_mov_b64 exec, -1
    buffer_load_dwordx4 v[8:11], v5, s[12:15], s34 offen sc1
    s_waitcnt vmcnt(15)
    buffer_load_dwordx4 v[68:71], v1, s[4:7], s32 offen offset:0 nt
    s_add_u32 s32, s32, 6144
    s_waitcnt vmcnt(15)
    buffer_load_dwordx4 v[72:75], v1, s[4:7], s32 offen offset:0 nt
    s_add_u32 s32, s32, 6144
    s_waitcnt vmcnt(15)
    buffer_load_dwordx4 v[76:79], v1, s[4:7], s32 offen offset:0 nt
    s_add_u32 s32, s32, 6144
    s_waitcnt vmcnt(15)
    buffer_load_dwordx4 v[80:83], v1, s[4:7], s32 offen offset:0 nt
    s_add_u32 s32, s32, 6144
    s_waitcnt vmcnt(15)
    buffer_load_dwordx4 v[84:87], v1, s[4:7], s32 offen offset:0 nt
    s_add_u32 s32, s32, 6144
    s_waitcnt vmcnt(15)
    buffer_load_dwordx4 v[88:91], v1, s[4:7], s32 offen offset:0 nt
    s_add_u32 s32, s32, 6144
    s_waitcnt vmcnt(15)
    buffer_load_dwordx4 v[92:95], v1, s[4:7], s32 offen offset:0 nt
    s_add_u32 s32, s32, 6144
    s_waitcnt vmcnt(15)
    buffer_load_dwordx4 v[96:99], v1, s[4:7], s32 offen offset:0 nt
    s_add_u32 s32, s32, 6144
    s_waitcnt vmcnt(15)
    buffer_load_dwordx4 v[100:103], v1, s[4:7], s32 offen offset:0 nt
    s_add_u32 s32, s32, 6144
    s_waitcnt vmcnt(15)
    buffer_load_dwordx4 v[104:107], v1, s[4:7], s32 offen offset:0 nt
    s_add_u32 s32, s32, 6144
    s_waitcnt vmcnt(15)
    buffer_load_dwordx4 v[108:111], v1, s[4:7], s32 offen offset:0 nt
    s_add_u32 s32, s32, 6144
    s_waitcnt vmcnt(15)
    buffer_load_dwordx4 v[112:115], v1, s[4:7], s32 offen offset:0 nt
    s_add_u32 s32, s32, 6144
    s_waitcnt vmcnt(15)
    buffer_load_dwordx4 v[116:119], v1, s[4:7], s32 offen offset:0 nt
    s_add_u32 s32, s32, 6144
    s_waitcnt vmcnt(15)
    buffer_load_dwordx4 v[120:123], v1, s[4:7], s32 offen offset:0 nt
    s_add_u32 s32, s32, 6144
    s_waitcnt vmcnt(15)
    buffer_load_dwordx4 v[124:127], v1, s[4:7], s32 offen offset:0 nt
    s_add_u32 s32, s32, 6144
    s_waitcnt vmcnt(15)
    v_mov_b32_dpp v32, v8 quad_perm:[0,1,2,3] row_mask:0xf bank_mask:0x1
    v_mov_b32_dpp v33, v9 quad_perm:[0,1,2,3] row_mask:0xf bank_mask:0x1
    v_mov_b32_dpp v34, v10 quad_perm:[0,1,2,3] row_mask:0xf bank_mask:0x1
    v_mov_b32_dpp v35, v11 quad_perm:[0,1,2,3] row_mask:0xf bank_mask:0x1
    v_mov_b32_dpp v36, v8 quad_perm:[0,1,2,3] row_mask:0xf bank_mask:0x2
    v_mov_b32_dpp v37, v9 quad_perm:[0,1,2,3] row_mask:0xf bank_mask:0x2
    v_mov_b32_dpp v38, v10 quad_perm:[0,1,2,3] row_mask:0xf bank_mask:0x2
    v_mov_b32_dpp v39, v11 quad_perm:[0,1,2,3] row_mask:0xf bank_mask:0x2
    v_mov_b32_dpp v40, v8 quad_perm:[0,1,2,3] row_mask:0xf bank_mask:0x4
    v_mov_b32_dpp v41, v9 quad_perm:[0,1,2,3] row_mask:0xf bank_mask:0x4
    v_mov_b32_dpp v42, v10 quad_perm:[0,1,2,3] row_mask:0xf bank_mask:0x4
    v_mov_b32_dpp v43, v11 quad_perm:[0,1,2,3] row_mask:0xf bank_mask:0x4
    v_mov_b32_dpp v44, v8 quad_perm:[0,1,2,3] row_mask:0xf bank_mask:0x8
    v_mov_b32_dpp v45, v9 quad_perm:[0,1,2,3] row_mask:0xf bank_mask:0x8
    v_mov_b32_dpp v46, v10 quad_perm:[0,1,2,3] row_mask:0xf bank_mask:0x8
    v_mov_b32_dpp v47, v11 quad_perm:[0,1,2,3] row_mask:0xf bank_mask:0x8
    s_mov_b32 s27, 1
L_BK:
    s_cmp_lg_u32 s27, 9
    s_cbranch_scc1 L_BK_a
    s_add_u32 s4, s52, s30
    s_addc_u32 s5, s53, 0
    s_mov_b32 s32, s35
    v_mov_b32 v1, v2
L_BK_a:
    s_barrier
    s_cmp_lg_u32 s27, 7
    s_cbranch_scc1 L_BK_x0
    s_and_b32 s24, s2, 7
    s_lshl_b32 s24, s24, 7
    s_add_u32 s24, s24, 0x1d8000
    v_and_b32 v63, 7, v0
    v_lshlrev_b32 v63, 2, v63
    buffer_load_dword v62, v63, s[12:15], s24 offen sc1
L_BK_x0:
    s_cmp_lg_u32 s27, 8
    s_cbranch_scc1 L_BK_x1
    s_getreg_b32 s24, hwreg(HW_REG_XCC_ID, 0, 4)
    v_cmp_ne_u32 vcc, s24, v62
    s_nop 0
    s_or_b32 s75, vcc_lo, vcc_hi
    v_mov_b32 v28, -1
    v_mov_b32 v29, -1
    v_mov_b32 v30, -1
    v_mov_b32 v31, -1
    s_mov_b64 exec, 0xffff
    s_cbranch_scc1 L_far2
    buffer_store_dwordx4 v[28:31], v2, s[12:15], s73 offen
    s_branch L_near2
L_far2:
    buffer_store_dwordx4 v[28:31], v2, s[12:15], s73 offen sc1
L_near2:
    s_mov_b64 exec, -1
L_BK_x1:
    v_mov_b32 v49, v50
    v_mov_b32 v50, v51
    v_mov_b32 v51, v52
    v_mov_b32 v52, v53
    v_mov_b32 v53, v54
    v_mov_b32 v54, v55
    v_mov_b32 v55, v56
    v_mov_b32 v56, v57
    s_waitcnt vmcnt(15)
    v_mfma_f32_16x16x32_bf16 v[12:15], v[64:67], v[32:35], 0
    buffer_load_dwordx4 v[64:67], v1, s[4:7], s32 offen offset:0 nt
    s_add_u32 s32, s32, 6144
    s_waitcnt vmcnt(15)
    v_mfma_f32_16x16x32_bf16 v[12:15], v[68:71], v[36:39], v[12:15]
    buffer_load_dwordx4 v[68:71], v1, s[4:7], s32 offen offset:0 nt
    s_add_u32 s32, s32, 6144
    s_waitcnt vmcnt(15)
    v_mfma_f32_16x16x32_bf16 v[12:15], v[72:75], v[40:43], v[12:15]
    buffer_load_dwordx4 v[72:75], v1, s[4:7], s32 offen offset:0 nt
    s_add_u32 s32, s32, 6144
    s_waitcnt vmcnt(15)
    v_mfma_f32_16x16x32_bf16 v[12:15], v[76:79], v[44:47], v[12:15]
    buffer_load_dwordx4 v[76:79], v1, s[4:7], s32 offen offset:0 nt
    s_add_u32 s32, s32, 6144
    s_nop 5
    v_add_f32_dpp v57, v13, v12 quad_perm:[1,1,1,1] row_mask:0xf bank_mask:0xf
    s_nop 1
    v_add_f32_dpp v57, v14, v57 quad_perm:[2,2,2,2] row_mask:0xf bank_mask:0xf
    s_nop 1
    v_add_f32_dpp v57, v15, v57 quad_perm:[3,3,3,3] row_mask:0xf bank_mask:0xf
    s_waitcnt vmcnt(15)
    v_mfma_f32_16x16x32_bf16 v[16:19], v[80:83], v[32:35], 0
    buffer_load_dwordx4 v[80:83], v1, s[4:7], s32 offen offset:0 nt
    s_add_u32 s32, s32, 6144
    s_waitcnt vmcnt(15)
    v_mfma_f32_16x16x32_bf16 v[16:19], v[84:87], v[36:39], v[16:19]
    buffer_load_dwordx4 v[84:87], v1, s[4:7], s32 offen offset:0 nt
    s_add_u32 s32, s32, 6144
    s_waitcnt vmcnt(15)
    v_mfma_f32_16x16x32_bf16 v[16:19], v[88:91], v[40:43], v[16:19]
    buffer_load_dwordx4 v[88:91], v1, s[4:7], s32 offen offset:0 nt
    s_add_u32 s32, s32, 6144
    s_waitcnt vmcnt(15)
    v_mfma_f32_16x16x32_bf16 v[16:19], v[92:95], v[44:47], v[16:19]
    buffer_load_dwordx4 v[92:95], v1, s[4:7], s32 offen offset:0 nt
    s_add_u32 s32, s32, 6144
    s_nop 5
    v_add_f32_dpp v3, v16, v17 quad_perm:[0,0,0,0] row_mask:0xf bank_mask:0xf
    s_nop 1
    v_add_f32_dpp v3, v18, v3 quad_perm:[2,2,2,2] row_mask:0xf bank_mask:0xf
    s_nop 1
    v_add_f32_dpp v3, v19, v3 quad_perm:[3,3,3,3] row_mask:0xf bank_mask:0xf
    v_cndmask_b32 v57, v57, v3, s[64:65]
    s_waitcnt vmcnt(15)
    v_mfma_f32_16x16x32_bf16 v[12:15], v[96:99], v[32:35], 0
    buffer_load_dwordx4 v[96:99], v1, s[4:7], s32 offen offset:0 nt
    s_add_u32 s32, s32, 6144
    s_waitcnt vmcnt(15)
    v_mfma_f32_16x16x32_bf16 v[12:15], v[100:103], v[36:39], v[12:15]
    buffer_load_dwordx4 v[100:103], v1, s[4:7], s32 offen offset:0 nt
    s_add_u32 s32, s32, 6144
    s_waitcnt vmcnt(15)
    v_mfma_f32_16x16x32_bf16 v[12:15], v[104:107], v[40:43], v[12:15]
    buffer_load_dwordx4 v[104:107], v1, s[4:7], s32 offen offset:0 nt
    s_add_u32 s32, s32, 6144
    s_waitcnt vmcnt(15)
    v_mfma_f32_16x16x32_bf16 v[12:15], v[108:111], v[44:47], v[12:15]
    buffer_load_dwordx4 v[108:111], v1, s[4:7], s32 offen offset:0 nt
    s_add_u32 s32, s32, 6144
    s_nop 5
    v_add_f32_dpp v3, v12, v14 quad_perm:[0,0,0,0] row_mask:0xf bank_mask:0xf
    s_nop 1
    v_add_f32_dpp v3, v13, v3 quad_perm:[1,1,1,1] row_mask:0xf bank_mask:0xf
    s_nop 1
    v_add_f32_dpp v3, v15, v3 quad_perm:[3,3,3,3] row_mask:0xf bank_mask:0xf
    v_cndmask_b32 v57, v57, v3, s[66:67]
    s_waitcnt vmcnt(15)
    v_mfma_f32_16x16x32_bf16 v[16:19], v[112:115], v[32:35], 0
    buffer_load_dwordx4 v[112:115], v1, s[4:7], s32 offen offset:0 nt
    s_add_u32 s32, s32, 6144
    s_waitcnt vmcnt(15)
    v_mfma_f32_16x16x32_bf16 v[16:19], v[116:119], v[36:39], v[16:19]
    buffer_load_dwordx4 v[116:119], v1, s[4:7], s32 offen offset:0 nt
    s_add_u32 s32, s32, 6144
    s_waitcnt vmcnt(15)
    v_mfma_f32_16x16x32_bf16 v[16:19], v[120:123], v[40:43], v[16:19]
    buffer_load_dwordx4 v[120:123], v1, s[4:7], s32 offen offset:0 nt
    s_add_u32 s32, s32, 6144
    s_waitcnt vmcnt(15)
    v_mfma_f32_16x16x32_bf16 v[16:19], v[124:127], v[44:47], v[16:19]
    buffer_load_dwordx4 v[124:127], v1, s[4:7], s32 offen offset:0 nt
    s_add_u32 s32, s32, 6144
    s_nop 5
    v_add_f32_dpp v3, v16, v19 quad_perm:[0,0,0,0] row_mask:0xf bank_mask:0xf
    s_nop 1
    v_add_f32_dpp v3, v17, v3 quad_perm:[1,1,1,1] row_mask:0xf bank_mask:0xf
    s_nop 1
    v_add_f32_dpp v3, v18, v3 quad_perm:[2,2,2,2] row_mask:0xf bank_mask:0xf
    v_cndmask_b32 v57, v57, v3, s[68:69]
    s_cmp_lg_u32 s27, 3
    s_cbranch_scc1 L_BK_c0
    v_mfma_f32_16x16x32_bf16 v[12:15], a[64:67], v[32:35], 0
    v_mfma_f32_16x16x32_bf16 v[12:15], a[68:71], v[36:39], v[12:15]
    v_mfma_f32_16x16x32_bf16 v[12:15], a[72:75], v[40:43], v[12:15]
    v_mfma_f32_16x16x32_bf16 v[12:15], a[76:79], v[44:47], v[12:15]
    s_nop 7
    v_add_f32_dpp v48, v13, v12 quad_perm:[1,1,1,1] row_mask:0xf bank_mask:0xf
    s_nop 1
    v_add_f32_dpp v48, v14, v48 quad_perm:[2,2,2,2] row_mask:0xf bank_mask:0xf
    s_nop 1
    v_add_f32_dpp v48, v15, v48 quad_perm:[3,3,3,3] row_mask:0xf bank_mask:0xf
    v_mfma_f32_16x16x32_bf16 v[16:19], a[80:83], v[32:35], 0
    v_mfma_f32_16x16x32_bf16 v[16:19], a[84:87], v[36:39], v[16:19]
    v_mfma_f32_16x16x32_bf16 v[16:19], a[88:91], v[40:43], v[16:19]
    v_mfma_f32_16x16x32_bf16 v[16:19], a[92:95], v[44:47], v[16:19]
    s_nop 7
    v_add_f32_dpp v3, v16, v17 quad_perm:[0,0,0,0] row_mask:0xf bank_mask:0xf
    s_nop 1
    v_add_f32_dpp v3, v18, v3 quad_perm:[2,2,2,2] row_mask:0xf bank_mask:0xf
    s_nop 1
    v_add_f32_dpp v3, v19, v3 quad_perm:[3,3,3,3] row_mask:0xf bank_mask:0xf
    v_cndmask_b32 v48, v48, v3, s[64:65]
    v_mfma_f32_16x16x32_bf16 v[12:15], a[96:99], v[32:35], 0
    v_mfma_f32_16x16x32_bf16 v[12:15], a[100:103], v[36:39], v[12:15]
    v_mfma_f32_16x16x32_bf16 v[12:15], a[104:107], v[40:43], v[12:15]
    v_mfma_f32_16x16x32_bf16 v[12:15], a[108:111], v[44:47], v[12:15]
    s_nop 7
    v_add_f32_dpp v3, v12, v14 quad_perm:[0,0,0,0] row_mask:0xf bank_mask:0xf
    s_nop 1
    v_add_f32_dpp v3, v13, v3 quad_perm:[1,1,1,1] row_mask:0xf bank_mask:0xf
    s_nop 1
    v_add_f32_dpp v3, v15, v3 quad_perm:[3,3,3,3] row_mask:0xf bank_mask:0xf
    v_cndmask_b32 v48, v48, v3, s[66:67]
    v_mfma_f32_16x16x32_bf16 v[16:19], a[112:115], v[32:35], 0
    v_mfma_f32_16x16x32_bf16 v[16:19], a[116:119], v[36:39], v[16:19]
    v_mfma_f32_16x16x32_bf16 v[16:19], a[120:123], v[40:43], v[16:19]
    v_mfma_f32_16x16x32_bf16 v[16:19], a[124:127], v[44:47], v[16:19]
    s_nop 7
    v_add_f32_dpp v3, v16, v19 quad_perm:[0,0,0,0] row_mask:0xf bank_mask:0xf
    s_nop 1
    v_add_f32_dpp v3, v17, v3 quad_perm:[1,1,1,1] row_mask:0xf bank_mask:0xf
    s_nop 1
    v_add_f32_dpp v3, v18, v3 quad_perm:[2,2,2,2] row_mask:0xf bank_mask:0xf
    v_cndmask_b32 v48, v48, v3, s[68:69]
L_BK_c0:
    s_cmp_lg_u32 s27, 2
    s_cbranch_scc1 L_BK_b
    v_mfma_f32_16x16x32_bf16 v[12:15], a[0:3], v[32:35], 0
    v_mfma_f32_16x16x32_bf16 v[12:15], a[4:7], v[36:39], v[12:15]
    v_mfma_f32_16x16x32_bf16 v[12:15], a[8:11], v[40:43], v[12:15]
    v_mfma_f32_16x16x32_bf16 v[12:15], a[12:15], v[44:47], v[12:15]
    s_nop 7
    v_add_f32_dpp v58, v13, v12 quad_perm:[1,1,1,1] row_mask:0xf bank_mask:0xf
    s_nop 1
    v_add_f32_dpp v58, v14, v58 quad_perm:[2,2,2,2] row_mask:0xf bank_mask:0xf
    s_nop 1
    v_add_f32_dpp v58, v15, v58 quad_perm:[3,3,3,3] row_mask:0xf bank_mask:0xf
    v_mfma_f32_16x16x32_bf16 v[16:19], a[16:19], v[32:35], 0
    v_mfma_f32_16x16x32_bf16 v[16:19], a[20:23], v[36:39], v[16:19]
    v_mfma_f32_16x16x32_bf16 v[16:19], a[24:27], v[40:43], v[16:19]
    v_mfma_f32_16x16x32_bf16 v[16:19], a[28:31], v[44:47], v[16:19]
    s_nop 7
    v_add_f32_dpp v3, v16, v17 quad_perm:[0,0,0,0] row_mask:0xf bank_mask:0xf
    s_nop 1
    v_add_f32_dpp v3, v18, v3 quad_perm:[2,2,2,2] row_mask:0xf bank_mask:0xf
    s_nop 1
    v_add_f32_dpp v3, v19, v3 quad_perm:[3,3,3,3] row_mask:0xf bank_mask:0xf
    v_cndmask_b32 v58, v58, v3, s[64:65]
    v_mfma_f32_16x16x32_bf16 v[12:15], a[32:35], v[32:35], 0
    v_mfma_f32_16x16x32_bf16 v[12:15], a[36:39], v[36:39], v[12:15]
    v_mfma_f32_16x16x32_bf16 v[12:15], a[40:43], v[40:43], v[12:15]
    s_nop 7
    v_add_f32_dpp v3, v12, v14 quad_perm:[0,0,0,0] row_mask:0xf bank_mask:0xf
    s_nop 1
    v_add_f32_dpp v3, v13, v3 quad_perm:[1,1,1,1] row_mask:0xf bank_mask:0xf
    s_nop 1
    v_add_f32_dpp v3, v15, v3 quad_perm:[3,3,3,3] row_mask:0xf bank_mask:0xf
    v_cndmask_b32 v58, v58, v3, s[66:67]
    s_mul_i32 s24, s31, 1
    s_sub_i32 s24, 4, s24
    s_max_i32 s24, s24, 0
    s_min_i32 s24, s24, 1
    s_add_u32 s24, s24, 10
    v_and_b32 v3, 3, v0
    v_bfe_u32 v4, v0, 2, 2
    v_lshl_add_u32 v3, v3, 2, v4
    v_mov_b32 v4, 0xff800000
    v_cmp_gt_u32 vcc, s24, v3
    s_nop 1
    v_cndmask_b32 v58, v4, v58, vcc
    v_mov_b32 v61, 0x3e0293ee
    v_mov_b32 v7, 0
    s_lshr_b32 s34, s2, 3
    s_lshl_b32 s34, s34, 12
    s_and_b32 s24, s2, 7
    s_lshl_b32 s24, s24, 7
    s_add_u32 s34, s34, s24
    s_add_u32 s34, s34, 0x1b8000
L_BK_b:
    s_add_u32 s27, s27, 1
    s_cmp_lt_u32 s27, 10
    s_cbranch_scc1 L_BK
    v_max3_f32 v3, v48, v49, v50
    v_max3_f32 v3, v3, v51, v52
    v_max3_f32 v3, v3, v53, v54
    v_max3_f32 v3, v3, v55, v56
    v_max3_f32 v3, v3, v57, v58
    s_nop 1
    v_max_f32_dpp v3, v3, v3 row_ror:8 row_mask:0xf bank_mask:0xf
    s_nop 1
    v_max_f32_dpp v3, v3, v3 row_ror:4 row_mask:0xf bank_mask:0xf
    s_nop 1
    v_max_f32_dpp v3, v3, v3 row_ror:2 row_mask:0xf bank_mask:0xf
    s_nop 1
    v_max_f32_dpp v3, v3, v3 row_ror:1 row_mask:0xf bank_mask:0xf
    s_nop 1
    v_max_f32_dpp v3, v3, v3 row_bcast:15 row_mask:0xa bank_mask:0xf
    s_nop 1
    v_max_f32_dpp v3, v3, v3 row_bcast:31 row_mask:0xc bank_mask:0xf
    s_nop 0
    v_readlane_b32 s24, v3, 63
    s_nop 1
    v_mul_f32 v6, s24, v61
    v_mov_b32 v12, 0
    v_mov_b32 v13, 0
    v_mov_b32 v14, 0
    v_mov_b32 v15, 0
    v_fma_f32 v48, v48, v61, -v6
    v_exp_f32 v48, v48
    s_nop 0
    v_add_f32 v7, v7, v48
    v_cvt_pk_bf16_f32 v48, v48, v48
    s_mov_b32 s27, 0
L_BV:
    s_barrier
    s_cmp_ge_u32 s27, 1
    s_cselect_b32 s71, s3, 4
    s_cmp_lg_u32 s71, 0
    s_cbranch_scc1 L_BV_p0
    s_lshl_b32 s24, s27, 2
    s_add_u32 s24, s24, 0
    s_mov_b64 exec, 1
    v_mov_b32 v63, s24
    s_cmp_lg_u32 s75, 0
    s_cbranch_scc1 L_far3
    buffer_store_dword v63, off, s[12:15], s34 offset:64
    s_branch L_near3
L_far3:
    buffer_store_dword v63, off, s[12:15], s34 offset:64 sc1
L_near3:
    s_mov_b64 exec, -1
L_BV_p0:
    v_and_b32_dpp v8, v48, v20 row_newbcast:0 row_mask:0xf bank_mask:0xf
    v_and_b32_dpp v9, v48, v21 row_newbcast:0 row_mask:0xf bank_mask:0xf
    v_and_b32_dpp v10, v48, v22 row_newbcast:0 row_mask:0xf bank_mask:0xf
    v_and_b32_dpp v11, v48, v23 row_newbcast:0 row_mask:0xf bank_mask:0xf
    s_waitcnt vmcnt(15)
    s_nop 0
    v_mfma_f32_16x16x32_bf16 v[12:15], v[64:67], v[8:11], v[12:15]
    buffer_load_dwordx4 v[64:67], v1, s[4:7], s32 offen offset:0 nt
    s_add_u32 s32, s32, 6144
    v_and_b32_dpp v8, v48, v20 row_newbcast:4 row_mask:0xf bank_mask:0xf
    v_and_b32_dpp v9, v48, v21 row_newbcast:4 row_mask:0xf bank_mask:0xf
    v_and_b32_dpp v10, v48, v22 row_newbcast:4 row_mask:0xf bank_mask:0xf
    v_and_b32_dpp v11, v48, v23 row_newbcast:4 row_mask:0xf bank_mask:0xf
    s_waitcnt vmcnt(15)
    s_nop 0
    v_mfma_f32_16x16x32_bf16 v[12:15], v[68:71], v[8:11], v[12:15]
    buffer_load_dwordx4 v[68:71], v1, s[4:7], s32 offen offset:0 nt
    s_add_u32 s32, s32, 6144
    v_and_b32_dpp v8, v48, v20 row_newbcast:8 row_mask:0xf bank_mask:0xf
    v_and_b32_dpp v9, v48, v21 row_newbcast:8 row_mask:0xf bank_mask:0xf
    v_and_b32_dpp v10, v48, v22 row_newbcast:8 row_mask:0xf bank_mask:0xf
    v_and_b32_dpp v11, v48, v23 row_newbcast:8 row_mask:0xf bank_mask:0xf
    s_waitcnt vmcnt(15)
    s_nop 0
    v_mfma_f32_16x16x32_bf16 v[12:15], v[72:75], v[8:11], v[12:15]
    buffer_load_dwordx4 v[72:75], v1, s[4:7], s32 offen offset:0 nt
    s_add_u32 s32, s32, 6144
    v_and_b32_dpp v8, v48, v20 row_newbcast:12 row_mask:0xf bank_mask:0xf
    v_and_b32_dpp v9, v48, v21 row_newbcast:12 row_mask:0xf bank_mask:0xf
    v_and_b32_dpp v10, v48, v22 row_newbcast:12 row_mask:0xf bank_mask:0xf
    v_and_b32_dpp v11, v48, v23 row_newbcast:12 row_mask:0xf bank_mask:0xf
    s_waitcnt vmcnt(15)
    s_nop 0
    v_mfma_f32_16x16x32_bf16 v[12:15], v[76:79], v[8:11], v[12:15]
    buffer_load_dwordx4 v[76:79], v1, s[4:7], s32 offen offset:0 nt
    s_add_u32 s32, s32, 6144
    s_cmp_lg_u32 s71, 1
    s_cbranch_scc1 L_BV_p1
    s_lshl_b32 s24, s27, 2
    s_add_u32 s24, s24, 1
    s_mov_b64 exec, 1
    v_mov_b32 v63, s24
    s_cmp_lg_u32 s75, 0
    s_cbranch_scc1 L_far4
    buffer_store_dword v63, off, s[12:15], s34 offset:64
    s_branch L_near4
L_far4:
    buffer_store_dword v63, off, s[12:15], s34 offset:64 sc1
L_near4:
    s_mov_b64 exec, -1
L_BV_p1:
    v_and_b32_dpp v8, v48, v20 row_newbcast:1 row_mask:0xf bank_mask:0xf
    v_and_b32_dpp v9, v48, v21 row_newbcast:1 row_mask:0xf bank_mask:0xf
    v_and_b32_dpp v10, v48, v22 row_newbcast:1 row_mask:0xf bank_mask:0xf
    v_and_b32_dpp v11, v48, v23 row_newbcast:1 row_mask:0xf bank_mask:0xf
    s_waitcnt vmcnt(15)
    s_nop 0
    v_mfma_f32_16x16x32_bf16 v[12:15], v[80:83], v[8:11], v[12:15]
    buffer_load_dwordx4 v[80:83], v1, s[4:7], s32 offen offset:0 nt
    s_add_u32 s32, s32, 6144
    v_and_b32_dpp v8, v48, v20 row_newbcast:5 row_mask:0xf bank_mask:0xf
    v_and_b32_dpp v9, v48, v21 row_newbcast:5 row_mask:0xf bank_mask:0xf
    v_and_b32_dpp v10, v48, v22 row_newbcast:5 row_mask:0xf bank_mask:0xf
    v_and_b32_dpp v11, v48, v23 row_newbcast:5 row_mask:0xf bank_mask:0xf
    s_waitcnt vmcnt(15)
    s_nop 0
    v_mfma_f32_16x16x32_bf16 v[12:15], v[84:87], v[8:11], v[12:15]
    buffer_load_dwordx4 v[84:87], v1, s[4:7], s32 offen offset:0 nt
    s_add_u32 s32, s32, 6144
    v_and_b32_dpp v8, v48, v20 row_newbcast:9 row_mask:0xf bank_mask:0xf
    v_and_b32_dpp v9, v48, v21 row_newbcast:9 row_mask:0xf bank_mask:0xf
    v_and_b32_dpp v10, v48, v22 row_newbcast:9 row_mask:0xf bank_mask:0xf
    v_and_b32_dpp v11, v48, v23 row_newbcast:9 row_mask:0xf bank_mask:0xf
    s_waitcnt vmcnt(15)
    s_nop 0
    v_mfma_f32_16x16x32_bf16 v[12:15], v[88:91], v[8:11], v[12:15]
    buffer_load_dwordx4 v[88:91], v1, s[4:7], s32 offen offset:0 nt
    s_add_u32 s32, s32, 6144
    v_and_b32_dpp v8, v48, v20 row_newbcast:13 row_mask:0xf bank_mask:0xf
    v_and_b32_dpp v9, v48, v21 row_newbcast:13 row_mask:0xf bank_mask:0xf
    v_and_b32_dpp v10, v48, v22 row_newbcast:13 row_mask:0xf bank_mask:0xf
    v_and_b32_dpp v11, v48, v23 row_newbcast:13 row_mask:0xf bank_mask:0xf
    s_waitcnt vmcnt(15)
    s_nop 0
    v_mfma_f32_16x16x32_bf16 v[12:15], v[92:95], v[8:11], v[12:15]
    buffer_load_dwordx4 v[92:95], v1, s[4:7], s32 offen offset:0 nt
    s_add_u32 s32, s32, 6144
    s_cmp_lg_u32 s71, 2
    s_cbranch_scc1 L_BV_p2
    s_lshl_b32 s24, s27, 2
    s_add_u32 s24, s24, 2
    s_mov_b64 exec, 1
    v_mov_b32 v63, s24
    s_cmp_lg_u32 s75, 0
    s_cbranch_scc1 L_far5
    buffer_store_dword v63, off, s[12:15], s34 offset:64
    s_branch L_near5
L_far5:
    buffer_store_dword v63, off, s[12:15], s34 offset:64 sc1
L_near5:
    s_mov_b64 exec, -1
L_BV_p2:
    v_and_b32_dpp v8, v48, v20 row_newbcast:2 row_mask:0xf bank_mask:0xf
    v_and_b32_dpp v9, v48, v21 row_newbcast:2 row_mask:0xf bank_mask:0xf
    v_and_b32_dpp v10, v48, v22 row_newbcast:2 row_mask:0xf bank_mask:0xf
    v_and_b32_dpp v11, v48, v23 row_newbcast:2 row_mask:0xf bank_mask:0xf
    s_waitcnt vmcnt(15)
    s_nop 0
    v_mfma_f32_16x16x32_bf16 v[12:15], v[96:99], v[8:11], v[12:15]
    buffer_load_dwordx4 v[96:99], v1, s[4:7], s32 offen offset:0 nt
    s_add_u32 s32, s32, 6144
    v_and_b32_dpp v8, v48, v20 row_newbcast:6 row_mask:0xf bank_mask:0xf
    v_and_b32_dpp v9, v48, v21 row_newbcast:6 row_mask:0xf bank_mask:0xf
    v_and_b32_dpp v10, v48, v22 row_newbcast:6 row_mask:0xf bank_mask:0xf
    v_and_b32_dpp v11, v48, v23 row_newbcast:6 row_mask:0xf bank_mask:0xf
    s_waitcnt vmcnt(15)
    s_nop 0
    v_mfma_f32_16x16x32_bf16 v[12:15], v[100:103], v[8:11], v[12:15]
    buffer_load_dwordx4 v[100:103], v1, s[4:7], s32 offen offset:0 nt
    s_add_u32 s32, s32, 6144
    s_cmp_eq_u32 s27, 9
    s_cbranch_scc1 L_BT
    v_and_b32_dpp v8, v48, v20 row_newbcast:10 row_mask:0xf bank_mask:0xf
    v_and_b32_dpp v9, v48, v21 row_newbcast:10 row_mask:0xf bank_mask:0xf
    v_and_b32_dpp v10, v48, v22 row_newbcast:10 row_mask:0xf bank_mask:0xf
    v_and_b32_dpp v11, v48, v23 row_newbcast:10 row_mask:0xf bank_mask:0xf
    s_waitcnt vmcnt(15)
    s_nop 0
    v_mfma_f32_16x16x32_bf16 v[12:15], v[104:107], v[8:11], v[12:15]
    buffer_load_dwordx4 v[104:107], v1, s[4:7], s32 offen offset:0 nt
    s_add_u32 s32, s32, 6144
    v_and_b32_dpp v8, v48, v20 row_newbcast:14 row_mask:0xf bank_mask:0xf
    v_and_b32_dpp v9, v48, v21 row_newbcast:14 row_mask:0xf bank_mask:0xf
    v_and_b32_dpp v10, v48, v22 row_newbcast:14 row_mask:0xf bank_mask:0xf
    v_and_b32_dpp v11, v48, v23 row_newbcast:14 row_mask:0xf bank_mask:0xf
    s_waitcnt vmcnt(15)
    s_nop 0
    v_mfma_f32_16x16x32_bf16 v[12:15], v[108:111], v[8:11], v[12:15]
    buffer_load_dwordx4 v[108:111], v1, s[4:7], s32 offen offset:0 nt
    s_add_u32 s32, s32, 6144
    s_cmp_lg_u32 s71, 3
    s_cbranch_scc1 L_BV_p3
    s_lshl_b32 s24, s27, 2
    s_add_u32 s24, s24, 3
    s_mov_b64 exec, 1
    v_mov_b32 v63, s24
    s_cmp_lg_u32 s75, 0
    s_cbranch_scc1 L_far6
    buffer_store_dword v63, off, s[12:15], s34 offset:64
    s_branch L_near6
L_far6:
    buffer_store_dword v63, off, s[12:15], s34 offset:64 sc1
L_near6:
    s_mov_b64 exec, -1
L_BV_p3:
    v_and_b32_dpp v8, v48, v20 row_newbcast:3 row_mask:0xf bank_mask:0xf
    v_and_b32_dpp v9, v48, v21 row_newbcast:3 row_mask:0xf bank_mask:0xf
    v_and_b32_dpp v10, v48, v22 row_newbcast:3 row_mask:0xf bank_mask:0xf
    v_and_b32_dpp v11, v48, v23 row_newbcast:3 row_mask:0xf bank_mask:0xf
    s_waitcnt vmcnt(15)
    s_nop 0
    v_mfma_f32_16x16x32_bf16 v[12:15], v[112:115], v[8:11], v[12:15]
    buffer_load_dwordx4 v[112:115], v1, s[4:7], s32 offen offset:0 nt
    s_add_u32 s32, s32, 6144
    s_cmp_lg_u32 s27, 0
    s_cbranch_scc1 L_BV_d
    v_fma_f32 v49, v49, v61, -v6
    v_fma_f32 v50, v50, v61, -v6
    v_fma_f32 v51, v51, v61, -v6
    v_fma_f32 v52, v52, v61, -v6
    v_fma_f32 v53, v53, v61, -v6
    v_fma_f32 v54, v54, v61, -v6
    v_fma_f32 v55, v55, v61, -v6
    v_fma_f32 v56, v56, v61, -v6
    v_fma_f32 v57, v57, v61, -v6
    v_fma_f32 v58, v58, v61, -v6
    v_exp_f32 v49, v49
    v_exp_f32 v50, v50
    v_exp_f32 v51, v51
    v_exp_f32 v52, v52
    v_exp_f32 v53, v53
    v_exp_f32 v54, v54
    v_exp_f32 v55, v55
    v_exp_f32 v56, v56
    v_exp_f32 v57, v57
    v_exp_f32 v58, v58
    v_add_f32 v7, v7, v49
    v_add_f32 v7, v7, v50
    v_add_f32 v7, v7, v51
    v_add_f32 v7, v7, v52
    v_add_f32 v7, v7, v53
    v_add_f32 v7, v7, v54
    v_add_f32 v7, v7, v55
    v_add_f32 v7, v7, v56
    v_add_f32 v7, v7, v57
    v_add_f32 v7, v7, v58
    v_cvt_pk_bf16_f32 v49, v49, v49
    v_cvt_pk_bf16_f32 v50, v50, v50
    v_cvt_pk_bf16_f32 v51, v51, v51
    v_cvt_pk_bf16_f32 v52, v52, v52
    v_cvt_pk_bf16_f32 v53, v53, v53
    v_cvt_pk_bf16_f32 v54, v54, v54
    v_cvt_pk_bf16_f32 v55, v55, v55
    v_cvt_pk_bf16_f32 v56, v56, v56
    v_cvt_pk_bf16_f32 v57, v57, v57
    v_cvt_pk_bf16_f32 v58, v58, v58
    v_add_f32_dpp v7, v7, v7 row_ror:8 row_mask:0xf bank_mask:0xf
    s_nop 1
    v_add_f32_dpp v7, v7, v7 row_ror:4 row_mask:0xf bank_mask:0xf
    s_nop 1
    v_add_f32_dpp v7, v7, v7 row_ror:2 row_mask:0xf bank_mask:0xf
    s_nop 1
    v_add_f32_dpp v7, v7, v7 row_ror:1 row_mask:0xf bank_mask:0xf
    s_nop 1
    v_add_f32_dpp v7, v7, v7 row_bcast:15 row_mask:0xa bank_mask:0xf
    s_nop 1
    v_add_f32_dpp v7, v7, v7 row_bcast:31 row_mask:0xc bank_mask:0xf
    s_nop 0
    v_readlane_b32 s70, v7, 63
    s_lshl_b32 s25, s3, 4
    s_add_u32 s25, s25, s34
    s_mov_b64 exec, 1
    v_mov_b32 v7, s70
    s_cmp_lg_u32 s75, 0
    s_cbranch_scc1 L_far7
    buffer_store_dwordx2 v[6:7], off, s[12:15], s25
    s_branch L_near7
L_far7:
    buffer_store_dwordx2 v[6:7], off, s[12:15], s25 sc1
L_near7:
    s_mov_b64 exec, -1
L_BV_d:
    v_and_b32_dpp v8, v48, v20 row_newbcast:7 row_mask:0xf bank_mask:0xf
    v_and_b32_dpp v9, v48, v21 row_newbcast:7 row_mask:0xf bank_mask:0xf
    v_and_b32_dpp v10, v48, v22 row_newbcast:7 row_mask:0xf bank_mask:0xf
    v_and_b32_dpp v11, v48, v23 row_newbcast:7 row_mask:0xf bank_mask:0xf
    s_waitcnt vmcnt(15)
    s_nop 0
    v_mfma_f32_16x16x32_bf16 v[12:15], v[116:119], v[8:11], v[12:15]
    buffer_load_dwordx4 v[116:119], v1, s[4:7], s32 offen offset:0 nt
    s_add_u32 s32, s32, 6144
    v_and_b32_dpp v8, v48, v20 row_newbcast:11 row_mask:0xf bank_mask:0xf
    v_and_b32_dpp v9, v48, v21 row_newbcast:11 row_mask:0xf bank_mask:0xf
    v_and_b32_dpp v10, v48, v22 row_newbcast:11 row_mask:0xf bank_mask:0xf
    v_and_b32_dpp v11, v48, v23 row_newbcast:11 row_mask:0xf bank_mask:0xf
    s_waitcnt vmcnt(15)
    s_nop 0
    v_mfma_f32_16x16x32_bf16 v[12:15], v[120:123], v[8:11], v[12:15]
    buffer_load_dwordx4 v[120:123], v1, s[4:7], s32 offen offset:0 nt
    s_add_u32 s32, s32, 6144
    v_and_b32_dpp v8, v48, v20 row_newbcast:15 row_mask:0xf bank_mask:0xf
    v_and_b32_dpp v9, v48, v21 row_newbcast:15 row_mask:0xf bank_mask:0xf
    v_and_b32_dpp v10, v48, v22 row_newbcast:15 row_mask:0xf bank_mask:0xf
    v_and_b32_dpp v11, v48, v23 row_newbcast:15 row_mask:0xf bank_mask:0xf
    s_waitcnt vmcnt(15)
    s_nop 0
    v_mfma_f32_16x16x32_bf16 v[12:15], v[124:127], v[8:11], v[12:15]
    buffer_load_dwordx4 v[124:127], v1, s[4:7], s32 offen offset:0 nt
    s_add_u32 s32, s32, 6144
    v_mov_b32 v48, v49
    v_mov_b32 v49, v50
    v_mov_b32 v50, v51
    v_mov_b32 v51, v52
    v_mov_b32 v52, v53
    v_mov_b32 v53, v54
    v_mov_b32 v54, v55
    v_mov_b32 v55, v56
    v_mov_b32 v56, v57
    v_mov_b32 v57, v58
    s_add_u32 s27, s27, 1
    s_branch L_BV
L_BT:
    v_and_b32_dpp v8, v48, v20 row_newbcast:10 row_mask:0xf bank_mask:0xf
    v_and_b32_dpp v9, v48, v21 row_newbcast:10 row_mask:0xf bank_mask:0xf
    v_and_b32_dpp v10, v48, v22 row_newbcast:10 row_mask:0xf bank_mask:0xf
    v_and_b32_dpp v11, v48, v23 row_newbcast:10 row_mask:0xf bank_mask:0xf
    s_waitcnt vmcnt(15)
    s_nop 0
    v_mfma_f32_16x16x32_bf16 v[12:15], v[104:107], v[8:11], v[12:15]
    buffer_load_dwordx4 v[104:107], v1, s[4:7], s28 offen offset:0 nt
    v_and_b32_dpp v8, v48, v20 row_newbcast:14 row_mask:0xf bank_mask:0xf
    v_and_b32_dpp v9, v48, v21 row_newbcast:14 row_mask:0xf bank_mask:0xf
    v_and_b32_dpp v10, v48, v22 row_newbcast:14 row_mask:0xf bank_mask:0xf
    v_and_b32_dpp v11, v48, v23 row_newbcast:14 row_mask:0xf bank_mask:0xf
    s_waitcnt vmcnt(15)
    s_nop 0
    v_mfma_f32_16x16x32_bf16 v[12:15], v[108:111], v[8:11], v[12:15]
    v_and_b32_dpp v8, v48, v20 row_newbcast:3 row_mask:0xf bank_mask:0xf
    v_and_b32_dpp v9, v48, v21 row_newbcast:3 row_mask:0xf bank_mask:0xf
    v_and_b32_dpp v10, v48, v22 row_newbcast:3 row_mask:0xf bank_mask:0xf
    v_and_b32_dpp v11, v48, v23 row_newbcast:3 row_mask:0xf bank_mask:0xf
    s_waitcnt vmcnt(14)
    s_nop 0
    v_mfma_f32_16x16x32_bf16 v[12:15], v[112:115], v[8:11], v[12:15]
    v_and_b32_dpp v8, v48, v20 row_newbcast:7 row_mask:0xf bank_mask:0xf
    v_and_b32_dpp v9, v48, v21 row_newbcast:7 row_mask:0xf bank_mask:0xf
    v_and_b32_dpp v10, v48, v22 row_newbcast:7 row_mask:0xf bank_mask:0xf
    v_and_b32_dpp v11, v48, v23 row_newbcast:7 row_mask:0xf bank_mask:0xf
    s_waitcnt vmcnt(13)
    s_nop 0
    v_mfma_f32_16x16x32_bf16 v[12:15], v[116:119], v[8:11], v[12:15]
    v_and_b32_dpp v8, v48, v20 row_newbcast:11 row_mask:0xf bank_mask:0xf
    v_and_b32_dpp v9, v48, v21 row_newbcast:11 row_mask:0xf bank_mask:0xf
    v_and_b32_dpp v10, v48, v22 row_newbcast:11 row_mask:0xf bank_mask:0xf
    v_and_b32_dpp v11, v48, v23 row_newbcast:11 row_mask:0xf bank_mask:0xf
    s_waitcnt vmcnt(12)
    s_nop 0
    v_mfma_f32_16x16x32_bf16 v[12:15], v[120:123], v[8:11], v[12:15]
    v_and_b32_dpp v8, v48, v20 row_newbcast:15 row_mask:0xf bank_mask:0xf
    v_and_b32_dpp v9, v48, v21 row_newbcast:15 row_mask:0xf bank_mask:0xf
    v_and_b32_dpp v10, v48, v22 row_newbcast:15 row_mask:0xf bank_mask:0xf
    v_and_b32_dpp v11, v48, v23 row_newbcast:15 row_mask:0xf bank_mask:0xf
    s_waitcnt vmcnt(11)
    s_nop 0
    v_mfma_f32_16x16x32_bf16 v[12:15], v[124:127], v[8:11], v[12:15]
    v_and_b32_dpp v8, v49, v20 row_newbcast:0 row_mask:0xf bank_mask:0xf
    v_and_b32_dpp v9, v49, v21 row_newbcast:0 row_mask:0xf bank_mask:0xf
    v_and_b32_dpp v10, v49, v22 row_newbcast:0 row_mask:0xf bank_mask:0xf
    v_and_b32_dpp v11, v49, v23 row_newbcast:0 row_mask:0xf bank_mask:0xf
    s_waitcnt vmcnt(10)
    s_nop 0
    v_mfma_f32_16x16x32_bf16 v[12:15], v[64:67], v[8:11], v[12:15]
    v_and_b32_dpp v8, v49, v20 row_newbcast:4 row_mask:0xf bank_mask:0xf
    v_and_b32_dpp v9, v49, v21 row_newbcast:4 row_mask:0xf bank_mask:0xf
    v_and_b32_dpp v10, v49, v22 row_newbcast:4 row_mask:0xf bank_mask:0xf
    v_and_b32_dpp v11, v49, v23 row_newbcast:4 row_mask:0xf bank_mask:0xf
    s_waitcnt vmcnt(9)
    s_nop 0
    v_mfma_f32_16x16x32_bf16 v[12:15], v[68:71], v[8:11], v[12:15]
    v_and_b32_dpp v8, v49, v20 row_newbcast:8 row_mask:0xf bank_mask:0xf
    v_and_b32_dpp v9, v49, v21 row_newbcast:8 row_mask:0xf bank_mask:0xf
    v_and_b32_dpp v10, v49, v22 row_newbcast:8 row_mask:0xf bank_mask:0xf
    v_and_b32_dpp v11, v49, v23 row_newbcast:8 row_mask:0xf bank_mask:0xf
    s_waitcnt vmcnt(8)
    s_nop 0
    v_mfma_f32_16x16x32_bf16 v[12:15], v[72:75], v[8:11], v[12:15]
    v_and_b32_dpp v8, v49, v20 row_newbcast:12 row_mask:0xf bank_mask:0xf
    v_and_b32_dpp v9, v49, v21 row_newbcast:12 row_mask:0xf bank_mask:0xf
    v_and_b32_dpp v10, v49, v22 row_newbcast:12 row_mask:0xf bank_mask:0xf
    v_and_b32_dpp v11, v49, v23 row_newbcast:12 row_mask:0xf bank_mask:0xf
    s_waitcnt vmcnt(7)
    s_nop 0
    v_mfma_f32_16x16x32_bf16 v[12:15], v[76:79], v[8:11], v[12:15]
    v_and_b32_dpp v8, v49, v20 row_newbcast:1 row_mask:0xf bank_mask:0xf
    v_and_b32_dpp v9, v49, v21 row_newbcast:1 row_mask:0xf bank_mask:0xf
    v_and_b32_dpp v10, v49, v22 row_newbcast:1 row_mask:0xf bank_mask:0xf
    v_and_b32_dpp v11, v49, v23 row_newbcast:1 row_mask:0xf bank_mask:0xf
    s_waitcnt vmcnt(6)
    s_nop 0
    v_mfma_f32_16x16x32_bf16 v[12:15], v[80:83], v[8:11], v[12:15]
    v_and_b32_dpp v8, v49, v20 row_newbcast:5 row_mask:0xf bank_mask:0xf
    v_and_b32_dpp v9, v49, v21 row_newbcast:5 row_mask:0xf bank_mask:0xf
    v_and_b32_dpp v10, v49, v22 row_newbcast:5 row_mask:0xf bank_mask:0xf
    v_and_b32_dpp v11, v49, v23 row_newbcast:5 row_mask:0xf bank_mask:0xf
    s_waitcnt vmcnt(5)
    s_nop 0
    v_mfma_f32_16x16x32_bf16 v[12:15], v[84:87], v[8:11], v[12:15]
    v_and_b32_dpp v8, v49, v20 row_newbcast:9 row_mask:0xf bank_mask:0xf
    v_and_b32_dpp v9, v49, v21 row_newbcast:9 row_mask:0xf bank_mask:0xf
    v_and_b32_dpp v10, v49, v22 row_newbcast:9 row_mask:0xf bank_mask:0xf
    v_and_b32_dpp v11, v49, v23 row_newbcast:9 row_mask:0xf bank_mask:0xf
    s_waitcnt vmcnt(4)
    s_nop 0
    v_mfma_f32_16x16x32_bf16 v[12:15], v[88:91], v[8:11], v[12:15]
    v_and_b32_dpp v8, v49, v20 row_newbcast:13 row_mask:0xf bank_mask:0xf
    v_and_b32_dpp v9, v49, v21 row_newbcast:13 row_mask:0xf bank_mask:0xf
    v_and_b32_dpp v10, v49, v22 row_newbcast:13 row_mask:0xf bank_mask:0xf
    v_and_b32_dpp v11, v49, v23 row_newbcast:13 row_mask:0xf bank_mask:0xf
    s_waitcnt vmcnt(3)
    s_nop 0
    v_mfma_f32_16x16x32_bf16 v[12:15], v[92:95], v[8:11], v[12:15]
    v_and_b32_dpp v8, v49, v20 row_newbcast:2 row_mask:0xf bank_mask:0xf
    v_and_b32_dpp v9, v49, v21 row_newbcast:2 row_mask:0xf bank_mask:0xf
    v_and_b32_dpp v10, v49, v22 row_newbcast:2 row_mask:0xf bank_mask:0xf
    v_and_b32_dpp v11, v49, v23 row_newbcast:2 row_mask:0xf bank_mask:0xf
    s_waitcnt vmcnt(2)
    s_nop 0
    v_mfma_f32_16x16x32_bf16 v[12:15], v[96:99], v[8:11], v[12:15]
    v_and_b32_dpp v8, v49, v20 row_newbcast:6 row_mask:0xf bank_mask:0xf
    v_and_b32_dpp v9, v49, v21 row_newbcast:6 row_mask:0xf bank_mask:0xf
    v_and_b32_dpp v10, v49, v22 row_newbcast:6 row_mask:0xf bank_mask:0xf
    v_and_b32_dpp v11, v49, v23 row_newbcast:6 row_mask:0xf bank_mask:0xf
    s_waitcnt vmcnt(1)
    s_nop 0
    v_mfma_f32_16x16x32_bf16 v[12:15], v[100:103], v[8:11], v[12:15]
    v_and_b32_dpp v8, v49, v20 row_newbcast:10 row_mask:0xf bank_mask:0xf
    v_and_b32_dpp v9, v49, v21 row_newbcast:10 row_mask:0xf bank_mask:0xf
    v_and_b32_dpp v10, v49, v22 row_newbcast:10 row_mask:0xf bank_mask:0xf
    v_and_b32_dpp v11, v49, v23 row_newbcast:10 row_mask:0xf bank_mask:0xf
    s_waitcnt vmcnt(0)
    s_nop 0
    v_mfma_f32_16x16x32_bf16 v[12:15], v[104:107], v[8:11], v[12:15]
    s_mov_b32 exec_lo, 0x00ff00ff
    s_mov_b32 exec_hi, 0x00ff00ff
    s_cmp_lg_u32 s75, 0
    s_nop 4
    v_cvt_pk_bf16_f32 v4, v12, v13
    v_cvt_pk_bf16_f32 v5, v14, v15
    s_cbranch_scc1 L_far8
    buffer_store_dwordx2 v[4:5], v60, s[12:15], s73 offen
    s_branch L_near8
L_far8:
    buffer_store_dwordx2 v[4:5], v60, s[12:15], s73 offen sc1
L_near8:
    s_endpgm
L_A:
    v_lshrrev_b32 v1, 6, v0
    v_and_b32 v0, 63, v0
    v_readfirstlane_b32 s3, v1
    v_lshlrev_b32 v2, 4, v0
    s_mov_b32 s74, s2
    s_and_b32 s72, s2, 31
    s_and_b32 s70, s2, 6
    s_and_b32 s25, s2, 7
    s_add_u32 s70, s70, s25
    s_lshr_b32 s26, s72, 3
    s_and_b32 s25, s26, 1
    s_lshl_b32 s25, s25, 1
    s_and_b32 s26, s26, 2
    s_lshl_b32 s26, s26, 3
    s_or_b32 s26, s26, s25
    s_or_b32 s26, s26, s70
    v_lshrrev_b32 v3, 4, v0
    v_and_b32 v4, 15, v0
    v_lshlrev_b32 v18, 18, v3
    v_lshl_add_u32 v18, v4, 4, v18
    v_lshrrev_b32 v6, 3, v4
    v_lshlrev_b32 v6, 10, v6
    v_lshl_add_u32 v19, v3, 6, v6
    v_bfe_u32 v1, v0, 2, 2
    v_lshlrev_b32 v64, 18, v1
    v_lshl_add_u32 v64, v3, 6, v64
    v_and_b32 v4, 3, v0
    v_lshl_add_u32 v64, v4, 4, v64
    v_lshlrev_b32 v65, 9, v1
    v_lshl_add_u32 v65, v3, 7, v65
    v_lshl_add_u32 v65, v4, 5, v65
    v_add_u32 v65, 135168, v65
    v_lshlrev_b32 v66, 17, v1
    v_lshl_add_u32 v66, v3, 6, v66
    v_lshl_add_u32 v66, v4, 4, v66
    v_and_b32 v4, 15, v0
    v_lshlrev_b32 v67, 10, v3
    v_lshl_add_u32 v67, v4, 4, v67
    s_lshl_b32 s35, s3, 20
    s_lshl_b32 s24, s26, 8
    s_add_u32 s35, s35, s24
    s_waitcnt lgkmcnt(0)
    s_cmp_lt_u32 s74, 32
    s_cselect_b64 s[4:5], s[40:41], s[54:55]
    s_mov_b32 s6, 0x400000
    s_mov_b32 s7, 0x20000
    s_cselect_b64 s[20:21], s[36:37], s[48:49]
    s_mov_b32 s22, 4096
    s_mov_b32 s23, 0x20000
    s_cselect_b32 s75, 0x400000, 0
    s_lshl_b32 s24, s3, 8
    s_mov_b32 s32, s35
    buffer_load_dwordx4 v[12:15], v67, s[20:23], s24 offen
    buffer_load_dwordx4 v[128:131], v18, s[4:7], s32 offen
    s_add_u32 s32, s32, 8192
    buffer_load_dwordx4 v[132:135], v18, s[4:7], s32 offen
    s_add_u32 s32, s32, 8192
    buffer_load_dwordx4 v[136:139], v18, s[4:7], s32 offen
    s_add_u32 s32, s32, 8192
    buffer_load_dwordx4 v[140:143], v18, s[4:7], s32 offen
    s_add_u32 s32, s32, 8192
    buffer_load_dwordx4 v[144:147], v18, s[4:7], s32 offen
    s_add_u32 s32, s32, 8192
    buffer_load_dwordx4 v[148:151], v18, s[4:7], s32 offen
    s_add_u32 s32, s32, 8192
    buffer_load_dwordx4 v[152:155], v18, s[4:7], s32 offen
    s_add_u32 s32, s32, 8192
    buffer_load_dwordx4 v[156:159], v18, s[4:7], s32 offen
    s_add_u32 s32, s32, 8192
    buffer_load_dwordx4 v[160:163], v18, s[4:7], s32 offen
    s_add_u32 s32, s32, 8192
    buffer_load_dwordx4 v[164:167], v18, s[4:7], s32 offen
    s_add_u32 s32, s32, 8192
    buffer_load_dwordx4 v[168:171], v18, s[4:7], s32 offen
    s_add_u32 s32, s32, 8192
    buffer_load_dwordx4 v[172:175], v18, s[4:7], s32 offen
    s_add_u32 s32, s32, 8192
    s_mov_b32 s12, s62
    s_mov_b32 s13, s63
    s_mov_b32 s14, 0x600000
    s_mov_b32 s15, 0x20000
    s_mov_b32 s16, s60
    s_mov_b32 s17, s61
    s_mov_b32 s18, 0x100
    s_mov_b32 s19, 0x20000
    v_and_b32 v3, 1, v0
    v_lshlrev_b32 v3, 4, v3
    v_mov_b32 v4, 0xffff
    v_lshlrev_b32 v4, v3, v4
    v_bfe_u32 v3, v0, 1, 2
    v_cmp_eq_u32 vcc, 0, v3
    s_nop 1
    v_cndmask_b32 v20, 0, v4, vcc
    v_cmp_eq_u32 vcc, 1, v3
    s_nop 1
    v_cndmask_b32 v21, 0, v4, vcc
    v_cmp_eq_u32 vcc, 2, v3
    s_nop 1
    v_cndmask_b32 v22, 0, v4, vcc
    v_cmp_eq_u32 vcc, 3, v3
    s_nop 1
    v_cndmask_b32 v23, 0, v4, vcc
    v_mov_b32 v3, 0x0c0c0c0c
    s_mov_b32 s24, 0x01000100
    s_mov_b32 s25, 0x03020302
    v_bfi_b32 v24, v20, s24, v3
    v_bfi_b32 v28, v20, s25, v3
    v_bfi_b32 v25, v21, s24, v3
    v_bfi_b32 v29, v21, s25, v3
    v_bfi_b32 v26, v22, s24, v3
    v_bfi_b32 v30, v22, s25, v3
    v_bfi_b32 v27, v23, s24, v3
    v_bfi_b32 v31, v23, s25, v3
    s_mov_b32 s64, 0x22222222
    s_mov_b32 s65, 0x22222222
    s_mov_b32 s66, 0x44444444
    s_mov_b32 s67, 0x44444444
    s_mov_b32 s68, 0x88888888
    s_mov_b32 s69, 0x88888888
    s_lshl_b32 s24, s3, 8
    s_add_u32 s24, s24, 145408
    v_add_u32 v3, s24, v67
    v_add_u32 v4, s24, v19
    s_waitcnt vmcnt(12)
    ds_write_b128 v3, v[12:15]
    s_waitcnt lgkmcnt(0)
    ds_read_b128 v[32:35], v4 offset:0
    ds_read_b128 v[36:39], v4 offset:16
    ds_read_b128 v[40:43], v4 offset:32
    ds_read_b128 v[44:47], v4 offset:48
    ds_read_b128 v[48:51], v4 offset:2048
    ds_read_b128 v[52:55], v4 offset:2064
    ds_read_b128 v[56:59], v4 offset:2080
    ds_read_b128 v[60:63], v4 offset:2096
    s_waitcnt lgkmcnt(0)
    v_mov_b32 v76, -1
    v_mov_b32 v77, -1
    v_mov_b32 v78, -1
    v_mov_b32 v79, -1
    s_lshl_b32 s71, s72, 2
    s_add_u32 s71, s71, s3
    s_lshl_b32 s71, s71, 12
    s_add_u32 s71, s71, 0x1c0000
    s_cmp_lt_u32 s74, 32
    s_cselect_b32 s71, 0x600000, s71
    v_perm_b32 v8, v32, v32, v24
    v_perm_b32 v9, v32, v32, v25
    v_perm_b32 v10, v32, v32, v26
    v_perm_b32 v11, v32, v32, v27
    v_perm_b32 v4, v48, v48, v24
    v_perm_b32 v5, v48, v48, v25
    v_perm_b32 v6, v48, v48, v26
    v_perm_b32 v7, v48, v48, v27
    s_waitcnt vmcnt(11)
    v_mfma_f32_16x16x32_bf16 v[12:15], v[128:131], v[8:11], 0
    v_mfma_f32_16x16x32_bf16 v[68:71], v[128:131], v[4:7], 0
    buffer_load_dwordx4 v[176:179], v18, s[4:7], s32 offen nt
    s_add_u32 s32, s32, 8192
    v_perm_b32 v8, v32, v32, v28
    v_perm_b32 v9, v32, v32, v29
    v_perm_b32 v10, v32, v32, v30
    v_perm_b32 v11, v32, v32, v31
    v_perm_b32 v4, v48, v48, v28
    v_perm_b32 v5, v48, v48, v29
    v_perm_b32 v6, v48, v48, v30
    v_perm_b32 v7, v48, v48, v31
    s_waitcnt vmcnt(11)
    v_mfma_f32_16x16x32_bf16 v[12:15], v[132:135], v[8:11], v[12:15]
    v_mfma_f32_16x16x32_bf16 v[68:71], v[132:135], v[4:7], v[68:71]
    buffer_load_dwordx4 v[180:183], v18, s[4:7], s32 offen nt
    s_add_u32 s32, s32, 8192
    v_perm_b32 v8, v33, v33, v24
    v_perm_b32 v9, v33, v33, v25
    v_perm_b32 v10, v33, v33, v26
    v_perm_b32 v11, v33, v33, v27
    v_perm_b32 v4, v49, v49, v24
    v_perm_b32 v5, v49, v49, v25
    v_perm_b32 v6, v49, v49, v26
    v_perm_b32 v7, v49, v49, v27
    s_waitcnt vmcnt(11)
    v_mfma_f32_16x16x32_bf16 v[12:15], v[136:139], v[8:11], v[12:15]
    v_mfma_f32_16x16x32_bf16 v[68:71], v[136:139], v[4:7], v[68:71]
    buffer_load_dwordx4 v[184:187], v18, s[4:7], s32 offen nt
    s_add_u32 s32, s32, 8192
    v_perm_b32 v8, v33, v33, v28
    v_perm_b32 v9, v33, v33, v29
    v_perm_b32 v10, v33, v33, v30
    v_perm_b32 v11, v33, v33, v31
    v_perm_b32 v4, v49, v49, v28
    v_perm_b32 v5, v49, v49, v29
    v_perm_b32 v6, v49, v49, v30
    v_perm_b32 v7, v49, v49, v31
    s_waitcnt vmcnt(11)
    v_mfma_f32_16x16x32_bf16 v[12:15], v[140:143], v[8:11], v[12:15]
    v_mfma_f32_16x16x32_bf16 v[68:71], v[140:143], v[4:7], v[68:71]
    buffer_load_dwordx4 v[188:191], v18, s[4:7], s32 offen nt
    s_add_u32 s32, s32, 8192
    v_perm_b32 v8, v34, v34, v24
    v_perm_b32 v9, v34, v34, v25
    v_perm_b32 v10, v34, v34, v26
    v_perm_b32 v11, v34, v34, v27
    v_perm_b32 v4, v50, v50, v24
    v_perm_b32 v5, v50, v50, v25
    v_perm_b32 v6, v50, v50, v26
    v_perm_b32 v7, v50, v50, v27
    s_waitcnt vmcnt(11)
    v_mfma_f32_16x16x32_bf16 v[12:15], v[144:147], v[8:11], v[12:15]
    v_mfma_f32_16x16x32_bf16 v[68:71], v[144:147], v[4:7], v[68:71]
    buffer_load_dwordx4 v[192:195], v18, s[4:7], s32 offen nt
    s_add_u32 s32, s32, 8192
    v_perm_b32 v8, v34, v34, v28
    v_perm_b32 v9, v34, v34, v29
    v_perm_b32 v10, v34, v34, v30
    v_perm_b32 v11, v34, v34, v31
    v_perm_b32 v4, v50, v50, v28
    v_perm_b32 v5, v50, v50, v29
    v_perm_b32 v6, v50, v50, v30
    v_perm_b32 v7, v50, v50, v31
    s_waitcnt vmcnt(11)
    v_mfma_f32_16x16x32_bf16 v[12:15], v[148:151], v[8:11], v[12:15]
    v_mfma_f32_16x16x32_bf16 v[68:71], v[148:151], v[4:7], v[68:71]
    buffer_load_dwordx4 v[196:199], v18, s[4:7], s32 offen nt
    s_add_u32 s32, s32, 8192
    v_perm_b32 v8, v35, v35, v24
    v_perm_b32 v9, v35, v35, v25
    v_perm_b32 v10, v35, v35, v26
    v_perm_b32 v11, v35, v35, v27
    v_perm_b32 v4, v51, v51, v24
    v_perm_b32 v5, v51, v51, v25
    v_perm_b32 v6, v51, v51, v26
    v_perm_b32 v7, v51, v51, v27
    s_waitcnt vmcnt(11)
    v_mfma_f32_16x16x32_bf16 v[12:15], v[152:155], v[8:11], v[12:15]
    v_mfma_f32_16x16x32_bf16 v[68:71], v[152:155], v[4:7], v[68:71]
    buffer_load_dwordx4 v[200:203], v18, s[4:7], s32 offen nt
    s_add_u32 s32, s32, 8192
    v_perm_b32 v8, v35, v35, v28
    v_perm_b32 v9, v35, v35, v29
    v_perm_b32 v10, v35, v35, v30
    v_perm_b32 v11, v35, v35, v31
    v_perm_b32 v4, v51, v51, v28
    v_perm_b32 v5, v51, v51, v29
    v_perm_b32 v6, v51, v51, v30
    v_perm_b32 v7, v51, v51, v31
    s_waitcnt vmcnt(11)
    v_mfma_f32_16x16x32_bf16 v[12:15], v[156:159], v[8:11], v[12:15]
    v_mfma_f32_16x16x32_bf16 v[68:71], v[156:159], v[4:7], v[68:71]
    buffer_load_dwordx4 v[204:207], v18, s[4:7], s32 offen nt
    s_add_u32 s32, s32, 8192
    v_perm_b32 v8, v36, v36, v24
    v_perm_b32 v9, v36, v36, v25
    v_perm_b32 v10, v36, v36, v26
    v_perm_b32 v11, v36, v36, v27
    v_perm_b32 v4, v52, v52, v24
    v_perm_b32 v5, v52, v52, v25
    v_perm_b32 v6, v52, v52, v26
    v_perm_b32 v7, v52, v52, v27
    s_waitcnt vmcnt(11)
    v_mfma_f32_16x16x32_bf16 v[12:15], v[160:163], v[8:11], v[12:15]
    v_mfma_f32_16x16x32_bf16 v[68:71], v[160:163], v[4:7], v[68:71]
    buffer_load_dwordx4 v[208:211], v18, s[4:7], s32 offen nt
    s_add_u32 s32, s32, 8192
    v_perm_b32 v8, v36, v36, v28
    v_perm_b32 v9, v36, v36, v29
    v_perm_b32 v10, v36, v36, v30
    v_perm_b32 v11, v36, v36, v31
    v_perm_b32 v4, v52, v52, v28
    v_perm_b32 v5, v52, v52, v29
    v_perm_b32 v6, v52, v52, v30
    v_perm_b32 v7, v52, v52, v31
    s_waitcnt vmcnt(11)
    v_mfma_f32_16x16x32_bf16 v[12:15], v[164:167], v[8:11], v[12:15]
    v_mfma_f32_16x16x32_bf16 v[68:71], v[164:167], v[4:7], v[68:71]
    buffer_load_dwordx4 v[212:215], v18, s[4:7], s32 offen nt
    s_add_u32 s32, s32, 8192
    v_perm_b32 v8, v37, v37, v24
    v_perm_b32 v9, v37, v37, v25
    v_perm_b32 v10, v37, v37, v26
    v_perm_b32 v11, v37, v37, v27
    v_perm_b32 v4, v53, v53, v24
    v_perm_b32 v5, v53, v53, v25
    v_perm_b32 v6, v53, v53, v26
    v_perm_b32 v7, v53, v53, v27
    s_waitcnt vmcnt(11)
    v_mfma_f32_16x16x32_bf16 v[12:15], v[168:171], v[8:11], v[12:15]
    v_mfma_f32_16x16x32_bf16 v[68:71], v[168:171], v[4:7], v[68:71]
    buffer_load_dwordx4 v[216:219], v18, s[4:7], s32 offen nt
    s_add_u32 s32, s32, 8192
    v_perm_b32 v8, v37, v37, v28
    v_perm_b32 v9, v37, v37, v29
    v_perm_b32 v10, v37, v37, v30
    v_perm_b32 v11, v37, v37, v31
    v_perm_b32 v4, v53, v53, v28
    v_perm_b32 v5, v53, v53, v29
    v_perm_b32 v6, v53, v53, v30
    v_perm_b32 v7, v53, v53, v31
    s_waitcnt vmcnt(11)
    v_mfma_f32_16x16x32_bf16 v[12:15], v[172:175], v[8:11], v[12:15]
    v_mfma_f32_16x16x32_bf16 v[68:71], v[172:175], v[4:7], v[68:71]
    buffer_load_dwordx4 v[220:223], v18, s[4:7], s32 offen nt
    s_add_u32 s32, s32, 8192
    v_perm_b32 v8, v38, v38, v24
    v_perm_b32 v9, v38, v38, v25
    v_perm_b32 v10, v38, v38, v26
    v_perm_b32 v11, v38, v38, v27
    v_perm_b32 v4, v54, v54, v24
    v_perm_b32 v5, v54, v54, v25
    v_perm_b32 v6, v54, v54, v26
    v_perm_b32 v7, v54, v54, v27
    s_waitcnt vmcnt(11)
    v_mfma_f32_16x16x32_bf16 v[12:15], v[176:179], v[8:11], v[12:15]
    v_mfma_f32_16x16x32_bf16 v[68:71], v[176:179], v[4:7], v[68:71]
    buffer_load_dwordx4 v[224:227], v18, s[4:7], s32 offen nt
    s_add_u32 s32, s32, 8192
    v_perm_b32 v8, v38, v38, v28
    v_perm_b32 v9, v38, v38, v29
    v_perm_b32 v10, v38, v38, v30
    v_perm_b32 v11, v38, v38, v31
    v_perm_b32 v4, v54, v54, v28
    v_perm_b32 v5, v54, v54, v29
    v_perm_b32 v6, v54, v54, v30
    v_perm_b32 v7, v54, v54, v31
    s_waitcnt vmcnt(11)
    v_mfma_f32_16x16x32_bf16 v[12:15], v[180:183], v[8:11], v[12:15]
    v_mfma_f32_16x16x32_bf16 v[68:71], v[180:183], v[4:7], v[68:71]
    buffer_load_dwordx4 v[228:231], v18, s[4:7], s32 offen nt
    s_add_u32 s32, s32, 8192
    v_perm_b32 v8, v39, v39, v24
    v_perm_b32 v9, v39, v39, v25
    v_perm_b32 v10, v39, v39, v26
    v_perm_b32 v11, v39, v39, v27
    v_perm_b32 v4, v55, v55, v24
    v_perm_b32 v5, v55, v55, v25
    v_perm_b32 v6, v55, v55, v26
    v_perm_b32 v7, v55, v55, v27
    s_waitcnt vmcnt(11)
    v_mfma_f32_16x16x32_bf16 v[12:15], v[184:187], v[8:11], v[12:15]
    v_mfma_f32_16x16x32_bf16 v[68:71], v[184:187], v[4:7], v[68:71]
    buffer_load_dwordx4 v[232:235], v18, s[4:7], s32 offen nt
    s_add_u32 s32, s32, 8192
    v_perm_b32 v8, v39, v39, v28
    v_perm_b32 v9, v39, v39, v29
    v_perm_b32 v10, v39, v39, v30
    v_perm_b32 v11, v39, v39, v31
    v_perm_b32 v4, v55, v55, v28
    v_perm_b32 v5, v55, v55, v29
    v_perm_b32 v6, v55, v55, v30
    v_perm_b32 v7, v55, v55, v31
    s_waitcnt vmcnt(11)
    v_mfma_f32_16x16x32_bf16 v[12:15], v[188:191], v[8:11], v[12:15]
    v_mfma_f32_16x16x32_bf16 v[68:71], v[188:191], v[4:7], v[68:71]
    buffer_load_dwordx4 v[236:239], v18, s[4:7], s32 offen nt
    s_add_u32 s32, s32, 8192
    v_perm_b32 v8, v40, v40, v24
    v_perm_b32 v9, v40, v40, v25
    v_perm_b32 v10, v40, v40, v26
    v_perm_b32 v11, v40, v40, v27
    v_perm_b32 v4, v56, v56, v24
    v_perm_b32 v5, v56, v56, v25
    v_perm_b32 v6, v56, v56, v26
    v_perm_b32 v7, v56, v56, v27
    s_waitcnt vmcnt(11)
    v_mfma_f32_16x16x32_bf16 v[12:15], v[192:195], v[8:11], v[12:15]
    v_mfma_f32_16x16x32_bf16 v[68:71], v[192:195], v[4:7], v[68:71]
    buffer_load_dwordx4 v[240:243], v18, s[4:7], s32 offen nt
    s_add_u32 s32, s32, 8192
    v_perm_b32 v8, v40, v40, v28
    v_perm_b32 v9, v40, v40, v29
    v_perm_b32 v10, v40, v40, v30
    v_perm_b32 v11, v40, v40, v31
    v_perm_b32 v4, v56, v56, v28
    v_perm_b32 v5, v56, v56, v29
    v_perm_b32 v6, v56, v56, v30
    v_perm_b32 v7, v56, v56, v31
    s_waitcnt vmcnt(11)
    v_mfma_f32_16x16x32_bf16 v[12:15], v[196:199], v[8:11], v[12:15]
    v_mfma_f32_16x16x32_bf16 v[68:71], v[196:199], v[4:7], v[68:71]
    buffer_load_dwordx4 v[244:247], v18, s[4:7], s32 offen nt
    s_add_u32 s32, s32, 8192
    v_perm_b32 v8, v41, v41, v24
    v_perm_b32 v9, v41, v41, v25
    v_perm_b32 v10, v41, v41, v26
    v_perm_b32 v11, v41, v41, v27
    v_perm_b32 v4, v57, v57, v24
    v_perm_b32 v5, v57, v57, v25
    v_perm_b32 v6, v57, v57, v26
    v_perm_b32 v7, v57, v57, v27
    s_waitcnt vmcnt(11)
    v_mfma_f32_16x16x32_bf16 v[12:15], v[200:203], v[8:11], v[12:15]
    v_mfma_f32_16x16x32_bf16 v[68:71], v[200:203], v[4:7], v[68:71]
    buffer_load_dwordx4 v[248:251], v18, s[4:7], s32 offen nt
    s_add_u32 s32, s32, 8192
    v_perm_b32 v8, v41, v41, v28
    v_perm_b32 v9, v41, v41, v29
    v_perm_b32 v10, v41, v41, v30
    v_perm_b32 v11, v41, v41, v31
    v_perm_b32 v4, v57, v57, v28
    v_perm_b32 v5, v57, v57, v29
    v_perm_b32 v6, v57, v57, v30
    v_perm_b32 v7, v57, v57, v31
    s_waitcnt vmcnt(11)
    v_mfma_f32_16x16x32_bf16 v[12:15], v[204:207], v[8:11], v[12:15]
    v_mfma_f32_16x16x32_bf16 v[68:71], v[204:207], v[4:7], v[68:71]
    buffer_load_dwordx4 v[252:255], v18, s[4:7], s32 offen nt
    s_add_u32 s32, s32, 8192
    v_perm_b32 v8, v42, v42, v24
    v_perm_b32 v9, v42, v42, v25
    v_perm_b32 v10, v42, v42, v26
    v_perm_b32 v11, v42, v42, v27
    v_perm_b32 v4, v58, v58, v24
    v_perm_b32 v5, v58, v58, v25
    v_perm_b32 v6, v58, v58, v26
    v_perm_b32 v7, v58, v58, v27
    s_waitcnt vmcnt(11)
    v_mfma_f32_16x16x32_bf16 v[12:15], v[208:211], v[8:11], v[12:15]
    v_mfma_f32_16x16x32_bf16 v[68:71], v[208:211], v[4:7], v[68:71]
    s_lshl_b32 s73, s74, 7
    s_add_u32 s73, s73, 0x170000
    s_cmp_lg_u32 s3, 0
    s_cbranch_scc1 L_A_nofl
    s_mov_b64 exec, 1
    buffer_store_dwordx4 v[76:79], off, s[12:15], s73 sc1
    s_mov_b64 exec, -1
L_A_nofl:
    s_cmp_ge_u32 s71, 0x1fe000
    s_cselect_b32 s71, 0x600000, s71
    buffer_store_dwordx4 v[76:79], v2, s[12:15], s71 offen sc1
    s_add_u32 s71, s71, 0x20000
    s_getpc_b64 s[24:25]
L_pc9:
    s_add_u32 s24, s24, L_A2-L_pc9
    s_addc_u32 s25, s25, 0
    v_lshl_add_u32 v16, v0, 2, s3
    v_lshlrev_b32 v16, 7, v16
    v_min_u32 v16, L_last-L_A2-4, v16
    v_mov_b32 v17, s25
    v_add_co_u32 v16, vcc, s24, v16
    s_nop 1
    v_addc_co_u32 v17, vcc, 0, v17, vcc
    global_load_dword v17, v[16:17], off
    s_mov_b32 s4, s42
    s_mov_b32 s5, s43
    s_mov_b32 s6, s75
    s_mov_b32 s32, s35
    buffer_load_dwordx4 v[128:131], v64, s[4:7], s32 offen nt
    s_add_u32 s32, s32, 8192
    v_perm_b32 v8, v42, v42, v28
    v_perm_b32 v9, v42, v42, v29
    v_perm_b32 v10, v42, v42, v30
    v_perm_b32 v11, v42, v42, v31
    v_perm_b32 v4, v58, v58, v28
    v_perm_b32 v5, v58, v58, v29
    v_perm_b32 v6, v58, v58, v30
    v_perm_b32 v7, v58, v58, v31
    s_waitcnt vmcnt(13)
    v_mfma_f32_16x16x32_bf16 v[12:15], v[212:215], v[8:11], v[12:15]
    v_mfma_f32_16x16x32_bf16 v[68:71], v[212:215], v[4:7], v[68:71]
    buffer_load_dwordx4 v[132:135], v64, s[4:7], s32 offen nt
    s_add_u32 s32, s32, 8192
    v_perm_b32 v8, v43, v43, v24
    v_perm_b32 v9, v43, v43, v25
    v_perm_b32 v10, v43, v43, v26
    v_perm_b32 v11, v43, v43, v27
    v_perm_b32 v4, v59, v59, v24
    v_perm_b32 v5, v59, v59, v25
    v_perm_b32 v6, v59, v59, v26
    v_perm_b32 v7, v59, v59, v27
    s_waitcnt vmcnt(13)
    v_mfma_f32_16x16x32_bf16 v[12:15], v[216:219], v[8:11], v[12:15]
    v_mfma_f32_16x16x32_bf16 v[68:71], v[216:219], v[4:7], v[68:71]
    buffer_load_dwordx4 v[136:139], v64, s[4:7], s32 offen nt
    s_add_u32 s32, s32, 8192
    v_perm_b32 v8, v43, v43, v28
    v_perm_b32 v9, v43, v43, v29
    v_perm_b32 v10, v43, v43, v30
    v_perm_b32 v11, v43, v43, v31
    v_perm_b32 v4, v59, v59, v28
    v_perm_b32 v5, v59, v59, v29
    v_perm_b32 v6, v59, v59, v30
    v_perm_b32 v7, v59, v59, v31
    s_waitcnt vmcnt(13)
    v_mfma_f32_16x16x32_bf16 v[12:15], v[220:223], v[8:11], v[12:15]
    v_mfma_f32_16x16x32_bf16 v[68:71], v[220:223], v[4:7], v[68:71]
    buffer_load_dwordx4 v[140:143], v64, s[4:7], s32 offen nt
    s_add_u32 s32, s32, 8192
    v_perm_b32 v8, v44, v44, v24
    v_perm_b32 v9, v44, v44, v25
    v_perm_b32 v10, v44, v44, v26
    v_perm_b32 v11, v44, v44, v27
    v_perm_b32 v4, v60, v60, v24
    v_perm_b32 v5, v60, v60, v25
    v_perm_b32 v6, v60, v60, v26
    v_perm_b32 v7, v60, v60, v27
    s_waitcnt vmcnt(13)
    v_mfma_f32_16x16x32_bf16 v[12:15], v[224:227], v[8:11], v[12:15]
    v_mfma_f32_16x16x32_bf16 v[68:71], v[224:227], v[4:7], v[68:71]
    buffer_load_dwordx4 v[144:147], v64, s[4:7], s32 offen nt
    s_add_u32 s32, s32, 8192
    v_perm_b32 v8, v44, v44, v28
    v_perm_b32 v9, v44, v44, v29
    v_perm_b32 v10, v44, v44, v30
    v_perm_b32 v11, v44, v44, v31
    v_perm_b32 v4, v60, v60, v28
    v_perm_b32 v5, v60, v60, v29
    v_perm_b32 v6, v60, v60, v30
    v_perm_b32 v7, v60, v60, v31
    s_waitcnt vmcnt(13)
    v_mfma_f32_16x16x32_bf16 v[12:15], v[228:231], v[8:11], v[12:15]
    v_mfma_f32_16x16x32_bf16 v[68:71], v[228:231], v[4:7], v[68:71]
    buffer_load_dwordx4 v[148:151], v64, s[4:7], s32 offen nt
    s_add_u32 s32, s32, 8192
    v_perm_b32 v8, v45, v45, v24
    v_perm_b32 v9, v45, v45, v25
    v_perm_b32 v10, v45, v45, v26
    v_perm_b32 v11, v45, v45, v27
    v_perm_b32 v4, v61, v61, v24
    v_perm_b32 v5, v61, v61, v25
    v_perm_b32 v6, v61, v61, v26
    v_perm_b32 v7, v61, v61, v27
    s_waitcnt vmcnt(13)
    v_mfma_f32_16x16x32_bf16 v[12:15], v[232:235], v[8:11], v[12:15]
    v_mfma_f32_16x16x32_bf16 v[68:71], v[232:235], v[4:7], v[68:71]
    buffer_load_dwordx4 v[152:155], v64, s[4:7], s32 offen nt
    s_add_u32 s32, s32, 8192
    v_perm_b32 v8, v45, v45, v28
    v_perm_b32 v9, v45, v45, v29
    v_perm_b32 v10, v45, v45, v30
    v_perm_b32 v11, v45, v45, v31
    v_perm_b32 v4, v61, v61, v28
    v_perm_b32 v5, v61, v61, v29
    v_perm_b32 v6, v61, v61, v30
    v_perm_b32 v7, v61, v61, v31
    s_waitcnt vmcnt(13)
    v_mfma_f32_16x16x32_bf16 v[12:15], v[236:239], v[8:11], v[12:15]
    v_mfma_f32_16x16x32_bf16 v[68:71], v[236:239], v[4:7], v[68:71]
    buffer_load_dwordx4 v[156:159], v64, s[4:7], s32 offen nt
    s_add_u32 s32, s32, 8192
    v_perm_b32 v8, v46, v46, v24
    v_perm_b32 v9, v46, v46, v25
    v_perm_b32 v10, v46, v46, v26
    v_perm_b32 v11, v46, v46, v27
    v_perm_b32 v4, v62, v62, v24
    v_perm_b32 v5, v62, v62, v25
    v_perm_b32 v6, v62, v62, v26
    v_perm_b32 v7, v62, v62, v27
    s_waitcnt vmcnt(13)
    v_mfma_f32_16x16x32_bf16 v[12:15], v[240:243], v[8:11], v[12:15]
    v_mfma_f32_16x16x32_bf16 v[68:71], v[240:243], v[4:7], v[68:71]
    buffer_load_dwordx4 v[160:163], v64, s[4:7], s32 offen nt
    s_add_u32 s32, s32, 8192
    v_perm_b32 v8, v46, v46, v28
    v_perm_b32 v9, v46, v46, v29
    v_perm_b32 v10, v46, v46, v30
    v_perm_b32 v11, v46, v46, v31
    v_perm_b32 v4, v62, v62, v28
    v_perm_b32 v5, v62, v62, v29
    v_perm_b32 v6, v62, v62, v30
    v_perm_b32 v7, v62, v62, v31
    s_waitcnt vmcnt(13)
    v_mfma_f32_16x16x32_bf16 v[12:15], v[244:247], v[8:11], v[12:15]
    v_mfma_f32_16x16x32_bf16 v[68:71], v[244:247], v[4:7], v[68:71]
    buffer_load_dwordx4 v[164:167], v64, s[4:7], s32 offen nt
    s_add_u32 s32, s32, 8192
    v_perm_b32 v8, v47, v47, v24
    v_perm_b32 v9, v47, v47, v25
    v_perm_b32 v10, v47, v47, v26
    v_perm_b32 v11, v47, v47, v27
    v_perm_b32 v4, v63, v63, v24
    v_perm_b32 v5, v63, v63, v25
    v_perm_b32 v6, v63, v63, v26
    v_perm_b32 v7, v63, v63, v27
    s_waitcnt vmcnt(13)
    v_mfma_f32_16x16x32_bf16 v[12:15], v[248:251], v[8:11], v[12:15]
    v_mfma_f32_16x16x32_bf16 v[68:71], v[248:251], v[4:7], v[68:71]
    buffer_load_dwordx4 v[168:171], v64, s[4:7], s32 offen nt
    s_add_u32 s32, s32, 8192
    v_perm_b32 v8, v47, v47, v28
    v_perm_b32 v9, v47, v47, v29
    v_perm_b32 v10, v47, v47, v30
    v_perm_b32 v11, v47, v47, v31
    v_perm_b32 v4, v63, v63, v28
    v_perm_b32 v5, v63, v63, v29
    v_perm_b32 v6, v63, v63, v30
    v_perm_b32 v7, v63, v63, v31
    s_waitcnt vmcnt(13)
    v_mfma_f32_16x16x32_bf16 v[12:15], v[252:255], v[8:11], v[12:15]
    v_mfma_f32_16x16x32_bf16 v[68:71], v[252:255], v[4:7], v[68:71]
    buffer_load_dwordx4 v[172:175], v64, s[4:7], s32 offen nt
    s_add_u32 s32, s32, 8192
    v_lshrrev_b32 v3, 4, v0
    v_lshlrev_b32 v3, 7, v3
    v_and_b32 v4, 7, v0
    v_lshl_add_u32 v3, v4, 2, v3
    v_bfe_u32 v4, v0, 3, 1
    v_lshl_add_u32 v3, v4, 9, v3
    s_lshl_b32 s24, s3, 11
    s_add_u32 s24, s24, 135168
    v_add_u32 v3, s24, v3
    ds_write_b32 v3, v12 offset:0
    ds_write_b32 v3, v13 offset:32
    ds_write_b32 v3, v14 offset:64
    ds_write_b32 v3, v15 offset:96
    ds_write_b32 v3, v68 offset:1024
    ds_write_b32 v3, v69 offset:1056
    ds_write_b32 v3, v70 offset:1088
    ds_write_b32 v3, v71 offset:1120
    s_waitcnt lgkmcnt(0)
    s_barrier
    ds_read_b128 v[72:75], v65 offset:0
    ds_read_b128 v[76:79], v65 offset:16
    ds_read_b128 v[80:83], v65 offset:2048
    ds_read_b128 v[84:87], v65 offset:2064
    ds_read_b128 v[88:91], v65 offset:4096
    ds_read_b128 v[92:95], v65 offset:4112
    ds_read_b128 v[96:99], v65 offset:6144
    ds_read_b128 v[100:103], v65 offset:6160
    s_waitcnt lgkmcnt(4)
    v_add_f32 v72, v72, v80
    v_add_f32 v73, v73, v81
    v_add_f32 v74, v74, v82
    v_add_f32 v75, v75, v83
    v_add_f32 v76, v76, v84
    v_add_f32 v77, v77, v85
    v_add_f32 v78, v78, v86
    v_add_f32 v79, v79, v87
    s_waitcnt lgkmcnt(2)
    v_add_f32 v72, v72, v88
    v_add_f32 v73, v73, v89
    v_add_f32 v74, v74, v90
    v_add_f32 v75, v75, v91
    v_add_f32 v76, v76, v92
    v_add_f32 v77, v77, v93
    v_add_f32 v78, v78, v94
    v_add_f32 v79, v79, v95
    s_waitcnt lgkmcnt(0)
    v_add_f32 v72, v72, v96
    v_add_f32 v73, v73, v97
    v_add_f32 v74, v74, v98
    v_add_f32 v75, v75, v99
    v_add_f32 v76, v76, v100
    v_add_f32 v77, v77, v101
    v_add_f32 v78, v78, v102
    v_add_f32 v79, v79, v103
    v_cvt_pk_bf16_f32 v8, v72, v73
    v_cvt_pk_bf16_f32 v9, v74, v75
    v_cvt_pk_bf16_f32 v10, v76, v77
    v_cvt_pk_bf16_f32 v11, v78, v79
    s_cmp_ge_u32 s74, 32
    s_cbranch_scc1 L_C
L_A2:
    buffer_load_dwordx4 v[176:179], v64, s[4:7], s32 offen nt
    s_add_u32 s32, s32, 8192
    buffer_load_dwordx4 v[180:183], v64, s[4:7], s32 offen nt
    s_add_u32 s32, s32, 8192
    buffer_load_dwordx4 v[184:187], v64, s[4:7], s32 offen nt
    s_add_u32 s32, s32, 8192
    buffer_load_dwordx4 v[188:191], v64, s[4:7], s32 offen nt
    s_add_u32 s32, s32, 8192
    buffer_load_dwordx4 v[192:195], v64, s[4:7], s32 offen nt
    s_add_u32 s32, s32, 8192
    buffer_load_dwordx4 v[196:199], v64, s[4:7], s32 offen nt
    s_add_u32 s32, s32, 8192
    buffer_load_dwordx4 v[200:203], v64, s[4:7], s32 offen nt
    s_add_u32 s32, s32, 8192
    buffer_load_dwordx4 v[204:207], v64, s[4:7], s32 offen nt
    s_add_u32 s32, s32, 8192
    buffer_load_dwordx4 v[208:211], v64, s[4:7], s32 offen nt
    s_add_u32 s32, s32, 8192
    buffer_load_dwordx4 v[212:215], v64, s[4:7], s32 offen nt
    s_add_u32 s32, s32, 8192
    buffer_load_dwordx4 v[216:219], v64, s[4:7], s32 offen nt
    s_add_u32 s32, s32, 8192
    buffer_load_dwordx4 v[220:223], v64, s[4:7], s32 offen nt
    s_add_u32 s32, s32, 8192
    buffer_load_dwordx4 v[224:227], v64, s[4:7], s32 offen nt
    s_add_u32 s32, s32, 8192
    buffer_load_dwordx4 v[228:231], v64, s[4:7], s32 offen nt
    s_add_u32 s32, s32, 8192
    buffer_load_dwordx4 v[232:235], v64, s[4:7], s32 offen nt
    s_add_u32 s32, s32, 8192
    buffer_load_dwordx4 v[236:239], v64, s[4:7], s32 offen nt
    s_add_u32 s32, s32, 8192
    buffer_load_dwordx4 v[240:243], v64, s[4:7], s32 offen nt
    s_add_u32 s32, s32, 8192
    buffer_load_dwordx4 v[244:247], v64, s[4:7], s32 offen nt
    s_add_u32 s32, s32, 8192
    buffer_load_dwordx4 v[248:251], v64, s[4:7], s32 offen nt
    s_add_u32 s32, s32, 8192
    buffer_load_dwordx4 v[252:255], v64, s[4:7], s32 offen nt
    s_add_u32 s32, s32, 8192
    s_waitcnt vmcnt(31)
    v_mfma_f32_16x16x32_bf16 v[80:83], v[128:131], v[8:11], 0
    s_waitcnt vmcnt(30)
    v_mfma_f32_16x16x32_bf16 v[84:87], v[132:135], v[8:11], 0
    s_waitcnt vmcnt(29)
    v_mfma_f32_16x16x32_bf16 v[88:91], v[136:139], v[8:11], 0
    s_waitcnt vmcnt(28)
    v_mfma_f32_16x16x32_bf16 v[92:95], v[140:143], v[8:11], 0
    s_waitcnt vmcnt(27)
    v_mfma_f32_16x16x32_bf16 v[96:99], v[144:147], v[8:11], 0
    s_waitcnt vmcnt(26)
    v_mfma_f32_16x16x32_bf16 v[100:103], v[148:151], v[8:11], 0
    s_waitcnt vmcnt(25)
    v_mfma_f32_16x16x32_bf16 v[104:107], v[152:155], v[8:11], 0
    s_waitcnt vmcnt(24)
    v_mfma_f32_16x16x32_bf16 v[108:111], v[156:159], v[8:11], 0
    v_add_f32_dpp v72, v81, v80 quad_perm:[1,1,1,1] row_mask:0xf bank_mask:0xf
    v_add_f32_dpp v73, v85, v84 quad_perm:[1,1,1,1] row_mask:0xf bank_mask:0xf
    v_add_f32_dpp v74, v89, v88 quad_perm:[1,1,1,1] row_mask:0xf bank_mask:0xf
    v_add_f32_dpp v75, v93, v92 quad_perm:[1,1,1,1] row_mask:0xf bank_mask:0xf
    v_add_f32_dpp v76, v97, v96 quad_perm:[1,1,1,1] row_mask:0xf bank_mask:0xf
    v_add_f32_dpp v77, v101, v100 quad_perm:[1,1,1,1] row_mask:0xf bank_mask:0xf
    v_add_f32_dpp v78, v105, v104 quad_perm:[1,1,1,1] row_mask:0xf bank_mask:0xf
    s_nop 0
    v_add_f32_dpp v79, v109, v108 quad_perm:[1,1,1,1] row_mask:0xf bank_mask:0xf
    v_add_f32_dpp v72, v82, v72 quad_perm:[2,2,2,2] row_mask:0xf bank_mask:0xf
    v_add_f32_dpp v73, v86, v73 quad_perm:[2,2,2,2] row_mask:0xf bank_mask:0xf
    v_add_f32_dpp v74, v90, v74 quad_perm:[2,2,2,2] row_mask:0xf bank_mask:0xf
    v_add_f32_dpp v75, v94, v75 quad_perm:[2,2,2,2] row_mask:0xf bank_mask:0xf
    v_add_f32_dpp v76, v98, v76 quad_perm:[2,2,2,2] row_mask:0xf bank_mask:0xf
    v_add_f32_dpp v77, v102, v77 quad_perm:[2,2,2,2] row_mask:0xf bank_mask:0xf
    v_add_f32_dpp v78, v106, v78 quad_perm:[2,2,2,2] row_mask:0xf bank_mask:0xf
    v_add_f32_dpp v79, v110, v79 quad_perm:[2,2,2,2] row_mask:0xf bank_mask:0xf
    v_add_f32_dpp v72, v83, v72 quad_perm:[3,3,3,3] row_mask:0xf bank_mask:0xf
    v_add_f32_dpp v73, v87, v73 quad_perm:[3,3,3,3] row_mask:0xf bank_mask:0xf
    v_add_f32_dpp v74, v91, v74 quad_perm:[3,3,3,3] row_mask:0xf bank_mask:0xf
    v_add_f32_dpp v75, v95, v75 quad_perm:[3,3,3,3] row_mask:0xf bank_mask:0xf
    v_add_f32_dpp v76, v99, v76 quad_perm:[3,3,3,3] row_mask:0xf bank_mask:0xf
    v_add_f32_dpp v77, v103, v77 quad_perm:[3,3,3,3] row_mask:0xf bank_mask:0xf
    v_add_f32_dpp v78, v107, v78 quad_perm:[3,3,3,3] row_mask:0xf bank_mask:0xf
    v_add_f32_dpp v79, v111, v79 quad_perm:[3,3,3,3] row_mask:0xf bank_mask:0xf
    s_waitcnt vmcnt(23)
    v_mfma_f32_16x16x32_bf16 v[80:83], v[160:163], v[8:11], 0
    s_waitcnt vmcnt(22)
    v_mfma_f32_16x16x32_bf16 v[84:87], v[164:167], v[8:11], 0
    s_waitcnt vmcnt(21)
    v_mfma_f32_16x16x32_bf16 v[88:91], v[168:171], v[8:11], 0
    s_waitcnt vmcnt(20)
    v_mfma_f32_16x16x32_bf16 v[92:95], v[172:175], v[8:11], 0
    s_waitcnt vmcnt(19)
    v_mfma_f32_16x16x32_bf16 v[96:99], v[176:179], v[8:11], 0
    s_waitcnt vmcnt(18)
    v_mfma_f32_16x16x32_bf16 v[100:103], v[180:183], v[8:11], 0
    s_waitcnt vmcnt(17)
    v_mfma_f32_16x16x32_bf16 v[104:107], v[184:187], v[8:11], 0
    s_waitcnt vmcnt(16)
    v_mfma_f32_16x16x32_bf16 v[108:111], v[188:191], v[8:11], 0
    v_add_f32_dpp v112, v80, v81 quad_perm:[0,0,0,0] row_mask:0xf bank_mask:0xf
    v_add_f32_dpp v113, v84, v85 quad_perm:[0,0,0,0] row_mask:0xf bank_mask:0xf
    v_add_f32_dpp v114, v88, v89 quad_perm:[0,0,0,0] row_mask:0xf bank_mask:0xf
    v_add_f32_dpp v115, v92, v93 quad_perm:[0,0,0,0] row_mask:0xf bank_mask:0xf
    v_add_f32_dpp v116, v96, v97 quad_perm:[0,0,0,0] row_mask:0xf bank_mask:0xf
    v_add_f32_dpp v117, v100, v101 quad_perm:[0,0,0,0] row_mask:0xf bank_mask:0xf
    v_add_f32_dpp v118, v104, v105 quad_perm:[0,0,0,0] row_mask:0xf bank_mask:0xf
    s_nop 0
    v_add_f32_dpp v119, v108, v109 quad_perm:[0,0,0,0] row_mask:0xf bank_mask:0xf
    v_add_f32_dpp v112, v82, v112 quad_perm:[2,2,2,2] row_mask:0xf bank_mask:0xf
    v_add_f32_dpp v113, v86, v113 quad_perm:[2,2,2,2] row_mask:0xf bank_mask:0xf
    v_add_f32_dpp v114, v90, v114 quad_perm:[2,2,2,2] row_mask:0xf bank_mask:0xf
    v_add_f32_dpp v115, v94, v115 quad_perm:[2,2,2,2] row_mask:0xf bank_mask:0xf
    v_add_f32_dpp v116, v98, v116 quad_perm:[2,2,2,2] row_mask:0xf bank_mask:0xf
    v_add_f32_dpp v117, v102, v117 quad_perm:[2,2,2,2] row_mask:0xf bank_mask:0xf
    v_add_f32_dpp v118, v106, v118 quad_perm:[2,2,2,2] row_mask:0xf bank_mask:0xf
    v_add_f32_dpp v119, v110, v119 quad_perm:[2,2,2,2] row_mask:0xf bank_mask:0xf
    v_add_f32_dpp v112, v83, v112 quad_perm:[3,3,3,3] row_mask:0xf bank_mask:0xf
    v_add_f32_dpp v113, v87, v113 quad_perm:[3,3,3,3] row_mask:0xf bank_mask:0xf
    v_add_f32_dpp v114, v91, v114 quad_perm:[3,3,3,3] row_mask:0xf bank_mask:0xf
    v_add_f32_dpp v115, v95, v115 quad_perm:[3,3,3,3] row_mask:0xf bank_mask:0xf
    v_add_f32_dpp v116, v99, v116 quad_perm:[3,3,3,3] row_mask:0xf bank_mask:0xf
    v_add_f32_dpp v117, v103, v117 quad_perm:[3,3,3,3] row_mask:0xf bank_mask:0xf
    v_add_f32_dpp v118, v107, v118 quad_perm:[3,3,3,3] row_mask:0xf bank_mask:0xf
    v_add_f32_dpp v119, v111, v119 quad_perm:[3,3,3,3] row_mask:0xf bank_mask:0xf
    v_cndmask_b32 v72, v72, v112, s[64:65]
    v_cndmask_b32 v73, v73, v113, s[64:65]
    v_cndmask_b32 v74, v74, v114, s[64:65]
    v_cndmask_b32 v75, v75, v115, s[64:65]
    v_cndmask_b32 v76, v76, v116, s[64:65]
    v_cndmask_b32 v77, v77, v117, s[64:65]
    v_cndmask_b32 v78, v78, v118, s[64:65]
    v_cndmask_b32 v79, v79, v119, s[64:65]
    s_waitcnt vmcnt(15)
    v_mfma_f32_16x16x32_bf16 v[80:83], v[192:195], v[8:11], 0
    s_waitcnt vmcnt(14)
    v_mfma_f32_16x16x32_bf16 v[84:87], v[196:199], v[8:11], 0
    s_waitcnt vmcnt(13)
    v_mfma_f32_16x16x32_bf16 v[88:91], v[200:203], v[8:11], 0
    s_waitcnt vmcnt(12)
    v_mfma_f32_16x16x32_bf16 v[92:95], v[204:207], v[8:11], 0
    s_waitcnt vmcnt(11)
    v_mfma_f32_16x16x32_bf16 v[96:99], v[208:211], v[8:11], 0
    s_waitcnt vmcnt(10)
    v_mfma_f32_16x16x32_bf16 v[100:103], v[212:215], v[8:11], 0
    s_waitcnt vmcnt(9)
    v_mfma_f32_16x16x32_bf16 v[104:107], v[216:219], v[8:11], 0
    s_waitcnt vmcnt(8)
    v_mfma_f32_16x16x32_bf16 v[108:111], v[220:223], v[8:11], 0
    v_add_f32_dpp v112, v80, v82 quad_perm:[0,0,0,0] row_mask:0xf bank_mask:0xf
    v_add_f32_dpp v113, v84, v86 quad_perm:[0,0,0,0] row_mask:0xf bank_mask:0xf
    v_add_f32_dpp v114, v88, v90 quad_perm:[0,0,0,0] row_mask:0xf bank_mask:0xf
    v_add_f32_dpp v115, v92, v94 quad_perm:[0,0,0,0] row_mask:0xf bank_mask:0xf
    v_add_f32_dpp v116, v96, v98 quad_perm:[0,0,0,0] row_mask:0xf bank_mask:0xf
    v_add_f32_dpp v117, v100, v102 quad_perm:[0,0,0,0] row_mask:0xf bank_mask:0xf
    v_add_f32_dpp v118, v104, v106 quad_perm:[0,0,0,0] row_mask:0xf bank_mask:0xf
    s_nop 0
    v_add_f32_dpp v119, v108, v110 quad_perm:[0,0,0,0] row_mask:0xf bank_mask:0xf
    v_add_f32_dpp v112, v81, v112 quad_perm:[1,1,1,1] row_mask:0xf bank_mask:0xf
    v_add_f32_dpp v113, v85, v113 quad_perm:[1,1,1,1] row_mask:0xf bank_mask:0xf
    v_add_f32_dpp v114, v89, v114 quad_perm:[1,1,1,1] row_mask:0xf bank_mask:0xf
    v_add_f32_dpp v115, v93, v115 quad_perm:[1,1,1,1] row_mask:0xf bank_mask:0xf
    v_add_f32_dpp v116, v97, v116 quad_perm:[1,1,1,1] row_mask:0xf bank_mask:0xf
    v_add_f32_dpp v117, v101, v117 quad_perm:[1,1,1,1] row_mask:0xf bank_mask:0xf
    v_add_f32_dpp v118, v105, v118 quad_perm:[1,1,1,1] row_mask:0xf bank_mask:0xf
    v_add_f32_dpp v119, v109, v119 quad_perm:[1,1,1,1] row_mask:0xf bank_mask:0xf
    v_add_f32_dpp v112, v83, v112 quad_perm:[3,3,3,3] row_mask:0xf bank_mask:0xf
    v_add_f32_dpp v113, v87, v113 quad_perm:[3,3,3,3] row_mask:0xf bank_mask:0xf
    v_add_f32_dpp v114, v91, v114 quad_perm:[3,3,3,3] row_mask:0xf bank_mask:0xf
    v_add_f32_dpp v115, v95, v115 quad_perm:[3,3,3,3] row_mask:0xf bank_mask:0xf
    v_add_f32_dpp v116, v99, v116 quad_perm:[3,3,3,3] row_mask:0xf bank_mask:0xf
    v_add_f32_dpp v117, v103, v117 quad_perm:[3,3,3,3] row_mask:0xf bank_mask:0xf
    v_add_f32_dpp v118, v107, v118 quad_perm:[3,3,3,3] row_mask:0xf bank_mask:0xf
    v_add_f32_dpp v119, v111, v119 quad_perm:[3,3,3,3] row_mask:0xf bank_mask:0xf
    v_cndmask_b32 v72, v72, v112, s[66:67]
    v_cndmask_b32 v73, v73, v113, s[66:67]
    v_cndmask_b32 v74, v74, v114, s[66:67]
    v_cndmask_b32 v75, v75, v115, s[66:67]
    v_cndmask_b32 v76, v76, v116, s[66:67]
    v_cndmask_b32 v77, v77, v117, s[66:67]
    v_cndmask_b32 v78, v78, v118, s[66:67]
    v_cndmask_b32 v79, v79, v119, s[66:67]
    s_waitcnt vmcnt(7)
    v_mfma_f32_16x16x32_bf16 v[80:83], v[224:227], v[8:11], 0
    s_waitcnt vmcnt(6)
    v_mfma_f32_16x16x32_bf16 v[84:87], v[228:231], v[8:11], 0
    s_waitcnt vmcnt(5)
    v_mfma_f32_16x16x32_bf16 v[88:91], v[232:235], v[8:11], 0
    s_waitcnt vmcnt(4)
    v_mfma_f32_16x16x32_bf16 v[92:95], v[236:239], v[8:11], 0
    s_waitcnt vmcnt(3)
    v_mfma_f32_16x16x32_bf16 v[96:99], v[240:243], v[8:11], 0
    s_waitcnt vmcnt(2)
    v_mfma_f32_16x16x32_bf16 v[100:103], v[244:247], v[8:11], 0
    s_waitcnt vmcnt(1)
    v_mfma_f32_16x16x32_bf16 v[104:107], v[248:251], v[8:11], 0
    s_waitcnt vmcnt(0)
    v_mfma_f32_16x16x32_bf16 v[108:111], v[252:255], v[8:11], 0
    v_add_f32_dpp v112, v80, v83 quad_perm:[0,0,0,0] row_mask:0xf bank_mask:0xf
    v_add_f32_dpp v113, v84, v87 quad_perm:[0,0,0,0] row_mask:0xf bank_mask:0xf
    v_add_f32_dpp v114, v88, v91 quad_perm:[0,0,0,0] row_mask:0xf bank_mask:0xf
    v_add_f32_dpp v115, v92, v95 quad_perm:[0,0,0,0] row_mask:0xf bank_mask:0xf
    v_add_f32_dpp v116, v96, v99 quad_perm:[0,0,0,0] row_mask:0xf bank_mask:0xf
    v_add_f32_dpp v117, v100, v103 quad_perm:[0,0,0,0] row_mask:0xf bank_mask:0xf
    v_add_f32_dpp v118, v104, v107 quad_perm:[0,0,0,0] row_mask:0xf bank_mask:0xf
    s_nop 0
    v_add_f32_dpp v119, v108, v111 quad_perm:[0,0,0,0] row_mask:0xf bank_mask:0xf
    v_add_f32_dpp v112, v81, v112 quad_perm:[1,1,1,1] row_mask:0xf bank_mask:0xf
    v_add_f32_dpp v113, v85, v113 quad_perm:[1,1,1,1] row_mask:0xf bank_mask:0xf
    v_add_f32_dpp v114, v89, v114 quad_perm:[1,1,1,1] row_mask:0xf bank_mask:0xf
    v_add_f32_dpp v115, v93, v115 quad_perm:[1,1,1,1] row_mask:0xf bank_mask:0xf
    v_add_f32_dpp v116, v97, v116 quad_perm:[1,1,1,1] row_mask:0xf bank_mask:0xf
    v_add_f32_dpp v117, v101, v117 quad_perm:[1,1,1,1] row_mask:0xf bank_mask:0xf
    v_add_f32_dpp v118, v105, v118 quad_perm:[1,1,1,1] row_mask:0xf bank_mask:0xf
    v_add_f32_dpp v119, v109, v119 quad_perm:[1,1,1,1] row_mask:0xf bank_mask:0xf
    v_add_f32_dpp v112, v82, v112 quad_perm:[2,2,2,2] row_mask:0xf bank_mask:0xf
    v_add_f32_dpp v113, v86, v113 quad_perm:[2,2,2,2] row_mask:0xf bank_mask:0xf
    v_add_f32_dpp v114, v90, v114 quad_perm:[2,2,2,2] row_mask:0xf bank_mask:0xf
    v_add_f32_dpp v115, v94, v115 quad_perm:[2,2,2,2] row_mask:0xf bank_mask:0xf
    v_add_f32_dpp v116, v98, v116 quad_perm:[2,2,2,2] row_mask:0xf bank_mask:0xf
    v_add_f32_dpp v117, v102, v117 quad_perm:[2,2,2,2] row_mask:0xf bank_mask:0xf
    v_add_f32_dpp v118, v106, v118 quad_perm:[2,2,2,2] row_mask:0xf bank_mask:0xf
    v_add_f32_dpp v119, v110, v119 quad_perm:[2,2,2,2] row_mask:0xf bank_mask:0xf
    v_cndmask_b32 v72, v72, v112, s[68:69]
    v_cndmask_b32 v73, v73, v113, s[68:69]
    v_cndmask_b32 v74, v74, v114, s[68:69]
    v_cndmask_b32 v75, v75, v115, s[68:69]
    v_cndmask_b32 v76, v76, v116, s[68:69]
    v_cndmask_b32 v77, v77, v117, s[68:69]
    v_cndmask_b32 v78, v78, v118, s[68:69]
    v_cndmask_b32 v79, v79, v119, s[68:69]
    s_mov_b32 s71, 0x3e0293ee
    v_mul_f32 v72, s71, v72
    v_mul_f32 v73, s71, v73
    v_mul_f32 v74, s71, v74
    v_mul_f32 v75, s71, v75
    v_mul_f32 v76, s71, v76
    v_mul_f32 v77, s71, v77
    v_mul_f32 v78, s71, v78
    v_mul_f32 v79, s71, v79
    v_cvt_pk_bf16_f32 v4, v72, v73
    v_cvt_pk_bf16_f32 v5, v74, v75
    v_cvt_pk_bf16_f32 v6, v76, v77
    v_cvt_pk_bf16_f32 v7, v78, v79
    s_lshl_b32 s24, s26, 12
    s_lshl_b32 s25, s3, 8
    s_add_u32 s24, s24, s25
    s_add_u32 s24, s24, 0x0
    buffer_store_dwordx4 v[4:7], v66, s[12:15], s24 offen sc1
    s_mov_b32 s8, s56
    s_mov_b32 s9, s57
    s_mov_b32 s10, 0x400000
    s_mov_b32 s11, 0x20000
    s_and_b32 s24, s3, 1
    s_lshl_b32 s24, s24, 1
    s_and_b32 s25, s3, 2
    s_lshl_b32 s25, s25, 3
    s_or_b32 s25, s25, s24
    s_and_b32 s24, s26, 13
    s_or_b32 s25, s25, s24
    s_lshl_b32 s25, s25, 17
    s_lshr_b32 s24, s74, 3
    s_lshl_b32 s24, s24, 7
    s_add_u32 s24, s24, s25
    v_lshrrev_b32 v3, 4, v0
    v_lshlrev_b32 v3, 15, v3
    v_and_b32 v4, 8, v0
    v_lshl_add_u32 v3, v4, 10, v3
    v_and_b32 v4, 0x70, v2
    v_add_u32 v3, v3, v4
    s_mul_i32 m0, s3, 16896
    s_nop 0
    buffer_load_dwordx4 v3, s[8:11], s24 offen nt lds
    s_add_u32 m0, m0, 1056
    s_add_u32 s24, s24, 2048
    buffer_load_dwordx4 v3, s[8:11], s24 offen nt lds
    s_add_u32 m0, m0, 1056
    s_add_u32 s24, s24, 2048
    buffer_load_dwordx4 v3, s[8:11], s24 offen nt lds
    s_add_u32 m0, m0, 1056
    s_add_u32 s24, s24, 2048
    buffer_load_dwordx4 v3, s[8:11], s24 offen nt lds
    s_add_u32 m0, m0, 1056
    s_add_u32 s24, s24, 10240
    buffer_load_dwordx4 v3, s[8:11], s24 offen nt lds
    s_add_u32 m0, m0, 1056
    s_add_u32 s24, s24, 2048
    buffer_load_dwordx4 v3, s[8:11], s24 offen nt lds
    s_add_u32 m0, m0, 1056
    s_add_u32 s24, s24, 2048
    buffer_load_dwordx4 v3, s[8:11], s24 offen nt lds
    s_add_u32 m0, m0, 1056
    s_add_u32 s24, s24, 2048
    buffer_load_dwordx4 v3, s[8:11], s24 offen nt lds
    s_add_u32 m0, m0, 1056
    s_add_u32 s24, s24, -21504
    buffer_load_dwordx4 v3, s[8:11], s24 offen nt lds
    s_add_u32 m0, m0, 1056
    s_add_u32 s24, s24, 2048
    buffer_load_dwordx4 v3, s[8:11], s24 offen nt lds
    s_add_u32 m0, m0, 1056
    s_add_u32 s24, s24, 2048
    buffer_load_dwordx4 v3, s[8:11], s24 offen nt lds
    s_add_u32 m0, m0, 1056
    s_add_u32 s24, s24, 2048
    buffer_load_dwordx4 v3, s[8:11], s24 offen nt lds
    s_add_u32 m0, m0, 1056
    s_add_u32 s24, s24, 10240
    buffer_load_dwordx4 v3, s[8:11], s24 offen nt lds
    s_add_u32 m0, m0, 1056
    s_add_u32 s24, s24, 2048
    buffer_load_dwordx4 v3, s[8:11], s24 offen nt lds
    s_add_u32 m0, m0, 1056
    s_add_u32 s24, s24, 2048
    buffer_load_dwordx4 v3, s[8:11], s24 offen nt lds
    s_add_u32 m0, m0, 1056
    s_add_u32 s24, s24, 2048
    buffer_load_dwordx4 v3, s[8:11], s24 offen nt lds
    s_waitcnt vmcnt(0)
    s_barrier
    s_cmp_lg_u32 s3, 0
    s_cbranch_scc1 L_sig10
    s_mov_b64 exec, 1
    v_mov_b32 v3, 1
    buffer_atomic_add v3, off, s[16:19], 0 offset:0 sc0
    s_waitcnt vmcnt(0)
    v_readfirstlane_b32 s24, v3
    s_mov_b64 exec, -1
    s_and_b32 s24, s24, 63
    s_cmp_lg_u32 s24, 63
    s_cbranch_scc1 L_sig10
    v_lshlrev_b32 v4, 7, v0
    v_mov_b32 v3, 1
    s_mov_b32 s24, 0x170000
    buffer_store_dword v3, v4, s[12:15], s24 offen offset:0 sc1
L_sig10:
    v_lshrrev_b32 v3, 2, v0
    v_mul_u32_u24 v3, 1056, v3
    v_and_b32 v4, 3, v0
    v_lshl_add_u32 v3, v4, 3, v3
    s_lshl_b32 s24, s3, 5
    v_add_u32 v3, s24, v3
    ds_read_b64_tr_b16 a[128:129], v3 offset:0
    ds_read_b64_tr_b16 a[130:131], v3 offset:128
    ds_read_b64_tr_b16 a[132:133], v3 offset:256
    ds_read_b64_tr_b16 a[134:135], v3 offset:384
    ds_read_b64_tr_b16 a[136:137], v3 offset:512
    ds_read_b64_tr_b16 a[138:139], v3 offset:640
    ds_read_b64_tr_b16 a[140:141], v3 offset:768
    ds_read_b64_tr_b16 a[142:143], v3 offset:896
    ds_read_b64_tr_b16 a[144:145], v3 offset:16896
    ds_read_b64_tr_b16 a[146:147], v3 offset:17024
    ds_read_b64_tr_b16 a[148:149], v3 offset:17152
    ds_read_b64_tr_b16 a[150:151], v3 offset:17280
    ds_read_b64_tr_b16 a[152:153], v3 offset:17408
    ds_read_b64_tr_b16 a[154:155], v3 offset:17536
    ds_read_b64_tr_b16 a[156:157], v3 offset:17664
    ds_read_b64_tr_b16 a[158:159], v3 offset:17792
    ds_read_b64_tr_b16 a[160:161], v3 offset:33792
    ds_read_b64_tr_b16 a[162:163], v3 offset:33920
    ds_read_b64_tr_b16 a[164:165], v3 offset:34048
    ds_read_b64_tr_b16 a[166:167], v3 offset:34176
    ds_read_b64_tr_b16 a[168:169], v3 offset:34304
    ds_read_b64_tr_b16 a[170:171], v3 offset:34432
    ds_read_b64_tr_b16 a[172:173], v3 offset:34560
    ds_read_b64_tr_b16 a[174:175], v3 offset:34688
    ds_read_b64_tr_b16 a[176:177], v3 offset:50688
    ds_read_b64_tr_b16 a[178:179], v3 offset:50816
    ds_read_b64_tr_b16 a[180:181], v3 offset:50944
    ds_read_b64_tr_b16 a[182:183], v3 offset:51072
    ds_read_b64_tr_b16 a[184:185], v3 offset:51200
    ds_read_b64_tr_b16 a[186:187], v3 offset:51328
    ds_read_b64_tr_b16 a[188:189], v3 offset:51456
    ds_read_b64_tr_b16 a[190:191], v3 offset:51584
    s_mov_b32 s4, s44
    s_mov_b32 s5, s45
    s_mov_b32 s6, 0x400000
    s_mov_b32 s7, 0x20000
    s_mov_b32 s8, s46
    s_mov_b32 s9, s47
    s_mov_b32 s10, 0x400000
    s_mov_b32 s11, 0x20000
    s_mov_b32 s32, s35
    buffer_load_dwordx4 v[128:131], v18, s[4:7], s32 offen nt
    s_add_u32 s32, s32, 8192
    buffer_load_dwordx4 v[132:135], v18, s[4:7], s32 offen nt
    s_add_u32 s32, s32, 8192
    buffer_load_dwordx4 v[136:139], v18, s[4:7], s32 offen nt
    s_add_u32 s32, s32, 8192
    buffer_load_dwordx4 v[140:143], v18, s[4:7], s32 offen nt
    s_add_u32 s32, s32, 8192
    buffer_load_dwordx4 v[144:147], v18, s[4:7], s32 offen nt
    s_add_u32 s32, s32, 8192
    buffer_load_dwordx4 v[148:151], v18, s[4:7], s32 offen nt
    s_add_u32 s32, s32, 8192
    buffer_load_dwordx4 v[152:155], v18, s[4:7], s32 offen nt
    s_add_u32 s32, s32, 8192
    buffer_load_dwordx4 v[156:159], v18, s[4:7], s32 offen nt
    s_add_u32 s32, s32, 8192
    buffer_load_dwordx4 v[160:163], v18, s[4:7], s32 offen nt
    s_add_u32 s32, s32, 8192
    buffer_load_dwordx4 v[164:167], v18, s[4:7], s32 offen nt
    s_add_u32 s32, s32, 8192
    buffer_load_dwordx4 v[168:171], v18, s[4:7], s32 offen nt
    s_add_u32 s32, s32, 8192
    buffer_load_dwordx4 v[172:175], v18, s[4:7], s32 offen nt
    s_add_u32 s32, s32, 8192
    buffer_load_dwordx4 v[176:179], v18, s[4:7], s32 offen nt
    s_add_u32 s32, s32, 8192
    buffer_load_dwordx4 v[180:183], v18, s[4:7], s32 offen nt
    s_add_u32 s32, s32, 8192
    buffer_load_dwordx4 v[184:187], v18, s[4:7], s32 offen nt
    s_add_u32 s32, s32, 8192
    buffer_load_dwordx4 v[188:191], v18, s[4:7], s32 offen nt
    s_add_u32 s32, s32, 8192
    buffer_load_dwordx4 v[192:195], v18, s[4:7], s32 offen nt
    s_add_u32 s32, s32, 8192
    buffer_load_dwordx4 v[196:199], v18, s[4:7], s32 offen nt
    s_add_u32 s32, s32, 8192
    buffer_load_dwordx4 v[200:203], v18, s[4:7], s32 offen nt
    s_add_u32 s32, s32, 8192
    buffer_load_dwordx4 v[204:207], v18, s[4:7], s32 offen nt
    s_add_u32 s32, s32, 8192
    buffer_load_dwordx4 v[208:211], v18, s[4:7], s32 offen nt
    s_add_u32 s32, s32, 8192
    buffer_load_dwordx4 v[212:215], v18, s[4:7], s32 offen nt
    s_add_u32 s32, s32, 8192
    buffer_load_dwordx4 v[216:219], v18, s[4:7], s32 offen nt
    s_add_u32 s32, s32, 8192
    buffer_load_dwordx4 v[220:223], v18, s[4:7], s32 offen nt
    s_add_u32 s32, s32, 8192
    buffer_load_dwordx4 v[224:227], v18, s[4:7], s32 offen nt
    s_add_u32 s32, s32, 8192
    buffer_load_dwordx4 v[228:231], v18, s[4:7], s32 offen nt
    s_add_u32 s32, s32, 8192
    buffer_load_dwordx4 v[232:235], v18, s[4:7], s32 offen nt
    s_add_u32 s32, s32, 8192
    buffer_load_dwordx4 v[236:239], v18, s[4:7], s32 offen nt
    s_add_u32 s32, s32, 8192
    buffer_load_dwordx4 v[240:243], v18, s[4:7], s32 offen nt
    s_add_u32 s32, s32, 8192
    buffer_load_dwordx4 v[244:247], v18, s[4:7], s32 offen nt
    s_add_u32 s32, s32, 8192
    buffer_load_dwordx4 v[248:251], v18, s[4:7], s32 offen nt
    s_add_u32 s32, s32, 8192
    buffer_load_dwordx4 v[252:255], v18, s[4:7], s32 offen nt
    s_add_u32 s32, s32, 8192
    s_lshl_b32 s33, s26, 17
    s_lshl_b32 s24, s3, 15
    s_add_u32 s33, s33, s24
    s_mul_i32 s34, s3, 33792
    s_waitcnt lgkmcnt(0)
    s_barrier
    s_mov_b32 s70, 0
L_woA:
    s_and_b32 s24, s70, 3
    s_lshl_b32 s24, s24, 1
    s_lshr_b32 s25, s70, 2
    s_or_b32 s24, s24, s25
    s_lshl_b32 s24, s24, 10
    s_add_u32 s24, s24, s33
    s_mul_i32 s25, s70, 4224
    s_add_u32 m0, s25, s34
    s_waitcnt vmcnt(24)
    buffer_load_dwordx4 v2, s[8:11], s24 offen nt lds
    s_add_u32 m0, m0, 1056
    s_add_u32 s24, s24, 8192
    s_waitcnt vmcnt(24)
    buffer_load_dwordx4 v2, s[8:11], s24 offen nt lds
    s_add_u32 m0, m0, 1056
    s_add_u32 s24, s24, 8192
    s_waitcnt vmcnt(24)
    buffer_load_dwordx4 v2, s[8:11], s24 offen nt lds
    s_add_u32 m0, m0, 1056
    s_add_u32 s24, s24, 8192
    s_waitcnt vmcnt(24)
    buffer_load_dwordx4 v2, s[8:11], s24 offen nt lds
    s_add_u32 s70, s70, 1
    s_cmp_lt_u32 s70, 8
    s_cbranch_scc1 L_woA
    s_waitcnt vmcnt(0)
    s_barrier
    v_lshrrev_b32 v3, 2, v0
    v_mul_u32_u24 v3, 1056, v3
    v_and_b32 v4, 3, v0
    v_lshl_add_u32 v3, v4, 3, v3
    s_lshl_b32 s24, s3, 8
    v_add_u32 v3, s24, v3
    v_add_u32 v4, 67584, v3
    ds_read_b64_tr_b16 a[0:1], v3 offset:0
    ds_read_b64_tr_b16 a[2:3], v3 offset:16896
    ds_read_b64_tr_b16 a[4:5], v3 offset:33792
    ds_read_b64_tr_b16 a[6:7], v3 offset:50688
    ds_read_b64_tr_b16 a[8:9], v4 offset:0
    ds_read_b64_tr_b16 a[10:11], v4 offset:16896
    ds_read_b64_tr_b16 a[12:13], v4 offset:33792
    ds_read_b64_tr_b16 a[14:15], v4 offset:50688
    ds_read_b64_tr_b16 a[16:17], v3 offset:32
    ds_read_b64_tr_b16 a[18:19], v3 offset:16928
    ds_read_b64_tr_b16 a[20:21], v3 offset:33824
    ds_read_b64_tr_b16 a[22:23], v3 offset:50720
    ds_read_b64_tr_b16 a[24:25], v4 offset:32
    ds_read_b64_tr_b16 a[26:27], v4 offset:16928
    ds_read_b64_tr_b16 a[28:29], v4 offset:33824
    ds_read_b64_tr_b16 a[30:31], v4 offset:50720
    ds_read_b64_tr_b16 a[32:33], v3 offset:64
    ds_read_b64_tr_b16 a[34:35], v3 offset:16960
    ds_read_b64_tr_b16 a[36:37], v3 offset:33856
    ds_read_b64_tr_b16 a[38:39], v3 offset:50752
    ds_read_b64_tr_b16 a[40:41], v4 offset:64
    ds_read_b64_tr_b16 a[42:43], v4 offset:16960
    ds_read_b64_tr_b16 a[44:45], v4 offset:33856
    ds_read_b64_tr_b16 a[46:47], v4 offset:50752
    ds_read_b64_tr_b16 a[48:49], v3 offset:96
    ds_read_b64_tr_b16 a[50:51], v3 offset:16992
    ds_read_b64_tr_b16 a[52:53], v3 offset:33888
    ds_read_b64_tr_b16 a[54:55], v3 offset:50784
    ds_read_b64_tr_b16 a[56:57], v4 offset:96
    ds_read_b64_tr_b16 a[58:59], v4 offset:16992
    ds_read_b64_tr_b16 a[60:61], v4 offset:33888
    ds_read_b64_tr_b16 a[62:63], v4 offset:50784
    ds_read_b64_tr_b16 a[64:65], v3 offset:128
    ds_read_b64_tr_b16 a[66:67], v3 offset:17024
    ds_read_b64_tr_b16 a[68:69], v3 offset:33920
    ds_read_b64_tr_b16 a[70:71], v3 offset:50816
    ds_read_b64_tr_b16 a[72:73], v4 offset:128
    ds_read_b64_tr_b16 a[74:75], v4 offset:17024
    ds_read_b64_tr_b16 a[76:77], v4 offset:33920
    ds_read_b64_tr_b16 a[78:79], v4 offset:50816
    ds_read_b64_tr_b16 a[80:81], v3 offset:160
    ds_read_b64_tr_b16 a[82:83], v3 offset:17056
    ds_read_b64_tr_b16 a[84:85], v3 offset:33952
    ds_read_b64_tr_b16 a[86:87], v3 offset:50848
    ds_read_b64_tr_b16 a[88:89], v4 offset:160
    ds_read_b64_tr_b16 a[90:91], v4 offset:17056
    ds_read_b64_tr_b16 a[92:93], v4 offset:33952
    ds_read_b64_tr_b16 a[94:95], v4 offset:50848
    ds_read_b64_tr_b16 a[96:97], v3 offset:192
    ds_read_b64_tr_b16 a[98:99], v3 offset:17088
    ds_read_b64_tr_b16 a[100:101], v3 offset:33984
    ds_read_b64_tr_b16 a[102:103], v3 offset:50880
    ds_read_b64_tr_b16 a[104:105], v4 offset:192
    ds_read_b64_tr_b16 a[106:107], v4 offset:17088
    ds_read_b64_tr_b16 a[108:109], v4 offset:33984
    ds_read_b64_tr_b16 a[110:111], v4 offset:50880
    ds_read_b64_tr_b16 a[112:113], v3 offset:224
    ds_read_b64_tr_b16 a[114:115], v3 offset:17120
    ds_read_b64_tr_b16 a[116:117], v3 offset:34016
    ds_read_b64_tr_b16 a[118:119], v3 offset:50912
    ds_read_b64_tr_b16 a[120:121], v4 offset:224
    ds_read_b64_tr_b16 a[122:123], v4 offset:17120
    ds_read_b64_tr_b16 a[124:125], v4 offset:34016
    ds_read_b64_tr_b16 a[126:127], v4 offset:50912
    s_waitcnt lgkmcnt(0)
    s_cmp_lg_u32 s3, 0
    s_cbranch_scc1 L_awx11
    s_mov_b32 s24, 262144
    s_mov_b64 exec, 1
L_aw12:
    buffer_load_dword v1, off, s[12:15], s73 offset:0 sc1
    s_waitcnt vmcnt(0)
    v_readfirstlane_b32 s25, v1
    s_nop 0
    s_cmp_eq_u32 s25, 1
    s_cbranch_scc1 L_awx11
    s_sleep 4
    s_sub_u32 s24, s24, 1
    s_cmp_lg_u32 s24, 0
    s_cbranch_scc1 L_aw12
L_awx11:
    s_mov_b64 exec, -1
    s_barrier
    s_cmp_lg_u32 s3, 0
    s_cbranch_scc1 L_xi13
    s_and_b32 s24, s74, 7
    s_lshl_b32 s24, s24, 5
    s_lshr_b32 s25, s74, 3
    s_add_u32 s24, s24, s25
    s_lshl_b32 s24, s24, 2
    s_add_u32 s24, s24, 0x1d8000
    s_getreg_b32 s25, hwreg(HW_REG_XCC_ID, 0, 4)
    s_mov_b64 exec, 1
    v_mov_b32 v3, s25
    buffer_store_dword v3, off, s[12:15], s24 sc1
    s_mov_b64 exec, -1
L_xi13:
    s_cmp_lg_u32 s3, 0
    s_cbranch_scc1 L_awx14
    s_mov_b32 s24, 262144
    s_mov_b64 exec, 1
L_aw15:
    buffer_load_dword v1, off, s[12:15], s73 offset:4 sc1
    s_waitcnt vmcnt(0)
    v_readfirstlane_b32 s25, v1
    s_nop 0
    s_cmp_eq_u32 s25, 1
    s_cbranch_scc1 L_awx14
    s_sleep 4
    s_sub_u32 s24, s24, 1
    s_cmp_lg_u32 s24, 0
    s_cbranch_scc1 L_aw15
L_awx14:
    s_mov_b64 exec, -1
    s_barrier
    s_lshl_b32 s24, s3, 10
    s_lshl_b32 s25, s26, 3
    s_add_u32 s25, s25, s24
    s_add_u32 s25, s25, 0x120000
    v_and_b32 v3, 3, v0
    v_lshlrev_b32 v3, 8, v3
    buffer_load_dwordx2 v[4:5], v3, s[12:15], s25 offen sc1
    s_lshl_b32 s24, s3, 18
    s_lshl_b32 s25, s26, 11
    s_add_u32 s24, s24, s25
    s_add_u32 s24, s24, 0x400000
    buffer_load_dwordx4 v[72:75], v2, s[12:15], s24 offen sc1 nt
    s_add_u32 s24, s24, 65536
    buffer_load_dwordx4 v[76:79], v2, s[12:15], s24 offen sc1 nt
    s_add_u32 s24, s24, 65536
    buffer_load_dwordx4 v[80:83], v2, s[12:15], s24 offen sc1 nt
    s_add_u32 s24, s24, 65536
    buffer_load_dwordx4 v[84:87], v2, s[12:15], s24 offen sc1 nt
    s_add_u32 s24, s24, 65536
    s_waitcnt vmcnt(4)
    v_mov_b32 v6, v4
    s_nop 1
    v_max_f32_dpp v6, v6, v6 row_ror:2 row_mask:0xf bank_mask:0xf
    s_nop 1
    v_max_f32_dpp v6, v6, v6 row_ror:1 row_mask:0xf bank_mask:0xf
    v_sub_f32 v4, v4, v6
    v_exp_f32 v4, v4
    s_nop 0
    v_mul_f32 v5, v4, v5
    s_nop 1
    v_add_f32_dpp v5, v5, v5 row_ror:2 row_mask:0xf bank_mask:0xf
    s_nop 1
    v_add_f32_dpp v5, v5, v5 row_ror:1 row_mask:0xf bank_mask:0xf
    v_rcp_f32 v5, v5
    s_nop 0
    v_mul_f32 v4, v4, v5
    s_nop 0
    v_readlane_b32 s24, v4, 0
    s_waitcnt vmcnt(3)
    v_lshlrev_b32 v5, 16, v72
    v_and_b32 v6, 0xffff0000, v72
    v_mul_f32 v104, s24, v5
    v_mul_f32 v105, s24, v6
    v_lshlrev_b32 v5, 16, v73
    v_and_b32 v6, 0xffff0000, v73
    v_mul_f32 v106, s24, v5
    v_mul_f32 v107, s24, v6
    v_lshlrev_b32 v5, 16, v74
    v_and_b32 v6, 0xffff0000, v74
    v_mul_f32 v108, s24, v5
    v_mul_f32 v109, s24, v6
    v_lshlrev_b32 v5, 16, v75
    v_and_b32 v6, 0xffff0000, v75
    v_mul_f32 v110, s24, v5
    v_mul_f32 v111, s24, v6
    v_readlane_b32 s24, v4, 1
    s_waitcnt vmcnt(2)
    v_lshlrev_b32 v5, 16, v76
    v_and_b32 v6, 0xffff0000, v76
    v_fmac_f32 v104, s24, v5
    v_fmac_f32 v105, s24, v6
    v_lshlrev_b32 v5, 16, v77
    v_and_b32 v6, 0xffff0000, v77
    v_fmac_f32 v106, s24, v5
    v_fmac_f32 v107, s24, v6
    v_lshlrev_b32 v5, 16, v78
    v_and_b32 v6, 0xffff0000, v78
    v_fmac_f32 v108, s24, v5
    v_fmac_f32 v109, s24, v6
    v_lshlrev_b32 v5, 16, v79
    v_and_b32 v6, 0xffff0000, v79
    v_fmac_f32 v110, s24, v5
    v_fmac_f32 v111, s24, v6
    v_readlane_b32 s24, v4, 2
    s_waitcnt vmcnt(1)
    v_lshlrev_b32 v5, 16, v80
    v_and_b32 v6, 0xffff0000, v80
    v_fmac_f32 v104, s24, v5
    v_fmac_f32 v105, s24, v6
    v_lshlrev_b32 v5, 16, v81
    v_and_b32 v6, 0xffff0000, v81
    v_fmac_f32 v106, s24, v5
    v_fmac_f32 v107, s24, v6
    v_lshlrev_b32 v5, 16, v82
    v_and_b32 v6, 0xffff0000, v82
    v_fmac_f32 v108, s24, v5
    v_fmac_f32 v109, s24, v6
    v_lshlrev_b32 v5, 16, v83
    v_and_b32 v6, 0xffff0000, v83
    v_fmac_f32 v110, s24, v5
    v_fmac_f32 v111, s24, v6
    v_readlane_b32 s24, v4, 3
    s_waitcnt vmcnt(0)
    v_lshlrev_b32 v5, 16, v84
    v_and_b32 v6, 0xffff0000, v84
    v_fmac_f32 v104, s24, v5
    v_fmac_f32 v105, s24, v6
    v_lshlrev_b32 v5, 16, v85
    v_and_b32 v6, 0xffff0000, v85
    v_fmac_f32 v106, s24, v5
    v_fmac_f32 v107, s24, v6
    v_lshlrev_b32 v5, 16, v86
    v_and_b32 v6, 0xffff0000, v86
    v_fmac_f32 v108, s24, v5
    v_fmac_f32 v109, s24, v6
    v_lshlrev_b32 v5, 16, v87
    v_and_b32 v6, 0xffff0000, v87
    v_fmac_f32 v110, s24, v5
    v_fmac_f32 v111, s24, v6
    v_cvt_pk_bf16_f32 v4, v104, v105
    v_cvt_pk_bf16_f32 v5, v106, v107
    v_cvt_pk_bf16_f32 v6, v108, v109
    v_cvt_pk_bf16_f32 v7, v110, v111
    s_lshl_b32 s24, s3, 10
    s_add_u32 s24, s24, 145408
    v_add_u32 v3, s24, v2
    ds_write_b128 v3, v[4:7]
    s_lshl_b32 s24, s3, 8
    s_add_u32 s24, s24, 145408
    v_add_u32 v3, s24, v19
    s_waitcnt lgkmcnt(0)
    s_barrier
    ds_read_b128 v[32:35], v3 offset:0
    ds_read_b128 v[36:39], v3 offset:16
    ds_read_b128 v[40:43], v3 offset:32
    ds_read_b128 v[44:47], v3 offset:48
    ds_read_b128 v[48:51], v3 offset:2048
    ds_read_b128 v[52:55], v3 offset:2064
    ds_read_b128 v[56:59], v3 offset:2080
    ds_read_b128 v[60:63], v3 offset:2096
    s_waitcnt lgkmcnt(0)
    v_perm_b32 v8, v32, v32, v24
    v_perm_b32 v9, v32, v32, v25
    v_perm_b32 v10, v32, v32, v26
    v_perm_b32 v11, v32, v32, v27
    v_perm_b32 v4, v48, v48, v24
    v_perm_b32 v5, v48, v48, v25
    v_perm_b32 v6, v48, v48, v26
    v_perm_b32 v7, v48, v48, v27
    v_mfma_f32_16x16x32_bf16 v[12:15], v[128:131], v[8:11], 0
    s_nop 0
    v_mfma_f32_16x16x32_bf16 v[68:71], v[128:131], v[4:7], 0
    v_perm_b32 v8, v32, v32, v28
    v_perm_b32 v9, v32, v32, v29
    v_perm_b32 v10, v32, v32, v30
    v_perm_b32 v11, v32, v32, v31
    v_perm_b32 v4, v48, v48, v28
    v_perm_b32 v5, v48, v48, v29
    v_perm_b32 v6, v48, v48, v30
    v_perm_b32 v7, v48, v48, v31
    v_mfma_f32_16x16x32_bf16 v[12:15], v[132:135], v[8:11], v[12:15]
    s_nop 0
    v_mfma_f32_16x16x32_bf16 v[68:71], v[132:135], v[4:7], v[68:71]
    v_perm_b32 v8, v33, v33, v24
    v_perm_b32 v9, v33, v33, v25
    v_perm_b32 v10, v33, v33, v26
    v_perm_b32 v11, v33, v33, v27
    v_perm_b32 v4, v49, v49, v24
    v_perm_b32 v5, v49, v49, v25
    v_perm_b32 v6, v49, v49, v26
    v_perm_b32 v7, v49, v49, v27
    v_mfma_f32_16x16x32_bf16 v[12:15], v[136:139], v[8:11], v[12:15]
    s_nop 0
    v_mfma_f32_16x16x32_bf16 v[68:71], v[136:139], v[4:7], v[68:71]
    v_perm_b32 v8, v33, v33, v28
    v_perm_b32 v9, v33, v33, v29
    v_perm_b32 v10, v33, v33, v30
    v_perm_b32 v11, v33, v33, v31
    v_perm_b32 v4, v49, v49, v28
    v_perm_b32 v5, v49, v49, v29
    v_perm_b32 v6, v49, v49, v30
    v_perm_b32 v7, v49, v49, v31
    v_mfma_f32_16x16x32_bf16 v[12:15], v[140:143], v[8:11], v[12:15]
    s_nop 0
    v_mfma_f32_16x16x32_bf16 v[68:71], v[140:143], v[4:7], v[68:71]
    v_perm_b32 v8, v34, v34, v24
    v_perm_b32 v9, v34, v34, v25
    v_perm_b32 v10, v34, v34, v26
    v_perm_b32 v11, v34, v34, v27
    v_perm_b32 v4, v50, v50, v24
    v_perm_b32 v5, v50, v50, v25
    v_perm_b32 v6, v50, v50, v26
    v_perm_b32 v7, v50, v50, v27
    v_mfma_f32_16x16x32_bf16 v[12:15], v[144:147], v[8:11], v[12:15]
    s_nop 0
    v_mfma_f32_16x16x32_bf16 v[68:71], v[144:147], v[4:7], v[68:71]
    v_perm_b32 v8, v34, v34, v28
    v_perm_b32 v9, v34, v34, v29
    v_perm_b32 v10, v34, v34, v30
    v_perm_b32 v11, v34, v34, v31
    v_perm_b32 v4, v50, v50, v28
    v_perm_b32 v5, v50, v50, v29
    v_perm_b32 v6, v50, v50, v30
    v_perm_b32 v7, v50, v50, v31
    v_mfma_f32_16x16x32_bf16 v[12:15], v[148:151], v[8:11], v[12:15]
    s_nop 0
    v_mfma_f32_16x16x32_bf16 v[68:71], v[148:151], v[4:7], v[68:71]
    v_perm_b32 v8, v35, v35, v24
    v_perm_b32 v9, v35, v35, v25
    v_perm_b32 v10, v35, v35, v26
    v_perm_b32 v11, v35, v35, v27
    v_perm_b32 v4, v51, v51, v24
    v_perm_b32 v5, v51, v51, v25
    v_perm_b32 v6, v51, v51, v26
    v_perm_b32 v7, v51, v51, v27
    v_mfma_f32_16x16x32_bf16 v[12:15], v[152:155], v[8:11], v[12:15]
    s_nop 0
    v_mfma_f32_16x16x32_bf16 v[68:71], v[152:155], v[4:7], v[68:71]
    v_perm_b32 v8, v35, v35, v28
    v_perm_b32 v9, v35, v35, v29
    v_perm_b32 v10, v35, v35, v30
    v_perm_b32 v11, v35, v35, v31
    v_perm_b32 v4, v51, v51, v28
    v_perm_b32 v5, v51, v51, v29
    v_perm_b32 v6, v51, v51, v30
    v_perm_b32 v7, v51, v51, v31
    v_mfma_f32_16x16x32_bf16 v[12:15], v[156:159], v[8:11], v[12:15]
    s_nop 0
    v_mfma_f32_16x16x32_bf16 v[68:71], v[156:159], v[4:7], v[68:71]
    v_perm_b32 v8, v36, v36, v24
    v_perm_b32 v9, v36, v36, v25
    v_perm_b32 v10, v36, v36, v26
    v_perm_b32 v11, v36, v36, v27
    v_perm_b32 v4, v52, v52, v24
    v_perm_b32 v5, v52, v52, v25
    v_perm_b32 v6, v52, v52, v26
    v_perm_b32 v7, v52, v52, v27
    v_mfma_f32_16x16x32_bf16 v[12:15], v[160:163], v[8:11], v[12:15]
    s_nop 0
    v_mfma_f32_16x16x32_bf16 v[68:71], v[160:163], v[4:7], v[68:71]
    v_perm_b32 v8, v36, v36, v28
    v_perm_b32 v9, v36, v36, v29
    v_perm_b32 v10, v36, v36, v30
    v_perm_b32 v11, v36, v36, v31
    v_perm_b32 v4, v52, v52, v28
    v_perm_b32 v5, v52, v52, v29
    v_perm_b32 v6, v52, v52, v30
    v_perm_b32 v7, v52, v52, v31
    v_mfma_f32_16x16x32_bf16 v[12:15], v[164:167], v[8:11], v[12:15]
    s_nop 0
    v_mfma_f32_16x16x32_bf16 v[68:71], v[164:167], v[4:7], v[68:71]
    v_perm_b32 v8, v37, v37, v24
    v_perm_b32 v9, v37, v37, v25
    v_perm_b32 v10, v37, v37, v26
    v_perm_b32 v11, v37, v37, v27
    v_perm_b32 v4, v53, v53, v24
    v_perm_b32 v5, v53, v53, v25
    v_perm_b32 v6, v53, v53, v26
    v_perm_b32 v7, v53, v53, v27
    v_mfma_f32_16x16x32_bf16 v[12:15], v[168:171], v[8:11], v[12:15]
    s_nop 0
    v_mfma_f32_16x16x32_bf16 v[68:71], v[168:171], v[4:7], v[68:71]
    v_perm_b32 v8, v37, v37, v28
    v_perm_b32 v9, v37, v37, v29
    v_perm_b32 v10, v37, v37, v30
    v_perm_b32 v11, v37, v37, v31
    v_perm_b32 v4, v53, v53, v28
    v_perm_b32 v5, v53, v53, v29
    v_perm_b32 v6, v53, v53, v30
    v_perm_b32 v7, v53, v53, v31
    v_mfma_f32_16x16x32_bf16 v[12:15], v[172:175], v[8:11], v[12:15]
    s_nop 0
    v_mfma_f32_16x16x32_bf16 v[68:71], v[172:175], v[4:7], v[68:71]
    v_perm_b32 v8, v38, v38, v24
    v_perm_b32 v9, v38, v38, v25
    v_perm_b32 v10, v38, v38, v26
    v_perm_b32 v11, v38, v38, v27
    v_perm_b32 v4, v54, v54, v24
    v_perm_b32 v5, v54, v54, v25
    v_perm_b32 v6, v54, v54, v26
    v_perm_b32 v7, v54, v54, v27
    v_mfma_f32_16x16x32_bf16 v[12:15], v[176:179], v[8:11], v[12:15]
    s_nop 0
    v_mfma_f32_16x16x32_bf16 v[68:71], v[176:179], v[4:7], v[68:71]
    v_perm_b32 v8, v38, v38, v28
    v_perm_b32 v9, v38, v38, v29
    v_perm_b32 v10, v38, v38, v30
    v_perm_b32 v11, v38, v38, v31
    v_perm_b32 v4, v54, v54, v28
    v_perm_b32 v5, v54, v54, v29
    v_perm_b32 v6, v54, v54, v30
    v_perm_b32 v7, v54, v54, v31
    v_mfma_f32_16x16x32_bf16 v[12:15], v[180:183], v[8:11], v[12:15]
    s_nop 0
    v_mfma_f32_16x16x32_bf16 v[68:71], v[180:183], v[4:7], v[68:71]
    v_perm_b32 v8, v39, v39, v24
    v_perm_b32 v9, v39, v39, v25
    v_perm_b32 v10, v39, v39, v26
    v_perm_b32 v11, v39, v39, v27
    v_perm_b32 v4, v55, v55, v24
    v_perm_b32 v5, v55, v55, v25
    v_perm_b32 v6, v55, v55, v26
    v_perm_b32 v7, v55, v55, v27
    v_mfma_f32_16x16x32_bf16 v[12:15], v[184:187], v[8:11], v[12:15]
    s_nop 0
    v_mfma_f32_16x16x32_bf16 v[68:71], v[184:187], v[4:7], v[68:71]
    v_perm_b32 v8, v39, v39, v28
    v_perm_b32 v9, v39, v39, v29
    v_perm_b32 v10, v39, v39, v30
    v_perm_b32 v11, v39, v39, v31
    v_perm_b32 v4, v55, v55, v28
    v_perm_b32 v5, v55, v55, v29
    v_perm_b32 v6, v55, v55, v30
    v_perm_b32 v7, v55, v55, v31
    v_mfma_f32_16x16x32_bf16 v[12:15], v[188:191], v[8:11], v[12:15]
    s_nop 0
    v_mfma_f32_16x16x32_bf16 v[68:71], v[188:191], v[4:7], v[68:71]
    v_perm_b32 v8, v40, v40, v24
    v_perm_b32 v9, v40, v40, v25
    v_perm_b32 v10, v40, v40, v26
    v_perm_b32 v11, v40, v40, v27
    v_perm_b32 v4, v56, v56, v24
    v_perm_b32 v5, v56, v56, v25
    v_perm_b32 v6, v56, v56, v26
    v_perm_b32 v7, v56, v56, v27
    v_mfma_f32_16x16x32_bf16 v[12:15], v[192:195], v[8:11], v[12:15]
    s_nop 0
    v_mfma_f32_16x16x32_bf16 v[68:71], v[192:195], v[4:7], v[68:71]
    v_perm_b32 v8, v40, v40, v28
    v_perm_b32 v9, v40, v40, v29
    v_perm_b32 v10, v40, v40, v30
    v_perm_b32 v11, v40, v40, v31
    v_perm_b32 v4, v56, v56, v28
    v_perm_b32 v5, v56, v56, v29
    v_perm_b32 v6, v56, v56, v30
    v_perm_b32 v7, v56, v56, v31
    v_mfma_f32_16x16x32_bf16 v[12:15], v[196:199], v[8:11], v[12:15]
    s_nop 0
    v_mfma_f32_16x16x32_bf16 v[68:71], v[196:199], v[4:7], v[68:71]
    v_perm_b32 v8, v41, v41, v24
    v_perm_b32 v9, v41, v41, v25
    v_perm_b32 v10, v41, v41, v26
    v_perm_b32 v11, v41, v41, v27
    v_perm_b32 v4, v57, v57, v24
    v_perm_b32 v5, v57, v57, v25
    v_perm_b32 v6, v57, v57, v26
    v_perm_b32 v7, v57, v57, v27
    v_mfma_f32_16x16x32_bf16 v[12:15], v[200:203], v[8:11], v[12:15]
    s_nop 0
    v_mfma_f32_16x16x32_bf16 v[68:71], v[200:203], v[4:7], v[68:71]
    v_perm_b32 v8, v41, v41, v28
    v_perm_b32 v9, v41, v41, v29
    v_perm_b32 v10, v41, v41, v30
    v_perm_b32 v11, v41, v41, v31
    v_perm_b32 v4, v57, v57, v28
    v_perm_b32 v5, v57, v57, v29
    v_perm_b32 v6, v57, v57, v30
    v_perm_b32 v7, v57, v57, v31
    v_mfma_f32_16x16x32_bf16 v[12:15], v[204:207], v[8:11], v[12:15]
    s_nop 0
    v_mfma_f32_16x16x32_bf16 v[68:71], v[204:207], v[4:7], v[68:71]
    v_perm_b32 v8, v42, v42, v24
    v_perm_b32 v9, v42, v42, v25
    v_perm_b32 v10, v42, v42, v26
    v_perm_b32 v11, v42, v42, v27
    v_perm_b32 v4, v58, v58, v24
    v_perm_b32 v5, v58, v58, v25
    v_perm_b32 v6, v58, v58, v26
    v_perm_b32 v7, v58, v58, v27
    v_mfma_f32_16x16x32_bf16 v[12:15], v[208:211], v[8:11], v[12:15]
    s_nop 0
    v_mfma_f32_16x16x32_bf16 v[68:71], v[208:211], v[4:7], v[68:71]
    v_perm_b32 v8, v42, v42, v28
    v_perm_b32 v9, v42, v42, v29
    v_perm_b32 v10, v42, v42, v30
    v_perm_b32 v11, v42, v42, v31
    v_perm_b32 v4, v58, v58, v28
    v_perm_b32 v5, v58, v58, v29
    v_perm_b32 v6, v58, v58, v30
    v_perm_b32 v7, v58, v58, v31
    v_mfma_f32_16x16x32_bf16 v[12:15], v[212:215], v[8:11], v[12:15]
    s_nop 0
    v_mfma_f32_16x16x32_bf16 v[68:71], v[212:215], v[4:7], v[68:71]
    v_perm_b32 v8, v43, v43, v24
    v_perm_b32 v9, v43, v43, v25
    v_perm_b32 v10, v43, v43, v26
    v_perm_b32 v11, v43, v43, v27
    v_perm_b32 v4, v59, v59, v24
    v_perm_b32 v5, v59, v59, v25
    v_perm_b32 v6, v59, v59, v26
    v_perm_b32 v7, v59, v59, v27
    v_mfma_f32_16x16x32_bf16 v[12:15], v[216:219], v[8:11], v[12:15]
    s_nop 0
    v_mfma_f32_16x16x32_bf16 v[68:71], v[216:219], v[4:7], v[68:71]
    v_perm_b32 v8, v43, v43, v28
    v_perm_b32 v9, v43, v43, v29
    v_perm_b32 v10, v43, v43, v30
    v_perm_b32 v11, v43, v43, v31
    v_perm_b32 v4, v59, v59, v28
    v_perm_b32 v5, v59, v59, v29
    v_perm_b32 v6, v59, v59, v30
    v_perm_b32 v7, v59, v59, v31
    v_mfma_f32_16x16x32_bf16 v[12:15], v[220:223], v[8:11], v[12:15]
    s_nop 0
    v_mfma_f32_16x16x32_bf16 v[68:71], v[220:223], v[4:7], v[68:71]
    v_perm_b32 v8, v44, v44, v24
    v_perm_b32 v9, v44, v44, v25
    v_perm_b32 v10, v44, v44, v26
    v_perm_b32 v11, v44, v44, v27
    v_perm_b32 v4, v60, v60, v24
    v_perm_b32 v5, v60, v60, v25
    v_perm_b32 v6, v60, v60, v26
    v_perm_b32 v7, v60, v60, v27
    v_mfma_f32_16x16x32_bf16 v[12:15], v[224:227], v[8:11], v[12:15]
    s_nop 0
    v_mfma_f32_16x16x32_bf16 v[68:71], v[224:227], v[4:7], v[68:71]
    v_perm_b32 v8, v44, v44, v28
    v_perm_b32 v9, v44, v44, v29
    v_perm_b32 v10, v44, v44, v30
    v_perm_b32 v11, v44, v44, v31
    v_perm_b32 v4, v60, v60, v28
    v_perm_b32 v5, v60, v60, v29
    v_perm_b32 v6, v60, v60, v30
    v_perm_b32 v7, v60, v60, v31
    v_mfma_f32_16x16x32_bf16 v[12:15], v[228:231], v[8:11], v[12:15]
    s_nop 0
    v_mfma_f32_16x16x32_bf16 v[68:71], v[228:231], v[4:7], v[68:71]
    v_perm_b32 v8, v45, v45, v24
    v_perm_b32 v9, v45, v45, v25
    v_perm_b32 v10, v45, v45, v26
    v_perm_b32 v11, v45, v45, v27
    v_perm_b32 v4, v61, v61, v24
    v_perm_b32 v5, v61, v61, v25
    v_perm_b32 v6, v61, v61, v26
    v_perm_b32 v7, v61, v61, v27
    v_mfma_f32_16x16x32_bf16 v[12:15], v[232:235], v[8:11], v[12:15]
    s_nop 0
    v_mfma_f32_16x16x32_bf16 v[68:71], v[232:235], v[4:7], v[68:71]
    v_perm_b32 v8, v45, v45, v28
    v_perm_b32 v9, v45, v45, v29
    v_perm_b32 v10, v45, v45, v30
    v_perm_b32 v11, v45, v45, v31
    v_perm_b32 v4, v61, v61, v28
    v_perm_b32 v5, v61, v61, v29
    v_perm_b32 v6, v61, v61, v30
    v_perm_b32 v7, v61, v61, v31
    v_mfma_f32_16x16x32_bf16 v[12:15], v[236:239], v[8:11], v[12:15]
    s_nop 0
    v_mfma_f32_16x16x32_bf16 v[68:71], v[236:239], v[4:7], v[68:71]
    v_perm_b32 v8, v46, v46, v24
    v_perm_b32 v9, v46, v46, v25
    v_perm_b32 v10, v46, v46, v26
    v_perm_b32 v11, v46, v46, v27
    v_perm_b32 v4, v62, v62, v24
    v_perm_b32 v5, v62, v62, v25
    v_perm_b32 v6, v62, v62, v26
    v_perm_b32 v7, v62, v62, v27
    v_mfma_f32_16x16x32_bf16 v[12:15], v[240:243], v[8:11], v[12:15]
    s_nop 0
    v_mfma_f32_16x16x32_bf16 v[68:71], v[240:243], v[4:7], v[68:71]
    v_perm_b32 v8, v46, v46, v28
    v_perm_b32 v9, v46, v46, v29
    v_perm_b32 v10, v46, v46, v30
    v_perm_b32 v11, v46, v46, v31
    v_perm_b32 v4, v62, v62, v28
    v_perm_b32 v5, v62, v62, v29
    v_perm_b32 v6, v62, v62, v30
    v_perm_b32 v7, v62, v62, v31
    v_mfma_f32_16x16x32_bf16 v[12:15], v[244:247], v[8:11], v[12:15]
    s_nop 0
    v_mfma_f32_16x16x32_bf16 v[68:71], v[244:247], v[4:7], v[68:71]
    v_perm_b32 v8, v47, v47, v24
    v_perm_b32 v9, v47, v47, v25
    v_perm_b32 v10, v47, v47, v26
    v_perm_b32 v11, v47, v47, v27
    v_perm_b32 v4, v63, v63, v24
    v_perm_b32 v5, v63, v63, v25
    v_perm_b32 v6, v63, v63, v26
    v_perm_b32 v7, v63, v63, v27
    v_mfma_f32_16x16x32_bf16 v[12:15], v[248:251], v[8:11], v[12:15]
    s_nop 0
    v_mfma_f32_16x16x32_bf16 v[68:71], v[248:251], v[4:7], v[68:71]
    v_perm_b32 v8, v47, v47, v28
    v_perm_b32 v9, v47, v47, v29
    v_perm_b32 v10, v47, v47, v30
    v_perm_b32 v11, v47, v47, v31
    v_perm_b32 v4, v63, v63, v28
    v_perm_b32 v5, v63, v63, v29
    v_perm_b32 v6, v63, v63, v30
    v_perm_b32 v7, v63, v63, v31
    v_mfma_f32_16x16x32_bf16 v[12:15], v[252:255], v[8:11], v[12:15]
    s_nop 0
    v_mfma_f32_16x16x32_bf16 v[68:71], v[252:255], v[4:7], v[68:71]
    v_lshrrev_b32 v3, 4, v0
    v_lshlrev_b32 v3, 7, v3
    v_and_b32 v4, 7, v0
    v_lshl_add_u32 v3, v4, 4, v3
    v_bfe_u32 v4, v0, 3, 1
    v_lshl_add_u32 v3, v4, 9, v3
    s_lshl_b32 s24, s3, 11
    s_add_u32 s24, s24, 135168
    v_add_u32 v3, s24, v3
    ds_write_b128 v3, v[12:15]
    ds_write_b128 v3, v[68:71] offset:1024
    s_waitcnt lgkmcnt(0)
    s_barrier
    v_and_b32 v5, 31, v0
    s_lshl_b32 s24, s3, 9
    s_add_u32 s24, s24, 135168
    v_lshl_add_u32 v3, v5, 4, s24
    ds_read_b128 v[72:75], v3 offset:0
    ds_read_b128 v[76:79], v3 offset:2048
    ds_read_b128 v[80:83], v3 offset:4096
    ds_read_b128 v[84:87], v3 offset:6144
    s_mul_i32 s24, s3, 320
    s_add_u32 s24, s24, 143360
    v_lshl_add_u32 v5, v5, 3, s24
    s_waitcnt lgkmcnt(0)
    v_add_f32 v72, v72, v76
    v_add_f32 v73, v73, v77
    v_add_f32 v74, v74, v78
    v_add_f32 v75, v75, v79
    v_add_f32 v72, v72, v80
    v_add_f32 v73, v73, v81
    v_add_f32 v74, v74, v82
    v_add_f32 v75, v75, v83
    v_add_f32 v72, v72, v84
    v_add_f32 v73, v73, v85
    v_add_f32 v74, v74, v86
    v_add_f32 v75, v75, v87
    v_cvt_pk_bf16_f32 v6, v72, v73
    v_cvt_pk_bf16_f32 v7, v74, v75
    ds_write_b64 v5, v[6:7]
    v_lshrrev_b32 v3, 4, v0
    v_and_b32 v4, 3, v0
    v_mul_u32_u24 v5, 320, v4
    v_lshl_add_u32 v5, v3, 4, v5
    v_add_u32 v5, 143360, v5
    s_waitcnt lgkmcnt(0)
    s_barrier
    ds_read_b128 v[32:35], v5 offset:0
    ds_read_b128 v[36:39], v5 offset:64
    ds_read_b128 v[40:43], v5 offset:128
    ds_read_b128 v[44:47], v5 offset:192
    s_waitcnt lgkmcnt(3)
    v_mfma_f32_16x16x32_bf16 v[72:75], v[32:35], a[0:3], 0
    s_waitcnt lgkmcnt(2)
    v_mfma_f32_16x16x32_bf16 v[72:75], v[36:39], a[4:7], v[72:75]
    s_waitcnt lgkmcnt(1)
    v_mfma_f32_16x16x32_bf16 v[72:75], v[40:43], a[8:11], v[72:75]
    s_waitcnt lgkmcnt(0)
    v_mfma_f32_16x16x32_bf16 v[72:75], v[44:47], a[12:15], v[72:75]
    v_mfma_f32_16x16x32_bf16 v[76:79], v[32:35], a[16:19], 0
    v_mfma_f32_16x16x32_bf16 v[76:79], v[36:39], a[20:23], v[76:79]
    v_mfma_f32_16x16x32_bf16 v[76:79], v[40:43], a[24:27], v[76:79]
    v_mfma_f32_16x16x32_bf16 v[76:79], v[44:47], a[28:31], v[76:79]
    v_mfma_f32_16x16x32_bf16 v[80:83], v[32:35], a[32:35], 0
    v_mfma_f32_16x16x32_bf16 v[80:83], v[36:39], a[36:39], v[80:83]
    v_mfma_f32_16x16x32_bf16 v[80:83], v[40:43], a[40:43], v[80:83]
    v_mfma_f32_16x16x32_bf16 v[80:83], v[44:47], a[44:47], v[80:83]
    v_mov_b32_dpp v4, v72 quad_perm:[0,1,2,3] row_mask:0x1 bank_mask:0xf
    v_mov_b32_dpp v5, v73 quad_perm:[0,1,2,3] row_mask:0x1 bank_mask:0xf
    v_mov_b32_dpp v6, v74 quad_perm:[0,1,2,3] row_mask:0x1 bank_mask:0xf
    v_mov_b32_dpp v7, v75 quad_perm:[0,1,2,3] row_mask:0x1 bank_mask:0xf
    v_mfma_f32_16x16x32_bf16 v[84:87], v[32:35], a[48:51], 0
    v_mfma_f32_16x16x32_bf16 v[84:87], v[36:39], a[52:55], v[84:87]
    v_mfma_f32_16x16x32_bf16 v[84:87], v[40:43], a[56:59], v[84:87]
    v_mfma_f32_16x16x32_bf16 v[84:87], v[44:47], a[60:63], v[84:87]
    v_mov_b32_dpp v4, v76 quad_perm:[0,1,2,3] row_mask:0x2 bank_mask:0xf
    v_mov_b32_dpp v5, v77 quad_perm:[0,1,2,3] row_mask:0x2 bank_mask:0xf
    v_mov_b32_dpp v6, v78 quad_perm:[0,1,2,3] row_mask:0x2 bank_mask:0xf
    v_mov_b32_dpp v7, v79 quad_perm:[0,1,2,3] row_mask:0x2 bank_mask:0xf
    v_mfma_f32_16x16x32_bf16 v[88:91], v[32:35], a[64:67], 0
    v_mfma_f32_16x16x32_bf16 v[88:91], v[36:39], a[68:71], v[88:91]
    v_mfma_f32_16x16x32_bf16 v[88:91], v[40:43], a[72:75], v[88:91]
    v_mfma_f32_16x16x32_bf16 v[88:91], v[44:47], a[76:79], v[88:91]
    v_mov_b32_dpp v4, v80 quad_perm:[0,1,2,3] row_mask:0x4 bank_mask:0xf
    v_mov_b32_dpp v5, v81 quad_perm:[0,1,2,3] row_mask:0x4 bank_mask:0xf
    v_mov_b32_dpp v6, v82 quad_perm:[0,1,2,3] row_mask:0x4 bank_mask:0xf
    v_mov_b32_dpp v7, v83 quad_perm:[0,1,2,3] row_mask:0x4 bank_mask:0xf
    v_mfma_f32_16x16x32_bf16 v[92:95], v[32:35], a[80:83], 0
    v_mfma_f32_16x16x32_bf16 v[92:95], v[36:39], a[84:87], v[92:95]
    v_mfma_f32_16x16x32_bf16 v[92:95], v[40:43], a[88:91], v[92:95]
    v_mfma_f32_16x16x32_bf16 v[92:95], v[44:47], a[92:95], v[92:95]
    v_mov_b32_dpp v4, v84 quad_perm:[0,1,2,3] row_mask:0x8 bank_mask:0xf
    v_mov_b32_dpp v5, v85 quad_perm:[0,1,2,3] row_mask:0x8 bank_mask:0xf
    v_mov_b32_dpp v6, v86 quad_perm:[0,1,2,3] row_mask:0x8 bank_mask:0xf
    v_mov_b32_dpp v7, v87 quad_perm:[0,1,2,3] row_mask:0x8 bank_mask:0xf
    v_mfma_f32_16x16x32_bf16 v[96:99], v[32:35], a[96:99], 0
    v_mfma_f32_16x16x32_bf16 v[96:99], v[36:39], a[100:103], v[96:99]
    v_mfma_f32_16x16x32_bf16 v[96:99], v[40:43], a[104:107], v[96:99]
    v_mfma_f32_16x16x32_bf16 v[96:99], v[44:47], a[108:111], v[96:99]
    v_mov_b32_dpp v8, v88 quad_perm:[0,1,2,3] row_mask:0x1 bank_mask:0xf
    v_mov_b32_dpp v9, v89 quad_perm:[0,1,2,3] row_mask:0x1 bank_mask:0xf
    v_mov_b32_dpp v10, v90 quad_perm:[0,1,2,3] row_mask:0x1 bank_mask:0xf
    v_mov_b32_dpp v11, v91 quad_perm:[0,1,2,3] row_mask:0x1 bank_mask:0xf
    v_mfma_f32_16x16x32_bf16 v[100:103], v[32:35], a[112:115], 0
    v_mfma_f32_16x16x32_bf16 v[100:103], v[36:39], a[116:119], v[100:103]
    v_mfma_f32_16x16x32_bf16 v[100:103], v[40:43], a[120:123], v[100:103]
    v_mfma_f32_16x16x32_bf16 v[100:103], v[44:47], a[124:127], v[100:103]
    v_mov_b32_dpp v8, v92 quad_perm:[0,1,2,3] row_mask:0x2 bank_mask:0xf
    v_mov_b32_dpp v9, v93 quad_perm:[0,1,2,3] row_mask:0x2 bank_mask:0xf
    v_mov_b32_dpp v10, v94 quad_perm:[0,1,2,3] row_mask:0x2 bank_mask:0xf
    v_mov_b32_dpp v11, v95 quad_perm:[0,1,2,3] row_mask:0x2 bank_mask:0xf
    v_mov_b32_dpp v8, v96 quad_perm:[0,1,2,3] row_mask:0x4 bank_mask:0xf
    v_mov_b32_dpp v9, v97 quad_perm:[0,1,2,3] row_mask:0x4 bank_mask:0xf
    v_mov_b32_dpp v10, v98 quad_perm:[0,1,2,3] row_mask:0x4 bank_mask:0xf
    v_mov_b32_dpp v11, v99 quad_perm:[0,1,2,3] row_mask:0x4 bank_mask:0xf
    v_mov_b32_dpp v8, v100 quad_perm:[0,1,2,3] row_mask:0x8 bank_mask:0xf
    v_mov_b32_dpp v9, v101 quad_perm:[0,1,2,3] row_mask:0x8 bank_mask:0xf
    v_mov_b32_dpp v10, v102 quad_perm:[0,1,2,3] row_mask:0x8 bank_mask:0xf
    v_mov_b32_dpp v11, v103 quad_perm:[0,1,2,3] row_mask:0x8 bank_mask:0xf
    v_cvt_pk_bf16_f32 v12, v4, v5
    v_cvt_pk_bf16_f32 v13, v6, v7
    v_cvt_pk_bf16_f32 v14, v8, v9
    v_cvt_pk_bf16_f32 v15, v10, v11
    s_mov_b32 s20, s58
    s_mov_b32 s21, s59
    s_mov_b32 s22, 0x2000
    s_mov_b32 s23, 0x20000
    v_and_b32 v3, 3, v0
    v_lshlrev_b32 v80, 4, v3
    v_bfe_u32 v4, v0, 2, 1
    v_lshl_add_u32 v80, v4, 3, v80
    v_lshrrev_b32 v5, 3, v0
    v_lshl_add_u32 v80, v5, 6, v80
    v_lshlrev_b32 v82, 11, v3
    v_lshl_add_u32 v82, v4, 3, v82
    v_lshrrev_b32 v3, 4, v0
    v_lshl_add_u32 v82, v3, 4, v82
    v_and_b32 v5, 1, v5
    v_lshl_add_u32 v82, v5, 6, v82
    v_and_b32 v81, 0xf0, v2
    v_lshl_add_u32 v81, v3, 14, v81
    v_cmp_eq_u32 vcc, 0, v5
    v_mov_b32 v3, 0x3f803f80
    s_nop 0
    v_cndmask_b32 v4, 0, v3, vcc
    v_xor_b32 v5, v3, v4
    v_and_b32 v84, v4, v20
    v_and_b32 v88, v5, v20
    v_and_b32 v85, v4, v21
    v_and_b32 v89, v5, v21
    v_and_b32 v86, v4, v22
    v_and_b32 v90, v5, v22
    v_and_b32 v87, v4, v23
    v_and_b32 v91, v5, v23
    s_lshl_b32 s30, s3, 12
    s_add_u32 s30, s30, 0x80000
    s_lshl_b32 s24, s26, 14
    s_add_u32 s24, s24, s30
    buffer_store_dwordx2 v[12:13], v80, s[12:15], s24 offen sc1 nt
    buffer_store_dwordx2 v[14:15], v80, s[12:15], s24 offen offset:512 sc1 nt
    s_lshl_b32 s24, s3, 7
    s_add_u32 s24, s24, 0x1d9000
    s_waitcnt vmcnt(0)
    s_mov_b64 exec, 1
    v_mov_b32 v83, 64
    buffer_atomic_add v83, off, s[12:15], s24 sc0
    s_mov_b64 exec, -1
    s_waitcnt vmcnt(0)
    v_readfirstlane_b32 s24, v83
    s_nop 0
    s_cmp_lg_u32 s24, 1983
    s_cbranch_scc1 L_W_x
    s_lshl_b32 s31, s3, 8
L_W_f:
    s_mov_b32 s25, 262144
L_fi16:
    s_mov_b32 s24, s30
    buffer_load_dwordx4 v[128:131], v81, s[12:15], s24 offen offset:0 sc1 nt
    buffer_load_dwordx4 v[132:135], v81, s[12:15], s24 offen offset:256 sc1 nt
    s_add_u32 s24, s24, 65536
    buffer_load_dwordx4 v[136:139], v81, s[12:15], s24 offen offset:0 sc1 nt
    buffer_load_dwordx4 v[140:143], v81, s[12:15], s24 offen offset:256 sc1 nt
    s_add_u32 s24, s24, 65536
    buffer_load_dwordx4 v[144:147], v81, s[12:15], s24 offen offset:0 sc1 nt
    buffer_load_dwordx4 v[148:151], v81, s[12:15], s24 offen offset:256 sc1 nt
    s_add_u32 s24, s24, 65536
    buffer_load_dwordx4 v[152:155], v81, s[12:15], s24 offen offset:0 sc1 nt
    buffer_load_dwordx4 v[156:159], v81, s[12:15], s24 offen offset:256 sc1 nt
    s_add_u32 s24, s24, 65536
    buffer_load_dwordx4 v[160:163], v81, s[12:15], s24 offen offset:0 sc1 nt
    buffer_load_dwordx4 v[164:167], v81, s[12:15], s24 offen offset:256 sc1 nt
    s_add_u32 s24, s24, 65536
    buffer_load_dwordx4 v[168:171], v81, s[12:15], s24 offen offset:0 sc1 nt
    buffer_load_dwordx4 v[172:175], v81, s[12:15], s24 offen offset:256 sc1 nt
    s_add_u32 s24, s24, 65536
    buffer_load_dwordx4 v[176:179], v81, s[12:15], s24 offen offset:0 sc1 nt
    buffer_load_dwordx4 v[180:183], v81, s[12:15], s24 offen offset:256 sc1 nt
    s_add_u32 s24, s24, 65536
    buffer_load_dwordx4 v[184:187], v81, s[12:15], s24 offen offset:0 sc1 nt
    buffer_load_dwordx4 v[188:191], v81, s[12:15], s24 offen offset:256 sc1 nt
    s_waitcnt vmcnt(15)
    v_mfma_f32_16x16x32_bf16 v[92:95], v[128:131], v[84:87], 0
    s_waitcnt vmcnt(14)
    v_mfma_f32_16x16x32_bf16 v[92:95], v[132:135], v[88:91], v[92:95]
    s_waitcnt vmcnt(13)
    v_mfma_f32_16x16x32_bf16 v[92:95], v[136:139], v[84:87], v[92:95]
    s_waitcnt vmcnt(12)
    v_mfma_f32_16x16x32_bf16 v[92:95], v[140:143], v[88:91], v[92:95]
    s_waitcnt vmcnt(11)
    v_mfma_f32_16x16x32_bf16 v[92:95], v[144:147], v[84:87], v[92:95]
    s_waitcnt vmcnt(10)
    v_mfma_f32_16x16x32_bf16 v[92:95], v[148:151], v[88:91], v[92:95]
    s_waitcnt vmcnt(9)
    v_mfma_f32_16x16x32_bf16 v[92:95], v[152:155], v[84:87], v[92:95]
    s_waitcnt vmcnt(8)
    v_mfma_f32_16x16x32_bf16 v[92:95], v[156:159], v[88:91], v[92:95]
    s_waitcnt vmcnt(7)
    v_mfma_f32_16x16x32_bf16 v[92:95], v[160:163], v[84:87], v[92:95]
    s_waitcnt vmcnt(6)
    v_mfma_f32_16x16x32_bf16 v[92:95], v[164:167], v[88:91], v[92:95]
    s_waitcnt vmcnt(5)
    v_mfma_f32_16x16x32_bf16 v[92:95], v[168:171], v[84:87], v[92:95]
    s_waitcnt vmcnt(4)
    v_mfma_f32_16x16x32_bf16 v[92:95], v[172:175], v[88:91], v[92:95]
    s_waitcnt vmcnt(3)
    v_mfma_f32_16x16x32_bf16 v[92:95], v[176:179], v[84:87], v[92:95]
    s_waitcnt vmcnt(2)
    v_mfma_f32_16x16x32_bf16 v[92:95], v[180:183], v[88:91], v[92:95]
    s_waitcnt vmcnt(1)
    v_mfma_f32_16x16x32_bf16 v[92:95], v[184:187], v[84:87], v[92:95]
    s_waitcnt vmcnt(0)
    v_mfma_f32_16x16x32_bf16 v[92:95], v[188:191], v[88:91], v[92:95]
    s_nop 7
    v_cmp_u_f32 vcc, v92, v93
    v_cmp_u_f32 s[68:69], v94, v95
    v_cvt_pk_bf16_f32 v4, v92, v93
    v_cvt_pk_bf16_f32 v5, v94, v95
    s_or_b64 vcc, vcc, s[68:69]
    s_cbranch_scc0 L_fi16_x
    v_max_u32 v3, v128, v129
    v_max3_u32 v3, v3, v130, v131
    v_max3_u32 v3, v3, v132, v133
    v_max3_u32 v3, v3, v134, v135
    v_max3_u32 v3, v3, v136, v137
    v_max3_u32 v3, v3, v138, v139
    v_max3_u32 v3, v3, v140, v141
    v_max3_u32 v3, v3, v142, v143
    v_max3_u32 v3, v3, v144, v145
    v_max3_u32 v3, v3, v146, v147
    v_max3_u32 v3, v3, v148, v149
    v_max3_u32 v3, v3, v150, v151
    v_max3_u32 v3, v3, v152, v153
    v_max3_u32 v3, v3, v154, v155
    v_max3_u32 v3, v3, v156, v157
    v_max3_u32 v3, v3, v158, v159
    v_max3_u32 v3, v3, v160, v161
    v_max3_u32 v3, v3, v162, v163
    v_max3_u32 v3, v3, v164, v165
    v_max3_u32 v3, v3, v166, v167
    v_max3_u32 v3, v3, v168, v169
    v_max3_u32 v3, v3, v170, v171
    v_max3_u32 v3, v3, v172, v173
    v_max3_u32 v3, v3, v174, v175
    v_max3_u32 v3, v3, v176, v177
    v_max3_u32 v3, v3, v178, v179
    v_max3_u32 v3, v3, v180, v181
    v_max3_u32 v3, v3, v182, v183
    v_max3_u32 v3, v3, v184, v185
    v_max3_u32 v3, v3, v186, v187
    v_max3_u32 v3, v3, v188, v189
    v_max3_u32 v3, v3, v190, v191
    v_cmp_eq_u32 vcc, -1, v3
    s_sub_u32 s25, s25, 1
    s_cmp_eq_u32 s25, 0
    s_cbranch_scc1 L_fi16_x
    s_cmp_lg_u64 vcc, 0
    s_cbranch_scc1 L_fi16
L_fi16_x:
    buffer_store_dwordx2 v[4:5], v82, s[20:23], s31 offen
    s_add_u32 s30, s30, 512
    s_add_u32 s31, s31, 128
    s_bitcmp1_b32 s31, 7
    s_cbranch_scc1 L_W_f
L_W_x:
    s_barrier
L_R:
    s_mov_b32 s20, s58
    s_mov_b32 s21, s59
    s_mov_b32 s22, 0x2000
    s_mov_b32 s23, 0x20000
    v_and_b32 v3, 1, v0
    v_lshlrev_b32 v3, 4, v3
    v_mov_b32 v4, 0xffff
    v_lshlrev_b32 v4, v3, v4
    v_bfe_u32 v3, v0, 1, 2
    v_cmp_eq_u32 vcc, 0, v3
    s_nop 1
    v_cndmask_b32 v20, 0, v4, vcc
    v_cmp_eq_u32 vcc, 1, v3
    s_nop 1
    v_cndmask_b32 v21, 0, v4, vcc
    v_cmp_eq_u32 vcc, 2, v3
    s_nop 1
    v_cndmask_b32 v22, 0, v4, vcc
    v_cmp_eq_u32 vcc, 3, v3
    s_nop 1
    v_cndmask_b32 v23, 0, v4, vcc
    v_lshrrev_b32 v3, 4, v0
    v_and_b32 v4, 7, v0
    v_bfe_u32 v7, v0, 3, 1
    v_lshl_add_u32 v5, v3, 3, v4
    v_mul_u32_u24 v6, 320, v7
    v_lshl_add_u32 v5, v5, 3, v6
    s_mul_i32 s24, s3, 1280
    s_add_u32 s24, s24, 135168
    v_add_u32 v24, s24, v5
    v_and_b32 v5, 3, v0
    v_mul_u32_u24 v25, 320, v5
    v_lshl_add_u32 v25, v3, 4, v25
    v_add_u32 v25, 135168, v25
    v_lshlrev_b32 v26, 4, v4
    v_lshl_add_u32 v26, v7, 3, v26
    v_and_b32 v5, 15, v0
    v_lshlrev_b32 v28, 11, v3
    v_lshl_add_u32 v28, v5, 1, v28
    s_and_b32 s24, s74, 7
    s_lshl_b32 s24, s24, 3
    s_bfm_b64 s[44:45], 8, s24
    s_not_b64 s[44:45], s[44:45]
    v_min_u32 v6, 5, v4
    v_lshrrev_b32 v5, 1, v6
    v_and_b32 v8, 1, v3
    v_mad_u32_u24 v5, v8, 3, v5
    v_lshlrev_b32 v31, 12, v5
    v_and_b32 v6, 1, v6
    v_lshl_add_u32 v6, v7, 1, v6
    v_lshl_add_u32 v31, v6, 4, v31
    s_and_b32 s35, s72, 7
    s_lshl_b32 s35, s35, 7
    s_add_u32 s35, s35, 0x1c0000
    s_lshr_b32 s34, s72, 3
    s_mul_i32 s34, s34, 6
    s_mul_i32 s29, s3, 24576
    s_add_u32 s29, s29, s35
    s_mov_b32 s24, 262144
    s_branch L_pd17_in
L_pd17:
    s_sleep 64
L_pd17_in:
    buffer_load_dwordx2 v[8:9], v31, s[12:15], s29 offen sc1
    s_waitcnt vmcnt(0)
    v_max_u32 v3, v8, v9
    v_cmp_eq_u32 vcc, -1, v3
    s_sub_u32 s24, s24, 1
    s_cmp_eq_u32 s24, 0
    s_cbranch_scc1 L_pd17_x
    s_and_b64 exec, exec, vcc
    s_cbranch_scc1 L_pd17
L_pd17_x:
    s_mov_b64 exec, -1
    v_mov_b32 v6, v8
    s_nop 1
    v_max_f32_dpp v6, v6, v6 quad_perm:[1,0,3,2] row_mask:0xf bank_mask:0xf
    s_nop 1
    v_max_f32_dpp v6, v6, v6 quad_perm:[2,3,0,1] row_mask:0xf bank_mask:0xf
    s_nop 1
    v_max_f32_dpp v6, v6, v6 row_half_mirror row_mask:0xf bank_mask:0xf
    v_sub_f32 v8, v8, v6
    v_exp_f32 v8, v8
    v_cmp_gt_u32 vcc, 6, v4
    s_nop 1
    v_cndmask_b32 v8, 0, v8, vcc
    v_mul_f32 v9, v8, v9
    s_nop 1
    v_add_f32_dpp v9, v9, v9 quad_perm:[1,0,3,2] row_mask:0xf bank_mask:0xf
    s_nop 1
    v_add_f32_dpp v9, v9, v9 quad_perm:[2,3,0,1] row_mask:0xf bank_mask:0xf
    s_nop 1
    v_add_f32_dpp v9, v9, v9 row_half_mirror row_mask:0xf bank_mask:0xf
    v_rcp_f32 v9, v9
    s_nop 0
    v_mul_f32 v8, v8, v9
    v_cvt_pk_bf16_f32 v8, v8, v8
    v_lshrrev_b32 v3, 4, v0
    v_mul_u32_u24 v9, 6, v7
    v_sub_u32 v3, v3, v9
    v_lshlrev_b32 v9, 3, v7
    v_add_u32 v5, 0, v3
    v_min_u32 v5, 6, v5
    v_add_u32 v5, v5, v9
    v_lshlrev_b32 v5, 2, v5
    ds_bpermute_b32 v10, v5, v8
    ds_bpermute_b32 v13, v5, v8 offset:64
    v_add_u32 v5, 4, v3
    v_min_u32 v5, 6, v5
    v_add_u32 v5, v5, v9
    v_lshlrev_b32 v5, 2, v5
    ds_bpermute_b32 v11, v5, v8
    ds_bpermute_b32 v14, v5, v8 offset:64
    v_add_u32 v5, 8, v3
    v_min_u32 v5, 6, v5
    v_add_u32 v5, v5, v9
    v_lshlrev_b32 v5, 2, v5
    ds_bpermute_b32 v12, v5, v8
    ds_bpermute_b32 v15, v5, v8 offset:64
    s_waitcnt lgkmcnt(0)
    v_and_b32 v32, v10, v20
    v_and_b32 v33, v10, v21
    v_and_b32 v34, v10, v22
    v_and_b32 v35, v10, v23
    v_and_b32 v36, v11, v20
    v_and_b32 v37, v11, v21
    v_and_b32 v38, v11, v22
    v_and_b32 v39, v11, v23
    v_and_b32 v40, v12, v20
    v_and_b32 v41, v12, v21
    v_and_b32 v42, v12, v22
    v_and_b32 v43, v12, v23
    v_and_b32 v44, v13, v20
    v_and_b32 v45, v13, v21
    v_and_b32 v46, v13, v22
    v_and_b32 v47, v13, v23
    v_and_b32 v48, v14, v20
    v_and_b32 v49, v14, v21
    v_and_b32 v50, v14, v22
    v_and_b32 v51, v14, v23
    v_and_b32 v52, v15, v20
    v_and_b32 v53, v15, v21
    v_and_b32 v54, v15, v22
    v_and_b32 v55, v15, v23
    s_and_b32 s24, s3, 1
    s_lshl_b32 s24, s24, 1
    s_and_b32 s29, s3, 2
    s_lshl_b32 s29, s29, 3
    s_or_b32 s29, s29, s24
    s_and_b32 s24, s26, 13
    s_or_b32 s29, s29, s24
    s_mul_i32 s29, s29, 6144
    s_add_u32 s29, s29, 0x180000
    s_add_u32 s42, s29, 4096
    s_lshr_b32 s24, s74, 3
    s_lshl_b32 s24, s24, 2
    s_add_u32 s24, s24, s3
    s_lshl_b32 s36, s24, 12
    s_add_u32 s36, s36, 0x1de000
    s_and_b32 s37, s74, 7
    s_lshl_b32 s37, s37, 7
    s_add_u32 s37, s37, s36
    s_lshl_b32 s38, s3, 12
    s_andn2_b32 s25, s74, 7
    s_lshl_b32 s25, s25, 4
    s_add_u32 s38, s38, s25
    s_add_u32 s38, s38, 0x1da000
    s_lshl_b32 s39, s24, 5
    s_add_u32 s39, s39, 1024
    s_mov_b32 s30, 0x600000
    s_mov_b32 s31, s30
    s_mov_b32 s40, s30
    s_mov_b32 s41, s30
    s_mov_b32 s33, 0
    s_branch L_P_go
L_P:
    s_mov_b64 s[30:31], s[36:37]
    s_mov_b64 s[40:41], s[38:39]
    s_mov_b32 s33, 447
    s_cmp_lg_u32 s3, 0
    s_cbranch_scc1 L_H_x
    s_lshr_b32 s24, s74, 5
    s_mul_i32 s25, s24, 3
    s_add_u32 s34, s34, s25
    s_lshl_b32 s24, s24, 6
    s_add_u32 s24, s24, s26
    s_lshl_b32 s24, s24, 20
    s_add_u32 s4, s52, s24
    s_addc_u32 s5, s53, 0
    s_mov_b32 s6, 0x100000
    s_mov_b32 s7, 0x20000
    s_add_u32 s8, s4, 0x2000000
    s_addc_u32 s9, s5, 0
    s_mov_b32 s10, s6
    s_mov_b32 s11, 0x20000
    v_lshrrev_b32 v3, 4, v0
    v_mul_u32_u24 v16, 6144, v3
    v_and_b32 v3, 15, v0
    v_lshl_add_u32 v16, v3, 7, v16
    v_lshlrev_b32 v17, 12, v0
    v_mov_b32 v18, 0
    s_mov_b32 s27, 43
    s_mov_b32 s28, 43
    s_mov_b32 s32, 43
    s_mov_b32 s75, 1024
L_H:
    s_sub_u32 s75, s75, 1
    s_cmp_eq_u32 s75, 0
    s_cbranch_scc1 L_H_x
    s_mov_b64 exec, 0xffffff
    buffer_load_dword v18, v17, s[12:15], s35 offen offset:64 sc1
    s_mov_b64 exec, -1
    s_waitcnt vmcnt(0)
    v_max_i32 v19, 0, v18
    s_nop 1
    v_add_u32_dpp v3, v19, v19 row_ror:8 row_mask:0xf bank_mask:0xf
    s_nop 1
    v_add_u32_dpp v3, v3, v3 row_ror:4 row_mask:0xf bank_mask:0xf
    s_nop 1
    v_add_u32_dpp v3, v3, v3 row_ror:2 row_mask:0xf bank_mask:0xf
    s_nop 1
    v_add_u32_dpp v3, v3, v3 row_ror:1 row_mask:0xf bank_mask:0xf
    s_nop 0
    v_readlane_b32 s70, v3, 0
    v_readlane_b32 s24, v3, 16
    s_nop 0
    s_add_u32 s70, s70, s24
    s_add_u32 s24, s34, 0
    s_nop 0
    v_readlane_b32 s24, v19, s24
    s_sub_u32 s25, 43, s27
    s_mul_i32 s25, s25, 17
    s_mul_i32 s64, s24, 24
    s_add_u32 s64, s64, s25
    s_add_u32 s24, s24, 8
    s_cmp_gt_u32 s24, s27
    s_cselect_b32 s64, 0xffff, s64
    s_add_u32 s24, s34, 1
    v_readlane_b32 s24, v19, s24
    s_sub_u32 s25, 43, s28
    s_mul_i32 s25, s25, 17
    s_mul_i32 s65, s24, 24
    s_add_u32 s65, s65, s25
    s_add_u32 s24, s24, 8
    s_cmp_gt_u32 s24, s28
    s_cselect_b32 s65, 0xffff, s65
    s_add_u32 s24, s34, 2
    v_readlane_b32 s24, v19, s24
    s_sub_u32 s25, 43, s32
    s_mul_i32 s25, s25, 17
    s_mul_i32 s66, s24, 24
    s_add_u32 s66, s66, s25
    s_add_u32 s24, s24, 8
    s_cmp_gt_u32 s24, s32
    s_cselect_b32 s66, 0xffff, s66
    s_min_u32 s71, s64, s65
    s_min_u32 s71, s71, s66
    s_cmp_eq_u32 s71, 0xffff
    s_cbranch_scc1 L_H_x
    s_add_u32 s24, s71, 36
    s_cmp_lt_i32 s24, s70
    s_cbranch_scc1 L_H_go
    s_sleep 4
    s_branch L_H
L_H_go:
    s_cmp_lg_u32 s71, s64
    s_cbranch_scc1 L_H_n0
    s_sub_u32 s27, s27, 2
    s_mul_i32 s24, s27, 24576
    s_add_u32 s24, s24, 0
    s_branch L_H_ld
L_H_n0:
    s_cmp_lg_u32 s71, s65
    s_cbranch_scc1 L_H_n1
    s_sub_u32 s28, s28, 2
    s_mul_i32 s24, s28, 24576
    s_add_u32 s24, s24, 2048
    s_branch L_H_ld
L_H_n1:
    s_sub_u32 s32, s32, 2
    s_mul_i32 s24, s32, 24576
    s_add_u32 s24, s24, 4096
L_H_ld:
    buffer_load_dword v5, v16, s[4:7], s24 offen
    buffer_load_dword v5, v16, s[8:11], s24 offen
    s_add_u32 s24, s24, 24576
    buffer_load_dword v5, v16, s[4:7], s24 offen
    buffer_load_dword v5, v16, s[8:11], s24 offen
    s_branch L_H
L_H_x:
    s_barrier
    s_mov_b32 s24, 262144
L_pd18:
    buffer_load_dwordx4 v[56:59], v2, s[12:15], s29 offen offset:0 sc1
    buffer_load_dwordx4 v[60:63], v2, s[12:15], s29 offen offset:1024 sc1
    buffer_load_dwordx4 v[64:67], v2, s[12:15], s29 offen offset:2048 sc1
    buffer_load_dwordx4 v[68:71], v2, s[12:15], s29 offen offset:3072 sc1
    buffer_load_dwordx4 v[72:75], v2, s[12:15], s42 offen offset:0 sc1
    buffer_load_dwordx4 v[76:79], v2, s[12:15], s42 offen offset:1024 sc1
    s_waitcnt vmcnt(0)
    v_max_u32 v3, v56, v57
    v_max3_u32 v3, v3, v58, v59
    v_max3_u32 v3, v3, v60, v61
    v_max3_u32 v3, v3, v62, v63
    v_max3_u32 v3, v3, v64, v65
    v_max3_u32 v3, v3, v66, v67
    v_max3_u32 v3, v3, v68, v69
    v_max3_u32 v3, v3, v70, v71
    v_max3_u32 v3, v3, v72, v73
    v_max3_u32 v3, v3, v74, v75
    v_max3_u32 v3, v3, v76, v77
    v_max3_u32 v3, v3, v78, v79
    v_cmp_eq_u32 vcc, -1, v3
    s_sub_u32 s24, s24, 1
    s_cmp_eq_u32 s24, 0
    s_cbranch_scc1 L_pd18_x
    s_and_b64 exec, exec, vcc
    s_cbranch_scc1 L_pd18
L_pd18_x:
    s_mov_b64 exec, -1
L_P_go:
    v_mfma_f32_16x16x32_bf16 v[12:15], v[56:59], v[32:35], 0
    v_mfma_f32_16x16x32_bf16 v[16:19], v[68:71], v[44:47], 0
    v_mfma_f32_16x16x32_bf16 v[12:15], v[60:63], v[36:39], v[12:15]
    v_mfma_f32_16x16x32_bf16 v[16:19], v[72:75], v[48:51], v[16:19]
    v_mfma_f32_16x16x32_bf16 v[12:15], v[64:67], v[40:43], v[12:15]
    v_mfma_f32_16x16x32_bf16 v[16:19], v[76:79], v[52:55], v[16:19]
    s_barrier
    s_mov_b64 exec, 1
    v_mov_b32 v83, 64
    buffer_atomic_add v83, off, s[12:15], s40 sc0
    s_mov_b64 exec, -1
    s_nop 1
    v_cvt_pk_bf16_f32 v4, v12, v13
    v_cvt_pk_bf16_f32 v5, v14, v15
    ds_write_b64 v24, v[4:5]
    v_cvt_pk_bf16_f32 v6, v16, v17
    v_cvt_pk_bf16_f32 v7, v18, v19
    ds_write_b64 v24, v[6:7] offset:640
    s_waitcnt lgkmcnt(0)
    s_barrier
    ds_read_b128 v[128:131], v25 offset:0
    ds_read_b128 v[132:135], v25 offset:64
    ds_read_b128 v[136:139], v25 offset:128
    ds_read_b128 v[140:143], v25 offset:192
    ds_read_b128 v[144:147], v25 offset:1280
    ds_read_b128 v[148:151], v25 offset:1344
    ds_read_b128 v[152:155], v25 offset:1408
    ds_read_b128 v[156:159], v25 offset:1472
    ds_read_b128 v[160:163], v25 offset:2560
    s_waitcnt lgkmcnt(8)
    v_mfma_f32_16x16x32_bf16 v[12:15], v[128:131], a[128:131], 0
    ds_read_b128 v[164:167], v25 offset:2624
    s_waitcnt lgkmcnt(8)
    v_mfma_f32_16x16x32_bf16 v[12:15], v[132:135], a[132:135], v[12:15]
    ds_read_b128 v[168:171], v25 offset:2688
    s_waitcnt lgkmcnt(8)
    v_mfma_f32_16x16x32_bf16 v[12:15], v[136:139], a[136:139], v[12:15]
    ds_read_b128 v[172:175], v25 offset:2752
    s_waitcnt lgkmcnt(8)
    v_mfma_f32_16x16x32_bf16 v[12:15], v[140:143], a[140:143], v[12:15]
    ds_read_b128 v[176:179], v25 offset:3840
    s_waitcnt lgkmcnt(8)
    v_mfma_f32_16x16x32_bf16 v[12:15], v[144:147], a[144:147], v[12:15]
    ds_read_b128 v[180:183], v25 offset:3904
    s_waitcnt lgkmcnt(8)
    v_mfma_f32_16x16x32_bf16 v[12:15], v[148:151], a[148:151], v[12:15]
    ds_read_b128 v[184:187], v25 offset:3968
    s_waitcnt lgkmcnt(8)
    v_mfma_f32_16x16x32_bf16 v[12:15], v[152:155], a[152:155], v[12:15]
    ds_read_b128 v[188:191], v25 offset:4032
    s_waitcnt lgkmcnt(8)
    v_mfma_f32_16x16x32_bf16 v[12:15], v[156:159], a[156:159], v[12:15]
    s_waitcnt lgkmcnt(7)
    v_mfma_f32_16x16x32_bf16 v[12:15], v[160:163], a[160:163], v[12:15]
    s_waitcnt lgkmcnt(6)
    v_mfma_f32_16x16x32_bf16 v[12:15], v[164:167], a[164:167], v[12:15]
    s_waitcnt lgkmcnt(5)
    v_mfma_f32_16x16x32_bf16 v[12:15], v[168:171], a[168:171], v[12:15]
    s_waitcnt lgkmcnt(4)
    v_mfma_f32_16x16x32_bf16 v[12:15], v[172:175], a[172:175], v[12:15]
    s_waitcnt lgkmcnt(3)
    v_mfma_f32_16x16x32_bf16 v[12:15], v[176:179], a[176:179], v[12:15]
    s_waitcnt lgkmcnt(2)
    v_mfma_f32_16x16x32_bf16 v[12:15], v[180:183], a[180:183], v[12:15]
    s_waitcnt lgkmcnt(1)
    v_mfma_f32_16x16x32_bf16 v[12:15], v[184:187], a[184:187], v[12:15]
    s_waitcnt lgkmcnt(0)
    v_mfma_f32_16x16x32_bf16 v[12:15], v[188:191], a[188:191], v[12:15]
    s_nop 7
    v_cvt_pk_bf16_f32 v4, v12, v13
    v_cvt_pk_bf16_f32 v5, v14, v15
    s_mov_b64 exec, 0xffff
    buffer_store_dwordx2 v[4:5], v26, s[12:15], s31 offen sc1
    s_mov_b64 exec, -1
    v_mov_b32 v16, v4
    v_mov_b32 v17, v5
    v_mov_b32 v18, v4
    v_mov_b32 v19, v5
    v_mov_b32_dpp v16, v4 row_ror:8 row_mask:0xf bank_mask:0xc
    v_mov_b32_dpp v17, v5 row_ror:8 row_mask:0xf bank_mask:0xc
    v_mov_b32_dpp v18, v4 row_ror:8 row_mask:0xf bank_mask:0x3
    v_mov_b32_dpp v19, v5 row_ror:8 row_mask:0xf bank_mask:0x3
    s_waitcnt vmcnt(1)
    v_readfirstlane_b32 s24, v83
    s_nop 0
    s_cmp_eq_u32 s24, s33
    s_cbranch_scc1 L_P_f
    s_waitcnt vmcnt(0)
    v_readfirstlane_b32 s24, v83
    s_nop 0
    s_cmp_lg_u32 s24, s33
    s_cbranch_scc1 L_P_n
L_P_f:
    s_mov_b64 exec, s[44:45]
    s_mov_b32 s24, 262144
L_pd19:
    buffer_load_dwordx4 v[16:19], v2, s[12:15], s30 offen sc1
    s_waitcnt vmcnt(0)
    v_max_u32 v3, v16, v17
    v_max3_u32 v3, v3, v18, v19
    v_cmp_eq_u32 vcc, -1, v3
    s_sub_u32 s24, s24, 1
    s_cmp_eq_u32 s24, 0
    s_cbranch_scc1 L_pd19_x
    s_and_b64 exec, exec, vcc
    s_cbranch_scc1 L_pd19
L_pd19_x:
    s_mov_b64 exec, -1
    v_lshlrev_b32 v56, 16, v16
    v_and_b32 v57, 0xffff0000, v16
    v_lshlrev_b32 v58, 16, v17
    v_and_b32 v59, 0xffff0000, v17
    v_lshlrev_b32 v60, 16, v18
    v_and_b32 v61, 0xffff0000, v18
    v_lshlrev_b32 v62, 16, v19
    v_and_b32 v63, 0xffff0000, v19
    v_permlane32_swap_b32 v56, v58
    v_permlane32_swap_b32 v57, v59
    v_permlane32_swap_b32 v60, v62
    v_permlane32_swap_b32 v61, v63
    v_add_f32 v56, v56, v58
    v_add_f32 v57, v57, v59
    v_add_f32 v60, v60, v62
    v_add_f32 v61, v61, v63
    v_permlane16_swap_b32 v56, v57
    s_nop 0
    v_permlane16_swap_b32 v60, v61
    v_add_f32 v56, v56, v57
    v_add_f32 v60, v60, v61
    s_nop 0
    v_add_f32_dpp v4, v56, v56 row_ror:8 row_mask:0xf bank_mask:0x3
    s_nop 1
    v_add_f32_dpp v4, v60, v60 row_ror:8 row_mask:0xf bank_mask:0xc
    v_cvt_pk_bf16_f32 v4, v4, v4
    buffer_store_short v4, v28, s[20:23], s41 offen
L_P_n:
    s_cmp_lg_u32 s33, 0
    s_cbranch_scc1 L_P_x
    s_barrier
    s_branch L_P
L_P_x:
L_end:
    s_endpgm
L_C:
    s_cmp_lg_u32 s3, 0
    s_cbranch_scc1 L_C_q
    v_lshrrev_b32 v3, 4, v0
    v_and_b32 v4, 3, v0
    v_lshlrev_b32 v5, 6, v3
    v_lshl_add_u32 v5, v4, 4, v5
    v_bfe_u32 v4, v0, 2, 2
    v_lshl_add_u32 v5, v4, 8, v5
    s_lshl_b32 s24, s26, 12
    s_add_u32 s24, s24, 0x140000
    buffer_store_dwordx4 v[8:11], v5, s[12:15], s24 offen sc1
L_C_q:
    s_waitcnt vmcnt(0)
    s_barrier
    s_cmp_lg_u32 s3, 0
    s_cbranch_scc1 L_sig20
    s_mov_b64 exec, 1
    v_mov_b32 v3, 1
    v_mov_b32 v4, 1
    buffer_atomic_add v4, off, s[16:19], 0 offset:128
    buffer_atomic_add v3, off, s[16:19], 0 offset:0 sc0
    s_waitcnt vmcnt(0)
    v_readfirstlane_b32 s24, v3
    s_mov_b64 exec, -1
    s_and_b32 s24, s24, 63
    s_cmp_lg_u32 s24, 63
    s_cbranch_scc1 L_sig20
    v_lshlrev_b32 v4, 7, v0
    v_mov_b32 v3, 1
    s_mov_b32 s24, 0x170000
    buffer_store_dword v3, v4, s[12:15], s24 offen offset:0 sc1
L_sig20:
    s_mov_b32 s8, s56
    s_mov_b32 s9, s57
    s_mov_b32 s10, 0x400000
    s_mov_b32 s11, 0x20000
    s_and_b32 s24, s3, 1
    s_lshl_b32 s24, s24, 1
    s_and_b32 s25, s3, 2
    s_lshl_b32 s25, s25, 3
    s_or_b32 s25, s25, s24
    s_and_b32 s24, s26, 13
    s_or_b32 s25, s25, s24
    s_lshl_b32 s25, s25, 17
    s_lshr_b32 s24, s74, 3
    s_lshl_b32 s24, s24, 7
    s_add_u32 s24, s24, s25
    v_lshrrev_b32 v3, 4, v0
    v_lshlrev_b32 v3, 15, v3
    v_and_b32 v4, 8, v0
    v_lshl_add_u32 v3, v4, 10, v3
    v_and_b32 v4, 0x70, v2
    v_add_u32 v3, v3, v4
    s_mul_i32 m0, s3, 16896
    s_nop 0
    buffer_load_dwordx4 v3, s[8:11], s24 offen nt lds
    s_add_u32 m0, m0, 1056
    s_add_u32 s24, s24, 2048
    buffer_load_dwordx4 v3, s[8:11], s24 offen nt lds
    s_add_u32 m0, m0, 1056
    s_add_u32 s24, s24, 2048
    buffer_load_dwordx4 v3, s[8:11], s24 offen nt lds
    s_add_u32 m0, m0, 1056
    s_add_u32 s24, s24, 2048
    buffer_load_dwordx4 v3, s[8:11], s24 offen nt lds
    s_add_u32 m0, m0, 1056
    s_add_u32 s24, s24, 10240
    buffer_load_dwordx4 v3, s[8:11], s24 offen nt lds
    s_add_u32 m0, m0, 1056
    s_add_u32 s24, s24, 2048
    buffer_load_dwordx4 v3, s[8:11], s24 offen nt lds
    s_add_u32 m0, m0, 1056
    s_add_u32 s24, s24, 2048
    buffer_load_dwordx4 v3, s[8:11], s24 offen nt lds
    s_add_u32 m0, m0, 1056
    s_add_u32 s24, s24, 2048
    buffer_load_dwordx4 v3, s[8:11], s24 offen nt lds
    s_add_u32 m0, m0, 1056
    s_add_u32 s24, s24, -21504
    buffer_load_dwordx4 v3, s[8:11], s24 offen nt lds
    s_add_u32 m0, m0, 1056
    s_add_u32 s24, s24, 2048
    buffer_load_dwordx4 v3, s[8:11], s24 offen nt lds
    s_add_u32 m0, m0, 1056
    s_add_u32 s24, s24, 2048
    buffer_load_dwordx4 v3, s[8:11], s24 offen nt lds
    s_add_u32 m0, m0, 1056
    s_add_u32 s24, s24, 2048
    buffer_load_dwordx4 v3, s[8:11], s24 offen nt lds
    s_add_u32 m0, m0, 1056
    s_add_u32 s24, s24, 10240
    buffer_load_dwordx4 v3, s[8:11], s24 offen nt lds
    s_add_u32 m0, m0, 1056
    s_add_u32 s24, s24, 2048
    buffer_load_dwordx4 v3, s[8:11], s24 offen nt lds
    s_add_u32 m0, m0, 1056
    s_add_u32 s24, s24, 2048
    buffer_load_dwordx4 v3, s[8:11], s24 offen nt lds
    s_add_u32 m0, m0, 1056
    s_add_u32 s24, s24, 2048
    buffer_load_dwordx4 v3, s[8:11], s24 offen nt lds
    s_waitcnt vmcnt(0)
    s_barrier
    v_lshrrev_b32 v3, 2, v0
    v_mul_u32_u24 v3, 1056, v3
    v_and_b32 v4, 3, v0
    v_lshl_add_u32 v3, v4, 3, v3
    s_lshl_b32 s24, s3, 5
    v_add_u32 v3, s24, v3
    ds_read_b64_tr_b16 a[128:129], v3 offset:0
    ds_read_b64_tr_b16 a[130:131], v3 offset:128
    ds_read_b64_tr_b16 a[132:133], v3 offset:256
    ds_read_b64_tr_b16 a[134:135], v3 offset:384
    ds_read_b64_tr_b16 a[136:137], v3 offset:512
    ds_read_b64_tr_b16 a[138:139], v3 offset:640
    ds_read_b64_tr_b16 a[140:141], v3 offset:768
    ds_read_b64_tr_b16 a[142:143], v3 offset:896
    ds_read_b64_tr_b16 a[144:145], v3 offset:16896
    ds_read_b64_tr_b16 a[146:147], v3 offset:17024
    ds_read_b64_tr_b16 a[148:149], v3 offset:17152
    ds_read_b64_tr_b16 a[150:151], v3 offset:17280
    ds_read_b64_tr_b16 a[152:153], v3 offset:17408
    ds_read_b64_tr_b16 a[154:155], v3 offset:17536
    ds_read_b64_tr_b16 a[156:157], v3 offset:17664
    ds_read_b64_tr_b16 a[158:159], v3 offset:17792
    ds_read_b64_tr_b16 a[160:161], v3 offset:33792
    ds_read_b64_tr_b16 a[162:163], v3 offset:33920
    ds_read_b64_tr_b16 a[164:165], v3 offset:34048
    ds_read_b64_tr_b16 a[166:167], v3 offset:34176
    ds_read_b64_tr_b16 a[168:169], v3 offset:34304
    ds_read_b64_tr_b16 a[170:171], v3 offset:34432
    ds_read_b64_tr_b16 a[172:173], v3 offset:34560
    ds_read_b64_tr_b16 a[174:175], v3 offset:34688
    ds_read_b64_tr_b16 a[176:177], v3 offset:50688
    ds_read_b64_tr_b16 a[178:179], v3 offset:50816
    ds_read_b64_tr_b16 a[180:181], v3 offset:50944
    ds_read_b64_tr_b16 a[182:183], v3 offset:51072
    ds_read_b64_tr_b16 a[184:185], v3 offset:51200
    ds_read_b64_tr_b16 a[186:187], v3 offset:51328
    ds_read_b64_tr_b16 a[188:189], v3 offset:51456
    ds_read_b64_tr_b16 a[190:191], v3 offset:51584
    s_and_b32 s70, s72, 3
    s_lshr_b32 s71, s72, 4
    s_bfe_u32 s24, s72, 0x10002
    s_lshl_b32 s24, s24, 1
    s_add_u32 s71, s71, s24
    s_bfe_u32 s75, s72, 0x10003
    s_lshl_b32 s30, s71, 22
    s_add_u32 s4, s38, s30
    s_addc_u32 s5, s39, 0
    s_mov_b32 s6, 0x400000
    s_mov_b32 s7, 0x20000
    s_mul_i32 s32, s3, 65536
    s_lshl_b32 s24, s70, 10
    s_add_u32 s32, s32, s24
    s_mul_i32 s34, s3, 16896
    s_waitcnt lgkmcnt(0)
    s_barrier
    s_mov_b32 m0, s34
    s_nop 0
    buffer_load_dwordx4 v2, s[4:7], s32 offen lds
    s_add_u32 m0, m0, 1056
    s_add_u32 s32, s32, 4096
    buffer_load_dwordx4 v2, s[4:7], s32 offen lds
    s_add_u32 m0, m0, 1056
    s_add_u32 s32, s32, 4096
    buffer_load_dwordx4 v2, s[4:7], s32 offen lds
    s_add_u32 m0, m0, 1056
    s_add_u32 s32, s32, 4096
    buffer_load_dwordx4 v2, s[4:7], s32 offen lds
    s_add_u32 m0, m0, 1056
    s_add_u32 s32, s32, 4096
    buffer_load_dwordx4 v2, s[4:7], s32 offen lds
    s_add_u32 m0, m0, 1056
    s_add_u32 s32, s32, 4096
    buffer_load_dwordx4 v2, s[4:7], s32 offen lds
    s_add_u32 m0, m0, 1056
    s_add_u32 s32, s32, 4096
    buffer_load_dwordx4 v2, s[4:7], s32 offen lds
    s_add_u32 m0, m0, 1056
    s_add_u32 s32, s32, 4096
    buffer_load_dwordx4 v2, s[4:7], s32 offen lds
    s_add_u32 m0, m0, 1056
    s_add_u32 s32, s32, 4096
    buffer_load_dwordx4 v2, s[4:7], s32 offen lds
    s_add_u32 m0, m0, 1056
    s_add_u32 s32, s32, 4096
    buffer_load_dwordx4 v2, s[4:7], s32 offen lds
    s_add_u32 m0, m0, 1056
    s_add_u32 s32, s32, 4096
    buffer_load_dwordx4 v2, s[4:7], s32 offen lds
    s_add_u32 m0, m0, 1056
    s_add_u32 s32, s32, 4096
    buffer_load_dwordx4 v2, s[4:7], s32 offen lds
    s_add_u32 m0, m0, 1056
    s_add_u32 s32, s32, 4096
    buffer_load_dwordx4 v2, s[4:7], s32 offen lds
    s_add_u32 m0, m0, 1056
    s_add_u32 s32, s32, 4096
    buffer_load_dwordx4 v2, s[4:7], s32 offen lds
    s_add_u32 m0, m0, 1056
    s_add_u32 s32, s32, 4096
    buffer_load_dwordx4 v2, s[4:7], s32 offen lds
    s_add_u32 m0, m0, 1056
    s_add_u32 s32, s32, 4096
    buffer_load_dwordx4 v2, s[4:7], s32 offen lds
    s_add_u32 m0, m0, 1056
    s_add_u32 s32, s32, 200704
    s_lshr_b32 s28, s3, 1
    s_and_b32 s29, s3, 1
    v_and_b32 v3, 15, v0
    v_lshrrev_b32 v4, 4, v0
    v_mul_u32_u24 v19, 1056, v3
    v_lshl_add_u32 v19, v4, 4, v19
    v_lshrrev_b32 v5, 2, v0
    v_mul_u32_u24 v20, 1056, v5
    v_and_b32 v5, 3, v0
    v_lshl_add_u32 v20, v5, 3, v20
    s_lshl_b32 s24, s29, 9
    v_add_u32 v20, s24, v20
    v_and_b32 v3, 15, v0
    v_mul_u32_u24 v18, 1056, v3
    v_lshl_add_u32 v18, v4, 4, v18
    v_add_u32 v18, 101376, v18
    s_mul_i32 s24, s28, 33792
    v_add_u32 v19, s24, v19
    v_add_u32 v20, s24, v20
    v_mov_b32 v128, 0
    v_mov_b32 v129, 0
    v_mov_b32 v130, 0
    v_mov_b32 v131, 0
    v_mov_b32 v132, 0
    v_mov_b32 v133, 0
    v_mov_b32 v134, 0
    v_mov_b32 v135, 0
    v_mov_b32 v136, 0
    v_mov_b32 v137, 0
    v_mov_b32 v138, 0
    v_mov_b32 v139, 0
    v_mov_b32 v140, 0
    v_mov_b32 v141, 0
    v_mov_b32 v142, 0
    v_mov_b32 v143, 0
    v_mov_b32 v144, 0
    v_mov_b32 v145, 0
    v_mov_b32 v146, 0
    v_mov_b32 v147, 0
    v_mov_b32 v148, 0
    v_mov_b32 v149, 0
    v_mov_b32 v150, 0
    v_mov_b32 v151, 0
    v_mov_b32 v152, 0
    v_mov_b32 v153, 0
    v_mov_b32 v154, 0
    v_mov_b32 v155, 0
    v_mov_b32 v156, 0
    v_mov_b32 v157, 0
    v_mov_b32 v158, 0
    v_mov_b32 v159, 0
    v_mov_b32 v160, 0
    v_mov_b32 v161, 0
    v_mov_b32 v162, 0
    v_mov_b32 v163, 0
    v_mov_b32 v164, 0
    v_mov_b32 v165, 0
    v_mov_b32 v166, 0
    v_mov_b32 v167, 0
    v_mov_b32 v168, 0
    v_mov_b32 v169, 0
    v_mov_b32 v170, 0
    v_mov_b32 v171, 0
    v_mov_b32 v172, 0
    v_mov_b32 v173, 0
    v_mov_b32 v174, 0
    v_mov_b32 v175, 0
    v_mov_b32 v176, 0
    v_mov_b32 v177, 0
    v_mov_b32 v178, 0
    v_mov_b32 v179, 0
    v_mov_b32 v180, 0
    v_mov_b32 v181, 0
    v_mov_b32 v182, 0
    v_mov_b32 v183, 0
    v_mov_b32 v184, 0
    v_mov_b32 v185, 0
    v_mov_b32 v186, 0
    v_mov_b32 v187, 0
    v_mov_b32 v188, 0
    v_mov_b32 v189, 0
    v_mov_b32 v190, 0
    v_mov_b32 v191, 0
    v_mov_b32 v22, 0xff800000
    v_mov_b32 v23, 0
    s_cmp_lg_u32 s3, 0
    s_cbranch_scc1 L_awx21
    s_mov_b32 s24, 262144
    s_mov_b64 exec, 1
L_aw22:
    buffer_load_dword v1, off, s[12:15], s73 offset:0 sc1
    s_waitcnt vmcnt(0)
    v_readfirstlane_b32 s25, v1
    s_nop 0
    s_cmp_eq_u32 s25, 1
    s_cbranch_scc1 L_awx21
    s_sleep 4
    s_sub_u32 s24, s24, 1
    s_cmp_lg_u32 s24, 0
    s_cbranch_scc1 L_aw22
L_awx21:
    s_mov_b64 exec, -1
    s_barrier
    s_lshl_b32 s24, s71, 17
    s_mul_i32 s25, s3, 16384
    s_add_u32 s24, s24, s25
    s_add_u32 s24, s24, 0x0
    s_mul_i32 s25, s75, 65536
    s_add_u32 s24, s24, s25
    buffer_load_dwordx4 v[32:35], v2, s[12:15], s24 offen sc1
    s_add_u32 s24, s24, 4096
    buffer_load_dwordx4 v[36:39], v2, s[12:15], s24 offen sc1
    s_add_u32 s24, s24, 4096
    buffer_load_dwordx4 v[40:43], v2, s[12:15], s24 offen sc1
    s_add_u32 s24, s24, 4096
    buffer_load_dwordx4 v[44:47], v2, s[12:15], s24 offen sc1
    s_add_u32 s24, s24, 4096
    s_mul_i32 s24, s3, 4224
    s_add_u32 s24, s24, 101376
    v_add_u32 v3, s24, v2
    s_waitcnt vmcnt(3)
    ds_write_b128 v3, v[32:35] offset:0
    s_waitcnt vmcnt(2)
    ds_write_b128 v3, v[36:39] offset:1056
    s_waitcnt vmcnt(1)
    ds_write_b128 v3, v[40:43] offset:2112
    s_waitcnt vmcnt(0)
    ds_write_b128 v3, v[44:47] offset:3168
    s_waitcnt lgkmcnt(0)
    s_barrier
    ds_read_b128 a[0:3], v18 offset:0
    ds_read_b128 a[4:7], v18 offset:64
    ds_read_b128 a[8:11], v18 offset:128
    ds_read_b128 a[12:15], v18 offset:192
    ds_read_b128 a[16:19], v18 offset:256
    ds_read_b128 a[20:23], v18 offset:320
    ds_read_b128 a[24:27], v18 offset:384
    ds_read_b128 a[28:31], v18 offset:448
    ds_read_b128 a[32:35], v18 offset:512
    ds_read_b128 a[36:39], v18 offset:576
    ds_read_b128 a[40:43], v18 offset:640
    ds_read_b128 a[44:47], v18 offset:704
    ds_read_b128 a[48:51], v18 offset:768
    ds_read_b128 a[52:55], v18 offset:832
    ds_read_b128 a[56:59], v18 offset:896
    ds_read_b128 a[60:63], v18 offset:960
    s_cmp_lg_u32 s3, 0
    s_cbranch_scc1 L_xi23
    s_and_b32 s24, s74, 7
    s_lshl_b32 s24, s24, 5
    s_lshr_b32 s25, s74, 3
    s_add_u32 s24, s24, s25
    s_lshl_b32 s24, s24, 2
    s_add_u32 s24, s24, 0x1d8000
    s_getreg_b32 s25, hwreg(HW_REG_XCC_ID, 0, 4)
    s_mov_b64 exec, 1
    v_mov_b32 v3, s25
    buffer_store_dword v3, off, s[12:15], s24 sc1
    s_mov_b64 exec, -1
L_xi23:
    s_mov_b32 s27, 0
    s_mov_b32 s33, 67584
    s_mov_b32 s35, 0
    s_waitcnt lgkmcnt(0)
L_CT:
    s_waitcnt vmcnt(0)
    s_barrier
    v_add_u32 v24, s35, v19
    v_add_u32 v25, s35, v20
    ds_read_b128 v[32:35], v24 offset:0
    ds_read_b128 v[36:39], v24 offset:16896
    ds_read_b128 v[40:43], v24 offset:64
    ds_read_b128 v[44:47], v24 offset:16960
    ds_read_b128 v[48:51], v24 offset:128
    ds_read_b128 v[52:55], v24 offset:17024
    ds_read_b128 v[56:59], v24 offset:192
    s_add_u32 m0, s33, s34
    s_mov_b32 s33, s35
    s_add_u32 s35, s35, 67584
    s_cmp_eq_u32 s35, 135168
    s_cselect_b32 s35, 0, s35
    s_waitcnt lgkmcnt(6)
    v_mfma_f32_16x16x32_bf16 v[64:67], v[32:35], a[0:3], 0
    ds_read_b128 v[60:63], v24 offset:17088
    buffer_load_dwordx4 v2, s[4:7], s32 offen lds
    s_add_u32 m0, m0, 1056
    s_add_u32 s32, s32, 4096
    s_waitcnt lgkmcnt(6)
    v_mfma_f32_16x16x32_bf16 v[68:71], v[36:39], a[0:3], 0
    ds_read_b128 v[32:35], v24 offset:256
    s_waitcnt lgkmcnt(6)
    v_mfma_f32_16x16x32_bf16 v[64:67], v[40:43], a[4:7], v[64:67]
    ds_read_b128 v[36:39], v24 offset:17152
    s_waitcnt lgkmcnt(6)
    v_mfma_f32_16x16x32_bf16 v[68:71], v[44:47], a[4:7], v[68:71]
    ds_read_b128 v[40:43], v24 offset:320
    s_waitcnt lgkmcnt(6)
    v_mfma_f32_16x16x32_bf16 v[64:67], v[48:51], a[8:11], v[64:67]
    ds_read_b128 v[44:47], v24 offset:17216
    buffer_load_dwordx4 v2, s[4:7], s32 offen lds
    s_add_u32 m0, m0, 1056
    s_add_u32 s32, s32, 4096
    s_waitcnt lgkmcnt(6)
    v_mfma_f32_16x16x32_bf16 v[68:71], v[52:55], a[8:11], v[68:71]
    ds_read_b128 v[48:51], v24 offset:384
    s_waitcnt lgkmcnt(6)
    v_mfma_f32_16x16x32_bf16 v[64:67], v[56:59], a[12:15], v[64:67]
    ds_read_b128 v[52:55], v24 offset:17280
    s_waitcnt lgkmcnt(6)
    v_mfma_f32_16x16x32_bf16 v[68:71], v[60:63], a[12:15], v[68:71]
    ds_read_b128 v[56:59], v24 offset:448
    s_waitcnt lgkmcnt(6)
    v_mfma_f32_16x16x32_bf16 v[64:67], v[32:35], a[16:19], v[64:67]
    ds_read_b128 v[60:63], v24 offset:17344
    buffer_load_dwordx4 v2, s[4:7], s32 offen lds
    s_add_u32 m0, m0, 1056
    s_add_u32 s32, s32, 4096
    s_waitcnt lgkmcnt(6)
    v_mfma_f32_16x16x32_bf16 v[68:71], v[36:39], a[16:19], v[68:71]
    ds_read_b128 v[32:35], v24 offset:512
    s_waitcnt lgkmcnt(6)
    v_mfma_f32_16x16x32_bf16 v[64:67], v[40:43], a[20:23], v[64:67]
    ds_read_b128 v[36:39], v24 offset:17408
    s_waitcnt lgkmcnt(6)
    v_mfma_f32_16x16x32_bf16 v[68:71], v[44:47], a[20:23], v[68:71]
    ds_read_b128 v[40:43], v24 offset:576
    s_waitcnt lgkmcnt(6)
    v_mfma_f32_16x16x32_bf16 v[64:67], v[48:51], a[24:27], v[64:67]
    ds_read_b128 v[44:47], v24 offset:17472
    buffer_load_dwordx4 v2, s[4:7], s32 offen lds
    s_add_u32 m0, m0, 1056
    s_add_u32 s32, s32, 4096
    s_waitcnt lgkmcnt(6)
    v_mfma_f32_16x16x32_bf16 v[68:71], v[52:55], a[24:27], v[68:71]
    ds_read_b128 v[48:51], v24 offset:640
    s_waitcnt lgkmcnt(6)
    v_mfma_f32_16x16x32_bf16 v[64:67], v[56:59], a[28:31], v[64:67]
    ds_read_b128 v[52:55], v24 offset:17536
    s_waitcnt lgkmcnt(6)
    v_mfma_f32_16x16x32_bf16 v[68:71], v[60:63], a[28:31], v[68:71]
    ds_read_b128 v[56:59], v24 offset:704
    s_waitcnt lgkmcnt(6)
    v_mfma_f32_16x16x32_bf16 v[64:67], v[32:35], a[32:35], v[64:67]
    ds_read_b128 v[60:63], v24 offset:17600
    buffer_load_dwordx4 v2, s[4:7], s32 offen lds
    s_add_u32 m0, m0, 1056
    s_add_u32 s32, s32, 4096
    s_waitcnt lgkmcnt(6)
    v_mfma_f32_16x16x32_bf16 v[68:71], v[36:39], a[32:35], v[68:71]
    ds_read_b128 v[32:35], v24 offset:768
    s_waitcnt lgkmcnt(6)
    v_mfma_f32_16x16x32_bf16 v[64:67], v[40:43], a[36:39], v[64:67]
    ds_read_b128 v[36:39], v24 offset:17664
    s_waitcnt lgkmcnt(6)
    v_mfma_f32_16x16x32_bf16 v[68:71], v[44:47], a[36:39], v[68:71]
    ds_read_b128 v[40:43], v24 offset:832
    s_waitcnt lgkmcnt(6)
    v_mfma_f32_16x16x32_bf16 v[64:67], v[48:51], a[40:43], v[64:67]
    ds_read_b128 v[44:47], v24 offset:17728
    buffer_load_dwordx4 v2, s[4:7], s32 offen lds
    s_add_u32 m0, m0, 1056
    s_add_u32 s32, s32, 4096
    s_waitcnt lgkmcnt(6)
    v_mfma_f32_16x16x32_bf16 v[68:71], v[52:55], a[40:43], v[68:71]
    ds_read_b128 v[48:51], v24 offset:896
    s_waitcnt lgkmcnt(6)
    v_mfma_f32_16x16x32_bf16 v[64:67], v[56:59], a[44:47], v[64:67]
    ds_read_b128 v[52:55], v24 offset:17792
    s_waitcnt lgkmcnt(6)
    v_mfma_f32_16x16x32_bf16 v[68:71], v[60:63], a[44:47], v[68:71]
    ds_read_b128 v[56:59], v24 offset:960
    s_waitcnt lgkmcnt(6)
    v_mfma_f32_16x16x32_bf16 v[64:67], v[32:35], a[48:51], v[64:67]
    ds_read_b128 v[60:63], v24 offset:17856
    buffer_load_dwordx4 v2, s[4:7], s32 offen lds
    s_add_u32 m0, m0, 1056
    s_add_u32 s32, s32, 4096
    s_waitcnt lgkmcnt(6)
    v_mfma_f32_16x16x32_bf16 v[68:71], v[36:39], a[48:51], v[68:71]
    ds_read_b64_tr_b16 v[192:193], v25 offset:0
    s_waitcnt lgkmcnt(6)
    v_mfma_f32_16x16x32_bf16 v[64:67], v[40:43], a[52:55], v[64:67]
    ds_read_b64_tr_b16 v[194:195], v25 offset:16896
    s_waitcnt lgkmcnt(6)
    v_mfma_f32_16x16x32_bf16 v[68:71], v[44:47], a[52:55], v[68:71]
    ds_read_b64_tr_b16 v[196:197], v25 offset:32
    s_waitcnt lgkmcnt(6)
    v_mfma_f32_16x16x32_bf16 v[64:67], v[48:51], a[56:59], v[64:67]
    ds_read_b64_tr_b16 v[198:199], v25 offset:16928
    buffer_load_dwordx4 v2, s[4:7], s32 offen lds
    s_add_u32 m0, m0, 1056
    s_add_u32 s32, s32, 4096
    s_waitcnt lgkmcnt(6)
    v_mfma_f32_16x16x32_bf16 v[68:71], v[52:55], a[56:59], v[68:71]
    ds_read_b64_tr_b16 v[200:201], v25 offset:64
    s_waitcnt lgkmcnt(6)
    v_mfma_f32_16x16x32_bf16 v[64:67], v[56:59], a[60:63], v[64:67]
    ds_read_b64_tr_b16 v[202:203], v25 offset:16960
    s_waitcnt lgkmcnt(6)
    v_mfma_f32_16x16x32_bf16 v[68:71], v[60:63], a[60:63], v[68:71]
    ds_read_b64_tr_b16 v[204:205], v25 offset:96
    ds_read_b64_tr_b16 v[206:207], v25 offset:16992
    ds_read_b64_tr_b16 v[208:209], v25 offset:128
    ds_read_b64_tr_b16 v[210:211], v25 offset:17024
    ds_read_b64_tr_b16 v[212:213], v25 offset:160
    ds_read_b64_tr_b16 v[214:215], v25 offset:17056
    ds_read_b64_tr_b16 v[216:217], v25 offset:192
    ds_read_b64_tr_b16 v[218:219], v25 offset:17088
    v_max3_f32 v3, v64, v65, v22
    buffer_load_dwordx4 v2, s[4:7], s32 offen lds
    s_add_u32 m0, m0, 1056
    s_add_u32 s32, s32, 4096
    v_max3_f32 v3, v3, v66, v67
    v_max3_f32 v3, v3, v68, v69
    buffer_load_dwordx4 v2, s[4:7], s32 offen lds
    s_add_u32 m0, m0, 1056
    s_add_u32 s32, s32, 4096
    v_max3_f32 v3, v3, v70, v71
    v_mov_b32 v4, v3
    ds_read_b64_tr_b16 v[220:221], v25 offset:224
    buffer_load_dwordx4 v2, s[4:7], s32 offen lds
    s_add_u32 m0, m0, 1056
    s_add_u32 s32, s32, 4096
    v_permlane32_swap_b32 v3, v4
    ds_read_b64_tr_b16 v[222:223], v25 offset:17120
    v_max_f32 v3, v3, v4
    ds_read_b64_tr_b16 v[224:225], v25 offset:256
    buffer_load_dwordx4 v2, s[4:7], s32 offen lds
    s_add_u32 m0, m0, 1056
    s_add_u32 s32, s32, 4096
    v_mov_b32 v4, v3
    ds_read_b64_tr_b16 v[226:227], v25 offset:17152
    s_nop 0
    v_permlane16_swap_b32 v3, v4
    ds_read_b64_tr_b16 v[228:229], v25 offset:288
    buffer_load_dwordx4 v2, s[4:7], s32 offen lds
    s_add_u32 m0, m0, 1056
    s_add_u32 s32, s32, 4096
    v_max_f32 v3, v3, v4
    ds_read_b64_tr_b16 v[230:231], v25 offset:17184
    v_sub_f32 v4, v22, v3
    ds_read_b64_tr_b16 v[232:233], v25 offset:320
    buffer_load_dwordx4 v2, s[4:7], s32 offen lds
    s_add_u32 m0, m0, 1056
    s_add_u32 s32, s32, 4096
    v_exp_f32 v4, v4
    ds_read_b64_tr_b16 v[234:235], v25 offset:17216
    v_mov_b32 v22, v3
    ds_read_b64_tr_b16 v[236:237], v25 offset:352
    buffer_load_dwordx4 v2, s[4:7], s32 offen lds
    s_add_u32 m0, m0, 1056
    s_add_u32 s32, s32, 4096
    v_sub_f32 v64, v64, v3
    ds_read_b64_tr_b16 v[238:239], v25 offset:17248
    v_sub_f32 v65, v65, v3
    ds_read_b64_tr_b16 v[240:241], v25 offset:384
    buffer_load_dwordx4 v2, s[4:7], s32 offen lds
    s_add_u32 m0, m0, 1056
    s_add_u32 s32, s32, 200704
    v_sub_f32 v66, v66, v3
    ds_read_b64_tr_b16 v[242:243], v25 offset:17280
    v_sub_f32 v67, v67, v3
    ds_read_b64_tr_b16 v[244:245], v25 offset:416
    v_sub_f32 v68, v68, v3
    ds_read_b64_tr_b16 v[246:247], v25 offset:17312
    v_sub_f32 v69, v69, v3
    ds_read_b64_tr_b16 v[248:249], v25 offset:448
    v_sub_f32 v70, v70, v3
    ds_read_b64_tr_b16 v[250:251], v25 offset:17344
    v_sub_f32 v71, v71, v3
    ds_read_b64_tr_b16 v[252:253], v25 offset:480
    v_exp_f32 v64, v64
    ds_read_b64_tr_b16 v[254:255], v25 offset:17376
    v_exp_f32 v65, v65
    v_exp_f32 v66, v66
    v_exp_f32 v67, v67
    v_exp_f32 v68, v68
    v_exp_f32 v69, v69
    v_exp_f32 v70, v70
    v_exp_f32 v71, v71
    v_cvt_pk_bf16_f32 v72, v64, v65
    v_cvt_pk_bf16_f32 v73, v66, v67
    v_cvt_pk_bf16_f32 v74, v68, v69
    v_cvt_pk_bf16_f32 v75, v70, v71
    v_mul_f32 v128, v128, v4
    v_mul_f32 v129, v129, v4
    v_mul_f32 v130, v130, v4
    v_mul_f32 v131, v131, v4
    v_mul_f32 v132, v132, v4
    v_mul_f32 v133, v133, v4
    v_mul_f32 v134, v134, v4
    v_mul_f32 v135, v135, v4
    s_waitcnt lgkmcnt(0)
    v_mfma_f32_16x16x32_bf16 v[128:131], v[192:195], v[72:75], v[128:131]
    v_mul_f32 v136, v136, v4
    v_mul_f32 v137, v137, v4
    v_mul_f32 v138, v138, v4
    v_mul_f32 v139, v139, v4
    v_mfma_f32_16x16x32_bf16 v[132:135], v[196:199], v[72:75], v[132:135]
    v_mul_f32 v140, v140, v4
    v_mul_f32 v141, v141, v4
    v_mul_f32 v142, v142, v4
    v_mul_f32 v143, v143, v4
    v_mfma_f32_16x16x32_bf16 v[136:139], v[200:203], v[72:75], v[136:139]
    v_mul_f32 v144, v144, v4
    v_mul_f32 v145, v145, v4
    v_mul_f32 v146, v146, v4
    v_mul_f32 v147, v147, v4
    v_mfma_f32_16x16x32_bf16 v[140:143], v[204:207], v[72:75], v[140:143]
    v_mul_f32 v148, v148, v4
    v_mul_f32 v149, v149, v4
    v_mul_f32 v150, v150, v4
    v_mul_f32 v151, v151, v4
    v_mfma_f32_16x16x32_bf16 v[144:147], v[208:211], v[72:75], v[144:147]
    v_mul_f32 v152, v152, v4
    v_mul_f32 v153, v153, v4
    v_mul_f32 v154, v154, v4
    v_mul_f32 v155, v155, v4
    v_mfma_f32_16x16x32_bf16 v[148:151], v[212:215], v[72:75], v[148:151]
    v_mul_f32 v156, v156, v4
    v_mul_f32 v157, v157, v4
    v_mul_f32 v158, v158, v4
    v_mul_f32 v159, v159, v4
    v_mfma_f32_16x16x32_bf16 v[152:155], v[216:219], v[72:75], v[152:155]
    v_mul_f32 v160, v160, v4
    v_mul_f32 v161, v161, v4
    v_mul_f32 v162, v162, v4
    v_mul_f32 v163, v163, v4
    v_mfma_f32_16x16x32_bf16 v[156:159], v[220:223], v[72:75], v[156:159]
    v_mul_f32 v164, v164, v4
    v_mul_f32 v165, v165, v4
    v_mul_f32 v166, v166, v4
    v_mul_f32 v167, v167, v4
    v_mfma_f32_16x16x32_bf16 v[160:163], v[224:227], v[72:75], v[160:163]
    v_mul_f32 v168, v168, v4
    v_mul_f32 v169, v169, v4
    v_mul_f32 v170, v170, v4
    v_mul_f32 v171, v171, v4
    v_mfma_f32_16x16x32_bf16 v[164:167], v[228:231], v[72:75], v[164:167]
    v_mul_f32 v172, v172, v4
    v_mul_f32 v173, v173, v4
    v_mul_f32 v174, v174, v4
    v_mul_f32 v175, v175, v4
    v_mfma_f32_16x16x32_bf16 v[168:171], v[232:235], v[72:75], v[168:171]
    v_mul_f32 v176, v176, v4
    v_mul_f32 v177, v177, v4
    v_mul_f32 v178, v178, v4
    v_mul_f32 v179, v179, v4
    v_mfma_f32_16x16x32_bf16 v[172:175], v[236:239], v[72:75], v[172:175]
    v_mul_f32 v180, v180, v4
    v_mul_f32 v181, v181, v4
    v_mul_f32 v182, v182, v4
    v_mul_f32 v183, v183, v4
    v_mfma_f32_16x16x32_bf16 v[176:179], v[240:243], v[72:75], v[176:179]
    v_mul_f32 v184, v184, v4
    v_mul_f32 v185, v185, v4
    v_mul_f32 v186, v186, v4
    v_mul_f32 v187, v187, v4
    v_mfma_f32_16x16x32_bf16 v[180:183], v[244:247], v[72:75], v[180:183]
    v_mul_f32 v188, v188, v4
    v_mul_f32 v189, v189, v4
    v_mul_f32 v190, v190, v4
    v_mul_f32 v191, v191, v4
    v_mfma_f32_16x16x32_bf16 v[184:187], v[248:251], v[72:75], v[184:187]
    s_nop 0
    v_mfma_f32_16x16x32_bf16 v[188:191], v[252:255], v[72:75], v[188:191]
    v_fma_f32 v23, v23, v4, v64
    v_add_f32 v23, v23, v65
    v_add_f32 v23, v23, v66
    v_add_f32 v23, v23, v67
    v_add_f32 v23, v23, v68
    v_add_f32 v23, v23, v69
    v_add_f32 v23, v23, v70
    v_add_f32 v23, v23, v71
    s_add_u32 s27, s27, 1
    s_cmp_lt_u32 s27, 16
    s_cbranch_scc1 L_CT
    s_waitcnt vmcnt(0)
    s_barrier
    v_mov_b32 v4, v23
    s_nop 1
    v_permlane32_swap_b32 v23, v4
    v_add_f32 v23, v23, v4
    v_mov_b32 v4, v23
    s_nop 1
    v_permlane16_swap_b32 v23, v4
    v_add_f32 v23, v23, v4
    s_lshl_b32 s24, s3, 9
    v_lshl_add_u32 v3, v0, 3, s24
    ds_write_b64 v3, v[22:23] offset:0
    v_xor_b32 v3, 0x400, v3
    s_waitcnt lgkmcnt(0)
    s_barrier
    ds_read_b64 v[6:7], v3 offset:0
    s_waitcnt lgkmcnt(0)
    v_max_f32 v3, v22, v6
    v_sub_f32 v4, v22, v3
    v_sub_f32 v6, v6, v3
    v_exp_f32 v4, v4
    v_exp_f32 v6, v6
    v_mov_b32 v22, v3
    v_mul_f32 v23, v23, v4
    v_fmac_f32 v23, v7, v6
    v_and_b32 v3, 15, v0
    v_lshlrev_b32 v5, 3, v3
    s_lshl_b32 s24, s71, 2
    s_add_u32 s31, s24, s70
    s_lshl_b32 s24, s31, 8
    s_mul_i32 s25, s75, 128
    s_add_u32 s24, s24, s25
    s_add_u32 s24, s24, 0x120000
    s_cmp_lg_u32 s3, 0
    s_cbranch_scc1 L_C_ml
    s_mov_b64 exec, 0xffff
    buffer_store_dwordx2 v[22:23], v5, s[12:15], s24 offen sc1
    s_mov_b64 exec, -1
L_C_ml:
    v_pk_mul_f32 v[128:129], v[128:129], v[4:5] op_sel_hi:[1,0]
    v_pk_mul_f32 v[130:131], v[130:131], v[4:5] op_sel_hi:[1,0]
    v_pk_mul_f32 v[132:133], v[132:133], v[4:5] op_sel_hi:[1,0]
    v_pk_mul_f32 v[134:135], v[134:135], v[4:5] op_sel_hi:[1,0]
    v_pk_mul_f32 v[136:137], v[136:137], v[4:5] op_sel_hi:[1,0]
    v_pk_mul_f32 v[138:139], v[138:139], v[4:5] op_sel_hi:[1,0]
    v_pk_mul_f32 v[140:141], v[140:141], v[4:5] op_sel_hi:[1,0]
    v_pk_mul_f32 v[142:143], v[142:143], v[4:5] op_sel_hi:[1,0]
    v_pk_mul_f32 v[144:145], v[144:145], v[4:5] op_sel_hi:[1,0]
    v_pk_mul_f32 v[146:147], v[146:147], v[4:5] op_sel_hi:[1,0]
    v_pk_mul_f32 v[148:149], v[148:149], v[4:5] op_sel_hi:[1,0]
    v_pk_mul_f32 v[150:151], v[150:151], v[4:5] op_sel_hi:[1,0]
    v_pk_mul_f32 v[152:153], v[152:153], v[4:5] op_sel_hi:[1,0]
    v_pk_mul_f32 v[154:155], v[154:155], v[4:5] op_sel_hi:[1,0]
    v_pk_mul_f32 v[156:157], v[156:157], v[4:5] op_sel_hi:[1,0]
    v_pk_mul_f32 v[158:159], v[158:159], v[4:5] op_sel_hi:[1,0]
    v_pk_mul_f32 v[160:161], v[160:161], v[4:5] op_sel_hi:[1,0]
    v_pk_mul_f32 v[162:163], v[162:163], v[4:5] op_sel_hi:[1,0]
    v_pk_mul_f32 v[164:165], v[164:165], v[4:5] op_sel_hi:[1,0]
    v_pk_mul_f32 v[166:167], v[166:167], v[4:5] op_sel_hi:[1,0]
    v_pk_mul_f32 v[168:169], v[168:169], v[4:5] op_sel_hi:[1,0]
    v_pk_mul_f32 v[170:171], v[170:171], v[4:5] op_sel_hi:[1,0]
    v_pk_mul_f32 v[172:173], v[172:173], v[4:5] op_sel_hi:[1,0]
    v_pk_mul_f32 v[174:175], v[174:175], v[4:5] op_sel_hi:[1,0]
    v_pk_mul_f32 v[176:177], v[176:177], v[4:5] op_sel_hi:[1,0]
    v_pk_mul_f32 v[178:179], v[178:179], v[4:5] op_sel_hi:[1,0]
    v_pk_mul_f32 v[180:181], v[180:181], v[4:5] op_sel_hi:[1,0]
    v_pk_mul_f32 v[182:183], v[182:183], v[4:5] op_sel_hi:[1,0]
    v_pk_mul_f32 v[184:185], v[184:185], v[4:5] op_sel_hi:[1,0]
    v_pk_mul_f32 v[186:187], v[186:187], v[4:5] op_sel_hi:[1,0]
    v_pk_mul_f32 v[188:189], v[188:189], v[4:5] op_sel_hi:[1,0]
    v_pk_mul_f32 v[190:191], v[190:191], v[4:5] op_sel_hi:[1,0]
    s_lshl_b32 s24, s3, 13
    s_add_u32 s24, s24, 4096
    v_add_u32 v6, s24, v2
    s_xor_b32 s24, s3, 2
    s_lshl_b32 s24, s24, 13
    s_add_u32 s24, s24, 4096
    v_add_u32 v7, s24, v2
    s_cmp_lg_u32 s28, 0
    s_cbranch_scc1 L_C_x1
    ds_write_b128 v6, v[160:163] offset:0
    ds_write_b128 v6, v[164:167] offset:1024
    ds_write_b128 v6, v[168:171] offset:2048
    ds_write_b128 v6, v[172:175] offset:3072
    ds_write_b128 v6, v[176:179] offset:4096
    ds_write_b128 v6, v[180:183] offset:5120
    ds_write_b128 v6, v[184:187] offset:6144
    ds_write_b128 v6, v[188:191] offset:7168
    s_branch L_C_x2
L_C_x1:
    ds_write_b128 v6, v[128:131] offset:0
    ds_write_b128 v6, v[132:135] offset:1024
    ds_write_b128 v6, v[136:139] offset:2048
    ds_write_b128 v6, v[140:143] offset:3072
    ds_write_b128 v6, v[144:147] offset:4096
    ds_write_b128 v6, v[148:151] offset:5120
    ds_write_b128 v6, v[152:155] offset:6144
    ds_write_b128 v6, v[156:159] offset:7168
    s_waitcnt lgkmcnt(0)
    v_mov_b32 v128, v160
    v_mov_b32 v129, v161
    v_mov_b32 v130, v162
    v_mov_b32 v131, v163
    v_mov_b32 v132, v164
    v_mov_b32 v133, v165
    v_mov_b32 v134, v166
    v_mov_b32 v135, v167
    v_mov_b32 v136, v168
    v_mov_b32 v137, v169
    v_mov_b32 v138, v170
    v_mov_b32 v139, v171
    v_mov_b32 v140, v172
    v_mov_b32 v141, v173
    v_mov_b32 v142, v174
    v_mov_b32 v143, v175
    v_mov_b32 v144, v176
    v_mov_b32 v145, v177
    v_mov_b32 v146, v178
    v_mov_b32 v147, v179
    v_mov_b32 v148, v180
    v_mov_b32 v149, v181
    v_mov_b32 v150, v182
    v_mov_b32 v151, v183
    v_mov_b32 v152, v184
    v_mov_b32 v153, v185
    v_mov_b32 v154, v186
    v_mov_b32 v155, v187
    v_mov_b32 v156, v188
    v_mov_b32 v157, v189
    v_mov_b32 v158, v190
    v_mov_b32 v159, v191
L_C_x2:
    s_waitcnt lgkmcnt(0)
    s_barrier
    ds_read_b128 v[192:195], v7 offset:0
    ds_read_b128 v[196:199], v7 offset:1024
    ds_read_b128 v[200:203], v7 offset:2048
    ds_read_b128 v[204:207], v7 offset:3072
    ds_read_b128 v[208:211], v7 offset:4096
    ds_read_b128 v[212:215], v7 offset:5120
    ds_read_b128 v[216:219], v7 offset:6144
    ds_read_b128 v[220:223], v7 offset:7168
    v_lshrrev_b32 v4, 4, v0
    v_mul_u32_u24 v3, 272, v3
    v_lshl_add_u32 v3, v4, 3, v3
    s_mul_i32 s24, s3, 4352
    s_add_u32 s24, s24, 40960
    v_add_u32 v3, s24, v3
    s_waitcnt lgkmcnt(7)
    v_add_f32 v128, v128, v192
    v_add_f32 v129, v129, v193
    v_add_f32 v130, v130, v194
    v_add_f32 v131, v131, v195
    v_cvt_pk_bf16_f32 v32, v128, v129
    v_cvt_pk_bf16_f32 v33, v130, v131
    ds_write_b64 v3, v[32:33] offset:0
    s_waitcnt lgkmcnt(7)
    v_add_f32 v132, v132, v196
    v_add_f32 v133, v133, v197
    v_add_f32 v134, v134, v198
    v_add_f32 v135, v135, v199
    v_cvt_pk_bf16_f32 v34, v132, v133
    v_cvt_pk_bf16_f32 v35, v134, v135
    ds_write_b64 v3, v[34:35] offset:32
    s_waitcnt lgkmcnt(7)
    v_add_f32 v136, v136, v200
    v_add_f32 v137, v137, v201
    v_add_f32 v138, v138, v202
    v_add_f32 v139, v139, v203
    v_cvt_pk_bf16_f32 v36, v136, v137
    v_cvt_pk_bf16_f32 v37, v138, v139
    ds_write_b64 v3, v[36:37] offset:64
    s_waitcnt lgkmcnt(7)
    v_add_f32 v140, v140, v204
    v_add_f32 v141, v141, v205
    v_add_f32 v142, v142, v206
    v_add_f32 v143, v143, v207
    v_cvt_pk_bf16_f32 v38, v140, v141
    v_cvt_pk_bf16_f32 v39, v142, v143
    ds_write_b64 v3, v[38:39] offset:96
    s_waitcnt lgkmcnt(7)
    v_add_f32 v144, v144, v208
    v_add_f32 v145, v145, v209
    v_add_f32 v146, v146, v210
    v_add_f32 v147, v147, v211
    v_cvt_pk_bf16_f32 v40, v144, v145
    v_cvt_pk_bf16_f32 v41, v146, v147
    ds_write_b64 v3, v[40:41] offset:128
    s_waitcnt lgkmcnt(7)
    v_add_f32 v148, v148, v212
    v_add_f32 v149, v149, v213
    v_add_f32 v150, v150, v214
    v_add_f32 v151, v151, v215
    v_cvt_pk_bf16_f32 v42, v148, v149
    v_cvt_pk_bf16_f32 v43, v150, v151
    ds_write_b64 v3, v[42:43] offset:160
    s_waitcnt lgkmcnt(7)
    v_add_f32 v152, v152, v216
    v_add_f32 v153, v153, v217
    v_add_f32 v154, v154, v218
    v_add_f32 v155, v155, v219
    v_cvt_pk_bf16_f32 v44, v152, v153
    v_cvt_pk_bf16_f32 v45, v154, v155
    ds_write_b64 v3, v[44:45] offset:192
    s_waitcnt lgkmcnt(7)
    v_add_f32 v156, v156, v220
    v_add_f32 v157, v157, v221
    v_add_f32 v158, v158, v222
    v_add_f32 v159, v159, v223
    v_cvt_pk_bf16_f32 v46, v156, v157
    v_cvt_pk_bf16_f32 v47, v158, v159
    ds_write_b64 v3, v[46:47] offset:224
    v_and_b32 v5, 15, v0
    v_mul_u32_u24 v3, 272, v4
    v_lshl_add_u32 v3, v5, 4, v3
    v_add_u32 v3, s24, v3
    v_lshlrev_b32 v4, 11, v4
    v_lshl_add_u32 v4, v5, 4, v4
    s_waitcnt lgkmcnt(0)
    ds_read_b128 v[64:67], v3 offset:0
    ds_read_b128 v[68:71], v3 offset:1088
    ds_read_b128 v[72:75], v3 offset:2176
    ds_read_b128 v[76:79], v3 offset:3264
    s_lshl_b32 s24, s31, 16
    s_lshl_b32 s25, s29, 9
    s_add_u32 s24, s24, s25
    s_lshl_b32 s25, s28, 8
    s_add_u32 s24, s24, s25
    s_mul_i32 s25, s75, 32768
    s_add_u32 s24, s24, s25
    s_add_u32 s24, s24, 0x400000
    s_waitcnt lgkmcnt(3)
    buffer_store_dwordx4 v[64:67], v4, s[12:15], s24 offen sc1 nt
    s_add_u32 s24, s24, 8192
    s_waitcnt lgkmcnt(2)
    buffer_store_dwordx4 v[68:71], v4, s[12:15], s24 offen sc1 nt
    s_add_u32 s24, s24, 8192
    s_waitcnt lgkmcnt(1)
    buffer_store_dwordx4 v[72:75], v4, s[12:15], s24 offen sc1 nt
    s_add_u32 s24, s24, 8192
    s_waitcnt lgkmcnt(0)
    buffer_store_dwordx4 v[76:79], v4, s[12:15], s24 offen sc1 nt
    s_add_u32 s24, s24, 8192
    s_waitcnt vmcnt(0)
    s_barrier
    s_cmp_lg_u32 s3, 0
    s_cbranch_scc1 L_sig24
    s_mov_b64 exec, 1
    v_mov_b32 v3, 1
    buffer_atomic_add v3, off, s[16:19], 0 offset:4 sc0
    s_waitcnt vmcnt(0)
    v_readfirstlane_b32 s24, v3
    s_mov_b64 exec, -1
    s_and_b32 s24, s24, 31
    s_cmp_lg_u32 s24, 31
    s_cbranch_scc1 L_sig24
    v_lshlrev_b32 v4, 7, v0
    v_mov_b32 v3, 1
    s_mov_b32 s24, 0x170000
    s_mov_b32 exec_hi, 0
    buffer_store_dword v3, v4, s[12:15], s24 offen offset:4 sc1
    s_mov_b64 exec, -1
L_sig24:
    s_branch L_R
L_last:
    s_endpgm
.section .rodata,"a"
.p2align 6
.amdhsa_kernel concat_heads__compressed_kv_cla__mha_block_cached__decode_kernel
  .amdhsa_next_free_vgpr 448
  .amdhsa_next_free_sgpr 102
  .amdhsa_accum_offset 256
  .amdhsa_group_segment_fixed_size 0
  .amdhsa_kernarg_size 112
  .amdhsa_user_sgpr_count 2
  .amdhsa_user_sgpr_kernarg_segment_ptr 1
  .amdhsa_system_sgpr_workgroup_id_x 1
  .amdhsa_float_denorm_mode_32 3
.end_amdhsa_kernel
```

```asm
; @launch grid=(256,1,1) block=(256,1,1) lds=149504
.amdgcn_target "amdgcn-amd-amdhsa--gfx950"
.text
.globl concat_heads__compressed_kv_cla__mha_block_cached__decode_kernel
.p2align 8
.type concat_heads__compressed_kv_cla__mha_block_cached__decode_kernel,@function
concat_heads__compressed_kv_cla__mha_block_cached__decode_kernel:
    s_load_dwordx16 s[36:51], s[0:1], 0
    s_load_dwordx8 s[52:59], s[0:1], 64
    s_load_dwordx4 s[60:63], s[0:1], 96
    s_cmp_ge_u32 s2, 256
    s_cbranch_scc1 L_end
    s_cmp_lt_u32 s2, 64
    s_getpc_b64 s[24:25]
L_pc0:
    s_cselect_b32 s20, L_A-L_pc0, 0
    v_lshlrev_b32 v16, 7, v0
    v_min_u32 v16, L_A-L_pc0-4, v16
    v_add_u32 v16, s20, v16
    v_add_co_u32 v16, vcc, s24, v16
    v_mov_b32 v17, s25
    s_nop 0
    v_addc_co_u32 v17, vcc, 0, v17, vcc
    global_load_dword v17, v[16:17], off
    s_cbranch_scc1 L_A
L_B:
    s_and_b32 s70, s2, 6
    s_and_b32 s25, s2, 7
    s_add_u32 s70, s70, s25
    s_lshl_b32 s25, s70, 8
    v_and_b32 v6, 15, v0
    v_lshl_add_u32 v24, v6, 4, s25
    v_and_b32 v4, 16, v0
    v_lshl_add_u32 v24, v4, 5, v24
    v_lshrrev_b32 v4, 5, v0
    v_lshl_add_u32 v24, v4, 12, v24
    s_lshr_b32 s74, s2, 3
    s_lshl_b32 s74, s74, 2
    s_addk_i32 s74, -32
    s_mov_b32 s10, 0x400000
    s_mov_b32 s11, 0x20000
    s_waitcnt lgkmcnt(0)
    s_mov_b64 s[8:9], s[54:55]
L_pfb:
    s_lshl_b32 s24, s74, 13
    buffer_load_dwordx4 v[28:31], v24, s[8:11], s24 offen
    s_addk_i32 s74, 96
    s_cmpk_lt_u32 s74, 512
    s_cbranch_scc1 L_pfb
    s_addk_i32 s74, -512
    s_mov_b64 s[8:9], s[40:41]
L_pfq:
    s_lshl_b32 s24, s74, 13
    buffer_load_dwordx4 v[28:31], v24, s[8:11], s24 offen
    s_addk_i32 s74, 96
    s_cmpk_lt_u32 s74, 512
    s_cbranch_scc1 L_pfq
    s_addk_i32 s74, -512
    v_lshrrev_b32 v1, 6, v0
    v_and_b32 v0, 63, v0
    v_readfirstlane_b32 s3, v1
    v_lshlrev_b32 v2, 4, v0
    s_lshr_b32 s24, s2, 3
    s_sub_u32 s24, s24, 8
    s_mul_i32 s26, s24, 43
    s_lshr_b32 s26, s26, 8
    s_mul_i32 s27, s26, 6
    s_sub_u32 s27, s24, s27
    s_and_b32 s25, s26, 1
    s_lshl_b32 s25, s25, 1
    s_and_b32 s26, s26, 2
    s_lshl_b32 s26, s26, 3
    s_or_b32 s26, s26, s25
    s_or_b32 s26, s26, s70
    s_lshl_b32 s25, s70, 17
    s_lshl_b32 s24, s3, 8
    s_add_u32 s25, s25, s24
    v_lshl_add_u32 v25, v6, 4, s25
    v_and_b32 v4, 16, v0
    v_lshl_add_u32 v25, v4, 14, v25
    v_and_b32 v4, 32, v0
    v_lshl_add_u32 v25, v4, 16, v25
    s_and_b32 s25, s2, 3
    s_lshl_b32 s25, s25, 10
    s_lshl_b32 s24, s3, 12
    s_add_u32 s25, s25, s24
    s_bfe_u32 s24, s2, 0x10002
    s_lshl_b32 s24, s24, 23
    s_add_u32 s25, s25, s24
    v_add_u32 v26, s25, v2
    s_cmp_ge_u32 s27, 3
    s_cselect_b32 s28, 1, 0
    s_mul_i32 s29, s28, 3
    s_sub_u32 s29, s27, s29
    s_lshr_b32 s72, s3, 1
    s_lshl_b32 s24, s28, 1
    s_add_u32 s72, s72, s24
    s_and_b32 s31, s3, 1
    s_lshl_b32 s24, s29, 1
    s_add_u32 s31, s31, s24
    s_lshl_b32 s30, s72, 5
    s_add_u32 s30, s30, s26
    s_lshl_b32 s30, s30, 20
    v_lshrrev_b32 v3, 4, v0
    v_and_b32 v4, 3, v0
    v_lshlrev_b32 v5, 6, v3
    v_lshl_add_u32 v5, v4, 4, v5
    v_bfe_u32 v1, v0, 2, 2
    v_lshl_add_u32 v1, v1, 8, v5
    s_mul_i32 s35, s31, 1024
    s_add_u32 s32, s35, 983040
    s_mul_i32 s28, s31, 1024
    s_add_u32 s28, s28, 1044480
    s_mov_b32 s6, 0x100000
    s_mov_b32 s7, 0x20000
    s_add_u32 s4, s50, s30
    s_addc_u32 s5, s51, 0
    s_mov_b32 s12, s62
    s_mov_b32 s13, s63
    s_mov_b32 s14, 0x600000
    s_mov_b32 s15, 0x20000
    s_mov_b32 s16, s60
    s_mov_b32 s17, s61
    s_mov_b32 s18, 0x100
    s_mov_b32 s19, 0x20000
    v_and_b32 v3, 1, v0
    v_lshlrev_b32 v3, 4, v3
    v_mov_b32 v4, 0xffff
    v_lshlrev_b32 v4, v3, v4
    v_bfe_u32 v3, v0, 1, 2
    v_cmp_eq_u32 vcc, 0, v3
    s_nop 1
    v_cndmask_b32 v20, 0, v4, vcc
    v_cmp_eq_u32 vcc, 1, v3
    s_nop 1
    v_cndmask_b32 v21, 0, v4, vcc
    v_cmp_eq_u32 vcc, 2, v3
    s_nop 1
    v_cndmask_b32 v22, 0, v4, vcc
    v_cmp_eq_u32 vcc, 3, v3
    s_nop 1
    v_cndmask_b32 v23, 0, v4, vcc
    s_mov_b32 s64, 0x22222222
    s_mov_b32 s65, 0x22222222
    s_mov_b32 s66, 0x44444444
    s_mov_b32 s67, 0x44444444
    s_mov_b32 s68, 0x88888888
    s_mov_b32 s69, 0x88888888
    v_mov_b32 v32, 0
    v_mov_b32 v33, 0
    v_mov_b32 v34, 0
    v_mov_b32 v35, 0
    v_mov_b32 v36, 0
    v_mov_b32 v37, 0
    v_mov_b32 v38, 0
    v_mov_b32 v39, 0
    v_mov_b32 v40, 0
    v_mov_b32 v41, 0
    v_mov_b32 v42, 0
    v_mov_b32 v43, 0
    v_mov_b32 v44, 0
    v_mov_b32 v45, 0
    v_mov_b32 v46, 0
    v_mov_b32 v47, 0
    v_lshrrev_b32 v3, 4, v0
    v_lshlrev_b32 v60, 6, v3
    v_and_b32 v4, 7, v0
    v_lshl_add_u32 v60, v4, 3, v60
    s_lshl_b32 s33, s26, 2
    s_add_u32 s33, s33, s72
    s_lshl_b32 s34, s26, 12
    s_lshl_b32 s24, s72, 8
    s_add_u32 s34, s34, s24
    s_add_u32 s34, s34, 0x140000
    s_mul_i32 s73, s33, 6
    s_add_u32 s73, s73, s31
    s_lshl_b32 s73, s73, 8
    s_add_u32 s73, s73, 0x180000
    s_mov_b64 s[8:9], s[56:57]
L_pfo:
    s_lshl_b32 s24, s74, 8
    s_waitcnt vmcnt(6)
    buffer_load_dwordx4 v[28:31], v25, s[8:11], s24 offen
    s_addk_i32 s74, 96
    s_cmpk_lt_u32 s74, 512
    s_cbranch_scc1 L_pfo
    s_addk_i32 s74, -512
    s_mov_b64 s[8:9], s[42:43]
L_pfk:
    s_lshl_b32 s24, s74, 13
    s_waitcnt vmcnt(6)
    buffer_load_dwordx4 v[28:31], v24, s[8:11], s24 offen
    s_addk_i32 s74, 96
    s_cmpk_lt_u32 s74, 512
    s_cbranch_scc1 L_pfk
    s_addk_i32 s74, -512
    s_mov_b64 s[8:9], s[44:45]
L_pfu:
    s_lshl_b32 s24, s74, 13
    s_waitcnt vmcnt(6)
    buffer_load_dwordx4 v[28:31], v24, s[8:11], s24 offen
    s_addk_i32 s74, 96
    s_cmpk_lt_u32 s74, 512
    s_cbranch_scc1 L_pfu
    s_addk_i32 s74, -512
    s_mov_b64 s[8:9], s[46:47]
L_pfv:
    s_lshl_b32 s24, s74, 8
    s_waitcnt vmcnt(6)
    buffer_load_dwordx4 v[28:31], v25, s[8:11], s24 offen
    s_addk_i32 s74, 96
    s_cmpk_lt_u32 s74, 512
    s_cbranch_scc1 L_pfv
    s_addk_i32 s74, -512
    s_mov_b64 s[8:9], s[38:39]
    s_mov_b32 s10, 0x1000000
L_pfc:
    s_lshl_b32 s24, s74, 12
    s_waitcnt vmcnt(6)
    buffer_load_dwordx4 v[28:31], v26, s[8:11], s24 offen
    s_addk_i32 s74, 96
    s_cmpk_lt_u32 s74, 2048
    s_cbranch_scc1 L_pfc
    s_addk_i32 s74, -2048
    s_mov_b32 s10, 0x400000
    s_waitcnt vmcnt(15)
    buffer_load_dwordx4 a[0:3], v1, s[4:7], s32 offen offset:0 nt
    s_add_u32 s32, s32, 6144
    s_waitcnt vmcnt(15)
    buffer_load_dwordx4 a[4:7], v1, s[4:7], s32 offen offset:0 nt
    s_add_u32 s32, s32, 6144
    s_waitcnt vmcnt(15)
    buffer_load_dwordx4 a[8:11], v1, s[4:7], s32 offen offset:0 nt
    s_add_u32 s32, s32, 6144
    s_waitcnt vmcnt(15)
    buffer_load_dwordx4 a[12:15], v1, s[4:7], s32 offen offset:0 nt
    s_add_u32 s32, s32, 6144
    s_waitcnt vmcnt(15)
    buffer_load_dwordx4 a[16:19], v1, s[4:7], s32 offen offset:0 nt
    s_add_u32 s32, s32, 6144
    s_waitcnt vmcnt(15)
    buffer_load_dwordx4 a[20:23], v1, s[4:7], s32 offen offset:0 nt
    s_add_u32 s32, s32, 6144
    s_waitcnt vmcnt(15)
    buffer_load_dwordx4 a[24:27], v1, s[4:7], s32 offen offset:0 nt
    s_add_u32 s32, s32, 6144
    s_waitcnt vmcnt(15)
    buffer_load_dwordx4 a[28:31], v1, s[4:7], s32 offen offset:0 nt
    s_add_u32 s32, s32, 6144
    s_waitcnt vmcnt(15)
    buffer_load_dwordx4 a[32:35], v1, s[4:7], s32 offen offset:0 nt
    s_add_u32 s32, s32, 6144
    s_waitcnt vmcnt(15)
    buffer_load_dwordx4 a[36:39], v1, s[4:7], s32 offen offset:0 nt
    s_add_u32 s32, s32, 6144
    s_waitcnt vmcnt(15)
    buffer_load_dwordx4 a[40:43], v1, s[4:7], s28 offen offset:0 nt
    s_waitcnt vmcnt(15)
    s_mov_b32 s32, s35
    buffer_load_dwordx4 a[64:67], v1, s[4:7], s32 offen offset:0 nt
    s_add_u32 s32, s32, 6144
    s_waitcnt vmcnt(15)
    buffer_load_dwordx4 a[68:71], v1, s[4:7], s32 offen offset:0 nt
    s_add_u32 s32, s32, 6144
    s_waitcnt vmcnt(15)
    buffer_load_dwordx4 a[72:75], v1, s[4:7], s32 offen offset:0 nt
    s_add_u32 s32, s32, 6144
    s_waitcnt vmcnt(15)
    buffer_load_dwordx4 a[76:79], v1, s[4:7], s32 offen offset:0 nt
    s_add_u32 s32, s32, 6144
    s_waitcnt vmcnt(15)
    buffer_load_dwordx4 a[80:83], v1, s[4:7], s32 offen offset:0 nt
    s_add_u32 s32, s32, 6144
    s_mov_b64 exec, 1
    buffer_load_dword v61, off, s[16:19], 0 offset:128 sc1
    s_mov_b64 exec, -1
    s_waitcnt vmcnt(15)
    buffer_load_dwordx4 a[84:87], v1, s[4:7], s32 offen offset:0 nt
    s_add_u32 s32, s32, 6144
    s_waitcnt vmcnt(15)
    buffer_load_dwordx4 a[88:91], v1, s[4:7], s32 offen offset:0 nt
    s_add_u32 s32, s32, 6144
    s_waitcnt vmcnt(15)
    buffer_load_dwordx4 a[92:95], v1, s[4:7], s32 offen offset:0 nt
    s_add_u32 s32, s32, 6144
    s_waitcnt vmcnt(15)
    buffer_load_dwordx4 a[96:99], v1, s[4:7], s32 offen offset:0 nt
    s_add_u32 s32, s32, 6144
    s_waitcnt vmcnt(15)
    buffer_load_dwordx4 a[100:103], v1, s[4:7], s32 offen offset:0 nt
    s_add_u32 s32, s32, 6144
    s_waitcnt vmcnt(15)
    buffer_load_dwordx4 a[104:107], v1, s[4:7], s32 offen offset:0 nt
    s_add_u32 s32, s32, 6144
    s_waitcnt vmcnt(15)
    buffer_load_dwordx4 a[108:111], v1, s[4:7], s32 offen offset:0 nt
    s_add_u32 s32, s32, 6144
    s_waitcnt vmcnt(15)
    buffer_load_dwordx4 a[112:115], v1, s[4:7], s32 offen offset:0 nt
    s_add_u32 s32, s32, 6144
    s_waitcnt vmcnt(15)
    buffer_load_dwordx4 a[116:119], v1, s[4:7], s32 offen offset:0 nt
    s_add_u32 s32, s32, 6144
    s_waitcnt vmcnt(15)
    buffer_load_dwordx4 a[120:123], v1, s[4:7], s32 offen offset:0 nt
    s_add_u32 s32, s32, 6144
    s_waitcnt vmcnt(15)
    buffer_load_dwordx4 a[124:127], v1, s[4:7], s32 offen offset:0 nt
    s_add_u32 s32, s32, 6144
    s_waitcnt vmcnt(15)
    buffer_load_dwordx4 v[64:67], v1, s[4:7], s32 offen offset:0 nt
    s_add_u32 s32, s32, 6144
    s_waitcnt vmcnt(12)
    v_readfirstlane_b32 s25, v61
    s_nop 0
    s_cmp_ge_u32 s25, 32
    s_cbranch_scc1 L_B_q
    s_mov_b32 s24, 262144
    s_mov_b64 exec, 1
L_aw1:
    buffer_load_dword v61, off, s[16:19], 0 offset:128 sc1
    s_waitcnt vmcnt(0)
    v_readfirstlane_b32 s25, v61
    s_nop 0
    s_cmp_ge_u32 s25, 32
    s_cbranch_scc1 L_B_q
    s_sleep 16
    s_sub_u32 s24, s24, 1
    s_cmp_lg_u32 s24, 0
    s_cbranch_scc1 L_aw1
L_B_q:
    s_mov_b64 exec, -1
    buffer_load_dwordx4 v[8:11], v5, s[12:15], s34 offen sc1
    s_waitcnt vmcnt(15)
    buffer_load_dwordx4 v[68:71], v1, s[4:7], s32 offen offset:0 nt
    s_add_u32 s32, s32, 6144
    s_waitcnt vmcnt(15)
    buffer_load_dwordx4 v[72:75], v1, s[4:7], s32 offen offset:0 nt
    s_add_u32 s32, s32, 6144
    s_waitcnt vmcnt(15)
    buffer_load_dwordx4 v[76:79], v1, s[4:7], s32 offen offset:0 nt
    s_add_u32 s32, s32, 6144
    s_waitcnt vmcnt(15)
    buffer_load_dwordx4 v[80:83], v1, s[4:7], s32 offen offset:0 nt
    s_add_u32 s32, s32, 6144
    s_waitcnt vmcnt(15)
    buffer_load_dwordx4 v[84:87], v1, s[4:7], s32 offen offset:0 nt
    s_add_u32 s32, s32, 6144
    s_waitcnt vmcnt(15)
    buffer_load_dwordx4 v[88:91], v1, s[4:7], s32 offen offset:0 nt
    s_add_u32 s32, s32, 6144
    s_waitcnt vmcnt(15)
    buffer_load_dwordx4 v[92:95], v1, s[4:7], s32 offen offset:0 nt
    s_add_u32 s32, s32, 6144
    s_waitcnt vmcnt(15)
    buffer_load_dwordx4 v[96:99], v1, s[4:7], s32 offen offset:0 nt
    s_add_u32 s32, s32, 6144
    s_waitcnt vmcnt(15)
    buffer_load_dwordx4 v[100:103], v1, s[4:7], s32 offen offset:0 nt
    s_add_u32 s32, s32, 6144
    s_waitcnt vmcnt(15)
    buffer_load_dwordx4 v[104:107], v1, s[4:7], s32 offen offset:0 nt
    s_add_u32 s32, s32, 6144
    s_waitcnt vmcnt(15)
    buffer_load_dwordx4 v[108:111], v1, s[4:7], s32 offen offset:0 nt
    s_add_u32 s32, s32, 6144
    s_waitcnt vmcnt(15)
    buffer_load_dwordx4 v[112:115], v1, s[4:7], s32 offen offset:0 nt
    s_add_u32 s32, s32, 6144
    s_waitcnt vmcnt(15)
    buffer_load_dwordx4 v[116:119], v1, s[4:7], s32 offen offset:0 nt
    s_add_u32 s32, s32, 6144
    s_waitcnt vmcnt(15)
    buffer_load_dwordx4 v[120:123], v1, s[4:7], s32 offen offset:0 nt
    s_add_u32 s32, s32, 6144
    s_waitcnt vmcnt(15)
    buffer_load_dwordx4 v[124:127], v1, s[4:7], s32 offen offset:0 nt
    s_add_u32 s32, s32, 6144
    s_waitcnt vmcnt(15)
    v_mov_b32_dpp v32, v8 quad_perm:[0,1,2,3] row_mask:0xf bank_mask:0x1
    v_mov_b32_dpp v33, v9 quad_perm:[0,1,2,3] row_mask:0xf bank_mask:0x1
    v_mov_b32_dpp v34, v10 quad_perm:[0,1,2,3] row_mask:0xf bank_mask:0x1
    v_mov_b32_dpp v35, v11 quad_perm:[0,1,2,3] row_mask:0xf bank_mask:0x1
    v_mov_b32_dpp v36, v8 quad_perm:[0,1,2,3] row_mask:0xf bank_mask:0x2
    v_mov_b32_dpp v37, v9 quad_perm:[0,1,2,3] row_mask:0xf bank_mask:0x2
    v_mov_b32_dpp v38, v10 quad_perm:[0,1,2,3] row_mask:0xf bank_mask:0x2
    v_mov_b32_dpp v39, v11 quad_perm:[0,1,2,3] row_mask:0xf bank_mask:0x2
    v_mov_b32_dpp v40, v8 quad_perm:[0,1,2,3] row_mask:0xf bank_mask:0x4
    v_mov_b32_dpp v41, v9 quad_perm:[0,1,2,3] row_mask:0xf bank_mask:0x4
    v_mov_b32_dpp v42, v10 quad_perm:[0,1,2,3] row_mask:0xf bank_mask:0x4
    v_mov_b32_dpp v43, v11 quad_perm:[0,1,2,3] row_mask:0xf bank_mask:0x4
    v_mov_b32_dpp v44, v8 quad_perm:[0,1,2,3] row_mask:0xf bank_mask:0x8
    v_mov_b32_dpp v45, v9 quad_perm:[0,1,2,3] row_mask:0xf bank_mask:0x8
    v_mov_b32_dpp v46, v10 quad_perm:[0,1,2,3] row_mask:0xf bank_mask:0x8
    v_mov_b32_dpp v47, v11 quad_perm:[0,1,2,3] row_mask:0xf bank_mask:0x8
    s_mov_b32 s27, 1
L_BK:
    s_cmp_lg_u32 s27, 9
    s_cbranch_scc1 L_BK_a
    s_add_u32 s4, s52, s30
    s_addc_u32 s5, s53, 0
    s_mov_b32 s32, s35
    v_mov_b32 v1, v2
L_BK_a:
    s_barrier
    s_cmp_lg_u32 s27, 8
    s_cbranch_scc1 L_BK_x0
    s_and_b32 s24, s2, 7
    s_lshl_b32 s24, s24, 7
    s_add_u32 s24, s24, 0x1d8000
    v_and_b32 v63, 7, v0
    v_lshlrev_b32 v63, 2, v63
    buffer_load_dword v62, v63, s[12:15], s24 offen sc1
L_BK_x0:
    s_cmp_lg_u32 s27, 9
    s_cbranch_scc1 L_BK_x1
    s_getreg_b32 s24, hwreg(HW_REG_XCC_ID, 0, 4)
    v_cmp_ne_u32 vcc, s24, v62
    s_nop 0
    s_or_b32 s75, vcc_lo, vcc_hi
L_BK_x1:
    v_mov_b32 v49, v50
    v_mov_b32 v50, v51
    v_mov_b32 v51, v52
    v_mov_b32 v52, v53
    v_mov_b32 v53, v54
    v_mov_b32 v54, v55
    v_mov_b32 v55, v56
    v_mov_b32 v56, v57
    s_waitcnt vmcnt(15)
    v_mfma_f32_16x16x32_bf16 v[12:15], v[64:67], v[32:35], 0
    buffer_load_dwordx4 v[64:67], v1, s[4:7], s32 offen offset:0 nt
    s_add_u32 s32, s32, 6144
    s_waitcnt vmcnt(15)
    v_mfma_f32_16x16x32_bf16 v[12:15], v[68:71], v[36:39], v[12:15]
    buffer_load_dwordx4 v[68:71], v1, s[4:7], s32 offen offset:0 nt
    s_add_u32 s32, s32, 6144
    s_waitcnt vmcnt(15)
    v_mfma_f32_16x16x32_bf16 v[12:15], v[72:75], v[40:43], v[12:15]
    buffer_load_dwordx4 v[72:75], v1, s[4:7], s32 offen offset:0 nt
    s_add_u32 s32, s32, 6144
    s_waitcnt vmcnt(15)
    v_mfma_f32_16x16x32_bf16 v[12:15], v[76:79], v[44:47], v[12:15]
    buffer_load_dwordx4 v[76:79], v1, s[4:7], s32 offen offset:0 nt
    s_add_u32 s32, s32, 6144
    s_nop 5
    v_add_f32_dpp v57, v13, v12 quad_perm:[1,1,1,1] row_mask:0xf bank_mask:0xf
    s_nop 1
    v_add_f32_dpp v57, v14, v57 quad_perm:[2,2,2,2] row_mask:0xf bank_mask:0xf
    s_nop 1
    v_add_f32_dpp v57, v15, v57 quad_perm:[3,3,3,3] row_mask:0xf bank_mask:0xf
    s_waitcnt vmcnt(15)
    v_mfma_f32_16x16x32_bf16 v[16:19], v[80:83], v[32:35], 0
    buffer_load_dwordx4 v[80:83], v1, s[4:7], s32 offen offset:0 nt
    s_add_u32 s32, s32, 6144
    s_waitcnt vmcnt(15)
    v_mfma_f32_16x16x32_bf16 v[16:19], v[84:87], v[36:39], v[16:19]
    buffer_load_dwordx4 v[84:87], v1, s[4:7], s32 offen offset:0 nt
    s_add_u32 s32, s32, 6144
    s_waitcnt vmcnt(15)
    v_mfma_f32_16x16x32_bf16 v[16:19], v[88:91], v[40:43], v[16:19]
    buffer_load_dwordx4 v[88:91], v1, s[4:7], s32 offen offset:0 nt
    s_add_u32 s32, s32, 6144
    s_waitcnt vmcnt(15)
    v_mfma_f32_16x16x32_bf16 v[16:19], v[92:95], v[44:47], v[16:19]
    buffer_load_dwordx4 v[92:95], v1, s[4:7], s32 offen offset:0 nt
    s_add_u32 s32, s32, 6144
    s_nop 5
    v_add_f32_dpp v3, v16, v17 quad_perm:[0,0,0,0] row_mask:0xf bank_mask:0xf
    s_nop 1
    v_add_f32_dpp v3, v18, v3 quad_perm:[2,2,2,2] row_mask:0xf bank_mask:0xf
    s_nop 1
    v_add_f32_dpp v3, v19, v3 quad_perm:[3,3,3,3] row_mask:0xf bank_mask:0xf
    v_cndmask_b32 v57, v57, v3, s[64:65]
    s_waitcnt vmcnt(15)
    v_mfma_f32_16x16x32_bf16 v[12:15], v[96:99], v[32:35], 0
    buffer_load_dwordx4 v[96:99], v1, s[4:7], s32 offen offset:0 nt
    s_add_u32 s32, s32, 6144
    s_waitcnt vmcnt(15)
    v_mfma_f32_16x16x32_bf16 v[12:15], v[100:103], v[36:39], v[12:15]
    buffer_load_dwordx4 v[100:103], v1, s[4:7], s32 offen offset:0 nt
    s_add_u32 s32, s32, 6144
    s_waitcnt vmcnt(15)
    v_mfma_f32_16x16x32_bf16 v[12:15], v[104:107], v[40:43], v[12:15]
    buffer_load_dwordx4 v[104:107], v1, s[4:7], s32 offen offset:0 nt
    s_add_u32 s32, s32, 6144
    s_waitcnt vmcnt(15)
    v_mfma_f32_16x16x32_bf16 v[12:15], v[108:111], v[44:47], v[12:15]
    buffer_load_dwordx4 v[108:111], v1, s[4:7], s32 offen offset:0 nt
    s_add_u32 s32, s32, 6144
    s_nop 5
    v_add_f32_dpp v3, v12, v14 quad_perm:[0,0,0,0] row_mask:0xf bank_mask:0xf
    s_nop 1
    v_add_f32_dpp v3, v13, v3 quad_perm:[1,1,1,1] row_mask:0xf bank_mask:0xf
    s_nop 1
    v_add_f32_dpp v3, v15, v3 quad_perm:[3,3,3,3] row_mask:0xf bank_mask:0xf
    v_cndmask_b32 v57, v57, v3, s[66:67]
    s_waitcnt vmcnt(15)
    v_mfma_f32_16x16x32_bf16 v[16:19], v[112:115], v[32:35], 0
    buffer_load_dwordx4 v[112:115], v1, s[4:7], s32 offen offset:0 nt
    s_add_u32 s32, s32, 6144
    s_waitcnt vmcnt(15)
    v_mfma_f32_16x16x32_bf16 v[16:19], v[116:119], v[36:39], v[16:19]
    buffer_load_dwordx4 v[116:119], v1, s[4:7], s32 offen offset:0 nt
    s_add_u32 s32, s32, 6144
    s_waitcnt vmcnt(15)
    v_mfma_f32_16x16x32_bf16 v[16:19], v[120:123], v[40:43], v[16:19]
    buffer_load_dwordx4 v[120:123], v1, s[4:7], s32 offen offset:0 nt
    s_add_u32 s32, s32, 6144
    s_waitcnt vmcnt(15)
    v_mfma_f32_16x16x32_bf16 v[16:19], v[124:127], v[44:47], v[16:19]
    buffer_load_dwordx4 v[124:127], v1, s[4:7], s32 offen offset:0 nt
    s_add_u32 s32, s32, 6144
    s_nop 5
    v_add_f32_dpp v3, v16, v19 quad_perm:[0,0,0,0] row_mask:0xf bank_mask:0xf
    s_nop 1
    v_add_f32_dpp v3, v17, v3 quad_perm:[1,1,1,1] row_mask:0xf bank_mask:0xf
    s_nop 1
    v_add_f32_dpp v3, v18, v3 quad_perm:[2,2,2,2] row_mask:0xf bank_mask:0xf
    v_cndmask_b32 v57, v57, v3, s[68:69]
    s_cmp_lg_u32 s27, 3
    s_cbranch_scc1 L_BK_c0
    v_mfma_f32_16x16x32_bf16 v[12:15], a[64:67], v[32:35], 0
    v_mfma_f32_16x16x32_bf16 v[12:15], a[68:71], v[36:39], v[12:15]
    v_mfma_f32_16x16x32_bf16 v[12:15], a[72:75], v[40:43], v[12:15]
    v_mfma_f32_16x16x32_bf16 v[12:15], a[76:79], v[44:47], v[12:15]
    s_nop 7
    v_add_f32_dpp v48, v13, v12 quad_perm:[1,1,1,1] row_mask:0xf bank_mask:0xf
    s_nop 1
    v_add_f32_dpp v48, v14, v48 quad_perm:[2,2,2,2] row_mask:0xf bank_mask:0xf
    s_nop 1
    v_add_f32_dpp v48, v15, v48 quad_perm:[3,3,3,3] row_mask:0xf bank_mask:0xf
    v_mfma_f32_16x16x32_bf16 v[16:19], a[80:83], v[32:35], 0
    v_mfma_f32_16x16x32_bf16 v[16:19], a[84:87], v[36:39], v[16:19]
    v_mfma_f32_16x16x32_bf16 v[16:19], a[88:91], v[40:43], v[16:19]
    v_mfma_f32_16x16x32_bf16 v[16:19], a[92:95], v[44:47], v[16:19]
    s_nop 7
    v_add_f32_dpp v3, v16, v17 quad_perm:[0,0,0,0] row_mask:0xf bank_mask:0xf
    s_nop 1
    v_add_f32_dpp v3, v18, v3 quad_perm:[2,2,2,2] row_mask:0xf bank_mask:0xf
    s_nop 1
    v_add_f32_dpp v3, v19, v3 quad_perm:[3,3,3,3] row_mask:0xf bank_mask:0xf
    v_cndmask_b32 v48, v48, v3, s[64:65]
    v_mfma_f32_16x16x32_bf16 v[12:15], a[96:99], v[32:35], 0
    v_mfma_f32_16x16x32_bf16 v[12:15], a[100:103], v[36:39], v[12:15]
    v_mfma_f32_16x16x32_bf16 v[12:15], a[104:107], v[40:43], v[12:15]
    v_mfma_f32_16x16x32_bf16 v[12:15], a[108:111], v[44:47], v[12:15]
    s_nop 7
    v_add_f32_dpp v3, v12, v14 quad_perm:[0,0,0,0] row_mask:0xf bank_mask:0xf
    s_nop 1
    v_add_f32_dpp v3, v13, v3 quad_perm:[1,1,1,1] row_mask:0xf bank_mask:0xf
    s_nop 1
    v_add_f32_dpp v3, v15, v3 quad_perm:[3,3,3,3] row_mask:0xf bank_mask:0xf
    v_cndmask_b32 v48, v48, v3, s[66:67]
    v_mfma_f32_16x16x32_bf16 v[16:19], a[112:115], v[32:35], 0
    v_mfma_f32_16x16x32_bf16 v[16:19], a[116:119], v[36:39], v[16:19]
    v_mfma_f32_16x16x32_bf16 v[16:19], a[120:123], v[40:43], v[16:19]
    v_mfma_f32_16x16x32_bf16 v[16:19], a[124:127], v[44:47], v[16:19]
    s_nop 7
    v_add_f32_dpp v3, v16, v19 quad_perm:[0,0,0,0] row_mask:0xf bank_mask:0xf
    s_nop 1
    v_add_f32_dpp v3, v17, v3 quad_perm:[1,1,1,1] row_mask:0xf bank_mask:0xf
    s_nop 1
    v_add_f32_dpp v3, v18, v3 quad_perm:[2,2,2,2] row_mask:0xf bank_mask:0xf
    v_cndmask_b32 v48, v48, v3, s[68:69]
L_BK_c0:
    s_cmp_lg_u32 s27, 2
    s_cbranch_scc1 L_BK_b
    v_mfma_f32_16x16x32_bf16 v[12:15], a[0:3], v[32:35], 0
    v_mfma_f32_16x16x32_bf16 v[12:15], a[4:7], v[36:39], v[12:15]
    v_mfma_f32_16x16x32_bf16 v[12:15], a[8:11], v[40:43], v[12:15]
    v_mfma_f32_16x16x32_bf16 v[12:15], a[12:15], v[44:47], v[12:15]
    s_nop 7
    v_add_f32_dpp v58, v13, v12 quad_perm:[1,1,1,1] row_mask:0xf bank_mask:0xf
    s_nop 1
    v_add_f32_dpp v58, v14, v58 quad_perm:[2,2,2,2] row_mask:0xf bank_mask:0xf
    s_nop 1
    v_add_f32_dpp v58, v15, v58 quad_perm:[3,3,3,3] row_mask:0xf bank_mask:0xf
    v_mfma_f32_16x16x32_bf16 v[16:19], a[16:19], v[32:35], 0
    v_mfma_f32_16x16x32_bf16 v[16:19], a[20:23], v[36:39], v[16:19]
    v_mfma_f32_16x16x32_bf16 v[16:19], a[24:27], v[40:43], v[16:19]
    v_mfma_f32_16x16x32_bf16 v[16:19], a[28:31], v[44:47], v[16:19]
    s_nop 7
    v_add_f32_dpp v3, v16, v17 quad_perm:[0,0,0,0] row_mask:0xf bank_mask:0xf
    s_nop 1
    v_add_f32_dpp v3, v18, v3 quad_perm:[2,2,2,2] row_mask:0xf bank_mask:0xf
    s_nop 1
    v_add_f32_dpp v3, v19, v3 quad_perm:[3,3,3,3] row_mask:0xf bank_mask:0xf
    v_cndmask_b32 v58, v58, v3, s[64:65]
    v_mfma_f32_16x16x32_bf16 v[12:15], a[32:35], v[32:35], 0
    v_mfma_f32_16x16x32_bf16 v[12:15], a[36:39], v[36:39], v[12:15]
    v_mfma_f32_16x16x32_bf16 v[12:15], a[40:43], v[40:43], v[12:15]
    s_nop 7
    v_add_f32_dpp v3, v12, v14 quad_perm:[0,0,0,0] row_mask:0xf bank_mask:0xf
    s_nop 1
    v_add_f32_dpp v3, v13, v3 quad_perm:[1,1,1,1] row_mask:0xf bank_mask:0xf
    s_nop 1
    v_add_f32_dpp v3, v15, v3 quad_perm:[3,3,3,3] row_mask:0xf bank_mask:0xf
    v_cndmask_b32 v58, v58, v3, s[66:67]
    s_mul_i32 s24, s31, 1
    s_sub_i32 s24, 4, s24
    s_max_i32 s24, s24, 0
    s_min_i32 s24, s24, 1
    s_add_u32 s24, s24, 10
    v_and_b32 v3, 3, v0
    v_bfe_u32 v4, v0, 2, 2
    v_lshl_add_u32 v3, v3, 2, v4
    v_mov_b32 v4, 0xff800000
    v_cmp_gt_u32 vcc, s24, v3
    s_nop 1
    v_cndmask_b32 v58, v4, v58, vcc
    v_mov_b32 v61, 0x3e0293ee
    v_mov_b32 v7, 0
    s_lshr_b32 s34, s2, 3
    s_lshl_b32 s34, s34, 12
    s_and_b32 s24, s2, 7
    s_lshl_b32 s24, s24, 7
    s_add_u32 s34, s34, s24
    s_add_u32 s34, s34, 0x1b8000
L_BK_b:
    s_add_u32 s27, s27, 1
    s_cmp_lt_u32 s27, 10
    s_cbranch_scc1 L_BK
    v_max3_f32 v3, v48, v49, v50
    v_max3_f32 v3, v3, v51, v52
    v_max3_f32 v3, v3, v53, v54
    v_max3_f32 v3, v3, v55, v56
    v_max3_f32 v3, v3, v57, v58
    s_nop 1
    v_max_f32_dpp v3, v3, v3 row_ror:8 row_mask:0xf bank_mask:0xf
    s_nop 1
    v_max_f32_dpp v3, v3, v3 row_ror:4 row_mask:0xf bank_mask:0xf
    s_nop 1
    v_max_f32_dpp v3, v3, v3 row_ror:2 row_mask:0xf bank_mask:0xf
    s_nop 1
    v_max_f32_dpp v3, v3, v3 row_ror:1 row_mask:0xf bank_mask:0xf
    s_nop 1
    v_max_f32_dpp v3, v3, v3 row_bcast:15 row_mask:0xa bank_mask:0xf
    s_nop 1
    v_max_f32_dpp v3, v3, v3 row_bcast:31 row_mask:0xc bank_mask:0xf
    s_nop 0
    v_readlane_b32 s24, v3, 63
    s_nop 1
    v_mul_f32 v6, s24, v61
    v_mov_b32 v12, 0
    v_mov_b32 v13, 0
    v_mov_b32 v14, 0
    v_mov_b32 v15, 0
    v_fma_f32 v48, v48, v61, -v6
    v_exp_f32 v48, v48
    s_nop 0
    v_add_f32 v7, v7, v48
    v_cvt_pk_bf16_f32 v48, v48, v48
    s_mov_b32 s27, 0
L_BV:
    s_barrier
    s_cmp_lg_u32 s27, 7
    s_cbranch_scc1 L_BV_c0
    v_mov_b32 v28, -1
    v_mov_b32 v29, -1
    v_mov_b32 v30, -1
    v_mov_b32 v31, -1
    s_mov_b64 exec, 0xffff
    s_cmp_lg_u32 s75, 0
    s_cbranch_scc1 L_far2
    buffer_store_dwordx4 v[28:31], v2, s[12:15], s73 offen
    s_branch L_near2
L_far2:
    buffer_store_dwordx4 v[28:31], v2, s[12:15], s73 offen sc1
L_near2:
    s_mov_b64 exec, -1
L_BV_c0:
    s_cmp_lg_u32 s27, 8
    s_cbranch_scc1 L_BV_c1
    s_lshl_b32 s25, s3, 4
    s_add_u32 s25, s25, s34
    s_mov_b64 exec, 1
    v_mov_b32 v28, 0
    v_mov_b32 v29, 0
    s_cmp_lg_u32 s75, 0
    s_cbranch_scc1 L_far3
    buffer_store_dwordx2 v[28:29], off, s[12:15], s25 offset:8
    s_branch L_near3
L_far3:
    buffer_store_dwordx2 v[28:29], off, s[12:15], s25 offset:8 sc1
L_near3:
    s_mov_b64 exec, -1
L_BV_c1:
    s_cmp_ge_u32 s27, 1
    s_cselect_b32 s71, s3, 4
    s_cmp_lg_u32 s71, 0
    s_cbranch_scc1 L_BV_p0
    s_lshl_b32 s24, s27, 2
    s_add_u32 s24, s24, 0
    s_mov_b64 exec, 1
    v_mov_b32 v63, s24
    s_cmp_lg_u32 s75, 0
    s_cbranch_scc1 L_far4
    buffer_store_dword v63, off, s[12:15], s34 offset:64
    s_branch L_near4
L_far4:
    buffer_store_dword v63, off, s[12:15], s34 offset:64 sc1
L_near4:
    s_mov_b64 exec, -1
L_BV_p0:
    v_and_b32_dpp v8, v48, v20 row_newbcast:0 row_mask:0xf bank_mask:0xf
    v_and_b32_dpp v9, v48, v21 row_newbcast:0 row_mask:0xf bank_mask:0xf
    v_and_b32_dpp v10, v48, v22 row_newbcast:0 row_mask:0xf bank_mask:0xf
    v_and_b32_dpp v11, v48, v23 row_newbcast:0 row_mask:0xf bank_mask:0xf
    s_waitcnt vmcnt(15)
    s_nop 0
    v_mfma_f32_16x16x32_bf16 v[12:15], v[64:67], v[8:11], v[12:15]
    buffer_load_dwordx4 v[64:67], v1, s[4:7], s32 offen offset:0 nt
    s_add_u32 s32, s32, 6144
    v_and_b32_dpp v8, v48, v20 row_newbcast:4 row_mask:0xf bank_mask:0xf
    v_and_b32_dpp v9, v48, v21 row_newbcast:4 row_mask:0xf bank_mask:0xf
    v_and_b32_dpp v10, v48, v22 row_newbcast:4 row_mask:0xf bank_mask:0xf
    v_and_b32_dpp v11, v48, v23 row_newbcast:4 row_mask:0xf bank_mask:0xf
    s_waitcnt vmcnt(15)
    s_nop 0
    v_mfma_f32_16x16x32_bf16 v[12:15], v[68:71], v[8:11], v[12:15]
    buffer_load_dwordx4 v[68:71], v1, s[4:7], s32 offen offset:0 nt
    s_add_u32 s32, s32, 6144
    v_and_b32_dpp v8, v48, v20 row_newbcast:8 row_mask:0xf bank_mask:0xf
    v_and_b32_dpp v9, v48, v21 row_newbcast:8 row_mask:0xf bank_mask:0xf
    v_and_b32_dpp v10, v48, v22 row_newbcast:8 row_mask:0xf bank_mask:0xf
    v_and_b32_dpp v11, v48, v23 row_newbcast:8 row_mask:0xf bank_mask:0xf
    s_waitcnt vmcnt(15)
    s_nop 0
    v_mfma_f32_16x16x32_bf16 v[12:15], v[72:75], v[8:11], v[12:15]
    buffer_load_dwordx4 v[72:75], v1, s[4:7], s32 offen offset:0 nt
    s_add_u32 s32, s32, 6144
    v_and_b32_dpp v8, v48, v20 row_newbcast:12 row_mask:0xf bank_mask:0xf
    v_and_b32_dpp v9, v48, v21 row_newbcast:12 row_mask:0xf bank_mask:0xf
    v_and_b32_dpp v10, v48, v22 row_newbcast:12 row_mask:0xf bank_mask:0xf
    v_and_b32_dpp v11, v48, v23 row_newbcast:12 row_mask:0xf bank_mask:0xf
    s_waitcnt vmcnt(15)
    s_nop 0
    v_mfma_f32_16x16x32_bf16 v[12:15], v[76:79], v[8:11], v[12:15]
    buffer_load_dwordx4 v[76:79], v1, s[4:7], s32 offen offset:0 nt
    s_add_u32 s32, s32, 6144
    s_cmp_lg_u32 s71, 1
    s_cbranch_scc1 L_BV_p1
    s_lshl_b32 s24, s27, 2
    s_add_u32 s24, s24, 1
    s_mov_b64 exec, 1
    v_mov_b32 v63, s24
    s_cmp_lg_u32 s75, 0
    s_cbranch_scc1 L_far5
    buffer_store_dword v63, off, s[12:15], s34 offset:64
    s_branch L_near5
L_far5:
    buffer_store_dword v63, off, s[12:15], s34 offset:64 sc1
L_near5:
    s_mov_b64 exec, -1
L_BV_p1:
    v_and_b32_dpp v8, v48, v20 row_newbcast:1 row_mask:0xf bank_mask:0xf
    v_and_b32_dpp v9, v48, v21 row_newbcast:1 row_mask:0xf bank_mask:0xf
    v_and_b32_dpp v10, v48, v22 row_newbcast:1 row_mask:0xf bank_mask:0xf
    v_and_b32_dpp v11, v48, v23 row_newbcast:1 row_mask:0xf bank_mask:0xf
    s_waitcnt vmcnt(15)
    s_nop 0
    v_mfma_f32_16x16x32_bf16 v[12:15], v[80:83], v[8:11], v[12:15]
    buffer_load_dwordx4 v[80:83], v1, s[4:7], s32 offen offset:0 nt
    s_add_u32 s32, s32, 6144
    v_and_b32_dpp v8, v48, v20 row_newbcast:5 row_mask:0xf bank_mask:0xf
    v_and_b32_dpp v9, v48, v21 row_newbcast:5 row_mask:0xf bank_mask:0xf
    v_and_b32_dpp v10, v48, v22 row_newbcast:5 row_mask:0xf bank_mask:0xf
    v_and_b32_dpp v11, v48, v23 row_newbcast:5 row_mask:0xf bank_mask:0xf
    s_waitcnt vmcnt(15)
    s_nop 0
    v_mfma_f32_16x16x32_bf16 v[12:15], v[84:87], v[8:11], v[12:15]
    buffer_load_dwordx4 v[84:87], v1, s[4:7], s32 offen offset:0 nt
    s_add_u32 s32, s32, 6144
    v_and_b32_dpp v8, v48, v20 row_newbcast:9 row_mask:0xf bank_mask:0xf
    v_and_b32_dpp v9, v48, v21 row_newbcast:9 row_mask:0xf bank_mask:0xf
    v_and_b32_dpp v10, v48, v22 row_newbcast:9 row_mask:0xf bank_mask:0xf
    v_and_b32_dpp v11, v48, v23 row_newbcast:9 row_mask:0xf bank_mask:0xf
    s_waitcnt vmcnt(15)
    s_nop 0
    v_mfma_f32_16x16x32_bf16 v[12:15], v[88:91], v[8:11], v[12:15]
    buffer_load_dwordx4 v[88:91], v1, s[4:7], s32 offen offset:0 nt
    s_add_u32 s32, s32, 6144
    v_and_b32_dpp v8, v48, v20 row_newbcast:13 row_mask:0xf bank_mask:0xf
    v_and_b32_dpp v9, v48, v21 row_newbcast:13 row_mask:0xf bank_mask:0xf
    v_and_b32_dpp v10, v48, v22 row_newbcast:13 row_mask:0xf bank_mask:0xf
    v_and_b32_dpp v11, v48, v23 row_newbcast:13 row_mask:0xf bank_mask:0xf
    s_waitcnt vmcnt(15)
    s_nop 0
    v_mfma_f32_16x16x32_bf16 v[12:15], v[92:95], v[8:11], v[12:15]
    buffer_load_dwordx4 v[92:95], v1, s[4:7], s32 offen offset:0 nt
    s_add_u32 s32, s32, 6144
    s_cmp_lg_u32 s71, 2
    s_cbranch_scc1 L_BV_p2
    s_lshl_b32 s24, s27, 2
    s_add_u32 s24, s24, 2
    s_mov_b64 exec, 1
    v_mov_b32 v63, s24
    s_cmp_lg_u32 s75, 0
    s_cbranch_scc1 L_far6
    buffer_store_dword v63, off, s[12:15], s34 offset:64
    s_branch L_near6
L_far6:
    buffer_store_dword v63, off, s[12:15], s34 offset:64 sc1
L_near6:
    s_mov_b64 exec, -1
L_BV_p2:
    v_and_b32_dpp v8, v48, v20 row_newbcast:2 row_mask:0xf bank_mask:0xf
    v_and_b32_dpp v9, v48, v21 row_newbcast:2 row_mask:0xf bank_mask:0xf
    v_and_b32_dpp v10, v48, v22 row_newbcast:2 row_mask:0xf bank_mask:0xf
    v_and_b32_dpp v11, v48, v23 row_newbcast:2 row_mask:0xf bank_mask:0xf
    s_waitcnt vmcnt(15)
    s_nop 0
    v_mfma_f32_16x16x32_bf16 v[12:15], v[96:99], v[8:11], v[12:15]
    buffer_load_dwordx4 v[96:99], v1, s[4:7], s32 offen offset:0 nt
    s_add_u32 s32, s32, 6144
    v_and_b32_dpp v8, v48, v20 row_newbcast:6 row_mask:0xf bank_mask:0xf
    v_and_b32_dpp v9, v48, v21 row_newbcast:6 row_mask:0xf bank_mask:0xf
    v_and_b32_dpp v10, v48, v22 row_newbcast:6 row_mask:0xf bank_mask:0xf
    v_and_b32_dpp v11, v48, v23 row_newbcast:6 row_mask:0xf bank_mask:0xf
    s_waitcnt vmcnt(15)
    s_nop 0
    v_mfma_f32_16x16x32_bf16 v[12:15], v[100:103], v[8:11], v[12:15]
    buffer_load_dwordx4 v[100:103], v1, s[4:7], s32 offen offset:0 nt
    s_add_u32 s32, s32, 6144
    s_cmp_eq_u32 s27, 9
    s_cbranch_scc1 L_BT
    v_and_b32_dpp v8, v48, v20 row_newbcast:10 row_mask:0xf bank_mask:0xf
    v_and_b32_dpp v9, v48, v21 row_newbcast:10 row_mask:0xf bank_mask:0xf
    v_and_b32_dpp v10, v48, v22 row_newbcast:10 row_mask:0xf bank_mask:0xf
    v_and_b32_dpp v11, v48, v23 row_newbcast:10 row_mask:0xf bank_mask:0xf
    s_waitcnt vmcnt(15)
    s_nop 0
    v_mfma_f32_16x16x32_bf16 v[12:15], v[104:107], v[8:11], v[12:15]
    buffer_load_dwordx4 v[104:107], v1, s[4:7], s32 offen offset:0 nt
    s_add_u32 s32, s32, 6144
    v_and_b32_dpp v8, v48, v20 row_newbcast:14 row_mask:0xf bank_mask:0xf
    v_and_b32_dpp v9, v48, v21 row_newbcast:14 row_mask:0xf bank_mask:0xf
    v_and_b32_dpp v10, v48, v22 row_newbcast:14 row_mask:0xf bank_mask:0xf
    v_and_b32_dpp v11, v48, v23 row_newbcast:14 row_mask:0xf bank_mask:0xf
    s_waitcnt vmcnt(15)
    s_nop 0
    v_mfma_f32_16x16x32_bf16 v[12:15], v[108:111], v[8:11], v[12:15]
    buffer_load_dwordx4 v[108:111], v1, s[4:7], s32 offen offset:0 nt
    s_add_u32 s32, s32, 6144
    s_cmp_lg_u32 s71, 3
    s_cbranch_scc1 L_BV_p3
    s_lshl_b32 s24, s27, 2
    s_add_u32 s24, s24, 3
    s_mov_b64 exec, 1
    v_mov_b32 v63, s24
    s_cmp_lg_u32 s75, 0
    s_cbranch_scc1 L_far7
    buffer_store_dword v63, off, s[12:15], s34 offset:64
    s_branch L_near7
L_far7:
    buffer_store_dword v63, off, s[12:15], s34 offset:64 sc1
L_near7:
    s_mov_b64 exec, -1
L_BV_p3:
    v_and_b32_dpp v8, v48, v20 row_newbcast:3 row_mask:0xf bank_mask:0xf
    v_and_b32_dpp v9, v48, v21 row_newbcast:3 row_mask:0xf bank_mask:0xf
    v_and_b32_dpp v10, v48, v22 row_newbcast:3 row_mask:0xf bank_mask:0xf
    v_and_b32_dpp v11, v48, v23 row_newbcast:3 row_mask:0xf bank_mask:0xf
    s_waitcnt vmcnt(15)
    s_nop 0
    v_mfma_f32_16x16x32_bf16 v[12:15], v[112:115], v[8:11], v[12:15]
    buffer_load_dwordx4 v[112:115], v1, s[4:7], s32 offen offset:0 nt
    s_add_u32 s32, s32, 6144
    s_cmp_lg_u32 s27, 0
    s_cbranch_scc1 L_BV_d
    v_fma_f32 v49, v49, v61, -v6
    v_fma_f32 v50, v50, v61, -v6
    v_fma_f32 v51, v51, v61, -v6
    v_fma_f32 v52, v52, v61, -v6
    v_fma_f32 v53, v53, v61, -v6
    v_fma_f32 v54, v54, v61, -v6
    v_fma_f32 v55, v55, v61, -v6
    v_fma_f32 v56, v56, v61, -v6
    v_fma_f32 v57, v57, v61, -v6
    v_fma_f32 v58, v58, v61, -v6
    v_exp_f32 v49, v49
    v_exp_f32 v50, v50
    v_exp_f32 v51, v51
    v_exp_f32 v52, v52
    v_exp_f32 v53, v53
    v_exp_f32 v54, v54
    v_exp_f32 v55, v55
    v_exp_f32 v56, v56
    v_exp_f32 v57, v57
    v_exp_f32 v58, v58
    v_add_f32 v7, v7, v49
    v_add_f32 v7, v7, v50
    v_add_f32 v7, v7, v51
    v_add_f32 v7, v7, v52
    v_add_f32 v7, v7, v53
    v_add_f32 v7, v7, v54
    v_add_f32 v7, v7, v55
    v_add_f32 v7, v7, v56
    v_add_f32 v7, v7, v57
    v_add_f32 v7, v7, v58
    v_cvt_pk_bf16_f32 v49, v49, v49
    v_cvt_pk_bf16_f32 v50, v50, v50
    v_cvt_pk_bf16_f32 v51, v51, v51
    v_cvt_pk_bf16_f32 v52, v52, v52
    v_cvt_pk_bf16_f32 v53, v53, v53
    v_cvt_pk_bf16_f32 v54, v54, v54
    v_cvt_pk_bf16_f32 v55, v55, v55
    v_cvt_pk_bf16_f32 v56, v56, v56
    v_cvt_pk_bf16_f32 v57, v57, v57
    v_cvt_pk_bf16_f32 v58, v58, v58
    v_add_f32_dpp v7, v7, v7 row_ror:8 row_mask:0xf bank_mask:0xf
    s_nop 1
    v_add_f32_dpp v7, v7, v7 row_ror:4 row_mask:0xf bank_mask:0xf
    s_nop 1
    v_add_f32_dpp v7, v7, v7 row_ror:2 row_mask:0xf bank_mask:0xf
    s_nop 1
    v_add_f32_dpp v7, v7, v7 row_ror:1 row_mask:0xf bank_mask:0xf
    s_nop 1
    v_add_f32_dpp v7, v7, v7 row_bcast:15 row_mask:0xa bank_mask:0xf
    s_nop 1
    v_add_f32_dpp v7, v7, v7 row_bcast:31 row_mask:0xc bank_mask:0xf
    s_nop 0
    v_readlane_b32 s70, v7, 63
    s_lshl_b32 s25, s3, 4
    s_add_u32 s25, s25, s34
    s_mov_b64 exec, 1
    v_mov_b32 v7, s70
    s_cmp_lg_u32 s75, 0
    s_cbranch_scc1 L_far8
    buffer_store_dwordx2 v[6:7], off, s[12:15], s25
    s_branch L_near8
L_far8:
    buffer_store_dwordx2 v[6:7], off, s[12:15], s25 sc1
L_near8:
    s_mov_b64 exec, -1
L_BV_d:
    v_and_b32_dpp v8, v48, v20 row_newbcast:7 row_mask:0xf bank_mask:0xf
    v_and_b32_dpp v9, v48, v21 row_newbcast:7 row_mask:0xf bank_mask:0xf
    v_and_b32_dpp v10, v48, v22 row_newbcast:7 row_mask:0xf bank_mask:0xf
    v_and_b32_dpp v11, v48, v23 row_newbcast:7 row_mask:0xf bank_mask:0xf
    s_waitcnt vmcnt(15)
    s_nop 0
    v_mfma_f32_16x16x32_bf16 v[12:15], v[116:119], v[8:11], v[12:15]
    buffer_load_dwordx4 v[116:119], v1, s[4:7], s32 offen offset:0 nt
    s_add_u32 s32, s32, 6144
    v_and_b32_dpp v8, v48, v20 row_newbcast:11 row_mask:0xf bank_mask:0xf
    v_and_b32_dpp v9, v48, v21 row_newbcast:11 row_mask:0xf bank_mask:0xf
    v_and_b32_dpp v10, v48, v22 row_newbcast:11 row_mask:0xf bank_mask:0xf
    v_and_b32_dpp v11, v48, v23 row_newbcast:11 row_mask:0xf bank_mask:0xf
    s_waitcnt vmcnt(15)
    s_nop 0
    v_mfma_f32_16x16x32_bf16 v[12:15], v[120:123], v[8:11], v[12:15]
    buffer_load_dwordx4 v[120:123], v1, s[4:7], s32 offen offset:0 nt
    s_add_u32 s32, s32, 6144
    v_and_b32_dpp v8, v48, v20 row_newbcast:15 row_mask:0xf bank_mask:0xf
    v_and_b32_dpp v9, v48, v21 row_newbcast:15 row_mask:0xf bank_mask:0xf
    v_and_b32_dpp v10, v48, v22 row_newbcast:15 row_mask:0xf bank_mask:0xf
    v_and_b32_dpp v11, v48, v23 row_newbcast:15 row_mask:0xf bank_mask:0xf
    s_waitcnt vmcnt(15)
    s_nop 0
    v_mfma_f32_16x16x32_bf16 v[12:15], v[124:127], v[8:11], v[12:15]
    buffer_load_dwordx4 v[124:127], v1, s[4:7], s32 offen offset:0 nt
    s_add_u32 s32, s32, 6144
    v_mov_b32 v48, v49
    v_mov_b32 v49, v50
    v_mov_b32 v50, v51
    v_mov_b32 v51, v52
    v_mov_b32 v52, v53
    v_mov_b32 v53, v54
    v_mov_b32 v54, v55
    v_mov_b32 v55, v56
    v_mov_b32 v56, v57
    v_mov_b32 v57, v58
    s_add_u32 s27, s27, 1
    s_branch L_BV
L_BT:
    v_and_b32_dpp v8, v48, v20 row_newbcast:10 row_mask:0xf bank_mask:0xf
    v_and_b32_dpp v9, v48, v21 row_newbcast:10 row_mask:0xf bank_mask:0xf
    v_and_b32_dpp v10, v48, v22 row_newbcast:10 row_mask:0xf bank_mask:0xf
    v_and_b32_dpp v11, v48, v23 row_newbcast:10 row_mask:0xf bank_mask:0xf
    s_waitcnt vmcnt(15)
    s_nop 0
    v_mfma_f32_16x16x32_bf16 v[12:15], v[104:107], v[8:11], v[12:15]
    buffer_load_dwordx4 v[104:107], v1, s[4:7], s28 offen offset:0 nt
    v_and_b32_dpp v8, v48, v20 row_newbcast:14 row_mask:0xf bank_mask:0xf
    v_and_b32_dpp v9, v48, v21 row_newbcast:14 row_mask:0xf bank_mask:0xf
    v_and_b32_dpp v10, v48, v22 row_newbcast:14 row_mask:0xf bank_mask:0xf
    v_and_b32_dpp v11, v48, v23 row_newbcast:14 row_mask:0xf bank_mask:0xf
    s_waitcnt vmcnt(15)
    s_nop 0
    v_mfma_f32_16x16x32_bf16 v[12:15], v[108:111], v[8:11], v[12:15]
    v_and_b32_dpp v8, v48, v20 row_newbcast:3 row_mask:0xf bank_mask:0xf
    v_and_b32_dpp v9, v48, v21 row_newbcast:3 row_mask:0xf bank_mask:0xf
    v_and_b32_dpp v10, v48, v22 row_newbcast:3 row_mask:0xf bank_mask:0xf
    v_and_b32_dpp v11, v48, v23 row_newbcast:3 row_mask:0xf bank_mask:0xf
    s_waitcnt vmcnt(14)
    s_nop 0
    v_mfma_f32_16x16x32_bf16 v[12:15], v[112:115], v[8:11], v[12:15]
    v_and_b32_dpp v8, v48, v20 row_newbcast:7 row_mask:0xf bank_mask:0xf
    v_and_b32_dpp v9, v48, v21 row_newbcast:7 row_mask:0xf bank_mask:0xf
    v_and_b32_dpp v10, v48, v22 row_newbcast:7 row_mask:0xf bank_mask:0xf
    v_and_b32_dpp v11, v48, v23 row_newbcast:7 row_mask:0xf bank_mask:0xf
    s_waitcnt vmcnt(13)
    s_nop 0
    v_mfma_f32_16x16x32_bf16 v[12:15], v[116:119], v[8:11], v[12:15]
    v_and_b32_dpp v8, v48, v20 row_newbcast:11 row_mask:0xf bank_mask:0xf
    v_and_b32_dpp v9, v48, v21 row_newbcast:11 row_mask:0xf bank_mask:0xf
    v_and_b32_dpp v10, v48, v22 row_newbcast:11 row_mask:0xf bank_mask:0xf
    v_and_b32_dpp v11, v48, v23 row_newbcast:11 row_mask:0xf bank_mask:0xf
    s_waitcnt vmcnt(12)
    s_nop 0
    v_mfma_f32_16x16x32_bf16 v[12:15], v[120:123], v[8:11], v[12:15]
    v_and_b32_dpp v8, v48, v20 row_newbcast:15 row_mask:0xf bank_mask:0xf
    v_and_b32_dpp v9, v48, v21 row_newbcast:15 row_mask:0xf bank_mask:0xf
    v_and_b32_dpp v10, v48, v22 row_newbcast:15 row_mask:0xf bank_mask:0xf
    v_and_b32_dpp v11, v48, v23 row_newbcast:15 row_mask:0xf bank_mask:0xf
    s_waitcnt vmcnt(11)
    s_nop 0
    v_mfma_f32_16x16x32_bf16 v[12:15], v[124:127], v[8:11], v[12:15]
    v_and_b32_dpp v8, v49, v20 row_newbcast:0 row_mask:0xf bank_mask:0xf
    v_and_b32_dpp v9, v49, v21 row_newbcast:0 row_mask:0xf bank_mask:0xf
    v_and_b32_dpp v10, v49, v22 row_newbcast:0 row_mask:0xf bank_mask:0xf
    v_and_b32_dpp v11, v49, v23 row_newbcast:0 row_mask:0xf bank_mask:0xf
    s_waitcnt vmcnt(10)
    s_nop 0
    v_mfma_f32_16x16x32_bf16 v[12:15], v[64:67], v[8:11], v[12:15]
    v_and_b32_dpp v8, v49, v20 row_newbcast:4 row_mask:0xf bank_mask:0xf
    v_and_b32_dpp v9, v49, v21 row_newbcast:4 row_mask:0xf bank_mask:0xf
    v_and_b32_dpp v10, v49, v22 row_newbcast:4 row_mask:0xf bank_mask:0xf
    v_and_b32_dpp v11, v49, v23 row_newbcast:4 row_mask:0xf bank_mask:0xf
    s_waitcnt vmcnt(9)
    s_nop 0
    v_mfma_f32_16x16x32_bf16 v[12:15], v[68:71], v[8:11], v[12:15]
    v_and_b32_dpp v8, v49, v20 row_newbcast:8 row_mask:0xf bank_mask:0xf
    v_and_b32_dpp v9, v49, v21 row_newbcast:8 row_mask:0xf bank_mask:0xf
    v_and_b32_dpp v10, v49, v22 row_newbcast:8 row_mask:0xf bank_mask:0xf
    v_and_b32_dpp v11, v49, v23 row_newbcast:8 row_mask:0xf bank_mask:0xf
    s_waitcnt vmcnt(8)
    s_nop 0
    v_mfma_f32_16x16x32_bf16 v[12:15], v[72:75], v[8:11], v[12:15]
    v_and_b32_dpp v8, v49, v20 row_newbcast:12 row_mask:0xf bank_mask:0xf
    v_and_b32_dpp v9, v49, v21 row_newbcast:12 row_mask:0xf bank_mask:0xf
    v_and_b32_dpp v10, v49, v22 row_newbcast:12 row_mask:0xf bank_mask:0xf
    v_and_b32_dpp v11, v49, v23 row_newbcast:12 row_mask:0xf bank_mask:0xf
    s_waitcnt vmcnt(7)
    s_nop 0
    v_mfma_f32_16x16x32_bf16 v[12:15], v[76:79], v[8:11], v[12:15]
    v_and_b32_dpp v8, v49, v20 row_newbcast:1 row_mask:0xf bank_mask:0xf
    v_and_b32_dpp v9, v49, v21 row_newbcast:1 row_mask:0xf bank_mask:0xf
    v_and_b32_dpp v10, v49, v22 row_newbcast:1 row_mask:0xf bank_mask:0xf
    v_and_b32_dpp v11, v49, v23 row_newbcast:1 row_mask:0xf bank_mask:0xf
    s_waitcnt vmcnt(6)
    s_nop 0
    v_mfma_f32_16x16x32_bf16 v[12:15], v[80:83], v[8:11], v[12:15]
    v_and_b32_dpp v8, v49, v20 row_newbcast:5 row_mask:0xf bank_mask:0xf
    v_and_b32_dpp v9, v49, v21 row_newbcast:5 row_mask:0xf bank_mask:0xf
    v_and_b32_dpp v10, v49, v22 row_newbcast:5 row_mask:0xf bank_mask:0xf
    v_and_b32_dpp v11, v49, v23 row_newbcast:5 row_mask:0xf bank_mask:0xf
    s_waitcnt vmcnt(5)
    s_nop 0
    v_mfma_f32_16x16x32_bf16 v[12:15], v[84:87], v[8:11], v[12:15]
    v_and_b32_dpp v8, v49, v20 row_newbcast:9 row_mask:0xf bank_mask:0xf
    v_and_b32_dpp v9, v49, v21 row_newbcast:9 row_mask:0xf bank_mask:0xf
    v_and_b32_dpp v10, v49, v22 row_newbcast:9 row_mask:0xf bank_mask:0xf
    v_and_b32_dpp v11, v49, v23 row_newbcast:9 row_mask:0xf bank_mask:0xf
    s_waitcnt vmcnt(4)
    s_nop 0
    v_mfma_f32_16x16x32_bf16 v[12:15], v[88:91], v[8:11], v[12:15]
    v_and_b32_dpp v8, v49, v20 row_newbcast:13 row_mask:0xf bank_mask:0xf
    v_and_b32_dpp v9, v49, v21 row_newbcast:13 row_mask:0xf bank_mask:0xf
    v_and_b32_dpp v10, v49, v22 row_newbcast:13 row_mask:0xf bank_mask:0xf
    v_and_b32_dpp v11, v49, v23 row_newbcast:13 row_mask:0xf bank_mask:0xf
    s_waitcnt vmcnt(3)
    s_nop 0
    v_mfma_f32_16x16x32_bf16 v[12:15], v[92:95], v[8:11], v[12:15]
    v_and_b32_dpp v8, v49, v20 row_newbcast:2 row_mask:0xf bank_mask:0xf
    v_and_b32_dpp v9, v49, v21 row_newbcast:2 row_mask:0xf bank_mask:0xf
    v_and_b32_dpp v10, v49, v22 row_newbcast:2 row_mask:0xf bank_mask:0xf
    v_and_b32_dpp v11, v49, v23 row_newbcast:2 row_mask:0xf bank_mask:0xf
    s_waitcnt vmcnt(2)
    s_nop 0
    v_mfma_f32_16x16x32_bf16 v[12:15], v[96:99], v[8:11], v[12:15]
    v_and_b32_dpp v8, v49, v20 row_newbcast:6 row_mask:0xf bank_mask:0xf
    v_and_b32_dpp v9, v49, v21 row_newbcast:6 row_mask:0xf bank_mask:0xf
    v_and_b32_dpp v10, v49, v22 row_newbcast:6 row_mask:0xf bank_mask:0xf
    v_and_b32_dpp v11, v49, v23 row_newbcast:6 row_mask:0xf bank_mask:0xf
    s_waitcnt vmcnt(1)
    s_nop 0
    v_mfma_f32_16x16x32_bf16 v[12:15], v[100:103], v[8:11], v[12:15]
    v_and_b32_dpp v8, v49, v20 row_newbcast:10 row_mask:0xf bank_mask:0xf
    v_and_b32_dpp v9, v49, v21 row_newbcast:10 row_mask:0xf bank_mask:0xf
    v_and_b32_dpp v10, v49, v22 row_newbcast:10 row_mask:0xf bank_mask:0xf
    v_and_b32_dpp v11, v49, v23 row_newbcast:10 row_mask:0xf bank_mask:0xf
    s_waitcnt vmcnt(0)
    s_nop 0
    v_mfma_f32_16x16x32_bf16 v[12:15], v[104:107], v[8:11], v[12:15]
    s_mov_b32 exec_lo, 0x00ff00ff
    s_mov_b32 exec_hi, 0x00ff00ff
    s_cmp_lg_u32 s75, 0
    s_nop 4
    v_cvt_pk_bf16_f32 v4, v12, v13
    v_cvt_pk_bf16_f32 v5, v14, v15
    s_cbranch_scc1 L_far9
    buffer_store_dwordx2 v[4:5], v60, s[12:15], s73 offen
    s_branch L_near9
L_far9:
    buffer_store_dwordx2 v[4:5], v60, s[12:15], s73 offen sc1
L_near9:
    s_endpgm
L_A:
    v_lshrrev_b32 v1, 6, v0
    v_and_b32 v0, 63, v0
    v_readfirstlane_b32 s3, v1
    v_lshlrev_b32 v2, 4, v0
    s_mov_b32 s74, s2
    s_and_b32 s72, s2, 31
    s_and_b32 s70, s2, 6
    s_and_b32 s25, s2, 7
    s_add_u32 s70, s70, s25
    s_lshr_b32 s26, s72, 3
    s_and_b32 s25, s26, 1
    s_lshl_b32 s25, s25, 1
    s_and_b32 s26, s26, 2
    s_lshl_b32 s26, s26, 3
    s_or_b32 s26, s26, s25
    s_or_b32 s26, s26, s70
    v_lshrrev_b32 v3, 4, v0
    v_and_b32 v4, 15, v0
    v_lshlrev_b32 v18, 18, v3
    v_lshl_add_u32 v18, v4, 4, v18
    v_lshrrev_b32 v6, 3, v4
    v_lshlrev_b32 v6, 10, v6
    v_lshl_add_u32 v19, v3, 6, v6
    v_bfe_u32 v1, v0, 2, 2
    v_lshlrev_b32 v64, 18, v1
    v_lshl_add_u32 v64, v3, 6, v64
    v_and_b32 v4, 3, v0
    v_lshl_add_u32 v64, v4, 4, v64
    v_lshlrev_b32 v65, 9, v1
    v_lshl_add_u32 v65, v3, 7, v65
    v_lshl_add_u32 v65, v4, 5, v65
    v_add_u32 v65, 135168, v65
    v_lshlrev_b32 v66, 17, v1
    v_lshl_add_u32 v66, v3, 6, v66
    v_lshl_add_u32 v66, v4, 4, v66
    v_and_b32 v4, 15, v0
    v_lshlrev_b32 v67, 10, v3
    v_lshl_add_u32 v67, v4, 4, v67
    s_lshl_b32 s35, s3, 20
    s_lshl_b32 s24, s26, 8
    s_add_u32 s35, s35, s24
    s_waitcnt lgkmcnt(0)
    s_cmp_lt_u32 s74, 32
    s_cselect_b64 s[4:5], s[40:41], s[54:55]
    s_mov_b32 s6, 0x400000
    s_mov_b32 s7, 0x20000
    s_cselect_b64 s[20:21], s[36:37], s[48:49]
    s_mov_b32 s22, 4096
    s_mov_b32 s23, 0x20000
    s_cselect_b32 s75, 0x400000, 0
    s_lshl_b32 s24, s3, 8
    s_mov_b32 s32, s35
    buffer_load_dwordx4 v[12:15], v67, s[20:23], s24 offen
    buffer_load_dwordx4 v[128:131], v18, s[4:7], s32 offen
    s_add_u32 s32, s32, 8192
    buffer_load_dwordx4 v[132:135], v18, s[4:7], s32 offen
    s_add_u32 s32, s32, 8192
    buffer_load_dwordx4 v[136:139], v18, s[4:7], s32 offen
    s_add_u32 s32, s32, 8192
    buffer_load_dwordx4 v[140:143], v18, s[4:7], s32 offen
    s_add_u32 s32, s32, 8192
    buffer_load_dwordx4 v[144:147], v18, s[4:7], s32 offen
    s_add_u32 s32, s32, 8192
    buffer_load_dwordx4 v[148:151], v18, s[4:7], s32 offen
    s_add_u32 s32, s32, 8192
    buffer_load_dwordx4 v[152:155], v18, s[4:7], s32 offen
    s_add_u32 s32, s32, 8192
    buffer_load_dwordx4 v[156:159], v18, s[4:7], s32 offen
    s_add_u32 s32, s32, 8192
    buffer_load_dwordx4 v[160:163], v18, s[4:7], s32 offen
    s_add_u32 s32, s32, 8192
    buffer_load_dwordx4 v[164:167], v18, s[4:7], s32 offen
    s_add_u32 s32, s32, 8192
    buffer_load_dwordx4 v[168:171], v18, s[4:7], s32 offen
    s_add_u32 s32, s32, 8192
    buffer_load_dwordx4 v[172:175], v18, s[4:7], s32 offen
    s_add_u32 s32, s32, 8192
    s_mov_b32 s12, s62
    s_mov_b32 s13, s63
    s_mov_b32 s14, 0x600000
    s_mov_b32 s15, 0x20000
    s_mov_b32 s16, s60
    s_mov_b32 s17, s61
    s_mov_b32 s18, 0x100
    s_mov_b32 s19, 0x20000
    v_and_b32 v3, 1, v0
    v_lshlrev_b32 v3, 4, v3
    v_mov_b32 v4, 0xffff
    v_lshlrev_b32 v4, v3, v4
    v_bfe_u32 v3, v0, 1, 2
    v_cmp_eq_u32 vcc, 0, v3
    s_nop 1
    v_cndmask_b32 v20, 0, v4, vcc
    v_cmp_eq_u32 vcc, 1, v3
    s_nop 1
    v_cndmask_b32 v21, 0, v4, vcc
    v_cmp_eq_u32 vcc, 2, v3
    s_nop 1
    v_cndmask_b32 v22, 0, v4, vcc
    v_cmp_eq_u32 vcc, 3, v3
    s_nop 1
    v_cndmask_b32 v23, 0, v4, vcc
    v_mov_b32 v3, 0x0c0c0c0c
    s_mov_b32 s24, 0x01000100
    s_mov_b32 s25, 0x03020302
    v_bfi_b32 v24, v20, s24, v3
    v_bfi_b32 v28, v20, s25, v3
    v_bfi_b32 v25, v21, s24, v3
    v_bfi_b32 v29, v21, s25, v3
    v_bfi_b32 v26, v22, s24, v3
    v_bfi_b32 v30, v22, s25, v3
    v_bfi_b32 v27, v23, s24, v3
    v_bfi_b32 v31, v23, s25, v3
    s_mov_b32 s64, 0x22222222
    s_mov_b32 s65, 0x22222222
    s_mov_b32 s66, 0x44444444
    s_mov_b32 s67, 0x44444444
    s_mov_b32 s68, 0x88888888
    s_mov_b32 s69, 0x88888888
    s_lshl_b32 s24, s3, 8
    s_add_u32 s24, s24, 145408
    v_add_u32 v3, s24, v67
    v_add_u32 v4, s24, v19
    s_waitcnt vmcnt(12)
    ds_write_b128 v3, v[12:15]
    s_waitcnt lgkmcnt(0)
    ds_read_b128 v[32:35], v4 offset:0
    ds_read_b128 v[36:39], v4 offset:16
    ds_read_b128 v[40:43], v4 offset:32
    ds_read_b128 v[44:47], v4 offset:48
    ds_read_b128 v[48:51], v4 offset:2048
    ds_read_b128 v[52:55], v4 offset:2064
    ds_read_b128 v[56:59], v4 offset:2080
    ds_read_b128 v[60:63], v4 offset:2096
    s_waitcnt lgkmcnt(0)
    v_mov_b32 v76, -1
    v_mov_b32 v77, -1
    v_mov_b32 v78, -1
    v_mov_b32 v79, -1
    s_lshl_b32 s71, s72, 2
    s_add_u32 s71, s71, s3
    s_lshl_b32 s71, s71, 12
    s_add_u32 s71, s71, 0x1c0000
    s_cmp_lt_u32 s74, 32
    s_cselect_b32 s71, 0x600000, s71
    v_perm_b32 v8, v32, v32, v24
    v_perm_b32 v9, v32, v32, v25
    v_perm_b32 v10, v32, v32, v26
    v_perm_b32 v11, v32, v32, v27
    v_perm_b32 v4, v48, v48, v24
    v_perm_b32 v5, v48, v48, v25
    v_perm_b32 v6, v48, v48, v26
    v_perm_b32 v7, v48, v48, v27
    s_waitcnt vmcnt(11)
    v_mfma_f32_16x16x32_bf16 v[12:15], v[128:131], v[8:11], 0
    v_mfma_f32_16x16x32_bf16 v[68:71], v[128:131], v[4:7], 0
    buffer_load_dwordx4 v[176:179], v18, s[4:7], s32 offen nt
    s_add_u32 s32, s32, 8192
    v_perm_b32 v8, v32, v32, v28
    v_perm_b32 v9, v32, v32, v29
    v_perm_b32 v10, v32, v32, v30
    v_perm_b32 v11, v32, v32, v31
    v_perm_b32 v4, v48, v48, v28
    v_perm_b32 v5, v48, v48, v29
    v_perm_b32 v6, v48, v48, v30
    v_perm_b32 v7, v48, v48, v31
    s_waitcnt vmcnt(11)
    v_mfma_f32_16x16x32_bf16 v[12:15], v[132:135], v[8:11], v[12:15]
    v_mfma_f32_16x16x32_bf16 v[68:71], v[132:135], v[4:7], v[68:71]
    buffer_load_dwordx4 v[180:183], v18, s[4:7], s32 offen nt
    s_add_u32 s32, s32, 8192
    v_perm_b32 v8, v33, v33, v24
    v_perm_b32 v9, v33, v33, v25
    v_perm_b32 v10, v33, v33, v26
    v_perm_b32 v11, v33, v33, v27
    v_perm_b32 v4, v49, v49, v24
    v_perm_b32 v5, v49, v49, v25
    v_perm_b32 v6, v49, v49, v26
    v_perm_b32 v7, v49, v49, v27
    s_waitcnt vmcnt(11)
    v_mfma_f32_16x16x32_bf16 v[12:15], v[136:139], v[8:11], v[12:15]
    v_mfma_f32_16x16x32_bf16 v[68:71], v[136:139], v[4:7], v[68:71]
    buffer_load_dwordx4 v[184:187], v18, s[4:7], s32 offen nt
    s_add_u32 s32, s32, 8192
    v_perm_b32 v8, v33, v33, v28
    v_perm_b32 v9, v33, v33, v29
    v_perm_b32 v10, v33, v33, v30
    v_perm_b32 v11, v33, v33, v31
    v_perm_b32 v4, v49, v49, v28
    v_perm_b32 v5, v49, v49, v29
    v_perm_b32 v6, v49, v49, v30
    v_perm_b32 v7, v49, v49, v31
    s_waitcnt vmcnt(11)
    v_mfma_f32_16x16x32_bf16 v[12:15], v[140:143], v[8:11], v[12:15]
    v_mfma_f32_16x16x32_bf16 v[68:71], v[140:143], v[4:7], v[68:71]
    buffer_load_dwordx4 v[188:191], v18, s[4:7], s32 offen nt
    s_add_u32 s32, s32, 8192
    v_perm_b32 v8, v34, v34, v24
    v_perm_b32 v9, v34, v34, v25
    v_perm_b32 v10, v34, v34, v26
    v_perm_b32 v11, v34, v34, v27
    v_perm_b32 v4, v50, v50, v24
    v_perm_b32 v5, v50, v50, v25
    v_perm_b32 v6, v50, v50, v26
    v_perm_b32 v7, v50, v50, v27
    s_waitcnt vmcnt(11)
    v_mfma_f32_16x16x32_bf16 v[12:15], v[144:147], v[8:11], v[12:15]
    v_mfma_f32_16x16x32_bf16 v[68:71], v[144:147], v[4:7], v[68:71]
    buffer_load_dwordx4 v[192:195], v18, s[4:7], s32 offen nt
    s_add_u32 s32, s32, 8192
    v_perm_b32 v8, v34, v34, v28
    v_perm_b32 v9, v34, v34, v29
    v_perm_b32 v10, v34, v34, v30
    v_perm_b32 v11, v34, v34, v31
    v_perm_b32 v4, v50, v50, v28
    v_perm_b32 v5, v50, v50, v29
    v_perm_b32 v6, v50, v50, v30
    v_perm_b32 v7, v50, v50, v31
    s_waitcnt vmcnt(11)
    v_mfma_f32_16x16x32_bf16 v[12:15], v[148:151], v[8:11], v[12:15]
    v_mfma_f32_16x16x32_bf16 v[68:71], v[148:151], v[4:7], v[68:71]
    buffer_load_dwordx4 v[196:199], v18, s[4:7], s32 offen nt
    s_add_u32 s32, s32, 8192
    v_perm_b32 v8, v35, v35, v24
    v_perm_b32 v9, v35, v35, v25
    v_perm_b32 v10, v35, v35, v26
    v_perm_b32 v11, v35, v35, v27
    v_perm_b32 v4, v51, v51, v24
    v_perm_b32 v5, v51, v51, v25
    v_perm_b32 v6, v51, v51, v26
    v_perm_b32 v7, v51, v51, v27
    s_waitcnt vmcnt(11)
    v_mfma_f32_16x16x32_bf16 v[12:15], v[152:155], v[8:11], v[12:15]
    v_mfma_f32_16x16x32_bf16 v[68:71], v[152:155], v[4:7], v[68:71]
    buffer_load_dwordx4 v[200:203], v18, s[4:7], s32 offen nt
    s_add_u32 s32, s32, 8192
    v_perm_b32 v8, v35, v35, v28
    v_perm_b32 v9, v35, v35, v29
    v_perm_b32 v10, v35, v35, v30
    v_perm_b32 v11, v35, v35, v31
    v_perm_b32 v4, v51, v51, v28
    v_perm_b32 v5, v51, v51, v29
    v_perm_b32 v6, v51, v51, v30
    v_perm_b32 v7, v51, v51, v31
    s_waitcnt vmcnt(11)
    v_mfma_f32_16x16x32_bf16 v[12:15], v[156:159], v[8:11], v[12:15]
    v_mfma_f32_16x16x32_bf16 v[68:71], v[156:159], v[4:7], v[68:71]
    buffer_load_dwordx4 v[204:207], v18, s[4:7], s32 offen nt
    s_add_u32 s32, s32, 8192
    v_perm_b32 v8, v36, v36, v24
    v_perm_b32 v9, v36, v36, v25
    v_perm_b32 v10, v36, v36, v26
    v_perm_b32 v11, v36, v36, v27
    v_perm_b32 v4, v52, v52, v24
    v_perm_b32 v5, v52, v52, v25
    v_perm_b32 v6, v52, v52, v26
    v_perm_b32 v7, v52, v52, v27
    s_waitcnt vmcnt(11)
    v_mfma_f32_16x16x32_bf16 v[12:15], v[160:163], v[8:11], v[12:15]
    v_mfma_f32_16x16x32_bf16 v[68:71], v[160:163], v[4:7], v[68:71]
    buffer_load_dwordx4 v[208:211], v18, s[4:7], s32 offen nt
    s_add_u32 s32, s32, 8192
    v_perm_b32 v8, v36, v36, v28
    v_perm_b32 v9, v36, v36, v29
    v_perm_b32 v10, v36, v36, v30
    v_perm_b32 v11, v36, v36, v31
    v_perm_b32 v4, v52, v52, v28
    v_perm_b32 v5, v52, v52, v29
    v_perm_b32 v6, v52, v52, v30
    v_perm_b32 v7, v52, v52, v31
    s_waitcnt vmcnt(11)
    v_mfma_f32_16x16x32_bf16 v[12:15], v[164:167], v[8:11], v[12:15]
    v_mfma_f32_16x16x32_bf16 v[68:71], v[164:167], v[4:7], v[68:71]
    buffer_load_dwordx4 v[212:215], v18, s[4:7], s32 offen nt
    s_add_u32 s32, s32, 8192
    v_perm_b32 v8, v37, v37, v24
    v_perm_b32 v9, v37, v37, v25
    v_perm_b32 v10, v37, v37, v26
    v_perm_b32 v11, v37, v37, v27
    v_perm_b32 v4, v53, v53, v24
    v_perm_b32 v5, v53, v53, v25
    v_perm_b32 v6, v53, v53, v26
    v_perm_b32 v7, v53, v53, v27
    s_waitcnt vmcnt(11)
    v_mfma_f32_16x16x32_bf16 v[12:15], v[168:171], v[8:11], v[12:15]
    v_mfma_f32_16x16x32_bf16 v[68:71], v[168:171], v[4:7], v[68:71]
    buffer_load_dwordx4 v[216:219], v18, s[4:7], s32 offen nt
    s_add_u32 s32, s32, 8192
    v_perm_b32 v8, v37, v37, v28
    v_perm_b32 v9, v37, v37, v29
    v_perm_b32 v10, v37, v37, v30
    v_perm_b32 v11, v37, v37, v31
    v_perm_b32 v4, v53, v53, v28
    v_perm_b32 v5, v53, v53, v29
    v_perm_b32 v6, v53, v53, v30
    v_perm_b32 v7, v53, v53, v31
    s_waitcnt vmcnt(11)
    v_mfma_f32_16x16x32_bf16 v[12:15], v[172:175], v[8:11], v[12:15]
    v_mfma_f32_16x16x32_bf16 v[68:71], v[172:175], v[4:7], v[68:71]
    buffer_load_dwordx4 v[220:223], v18, s[4:7], s32 offen nt
    s_add_u32 s32, s32, 8192
    v_perm_b32 v8, v38, v38, v24
    v_perm_b32 v9, v38, v38, v25
    v_perm_b32 v10, v38, v38, v26
    v_perm_b32 v11, v38, v38, v27
    v_perm_b32 v4, v54, v54, v24
    v_perm_b32 v5, v54, v54, v25
    v_perm_b32 v6, v54, v54, v26
    v_perm_b32 v7, v54, v54, v27
    s_waitcnt vmcnt(11)
    v_mfma_f32_16x16x32_bf16 v[12:15], v[176:179], v[8:11], v[12:15]
    v_mfma_f32_16x16x32_bf16 v[68:71], v[176:179], v[4:7], v[68:71]
    buffer_load_dwordx4 v[224:227], v18, s[4:7], s32 offen nt
    s_add_u32 s32, s32, 8192
    v_perm_b32 v8, v38, v38, v28
    v_perm_b32 v9, v38, v38, v29
    v_perm_b32 v10, v38, v38, v30
    v_perm_b32 v11, v38, v38, v31
    v_perm_b32 v4, v54, v54, v28
    v_perm_b32 v5, v54, v54, v29
    v_perm_b32 v6, v54, v54, v30
    v_perm_b32 v7, v54, v54, v31
    s_waitcnt vmcnt(11)
    v_mfma_f32_16x16x32_bf16 v[12:15], v[180:183], v[8:11], v[12:15]
    v_mfma_f32_16x16x32_bf16 v[68:71], v[180:183], v[4:7], v[68:71]
    buffer_load_dwordx4 v[228:231], v18, s[4:7], s32 offen nt
    s_add_u32 s32, s32, 8192
    v_perm_b32 v8, v39, v39, v24
    v_perm_b32 v9, v39, v39, v25
    v_perm_b32 v10, v39, v39, v26
    v_perm_b32 v11, v39, v39, v27
    v_perm_b32 v4, v55, v55, v24
    v_perm_b32 v5, v55, v55, v25
    v_perm_b32 v6, v55, v55, v26
    v_perm_b32 v7, v55, v55, v27
    s_waitcnt vmcnt(11)
    v_mfma_f32_16x16x32_bf16 v[12:15], v[184:187], v[8:11], v[12:15]
    v_mfma_f32_16x16x32_bf16 v[68:71], v[184:187], v[4:7], v[68:71]
    buffer_load_dwordx4 v[232:235], v18, s[4:7], s32 offen nt
    s_add_u32 s32, s32, 8192
    v_perm_b32 v8, v39, v39, v28
    v_perm_b32 v9, v39, v39, v29
    v_perm_b32 v10, v39, v39, v30
    v_perm_b32 v11, v39, v39, v31
    v_perm_b32 v4, v55, v55, v28
    v_perm_b32 v5, v55, v55, v29
    v_perm_b32 v6, v55, v55, v30
    v_perm_b32 v7, v55, v55, v31
    s_waitcnt vmcnt(11)
    v_mfma_f32_16x16x32_bf16 v[12:15], v[188:191], v[8:11], v[12:15]
    v_mfma_f32_16x16x32_bf16 v[68:71], v[188:191], v[4:7], v[68:71]
    buffer_load_dwordx4 v[236:239], v18, s[4:7], s32 offen nt
    s_add_u32 s32, s32, 8192
    v_perm_b32 v8, v40, v40, v24
    v_perm_b32 v9, v40, v40, v25
    v_perm_b32 v10, v40, v40, v26
    v_perm_b32 v11, v40, v40, v27
    v_perm_b32 v4, v56, v56, v24
    v_perm_b32 v5, v56, v56, v25
    v_perm_b32 v6, v56, v56, v26
    v_perm_b32 v7, v56, v56, v27
    s_waitcnt vmcnt(11)
    v_mfma_f32_16x16x32_bf16 v[12:15], v[192:195], v[8:11], v[12:15]
    v_mfma_f32_16x16x32_bf16 v[68:71], v[192:195], v[4:7], v[68:71]
    buffer_load_dwordx4 v[240:243], v18, s[4:7], s32 offen nt
    s_add_u32 s32, s32, 8192
    v_perm_b32 v8, v40, v40, v28
    v_perm_b32 v9, v40, v40, v29
    v_perm_b32 v10, v40, v40, v30
    v_perm_b32 v11, v40, v40, v31
    v_perm_b32 v4, v56, v56, v28
    v_perm_b32 v5, v56, v56, v29
    v_perm_b32 v6, v56, v56, v30
    v_perm_b32 v7, v56, v56, v31
    s_waitcnt vmcnt(11)
    v_mfma_f32_16x16x32_bf16 v[12:15], v[196:199], v[8:11], v[12:15]
    v_mfma_f32_16x16x32_bf16 v[68:71], v[196:199], v[4:7], v[68:71]
    buffer_load_dwordx4 v[244:247], v18, s[4:7], s32 offen nt
    s_add_u32 s32, s32, 8192
    v_perm_b32 v8, v41, v41, v24
    v_perm_b32 v9, v41, v41, v25
    v_perm_b32 v10, v41, v41, v26
    v_perm_b32 v11, v41, v41, v27
    v_perm_b32 v4, v57, v57, v24
    v_perm_b32 v5, v57, v57, v25
    v_perm_b32 v6, v57, v57, v26
    v_perm_b32 v7, v57, v57, v27
    s_waitcnt vmcnt(11)
    v_mfma_f32_16x16x32_bf16 v[12:15], v[200:203], v[8:11], v[12:15]
    v_mfma_f32_16x16x32_bf16 v[68:71], v[200:203], v[4:7], v[68:71]
    buffer_load_dwordx4 v[248:251], v18, s[4:7], s32 offen nt
    s_add_u32 s32, s32, 8192
    v_perm_b32 v8, v41, v41, v28
    v_perm_b32 v9, v41, v41, v29
    v_perm_b32 v10, v41, v41, v30
    v_perm_b32 v11, v41, v41, v31
    v_perm_b32 v4, v57, v57, v28
    v_perm_b32 v5, v57, v57, v29
    v_perm_b32 v6, v57, v57, v30
    v_perm_b32 v7, v57, v57, v31
    s_waitcnt vmcnt(11)
    v_mfma_f32_16x16x32_bf16 v[12:15], v[204:207], v[8:11], v[12:15]
    v_mfma_f32_16x16x32_bf16 v[68:71], v[204:207], v[4:7], v[68:71]
    buffer_load_dwordx4 v[252:255], v18, s[4:7], s32 offen nt
    s_add_u32 s32, s32, 8192
    v_perm_b32 v8, v42, v42, v24
    v_perm_b32 v9, v42, v42, v25
    v_perm_b32 v10, v42, v42, v26
    v_perm_b32 v11, v42, v42, v27
    v_perm_b32 v4, v58, v58, v24
    v_perm_b32 v5, v58, v58, v25
    v_perm_b32 v6, v58, v58, v26
    v_perm_b32 v7, v58, v58, v27
    s_waitcnt vmcnt(11)
    v_mfma_f32_16x16x32_bf16 v[12:15], v[208:211], v[8:11], v[12:15]
    v_mfma_f32_16x16x32_bf16 v[68:71], v[208:211], v[4:7], v[68:71]
    s_lshl_b32 s73, s74, 7
    s_add_u32 s73, s73, 0x170000
    s_cmp_lg_u32 s3, 0
    s_cbranch_scc1 L_A_nofl
    s_mov_b64 exec, 1
    buffer_store_dwordx4 v[76:79], off, s[12:15], s73 sc1
    s_mov_b64 exec, -1
L_A_nofl:
    s_cmp_ge_u32 s71, 0x1fe000
    s_cselect_b32 s71, 0x600000, s71
    buffer_store_dwordx4 v[76:79], v2, s[12:15], s71 offen sc1
    s_add_u32 s71, s71, 0x20000
    s_getpc_b64 s[24:25]
L_pc10:
    s_add_u32 s24, s24, L_A2-L_pc10
    s_addc_u32 s25, s25, 0
    v_lshl_add_u32 v16, v0, 2, s3
    v_lshlrev_b32 v16, 7, v16
    v_min_u32 v16, L_last-L_A2-4, v16
    v_mov_b32 v17, s25
    v_add_co_u32 v16, vcc, s24, v16
    s_nop 1
    v_addc_co_u32 v17, vcc, 0, v17, vcc
    global_load_dword v17, v[16:17], off
    s_mov_b32 s4, s42
    s_mov_b32 s5, s43
    s_mov_b32 s6, s75
    s_mov_b32 s32, s35
    buffer_load_dwordx4 v[128:131], v64, s[4:7], s32 offen nt
    s_add_u32 s32, s32, 8192
    v_perm_b32 v8, v42, v42, v28
    v_perm_b32 v9, v42, v42, v29
    v_perm_b32 v10, v42, v42, v30
    v_perm_b32 v11, v42, v42, v31
    v_perm_b32 v4, v58, v58, v28
    v_perm_b32 v5, v58, v58, v29
    v_perm_b32 v6, v58, v58, v30
    v_perm_b32 v7, v58, v58, v31
    s_waitcnt vmcnt(13)
    v_mfma_f32_16x16x32_bf16 v[12:15], v[212:215], v[8:11], v[12:15]
    v_mfma_f32_16x16x32_bf16 v[68:71], v[212:215], v[4:7], v[68:71]
    buffer_load_dwordx4 v[132:135], v64, s[4:7], s32 offen nt
    s_add_u32 s32, s32, 8192
    v_perm_b32 v8, v43, v43, v24
    v_perm_b32 v9, v43, v43, v25
    v_perm_b32 v10, v43, v43, v26
    v_perm_b32 v11, v43, v43, v27
    v_perm_b32 v4, v59, v59, v24
    v_perm_b32 v5, v59, v59, v25
    v_perm_b32 v6, v59, v59, v26
    v_perm_b32 v7, v59, v59, v27
    s_waitcnt vmcnt(13)
    v_mfma_f32_16x16x32_bf16 v[12:15], v[216:219], v[8:11], v[12:15]
    v_mfma_f32_16x16x32_bf16 v[68:71], v[216:219], v[4:7], v[68:71]
    buffer_load_dwordx4 v[136:139], v64, s[4:7], s32 offen nt
    s_add_u32 s32, s32, 8192
    v_perm_b32 v8, v43, v43, v28
    v_perm_b32 v9, v43, v43, v29
    v_perm_b32 v10, v43, v43, v30
    v_perm_b32 v11, v43, v43, v31
    v_perm_b32 v4, v59, v59, v28
    v_perm_b32 v5, v59, v59, v29
    v_perm_b32 v6, v59, v59, v30
    v_perm_b32 v7, v59, v59, v31
    s_waitcnt vmcnt(13)
    v_mfma_f32_16x16x32_bf16 v[12:15], v[220:223], v[8:11], v[12:15]
    v_mfma_f32_16x16x32_bf16 v[68:71], v[220:223], v[4:7], v[68:71]
    buffer_load_dwordx4 v[140:143], v64, s[4:7], s32 offen nt
    s_add_u32 s32, s32, 8192
    v_perm_b32 v8, v44, v44, v24
    v_perm_b32 v9, v44, v44, v25
    v_perm_b32 v10, v44, v44, v26
    v_perm_b32 v11, v44, v44, v27
    v_perm_b32 v4, v60, v60, v24
    v_perm_b32 v5, v60, v60, v25
    v_perm_b32 v6, v60, v60, v26
    v_perm_b32 v7, v60, v60, v27
    s_waitcnt vmcnt(13)
    v_mfma_f32_16x16x32_bf16 v[12:15], v[224:227], v[8:11], v[12:15]
    v_mfma_f32_16x16x32_bf16 v[68:71], v[224:227], v[4:7], v[68:71]
    buffer_load_dwordx4 v[144:147], v64, s[4:7], s32 offen nt
    s_add_u32 s32, s32, 8192
    v_perm_b32 v8, v44, v44, v28
    v_perm_b32 v9, v44, v44, v29
    v_perm_b32 v10, v44, v44, v30
    v_perm_b32 v11, v44, v44, v31
    v_perm_b32 v4, v60, v60, v28
    v_perm_b32 v5, v60, v60, v29
    v_perm_b32 v6, v60, v60, v30
    v_perm_b32 v7, v60, v60, v31
    s_waitcnt vmcnt(13)
    v_mfma_f32_16x16x32_bf16 v[12:15], v[228:231], v[8:11], v[12:15]
    v_mfma_f32_16x16x32_bf16 v[68:71], v[228:231], v[4:7], v[68:71]
    buffer_load_dwordx4 v[148:151], v64, s[4:7], s32 offen nt
    s_add_u32 s32, s32, 8192
    v_perm_b32 v8, v45, v45, v24
    v_perm_b32 v9, v45, v45, v25
    v_perm_b32 v10, v45, v45, v26
    v_perm_b32 v11, v45, v45, v27
    v_perm_b32 v4, v61, v61, v24
    v_perm_b32 v5, v61, v61, v25
    v_perm_b32 v6, v61, v61, v26
    v_perm_b32 v7, v61, v61, v27
    s_waitcnt vmcnt(13)
    v_mfma_f32_16x16x32_bf16 v[12:15], v[232:235], v[8:11], v[12:15]
    v_mfma_f32_16x16x32_bf16 v[68:71], v[232:235], v[4:7], v[68:71]
    buffer_load_dwordx4 v[152:155], v64, s[4:7], s32 offen nt
    s_add_u32 s32, s32, 8192
    v_perm_b32 v8, v45, v45, v28
    v_perm_b32 v9, v45, v45, v29
    v_perm_b32 v10, v45, v45, v30
    v_perm_b32 v11, v45, v45, v31
    v_perm_b32 v4, v61, v61, v28
    v_perm_b32 v5, v61, v61, v29
    v_perm_b32 v6, v61, v61, v30
    v_perm_b32 v7, v61, v61, v31
    s_waitcnt vmcnt(13)
    v_mfma_f32_16x16x32_bf16 v[12:15], v[236:239], v[8:11], v[12:15]
    v_mfma_f32_16x16x32_bf16 v[68:71], v[236:239], v[4:7], v[68:71]
    buffer_load_dwordx4 v[156:159], v64, s[4:7], s32 offen nt
    s_add_u32 s32, s32, 8192
    v_perm_b32 v8, v46, v46, v24
    v_perm_b32 v9, v46, v46, v25
    v_perm_b32 v10, v46, v46, v26
    v_perm_b32 v11, v46, v46, v27
    v_perm_b32 v4, v62, v62, v24
    v_perm_b32 v5, v62, v62, v25
    v_perm_b32 v6, v62, v62, v26
    v_perm_b32 v7, v62, v62, v27
    s_waitcnt vmcnt(13)
    v_mfma_f32_16x16x32_bf16 v[12:15], v[240:243], v[8:11], v[12:15]
    v_mfma_f32_16x16x32_bf16 v[68:71], v[240:243], v[4:7], v[68:71]
    buffer_load_dwordx4 v[160:163], v64, s[4:7], s32 offen nt
    s_add_u32 s32, s32, 8192
    v_perm_b32 v8, v46, v46, v28
    v_perm_b32 v9, v46, v46, v29
    v_perm_b32 v10, v46, v46, v30
    v_perm_b32 v11, v46, v46, v31
    v_perm_b32 v4, v62, v62, v28
    v_perm_b32 v5, v62, v62, v29
    v_perm_b32 v6, v62, v62, v30
    v_perm_b32 v7, v62, v62, v31
    s_waitcnt vmcnt(13)
    v_mfma_f32_16x16x32_bf16 v[12:15], v[244:247], v[8:11], v[12:15]
    v_mfma_f32_16x16x32_bf16 v[68:71], v[244:247], v[4:7], v[68:71]
    buffer_load_dwordx4 v[164:167], v64, s[4:7], s32 offen nt
    s_add_u32 s32, s32, 8192
    v_perm_b32 v8, v47, v47, v24
    v_perm_b32 v9, v47, v47, v25
    v_perm_b32 v10, v47, v47, v26
    v_perm_b32 v11, v47, v47, v27
    v_perm_b32 v4, v63, v63, v24
    v_perm_b32 v5, v63, v63, v25
    v_perm_b32 v6, v63, v63, v26
    v_perm_b32 v7, v63, v63, v27
    s_waitcnt vmcnt(13)
    v_mfma_f32_16x16x32_bf16 v[12:15], v[248:251], v[8:11], v[12:15]
    v_mfma_f32_16x16x32_bf16 v[68:71], v[248:251], v[4:7], v[68:71]
    buffer_load_dwordx4 v[168:171], v64, s[4:7], s32 offen nt
    s_add_u32 s32, s32, 8192
    v_perm_b32 v8, v47, v47, v28
    v_perm_b32 v9, v47, v47, v29
    v_perm_b32 v10, v47, v47, v30
    v_perm_b32 v11, v47, v47, v31
    v_perm_b32 v4, v63, v63, v28
    v_perm_b32 v5, v63, v63, v29
    v_perm_b32 v6, v63, v63, v30
    v_perm_b32 v7, v63, v63, v31
    s_waitcnt vmcnt(13)
    v_mfma_f32_16x16x32_bf16 v[12:15], v[252:255], v[8:11], v[12:15]
    v_mfma_f32_16x16x32_bf16 v[68:71], v[252:255], v[4:7], v[68:71]
    buffer_load_dwordx4 v[172:175], v64, s[4:7], s32 offen nt
    s_add_u32 s32, s32, 8192
    v_lshrrev_b32 v3, 4, v0
    v_lshlrev_b32 v3, 7, v3
    v_and_b32 v4, 7, v0
    v_lshl_add_u32 v3, v4, 2, v3
    v_bfe_u32 v4, v0, 3, 1
    v_lshl_add_u32 v3, v4, 9, v3
    s_lshl_b32 s24, s3, 11
    s_add_u32 s24, s24, 135168
    v_add_u32 v3, s24, v3
    ds_write_b32 v3, v12 offset:0
    ds_write_b32 v3, v13 offset:32
    ds_write_b32 v3, v14 offset:64
    ds_write_b32 v3, v15 offset:96
    ds_write_b32 v3, v68 offset:1024
    ds_write_b32 v3, v69 offset:1056
    ds_write_b32 v3, v70 offset:1088
    ds_write_b32 v3, v71 offset:1120
    s_waitcnt lgkmcnt(0)
    s_barrier
    ds_read_b128 v[72:75], v65 offset:0
    ds_read_b128 v[76:79], v65 offset:16
    ds_read_b128 v[80:83], v65 offset:2048
    ds_read_b128 v[84:87], v65 offset:2064
    ds_read_b128 v[88:91], v65 offset:4096
    ds_read_b128 v[92:95], v65 offset:4112
    ds_read_b128 v[96:99], v65 offset:6144
    ds_read_b128 v[100:103], v65 offset:6160
    s_waitcnt lgkmcnt(4)
    v_add_f32 v72, v72, v80
    v_add_f32 v73, v73, v81
    v_add_f32 v74, v74, v82
    v_add_f32 v75, v75, v83
    v_add_f32 v76, v76, v84
    v_add_f32 v77, v77, v85
    v_add_f32 v78, v78, v86
    v_add_f32 v79, v79, v87
    s_waitcnt lgkmcnt(2)
    v_add_f32 v72, v72, v88
    v_add_f32 v73, v73, v89
    v_add_f32 v74, v74, v90
    v_add_f32 v75, v75, v91
    v_add_f32 v76, v76, v92
    v_add_f32 v77, v77, v93
    v_add_f32 v78, v78, v94
    v_add_f32 v79, v79, v95
    s_waitcnt lgkmcnt(0)
    v_add_f32 v72, v72, v96
    v_add_f32 v73, v73, v97
    v_add_f32 v74, v74, v98
    v_add_f32 v75, v75, v99
    v_add_f32 v76, v76, v100
    v_add_f32 v77, v77, v101
    v_add_f32 v78, v78, v102
    v_add_f32 v79, v79, v103
    v_cvt_pk_bf16_f32 v8, v72, v73
    v_cvt_pk_bf16_f32 v9, v74, v75
    v_cvt_pk_bf16_f32 v10, v76, v77
    v_cvt_pk_bf16_f32 v11, v78, v79
    s_cmp_ge_u32 s74, 32
    s_cbranch_scc1 L_C
L_A2:
    buffer_load_dwordx4 v[176:179], v64, s[4:7], s32 offen nt
    s_add_u32 s32, s32, 8192
    buffer_load_dwordx4 v[180:183], v64, s[4:7], s32 offen nt
    s_add_u32 s32, s32, 8192
    buffer_load_dwordx4 v[184:187], v64, s[4:7], s32 offen nt
    s_add_u32 s32, s32, 8192
    buffer_load_dwordx4 v[188:191], v64, s[4:7], s32 offen nt
    s_add_u32 s32, s32, 8192
    buffer_load_dwordx4 v[192:195], v64, s[4:7], s32 offen nt
    s_add_u32 s32, s32, 8192
    buffer_load_dwordx4 v[196:199], v64, s[4:7], s32 offen nt
    s_add_u32 s32, s32, 8192
    buffer_load_dwordx4 v[200:203], v64, s[4:7], s32 offen nt
    s_add_u32 s32, s32, 8192
    buffer_load_dwordx4 v[204:207], v64, s[4:7], s32 offen nt
    s_add_u32 s32, s32, 8192
    buffer_load_dwordx4 v[208:211], v64, s[4:7], s32 offen nt
    s_add_u32 s32, s32, 8192
    buffer_load_dwordx4 v[212:215], v64, s[4:7], s32 offen nt
    s_add_u32 s32, s32, 8192
    buffer_load_dwordx4 v[216:219], v64, s[4:7], s32 offen nt
    s_add_u32 s32, s32, 8192
    buffer_load_dwordx4 v[220:223], v64, s[4:7], s32 offen nt
    s_add_u32 s32, s32, 8192
    buffer_load_dwordx4 v[224:227], v64, s[4:7], s32 offen nt
    s_add_u32 s32, s32, 8192
    buffer_load_dwordx4 v[228:231], v64, s[4:7], s32 offen nt
    s_add_u32 s32, s32, 8192
    buffer_load_dwordx4 v[232:235], v64, s[4:7], s32 offen nt
    s_add_u32 s32, s32, 8192
    buffer_load_dwordx4 v[236:239], v64, s[4:7], s32 offen nt
    s_add_u32 s32, s32, 8192
    buffer_load_dwordx4 v[240:243], v64, s[4:7], s32 offen nt
    s_add_u32 s32, s32, 8192
    buffer_load_dwordx4 v[244:247], v64, s[4:7], s32 offen nt
    s_add_u32 s32, s32, 8192
    buffer_load_dwordx4 v[248:251], v64, s[4:7], s32 offen nt
    s_add_u32 s32, s32, 8192
    buffer_load_dwordx4 v[252:255], v64, s[4:7], s32 offen nt
    s_add_u32 s32, s32, 8192
    s_waitcnt vmcnt(31)
    v_mfma_f32_16x16x32_bf16 v[80:83], v[128:131], v[8:11], 0
    s_waitcnt vmcnt(30)
    v_mfma_f32_16x16x32_bf16 v[84:87], v[132:135], v[8:11], 0
    s_waitcnt vmcnt(29)
    v_mfma_f32_16x16x32_bf16 v[88:91], v[136:139], v[8:11], 0
    s_waitcnt vmcnt(28)
    v_mfma_f32_16x16x32_bf16 v[92:95], v[140:143], v[8:11], 0
    s_waitcnt vmcnt(27)
    v_mfma_f32_16x16x32_bf16 v[96:99], v[144:147], v[8:11], 0
    s_waitcnt vmcnt(26)
    v_mfma_f32_16x16x32_bf16 v[100:103], v[148:151], v[8:11], 0
    s_waitcnt vmcnt(25)
    v_mfma_f32_16x16x32_bf16 v[104:107], v[152:155], v[8:11], 0
    s_waitcnt vmcnt(24)
    v_mfma_f32_16x16x32_bf16 v[108:111], v[156:159], v[8:11], 0
    v_add_f32_dpp v72, v81, v80 quad_perm:[1,1,1,1] row_mask:0xf bank_mask:0xf
    v_add_f32_dpp v73, v85, v84 quad_perm:[1,1,1,1] row_mask:0xf bank_mask:0xf
    v_add_f32_dpp v74, v89, v88 quad_perm:[1,1,1,1] row_mask:0xf bank_mask:0xf
    v_add_f32_dpp v75, v93, v92 quad_perm:[1,1,1,1] row_mask:0xf bank_mask:0xf
    v_add_f32_dpp v76, v97, v96 quad_perm:[1,1,1,1] row_mask:0xf bank_mask:0xf
    v_add_f32_dpp v77, v101, v100 quad_perm:[1,1,1,1] row_mask:0xf bank_mask:0xf
    v_add_f32_dpp v78, v105, v104 quad_perm:[1,1,1,1] row_mask:0xf bank_mask:0xf
    s_nop 0
    v_add_f32_dpp v79, v109, v108 quad_perm:[1,1,1,1] row_mask:0xf bank_mask:0xf
    v_add_f32_dpp v72, v82, v72 quad_perm:[2,2,2,2] row_mask:0xf bank_mask:0xf
    v_add_f32_dpp v73, v86, v73 quad_perm:[2,2,2,2] row_mask:0xf bank_mask:0xf
    v_add_f32_dpp v74, v90, v74 quad_perm:[2,2,2,2] row_mask:0xf bank_mask:0xf
    v_add_f32_dpp v75, v94, v75 quad_perm:[2,2,2,2] row_mask:0xf bank_mask:0xf
    v_add_f32_dpp v76, v98, v76 quad_perm:[2,2,2,2] row_mask:0xf bank_mask:0xf
    v_add_f32_dpp v77, v102, v77 quad_perm:[2,2,2,2] row_mask:0xf bank_mask:0xf
    v_add_f32_dpp v78, v106, v78 quad_perm:[2,2,2,2] row_mask:0xf bank_mask:0xf
    v_add_f32_dpp v79, v110, v79 quad_perm:[2,2,2,2] row_mask:0xf bank_mask:0xf
    v_add_f32_dpp v72, v83, v72 quad_perm:[3,3,3,3] row_mask:0xf bank_mask:0xf
    v_add_f32_dpp v73, v87, v73 quad_perm:[3,3,3,3] row_mask:0xf bank_mask:0xf
    v_add_f32_dpp v74, v91, v74 quad_perm:[3,3,3,3] row_mask:0xf bank_mask:0xf
    v_add_f32_dpp v75, v95, v75 quad_perm:[3,3,3,3] row_mask:0xf bank_mask:0xf
    v_add_f32_dpp v76, v99, v76 quad_perm:[3,3,3,3] row_mask:0xf bank_mask:0xf
    v_add_f32_dpp v77, v103, v77 quad_perm:[3,3,3,3] row_mask:0xf bank_mask:0xf
    v_add_f32_dpp v78, v107, v78 quad_perm:[3,3,3,3] row_mask:0xf bank_mask:0xf
    v_add_f32_dpp v79, v111, v79 quad_perm:[3,3,3,3] row_mask:0xf bank_mask:0xf
    s_waitcnt vmcnt(23)
    v_mfma_f32_16x16x32_bf16 v[80:83], v[160:163], v[8:11], 0
    s_waitcnt vmcnt(22)
    v_mfma_f32_16x16x32_bf16 v[84:87], v[164:167], v[8:11], 0
    s_waitcnt vmcnt(21)
    v_mfma_f32_16x16x32_bf16 v[88:91], v[168:171], v[8:11], 0
    s_waitcnt vmcnt(20)
    v_mfma_f32_16x16x32_bf16 v[92:95], v[172:175], v[8:11], 0
    s_waitcnt vmcnt(19)
    v_mfma_f32_16x16x32_bf16 v[96:99], v[176:179], v[8:11], 0
    s_waitcnt vmcnt(18)
    v_mfma_f32_16x16x32_bf16 v[100:103], v[180:183], v[8:11], 0
    s_waitcnt vmcnt(17)
    v_mfma_f32_16x16x32_bf16 v[104:107], v[184:187], v[8:11], 0
    s_waitcnt vmcnt(16)
    v_mfma_f32_16x16x32_bf16 v[108:111], v[188:191], v[8:11], 0
    v_add_f32_dpp v112, v80, v81 quad_perm:[0,0,0,0] row_mask:0xf bank_mask:0xf
    v_add_f32_dpp v113, v84, v85 quad_perm:[0,0,0,0] row_mask:0xf bank_mask:0xf
    v_add_f32_dpp v114, v88, v89 quad_perm:[0,0,0,0] row_mask:0xf bank_mask:0xf
    v_add_f32_dpp v115, v92, v93 quad_perm:[0,0,0,0] row_mask:0xf bank_mask:0xf
    v_add_f32_dpp v116, v96, v97 quad_perm:[0,0,0,0] row_mask:0xf bank_mask:0xf
    v_add_f32_dpp v117, v100, v101 quad_perm:[0,0,0,0] row_mask:0xf bank_mask:0xf
    v_add_f32_dpp v118, v104, v105 quad_perm:[0,0,0,0] row_mask:0xf bank_mask:0xf
    s_nop 0
    v_add_f32_dpp v119, v108, v109 quad_perm:[0,0,0,0] row_mask:0xf bank_mask:0xf
    v_add_f32_dpp v112, v82, v112 quad_perm:[2,2,2,2] row_mask:0xf bank_mask:0xf
    v_add_f32_dpp v113, v86, v113 quad_perm:[2,2,2,2] row_mask:0xf bank_mask:0xf
    v_add_f32_dpp v114, v90, v114 quad_perm:[2,2,2,2] row_mask:0xf bank_mask:0xf
    v_add_f32_dpp v115, v94, v115 quad_perm:[2,2,2,2] row_mask:0xf bank_mask:0xf
    v_add_f32_dpp v116, v98, v116 quad_perm:[2,2,2,2] row_mask:0xf bank_mask:0xf
    v_add_f32_dpp v117, v102, v117 quad_perm:[2,2,2,2] row_mask:0xf bank_mask:0xf
    v_add_f32_dpp v118, v106, v118 quad_perm:[2,2,2,2] row_mask:0xf bank_mask:0xf
    v_add_f32_dpp v119, v110, v119 quad_perm:[2,2,2,2] row_mask:0xf bank_mask:0xf
    v_add_f32_dpp v112, v83, v112 quad_perm:[3,3,3,3] row_mask:0xf bank_mask:0xf
    v_add_f32_dpp v113, v87, v113 quad_perm:[3,3,3,3] row_mask:0xf bank_mask:0xf
    v_add_f32_dpp v114, v91, v114 quad_perm:[3,3,3,3] row_mask:0xf bank_mask:0xf
    v_add_f32_dpp v115, v95, v115 quad_perm:[3,3,3,3] row_mask:0xf bank_mask:0xf
    v_add_f32_dpp v116, v99, v116 quad_perm:[3,3,3,3] row_mask:0xf bank_mask:0xf
    v_add_f32_dpp v117, v103, v117 quad_perm:[3,3,3,3] row_mask:0xf bank_mask:0xf
    v_add_f32_dpp v118, v107, v118 quad_perm:[3,3,3,3] row_mask:0xf bank_mask:0xf
    v_add_f32_dpp v119, v111, v119 quad_perm:[3,3,3,3] row_mask:0xf bank_mask:0xf
    v_cndmask_b32 v72, v72, v112, s[64:65]
    v_cndmask_b32 v73, v73, v113, s[64:65]
    v_cndmask_b32 v74, v74, v114, s[64:65]
    v_cndmask_b32 v75, v75, v115, s[64:65]
    v_cndmask_b32 v76, v76, v116, s[64:65]
    v_cndmask_b32 v77, v77, v117, s[64:65]
    v_cndmask_b32 v78, v78, v118, s[64:65]
    v_cndmask_b32 v79, v79, v119, s[64:65]
    s_waitcnt vmcnt(15)
    v_mfma_f32_16x16x32_bf16 v[80:83], v[192:195], v[8:11], 0
    s_waitcnt vmcnt(14)
    v_mfma_f32_16x16x32_bf16 v[84:87], v[196:199], v[8:11], 0
    s_waitcnt vmcnt(13)
    v_mfma_f32_16x16x32_bf16 v[88:91], v[200:203], v[8:11], 0
    s_waitcnt vmcnt(12)
    v_mfma_f32_16x16x32_bf16 v[92:95], v[204:207], v[8:11], 0
    s_waitcnt vmcnt(11)
    v_mfma_f32_16x16x32_bf16 v[96:99], v[208:211], v[8:11], 0
    s_waitcnt vmcnt(10)
    v_mfma_f32_16x16x32_bf16 v[100:103], v[212:215], v[8:11], 0
    s_waitcnt vmcnt(9)
    v_mfma_f32_16x16x32_bf16 v[104:107], v[216:219], v[8:11], 0
    s_waitcnt vmcnt(8)
    v_mfma_f32_16x16x32_bf16 v[108:111], v[220:223], v[8:11], 0
    v_add_f32_dpp v112, v80, v82 quad_perm:[0,0,0,0] row_mask:0xf bank_mask:0xf
    v_add_f32_dpp v113, v84, v86 quad_perm:[0,0,0,0] row_mask:0xf bank_mask:0xf
    v_add_f32_dpp v114, v88, v90 quad_perm:[0,0,0,0] row_mask:0xf bank_mask:0xf
    v_add_f32_dpp v115, v92, v94 quad_perm:[0,0,0,0] row_mask:0xf bank_mask:0xf
    v_add_f32_dpp v116, v96, v98 quad_perm:[0,0,0,0] row_mask:0xf bank_mask:0xf
    v_add_f32_dpp v117, v100, v102 quad_perm:[0,0,0,0] row_mask:0xf bank_mask:0xf
    v_add_f32_dpp v118, v104, v106 quad_perm:[0,0,0,0] row_mask:0xf bank_mask:0xf
    s_nop 0
    v_add_f32_dpp v119, v108, v110 quad_perm:[0,0,0,0] row_mask:0xf bank_mask:0xf
    v_add_f32_dpp v112, v81, v112 quad_perm:[1,1,1,1] row_mask:0xf bank_mask:0xf
    v_add_f32_dpp v113, v85, v113 quad_perm:[1,1,1,1] row_mask:0xf bank_mask:0xf
    v_add_f32_dpp v114, v89, v114 quad_perm:[1,1,1,1] row_mask:0xf bank_mask:0xf
    v_add_f32_dpp v115, v93, v115 quad_perm:[1,1,1,1] row_mask:0xf bank_mask:0xf
    v_add_f32_dpp v116, v97, v116 quad_perm:[1,1,1,1] row_mask:0xf bank_mask:0xf
    v_add_f32_dpp v117, v101, v117 quad_perm:[1,1,1,1] row_mask:0xf bank_mask:0xf
    v_add_f32_dpp v118, v105, v118 quad_perm:[1,1,1,1] row_mask:0xf bank_mask:0xf
    v_add_f32_dpp v119, v109, v119 quad_perm:[1,1,1,1] row_mask:0xf bank_mask:0xf
    v_add_f32_dpp v112, v83, v112 quad_perm:[3,3,3,3] row_mask:0xf bank_mask:0xf
    v_add_f32_dpp v113, v87, v113 quad_perm:[3,3,3,3] row_mask:0xf bank_mask:0xf
    v_add_f32_dpp v114, v91, v114 quad_perm:[3,3,3,3] row_mask:0xf bank_mask:0xf
    v_add_f32_dpp v115, v95, v115 quad_perm:[3,3,3,3] row_mask:0xf bank_mask:0xf
    v_add_f32_dpp v116, v99, v116 quad_perm:[3,3,3,3] row_mask:0xf bank_mask:0xf
    v_add_f32_dpp v117, v103, v117 quad_perm:[3,3,3,3] row_mask:0xf bank_mask:0xf
    v_add_f32_dpp v118, v107, v118 quad_perm:[3,3,3,3] row_mask:0xf bank_mask:0xf
    v_add_f32_dpp v119, v111, v119 quad_perm:[3,3,3,3] row_mask:0xf bank_mask:0xf
    v_cndmask_b32 v72, v72, v112, s[66:67]
    v_cndmask_b32 v73, v73, v113, s[66:67]
    v_cndmask_b32 v74, v74, v114, s[66:67]
    v_cndmask_b32 v75, v75, v115, s[66:67]
    v_cndmask_b32 v76, v76, v116, s[66:67]
    v_cndmask_b32 v77, v77, v117, s[66:67]
    v_cndmask_b32 v78, v78, v118, s[66:67]
    v_cndmask_b32 v79, v79, v119, s[66:67]
    s_waitcnt vmcnt(7)
    v_mfma_f32_16x16x32_bf16 v[80:83], v[224:227], v[8:11], 0
    s_waitcnt vmcnt(6)
    v_mfma_f32_16x16x32_bf16 v[84:87], v[228:231], v[8:11], 0
    s_waitcnt vmcnt(5)
    v_mfma_f32_16x16x32_bf16 v[88:91], v[232:235], v[8:11], 0
    s_waitcnt vmcnt(4)
    v_mfma_f32_16x16x32_bf16 v[92:95], v[236:239], v[8:11], 0
    s_waitcnt vmcnt(3)
    v_mfma_f32_16x16x32_bf16 v[96:99], v[240:243], v[8:11], 0
    s_waitcnt vmcnt(2)
    v_mfma_f32_16x16x32_bf16 v[100:103], v[244:247], v[8:11], 0
    s_waitcnt vmcnt(1)
    v_mfma_f32_16x16x32_bf16 v[104:107], v[248:251], v[8:11], 0
    s_waitcnt vmcnt(0)
    v_mfma_f32_16x16x32_bf16 v[108:111], v[252:255], v[8:11], 0
    v_add_f32_dpp v112, v80, v83 quad_perm:[0,0,0,0] row_mask:0xf bank_mask:0xf
    v_add_f32_dpp v113, v84, v87 quad_perm:[0,0,0,0] row_mask:0xf bank_mask:0xf
    v_add_f32_dpp v114, v88, v91 quad_perm:[0,0,0,0] row_mask:0xf bank_mask:0xf
    v_add_f32_dpp v115, v92, v95 quad_perm:[0,0,0,0] row_mask:0xf bank_mask:0xf
    v_add_f32_dpp v116, v96, v99 quad_perm:[0,0,0,0] row_mask:0xf bank_mask:0xf
    v_add_f32_dpp v117, v100, v103 quad_perm:[0,0,0,0] row_mask:0xf bank_mask:0xf
    v_add_f32_dpp v118, v104, v107 quad_perm:[0,0,0,0] row_mask:0xf bank_mask:0xf
    s_nop 0
    v_add_f32_dpp v119, v108, v111 quad_perm:[0,0,0,0] row_mask:0xf bank_mask:0xf
    v_add_f32_dpp v112, v81, v112 quad_perm:[1,1,1,1] row_mask:0xf bank_mask:0xf
    v_add_f32_dpp v113, v85, v113 quad_perm:[1,1,1,1] row_mask:0xf bank_mask:0xf
    v_add_f32_dpp v114, v89, v114 quad_perm:[1,1,1,1] row_mask:0xf bank_mask:0xf
    v_add_f32_dpp v115, v93, v115 quad_perm:[1,1,1,1] row_mask:0xf bank_mask:0xf
    v_add_f32_dpp v116, v97, v116 quad_perm:[1,1,1,1] row_mask:0xf bank_mask:0xf
    v_add_f32_dpp v117, v101, v117 quad_perm:[1,1,1,1] row_mask:0xf bank_mask:0xf
    v_add_f32_dpp v118, v105, v118 quad_perm:[1,1,1,1] row_mask:0xf bank_mask:0xf
    v_add_f32_dpp v119, v109, v119 quad_perm:[1,1,1,1] row_mask:0xf bank_mask:0xf
    v_add_f32_dpp v112, v82, v112 quad_perm:[2,2,2,2] row_mask:0xf bank_mask:0xf
    v_add_f32_dpp v113, v86, v113 quad_perm:[2,2,2,2] row_mask:0xf bank_mask:0xf
    v_add_f32_dpp v114, v90, v114 quad_perm:[2,2,2,2] row_mask:0xf bank_mask:0xf
    v_add_f32_dpp v115, v94, v115 quad_perm:[2,2,2,2] row_mask:0xf bank_mask:0xf
    v_add_f32_dpp v116, v98, v116 quad_perm:[2,2,2,2] row_mask:0xf bank_mask:0xf
    v_add_f32_dpp v117, v102, v117 quad_perm:[2,2,2,2] row_mask:0xf bank_mask:0xf
    v_add_f32_dpp v118, v106, v118 quad_perm:[2,2,2,2] row_mask:0xf bank_mask:0xf
    v_add_f32_dpp v119, v110, v119 quad_perm:[2,2,2,2] row_mask:0xf bank_mask:0xf
    v_cndmask_b32 v72, v72, v112, s[68:69]
    v_cndmask_b32 v73, v73, v113, s[68:69]
    v_cndmask_b32 v74, v74, v114, s[68:69]
    v_cndmask_b32 v75, v75, v115, s[68:69]
    v_cndmask_b32 v76, v76, v116, s[68:69]
    v_cndmask_b32 v77, v77, v117, s[68:69]
    v_cndmask_b32 v78, v78, v118, s[68:69]
    v_cndmask_b32 v79, v79, v119, s[68:69]
    s_mov_b32 s71, 0x3e0293ee
    v_mul_f32 v72, s71, v72
    v_mul_f32 v73, s71, v73
    v_mul_f32 v74, s71, v74
    v_mul_f32 v75, s71, v75
    v_mul_f32 v76, s71, v76
    v_mul_f32 v77, s71, v77
    v_mul_f32 v78, s71, v78
    v_mul_f32 v79, s71, v79
    v_cvt_pk_bf16_f32 v4, v72, v73
    v_cvt_pk_bf16_f32 v5, v74, v75
    v_cvt_pk_bf16_f32 v6, v76, v77
    v_cvt_pk_bf16_f32 v7, v78, v79
    s_lshl_b32 s24, s26, 12
    s_lshl_b32 s25, s3, 8
    s_add_u32 s24, s24, s25
    s_add_u32 s24, s24, 0x0
    buffer_store_dwordx4 v[4:7], v66, s[12:15], s24 offen sc1
    s_mov_b32 s8, s56
    s_mov_b32 s9, s57
    s_mov_b32 s10, 0x400000
    s_mov_b32 s11, 0x20000
    s_and_b32 s24, s3, 1
    s_lshl_b32 s24, s24, 1
    s_and_b32 s25, s3, 2
    s_lshl_b32 s25, s25, 3
    s_or_b32 s25, s25, s24
    s_and_b32 s24, s26, 13
    s_or_b32 s25, s25, s24
    s_lshl_b32 s25, s25, 17
    s_lshr_b32 s24, s74, 3
    s_lshl_b32 s24, s24, 7
    s_add_u32 s24, s24, s25
    v_lshrrev_b32 v3, 4, v0
    v_lshlrev_b32 v3, 15, v3
    v_and_b32 v4, 8, v0
    v_lshl_add_u32 v3, v4, 10, v3
    v_and_b32 v4, 0x70, v2
    v_add_u32 v3, v3, v4
    s_mul_i32 m0, s3, 16896
    s_nop 0
    buffer_load_dwordx4 v3, s[8:11], s24 offen nt lds
    s_add_u32 m0, m0, 1056
    s_add_u32 s24, s24, 2048
    buffer_load_dwordx4 v3, s[8:11], s24 offen nt lds
    s_add_u32 m0, m0, 1056
    s_add_u32 s24, s24, 2048
    buffer_load_dwordx4 v3, s[8:11], s24 offen nt lds
    s_add_u32 m0, m0, 1056
    s_add_u32 s24, s24, 2048
    buffer_load_dwordx4 v3, s[8:11], s24 offen nt lds
    s_add_u32 m0, m0, 1056
    s_add_u32 s24, s24, 10240
    buffer_load_dwordx4 v3, s[8:11], s24 offen nt lds
    s_add_u32 m0, m0, 1056
    s_add_u32 s24, s24, 2048
    buffer_load_dwordx4 v3, s[8:11], s24 offen nt lds
    s_add_u32 m0, m0, 1056
    s_add_u32 s24, s24, 2048
    buffer_load_dwordx4 v3, s[8:11], s24 offen nt lds
    s_add_u32 m0, m0, 1056
    s_add_u32 s24, s24, 2048
    buffer_load_dwordx4 v3, s[8:11], s24 offen nt lds
    s_add_u32 m0, m0, 1056
    s_add_u32 s24, s24, -21504
    buffer_load_dwordx4 v3, s[8:11], s24 offen nt lds
    s_add_u32 m0, m0, 1056
    s_add_u32 s24, s24, 2048
    buffer_load_dwordx4 v3, s[8:11], s24 offen nt lds
    s_add_u32 m0, m0, 1056
    s_add_u32 s24, s24, 2048
    buffer_load_dwordx4 v3, s[8:11], s24 offen nt lds
    s_add_u32 m0, m0, 1056
    s_add_u32 s24, s24, 2048
    buffer_load_dwordx4 v3, s[8:11], s24 offen nt lds
    s_add_u32 m0, m0, 1056
    s_add_u32 s24, s24, 10240
    buffer_load_dwordx4 v3, s[8:11], s24 offen nt lds
    s_add_u32 m0, m0, 1056
    s_add_u32 s24, s24, 2048
    buffer_load_dwordx4 v3, s[8:11], s24 offen nt lds
    s_add_u32 m0, m0, 1056
    s_add_u32 s24, s24, 2048
    buffer_load_dwordx4 v3, s[8:11], s24 offen nt lds
    s_add_u32 m0, m0, 1056
    s_add_u32 s24, s24, 2048
    buffer_load_dwordx4 v3, s[8:11], s24 offen nt lds
    s_waitcnt vmcnt(0)
    s_barrier
    s_cmp_lg_u32 s3, 0
    s_cbranch_scc1 L_sig11
    s_mov_b64 exec, 1
    v_mov_b32 v3, 1
    buffer_atomic_add v3, off, s[16:19], 0 offset:0 sc0
    s_waitcnt vmcnt(0)
    v_readfirstlane_b32 s24, v3
    s_mov_b64 exec, -1
    s_and_b32 s24, s24, 63
    s_cmp_lg_u32 s24, 63
    s_cbranch_scc1 L_sig11
    v_lshlrev_b32 v4, 7, v0
    v_mov_b32 v3, 1
    s_mov_b32 s24, 0x170000
    buffer_store_dword v3, v4, s[12:15], s24 offen offset:0 sc1
L_sig11:
    v_lshrrev_b32 v3, 2, v0
    v_mul_u32_u24 v3, 1056, v3
    v_and_b32 v4, 3, v0
    v_lshl_add_u32 v3, v4, 3, v3
    s_lshl_b32 s24, s3, 5
    v_add_u32 v3, s24, v3
    ds_read_b64_tr_b16 a[128:129], v3 offset:0
    ds_read_b64_tr_b16 a[130:131], v3 offset:128
    ds_read_b64_tr_b16 a[132:133], v3 offset:256
    ds_read_b64_tr_b16 a[134:135], v3 offset:384
    ds_read_b64_tr_b16 a[136:137], v3 offset:512
    ds_read_b64_tr_b16 a[138:139], v3 offset:640
    ds_read_b64_tr_b16 a[140:141], v3 offset:768
    ds_read_b64_tr_b16 a[142:143], v3 offset:896
    ds_read_b64_tr_b16 a[144:145], v3 offset:16896
    ds_read_b64_tr_b16 a[146:147], v3 offset:17024
    ds_read_b64_tr_b16 a[148:149], v3 offset:17152
    ds_read_b64_tr_b16 a[150:151], v3 offset:17280
    ds_read_b64_tr_b16 a[152:153], v3 offset:17408
    ds_read_b64_tr_b16 a[154:155], v3 offset:17536
    ds_read_b64_tr_b16 a[156:157], v3 offset:17664
    ds_read_b64_tr_b16 a[158:159], v3 offset:17792
    ds_read_b64_tr_b16 a[160:161], v3 offset:33792
    ds_read_b64_tr_b16 a[162:163], v3 offset:33920
    ds_read_b64_tr_b16 a[164:165], v3 offset:34048
    ds_read_b64_tr_b16 a[166:167], v3 offset:34176
    ds_read_b64_tr_b16 a[168:169], v3 offset:34304
    ds_read_b64_tr_b16 a[170:171], v3 offset:34432
    ds_read_b64_tr_b16 a[172:173], v3 offset:34560
    ds_read_b64_tr_b16 a[174:175], v3 offset:34688
    ds_read_b64_tr_b16 a[176:177], v3 offset:50688
    ds_read_b64_tr_b16 a[178:179], v3 offset:50816
    ds_read_b64_tr_b16 a[180:181], v3 offset:50944
    ds_read_b64_tr_b16 a[182:183], v3 offset:51072
    ds_read_b64_tr_b16 a[184:185], v3 offset:51200
    ds_read_b64_tr_b16 a[186:187], v3 offset:51328
    ds_read_b64_tr_b16 a[188:189], v3 offset:51456
    ds_read_b64_tr_b16 a[190:191], v3 offset:51584
    s_mov_b32 s4, s44
    s_mov_b32 s5, s45
    s_mov_b32 s6, 0x400000
    s_mov_b32 s7, 0x20000
    s_mov_b32 s8, s46
    s_mov_b32 s9, s47
    s_mov_b32 s10, 0x400000
    s_mov_b32 s11, 0x20000
    s_mov_b32 s32, s35
    buffer_load_dwordx4 v[128:131], v18, s[4:7], s32 offen nt
    s_add_u32 s32, s32, 8192
    buffer_load_dwordx4 v[132:135], v18, s[4:7], s32 offen nt
    s_add_u32 s32, s32, 8192
    buffer_load_dwordx4 v[136:139], v18, s[4:7], s32 offen nt
    s_add_u32 s32, s32, 8192
    buffer_load_dwordx4 v[140:143], v18, s[4:7], s32 offen nt
    s_add_u32 s32, s32, 8192
    buffer_load_dwordx4 v[144:147], v18, s[4:7], s32 offen nt
    s_add_u32 s32, s32, 8192
    buffer_load_dwordx4 v[148:151], v18, s[4:7], s32 offen nt
    s_add_u32 s32, s32, 8192
    buffer_load_dwordx4 v[152:155], v18, s[4:7], s32 offen nt
    s_add_u32 s32, s32, 8192
    buffer_load_dwordx4 v[156:159], v18, s[4:7], s32 offen nt
    s_add_u32 s32, s32, 8192
    buffer_load_dwordx4 v[160:163], v18, s[4:7], s32 offen nt
    s_add_u32 s32, s32, 8192
    buffer_load_dwordx4 v[164:167], v18, s[4:7], s32 offen nt
    s_add_u32 s32, s32, 8192
    buffer_load_dwordx4 v[168:171], v18, s[4:7], s32 offen nt
    s_add_u32 s32, s32, 8192
    buffer_load_dwordx4 v[172:175], v18, s[4:7], s32 offen nt
    s_add_u32 s32, s32, 8192
    buffer_load_dwordx4 v[176:179], v18, s[4:7], s32 offen nt
    s_add_u32 s32, s32, 8192
    buffer_load_dwordx4 v[180:183], v18, s[4:7], s32 offen nt
    s_add_u32 s32, s32, 8192
    buffer_load_dwordx4 v[184:187], v18, s[4:7], s32 offen nt
    s_add_u32 s32, s32, 8192
    buffer_load_dwordx4 v[188:191], v18, s[4:7], s32 offen nt
    s_add_u32 s32, s32, 8192
    buffer_load_dwordx4 v[192:195], v18, s[4:7], s32 offen nt
    s_add_u32 s32, s32, 8192
    buffer_load_dwordx4 v[196:199], v18, s[4:7], s32 offen nt
    s_add_u32 s32, s32, 8192
    buffer_load_dwordx4 v[200:203], v18, s[4:7], s32 offen nt
    s_add_u32 s32, s32, 8192
    buffer_load_dwordx4 v[204:207], v18, s[4:7], s32 offen nt
    s_add_u32 s32, s32, 8192
    buffer_load_dwordx4 v[208:211], v18, s[4:7], s32 offen nt
    s_add_u32 s32, s32, 8192
    buffer_load_dwordx4 v[212:215], v18, s[4:7], s32 offen nt
    s_add_u32 s32, s32, 8192
    buffer_load_dwordx4 v[216:219], v18, s[4:7], s32 offen nt
    s_add_u32 s32, s32, 8192
    buffer_load_dwordx4 v[220:223], v18, s[4:7], s32 offen nt
    s_add_u32 s32, s32, 8192
    buffer_load_dwordx4 v[224:227], v18, s[4:7], s32 offen nt
    s_add_u32 s32, s32, 8192
    buffer_load_dwordx4 v[228:231], v18, s[4:7], s32 offen nt
    s_add_u32 s32, s32, 8192
    buffer_load_dwordx4 v[232:235], v18, s[4:7], s32 offen nt
    s_add_u32 s32, s32, 8192
    buffer_load_dwordx4 v[236:239], v18, s[4:7], s32 offen nt
    s_add_u32 s32, s32, 8192
    buffer_load_dwordx4 v[240:243], v18, s[4:7], s32 offen nt
    s_add_u32 s32, s32, 8192
    buffer_load_dwordx4 v[244:247], v18, s[4:7], s32 offen nt
    s_add_u32 s32, s32, 8192
    buffer_load_dwordx4 v[248:251], v18, s[4:7], s32 offen nt
    s_add_u32 s32, s32, 8192
    buffer_load_dwordx4 v[252:255], v18, s[4:7], s32 offen nt
    s_add_u32 s32, s32, 8192
    s_lshl_b32 s33, s26, 17
    s_lshl_b32 s24, s3, 15
    s_add_u32 s33, s33, s24
    s_mul_i32 s34, s3, 33792
    s_waitcnt lgkmcnt(0)
    s_barrier
    s_mov_b32 s70, 0
L_woA:
    s_and_b32 s24, s70, 3
    s_lshl_b32 s24, s24, 1
    s_lshr_b32 s25, s70, 2
    s_or_b32 s24, s24, s25
    s_lshl_b32 s24, s24, 10
    s_add_u32 s24, s24, s33
    s_mul_i32 s25, s70, 4224
    s_add_u32 m0, s25, s34
    s_waitcnt vmcnt(24)
    buffer_load_dwordx4 v2, s[8:11], s24 offen nt lds
    s_add_u32 m0, m0, 1056
    s_add_u32 s24, s24, 8192
    s_waitcnt vmcnt(24)
    buffer_load_dwordx4 v2, s[8:11], s24 offen nt lds
    s_add_u32 m0, m0, 1056
    s_add_u32 s24, s24, 8192
    s_waitcnt vmcnt(24)
    buffer_load_dwordx4 v2, s[8:11], s24 offen nt lds
    s_add_u32 m0, m0, 1056
    s_add_u32 s24, s24, 8192
    s_waitcnt vmcnt(24)
    buffer_load_dwordx4 v2, s[8:11], s24 offen nt lds
    s_add_u32 s70, s70, 1
    s_cmp_lt_u32 s70, 8
    s_cbranch_scc1 L_woA
    s_waitcnt vmcnt(0)
    s_barrier
    v_lshrrev_b32 v3, 2, v0
    v_mul_u32_u24 v3, 1056, v3
    v_and_b32 v4, 3, v0
    v_lshl_add_u32 v3, v4, 3, v3
    s_lshl_b32 s24, s3, 8
    v_add_u32 v3, s24, v3
    v_add_u32 v4, 67584, v3
    ds_read_b64_tr_b16 a[0:1], v3 offset:0
    ds_read_b64_tr_b16 a[2:3], v3 offset:16896
    ds_read_b64_tr_b16 a[4:5], v3 offset:33792
    ds_read_b64_tr_b16 a[6:7], v3 offset:50688
    ds_read_b64_tr_b16 a[8:9], v4 offset:0
    ds_read_b64_tr_b16 a[10:11], v4 offset:16896
    ds_read_b64_tr_b16 a[12:13], v4 offset:33792
    ds_read_b64_tr_b16 a[14:15], v4 offset:50688
    ds_read_b64_tr_b16 a[16:17], v3 offset:32
    ds_read_b64_tr_b16 a[18:19], v3 offset:16928
    ds_read_b64_tr_b16 a[20:21], v3 offset:33824
    ds_read_b64_tr_b16 a[22:23], v3 offset:50720
    ds_read_b64_tr_b16 a[24:25], v4 offset:32
    ds_read_b64_tr_b16 a[26:27], v4 offset:16928
    ds_read_b64_tr_b16 a[28:29], v4 offset:33824
    ds_read_b64_tr_b16 a[30:31], v4 offset:50720
    ds_read_b64_tr_b16 a[32:33], v3 offset:64
    ds_read_b64_tr_b16 a[34:35], v3 offset:16960
    ds_read_b64_tr_b16 a[36:37], v3 offset:33856
    ds_read_b64_tr_b16 a[38:39], v3 offset:50752
    ds_read_b64_tr_b16 a[40:41], v4 offset:64
    ds_read_b64_tr_b16 a[42:43], v4 offset:16960
    ds_read_b64_tr_b16 a[44:45], v4 offset:33856
    ds_read_b64_tr_b16 a[46:47], v4 offset:50752
    ds_read_b64_tr_b16 a[48:49], v3 offset:96
    ds_read_b64_tr_b16 a[50:51], v3 offset:16992
    ds_read_b64_tr_b16 a[52:53], v3 offset:33888
    ds_read_b64_tr_b16 a[54:55], v3 offset:50784
    ds_read_b64_tr_b16 a[56:57], v4 offset:96
    ds_read_b64_tr_b16 a[58:59], v4 offset:16992
    ds_read_b64_tr_b16 a[60:61], v4 offset:33888
    ds_read_b64_tr_b16 a[62:63], v4 offset:50784
    ds_read_b64_tr_b16 a[64:65], v3 offset:128
    ds_read_b64_tr_b16 a[66:67], v3 offset:17024
    ds_read_b64_tr_b16 a[68:69], v3 offset:33920
    ds_read_b64_tr_b16 a[70:71], v3 offset:50816
    ds_read_b64_tr_b16 a[72:73], v4 offset:128
    ds_read_b64_tr_b16 a[74:75], v4 offset:17024
    ds_read_b64_tr_b16 a[76:77], v4 offset:33920
    ds_read_b64_tr_b16 a[78:79], v4 offset:50816
    ds_read_b64_tr_b16 a[80:81], v3 offset:160
    ds_read_b64_tr_b16 a[82:83], v3 offset:17056
    ds_read_b64_tr_b16 a[84:85], v3 offset:33952
    ds_read_b64_tr_b16 a[86:87], v3 offset:50848
    ds_read_b64_tr_b16 a[88:89], v4 offset:160
    ds_read_b64_tr_b16 a[90:91], v4 offset:17056
    ds_read_b64_tr_b16 a[92:93], v4 offset:33952
    ds_read_b64_tr_b16 a[94:95], v4 offset:50848
    ds_read_b64_tr_b16 a[96:97], v3 offset:192
    ds_read_b64_tr_b16 a[98:99], v3 offset:17088
    ds_read_b64_tr_b16 a[100:101], v3 offset:33984
    ds_read_b64_tr_b16 a[102:103], v3 offset:50880
    ds_read_b64_tr_b16 a[104:105], v4 offset:192
    ds_read_b64_tr_b16 a[106:107], v4 offset:17088
    ds_read_b64_tr_b16 a[108:109], v4 offset:33984
    ds_read_b64_tr_b16 a[110:111], v4 offset:50880
    ds_read_b64_tr_b16 a[112:113], v3 offset:224
    ds_read_b64_tr_b16 a[114:115], v3 offset:17120
    ds_read_b64_tr_b16 a[116:117], v3 offset:34016
    ds_read_b64_tr_b16 a[118:119], v3 offset:50912
    ds_read_b64_tr_b16 a[120:121], v4 offset:224
    ds_read_b64_tr_b16 a[122:123], v4 offset:17120
    ds_read_b64_tr_b16 a[124:125], v4 offset:34016
    ds_read_b64_tr_b16 a[126:127], v4 offset:50912
    s_waitcnt lgkmcnt(0)
    s_cmp_lg_u32 s3, 0
    s_cbranch_scc1 L_awx12
    s_mov_b32 s24, 262144
    s_mov_b64 exec, 1
L_aw13:
    buffer_load_dword v1, off, s[12:15], s73 offset:0 sc1
    s_waitcnt vmcnt(0)
    v_readfirstlane_b32 s25, v1
    s_nop 0
    s_cmp_eq_u32 s25, 1
    s_cbranch_scc1 L_awx12
    s_sleep 4
    s_sub_u32 s24, s24, 1
    s_cmp_lg_u32 s24, 0
    s_cbranch_scc1 L_aw13
L_awx12:
    s_mov_b64 exec, -1
    s_barrier
    s_cmp_lg_u32 s3, 0
    s_cbranch_scc1 L_xi14
    s_and_b32 s24, s74, 7
    s_lshl_b32 s24, s24, 5
    s_lshr_b32 s25, s74, 3
    s_add_u32 s24, s24, s25
    s_lshl_b32 s24, s24, 2
    s_add_u32 s24, s24, 0x1d8000
    s_getreg_b32 s25, hwreg(HW_REG_XCC_ID, 0, 4)
    s_mov_b64 exec, 1
    v_mov_b32 v3, s25
    buffer_store_dword v3, off, s[12:15], s24 sc1
    s_mov_b64 exec, -1
L_xi14:
    s_cmp_lg_u32 s3, 0
    s_cbranch_scc1 L_awx15
    s_mov_b32 s24, 262144
    s_mov_b64 exec, 1
L_aw16:
    buffer_load_dword v1, off, s[12:15], s73 offset:4 sc1
    s_waitcnt vmcnt(0)
    v_readfirstlane_b32 s25, v1
    s_nop 0
    s_cmp_eq_u32 s25, 1
    s_cbranch_scc1 L_awx15
    s_sleep 4
    s_sub_u32 s24, s24, 1
    s_cmp_lg_u32 s24, 0
    s_cbranch_scc1 L_aw16
L_awx15:
    s_mov_b64 exec, -1
    s_barrier
    s_lshl_b32 s24, s3, 10
    s_lshl_b32 s25, s26, 3
    s_add_u32 s25, s25, s24
    s_add_u32 s25, s25, 0x120000
    v_and_b32 v3, 3, v0
    v_lshlrev_b32 v3, 8, v3
    buffer_load_dwordx2 v[4:5], v3, s[12:15], s25 offen sc1
    s_lshl_b32 s24, s3, 18
    s_lshl_b32 s25, s26, 11
    s_add_u32 s24, s24, s25
    s_add_u32 s24, s24, 0x400000
    buffer_load_dwordx4 v[72:75], v2, s[12:15], s24 offen sc1 nt
    s_add_u32 s24, s24, 65536
    buffer_load_dwordx4 v[76:79], v2, s[12:15], s24 offen sc1 nt
    s_add_u32 s24, s24, 65536
    buffer_load_dwordx4 v[80:83], v2, s[12:15], s24 offen sc1 nt
    s_add_u32 s24, s24, 65536
    buffer_load_dwordx4 v[84:87], v2, s[12:15], s24 offen sc1 nt
    s_add_u32 s24, s24, 65536
    s_waitcnt vmcnt(4)
    v_mov_b32 v6, v4
    s_nop 1
    v_max_f32_dpp v6, v6, v6 row_ror:2 row_mask:0xf bank_mask:0xf
    s_nop 1
    v_max_f32_dpp v6, v6, v6 row_ror:1 row_mask:0xf bank_mask:0xf
    v_sub_f32 v4, v4, v6
    v_exp_f32 v4, v4
    s_nop 0
    v_mul_f32 v5, v4, v5
    s_nop 1
    v_add_f32_dpp v5, v5, v5 row_ror:2 row_mask:0xf bank_mask:0xf
    s_nop 1
    v_add_f32_dpp v5, v5, v5 row_ror:1 row_mask:0xf bank_mask:0xf
    v_rcp_f32 v5, v5
    s_nop 0
    v_mul_f32 v4, v4, v5
    s_nop 0
    v_readlane_b32 s24, v4, 0
    s_waitcnt vmcnt(3)
    v_lshlrev_b32 v5, 16, v72
    v_and_b32 v6, 0xffff0000, v72
    v_mul_f32 v104, s24, v5
    v_mul_f32 v105, s24, v6
    v_lshlrev_b32 v5, 16, v73
    v_and_b32 v6, 0xffff0000, v73
    v_mul_f32 v106, s24, v5
    v_mul_f32 v107, s24, v6
    v_lshlrev_b32 v5, 16, v74
    v_and_b32 v6, 0xffff0000, v74
    v_mul_f32 v108, s24, v5
    v_mul_f32 v109, s24, v6
    v_lshlrev_b32 v5, 16, v75
    v_and_b32 v6, 0xffff0000, v75
    v_mul_f32 v110, s24, v5
    v_mul_f32 v111, s24, v6
    v_readlane_b32 s24, v4, 1
    s_waitcnt vmcnt(2)
    v_lshlrev_b32 v5, 16, v76
    v_and_b32 v6, 0xffff0000, v76
    v_fmac_f32 v104, s24, v5
    v_fmac_f32 v105, s24, v6
    v_lshlrev_b32 v5, 16, v77
    v_and_b32 v6, 0xffff0000, v77
    v_fmac_f32 v106, s24, v5
    v_fmac_f32 v107, s24, v6
    v_lshlrev_b32 v5, 16, v78
    v_and_b32 v6, 0xffff0000, v78
    v_fmac_f32 v108, s24, v5
    v_fmac_f32 v109, s24, v6
    v_lshlrev_b32 v5, 16, v79
    v_and_b32 v6, 0xffff0000, v79
    v_fmac_f32 v110, s24, v5
    v_fmac_f32 v111, s24, v6
    v_readlane_b32 s24, v4, 2
    s_waitcnt vmcnt(1)
    v_lshlrev_b32 v5, 16, v80
    v_and_b32 v6, 0xffff0000, v80
    v_fmac_f32 v104, s24, v5
    v_fmac_f32 v105, s24, v6
    v_lshlrev_b32 v5, 16, v81
    v_and_b32 v6, 0xffff0000, v81
    v_fmac_f32 v106, s24, v5
    v_fmac_f32 v107, s24, v6
    v_lshlrev_b32 v5, 16, v82
    v_and_b32 v6, 0xffff0000, v82
    v_fmac_f32 v108, s24, v5
    v_fmac_f32 v109, s24, v6
    v_lshlrev_b32 v5, 16, v83
    v_and_b32 v6, 0xffff0000, v83
    v_fmac_f32 v110, s24, v5
    v_fmac_f32 v111, s24, v6
    v_readlane_b32 s24, v4, 3
    s_waitcnt vmcnt(0)
    v_lshlrev_b32 v5, 16, v84
    v_and_b32 v6, 0xffff0000, v84
    v_fmac_f32 v104, s24, v5
    v_fmac_f32 v105, s24, v6
    v_lshlrev_b32 v5, 16, v85
    v_and_b32 v6, 0xffff0000, v85
    v_fmac_f32 v106, s24, v5
    v_fmac_f32 v107, s24, v6
    v_lshlrev_b32 v5, 16, v86
    v_and_b32 v6, 0xffff0000, v86
    v_fmac_f32 v108, s24, v5
    v_fmac_f32 v109, s24, v6
    v_lshlrev_b32 v5, 16, v87
    v_and_b32 v6, 0xffff0000, v87
    v_fmac_f32 v110, s24, v5
    v_fmac_f32 v111, s24, v6
    v_cvt_pk_bf16_f32 v4, v104, v105
    v_cvt_pk_bf16_f32 v5, v106, v107
    v_cvt_pk_bf16_f32 v6, v108, v109
    v_cvt_pk_bf16_f32 v7, v110, v111
    s_lshl_b32 s24, s3, 10
    s_add_u32 s24, s24, 145408
    v_add_u32 v3, s24, v2
    ds_write_b128 v3, v[4:7]
    s_lshl_b32 s24, s3, 8
    s_add_u32 s24, s24, 145408
    v_add_u32 v3, s24, v19
    s_waitcnt lgkmcnt(0)
    s_barrier
    ds_read_b128 v[32:35], v3 offset:0
    ds_read_b128 v[36:39], v3 offset:16
    ds_read_b128 v[40:43], v3 offset:32
    ds_read_b128 v[44:47], v3 offset:48
    ds_read_b128 v[48:51], v3 offset:2048
    ds_read_b128 v[52:55], v3 offset:2064
    ds_read_b128 v[56:59], v3 offset:2080
    ds_read_b128 v[60:63], v3 offset:2096
    s_waitcnt lgkmcnt(0)
    v_perm_b32 v8, v32, v32, v24
    v_perm_b32 v9, v32, v32, v25
    v_perm_b32 v10, v32, v32, v26
    v_perm_b32 v11, v32, v32, v27
    v_perm_b32 v4, v48, v48, v24
    v_perm_b32 v5, v48, v48, v25
    v_perm_b32 v6, v48, v48, v26
    v_perm_b32 v7, v48, v48, v27
    v_mfma_f32_16x16x32_bf16 v[12:15], v[128:131], v[8:11], 0
    s_nop 0
    v_mfma_f32_16x16x32_bf16 v[68:71], v[128:131], v[4:7], 0
    v_perm_b32 v8, v32, v32, v28
    v_perm_b32 v9, v32, v32, v29
    v_perm_b32 v10, v32, v32, v30
    v_perm_b32 v11, v32, v32, v31
    v_perm_b32 v4, v48, v48, v28
    v_perm_b32 v5, v48, v48, v29
    v_perm_b32 v6, v48, v48, v30
    v_perm_b32 v7, v48, v48, v31
    v_mfma_f32_16x16x32_bf16 v[12:15], v[132:135], v[8:11], v[12:15]
    s_nop 0
    v_mfma_f32_16x16x32_bf16 v[68:71], v[132:135], v[4:7], v[68:71]
    v_perm_b32 v8, v33, v33, v24
    v_perm_b32 v9, v33, v33, v25
    v_perm_b32 v10, v33, v33, v26
    v_perm_b32 v11, v33, v33, v27
    v_perm_b32 v4, v49, v49, v24
    v_perm_b32 v5, v49, v49, v25
    v_perm_b32 v6, v49, v49, v26
    v_perm_b32 v7, v49, v49, v27
    v_mfma_f32_16x16x32_bf16 v[12:15], v[136:139], v[8:11], v[12:15]
    s_nop 0
    v_mfma_f32_16x16x32_bf16 v[68:71], v[136:139], v[4:7], v[68:71]
    v_perm_b32 v8, v33, v33, v28
    v_perm_b32 v9, v33, v33, v29
    v_perm_b32 v10, v33, v33, v30
    v_perm_b32 v11, v33, v33, v31
    v_perm_b32 v4, v49, v49, v28
    v_perm_b32 v5, v49, v49, v29
    v_perm_b32 v6, v49, v49, v30
    v_perm_b32 v7, v49, v49, v31
    v_mfma_f32_16x16x32_bf16 v[12:15], v[140:143], v[8:11], v[12:15]
    s_nop 0
    v_mfma_f32_16x16x32_bf16 v[68:71], v[140:143], v[4:7], v[68:71]
    v_perm_b32 v8, v34, v34, v24
    v_perm_b32 v9, v34, v34, v25
    v_perm_b32 v10, v34, v34, v26
    v_perm_b32 v11, v34, v34, v27
    v_perm_b32 v4, v50, v50, v24
    v_perm_b32 v5, v50, v50, v25
    v_perm_b32 v6, v50, v50, v26
    v_perm_b32 v7, v50, v50, v27
    v_mfma_f32_16x16x32_bf16 v[12:15], v[144:147], v[8:11], v[12:15]
    s_nop 0
    v_mfma_f32_16x16x32_bf16 v[68:71], v[144:147], v[4:7], v[68:71]
    v_perm_b32 v8, v34, v34, v28
    v_perm_b32 v9, v34, v34, v29
    v_perm_b32 v10, v34, v34, v30
    v_perm_b32 v11, v34, v34, v31
    v_perm_b32 v4, v50, v50, v28
    v_perm_b32 v5, v50, v50, v29
    v_perm_b32 v6, v50, v50, v30
    v_perm_b32 v7, v50, v50, v31
    v_mfma_f32_16x16x32_bf16 v[12:15], v[148:151], v[8:11], v[12:15]
    s_nop 0
    v_mfma_f32_16x16x32_bf16 v[68:71], v[148:151], v[4:7], v[68:71]
    v_perm_b32 v8, v35, v35, v24
    v_perm_b32 v9, v35, v35, v25
    v_perm_b32 v10, v35, v35, v26
    v_perm_b32 v11, v35, v35, v27
    v_perm_b32 v4, v51, v51, v24
    v_perm_b32 v5, v51, v51, v25
    v_perm_b32 v6, v51, v51, v26
    v_perm_b32 v7, v51, v51, v27
    v_mfma_f32_16x16x32_bf16 v[12:15], v[152:155], v[8:11], v[12:15]
    s_nop 0
    v_mfma_f32_16x16x32_bf16 v[68:71], v[152:155], v[4:7], v[68:71]
    v_perm_b32 v8, v35, v35, v28
    v_perm_b32 v9, v35, v35, v29
    v_perm_b32 v10, v35, v35, v30
    v_perm_b32 v11, v35, v35, v31
    v_perm_b32 v4, v51, v51, v28
    v_perm_b32 v5, v51, v51, v29
    v_perm_b32 v6, v51, v51, v30
    v_perm_b32 v7, v51, v51, v31
    v_mfma_f32_16x16x32_bf16 v[12:15], v[156:159], v[8:11], v[12:15]
    s_nop 0
    v_mfma_f32_16x16x32_bf16 v[68:71], v[156:159], v[4:7], v[68:71]
    v_perm_b32 v8, v36, v36, v24
    v_perm_b32 v9, v36, v36, v25
    v_perm_b32 v10, v36, v36, v26
    v_perm_b32 v11, v36, v36, v27
    v_perm_b32 v4, v52, v52, v24
    v_perm_b32 v5, v52, v52, v25
    v_perm_b32 v6, v52, v52, v26
    v_perm_b32 v7, v52, v52, v27
    v_mfma_f32_16x16x32_bf16 v[12:15], v[160:163], v[8:11], v[12:15]
    s_nop 0
    v_mfma_f32_16x16x32_bf16 v[68:71], v[160:163], v[4:7], v[68:71]
    v_perm_b32 v8, v36, v36, v28
    v_perm_b32 v9, v36, v36, v29
    v_perm_b32 v10, v36, v36, v30
    v_perm_b32 v11, v36, v36, v31
    v_perm_b32 v4, v52, v52, v28
    v_perm_b32 v5, v52, v52, v29
    v_perm_b32 v6, v52, v52, v30
    v_perm_b32 v7, v52, v52, v31
    v_mfma_f32_16x16x32_bf16 v[12:15], v[164:167], v[8:11], v[12:15]
    s_nop 0
    v_mfma_f32_16x16x32_bf16 v[68:71], v[164:167], v[4:7], v[68:71]
    v_perm_b32 v8, v37, v37, v24
    v_perm_b32 v9, v37, v37, v25
    v_perm_b32 v10, v37, v37, v26
    v_perm_b32 v11, v37, v37, v27
    v_perm_b32 v4, v53, v53, v24
    v_perm_b32 v5, v53, v53, v25
    v_perm_b32 v6, v53, v53, v26
    v_perm_b32 v7, v53, v53, v27
    v_mfma_f32_16x16x32_bf16 v[12:15], v[168:171], v[8:11], v[12:15]
    s_nop 0
    v_mfma_f32_16x16x32_bf16 v[68:71], v[168:171], v[4:7], v[68:71]
    v_perm_b32 v8, v37, v37, v28
    v_perm_b32 v9, v37, v37, v29
    v_perm_b32 v10, v37, v37, v30
    v_perm_b32 v11, v37, v37, v31
    v_perm_b32 v4, v53, v53, v28
    v_perm_b32 v5, v53, v53, v29
    v_perm_b32 v6, v53, v53, v30
    v_perm_b32 v7, v53, v53, v31
    v_mfma_f32_16x16x32_bf16 v[12:15], v[172:175], v[8:11], v[12:15]
    s_nop 0
    v_mfma_f32_16x16x32_bf16 v[68:71], v[172:175], v[4:7], v[68:71]
    v_perm_b32 v8, v38, v38, v24
    v_perm_b32 v9, v38, v38, v25
    v_perm_b32 v10, v38, v38, v26
    v_perm_b32 v11, v38, v38, v27
    v_perm_b32 v4, v54, v54, v24
    v_perm_b32 v5, v54, v54, v25
    v_perm_b32 v6, v54, v54, v26
    v_perm_b32 v7, v54, v54, v27
    v_mfma_f32_16x16x32_bf16 v[12:15], v[176:179], v[8:11], v[12:15]
    s_nop 0
    v_mfma_f32_16x16x32_bf16 v[68:71], v[176:179], v[4:7], v[68:71]
    v_perm_b32 v8, v38, v38, v28
    v_perm_b32 v9, v38, v38, v29
    v_perm_b32 v10, v38, v38, v30
    v_perm_b32 v11, v38, v38, v31
    v_perm_b32 v4, v54, v54, v28
    v_perm_b32 v5, v54, v54, v29
    v_perm_b32 v6, v54, v54, v30
    v_perm_b32 v7, v54, v54, v31
    v_mfma_f32_16x16x32_bf16 v[12:15], v[180:183], v[8:11], v[12:15]
    s_nop 0
    v_mfma_f32_16x16x32_bf16 v[68:71], v[180:183], v[4:7], v[68:71]
    v_perm_b32 v8, v39, v39, v24
    v_perm_b32 v9, v39, v39, v25
    v_perm_b32 v10, v39, v39, v26
    v_perm_b32 v11, v39, v39, v27
    v_perm_b32 v4, v55, v55, v24
    v_perm_b32 v5, v55, v55, v25
    v_perm_b32 v6, v55, v55, v26
    v_perm_b32 v7, v55, v55, v27
    v_mfma_f32_16x16x32_bf16 v[12:15], v[184:187], v[8:11], v[12:15]
    s_nop 0
    v_mfma_f32_16x16x32_bf16 v[68:71], v[184:187], v[4:7], v[68:71]
    v_perm_b32 v8, v39, v39, v28
    v_perm_b32 v9, v39, v39, v29
    v_perm_b32 v10, v39, v39, v30
    v_perm_b32 v11, v39, v39, v31
    v_perm_b32 v4, v55, v55, v28
    v_perm_b32 v5, v55, v55, v29
    v_perm_b32 v6, v55, v55, v30
    v_perm_b32 v7, v55, v55, v31
    v_mfma_f32_16x16x32_bf16 v[12:15], v[188:191], v[8:11], v[12:15]
    s_nop 0
    v_mfma_f32_16x16x32_bf16 v[68:71], v[188:191], v[4:7], v[68:71]
    v_perm_b32 v8, v40, v40, v24
    v_perm_b32 v9, v40, v40, v25
    v_perm_b32 v10, v40, v40, v26
    v_perm_b32 v11, v40, v40, v27
    v_perm_b32 v4, v56, v56, v24
    v_perm_b32 v5, v56, v56, v25
    v_perm_b32 v6, v56, v56, v26
    v_perm_b32 v7, v56, v56, v27
    v_mfma_f32_16x16x32_bf16 v[12:15], v[192:195], v[8:11], v[12:15]
    s_nop 0
    v_mfma_f32_16x16x32_bf16 v[68:71], v[192:195], v[4:7], v[68:71]
    v_perm_b32 v8, v40, v40, v28
    v_perm_b32 v9, v40, v40, v29
    v_perm_b32 v10, v40, v40, v30
    v_perm_b32 v11, v40, v40, v31
    v_perm_b32 v4, v56, v56, v28
    v_perm_b32 v5, v56, v56, v29
    v_perm_b32 v6, v56, v56, v30
    v_perm_b32 v7, v56, v56, v31
    v_mfma_f32_16x16x32_bf16 v[12:15], v[196:199], v[8:11], v[12:15]
    s_nop 0
    v_mfma_f32_16x16x32_bf16 v[68:71], v[196:199], v[4:7], v[68:71]
    v_perm_b32 v8, v41, v41, v24
    v_perm_b32 v9, v41, v41, v25
    v_perm_b32 v10, v41, v41, v26
    v_perm_b32 v11, v41, v41, v27
    v_perm_b32 v4, v57, v57, v24
    v_perm_b32 v5, v57, v57, v25
    v_perm_b32 v6, v57, v57, v26
    v_perm_b32 v7, v57, v57, v27
    v_mfma_f32_16x16x32_bf16 v[12:15], v[200:203], v[8:11], v[12:15]
    s_nop 0
    v_mfma_f32_16x16x32_bf16 v[68:71], v[200:203], v[4:7], v[68:71]
    v_perm_b32 v8, v41, v41, v28
    v_perm_b32 v9, v41, v41, v29
    v_perm_b32 v10, v41, v41, v30
    v_perm_b32 v11, v41, v41, v31
    v_perm_b32 v4, v57, v57, v28
    v_perm_b32 v5, v57, v57, v29
    v_perm_b32 v6, v57, v57, v30
    v_perm_b32 v7, v57, v57, v31
    v_mfma_f32_16x16x32_bf16 v[12:15], v[204:207], v[8:11], v[12:15]
    s_nop 0
    v_mfma_f32_16x16x32_bf16 v[68:71], v[204:207], v[4:7], v[68:71]
    v_perm_b32 v8, v42, v42, v24
    v_perm_b32 v9, v42, v42, v25
    v_perm_b32 v10, v42, v42, v26
    v_perm_b32 v11, v42, v42, v27
    v_perm_b32 v4, v58, v58, v24
    v_perm_b32 v5, v58, v58, v25
    v_perm_b32 v6, v58, v58, v26
    v_perm_b32 v7, v58, v58, v27
    v_mfma_f32_16x16x32_bf16 v[12:15], v[208:211], v[8:11], v[12:15]
    s_nop 0
    v_mfma_f32_16x16x32_bf16 v[68:71], v[208:211], v[4:7], v[68:71]
    v_perm_b32 v8, v42, v42, v28
    v_perm_b32 v9, v42, v42, v29
    v_perm_b32 v10, v42, v42, v30
    v_perm_b32 v11, v42, v42, v31
    v_perm_b32 v4, v58, v58, v28
    v_perm_b32 v5, v58, v58, v29
    v_perm_b32 v6, v58, v58, v30
    v_perm_b32 v7, v58, v58, v31
    v_mfma_f32_16x16x32_bf16 v[12:15], v[212:215], v[8:11], v[12:15]
    s_nop 0
    v_mfma_f32_16x16x32_bf16 v[68:71], v[212:215], v[4:7], v[68:71]
    v_perm_b32 v8, v43, v43, v24
    v_perm_b32 v9, v43, v43, v25
    v_perm_b32 v10, v43, v43, v26
    v_perm_b32 v11, v43, v43, v27
    v_perm_b32 v4, v59, v59, v24
    v_perm_b32 v5, v59, v59, v25
    v_perm_b32 v6, v59, v59, v26
    v_perm_b32 v7, v59, v59, v27
    v_mfma_f32_16x16x32_bf16 v[12:15], v[216:219], v[8:11], v[12:15]
    s_nop 0
    v_mfma_f32_16x16x32_bf16 v[68:71], v[216:219], v[4:7], v[68:71]
    v_perm_b32 v8, v43, v43, v28
    v_perm_b32 v9, v43, v43, v29
    v_perm_b32 v10, v43, v43, v30
    v_perm_b32 v11, v43, v43, v31
    v_perm_b32 v4, v59, v59, v28
    v_perm_b32 v5, v59, v59, v29
    v_perm_b32 v6, v59, v59, v30
    v_perm_b32 v7, v59, v59, v31
    v_mfma_f32_16x16x32_bf16 v[12:15], v[220:223], v[8:11], v[12:15]
    s_nop 0
    v_mfma_f32_16x16x32_bf16 v[68:71], v[220:223], v[4:7], v[68:71]
    v_perm_b32 v8, v44, v44, v24
    v_perm_b32 v9, v44, v44, v25
    v_perm_b32 v10, v44, v44, v26
    v_perm_b32 v11, v44, v44, v27
    v_perm_b32 v4, v60, v60, v24
    v_perm_b32 v5, v60, v60, v25
    v_perm_b32 v6, v60, v60, v26
    v_perm_b32 v7, v60, v60, v27
    v_mfma_f32_16x16x32_bf16 v[12:15], v[224:227], v[8:11], v[12:15]
    s_nop 0
    v_mfma_f32_16x16x32_bf16 v[68:71], v[224:227], v[4:7], v[68:71]
    v_perm_b32 v8, v44, v44, v28
    v_perm_b32 v9, v44, v44, v29
    v_perm_b32 v10, v44, v44, v30
    v_perm_b32 v11, v44, v44, v31
    v_perm_b32 v4, v60, v60, v28
    v_perm_b32 v5, v60, v60, v29
    v_perm_b32 v6, v60, v60, v30
    v_perm_b32 v7, v60, v60, v31
    v_mfma_f32_16x16x32_bf16 v[12:15], v[228:231], v[8:11], v[12:15]
    s_nop 0
    v_mfma_f32_16x16x32_bf16 v[68:71], v[228:231], v[4:7], v[68:71]
    v_perm_b32 v8, v45, v45, v24
    v_perm_b32 v9, v45, v45, v25
    v_perm_b32 v10, v45, v45, v26
    v_perm_b32 v11, v45, v45, v27
    v_perm_b32 v4, v61, v61, v24
    v_perm_b32 v5, v61, v61, v25
    v_perm_b32 v6, v61, v61, v26
    v_perm_b32 v7, v61, v61, v27
    v_mfma_f32_16x16x32_bf16 v[12:15], v[232:235], v[8:11], v[12:15]
    s_nop 0
    v_mfma_f32_16x16x32_bf16 v[68:71], v[232:235], v[4:7], v[68:71]
    v_perm_b32 v8, v45, v45, v28
    v_perm_b32 v9, v45, v45, v29
    v_perm_b32 v10, v45, v45, v30
    v_perm_b32 v11, v45, v45, v31
    v_perm_b32 v4, v61, v61, v28
    v_perm_b32 v5, v61, v61, v29
    v_perm_b32 v6, v61, v61, v30
    v_perm_b32 v7, v61, v61, v31
    v_mfma_f32_16x16x32_bf16 v[12:15], v[236:239], v[8:11], v[12:15]
    s_nop 0
    v_mfma_f32_16x16x32_bf16 v[68:71], v[236:239], v[4:7], v[68:71]
    v_perm_b32 v8, v46, v46, v24
    v_perm_b32 v9, v46, v46, v25
    v_perm_b32 v10, v46, v46, v26
    v_perm_b32 v11, v46, v46, v27
    v_perm_b32 v4, v62, v62, v24
    v_perm_b32 v5, v62, v62, v25
    v_perm_b32 v6, v62, v62, v26
    v_perm_b32 v7, v62, v62, v27
    v_mfma_f32_16x16x32_bf16 v[12:15], v[240:243], v[8:11], v[12:15]
    s_nop 0
    v_mfma_f32_16x16x32_bf16 v[68:71], v[240:243], v[4:7], v[68:71]
    v_perm_b32 v8, v46, v46, v28
    v_perm_b32 v9, v46, v46, v29
    v_perm_b32 v10, v46, v46, v30
    v_perm_b32 v11, v46, v46, v31
    v_perm_b32 v4, v62, v62, v28
    v_perm_b32 v5, v62, v62, v29
    v_perm_b32 v6, v62, v62, v30
    v_perm_b32 v7, v62, v62, v31
    v_mfma_f32_16x16x32_bf16 v[12:15], v[244:247], v[8:11], v[12:15]
    s_nop 0
    v_mfma_f32_16x16x32_bf16 v[68:71], v[244:247], v[4:7], v[68:71]
    v_perm_b32 v8, v47, v47, v24
    v_perm_b32 v9, v47, v47, v25
    v_perm_b32 v10, v47, v47, v26
    v_perm_b32 v11, v47, v47, v27
    v_perm_b32 v4, v63, v63, v24
    v_perm_b32 v5, v63, v63, v25
    v_perm_b32 v6, v63, v63, v26
    v_perm_b32 v7, v63, v63, v27
    v_mfma_f32_16x16x32_bf16 v[12:15], v[248:251], v[8:11], v[12:15]
    s_nop 0
    v_mfma_f32_16x16x32_bf16 v[68:71], v[248:251], v[4:7], v[68:71]
    v_perm_b32 v8, v47, v47, v28
    v_perm_b32 v9, v47, v47, v29
    v_perm_b32 v10, v47, v47, v30
    v_perm_b32 v11, v47, v47, v31
    v_perm_b32 v4, v63, v63, v28
    v_perm_b32 v5, v63, v63, v29
    v_perm_b32 v6, v63, v63, v30
    v_perm_b32 v7, v63, v63, v31
    v_mfma_f32_16x16x32_bf16 v[12:15], v[252:255], v[8:11], v[12:15]
    s_nop 0
    v_mfma_f32_16x16x32_bf16 v[68:71], v[252:255], v[4:7], v[68:71]
    v_lshrrev_b32 v3, 4, v0
    v_lshlrev_b32 v3, 7, v3
    v_and_b32 v4, 7, v0
    v_lshl_add_u32 v3, v4, 4, v3
    v_bfe_u32 v4, v0, 3, 1
    v_lshl_add_u32 v3, v4, 9, v3
    s_lshl_b32 s24, s3, 11
    s_add_u32 s24, s24, 135168
    v_add_u32 v3, s24, v3
    ds_write_b128 v3, v[12:15]
    ds_write_b128 v3, v[68:71] offset:1024
    s_waitcnt lgkmcnt(0)
    s_barrier
    v_and_b32 v5, 31, v0
    s_lshl_b32 s24, s3, 9
    s_add_u32 s24, s24, 135168
    v_lshl_add_u32 v3, v5, 4, s24
    ds_read_b128 v[72:75], v3 offset:0
    ds_read_b128 v[76:79], v3 offset:2048
    ds_read_b128 v[80:83], v3 offset:4096
    ds_read_b128 v[84:87], v3 offset:6144
    s_mul_i32 s24, s3, 320
    s_add_u32 s24, s24, 143360
    v_lshl_add_u32 v5, v5, 3, s24
    s_waitcnt lgkmcnt(0)
    v_add_f32 v72, v72, v76
    v_add_f32 v73, v73, v77
    v_add_f32 v74, v74, v78
    v_add_f32 v75, v75, v79
    v_add_f32 v72, v72, v80
    v_add_f32 v73, v73, v81
    v_add_f32 v74, v74, v82
    v_add_f32 v75, v75, v83
    v_add_f32 v72, v72, v84
    v_add_f32 v73, v73, v85
    v_add_f32 v74, v74, v86
    v_add_f32 v75, v75, v87
    v_cvt_pk_bf16_f32 v6, v72, v73
    v_cvt_pk_bf16_f32 v7, v74, v75
    ds_write_b64 v5, v[6:7]
    v_lshrrev_b32 v3, 4, v0
    v_and_b32 v4, 3, v0
    v_mul_u32_u24 v5, 320, v4
    v_lshl_add_u32 v5, v3, 4, v5
    v_add_u32 v5, 143360, v5
    s_waitcnt lgkmcnt(0)
    s_barrier
    ds_read_b128 v[32:35], v5 offset:0
    ds_read_b128 v[36:39], v5 offset:64
    ds_read_b128 v[40:43], v5 offset:128
    ds_read_b128 v[44:47], v5 offset:192
    s_waitcnt lgkmcnt(3)
    v_mfma_f32_16x16x32_bf16 v[72:75], v[32:35], a[0:3], 0
    s_waitcnt lgkmcnt(2)
    v_mfma_f32_16x16x32_bf16 v[72:75], v[36:39], a[4:7], v[72:75]
    s_waitcnt lgkmcnt(1)
    v_mfma_f32_16x16x32_bf16 v[72:75], v[40:43], a[8:11], v[72:75]
    s_waitcnt lgkmcnt(0)
    v_mfma_f32_16x16x32_bf16 v[72:75], v[44:47], a[12:15], v[72:75]
    v_mfma_f32_16x16x32_bf16 v[76:79], v[32:35], a[16:19], 0
    v_mfma_f32_16x16x32_bf16 v[76:79], v[36:39], a[20:23], v[76:79]
    v_mfma_f32_16x16x32_bf16 v[76:79], v[40:43], a[24:27], v[76:79]
    v_mfma_f32_16x16x32_bf16 v[76:79], v[44:47], a[28:31], v[76:79]
    v_mfma_f32_16x16x32_bf16 v[80:83], v[32:35], a[32:35], 0
    v_mfma_f32_16x16x32_bf16 v[80:83], v[36:39], a[36:39], v[80:83]
    v_mfma_f32_16x16x32_bf16 v[80:83], v[40:43], a[40:43], v[80:83]
    v_mfma_f32_16x16x32_bf16 v[80:83], v[44:47], a[44:47], v[80:83]
    v_mov_b32_dpp v4, v72 quad_perm:[0,1,2,3] row_mask:0x1 bank_mask:0xf
    v_mov_b32_dpp v5, v73 quad_perm:[0,1,2,3] row_mask:0x1 bank_mask:0xf
    v_mov_b32_dpp v6, v74 quad_perm:[0,1,2,3] row_mask:0x1 bank_mask:0xf
    v_mov_b32_dpp v7, v75 quad_perm:[0,1,2,3] row_mask:0x1 bank_mask:0xf
    v_mfma_f32_16x16x32_bf16 v[84:87], v[32:35], a[48:51], 0
    v_mfma_f32_16x16x32_bf16 v[84:87], v[36:39], a[52:55], v[84:87]
    v_mfma_f32_16x16x32_bf16 v[84:87], v[40:43], a[56:59], v[84:87]
    v_mfma_f32_16x16x32_bf16 v[84:87], v[44:47], a[60:63], v[84:87]
    v_mov_b32_dpp v4, v76 quad_perm:[0,1,2,3] row_mask:0x2 bank_mask:0xf
    v_mov_b32_dpp v5, v77 quad_perm:[0,1,2,3] row_mask:0x2 bank_mask:0xf
    v_mov_b32_dpp v6, v78 quad_perm:[0,1,2,3] row_mask:0x2 bank_mask:0xf
    v_mov_b32_dpp v7, v79 quad_perm:[0,1,2,3] row_mask:0x2 bank_mask:0xf
    v_mfma_f32_16x16x32_bf16 v[88:91], v[32:35], a[64:67], 0
    v_mfma_f32_16x16x32_bf16 v[88:91], v[36:39], a[68:71], v[88:91]
    v_mfma_f32_16x16x32_bf16 v[88:91], v[40:43], a[72:75], v[88:91]
    v_mfma_f32_16x16x32_bf16 v[88:91], v[44:47], a[76:79], v[88:91]
    v_mov_b32_dpp v4, v80 quad_perm:[0,1,2,3] row_mask:0x4 bank_mask:0xf
    v_mov_b32_dpp v5, v81 quad_perm:[0,1,2,3] row_mask:0x4 bank_mask:0xf
    v_mov_b32_dpp v6, v82 quad_perm:[0,1,2,3] row_mask:0x4 bank_mask:0xf
    v_mov_b32_dpp v7, v83 quad_perm:[0,1,2,3] row_mask:0x4 bank_mask:0xf
    v_mfma_f32_16x16x32_bf16 v[92:95], v[32:35], a[80:83], 0
    v_mfma_f32_16x16x32_bf16 v[92:95], v[36:39], a[84:87], v[92:95]
    v_mfma_f32_16x16x32_bf16 v[92:95], v[40:43], a[88:91], v[92:95]
    v_mfma_f32_16x16x32_bf16 v[92:95], v[44:47], a[92:95], v[92:95]
    v_mov_b32_dpp v4, v84 quad_perm:[0,1,2,3] row_mask:0x8 bank_mask:0xf
    v_mov_b32_dpp v5, v85 quad_perm:[0,1,2,3] row_mask:0x8 bank_mask:0xf
    v_mov_b32_dpp v6, v86 quad_perm:[0,1,2,3] row_mask:0x8 bank_mask:0xf
    v_mov_b32_dpp v7, v87 quad_perm:[0,1,2,3] row_mask:0x8 bank_mask:0xf
    v_mfma_f32_16x16x32_bf16 v[96:99], v[32:35], a[96:99], 0
    v_mfma_f32_16x16x32_bf16 v[96:99], v[36:39], a[100:103], v[96:99]
    v_mfma_f32_16x16x32_bf16 v[96:99], v[40:43], a[104:107], v[96:99]
    v_mfma_f32_16x16x32_bf16 v[96:99], v[44:47], a[108:111], v[96:99]
    v_mov_b32_dpp v8, v88 quad_perm:[0,1,2,3] row_mask:0x1 bank_mask:0xf
    v_mov_b32_dpp v9, v89 quad_perm:[0,1,2,3] row_mask:0x1 bank_mask:0xf
    v_mov_b32_dpp v10, v90 quad_perm:[0,1,2,3] row_mask:0x1 bank_mask:0xf
    v_mov_b32_dpp v11, v91 quad_perm:[0,1,2,3] row_mask:0x1 bank_mask:0xf
    v_mfma_f32_16x16x32_bf16 v[100:103], v[32:35], a[112:115], 0
    v_mfma_f32_16x16x32_bf16 v[100:103], v[36:39], a[116:119], v[100:103]
    v_mfma_f32_16x16x32_bf16 v[100:103], v[40:43], a[120:123], v[100:103]
    v_mfma_f32_16x16x32_bf16 v[100:103], v[44:47], a[124:127], v[100:103]
    v_mov_b32_dpp v8, v92 quad_perm:[0,1,2,3] row_mask:0x2 bank_mask:0xf
    v_mov_b32_dpp v9, v93 quad_perm:[0,1,2,3] row_mask:0x2 bank_mask:0xf
    v_mov_b32_dpp v10, v94 quad_perm:[0,1,2,3] row_mask:0x2 bank_mask:0xf
    v_mov_b32_dpp v11, v95 quad_perm:[0,1,2,3] row_mask:0x2 bank_mask:0xf
    v_mov_b32_dpp v8, v96 quad_perm:[0,1,2,3] row_mask:0x4 bank_mask:0xf
    v_mov_b32_dpp v9, v97 quad_perm:[0,1,2,3] row_mask:0x4 bank_mask:0xf
    v_mov_b32_dpp v10, v98 quad_perm:[0,1,2,3] row_mask:0x4 bank_mask:0xf
    v_mov_b32_dpp v11, v99 quad_perm:[0,1,2,3] row_mask:0x4 bank_mask:0xf
    v_mov_b32_dpp v8, v100 quad_perm:[0,1,2,3] row_mask:0x8 bank_mask:0xf
    v_mov_b32_dpp v9, v101 quad_perm:[0,1,2,3] row_mask:0x8 bank_mask:0xf
    v_mov_b32_dpp v10, v102 quad_perm:[0,1,2,3] row_mask:0x8 bank_mask:0xf
    v_mov_b32_dpp v11, v103 quad_perm:[0,1,2,3] row_mask:0x8 bank_mask:0xf
    v_cvt_pk_bf16_f32 v12, v4, v5
    v_cvt_pk_bf16_f32 v13, v6, v7
    v_cvt_pk_bf16_f32 v14, v8, v9
    v_cvt_pk_bf16_f32 v15, v10, v11
    s_mov_b32 s20, s58
    s_mov_b32 s21, s59
    s_mov_b32 s22, 0x2000
    s_mov_b32 s23, 0x20000
    v_and_b32 v3, 3, v0
    v_lshlrev_b32 v80, 4, v3
    v_bfe_u32 v4, v0, 2, 1
    v_lshl_add_u32 v80, v4, 3, v80
    v_lshrrev_b32 v5, 3, v0
    v_lshl_add_u32 v80, v5, 6, v80
    v_lshlrev_b32 v82, 11, v3
    v_lshl_add_u32 v82, v4, 3, v82
    v_lshrrev_b32 v3, 4, v0
    v_lshl_add_u32 v82, v3, 4, v82
    v_and_b32 v5, 1, v5
    v_lshl_add_u32 v82, v5, 6, v82
    v_and_b32 v81, 0xf0, v2
    v_lshl_add_u32 v81, v3, 14, v81
    v_cmp_eq_u32 vcc, 0, v5
    v_mov_b32 v3, 0x3f803f80
    s_nop 0
    v_cndmask_b32 v4, 0, v3, vcc
    v_xor_b32 v5, v3, v4
    v_and_b32 v84, v4, v20
    v_and_b32 v88, v5, v20
    v_and_b32 v85, v4, v21
    v_and_b32 v89, v5, v21
    v_and_b32 v86, v4, v22
    v_and_b32 v90, v5, v22
    v_and_b32 v87, v4, v23
    v_and_b32 v91, v5, v23
    s_lshl_b32 s30, s3, 12
    s_add_u32 s30, s30, 0x80000
    s_lshl_b32 s24, s26, 14
    s_add_u32 s24, s24, s30
    buffer_store_dwordx2 v[12:13], v80, s[12:15], s24 offen sc1 nt
    buffer_store_dwordx2 v[14:15], v80, s[12:15], s24 offen offset:512 sc1 nt
    s_lshl_b32 s24, s3, 7
    s_add_u32 s24, s24, 0x1d9000
    s_waitcnt vmcnt(0)
    s_mov_b64 exec, 1
    v_mov_b32 v83, 64
    buffer_atomic_add v83, off, s[12:15], s24 sc0
    s_mov_b64 exec, -1
    s_waitcnt vmcnt(0)
    v_readfirstlane_b32 s24, v83
    s_nop 0
    s_cmp_lg_u32 s24, 1983
    s_cbranch_scc1 L_W_x
    s_lshl_b32 s31, s3, 8
L_W_f:
    s_mov_b32 s25, 262144
L_fi17:
    s_mov_b32 s24, s30
    buffer_load_dwordx4 v[128:131], v81, s[12:15], s24 offen offset:0 sc1 nt
    buffer_load_dwordx4 v[132:135], v81, s[12:15], s24 offen offset:256 sc1 nt
    s_add_u32 s24, s24, 65536
    buffer_load_dwordx4 v[136:139], v81, s[12:15], s24 offen offset:0 sc1 nt
    buffer_load_dwordx4 v[140:143], v81, s[12:15], s24 offen offset:256 sc1 nt
    s_add_u32 s24, s24, 65536
    buffer_load_dwordx4 v[144:147], v81, s[12:15], s24 offen offset:0 sc1 nt
    buffer_load_dwordx4 v[148:151], v81, s[12:15], s24 offen offset:256 sc1 nt
    s_add_u32 s24, s24, 65536
    buffer_load_dwordx4 v[152:155], v81, s[12:15], s24 offen offset:0 sc1 nt
    buffer_load_dwordx4 v[156:159], v81, s[12:15], s24 offen offset:256 sc1 nt
    s_add_u32 s24, s24, 65536
    buffer_load_dwordx4 v[160:163], v81, s[12:15], s24 offen offset:0 sc1 nt
    buffer_load_dwordx4 v[164:167], v81, s[12:15], s24 offen offset:256 sc1 nt
    s_add_u32 s24, s24, 65536
    buffer_load_dwordx4 v[168:171], v81, s[12:15], s24 offen offset:0 sc1 nt
    buffer_load_dwordx4 v[172:175], v81, s[12:15], s24 offen offset:256 sc1 nt
    s_add_u32 s24, s24, 65536
    buffer_load_dwordx4 v[176:179], v81, s[12:15], s24 offen offset:0 sc1 nt
    buffer_load_dwordx4 v[180:183], v81, s[12:15], s24 offen offset:256 sc1 nt
    s_add_u32 s24, s24, 65536
    buffer_load_dwordx4 v[184:187], v81, s[12:15], s24 offen offset:0 sc1 nt
    buffer_load_dwordx4 v[188:191], v81, s[12:15], s24 offen offset:256 sc1 nt
    s_waitcnt vmcnt(15)
    v_mfma_f32_16x16x32_bf16 v[92:95], v[128:131], v[84:87], 0
    s_waitcnt vmcnt(14)
    v_mfma_f32_16x16x32_bf16 v[92:95], v[132:135], v[88:91], v[92:95]
    s_waitcnt vmcnt(13)
    v_mfma_f32_16x16x32_bf16 v[92:95], v[136:139], v[84:87], v[92:95]
    s_waitcnt vmcnt(12)
    v_mfma_f32_16x16x32_bf16 v[92:95], v[140:143], v[88:91], v[92:95]
    s_waitcnt vmcnt(11)
    v_mfma_f32_16x16x32_bf16 v[92:95], v[144:147], v[84:87], v[92:95]
    s_waitcnt vmcnt(10)
    v_mfma_f32_16x16x32_bf16 v[92:95], v[148:151], v[88:91], v[92:95]
    s_waitcnt vmcnt(9)
    v_mfma_f32_16x16x32_bf16 v[92:95], v[152:155], v[84:87], v[92:95]
    s_waitcnt vmcnt(8)
    v_mfma_f32_16x16x32_bf16 v[92:95], v[156:159], v[88:91], v[92:95]
    s_waitcnt vmcnt(7)
    v_mfma_f32_16x16x32_bf16 v[92:95], v[160:163], v[84:87], v[92:95]
    s_waitcnt vmcnt(6)
    v_mfma_f32_16x16x32_bf16 v[92:95], v[164:167], v[88:91], v[92:95]
    s_waitcnt vmcnt(5)
    v_mfma_f32_16x16x32_bf16 v[92:95], v[168:171], v[84:87], v[92:95]
    s_waitcnt vmcnt(4)
    v_mfma_f32_16x16x32_bf16 v[92:95], v[172:175], v[88:91], v[92:95]
    s_waitcnt vmcnt(3)
    v_mfma_f32_16x16x32_bf16 v[92:95], v[176:179], v[84:87], v[92:95]
    s_waitcnt vmcnt(2)
    v_mfma_f32_16x16x32_bf16 v[92:95], v[180:183], v[88:91], v[92:95]
    s_waitcnt vmcnt(1)
    v_mfma_f32_16x16x32_bf16 v[92:95], v[184:187], v[84:87], v[92:95]
    s_waitcnt vmcnt(0)
    v_mfma_f32_16x16x32_bf16 v[92:95], v[188:191], v[88:91], v[92:95]
    s_nop 7
    v_cmp_u_f32 vcc, v92, v93
    v_cmp_u_f32 s[68:69], v94, v95
    v_cvt_pk_bf16_f32 v4, v92, v93
    v_cvt_pk_bf16_f32 v5, v94, v95
    s_or_b64 vcc, vcc, s[68:69]
    s_cbranch_scc0 L_fi17_x
    v_max_u32 v3, v128, v129
    v_max3_u32 v3, v3, v130, v131
    v_max3_u32 v3, v3, v132, v133
    v_max3_u32 v3, v3, v134, v135
    v_max3_u32 v3, v3, v136, v137
    v_max3_u32 v3, v3, v138, v139
    v_max3_u32 v3, v3, v140, v141
    v_max3_u32 v3, v3, v142, v143
    v_max3_u32 v3, v3, v144, v145
    v_max3_u32 v3, v3, v146, v147
    v_max3_u32 v3, v3, v148, v149
    v_max3_u32 v3, v3, v150, v151
    v_max3_u32 v3, v3, v152, v153
    v_max3_u32 v3, v3, v154, v155
    v_max3_u32 v3, v3, v156, v157
    v_max3_u32 v3, v3, v158, v159
    v_max3_u32 v3, v3, v160, v161
    v_max3_u32 v3, v3, v162, v163
    v_max3_u32 v3, v3, v164, v165
    v_max3_u32 v3, v3, v166, v167
    v_max3_u32 v3, v3, v168, v169
    v_max3_u32 v3, v3, v170, v171
    v_max3_u32 v3, v3, v172, v173
    v_max3_u32 v3, v3, v174, v175
    v_max3_u32 v3, v3, v176, v177
    v_max3_u32 v3, v3, v178, v179
    v_max3_u32 v3, v3, v180, v181
    v_max3_u32 v3, v3, v182, v183
    v_max3_u32 v3, v3, v184, v185
    v_max3_u32 v3, v3, v186, v187
    v_max3_u32 v3, v3, v188, v189
    v_max3_u32 v3, v3, v190, v191
    v_cmp_eq_u32 vcc, -1, v3
    s_sub_u32 s25, s25, 1
    s_cmp_eq_u32 s25, 0
    s_cbranch_scc1 L_fi17_x
    s_cmp_lg_u64 vcc, 0
    s_cbranch_scc1 L_fi17
L_fi17_x:
    buffer_store_dwordx2 v[4:5], v82, s[20:23], s31 offen
    s_add_u32 s30, s30, 512
    s_add_u32 s31, s31, 128
    s_bitcmp1_b32 s31, 7
    s_cbranch_scc1 L_W_f
L_W_x:
    s_barrier
L_R:
    s_mov_b32 s20, s58
    s_mov_b32 s21, s59
    s_mov_b32 s22, 0x2000
    s_mov_b32 s23, 0x20000
    v_and_b32 v3, 1, v0
    v_lshlrev_b32 v3, 4, v3
    v_mov_b32 v4, 0xffff
    v_lshlrev_b32 v4, v3, v4
    v_bfe_u32 v3, v0, 1, 2
    v_cmp_eq_u32 vcc, 0, v3
    s_nop 1
    v_cndmask_b32 v20, 0, v4, vcc
    v_cmp_eq_u32 vcc, 1, v3
    s_nop 1
    v_cndmask_b32 v21, 0, v4, vcc
    v_cmp_eq_u32 vcc, 2, v3
    s_nop 1
    v_cndmask_b32 v22, 0, v4, vcc
    v_cmp_eq_u32 vcc, 3, v3
    s_nop 1
    v_cndmask_b32 v23, 0, v4, vcc
    v_lshrrev_b32 v3, 4, v0
    v_and_b32 v4, 7, v0
    v_bfe_u32 v7, v0, 3, 1
    v_lshl_add_u32 v5, v3, 3, v4
    v_mul_u32_u24 v6, 320, v7
    v_lshl_add_u32 v5, v5, 3, v6
    s_mul_i32 s24, s3, 1280
    s_add_u32 s24, s24, 135168
    v_add_u32 v24, s24, v5
    v_and_b32 v5, 3, v0
    v_mul_u32_u24 v25, 320, v5
    v_lshl_add_u32 v25, v3, 4, v25
    v_add_u32 v25, 135168, v25
    v_lshlrev_b32 v26, 4, v4
    v_lshl_add_u32 v26, v7, 3, v26
    v_and_b32 v5, 15, v0
    v_lshlrev_b32 v28, 11, v3
    v_lshl_add_u32 v28, v5, 1, v28
    s_and_b32 s24, s74, 7
    s_lshl_b32 s24, s24, 3
    s_bfm_b64 s[44:45], 8, s24
    s_not_b64 s[44:45], s[44:45]
    v_min_u32 v6, 5, v4
    v_lshrrev_b32 v5, 1, v6
    v_and_b32 v8, 1, v3
    v_mad_u32_u24 v5, v8, 3, v5
    v_lshlrev_b32 v31, 12, v5
    v_and_b32 v6, 1, v6
    v_lshl_add_u32 v6, v7, 1, v6
    v_lshl_add_u32 v31, v6, 4, v31
    s_and_b32 s35, s72, 7
    s_lshl_b32 s35, s35, 7
    s_add_u32 s35, s35, 0x1c0000
    s_lshr_b32 s34, s72, 3
    s_mul_i32 s34, s34, 6
    s_mul_i32 s29, s3, 24576
    s_add_u32 s29, s29, s35
    s_mov_b32 s24, 262144
    s_branch L_pd18_in
L_pd18:
    s_sleep 64
L_pd18_in:
    buffer_load_dwordx2 v[8:9], v31, s[12:15], s29 offen sc1
    s_waitcnt vmcnt(0)
    v_max_u32 v3, v8, v9
    v_cmp_eq_u32 vcc, -1, v3
    s_sub_u32 s24, s24, 1
    s_cmp_eq_u32 s24, 0
    s_cbranch_scc1 L_pd18_x
    s_and_b64 exec, exec, vcc
    s_cbranch_scc1 L_pd18
L_pd18_x:
    s_mov_b64 exec, -1
    v_mov_b32 v6, v8
    s_nop 1
    v_max_f32_dpp v6, v6, v6 quad_perm:[1,0,3,2] row_mask:0xf bank_mask:0xf
    s_nop 1
    v_max_f32_dpp v6, v6, v6 quad_perm:[2,3,0,1] row_mask:0xf bank_mask:0xf
    s_nop 1
    v_max_f32_dpp v6, v6, v6 row_half_mirror row_mask:0xf bank_mask:0xf
    v_sub_f32 v8, v8, v6
    v_exp_f32 v8, v8
    v_cmp_gt_u32 vcc, 6, v4
    s_nop 1
    v_cndmask_b32 v8, 0, v8, vcc
    v_mul_f32 v9, v8, v9
    s_nop 1
    v_add_f32_dpp v9, v9, v9 quad_perm:[1,0,3,2] row_mask:0xf bank_mask:0xf
    s_nop 1
    v_add_f32_dpp v9, v9, v9 quad_perm:[2,3,0,1] row_mask:0xf bank_mask:0xf
    s_nop 1
    v_add_f32_dpp v9, v9, v9 row_half_mirror row_mask:0xf bank_mask:0xf
    v_rcp_f32 v9, v9
    s_nop 0
    v_mul_f32 v8, v8, v9
    v_cvt_pk_bf16_f32 v8, v8, v8
    v_lshrrev_b32 v3, 4, v0
    v_mul_u32_u24 v9, 6, v7
    v_sub_u32 v3, v3, v9
    v_lshlrev_b32 v9, 3, v7
    v_add_u32 v5, 0, v3
    v_min_u32 v5, 6, v5
    v_add_u32 v5, v5, v9
    v_lshlrev_b32 v5, 2, v5
    ds_bpermute_b32 v10, v5, v8
    ds_bpermute_b32 v13, v5, v8 offset:64
    v_add_u32 v5, 4, v3
    v_min_u32 v5, 6, v5
    v_add_u32 v5, v5, v9
    v_lshlrev_b32 v5, 2, v5
    ds_bpermute_b32 v11, v5, v8
    ds_bpermute_b32 v14, v5, v8 offset:64
    v_add_u32 v5, 8, v3
    v_min_u32 v5, 6, v5
    v_add_u32 v5, v5, v9
    v_lshlrev_b32 v5, 2, v5
    ds_bpermute_b32 v12, v5, v8
    ds_bpermute_b32 v15, v5, v8 offset:64
    s_waitcnt lgkmcnt(0)
    v_and_b32 v32, v10, v20
    v_and_b32 v33, v10, v21
    v_and_b32 v34, v10, v22
    v_and_b32 v35, v10, v23
    v_and_b32 v36, v11, v20
    v_and_b32 v37, v11, v21
    v_and_b32 v38, v11, v22
    v_and_b32 v39, v11, v23
    v_and_b32 v40, v12, v20
    v_and_b32 v41, v12, v21
    v_and_b32 v42, v12, v22
    v_and_b32 v43, v12, v23
    v_and_b32 v44, v13, v20
    v_and_b32 v45, v13, v21
    v_and_b32 v46, v13, v22
    v_and_b32 v47, v13, v23
    v_and_b32 v48, v14, v20
    v_and_b32 v49, v14, v21
    v_and_b32 v50, v14, v22
    v_and_b32 v51, v14, v23
    v_and_b32 v52, v15, v20
    v_and_b32 v53, v15, v21
    v_and_b32 v54, v15, v22
    v_and_b32 v55, v15, v23
    s_mov_b32 s43, s29
    s_and_b32 s24, s3, 1
    s_lshl_b32 s24, s24, 1
    s_and_b32 s29, s3, 2
    s_lshl_b32 s29, s29, 3
    s_or_b32 s29, s29, s24
    s_and_b32 s24, s26, 13
    s_or_b32 s29, s29, s24
    s_mul_i32 s29, s29, 6144
    s_add_u32 s29, s29, 0x180000
    s_add_u32 s42, s29, 4096
    s_lshr_b32 s24, s74, 3
    s_lshl_b32 s24, s24, 2
    s_add_u32 s24, s24, s3
    s_lshl_b32 s36, s24, 12
    s_add_u32 s36, s36, 0x1de000
    s_and_b32 s37, s74, 7
    s_lshl_b32 s37, s37, 7
    s_add_u32 s37, s37, s36
    s_lshl_b32 s38, s3, 12
    s_andn2_b32 s25, s74, 7
    s_lshl_b32 s25, s25, 4
    s_add_u32 s38, s38, s25
    s_add_u32 s38, s38, 0x1da000
    s_lshl_b32 s39, s24, 5
    s_add_u32 s39, s39, 1024
    s_mov_b32 s30, 0x600000
    s_mov_b32 s31, s30
    s_mov_b32 s40, s30
    s_mov_b32 s41, s30
    s_mov_b32 s33, 0
    s_branch L_P_go
L_P:
    s_mov_b64 s[30:31], s[36:37]
    s_mov_b64 s[40:41], s[38:39]
    s_mov_b32 s33, 447
    s_cmp_lg_u32 s3, 0
    s_cbranch_scc1 L_H_x
    s_lshr_b32 s24, s74, 5
    s_mul_i32 s25, s24, 3
    s_add_u32 s34, s34, s25
    s_lshl_b32 s24, s24, 6
    s_add_u32 s24, s24, s26
    s_lshl_b32 s24, s24, 20
    s_add_u32 s4, s52, s24
    s_addc_u32 s5, s53, 0
    s_mov_b32 s6, 0x100000
    s_mov_b32 s7, 0x20000
    s_add_u32 s8, s4, 0x2000000
    s_addc_u32 s9, s5, 0
    s_mov_b32 s10, s6
    s_mov_b32 s11, 0x20000
    v_lshrrev_b32 v3, 4, v0
    v_mul_u32_u24 v16, 6144, v3
    v_and_b32 v3, 15, v0
    v_lshl_add_u32 v16, v3, 7, v16
    v_lshlrev_b32 v17, 12, v0
    v_mov_b32 v18, 0
    s_mov_b32 s27, 43
    s_mov_b32 s28, 43
    s_mov_b32 s32, 43
    s_mov_b32 s75, 1024
L_H:
    s_sub_u32 s75, s75, 1
    s_cmp_eq_u32 s75, 0
    s_cbranch_scc1 L_H_x
    s_mov_b64 exec, 0xffffff
    buffer_load_dword v18, v17, s[12:15], s35 offen offset:64 sc1
    s_mov_b64 exec, -1
    s_waitcnt vmcnt(0)
    v_max_i32 v19, 0, v18
    s_nop 1
    v_add_u32_dpp v3, v19, v19 row_ror:8 row_mask:0xf bank_mask:0xf
    s_nop 1
    v_add_u32_dpp v3, v3, v3 row_ror:4 row_mask:0xf bank_mask:0xf
    s_nop 1
    v_add_u32_dpp v3, v3, v3 row_ror:2 row_mask:0xf bank_mask:0xf
    s_nop 1
    v_add_u32_dpp v3, v3, v3 row_ror:1 row_mask:0xf bank_mask:0xf
    s_nop 0
    v_readlane_b32 s70, v3, 0
    v_readlane_b32 s24, v3, 16
    s_nop 0
    s_add_u32 s70, s70, s24
    s_add_u32 s24, s34, 0
    s_nop 0
    v_readlane_b32 s24, v19, s24
    s_sub_u32 s25, 43, s27
    s_mul_i32 s25, s25, 17
    s_mul_i32 s64, s24, 24
    s_add_u32 s64, s64, s25
    s_add_u32 s24, s24, 8
    s_cmp_gt_u32 s24, s27
    s_cselect_b32 s64, 0xffff, s64
    s_add_u32 s24, s34, 1
    v_readlane_b32 s24, v19, s24
    s_sub_u32 s25, 43, s28
    s_mul_i32 s25, s25, 17
    s_mul_i32 s65, s24, 24
    s_add_u32 s65, s65, s25
    s_add_u32 s24, s24, 8
    s_cmp_gt_u32 s24, s28
    s_cselect_b32 s65, 0xffff, s65
    s_add_u32 s24, s34, 2
    v_readlane_b32 s24, v19, s24
    s_sub_u32 s25, 43, s32
    s_mul_i32 s25, s25, 17
    s_mul_i32 s66, s24, 24
    s_add_u32 s66, s66, s25
    s_add_u32 s24, s24, 8
    s_cmp_gt_u32 s24, s32
    s_cselect_b32 s66, 0xffff, s66
    s_min_u32 s71, s64, s65
    s_min_u32 s71, s71, s66
    s_cmp_eq_u32 s71, 0xffff
    s_cbranch_scc1 L_H_x
    s_add_u32 s24, s71, 36
    s_cmp_lt_i32 s24, s70
    s_cbranch_scc1 L_H_go
    s_sleep 4
    s_branch L_H
L_H_go:
    s_cmp_lg_u32 s71, s64
    s_cbranch_scc1 L_H_n0
    s_sub_u32 s27, s27, 2
    s_mul_i32 s24, s27, 24576
    s_add_u32 s24, s24, 0
    s_branch L_H_ld
L_H_n0:
    s_cmp_lg_u32 s71, s65
    s_cbranch_scc1 L_H_n1
    s_sub_u32 s28, s28, 2
    s_mul_i32 s24, s28, 24576
    s_add_u32 s24, s24, 2048
    s_branch L_H_ld
L_H_n1:
    s_sub_u32 s32, s32, 2
    s_mul_i32 s24, s32, 24576
    s_add_u32 s24, s24, 4096
L_H_ld:
    buffer_load_dword v5, v16, s[4:7], s24 offen
    buffer_load_dword v5, v16, s[8:11], s24 offen
    s_add_u32 s24, s24, 24576
    buffer_load_dword v5, v16, s[4:7], s24 offen
    buffer_load_dword v5, v16, s[8:11], s24 offen
    s_branch L_H
L_H_x:
    s_barrier
    s_mov_b32 s24, 262144
    s_branch L_pd19_in
L_pd19:
    s_sleep 4
L_pd19_in:
    buffer_load_dwordx2 v[8:9], v31, s[12:15], s43 offen offset:8 sc1
    s_waitcnt vmcnt(0)
    v_max_u32 v3, v8, v9
    v_cmp_eq_u32 vcc, -1, v3
    s_sub_u32 s24, s24, 1
    s_cmp_eq_u32 s24, 0
    s_cbranch_scc1 L_pd19_x
    s_and_b64 exec, exec, vcc
    s_cbranch_scc1 L_pd19
L_pd19_x:
    s_mov_b64 exec, -1
    s_mov_b32 s24, 262144
L_pd20:
    buffer_load_dwordx4 v[56:59], v2, s[12:15], s29 offen offset:0 sc1
    buffer_load_dwordx4 v[60:63], v2, s[12:15], s29 offen offset:1024 sc1
    buffer_load_dwordx4 v[64:67], v2, s[12:15], s29 offen offset:2048 sc1
    buffer_load_dwordx4 v[68:71], v2, s[12:15], s29 offen offset:3072 sc1
    buffer_load_dwordx4 v[72:75], v2, s[12:15], s42 offen offset:0 sc1
    buffer_load_dwordx4 v[76:79], v2, s[12:15], s42 offen offset:1024 sc1
    s_waitcnt vmcnt(0)
    v_max_u32 v3, v56, v57
    v_max3_u32 v3, v3, v58, v59
    v_max3_u32 v3, v3, v60, v61
    v_max3_u32 v3, v3, v62, v63
    v_max3_u32 v3, v3, v64, v65
    v_max3_u32 v3, v3, v66, v67
    v_max3_u32 v3, v3, v68, v69
    v_max3_u32 v3, v3, v70, v71
    v_max3_u32 v3, v3, v72, v73
    v_max3_u32 v3, v3, v74, v75
    v_max3_u32 v3, v3, v76, v77
    v_max3_u32 v3, v3, v78, v79
    v_cmp_eq_u32 vcc, -1, v3
    s_sub_u32 s24, s24, 1
    s_cmp_eq_u32 s24, 0
    s_cbranch_scc1 L_pd20_x
    s_and_b64 exec, exec, vcc
    s_cbranch_scc1 L_pd20
L_pd20_x:
    s_mov_b64 exec, -1
L_P_go:
    v_mfma_f32_16x16x32_bf16 v[12:15], v[56:59], v[32:35], 0
    v_mfma_f32_16x16x32_bf16 v[16:19], v[68:71], v[44:47], 0
    v_mfma_f32_16x16x32_bf16 v[12:15], v[60:63], v[36:39], v[12:15]
    v_mfma_f32_16x16x32_bf16 v[16:19], v[72:75], v[48:51], v[16:19]
    v_mfma_f32_16x16x32_bf16 v[12:15], v[64:67], v[40:43], v[12:15]
    v_mfma_f32_16x16x32_bf16 v[16:19], v[76:79], v[52:55], v[16:19]
    s_barrier
    s_mov_b64 exec, 1
    v_mov_b32 v83, 64
    buffer_atomic_add v83, off, s[12:15], s40 sc0
    s_mov_b64 exec, -1
    s_nop 1
    v_cvt_pk_bf16_f32 v4, v12, v13
    v_cvt_pk_bf16_f32 v5, v14, v15
    ds_write_b64 v24, v[4:5]
    v_cvt_pk_bf16_f32 v6, v16, v17
    v_cvt_pk_bf16_f32 v7, v18, v19
    ds_write_b64 v24, v[6:7] offset:640
    s_waitcnt lgkmcnt(0)
    s_barrier
    ds_read_b128 v[128:131], v25 offset:0
    ds_read_b128 v[132:135], v25 offset:64
    ds_read_b128 v[136:139], v25 offset:128
    ds_read_b128 v[140:143], v25 offset:192
    ds_read_b128 v[144:147], v25 offset:1280
    ds_read_b128 v[148:151], v25 offset:1344
    ds_read_b128 v[152:155], v25 offset:1408
    ds_read_b128 v[156:159], v25 offset:1472
    ds_read_b128 v[160:163], v25 offset:2560
    s_waitcnt lgkmcnt(8)
    v_mfma_f32_16x16x32_bf16 v[12:15], v[128:131], a[128:131], 0
    ds_read_b128 v[164:167], v25 offset:2624
    s_waitcnt lgkmcnt(8)
    v_mfma_f32_16x16x32_bf16 v[12:15], v[132:135], a[132:135], v[12:15]
    ds_read_b128 v[168:171], v25 offset:2688
    s_waitcnt lgkmcnt(8)
    v_mfma_f32_16x16x32_bf16 v[12:15], v[136:139], a[136:139], v[12:15]
    ds_read_b128 v[172:175], v25 offset:2752
    s_waitcnt lgkmcnt(8)
    v_mfma_f32_16x16x32_bf16 v[12:15], v[140:143], a[140:143], v[12:15]
    ds_read_b128 v[176:179], v25 offset:3840
    s_waitcnt lgkmcnt(8)
    v_mfma_f32_16x16x32_bf16 v[12:15], v[144:147], a[144:147], v[12:15]
    ds_read_b128 v[180:183], v25 offset:3904
    s_waitcnt lgkmcnt(8)
    v_mfma_f32_16x16x32_bf16 v[12:15], v[148:151], a[148:151], v[12:15]
    ds_read_b128 v[184:187], v25 offset:3968
    s_waitcnt lgkmcnt(8)
    v_mfma_f32_16x16x32_bf16 v[12:15], v[152:155], a[152:155], v[12:15]
    ds_read_b128 v[188:191], v25 offset:4032
    s_waitcnt lgkmcnt(8)
    v_mfma_f32_16x16x32_bf16 v[12:15], v[156:159], a[156:159], v[12:15]
    s_waitcnt lgkmcnt(7)
    v_mfma_f32_16x16x32_bf16 v[12:15], v[160:163], a[160:163], v[12:15]
    s_waitcnt lgkmcnt(6)
    v_mfma_f32_16x16x32_bf16 v[12:15], v[164:167], a[164:167], v[12:15]
    s_waitcnt lgkmcnt(5)
    v_mfma_f32_16x16x32_bf16 v[12:15], v[168:171], a[168:171], v[12:15]
    s_waitcnt lgkmcnt(4)
    v_mfma_f32_16x16x32_bf16 v[12:15], v[172:175], a[172:175], v[12:15]
    s_waitcnt lgkmcnt(3)
    v_mfma_f32_16x16x32_bf16 v[12:15], v[176:179], a[176:179], v[12:15]
    s_waitcnt lgkmcnt(2)
    v_mfma_f32_16x16x32_bf16 v[12:15], v[180:183], a[180:183], v[12:15]
    s_waitcnt lgkmcnt(1)
    v_mfma_f32_16x16x32_bf16 v[12:15], v[184:187], a[184:187], v[12:15]
    s_waitcnt lgkmcnt(0)
    v_mfma_f32_16x16x32_bf16 v[12:15], v[188:191], a[188:191], v[12:15]
    s_nop 7
    v_cvt_pk_bf16_f32 v4, v12, v13
    v_cvt_pk_bf16_f32 v5, v14, v15
    s_mov_b64 exec, 0xffff
    buffer_store_dwordx2 v[4:5], v26, s[12:15], s31 offen sc1
    s_mov_b64 exec, -1
    v_mov_b32 v16, v4
    v_mov_b32 v17, v5
    v_mov_b32 v18, v4
    v_mov_b32 v19, v5
    v_mov_b32_dpp v16, v4 row_ror:8 row_mask:0xf bank_mask:0xc
    v_mov_b32_dpp v17, v5 row_ror:8 row_mask:0xf bank_mask:0xc
    v_mov_b32_dpp v18, v4 row_ror:8 row_mask:0xf bank_mask:0x3
    v_mov_b32_dpp v19, v5 row_ror:8 row_mask:0xf bank_mask:0x3
    s_waitcnt vmcnt(1)
    v_readfirstlane_b32 s24, v83
    s_nop 0
    s_cmp_eq_u32 s24, s33
    s_cbranch_scc1 L_P_f
    s_waitcnt vmcnt(0)
    v_readfirstlane_b32 s24, v83
    s_nop 0
    s_cmp_lg_u32 s24, s33
    s_cbranch_scc1 L_P_n
L_P_f:
    s_mov_b64 exec, s[44:45]
    s_mov_b32 s24, 262144
L_pd21:
    buffer_load_dwordx4 v[16:19], v2, s[12:15], s30 offen sc1
    s_waitcnt vmcnt(0)
    v_max_u32 v3, v16, v17
    v_max3_u32 v3, v3, v18, v19
    v_cmp_eq_u32 vcc, -1, v3
    s_sub_u32 s24, s24, 1
    s_cmp_eq_u32 s24, 0
    s_cbranch_scc1 L_pd21_x
    s_and_b64 exec, exec, vcc
    s_cbranch_scc1 L_pd21
L_pd21_x:
    s_mov_b64 exec, -1
    v_lshlrev_b32 v56, 16, v16
    v_and_b32 v57, 0xffff0000, v16
    v_lshlrev_b32 v58, 16, v17
    v_and_b32 v59, 0xffff0000, v17
    v_lshlrev_b32 v60, 16, v18
    v_and_b32 v61, 0xffff0000, v18
    v_lshlrev_b32 v62, 16, v19
    v_and_b32 v63, 0xffff0000, v19
    v_permlane32_swap_b32 v56, v58
    v_permlane32_swap_b32 v57, v59
    v_permlane32_swap_b32 v60, v62
    v_permlane32_swap_b32 v61, v63
    v_add_f32 v56, v56, v58
    v_add_f32 v57, v57, v59
    v_add_f32 v60, v60, v62
    v_add_f32 v61, v61, v63
    v_permlane16_swap_b32 v56, v57
    s_nop 0
    v_permlane16_swap_b32 v60, v61
    v_add_f32 v56, v56, v57
    v_add_f32 v60, v60, v61
    s_nop 0
    v_add_f32_dpp v4, v56, v56 row_ror:8 row_mask:0xf bank_mask:0x3
    s_nop 1
    v_add_f32_dpp v4, v60, v60 row_ror:8 row_mask:0xf bank_mask:0xc
    v_cvt_pk_bf16_f32 v4, v4, v4
    buffer_store_short v4, v28, s[20:23], s41 offen
L_P_n:
    s_cmp_lg_u32 s33, 0
    s_cbranch_scc1 L_P_x
    s_barrier
    s_branch L_P
L_P_x:
L_end:
    s_endpgm
L_C:
    s_cmp_lg_u32 s3, 0
    s_cbranch_scc1 L_C_q
    v_lshrrev_b32 v3, 4, v0
    v_and_b32 v4, 3, v0
    v_lshlrev_b32 v5, 6, v3
    v_lshl_add_u32 v5, v4, 4, v5
    v_bfe_u32 v4, v0, 2, 2
    v_lshl_add_u32 v5, v4, 8, v5
    s_lshl_b32 s24, s26, 12
    s_add_u32 s24, s24, 0x140000
    buffer_store_dwordx4 v[8:11], v5, s[12:15], s24 offen sc1
L_C_q:
    s_waitcnt vmcnt(0)
    s_barrier
    s_cmp_lg_u32 s3, 0
    s_cbranch_scc1 L_sig22
    s_mov_b64 exec, 1
    v_mov_b32 v3, 1
    v_mov_b32 v4, 1
    buffer_atomic_add v4, off, s[16:19], 0 offset:128
    buffer_atomic_add v3, off, s[16:19], 0 offset:0 sc0
    s_waitcnt vmcnt(0)
    v_readfirstlane_b32 s24, v3
    s_mov_b64 exec, -1
    s_and_b32 s24, s24, 63
    s_cmp_lg_u32 s24, 63
    s_cbranch_scc1 L_sig22
    v_lshlrev_b32 v4, 7, v0
    v_mov_b32 v3, 1
    s_mov_b32 s24, 0x170000
    buffer_store_dword v3, v4, s[12:15], s24 offen offset:0 sc1
L_sig22:
    s_mov_b32 s8, s56
    s_mov_b32 s9, s57
    s_mov_b32 s10, 0x400000
    s_mov_b32 s11, 0x20000
    s_and_b32 s24, s3, 1
    s_lshl_b32 s24, s24, 1
    s_and_b32 s25, s3, 2
    s_lshl_b32 s25, s25, 3
    s_or_b32 s25, s25, s24
    s_and_b32 s24, s26, 13
    s_or_b32 s25, s25, s24
    s_lshl_b32 s25, s25, 17
    s_lshr_b32 s24, s74, 3
    s_lshl_b32 s24, s24, 7
    s_add_u32 s24, s24, s25
    v_lshrrev_b32 v3, 4, v0
    v_lshlrev_b32 v3, 15, v3
    v_and_b32 v4, 8, v0
    v_lshl_add_u32 v3, v4, 10, v3
    v_and_b32 v4, 0x70, v2
    v_add_u32 v3, v3, v4
    s_mul_i32 m0, s3, 16896
    s_nop 0
    buffer_load_dwordx4 v3, s[8:11], s24 offen nt lds
    s_add_u32 m0, m0, 1056
    s_add_u32 s24, s24, 2048
    buffer_load_dwordx4 v3, s[8:11], s24 offen nt lds
    s_add_u32 m0, m0, 1056
    s_add_u32 s24, s24, 2048
    buffer_load_dwordx4 v3, s[8:11], s24 offen nt lds
    s_add_u32 m0, m0, 1056
    s_add_u32 s24, s24, 2048
    buffer_load_dwordx4 v3, s[8:11], s24 offen nt lds
    s_add_u32 m0, m0, 1056
    s_add_u32 s24, s24, 10240
    buffer_load_dwordx4 v3, s[8:11], s24 offen nt lds
    s_add_u32 m0, m0, 1056
    s_add_u32 s24, s24, 2048
    buffer_load_dwordx4 v3, s[8:11], s24 offen nt lds
    s_add_u32 m0, m0, 1056
    s_add_u32 s24, s24, 2048
    buffer_load_dwordx4 v3, s[8:11], s24 offen nt lds
    s_add_u32 m0, m0, 1056
    s_add_u32 s24, s24, 2048
    buffer_load_dwordx4 v3, s[8:11], s24 offen nt lds
    s_add_u32 m0, m0, 1056
    s_add_u32 s24, s24, -21504
    buffer_load_dwordx4 v3, s[8:11], s24 offen nt lds
    s_add_u32 m0, m0, 1056
    s_add_u32 s24, s24, 2048
    buffer_load_dwordx4 v3, s[8:11], s24 offen nt lds
    s_add_u32 m0, m0, 1056
    s_add_u32 s24, s24, 2048
    buffer_load_dwordx4 v3, s[8:11], s24 offen nt lds
    s_add_u32 m0, m0, 1056
    s_add_u32 s24, s24, 2048
    buffer_load_dwordx4 v3, s[8:11], s24 offen nt lds
    s_add_u32 m0, m0, 1056
    s_add_u32 s24, s24, 10240
    buffer_load_dwordx4 v3, s[8:11], s24 offen nt lds
    s_add_u32 m0, m0, 1056
    s_add_u32 s24, s24, 2048
    buffer_load_dwordx4 v3, s[8:11], s24 offen nt lds
    s_add_u32 m0, m0, 1056
    s_add_u32 s24, s24, 2048
    buffer_load_dwordx4 v3, s[8:11], s24 offen nt lds
    s_add_u32 m0, m0, 1056
    s_add_u32 s24, s24, 2048
    buffer_load_dwordx4 v3, s[8:11], s24 offen nt lds
    s_waitcnt vmcnt(0)
    s_barrier
    v_lshrrev_b32 v3, 2, v0
    v_mul_u32_u24 v3, 1056, v3
    v_and_b32 v4, 3, v0
    v_lshl_add_u32 v3, v4, 3, v3
    s_lshl_b32 s24, s3, 5
    v_add_u32 v3, s24, v3
    ds_read_b64_tr_b16 a[128:129], v3 offset:0
    ds_read_b64_tr_b16 a[130:131], v3 offset:128
    ds_read_b64_tr_b16 a[132:133], v3 offset:256
    ds_read_b64_tr_b16 a[134:135], v3 offset:384
    ds_read_b64_tr_b16 a[136:137], v3 offset:512
    ds_read_b64_tr_b16 a[138:139], v3 offset:640
    ds_read_b64_tr_b16 a[140:141], v3 offset:768
    ds_read_b64_tr_b16 a[142:143], v3 offset:896
    ds_read_b64_tr_b16 a[144:145], v3 offset:16896
    ds_read_b64_tr_b16 a[146:147], v3 offset:17024
    ds_read_b64_tr_b16 a[148:149], v3 offset:17152
    ds_read_b64_tr_b16 a[150:151], v3 offset:17280
    ds_read_b64_tr_b16 a[152:153], v3 offset:17408
    ds_read_b64_tr_b16 a[154:155], v3 offset:17536
    ds_read_b64_tr_b16 a[156:157], v3 offset:17664
    ds_read_b64_tr_b16 a[158:159], v3 offset:17792
    ds_read_b64_tr_b16 a[160:161], v3 offset:33792
    ds_read_b64_tr_b16 a[162:163], v3 offset:33920
    ds_read_b64_tr_b16 a[164:165], v3 offset:34048
    ds_read_b64_tr_b16 a[166:167], v3 offset:34176
    ds_read_b64_tr_b16 a[168:169], v3 offset:34304
    ds_read_b64_tr_b16 a[170:171], v3 offset:34432
    ds_read_b64_tr_b16 a[172:173], v3 offset:34560
    ds_read_b64_tr_b16 a[174:175], v3 offset:34688
    ds_read_b64_tr_b16 a[176:177], v3 offset:50688
    ds_read_b64_tr_b16 a[178:179], v3 offset:50816
    ds_read_b64_tr_b16 a[180:181], v3 offset:50944
    ds_read_b64_tr_b16 a[182:183], v3 offset:51072
    ds_read_b64_tr_b16 a[184:185], v3 offset:51200
    ds_read_b64_tr_b16 a[186:187], v3 offset:51328
    ds_read_b64_tr_b16 a[188:189], v3 offset:51456
    ds_read_b64_tr_b16 a[190:191], v3 offset:51584
    s_and_b32 s70, s72, 3
    s_lshr_b32 s71, s72, 4
    s_bfe_u32 s24, s72, 0x10002
    s_lshl_b32 s24, s24, 1
    s_add_u32 s71, s71, s24
    s_bfe_u32 s75, s72, 0x10003
    s_lshl_b32 s30, s71, 22
    s_add_u32 s4, s38, s30
    s_addc_u32 s5, s39, 0
    s_mov_b32 s6, 0x400000
    s_mov_b32 s7, 0x20000
    s_mul_i32 s32, s3, 65536
    s_lshl_b32 s24, s70, 10
    s_add_u32 s32, s32, s24
    s_mul_i32 s34, s3, 16896
    s_waitcnt lgkmcnt(0)
    s_barrier
    s_mov_b32 m0, s34
    s_nop 0
    buffer_load_dwordx4 v2, s[4:7], s32 offen lds
    s_add_u32 m0, m0, 1056
    s_add_u32 s32, s32, 4096
    buffer_load_dwordx4 v2, s[4:7], s32 offen lds
    s_add_u32 m0, m0, 1056
    s_add_u32 s32, s32, 4096
    buffer_load_dwordx4 v2, s[4:7], s32 offen lds
    s_add_u32 m0, m0, 1056
    s_add_u32 s32, s32, 4096
    buffer_load_dwordx4 v2, s[4:7], s32 offen lds
    s_add_u32 m0, m0, 1056
    s_add_u32 s32, s32, 4096
    buffer_load_dwordx4 v2, s[4:7], s32 offen lds
    s_add_u32 m0, m0, 1056
    s_add_u32 s32, s32, 4096
    buffer_load_dwordx4 v2, s[4:7], s32 offen lds
    s_add_u32 m0, m0, 1056
    s_add_u32 s32, s32, 4096
    buffer_load_dwordx4 v2, s[4:7], s32 offen lds
    s_add_u32 m0, m0, 1056
    s_add_u32 s32, s32, 4096
    buffer_load_dwordx4 v2, s[4:7], s32 offen lds
    s_add_u32 m0, m0, 1056
    s_add_u32 s32, s32, 4096
    buffer_load_dwordx4 v2, s[4:7], s32 offen lds
    s_add_u32 m0, m0, 1056
    s_add_u32 s32, s32, 4096
    buffer_load_dwordx4 v2, s[4:7], s32 offen lds
    s_add_u32 m0, m0, 1056
    s_add_u32 s32, s32, 4096
    buffer_load_dwordx4 v2, s[4:7], s32 offen lds
    s_add_u32 m0, m0, 1056
    s_add_u32 s32, s32, 4096
    buffer_load_dwordx4 v2, s[4:7], s32 offen lds
    s_add_u32 m0, m0, 1056
    s_add_u32 s32, s32, 4096
    buffer_load_dwordx4 v2, s[4:7], s32 offen lds
    s_add_u32 m0, m0, 1056
    s_add_u32 s32, s32, 4096
    buffer_load_dwordx4 v2, s[4:7], s32 offen lds
    s_add_u32 m0, m0, 1056
    s_add_u32 s32, s32, 4096
    buffer_load_dwordx4 v2, s[4:7], s32 offen lds
    s_add_u32 m0, m0, 1056
    s_add_u32 s32, s32, 4096
    buffer_load_dwordx4 v2, s[4:7], s32 offen lds
    s_add_u32 m0, m0, 1056
    s_add_u32 s32, s32, 200704
    s_lshr_b32 s28, s3, 1
    s_and_b32 s29, s3, 1
    v_and_b32 v3, 15, v0
    v_lshrrev_b32 v4, 4, v0
    v_mul_u32_u24 v19, 1056, v3
    v_lshl_add_u32 v19, v4, 4, v19
    v_lshrrev_b32 v5, 2, v0
    v_mul_u32_u24 v20, 1056, v5
    v_and_b32 v5, 3, v0
    v_lshl_add_u32 v20, v5, 3, v20
    s_lshl_b32 s24, s29, 9
    v_add_u32 v20, s24, v20
    v_and_b32 v3, 15, v0
    v_mul_u32_u24 v18, 1056, v3
    v_lshl_add_u32 v18, v4, 4, v18
    v_add_u32 v18, 101376, v18
    s_mul_i32 s24, s28, 33792
    v_add_u32 v19, s24, v19
    v_add_u32 v20, s24, v20
    v_mov_b32 v128, 0
    v_mov_b32 v129, 0
    v_mov_b32 v130, 0
    v_mov_b32 v131, 0
    v_mov_b32 v132, 0
    v_mov_b32 v133, 0
    v_mov_b32 v134, 0
    v_mov_b32 v135, 0
    v_mov_b32 v136, 0
    v_mov_b32 v137, 0
    v_mov_b32 v138, 0
    v_mov_b32 v139, 0
    v_mov_b32 v140, 0
    v_mov_b32 v141, 0
    v_mov_b32 v142, 0
    v_mov_b32 v143, 0
    v_mov_b32 v144, 0
    v_mov_b32 v145, 0
    v_mov_b32 v146, 0
    v_mov_b32 v147, 0
    v_mov_b32 v148, 0
    v_mov_b32 v149, 0
    v_mov_b32 v150, 0
    v_mov_b32 v151, 0
    v_mov_b32 v152, 0
    v_mov_b32 v153, 0
    v_mov_b32 v154, 0
    v_mov_b32 v155, 0
    v_mov_b32 v156, 0
    v_mov_b32 v157, 0
    v_mov_b32 v158, 0
    v_mov_b32 v159, 0
    v_mov_b32 v160, 0
    v_mov_b32 v161, 0
    v_mov_b32 v162, 0
    v_mov_b32 v163, 0
    v_mov_b32 v164, 0
    v_mov_b32 v165, 0
    v_mov_b32 v166, 0
    v_mov_b32 v167, 0
    v_mov_b32 v168, 0
    v_mov_b32 v169, 0
    v_mov_b32 v170, 0
    v_mov_b32 v171, 0
    v_mov_b32 v172, 0
    v_mov_b32 v173, 0
    v_mov_b32 v174, 0
    v_mov_b32 v175, 0
    v_mov_b32 v176, 0
    v_mov_b32 v177, 0
    v_mov_b32 v178, 0
    v_mov_b32 v179, 0
    v_mov_b32 v180, 0
    v_mov_b32 v181, 0
    v_mov_b32 v182, 0
    v_mov_b32 v183, 0
    v_mov_b32 v184, 0
    v_mov_b32 v185, 0
    v_mov_b32 v186, 0
    v_mov_b32 v187, 0
    v_mov_b32 v188, 0
    v_mov_b32 v189, 0
    v_mov_b32 v190, 0
    v_mov_b32 v191, 0
    v_mov_b32 v22, 0xff800000
    v_mov_b32 v23, 0
    s_cmp_lg_u32 s3, 0
    s_cbranch_scc1 L_awx23
    s_mov_b32 s24, 262144
    s_mov_b64 exec, 1
L_aw24:
    buffer_load_dword v1, off, s[12:15], s73 offset:0 sc1
    s_waitcnt vmcnt(0)
    v_readfirstlane_b32 s25, v1
    s_nop 0
    s_cmp_eq_u32 s25, 1
    s_cbranch_scc1 L_awx23
    s_sleep 4
    s_sub_u32 s24, s24, 1
    s_cmp_lg_u32 s24, 0
    s_cbranch_scc1 L_aw24
L_awx23:
    s_mov_b64 exec, -1
    s_barrier
    s_lshl_b32 s24, s71, 17
    s_mul_i32 s25, s3, 16384
    s_add_u32 s24, s24, s25
    s_add_u32 s24, s24, 0x0
    s_mul_i32 s25, s75, 65536
    s_add_u32 s24, s24, s25
    buffer_load_dwordx4 v[32:35], v2, s[12:15], s24 offen sc1
    s_add_u32 s24, s24, 4096
    buffer_load_dwordx4 v[36:39], v2, s[12:15], s24 offen sc1
    s_add_u32 s24, s24, 4096
    buffer_load_dwordx4 v[40:43], v2, s[12:15], s24 offen sc1
    s_add_u32 s24, s24, 4096
    buffer_load_dwordx4 v[44:47], v2, s[12:15], s24 offen sc1
    s_add_u32 s24, s24, 4096
    s_mul_i32 s24, s3, 4224
    s_add_u32 s24, s24, 101376
    v_add_u32 v3, s24, v2
    s_waitcnt vmcnt(3)
    ds_write_b128 v3, v[32:35] offset:0
    s_waitcnt vmcnt(2)
    ds_write_b128 v3, v[36:39] offset:1056
    s_waitcnt vmcnt(1)
    ds_write_b128 v3, v[40:43] offset:2112
    s_waitcnt vmcnt(0)
    ds_write_b128 v3, v[44:47] offset:3168
    s_waitcnt lgkmcnt(0)
    s_barrier
    ds_read_b128 a[0:3], v18 offset:0
    ds_read_b128 a[4:7], v18 offset:64
    ds_read_b128 a[8:11], v18 offset:128
    ds_read_b128 a[12:15], v18 offset:192
    ds_read_b128 a[16:19], v18 offset:256
    ds_read_b128 a[20:23], v18 offset:320
    ds_read_b128 a[24:27], v18 offset:384
    ds_read_b128 a[28:31], v18 offset:448
    ds_read_b128 a[32:35], v18 offset:512
    ds_read_b128 a[36:39], v18 offset:576
    ds_read_b128 a[40:43], v18 offset:640
    ds_read_b128 a[44:47], v18 offset:704
    ds_read_b128 a[48:51], v18 offset:768
    ds_read_b128 a[52:55], v18 offset:832
    ds_read_b128 a[56:59], v18 offset:896
    ds_read_b128 a[60:63], v18 offset:960
    s_cmp_lg_u32 s3, 0
    s_cbranch_scc1 L_xi25
    s_and_b32 s24, s74, 7
    s_lshl_b32 s24, s24, 5
    s_lshr_b32 s25, s74, 3
    s_add_u32 s24, s24, s25
    s_lshl_b32 s24, s24, 2
    s_add_u32 s24, s24, 0x1d8000
    s_getreg_b32 s25, hwreg(HW_REG_XCC_ID, 0, 4)
    s_mov_b64 exec, 1
    v_mov_b32 v3, s25
    buffer_store_dword v3, off, s[12:15], s24 sc1
    s_mov_b64 exec, -1
L_xi25:
    s_mov_b32 s27, 0
    s_mov_b32 s33, 67584
    s_mov_b32 s35, 0
    s_waitcnt lgkmcnt(0)
L_CT:
    s_waitcnt vmcnt(0)
    s_barrier
    v_add_u32 v24, s35, v19
    v_add_u32 v25, s35, v20
    ds_read_b128 v[32:35], v24 offset:0
    ds_read_b128 v[36:39], v24 offset:16896
    ds_read_b128 v[40:43], v24 offset:64
    ds_read_b128 v[44:47], v24 offset:16960
    ds_read_b128 v[48:51], v24 offset:128
    ds_read_b128 v[52:55], v24 offset:17024
    ds_read_b128 v[56:59], v24 offset:192
    s_add_u32 m0, s33, s34
    s_mov_b32 s33, s35
    s_add_u32 s35, s35, 67584
    s_cmp_eq_u32 s35, 135168
    s_cselect_b32 s35, 0, s35
    s_waitcnt lgkmcnt(6)
    v_mfma_f32_16x16x32_bf16 v[64:67], v[32:35], a[0:3], 0
    ds_read_b128 v[60:63], v24 offset:17088
    buffer_load_dwordx4 v2, s[4:7], s32 offen lds
    s_add_u32 m0, m0, 1056
    s_add_u32 s32, s32, 4096
    s_waitcnt lgkmcnt(6)
    v_mfma_f32_16x16x32_bf16 v[68:71], v[36:39], a[0:3], 0
    ds_read_b128 v[32:35], v24 offset:256
    s_waitcnt lgkmcnt(6)
    v_mfma_f32_16x16x32_bf16 v[64:67], v[40:43], a[4:7], v[64:67]
    ds_read_b128 v[36:39], v24 offset:17152
    s_waitcnt lgkmcnt(6)
    v_mfma_f32_16x16x32_bf16 v[68:71], v[44:47], a[4:7], v[68:71]
    ds_read_b128 v[40:43], v24 offset:320
    s_waitcnt lgkmcnt(6)
    v_mfma_f32_16x16x32_bf16 v[64:67], v[48:51], a[8:11], v[64:67]
    ds_read_b128 v[44:47], v24 offset:17216
    buffer_load_dwordx4 v2, s[4:7], s32 offen lds
    s_add_u32 m0, m0, 1056
    s_add_u32 s32, s32, 4096
    s_waitcnt lgkmcnt(6)
    v_mfma_f32_16x16x32_bf16 v[68:71], v[52:55], a[8:11], v[68:71]
    ds_read_b128 v[48:51], v24 offset:384
    s_waitcnt lgkmcnt(6)
    v_mfma_f32_16x16x32_bf16 v[64:67], v[56:59], a[12:15], v[64:67]
    ds_read_b128 v[52:55], v24 offset:17280
    s_waitcnt lgkmcnt(6)
    v_mfma_f32_16x16x32_bf16 v[68:71], v[60:63], a[12:15], v[68:71]
    ds_read_b128 v[56:59], v24 offset:448
    s_waitcnt lgkmcnt(6)
    v_mfma_f32_16x16x32_bf16 v[64:67], v[32:35], a[16:19], v[64:67]
    ds_read_b128 v[60:63], v24 offset:17344
    buffer_load_dwordx4 v2, s[4:7], s32 offen lds
    s_add_u32 m0, m0, 1056
    s_add_u32 s32, s32, 4096
    s_waitcnt lgkmcnt(6)
    v_mfma_f32_16x16x32_bf16 v[68:71], v[36:39], a[16:19], v[68:71]
    ds_read_b128 v[32:35], v24 offset:512
    s_waitcnt lgkmcnt(6)
    v_mfma_f32_16x16x32_bf16 v[64:67], v[40:43], a[20:23], v[64:67]
    ds_read_b128 v[36:39], v24 offset:17408
    s_waitcnt lgkmcnt(6)
    v_mfma_f32_16x16x32_bf16 v[68:71], v[44:47], a[20:23], v[68:71]
    ds_read_b128 v[40:43], v24 offset:576
    s_waitcnt lgkmcnt(6)
    v_mfma_f32_16x16x32_bf16 v[64:67], v[48:51], a[24:27], v[64:67]
    ds_read_b128 v[44:47], v24 offset:17472
    buffer_load_dwordx4 v2, s[4:7], s32 offen lds
    s_add_u32 m0, m0, 1056
    s_add_u32 s32, s32, 4096
    s_waitcnt lgkmcnt(6)
    v_mfma_f32_16x16x32_bf16 v[68:71], v[52:55], a[24:27], v[68:71]
    ds_read_b128 v[48:51], v24 offset:640
    s_waitcnt lgkmcnt(6)
    v_mfma_f32_16x16x32_bf16 v[64:67], v[56:59], a[28:31], v[64:67]
    ds_read_b128 v[52:55], v24 offset:17536
    s_waitcnt lgkmcnt(6)
    v_mfma_f32_16x16x32_bf16 v[68:71], v[60:63], a[28:31], v[68:71]
    ds_read_b128 v[56:59], v24 offset:704
    s_waitcnt lgkmcnt(6)
    v_mfma_f32_16x16x32_bf16 v[64:67], v[32:35], a[32:35], v[64:67]
    ds_read_b128 v[60:63], v24 offset:17600
    buffer_load_dwordx4 v2, s[4:7], s32 offen lds
    s_add_u32 m0, m0, 1056
    s_add_u32 s32, s32, 4096
    s_waitcnt lgkmcnt(6)
    v_mfma_f32_16x16x32_bf16 v[68:71], v[36:39], a[32:35], v[68:71]
    ds_read_b128 v[32:35], v24 offset:768
    s_waitcnt lgkmcnt(6)
    v_mfma_f32_16x16x32_bf16 v[64:67], v[40:43], a[36:39], v[64:67]
    ds_read_b128 v[36:39], v24 offset:17664
    s_waitcnt lgkmcnt(6)
    v_mfma_f32_16x16x32_bf16 v[68:71], v[44:47], a[36:39], v[68:71]
    ds_read_b128 v[40:43], v24 offset:832
    s_waitcnt lgkmcnt(6)
    v_mfma_f32_16x16x32_bf16 v[64:67], v[48:51], a[40:43], v[64:67]
    ds_read_b128 v[44:47], v24 offset:17728
    buffer_load_dwordx4 v2, s[4:7], s32 offen lds
    s_add_u32 m0, m0, 1056
    s_add_u32 s32, s32, 4096
    s_waitcnt lgkmcnt(6)
    v_mfma_f32_16x16x32_bf16 v[68:71], v[52:55], a[40:43], v[68:71]
    ds_read_b128 v[48:51], v24 offset:896
    s_waitcnt lgkmcnt(6)
    v_mfma_f32_16x16x32_bf16 v[64:67], v[56:59], a[44:47], v[64:67]
    ds_read_b128 v[52:55], v24 offset:17792
    s_waitcnt lgkmcnt(6)
    v_mfma_f32_16x16x32_bf16 v[68:71], v[60:63], a[44:47], v[68:71]
    ds_read_b128 v[56:59], v24 offset:960
    s_waitcnt lgkmcnt(6)
    v_mfma_f32_16x16x32_bf16 v[64:67], v[32:35], a[48:51], v[64:67]
    ds_read_b128 v[60:63], v24 offset:17856
    buffer_load_dwordx4 v2, s[4:7], s32 offen lds
    s_add_u32 m0, m0, 1056
    s_add_u32 s32, s32, 4096
    s_waitcnt lgkmcnt(6)
    v_mfma_f32_16x16x32_bf16 v[68:71], v[36:39], a[48:51], v[68:71]
    ds_read_b64_tr_b16 v[192:193], v25 offset:0
    s_waitcnt lgkmcnt(6)
    v_mfma_f32_16x16x32_bf16 v[64:67], v[40:43], a[52:55], v[64:67]
    ds_read_b64_tr_b16 v[194:195], v25 offset:16896
    s_waitcnt lgkmcnt(6)
    v_mfma_f32_16x16x32_bf16 v[68:71], v[44:47], a[52:55], v[68:71]
    ds_read_b64_tr_b16 v[196:197], v25 offset:32
    s_waitcnt lgkmcnt(6)
    v_mfma_f32_16x16x32_bf16 v[64:67], v[48:51], a[56:59], v[64:67]
    ds_read_b64_tr_b16 v[198:199], v25 offset:16928
    buffer_load_dwordx4 v2, s[4:7], s32 offen lds
    s_add_u32 m0, m0, 1056
    s_add_u32 s32, s32, 4096
    s_waitcnt lgkmcnt(6)
    v_mfma_f32_16x16x32_bf16 v[68:71], v[52:55], a[56:59], v[68:71]
    ds_read_b64_tr_b16 v[200:201], v25 offset:64
    s_waitcnt lgkmcnt(6)
    v_mfma_f32_16x16x32_bf16 v[64:67], v[56:59], a[60:63], v[64:67]
    ds_read_b64_tr_b16 v[202:203], v25 offset:16960
    s_waitcnt lgkmcnt(6)
    v_mfma_f32_16x16x32_bf16 v[68:71], v[60:63], a[60:63], v[68:71]
    ds_read_b64_tr_b16 v[204:205], v25 offset:96
    ds_read_b64_tr_b16 v[206:207], v25 offset:16992
    ds_read_b64_tr_b16 v[208:209], v25 offset:128
    ds_read_b64_tr_b16 v[210:211], v25 offset:17024
    ds_read_b64_tr_b16 v[212:213], v25 offset:160
    ds_read_b64_tr_b16 v[214:215], v25 offset:17056
    ds_read_b64_tr_b16 v[216:217], v25 offset:192
    ds_read_b64_tr_b16 v[218:219], v25 offset:17088
    v_max3_f32 v3, v64, v65, v22
    buffer_load_dwordx4 v2, s[4:7], s32 offen lds
    s_add_u32 m0, m0, 1056
    s_add_u32 s32, s32, 4096
    v_max3_f32 v3, v3, v66, v67
    v_max3_f32 v3, v3, v68, v69
    buffer_load_dwordx4 v2, s[4:7], s32 offen lds
    s_add_u32 m0, m0, 1056
    s_add_u32 s32, s32, 4096
    v_max3_f32 v3, v3, v70, v71
    v_mov_b32 v4, v3
    ds_read_b64_tr_b16 v[220:221], v25 offset:224
    buffer_load_dwordx4 v2, s[4:7], s32 offen lds
    s_add_u32 m0, m0, 1056
    s_add_u32 s32, s32, 4096
    v_permlane32_swap_b32 v3, v4
    ds_read_b64_tr_b16 v[222:223], v25 offset:17120
    v_max_f32 v3, v3, v4
    ds_read_b64_tr_b16 v[224:225], v25 offset:256
    buffer_load_dwordx4 v2, s[4:7], s32 offen lds
    s_add_u32 m0, m0, 1056
    s_add_u32 s32, s32, 4096
    v_mov_b32 v4, v3
    ds_read_b64_tr_b16 v[226:227], v25 offset:17152
    s_nop 0
    v_permlane16_swap_b32 v3, v4
    ds_read_b64_tr_b16 v[228:229], v25 offset:288
    buffer_load_dwordx4 v2, s[4:7], s32 offen lds
    s_add_u32 m0, m0, 1056
    s_add_u32 s32, s32, 4096
    v_max_f32 v3, v3, v4
    ds_read_b64_tr_b16 v[230:231], v25 offset:17184
    v_sub_f32 v4, v22, v3
    ds_read_b64_tr_b16 v[232:233], v25 offset:320
    buffer_load_dwordx4 v2, s[4:7], s32 offen lds
    s_add_u32 m0, m0, 1056
    s_add_u32 s32, s32, 4096
    v_exp_f32 v4, v4
    ds_read_b64_tr_b16 v[234:235], v25 offset:17216
    v_mov_b32 v22, v3
    ds_read_b64_tr_b16 v[236:237], v25 offset:352
    buffer_load_dwordx4 v2, s[4:7], s32 offen lds
    s_add_u32 m0, m0, 1056
    s_add_u32 s32, s32, 4096
    v_sub_f32 v64, v64, v3
    ds_read_b64_tr_b16 v[238:239], v25 offset:17248
    v_sub_f32 v65, v65, v3
    ds_read_b64_tr_b16 v[240:241], v25 offset:384
    buffer_load_dwordx4 v2, s[4:7], s32 offen lds
    s_add_u32 m0, m0, 1056
    s_add_u32 s32, s32, 200704
    v_sub_f32 v66, v66, v3
    ds_read_b64_tr_b16 v[242:243], v25 offset:17280
    v_sub_f32 v67, v67, v3
    ds_read_b64_tr_b16 v[244:245], v25 offset:416
    v_sub_f32 v68, v68, v3
    ds_read_b64_tr_b16 v[246:247], v25 offset:17312
    v_sub_f32 v69, v69, v3
    ds_read_b64_tr_b16 v[248:249], v25 offset:448
    v_sub_f32 v70, v70, v3
    ds_read_b64_tr_b16 v[250:251], v25 offset:17344
    v_sub_f32 v71, v71, v3
    ds_read_b64_tr_b16 v[252:253], v25 offset:480
    v_exp_f32 v64, v64
    ds_read_b64_tr_b16 v[254:255], v25 offset:17376
    v_exp_f32 v65, v65
    v_exp_f32 v66, v66
    v_exp_f32 v67, v67
    v_exp_f32 v68, v68
    v_exp_f32 v69, v69
    v_exp_f32 v70, v70
    v_exp_f32 v71, v71
    v_cvt_pk_bf16_f32 v72, v64, v65
    v_cvt_pk_bf16_f32 v73, v66, v67
    v_cvt_pk_bf16_f32 v74, v68, v69
    v_cvt_pk_bf16_f32 v75, v70, v71
    v_mul_f32 v128, v128, v4
    v_mul_f32 v129, v129, v4
    v_mul_f32 v130, v130, v4
    v_mul_f32 v131, v131, v4
    v_mul_f32 v132, v132, v4
    v_mul_f32 v133, v133, v4
    v_mul_f32 v134, v134, v4
    v_mul_f32 v135, v135, v4
    s_waitcnt lgkmcnt(0)
    v_mfma_f32_16x16x32_bf16 v[128:131], v[192:195], v[72:75], v[128:131]
    v_mul_f32 v136, v136, v4
    v_mul_f32 v137, v137, v4
    v_mul_f32 v138, v138, v4
    v_mul_f32 v139, v139, v4
    v_mfma_f32_16x16x32_bf16 v[132:135], v[196:199], v[72:75], v[132:135]
    v_mul_f32 v140, v140, v4
    v_mul_f32 v141, v141, v4
    v_mul_f32 v142, v142, v4
    v_mul_f32 v143, v143, v4
    v_mfma_f32_16x16x32_bf16 v[136:139], v[200:203], v[72:75], v[136:139]
    v_mul_f32 v144, v144, v4
    v_mul_f32 v145, v145, v4
    v_mul_f32 v146, v146, v4
    v_mul_f32 v147, v147, v4
    v_mfma_f32_16x16x32_bf16 v[140:143], v[204:207], v[72:75], v[140:143]
    v_mul_f32 v148, v148, v4
    v_mul_f32 v149, v149, v4
    v_mul_f32 v150, v150, v4
    v_mul_f32 v151, v151, v4
    v_mfma_f32_16x16x32_bf16 v[144:147], v[208:211], v[72:75], v[144:147]
    v_mul_f32 v152, v152, v4
    v_mul_f32 v153, v153, v4
    v_mul_f32 v154, v154, v4
    v_mul_f32 v155, v155, v4
    v_mfma_f32_16x16x32_bf16 v[148:151], v[212:215], v[72:75], v[148:151]
    v_mul_f32 v156, v156, v4
    v_mul_f32 v157, v157, v4
    v_mul_f32 v158, v158, v4
    v_mul_f32 v159, v159, v4
    v_mfma_f32_16x16x32_bf16 v[152:155], v[216:219], v[72:75], v[152:155]
    v_mul_f32 v160, v160, v4
    v_mul_f32 v161, v161, v4
    v_mul_f32 v162, v162, v4
    v_mul_f32 v163, v163, v4
    v_mfma_f32_16x16x32_bf16 v[156:159], v[220:223], v[72:75], v[156:159]
    v_mul_f32 v164, v164, v4
    v_mul_f32 v165, v165, v4
    v_mul_f32 v166, v166, v4
    v_mul_f32 v167, v167, v4
    v_mfma_f32_16x16x32_bf16 v[160:163], v[224:227], v[72:75], v[160:163]
    v_mul_f32 v168, v168, v4
    v_mul_f32 v169, v169, v4
    v_mul_f32 v170, v170, v4
    v_mul_f32 v171, v171, v4
    v_mfma_f32_16x16x32_bf16 v[164:167], v[228:231], v[72:75], v[164:167]
    v_mul_f32 v172, v172, v4
    v_mul_f32 v173, v173, v4
    v_mul_f32 v174, v174, v4
    v_mul_f32 v175, v175, v4
    v_mfma_f32_16x16x32_bf16 v[168:171], v[232:235], v[72:75], v[168:171]
    v_mul_f32 v176, v176, v4
    v_mul_f32 v177, v177, v4
    v_mul_f32 v178, v178, v4
    v_mul_f32 v179, v179, v4
    v_mfma_f32_16x16x32_bf16 v[172:175], v[236:239], v[72:75], v[172:175]
    v_mul_f32 v180, v180, v4
    v_mul_f32 v181, v181, v4
    v_mul_f32 v182, v182, v4
    v_mul_f32 v183, v183, v4
    v_mfma_f32_16x16x32_bf16 v[176:179], v[240:243], v[72:75], v[176:179]
    v_mul_f32 v184, v184, v4
    v_mul_f32 v185, v185, v4
    v_mul_f32 v186, v186, v4
    v_mul_f32 v187, v187, v4
    v_mfma_f32_16x16x32_bf16 v[180:183], v[244:247], v[72:75], v[180:183]
    v_mul_f32 v188, v188, v4
    v_mul_f32 v189, v189, v4
    v_mul_f32 v190, v190, v4
    v_mul_f32 v191, v191, v4
    v_mfma_f32_16x16x32_bf16 v[184:187], v[248:251], v[72:75], v[184:187]
    s_nop 0
    v_mfma_f32_16x16x32_bf16 v[188:191], v[252:255], v[72:75], v[188:191]
    v_fma_f32 v23, v23, v4, v64
    v_add_f32 v23, v23, v65
    v_add_f32 v23, v23, v66
    v_add_f32 v23, v23, v67
    v_add_f32 v23, v23, v68
    v_add_f32 v23, v23, v69
    v_add_f32 v23, v23, v70
    v_add_f32 v23, v23, v71
    s_add_u32 s27, s27, 1
    s_cmp_lt_u32 s27, 16
    s_cbranch_scc1 L_CT
    s_waitcnt vmcnt(0)
    s_barrier
    v_mov_b32 v4, v23
    s_nop 1
    v_permlane32_swap_b32 v23, v4
    v_add_f32 v23, v23, v4
    v_mov_b32 v4, v23
    s_nop 1
    v_permlane16_swap_b32 v23, v4
    v_add_f32 v23, v23, v4
    s_lshl_b32 s24, s3, 9
    v_lshl_add_u32 v3, v0, 3, s24
    ds_write_b64 v3, v[22:23] offset:0
    v_xor_b32 v3, 0x400, v3
    s_waitcnt lgkmcnt(0)
    s_barrier
    ds_read_b64 v[6:7], v3 offset:0
    s_waitcnt lgkmcnt(0)
    v_max_f32 v3, v22, v6
    v_sub_f32 v4, v22, v3
    v_sub_f32 v6, v6, v3
    v_exp_f32 v4, v4
    v_exp_f32 v6, v6
    v_mov_b32 v22, v3
    v_mul_f32 v23, v23, v4
    v_fmac_f32 v23, v7, v6
    v_and_b32 v3, 15, v0
    v_lshlrev_b32 v5, 3, v3
    s_lshl_b32 s24, s71, 2
    s_add_u32 s31, s24, s70
    s_lshl_b32 s24, s31, 8
    s_mul_i32 s25, s75, 128
    s_add_u32 s24, s24, s25
    s_add_u32 s24, s24, 0x120000
    s_cmp_lg_u32 s3, 0
    s_cbranch_scc1 L_C_ml
    s_mov_b64 exec, 0xffff
    buffer_store_dwordx2 v[22:23], v5, s[12:15], s24 offen sc1
    s_mov_b64 exec, -1
L_C_ml:
    v_pk_mul_f32 v[128:129], v[128:129], v[4:5] op_sel_hi:[1,0]
    v_pk_mul_f32 v[130:131], v[130:131], v[4:5] op_sel_hi:[1,0]
    v_pk_mul_f32 v[132:133], v[132:133], v[4:5] op_sel_hi:[1,0]
    v_pk_mul_f32 v[134:135], v[134:135], v[4:5] op_sel_hi:[1,0]
    v_pk_mul_f32 v[136:137], v[136:137], v[4:5] op_sel_hi:[1,0]
    v_pk_mul_f32 v[138:139], v[138:139], v[4:5] op_sel_hi:[1,0]
    v_pk_mul_f32 v[140:141], v[140:141], v[4:5] op_sel_hi:[1,0]
    v_pk_mul_f32 v[142:143], v[142:143], v[4:5] op_sel_hi:[1,0]
    v_pk_mul_f32 v[144:145], v[144:145], v[4:5] op_sel_hi:[1,0]
    v_pk_mul_f32 v[146:147], v[146:147], v[4:5] op_sel_hi:[1,0]
    v_pk_mul_f32 v[148:149], v[148:149], v[4:5] op_sel_hi:[1,0]
    v_pk_mul_f32 v[150:151], v[150:151], v[4:5] op_sel_hi:[1,0]
    v_pk_mul_f32 v[152:153], v[152:153], v[4:5] op_sel_hi:[1,0]
    v_pk_mul_f32 v[154:155], v[154:155], v[4:5] op_sel_hi:[1,0]
    v_pk_mul_f32 v[156:157], v[156:157], v[4:5] op_sel_hi:[1,0]
    v_pk_mul_f32 v[158:159], v[158:159], v[4:5] op_sel_hi:[1,0]
    v_pk_mul_f32 v[160:161], v[160:161], v[4:5] op_sel_hi:[1,0]
    v_pk_mul_f32 v[162:163], v[162:163], v[4:5] op_sel_hi:[1,0]
    v_pk_mul_f32 v[164:165], v[164:165], v[4:5] op_sel_hi:[1,0]
    v_pk_mul_f32 v[166:167], v[166:167], v[4:5] op_sel_hi:[1,0]
    v_pk_mul_f32 v[168:169], v[168:169], v[4:5] op_sel_hi:[1,0]
    v_pk_mul_f32 v[170:171], v[170:171], v[4:5] op_sel_hi:[1,0]
    v_pk_mul_f32 v[172:173], v[172:173], v[4:5] op_sel_hi:[1,0]
    v_pk_mul_f32 v[174:175], v[174:175], v[4:5] op_sel_hi:[1,0]
    v_pk_mul_f32 v[176:177], v[176:177], v[4:5] op_sel_hi:[1,0]
    v_pk_mul_f32 v[178:179], v[178:179], v[4:5] op_sel_hi:[1,0]
    v_pk_mul_f32 v[180:181], v[180:181], v[4:5] op_sel_hi:[1,0]
    v_pk_mul_f32 v[182:183], v[182:183], v[4:5] op_sel_hi:[1,0]
    v_pk_mul_f32 v[184:185], v[184:185], v[4:5] op_sel_hi:[1,0]
    v_pk_mul_f32 v[186:187], v[186:187], v[4:5] op_sel_hi:[1,0]
    v_pk_mul_f32 v[188:189], v[188:189], v[4:5] op_sel_hi:[1,0]
    v_pk_mul_f32 v[190:191], v[190:191], v[4:5] op_sel_hi:[1,0]
    s_lshl_b32 s24, s3, 13
    s_add_u32 s24, s24, 4096
    v_add_u32 v6, s24, v2
    s_xor_b32 s24, s3, 2
    s_lshl_b32 s24, s24, 13
    s_add_u32 s24, s24, 4096
    v_add_u32 v7, s24, v2
    s_cmp_lg_u32 s28, 0
    s_cbranch_scc1 L_C_x1
    ds_write_b128 v6, v[160:163] offset:0
    ds_write_b128 v6, v[164:167] offset:1024
    ds_write_b128 v6, v[168:171] offset:2048
    ds_write_b128 v6, v[172:175] offset:3072
    ds_write_b128 v6, v[176:179] offset:4096
    ds_write_b128 v6, v[180:183] offset:5120
    ds_write_b128 v6, v[184:187] offset:6144
    ds_write_b128 v6, v[188:191] offset:7168
    s_branch L_C_x2
L_C_x1:
    ds_write_b128 v6, v[128:131] offset:0
    ds_write_b128 v6, v[132:135] offset:1024
    ds_write_b128 v6, v[136:139] offset:2048
    ds_write_b128 v6, v[140:143] offset:3072
    ds_write_b128 v6, v[144:147] offset:4096
    ds_write_b128 v6, v[148:151] offset:5120
    ds_write_b128 v6, v[152:155] offset:6144
    ds_write_b128 v6, v[156:159] offset:7168
    s_waitcnt lgkmcnt(0)
    v_mov_b32 v128, v160
    v_mov_b32 v129, v161
    v_mov_b32 v130, v162
    v_mov_b32 v131, v163
    v_mov_b32 v132, v164
    v_mov_b32 v133, v165
    v_mov_b32 v134, v166
    v_mov_b32 v135, v167
    v_mov_b32 v136, v168
    v_mov_b32 v137, v169
    v_mov_b32 v138, v170
    v_mov_b32 v139, v171
    v_mov_b32 v140, v172
    v_mov_b32 v141, v173
    v_mov_b32 v142, v174
    v_mov_b32 v143, v175
    v_mov_b32 v144, v176
    v_mov_b32 v145, v177
    v_mov_b32 v146, v178
    v_mov_b32 v147, v179
    v_mov_b32 v148, v180
    v_mov_b32 v149, v181
    v_mov_b32 v150, v182
    v_mov_b32 v151, v183
    v_mov_b32 v152, v184
    v_mov_b32 v153, v185
    v_mov_b32 v154, v186
    v_mov_b32 v155, v187
    v_mov_b32 v156, v188
    v_mov_b32 v157, v189
    v_mov_b32 v158, v190
    v_mov_b32 v159, v191
L_C_x2:
    s_waitcnt lgkmcnt(0)
    s_barrier
    ds_read_b128 v[192:195], v7 offset:0
    ds_read_b128 v[196:199], v7 offset:1024
    ds_read_b128 v[200:203], v7 offset:2048
    ds_read_b128 v[204:207], v7 offset:3072
    ds_read_b128 v[208:211], v7 offset:4096
    ds_read_b128 v[212:215], v7 offset:5120
    ds_read_b128 v[216:219], v7 offset:6144
    ds_read_b128 v[220:223], v7 offset:7168
    v_lshrrev_b32 v4, 4, v0
    v_mul_u32_u24 v3, 272, v3
    v_lshl_add_u32 v3, v4, 3, v3
    s_mul_i32 s24, s3, 4352
    s_add_u32 s24, s24, 40960
    v_add_u32 v3, s24, v3
    s_waitcnt lgkmcnt(7)
    v_add_f32 v128, v128, v192
    v_add_f32 v129, v129, v193
    v_add_f32 v130, v130, v194
    v_add_f32 v131, v131, v195
    v_cvt_pk_bf16_f32 v32, v128, v129
    v_cvt_pk_bf16_f32 v33, v130, v131
    ds_write_b64 v3, v[32:33] offset:0
    s_waitcnt lgkmcnt(7)
    v_add_f32 v132, v132, v196
    v_add_f32 v133, v133, v197
    v_add_f32 v134, v134, v198
    v_add_f32 v135, v135, v199
    v_cvt_pk_bf16_f32 v34, v132, v133
    v_cvt_pk_bf16_f32 v35, v134, v135
    ds_write_b64 v3, v[34:35] offset:32
    s_waitcnt lgkmcnt(7)
    v_add_f32 v136, v136, v200
    v_add_f32 v137, v137, v201
    v_add_f32 v138, v138, v202
    v_add_f32 v139, v139, v203
    v_cvt_pk_bf16_f32 v36, v136, v137
    v_cvt_pk_bf16_f32 v37, v138, v139
    ds_write_b64 v3, v[36:37] offset:64
    s_waitcnt lgkmcnt(7)
    v_add_f32 v140, v140, v204
    v_add_f32 v141, v141, v205
    v_add_f32 v142, v142, v206
    v_add_f32 v143, v143, v207
    v_cvt_pk_bf16_f32 v38, v140, v141
    v_cvt_pk_bf16_f32 v39, v142, v143
    ds_write_b64 v3, v[38:39] offset:96
    s_waitcnt lgkmcnt(7)
    v_add_f32 v144, v144, v208
    v_add_f32 v145, v145, v209
    v_add_f32 v146, v146, v210
    v_add_f32 v147, v147, v211
    v_cvt_pk_bf16_f32 v40, v144, v145
    v_cvt_pk_bf16_f32 v41, v146, v147
    ds_write_b64 v3, v[40:41] offset:128
    s_waitcnt lgkmcnt(7)
    v_add_f32 v148, v148, v212
    v_add_f32 v149, v149, v213
    v_add_f32 v150, v150, v214
    v_add_f32 v151, v151, v215
    v_cvt_pk_bf16_f32 v42, v148, v149
    v_cvt_pk_bf16_f32 v43, v150, v151
    ds_write_b64 v3, v[42:43] offset:160
    s_waitcnt lgkmcnt(7)
    v_add_f32 v152, v152, v216
    v_add_f32 v153, v153, v217
    v_add_f32 v154, v154, v218
    v_add_f32 v155, v155, v219
    v_cvt_pk_bf16_f32 v44, v152, v153
    v_cvt_pk_bf16_f32 v45, v154, v155
    ds_write_b64 v3, v[44:45] offset:192
    s_waitcnt lgkmcnt(7)
    v_add_f32 v156, v156, v220
    v_add_f32 v157, v157, v221
    v_add_f32 v158, v158, v222
    v_add_f32 v159, v159, v223
    v_cvt_pk_bf16_f32 v46, v156, v157
    v_cvt_pk_bf16_f32 v47, v158, v159
    ds_write_b64 v3, v[46:47] offset:224
    v_and_b32 v5, 15, v0
    v_mul_u32_u24 v3, 272, v4
    v_lshl_add_u32 v3, v5, 4, v3
    v_add_u32 v3, s24, v3
    v_lshlrev_b32 v4, 11, v4
    v_lshl_add_u32 v4, v5, 4, v4
    s_waitcnt lgkmcnt(0)
    ds_read_b128 v[64:67], v3 offset:0
    ds_read_b128 v[68:71], v3 offset:1088
    ds_read_b128 v[72:75], v3 offset:2176
    ds_read_b128 v[76:79], v3 offset:3264
    s_lshl_b32 s24, s31, 16
    s_lshl_b32 s25, s29, 9
    s_add_u32 s24, s24, s25
    s_lshl_b32 s25, s28, 8
    s_add_u32 s24, s24, s25
    s_mul_i32 s25, s75, 32768
    s_add_u32 s24, s24, s25
    s_add_u32 s24, s24, 0x400000
    s_waitcnt lgkmcnt(3)
    buffer_store_dwordx4 v[64:67], v4, s[12:15], s24 offen sc1 nt
    s_add_u32 s24, s24, 8192
    s_waitcnt lgkmcnt(2)
    buffer_store_dwordx4 v[68:71], v4, s[12:15], s24 offen sc1 nt
    s_add_u32 s24, s24, 8192
    s_waitcnt lgkmcnt(1)
    buffer_store_dwordx4 v[72:75], v4, s[12:15], s24 offen sc1 nt
    s_add_u32 s24, s24, 8192
    s_waitcnt lgkmcnt(0)
    buffer_store_dwordx4 v[76:79], v4, s[12:15], s24 offen sc1 nt
    s_add_u32 s24, s24, 8192
    s_waitcnt vmcnt(0)
    s_barrier
    s_cmp_lg_u32 s3, 0
    s_cbranch_scc1 L_sig26
    s_mov_b64 exec, 1
    v_mov_b32 v3, 1
    buffer_atomic_add v3, off, s[16:19], 0 offset:4 sc0
    s_waitcnt vmcnt(0)
    v_readfirstlane_b32 s24, v3
    s_mov_b64 exec, -1
    s_and_b32 s24, s24, 31
    s_cmp_lg_u32 s24, 31
    s_cbranch_scc1 L_sig26
    v_lshlrev_b32 v4, 7, v0
    v_mov_b32 v3, 1
    s_mov_b32 s24, 0x170000
    s_mov_b32 exec_hi, 0
    buffer_store_dword v3, v4, s[12:15], s24 offen offset:4 sc1
    s_mov_b64 exec, -1
L_sig26:
    s_branch L_R
L_last:
    s_endpgm
.section .rodata,"a"
.p2align 6
.amdhsa_kernel concat_heads__compressed_kv_cla__mha_block_cached__decode_kernel
  .amdhsa_next_free_vgpr 448
  .amdhsa_next_free_sgpr 102
  .amdhsa_accum_offset 256
  .amdhsa_group_segment_fixed_size 0
  .amdhsa_kernarg_size 112
  .amdhsa_user_sgpr_count 2
  .amdhsa_user_sgpr_kernarg_segment_ptr 1
  .amdhsa_system_sgpr_workgroup_id_x 1
  .amdhsa_float_denorm_mode_32 3
.end_amdhsa_kernel
```

```asm
; @launch grid=(256,1,1) block=(256,1,1) lds=149504
.amdgcn_target "amdgcn-amd-amdhsa--gfx950"
.text
.globl concat_heads__compressed_kv_cla__mha_block_cached__decode_kernel
.p2align 8
.type concat_heads__compressed_kv_cla__mha_block_cached__decode_kernel,@function
concat_heads__compressed_kv_cla__mha_block_cached__decode_kernel:
    s_load_dwordx16 s[36:51], s[0:1], 0
    s_load_dwordx8 s[52:59], s[0:1], 64
    s_load_dwordx4 s[60:63], s[0:1], 96
    s_cmp_ge_u32 s2, 256
    s_cbranch_scc1 L_end
    s_cmp_lt_u32 s2, 64
    s_getpc_b64 s[24:25]
L_pc0:
    s_cselect_b32 s20, L_A-L_pc0, 0
    v_lshlrev_b32 v16, 7, v0
    v_min_u32 v16, L_A-L_pc0-4, v16
    v_add_u32 v16, s20, v16
    v_add_co_u32 v16, vcc, s24, v16
    v_mov_b32 v17, s25
    s_nop 0
    v_addc_co_u32 v17, vcc, 0, v17, vcc
    global_load_dword v17, v[16:17], off
    s_cbranch_scc1 L_A
L_B:
    s_and_b32 s70, s2, 6
    s_and_b32 s25, s2, 7
    s_add_u32 s70, s70, s25
    s_lshl_b32 s25, s70, 8
    v_and_b32 v6, 15, v0
    v_lshl_add_u32 v24, v6, 4, s25
    v_and_b32 v4, 16, v0
    v_lshl_add_u32 v24, v4, 5, v24
    v_lshrrev_b32 v4, 5, v0
    v_lshl_add_u32 v24, v4, 12, v24
    s_lshr_b32 s74, s2, 3
    s_lshl_b32 s74, s74, 2
    s_addk_i32 s74, -32
    s_mov_b32 s10, 0x400000
    s_mov_b32 s11, 0x20000
    s_waitcnt lgkmcnt(0)
    s_mov_b64 s[8:9], s[54:55]
L_pfb:
    s_lshl_b32 s24, s74, 13
    buffer_load_dwordx4 v[28:31], v24, s[8:11], s24 offen
    s_addk_i32 s74, 96
    s_cmpk_lt_u32 s74, 512
    s_cbranch_scc1 L_pfb
    s_addk_i32 s74, -512
    s_mov_b64 s[8:9], s[40:41]
L_pfq:
    s_lshl_b32 s24, s74, 13
    buffer_load_dwordx4 v[28:31], v24, s[8:11], s24 offen
    s_addk_i32 s74, 96
    s_cmpk_lt_u32 s74, 512
    s_cbranch_scc1 L_pfq
    s_addk_i32 s74, -512
    v_lshrrev_b32 v1, 6, v0
    v_and_b32 v0, 63, v0
    v_readfirstlane_b32 s3, v1
    v_lshlrev_b32 v2, 4, v0
    s_lshr_b32 s24, s2, 3
    s_sub_u32 s24, s24, 8
    s_mul_i32 s26, s24, 43
    s_lshr_b32 s26, s26, 8
    s_mul_i32 s27, s26, 6
    s_sub_u32 s27, s24, s27
    s_and_b32 s25, s26, 1
    s_lshl_b32 s25, s25, 1
    s_and_b32 s26, s26, 2
    s_lshl_b32 s26, s26, 3
    s_or_b32 s26, s26, s25
    s_or_b32 s26, s26, s70
    s_lshl_b32 s25, s70, 17
    s_lshl_b32 s24, s3, 8
    s_add_u32 s25, s25, s24
    v_lshl_add_u32 v25, v6, 4, s25
    v_and_b32 v4, 16, v0
    v_lshl_add_u32 v25, v4, 14, v25
    v_and_b32 v4, 32, v0
    v_lshl_add_u32 v25, v4, 16, v25
    s_and_b32 s25, s2, 3
    s_lshl_b32 s25, s25, 10
    s_lshl_b32 s24, s3, 12
    s_add_u32 s25, s25, s24
    s_bfe_u32 s24, s2, 0x10002
    s_lshl_b32 s24, s24, 23
    s_add_u32 s25, s25, s24
    v_add_u32 v26, s25, v2
    s_cmp_ge_u32 s27, 3
    s_cselect_b32 s28, 1, 0
    s_mul_i32 s29, s28, 3
    s_sub_u32 s29, s27, s29
    s_lshr_b32 s72, s3, 1
    s_lshl_b32 s24, s28, 1
    s_add_u32 s72, s72, s24
    s_and_b32 s31, s3, 1
    s_lshl_b32 s24, s29, 1
    s_add_u32 s31, s31, s24
    s_lshl_b32 s30, s72, 5
    s_add_u32 s30, s30, s26
    s_lshl_b32 s30, s30, 20
    v_lshrrev_b32 v3, 4, v0
    v_and_b32 v4, 3, v0
    v_lshlrev_b32 v5, 6, v3
    v_lshl_add_u32 v5, v4, 4, v5
    v_bfe_u32 v1, v0, 2, 2
    v_lshl_add_u32 v1, v1, 8, v5
    s_mul_i32 s35, s31, 1024
    s_add_u32 s32, s35, 983040
    s_mul_i32 s28, s31, 1024
    s_add_u32 s28, s28, 1044480
    s_mov_b32 s6, 0x100000
    s_mov_b32 s7, 0x20000
    s_add_u32 s4, s50, s30
    s_addc_u32 s5, s51, 0
    s_mov_b32 s12, s62
    s_mov_b32 s13, s63
    s_mov_b32 s14, 0x600000
    s_mov_b32 s15, 0x20000
    s_mov_b32 s16, s60
    s_mov_b32 s17, s61
    s_mov_b32 s18, 0x100
    s_mov_b32 s19, 0x20000
    v_and_b32 v3, 1, v0
    v_lshlrev_b32 v3, 4, v3
    v_mov_b32 v4, 0xffff
    v_lshlrev_b32 v4, v3, v4
    v_bfe_u32 v3, v0, 1, 2
    v_cmp_eq_u32 vcc, 0, v3
    s_nop 1
    v_cndmask_b32 v20, 0, v4, vcc
    v_cmp_eq_u32 vcc, 1, v3
    s_nop 1
    v_cndmask_b32 v21, 0, v4, vcc
    v_cmp_eq_u32 vcc, 2, v3
    s_nop 1
    v_cndmask_b32 v22, 0, v4, vcc
    v_cmp_eq_u32 vcc, 3, v3
    s_nop 1
    v_cndmask_b32 v23, 0, v4, vcc
    s_mov_b32 s64, 0x22222222
    s_mov_b32 s65, 0x22222222
    s_mov_b32 s66, 0x44444444
    s_mov_b32 s67, 0x44444444
    s_mov_b32 s68, 0x88888888
    s_mov_b32 s69, 0x88888888
    v_mov_b32 v32, 0
    v_mov_b32 v33, 0
    v_mov_b32 v34, 0
    v_mov_b32 v35, 0
    v_mov_b32 v36, 0
    v_mov_b32 v37, 0
    v_mov_b32 v38, 0
    v_mov_b32 v39, 0
    v_mov_b32 v40, 0
    v_mov_b32 v41, 0
    v_mov_b32 v42, 0
    v_mov_b32 v43, 0
    v_mov_b32 v44, 0
    v_mov_b32 v45, 0
    v_mov_b32 v46, 0
    v_mov_b32 v47, 0
    v_lshrrev_b32 v3, 4, v0
    v_lshlrev_b32 v60, 6, v3
    v_and_b32 v4, 7, v0
    v_lshl_add_u32 v60, v4, 3, v60
    s_lshl_b32 s33, s26, 2
    s_add_u32 s33, s33, s72
    s_lshl_b32 s34, s26, 12
    s_lshl_b32 s24, s72, 8
    s_add_u32 s34, s34, s24
    s_add_u32 s34, s34, 0x140000
    s_mul_i32 s73, s33, 6
    s_add_u32 s73, s73, s31
    s_lshl_b32 s73, s73, 8
    s_add_u32 s73, s73, 0x180000
    s_mov_b64 s[8:9], s[56:57]
L_pfo:
    s_lshl_b32 s24, s74, 8
    s_waitcnt vmcnt(6)
    buffer_load_dwordx4 v[28:31], v25, s[8:11], s24 offen
    s_addk_i32 s74, 96
    s_cmpk_lt_u32 s74, 512
    s_cbranch_scc1 L_pfo
    s_addk_i32 s74, -512
    s_mov_b64 s[8:9], s[42:43]
L_pfk:
    s_lshl_b32 s24, s74, 13
    s_waitcnt vmcnt(6)
    buffer_load_dwordx4 v[28:31], v24, s[8:11], s24 offen
    s_addk_i32 s74, 96
    s_cmpk_lt_u32 s74, 512
    s_cbranch_scc1 L_pfk
    s_addk_i32 s74, -512
    s_mov_b64 s[8:9], s[44:45]
L_pfu:
    s_lshl_b32 s24, s74, 13
    s_waitcnt vmcnt(6)
    buffer_load_dwordx4 v[28:31], v24, s[8:11], s24 offen
    s_addk_i32 s74, 96
    s_cmpk_lt_u32 s74, 512
    s_cbranch_scc1 L_pfu
    s_addk_i32 s74, -512
    s_mov_b64 s[8:9], s[46:47]
L_pfv:
    s_lshl_b32 s24, s74, 8
    s_waitcnt vmcnt(6)
    buffer_load_dwordx4 v[28:31], v25, s[8:11], s24 offen
    s_addk_i32 s74, 96
    s_cmpk_lt_u32 s74, 512
    s_cbranch_scc1 L_pfv
    s_addk_i32 s74, -512
    s_mov_b64 s[8:9], s[38:39]
    s_mov_b32 s10, 0x1000000
L_pfc:
    s_lshl_b32 s24, s74, 12
    s_waitcnt vmcnt(6)
    buffer_load_dwordx4 v[28:31], v26, s[8:11], s24 offen
    s_addk_i32 s74, 96
    s_cmpk_lt_u32 s74, 2048
    s_cbranch_scc1 L_pfc
    s_addk_i32 s74, -2048
    s_mov_b32 s10, 0x400000
    s_waitcnt vmcnt(15)
    buffer_load_dwordx4 a[0:3], v1, s[4:7], s32 offen offset:0 nt
    s_add_u32 s32, s32, 6144
    s_waitcnt vmcnt(15)
    buffer_load_dwordx4 a[4:7], v1, s[4:7], s32 offen offset:0 nt
    s_add_u32 s32, s32, 6144
    s_waitcnt vmcnt(15)
    buffer_load_dwordx4 a[8:11], v1, s[4:7], s32 offen offset:0 nt
    s_add_u32 s32, s32, 6144
    s_waitcnt vmcnt(15)
    buffer_load_dwordx4 a[12:15], v1, s[4:7], s32 offen offset:0 nt
    s_add_u32 s32, s32, 6144
    s_waitcnt vmcnt(15)
    buffer_load_dwordx4 a[16:19], v1, s[4:7], s32 offen offset:0 nt
    s_add_u32 s32, s32, 6144
    s_waitcnt vmcnt(15)
    buffer_load_dwordx4 a[20:23], v1, s[4:7], s32 offen offset:0 nt
    s_add_u32 s32, s32, 6144
    s_waitcnt vmcnt(15)
    buffer_load_dwordx4 a[24:27], v1, s[4:7], s32 offen offset:0 nt
    s_add_u32 s32, s32, 6144
    s_waitcnt vmcnt(15)
    buffer_load_dwordx4 a[28:31], v1, s[4:7], s32 offen offset:0 nt
    s_add_u32 s32, s32, 6144
    s_waitcnt vmcnt(15)
    buffer_load_dwordx4 a[32:35], v1, s[4:7], s32 offen offset:0 nt
    s_add_u32 s32, s32, 6144
    s_waitcnt vmcnt(15)
    buffer_load_dwordx4 a[36:39], v1, s[4:7], s32 offen offset:0 nt
    s_add_u32 s32, s32, 6144
    s_waitcnt vmcnt(15)
    buffer_load_dwordx4 a[40:43], v1, s[4:7], s28 offen offset:0 nt
    s_waitcnt vmcnt(15)
    s_mov_b32 s32, s35
    buffer_load_dwordx4 a[64:67], v1, s[4:7], s32 offen offset:0 nt
    s_add_u32 s32, s32, 6144
    s_waitcnt vmcnt(15)
    buffer_load_dwordx4 a[68:71], v1, s[4:7], s32 offen offset:0 nt
    s_add_u32 s32, s32, 6144
    s_waitcnt vmcnt(15)
    buffer_load_dwordx4 a[72:75], v1, s[4:7], s32 offen offset:0 nt
    s_add_u32 s32, s32, 6144
    s_waitcnt vmcnt(15)
    buffer_load_dwordx4 a[76:79], v1, s[4:7], s32 offen offset:0 nt
    s_add_u32 s32, s32, 6144
    s_waitcnt vmcnt(15)
    buffer_load_dwordx4 a[80:83], v1, s[4:7], s32 offen offset:0 nt
    s_add_u32 s32, s32, 6144
    s_mov_b64 exec, 1
    buffer_load_dword v61, off, s[16:19], 0 offset:128 sc1
    s_mov_b64 exec, -1
    s_waitcnt vmcnt(15)
    buffer_load_dwordx4 a[84:87], v1, s[4:7], s32 offen offset:0 nt
    s_add_u32 s32, s32, 6144
    s_waitcnt vmcnt(15)
    buffer_load_dwordx4 a[88:91], v1, s[4:7], s32 offen offset:0 nt
    s_add_u32 s32, s32, 6144
    s_waitcnt vmcnt(15)
    buffer_load_dwordx4 a[92:95], v1, s[4:7], s32 offen offset:0 nt
    s_add_u32 s32, s32, 6144
    s_waitcnt vmcnt(15)
    buffer_load_dwordx4 a[96:99], v1, s[4:7], s32 offen offset:0 nt
    s_add_u32 s32, s32, 6144
    s_waitcnt vmcnt(15)
    buffer_load_dwordx4 a[100:103], v1, s[4:7], s32 offen offset:0 nt
    s_add_u32 s32, s32, 6144
    s_waitcnt vmcnt(15)
    buffer_load_dwordx4 a[104:107], v1, s[4:7], s32 offen offset:0 nt
    s_add_u32 s32, s32, 6144
    s_waitcnt vmcnt(15)
    buffer_load_dwordx4 a[108:111], v1, s[4:7], s32 offen offset:0 nt
    s_add_u32 s32, s32, 6144
    s_waitcnt vmcnt(15)
    buffer_load_dwordx4 a[112:115], v1, s[4:7], s32 offen offset:0 nt
    s_add_u32 s32, s32, 6144
    s_waitcnt vmcnt(15)
    buffer_load_dwordx4 a[116:119], v1, s[4:7], s32 offen offset:0 nt
    s_add_u32 s32, s32, 6144
    s_waitcnt vmcnt(15)
    buffer_load_dwordx4 a[120:123], v1, s[4:7], s32 offen offset:0 nt
    s_add_u32 s32, s32, 6144
    s_waitcnt vmcnt(15)
    buffer_load_dwordx4 a[124:127], v1, s[4:7], s32 offen offset:0 nt
    s_add_u32 s32, s32, 6144
    s_waitcnt vmcnt(15)
    buffer_load_dwordx4 v[64:67], v1, s[4:7], s32 offen offset:0 nt
    s_add_u32 s32, s32, 6144
    s_waitcnt vmcnt(12)
    v_readfirstlane_b32 s25, v61
    s_nop 0
    s_cmp_ge_u32 s25, 32
    s_cbranch_scc1 L_B_q
    s_mov_b32 s24, 262144
    s_mov_b64 exec, 1
L_aw1:
    buffer_load_dword v61, off, s[16:19], 0 offset:128 sc1
    s_waitcnt vmcnt(0)
    v_readfirstlane_b32 s25, v61
    s_nop 0
    s_cmp_ge_u32 s25, 32
    s_cbranch_scc1 L_B_q
    s_sleep 16
    s_sub_u32 s24, s24, 1
    s_cmp_lg_u32 s24, 0
    s_cbranch_scc1 L_aw1
L_B_q:
    s_mov_b64 exec, -1
    buffer_load_dwordx4 v[8:11], v5, s[12:15], s34 offen sc1
    s_waitcnt vmcnt(15)
    buffer_load_dwordx4 v[68:71], v1, s[4:7], s32 offen offset:0 nt
    s_add_u32 s32, s32, 6144
    s_waitcnt vmcnt(15)
    buffer_load_dwordx4 v[72:75], v1, s[4:7], s32 offen offset:0 nt
    s_add_u32 s32, s32, 6144
    s_waitcnt vmcnt(15)
    buffer_load_dwordx4 v[76:79], v1, s[4:7], s32 offen offset:0 nt
    s_add_u32 s32, s32, 6144
    s_waitcnt vmcnt(15)
    buffer_load_dwordx4 v[80:83], v1, s[4:7], s32 offen offset:0 nt
    s_add_u32 s32, s32, 6144
    s_waitcnt vmcnt(15)
    buffer_load_dwordx4 v[84:87], v1, s[4:7], s32 offen offset:0 nt
    s_add_u32 s32, s32, 6144
    s_waitcnt vmcnt(15)
    buffer_load_dwordx4 v[88:91], v1, s[4:7], s32 offen offset:0 nt
    s_add_u32 s32, s32, 6144
    s_waitcnt vmcnt(15)
    buffer_load_dwordx4 v[92:95], v1, s[4:7], s32 offen offset:0 nt
    s_add_u32 s32, s32, 6144
    s_waitcnt vmcnt(15)
    buffer_load_dwordx4 v[96:99], v1, s[4:7], s32 offen offset:0 nt
    s_add_u32 s32, s32, 6144
    s_waitcnt vmcnt(15)
    buffer_load_dwordx4 v[100:103], v1, s[4:7], s32 offen offset:0 nt
    s_add_u32 s32, s32, 6144
    s_waitcnt vmcnt(15)
    buffer_load_dwordx4 v[104:107], v1, s[4:7], s32 offen offset:0 nt
    s_add_u32 s32, s32, 6144
    s_waitcnt vmcnt(15)
    buffer_load_dwordx4 v[108:111], v1, s[4:7], s32 offen offset:0 nt
    s_add_u32 s32, s32, 6144
    s_waitcnt vmcnt(15)
    buffer_load_dwordx4 v[112:115], v1, s[4:7], s32 offen offset:0 nt
    s_add_u32 s32, s32, 6144
    s_waitcnt vmcnt(15)
    buffer_load_dwordx4 v[116:119], v1, s[4:7], s32 offen offset:0 nt
    s_add_u32 s32, s32, 6144
    s_waitcnt vmcnt(15)
    buffer_load_dwordx4 v[120:123], v1, s[4:7], s32 offen offset:0 nt
    s_add_u32 s32, s32, 6144
    s_waitcnt vmcnt(15)
    buffer_load_dwordx4 v[124:127], v1, s[4:7], s32 offen offset:0 nt
    s_add_u32 s32, s32, 6144
    s_waitcnt vmcnt(15)
    v_mov_b32_dpp v32, v8 quad_perm:[0,1,2,3] row_mask:0xf bank_mask:0x1
    v_mov_b32_dpp v33, v9 quad_perm:[0,1,2,3] row_mask:0xf bank_mask:0x1
    v_mov_b32_dpp v34, v10 quad_perm:[0,1,2,3] row_mask:0xf bank_mask:0x1
    v_mov_b32_dpp v35, v11 quad_perm:[0,1,2,3] row_mask:0xf bank_mask:0x1
    v_mov_b32_dpp v36, v8 quad_perm:[0,1,2,3] row_mask:0xf bank_mask:0x2
    v_mov_b32_dpp v37, v9 quad_perm:[0,1,2,3] row_mask:0xf bank_mask:0x2
    v_mov_b32_dpp v38, v10 quad_perm:[0,1,2,3] row_mask:0xf bank_mask:0x2
    v_mov_b32_dpp v39, v11 quad_perm:[0,1,2,3] row_mask:0xf bank_mask:0x2
    v_mov_b32_dpp v40, v8 quad_perm:[0,1,2,3] row_mask:0xf bank_mask:0x4
    v_mov_b32_dpp v41, v9 quad_perm:[0,1,2,3] row_mask:0xf bank_mask:0x4
    v_mov_b32_dpp v42, v10 quad_perm:[0,1,2,3] row_mask:0xf bank_mask:0x4
    v_mov_b32_dpp v43, v11 quad_perm:[0,1,2,3] row_mask:0xf bank_mask:0x4
    v_mov_b32_dpp v44, v8 quad_perm:[0,1,2,3] row_mask:0xf bank_mask:0x8
    v_mov_b32_dpp v45, v9 quad_perm:[0,1,2,3] row_mask:0xf bank_mask:0x8
    v_mov_b32_dpp v46, v10 quad_perm:[0,1,2,3] row_mask:0xf bank_mask:0x8
    v_mov_b32_dpp v47, v11 quad_perm:[0,1,2,3] row_mask:0xf bank_mask:0x8
    s_mov_b32 s27, 1
L_BK:
    s_cmp_lg_u32 s27, 9
    s_cbranch_scc1 L_BK_a
    s_add_u32 s4, s52, s30
    s_addc_u32 s5, s53, 0
    s_mov_b32 s32, s35
    v_mov_b32 v1, v2
L_BK_a:
    s_barrier
    s_cmp_lg_u32 s27, 8
    s_cbranch_scc1 L_BK_x0
    s_and_b32 s24, s2, 7
    s_lshl_b32 s24, s24, 7
    s_add_u32 s24, s24, 0x1d8000
    v_and_b32 v63, 7, v0
    v_lshlrev_b32 v63, 2, v63
    buffer_load_dword v62, v63, s[12:15], s24 offen sc1
L_BK_x0:
    s_cmp_lg_u32 s27, 9
    s_cbranch_scc1 L_BK_x1
    s_getreg_b32 s24, hwreg(HW_REG_XCC_ID, 0, 4)
    v_cmp_ne_u32 vcc, s24, v62
    s_nop 0
    s_or_b32 s75, vcc_lo, vcc_hi
L_BK_x1:
    v_mov_b32 v49, v50
    v_mov_b32 v50, v51
    v_mov_b32 v51, v52
    v_mov_b32 v52, v53
    v_mov_b32 v53, v54
    v_mov_b32 v54, v55
    v_mov_b32 v55, v56
    v_mov_b32 v56, v57
    s_waitcnt vmcnt(15)
    v_mfma_f32_16x16x32_bf16 v[12:15], v[64:67], v[32:35], 0
    buffer_load_dwordx4 v[64:67], v1, s[4:7], s32 offen offset:0 nt
    s_add_u32 s32, s32, 6144
    s_waitcnt vmcnt(15)
    v_mfma_f32_16x16x32_bf16 v[12:15], v[68:71], v[36:39], v[12:15]
    buffer_load_dwordx4 v[68:71], v1, s[4:7], s32 offen offset:0 nt
    s_add_u32 s32, s32, 6144
    s_waitcnt vmcnt(15)
    v_mfma_f32_16x16x32_bf16 v[12:15], v[72:75], v[40:43], v[12:15]
    buffer_load_dwordx4 v[72:75], v1, s[4:7], s32 offen offset:0 nt
    s_add_u32 s32, s32, 6144
    s_waitcnt vmcnt(15)
    v_mfma_f32_16x16x32_bf16 v[12:15], v[76:79], v[44:47], v[12:15]
    buffer_load_dwordx4 v[76:79], v1, s[4:7], s32 offen offset:0 nt
    s_add_u32 s32, s32, 6144
    s_nop 5
    v_add_f32_dpp v57, v13, v12 quad_perm:[1,1,1,1] row_mask:0xf bank_mask:0xf
    s_nop 1
    v_add_f32_dpp v57, v14, v57 quad_perm:[2,2,2,2] row_mask:0xf bank_mask:0xf
    s_nop 1
    v_add_f32_dpp v57, v15, v57 quad_perm:[3,3,3,3] row_mask:0xf bank_mask:0xf
    s_waitcnt vmcnt(15)
    v_mfma_f32_16x16x32_bf16 v[16:19], v[80:83], v[32:35], 0
    buffer_load_dwordx4 v[80:83], v1, s[4:7], s32 offen offset:0 nt
    s_add_u32 s32, s32, 6144
    s_waitcnt vmcnt(15)
    v_mfma_f32_16x16x32_bf16 v[16:19], v[84:87], v[36:39], v[16:19]
    buffer_load_dwordx4 v[84:87], v1, s[4:7], s32 offen offset:0 nt
    s_add_u32 s32, s32, 6144
    s_waitcnt vmcnt(15)
    v_mfma_f32_16x16x32_bf16 v[16:19], v[88:91], v[40:43], v[16:19]
    buffer_load_dwordx4 v[88:91], v1, s[4:7], s32 offen offset:0 nt
    s_add_u32 s32, s32, 6144
    s_waitcnt vmcnt(15)
    v_mfma_f32_16x16x32_bf16 v[16:19], v[92:95], v[44:47], v[16:19]
    buffer_load_dwordx4 v[92:95], v1, s[4:7], s32 offen offset:0 nt
    s_add_u32 s32, s32, 6144
    s_nop 5
    v_add_f32_dpp v3, v16, v17 quad_perm:[0,0,0,0] row_mask:0xf bank_mask:0xf
    s_nop 1
    v_add_f32_dpp v3, v18, v3 quad_perm:[2,2,2,2] row_mask:0xf bank_mask:0xf
    s_nop 1
    v_add_f32_dpp v3, v19, v3 quad_perm:[3,3,3,3] row_mask:0xf bank_mask:0xf
    v_cndmask_b32 v57, v57, v3, s[64:65]
    s_waitcnt vmcnt(15)
    v_mfma_f32_16x16x32_bf16 v[12:15], v[96:99], v[32:35], 0
    buffer_load_dwordx4 v[96:99], v1, s[4:7], s32 offen offset:0 nt
    s_add_u32 s32, s32, 6144
    s_waitcnt vmcnt(15)
    v_mfma_f32_16x16x32_bf16 v[12:15], v[100:103], v[36:39], v[12:15]
    buffer_load_dwordx4 v[100:103], v1, s[4:7], s32 offen offset:0 nt
    s_add_u32 s32, s32, 6144
    s_waitcnt vmcnt(15)
    v_mfma_f32_16x16x32_bf16 v[12:15], v[104:107], v[40:43], v[12:15]
    buffer_load_dwordx4 v[104:107], v1, s[4:7], s32 offen offset:0 nt
    s_add_u32 s32, s32, 6144
    s_waitcnt vmcnt(15)
    v_mfma_f32_16x16x32_bf16 v[12:15], v[108:111], v[44:47], v[12:15]
    buffer_load_dwordx4 v[108:111], v1, s[4:7], s32 offen offset:0 nt
    s_add_u32 s32, s32, 6144
    s_nop 5
    v_add_f32_dpp v3, v12, v14 quad_perm:[0,0,0,0] row_mask:0xf bank_mask:0xf
    s_nop 1
    v_add_f32_dpp v3, v13, v3 quad_perm:[1,1,1,1] row_mask:0xf bank_mask:0xf
    s_nop 1
    v_add_f32_dpp v3, v15, v3 quad_perm:[3,3,3,3] row_mask:0xf bank_mask:0xf
    v_cndmask_b32 v57, v57, v3, s[66:67]
    s_waitcnt vmcnt(15)
    v_mfma_f32_16x16x32_bf16 v[16:19], v[112:115], v[32:35], 0
    buffer_load_dwordx4 v[112:115], v1, s[4:7], s32 offen offset:0 nt
    s_add_u32 s32, s32, 6144
    s_waitcnt vmcnt(15)
    v_mfma_f32_16x16x32_bf16 v[16:19], v[116:119], v[36:39], v[16:19]
    buffer_load_dwordx4 v[116:119], v1, s[4:7], s32 offen offset:0 nt
    s_add_u32 s32, s32, 6144
    s_waitcnt vmcnt(15)
    v_mfma_f32_16x16x32_bf16 v[16:19], v[120:123], v[40:43], v[16:19]
    buffer_load_dwordx4 v[120:123], v1, s[4:7], s32 offen offset:0 nt
    s_add_u32 s32, s32, 6144
    s_waitcnt vmcnt(15)
    v_mfma_f32_16x16x32_bf16 v[16:19], v[124:127], v[44:47], v[16:19]
    buffer_load_dwordx4 v[124:127], v1, s[4:7], s32 offen offset:0 nt
    s_add_u32 s32, s32, 6144
    s_nop 5
    v_add_f32_dpp v3, v16, v19 quad_perm:[0,0,0,0] row_mask:0xf bank_mask:0xf
    s_nop 1
    v_add_f32_dpp v3, v17, v3 quad_perm:[1,1,1,1] row_mask:0xf bank_mask:0xf
    s_nop 1
    v_add_f32_dpp v3, v18, v3 quad_perm:[2,2,2,2] row_mask:0xf bank_mask:0xf
    v_cndmask_b32 v57, v57, v3, s[68:69]
    s_cmp_lg_u32 s27, 3
    s_cbranch_scc1 L_BK_c0
    v_mfma_f32_16x16x32_bf16 v[12:15], a[64:67], v[32:35], 0
    v_mfma_f32_16x16x32_bf16 v[12:15], a[68:71], v[36:39], v[12:15]
    v_mfma_f32_16x16x32_bf16 v[12:15], a[72:75], v[40:43], v[12:15]
    v_mfma_f32_16x16x32_bf16 v[12:15], a[76:79], v[44:47], v[12:15]
    s_nop 7
    v_add_f32_dpp v48, v13, v12 quad_perm:[1,1,1,1] row_mask:0xf bank_mask:0xf
    s_nop 1
    v_add_f32_dpp v48, v14, v48 quad_perm:[2,2,2,2] row_mask:0xf bank_mask:0xf
    s_nop 1
    v_add_f32_dpp v48, v15, v48 quad_perm:[3,3,3,3] row_mask:0xf bank_mask:0xf
    v_mfma_f32_16x16x32_bf16 v[16:19], a[80:83], v[32:35], 0
    v_mfma_f32_16x16x32_bf16 v[16:19], a[84:87], v[36:39], v[16:19]
    v_mfma_f32_16x16x32_bf16 v[16:19], a[88:91], v[40:43], v[16:19]
    v_mfma_f32_16x16x32_bf16 v[16:19], a[92:95], v[44:47], v[16:19]
    s_nop 7
    v_add_f32_dpp v3, v16, v17 quad_perm:[0,0,0,0] row_mask:0xf bank_mask:0xf
    s_nop 1
    v_add_f32_dpp v3, v18, v3 quad_perm:[2,2,2,2] row_mask:0xf bank_mask:0xf
    s_nop 1
    v_add_f32_dpp v3, v19, v3 quad_perm:[3,3,3,3] row_mask:0xf bank_mask:0xf
    v_cndmask_b32 v48, v48, v3, s[64:65]
    v_mfma_f32_16x16x32_bf16 v[12:15], a[96:99], v[32:35], 0
    v_mfma_f32_16x16x32_bf16 v[12:15], a[100:103], v[36:39], v[12:15]
    v_mfma_f32_16x16x32_bf16 v[12:15], a[104:107], v[40:43], v[12:15]
    v_mfma_f32_16x16x32_bf16 v[12:15], a[108:111], v[44:47], v[12:15]
    s_nop 7
    v_add_f32_dpp v3, v12, v14 quad_perm:[0,0,0,0] row_mask:0xf bank_mask:0xf
    s_nop 1
    v_add_f32_dpp v3, v13, v3 quad_perm:[1,1,1,1] row_mask:0xf bank_mask:0xf
    s_nop 1
    v_add_f32_dpp v3, v15, v3 quad_perm:[3,3,3,3] row_mask:0xf bank_mask:0xf
    v_cndmask_b32 v48, v48, v3, s[66:67]
    v_mfma_f32_16x16x32_bf16 v[16:19], a[112:115], v[32:35], 0
    v_mfma_f32_16x16x32_bf16 v[16:19], a[116:119], v[36:39], v[16:19]
    v_mfma_f32_16x16x32_bf16 v[16:19], a[120:123], v[40:43], v[16:19]
    v_mfma_f32_16x16x32_bf16 v[16:19], a[124:127], v[44:47], v[16:19]
    s_nop 7
    v_add_f32_dpp v3, v16, v19 quad_perm:[0,0,0,0] row_mask:0xf bank_mask:0xf
    s_nop 1
    v_add_f32_dpp v3, v17, v3 quad_perm:[1,1,1,1] row_mask:0xf bank_mask:0xf
    s_nop 1
    v_add_f32_dpp v3, v18, v3 quad_perm:[2,2,2,2] row_mask:0xf bank_mask:0xf
    v_cndmask_b32 v48, v48, v3, s[68:69]
L_BK_c0:
    s_cmp_lg_u32 s27, 2
    s_cbranch_scc1 L_BK_b
    v_mfma_f32_16x16x32_bf16 v[12:15], a[0:3], v[32:35], 0
    v_mfma_f32_16x16x32_bf16 v[12:15], a[4:7], v[36:39], v[12:15]
    v_mfma_f32_16x16x32_bf16 v[12:15], a[8:11], v[40:43], v[12:15]
    v_mfma_f32_16x16x32_bf16 v[12:15], a[12:15], v[44:47], v[12:15]
    s_nop 7
    v_add_f32_dpp v58, v13, v12 quad_perm:[1,1,1,1] row_mask:0xf bank_mask:0xf
    s_nop 1
    v_add_f32_dpp v58, v14, v58 quad_perm:[2,2,2,2] row_mask:0xf bank_mask:0xf
    s_nop 1
    v_add_f32_dpp v58, v15, v58 quad_perm:[3,3,3,3] row_mask:0xf bank_mask:0xf
    v_mfma_f32_16x16x32_bf16 v[16:19], a[16:19], v[32:35], 0
    v_mfma_f32_16x16x32_bf16 v[16:19], a[20:23], v[36:39], v[16:19]
    v_mfma_f32_16x16x32_bf16 v[16:19], a[24:27], v[40:43], v[16:19]
    v_mfma_f32_16x16x32_bf16 v[16:19], a[28:31], v[44:47], v[16:19]
    s_nop 7
    v_add_f32_dpp v3, v16, v17 quad_perm:[0,0,0,0] row_mask:0xf bank_mask:0xf
    s_nop 1
    v_add_f32_dpp v3, v18, v3 quad_perm:[2,2,2,2] row_mask:0xf bank_mask:0xf
    s_nop 1
    v_add_f32_dpp v3, v19, v3 quad_perm:[3,3,3,3] row_mask:0xf bank_mask:0xf
    v_cndmask_b32 v58, v58, v3, s[64:65]
    v_mfma_f32_16x16x32_bf16 v[12:15], a[32:35], v[32:35], 0
    v_mfma_f32_16x16x32_bf16 v[12:15], a[36:39], v[36:39], v[12:15]
    v_mfma_f32_16x16x32_bf16 v[12:15], a[40:43], v[40:43], v[12:15]
    s_nop 7
    v_add_f32_dpp v3, v12, v14 quad_perm:[0,0,0,0] row_mask:0xf bank_mask:0xf
    s_nop 1
    v_add_f32_dpp v3, v13, v3 quad_perm:[1,1,1,1] row_mask:0xf bank_mask:0xf
    s_nop 1
    v_add_f32_dpp v3, v15, v3 quad_perm:[3,3,3,3] row_mask:0xf bank_mask:0xf
    v_cndmask_b32 v58, v58, v3, s[66:67]
    s_mul_i32 s24, s31, 1
    s_sub_i32 s24, 4, s24
    s_max_i32 s24, s24, 0
    s_min_i32 s24, s24, 1
    s_add_u32 s24, s24, 10
    v_and_b32 v3, 3, v0
    v_bfe_u32 v4, v0, 2, 2
    v_lshl_add_u32 v3, v3, 2, v4
    v_mov_b32 v4, 0xff800000
    v_cmp_gt_u32 vcc, s24, v3
    s_nop 1
    v_cndmask_b32 v58, v4, v58, vcc
    v_mov_b32 v61, 0x3e0293ee
    v_mov_b32 v7, 0
    s_lshr_b32 s34, s2, 3
    s_lshl_b32 s34, s34, 12
    s_and_b32 s24, s2, 7
    s_lshl_b32 s24, s24, 7
    s_add_u32 s34, s34, s24
    s_add_u32 s34, s34, 0x1b8000
L_BK_b:
    s_add_u32 s27, s27, 1
    s_cmp_lt_u32 s27, 10
    s_cbranch_scc1 L_BK
    v_max3_f32 v3, v48, v49, v50
    v_max3_f32 v3, v3, v51, v52
    v_max3_f32 v3, v3, v53, v54
    v_max3_f32 v3, v3, v55, v56
    v_max3_f32 v3, v3, v57, v58
    s_nop 1
    v_max_f32_dpp v3, v3, v3 row_ror:8 row_mask:0xf bank_mask:0xf
    s_nop 1
    v_max_f32_dpp v3, v3, v3 row_ror:4 row_mask:0xf bank_mask:0xf
    s_nop 1
    v_max_f32_dpp v3, v3, v3 row_ror:2 row_mask:0xf bank_mask:0xf
    s_nop 1
    v_max_f32_dpp v3, v3, v3 row_ror:1 row_mask:0xf bank_mask:0xf
    s_nop 1
    v_max_f32_dpp v3, v3, v3 row_bcast:15 row_mask:0xa bank_mask:0xf
    s_nop 1
    v_max_f32_dpp v3, v3, v3 row_bcast:31 row_mask:0xc bank_mask:0xf
    s_nop 0
    v_readlane_b32 s24, v3, 63
    s_nop 1
    v_mul_f32 v6, s24, v61
    v_mov_b32 v12, 0
    v_mov_b32 v13, 0
    v_mov_b32 v14, 0
    v_mov_b32 v15, 0
    v_fma_f32 v48, v48, v61, -v6
    v_exp_f32 v48, v48
    s_nop 0
    v_add_f32 v7, v7, v48
    v_cvt_pk_bf16_f32 v48, v48, v48
    s_mov_b32 s27, 0
L_BV:
    s_barrier
    s_cmp_lg_u32 s27, 7
    s_cbranch_scc1 L_BV_c0
    v_mov_b32 v28, -1
    v_mov_b32 v29, -1
    v_mov_b32 v30, -1
    v_mov_b32 v31, -1
    s_mov_b64 exec, 0xffff
    s_cmp_lg_u32 s75, 0
    s_cbranch_scc1 L_far2
    buffer_store_dwordx4 v[28:31], v2, s[12:15], s73 offen
    s_branch L_near2
L_far2:
    buffer_store_dwordx4 v[28:31], v2, s[12:15], s73 offen sc1
L_near2:
    s_mov_b64 exec, -1
L_BV_c0:
    s_cmp_lg_u32 s27, 8
    s_cbranch_scc1 L_BV_c1
    s_lshl_b32 s25, s3, 4
    s_add_u32 s25, s25, s34
    s_mov_b64 exec, 1
    v_mov_b32 v28, 0
    v_mov_b32 v29, 0
    s_cmp_lg_u32 s75, 0
    s_cbranch_scc1 L_far3
    buffer_store_dwordx2 v[28:29], off, s[12:15], s25 offset:8
    s_branch L_near3
L_far3:
    buffer_store_dwordx2 v[28:29], off, s[12:15], s25 offset:8 sc1
L_near3:
    s_mov_b64 exec, -1
L_BV_c1:
    s_cmp_ge_u32 s27, 1
    s_cselect_b32 s71, s3, 4
    s_cmp_lg_u32 s71, 0
    s_cbranch_scc1 L_BV_p0
    s_lshl_b32 s24, s27, 2
    s_add_u32 s24, s24, 0
    s_mov_b64 exec, 1
    v_mov_b32 v63, s24
    s_cmp_lg_u32 s75, 0
    s_cbranch_scc1 L_far4
    buffer_store_dword v63, off, s[12:15], s34 offset:64
    s_branch L_near4
L_far4:
    buffer_store_dword v63, off, s[12:15], s34 offset:64 sc1
L_near4:
    s_mov_b64 exec, -1
L_BV_p0:
    v_and_b32_dpp v8, v48, v20 row_newbcast:0 row_mask:0xf bank_mask:0xf
    v_and_b32_dpp v9, v48, v21 row_newbcast:0 row_mask:0xf bank_mask:0xf
    v_and_b32_dpp v10, v48, v22 row_newbcast:0 row_mask:0xf bank_mask:0xf
    v_and_b32_dpp v11, v48, v23 row_newbcast:0 row_mask:0xf bank_mask:0xf
    s_waitcnt vmcnt(15)
    s_nop 0
    v_mfma_f32_16x16x32_bf16 v[12:15], v[64:67], v[8:11], v[12:15]
    buffer_load_dwordx4 v[64:67], v1, s[4:7], s32 offen offset:0 nt
    s_add_u32 s32, s32, 6144
    v_and_b32_dpp v8, v48, v20 row_newbcast:4 row_mask:0xf bank_mask:0xf
    v_and_b32_dpp v9, v48, v21 row_newbcast:4 row_mask:0xf bank_mask:0xf
    v_and_b32_dpp v10, v48, v22 row_newbcast:4 row_mask:0xf bank_mask:0xf
    v_and_b32_dpp v11, v48, v23 row_newbcast:4 row_mask:0xf bank_mask:0xf
    s_waitcnt vmcnt(15)
    s_nop 0
    v_mfma_f32_16x16x32_bf16 v[12:15], v[68:71], v[8:11], v[12:15]
    buffer_load_dwordx4 v[68:71], v1, s[4:7], s32 offen offset:0 nt
    s_add_u32 s32, s32, 6144
    v_and_b32_dpp v8, v48, v20 row_newbcast:8 row_mask:0xf bank_mask:0xf
    v_and_b32_dpp v9, v48, v21 row_newbcast:8 row_mask:0xf bank_mask:0xf
    v_and_b32_dpp v10, v48, v22 row_newbcast:8 row_mask:0xf bank_mask:0xf
    v_and_b32_dpp v11, v48, v23 row_newbcast:8 row_mask:0xf bank_mask:0xf
    s_waitcnt vmcnt(15)
    s_nop 0
    v_mfma_f32_16x16x32_bf16 v[12:15], v[72:75], v[8:11], v[12:15]
    buffer_load_dwordx4 v[72:75], v1, s[4:7], s32 offen offset:0 nt
    s_add_u32 s32, s32, 6144
    v_and_b32_dpp v8, v48, v20 row_newbcast:12 row_mask:0xf bank_mask:0xf
    v_and_b32_dpp v9, v48, v21 row_newbcast:12 row_mask:0xf bank_mask:0xf
    v_and_b32_dpp v10, v48, v22 row_newbcast:12 row_mask:0xf bank_mask:0xf
    v_and_b32_dpp v11, v48, v23 row_newbcast:12 row_mask:0xf bank_mask:0xf
    s_waitcnt vmcnt(15)
    s_nop 0
    v_mfma_f32_16x16x32_bf16 v[12:15], v[76:79], v[8:11], v[12:15]
    buffer_load_dwordx4 v[76:79], v1, s[4:7], s32 offen offset:0 nt
    s_add_u32 s32, s32, 6144
    s_cmp_lg_u32 s71, 1
    s_cbranch_scc1 L_BV_p1
    s_lshl_b32 s24, s27, 2
    s_add_u32 s24, s24, 1
    s_mov_b64 exec, 1
    v_mov_b32 v63, s24
    s_cmp_lg_u32 s75, 0
    s_cbranch_scc1 L_far5
    buffer_store_dword v63, off, s[12:15], s34 offset:64
    s_branch L_near5
L_far5:
    buffer_store_dword v63, off, s[12:15], s34 offset:64 sc1
L_near5:
    s_mov_b64 exec, -1
L_BV_p1:
    v_and_b32_dpp v8, v48, v20 row_newbcast:1 row_mask:0xf bank_mask:0xf
    v_and_b32_dpp v9, v48, v21 row_newbcast:1 row_mask:0xf bank_mask:0xf
    v_and_b32_dpp v10, v48, v22 row_newbcast:1 row_mask:0xf bank_mask:0xf
    v_and_b32_dpp v11, v48, v23 row_newbcast:1 row_mask:0xf bank_mask:0xf
    s_waitcnt vmcnt(15)
    s_nop 0
    v_mfma_f32_16x16x32_bf16 v[12:15], v[80:83], v[8:11], v[12:15]
    buffer_load_dwordx4 v[80:83], v1, s[4:7], s32 offen offset:0 nt
    s_add_u32 s32, s32, 6144
    v_and_b32_dpp v8, v48, v20 row_newbcast:5 row_mask:0xf bank_mask:0xf
    v_and_b32_dpp v9, v48, v21 row_newbcast:5 row_mask:0xf bank_mask:0xf
    v_and_b32_dpp v10, v48, v22 row_newbcast:5 row_mask:0xf bank_mask:0xf
    v_and_b32_dpp v11, v48, v23 row_newbcast:5 row_mask:0xf bank_mask:0xf
    s_waitcnt vmcnt(15)
    s_nop 0
    v_mfma_f32_16x16x32_bf16 v[12:15], v[84:87], v[8:11], v[12:15]
    buffer_load_dwordx4 v[84:87], v1, s[4:7], s32 offen offset:0 nt
    s_add_u32 s32, s32, 6144
    v_and_b32_dpp v8, v48, v20 row_newbcast:9 row_mask:0xf bank_mask:0xf
    v_and_b32_dpp v9, v48, v21 row_newbcast:9 row_mask:0xf bank_mask:0xf
    v_and_b32_dpp v10, v48, v22 row_newbcast:9 row_mask:0xf bank_mask:0xf
    v_and_b32_dpp v11, v48, v23 row_newbcast:9 row_mask:0xf bank_mask:0xf
    s_waitcnt vmcnt(15)
    s_nop 0
    v_mfma_f32_16x16x32_bf16 v[12:15], v[88:91], v[8:11], v[12:15]
    buffer_load_dwordx4 v[88:91], v1, s[4:7], s32 offen offset:0 nt
    s_add_u32 s32, s32, 6144
    v_and_b32_dpp v8, v48, v20 row_newbcast:13 row_mask:0xf bank_mask:0xf
    v_and_b32_dpp v9, v48, v21 row_newbcast:13 row_mask:0xf bank_mask:0xf
    v_and_b32_dpp v10, v48, v22 row_newbcast:13 row_mask:0xf bank_mask:0xf
    v_and_b32_dpp v11, v48, v23 row_newbcast:13 row_mask:0xf bank_mask:0xf
    s_waitcnt vmcnt(15)
    s_nop 0
    v_mfma_f32_16x16x32_bf16 v[12:15], v[92:95], v[8:11], v[12:15]
    buffer_load_dwordx4 v[92:95], v1, s[4:7], s32 offen offset:0 nt
    s_add_u32 s32, s32, 6144
    s_cmp_lg_u32 s71, 2
    s_cbranch_scc1 L_BV_p2
    s_lshl_b32 s24, s27, 2
    s_add_u32 s24, s24, 2
    s_mov_b64 exec, 1
    v_mov_b32 v63, s24
    s_cmp_lg_u32 s75, 0
    s_cbranch_scc1 L_far6
    buffer_store_dword v63, off, s[12:15], s34 offset:64
    s_branch L_near6
L_far6:
    buffer_store_dword v63, off, s[12:15], s34 offset:64 sc1
L_near6:
    s_mov_b64 exec, -1
L_BV_p2:
    v_and_b32_dpp v8, v48, v20 row_newbcast:2 row_mask:0xf bank_mask:0xf
    v_and_b32_dpp v9, v48, v21 row_newbcast:2 row_mask:0xf bank_mask:0xf
    v_and_b32_dpp v10, v48, v22 row_newbcast:2 row_mask:0xf bank_mask:0xf
    v_and_b32_dpp v11, v48, v23 row_newbcast:2 row_mask:0xf bank_mask:0xf
    s_waitcnt vmcnt(15)
    s_nop 0
    v_mfma_f32_16x16x32_bf16 v[12:15], v[96:99], v[8:11], v[12:15]
    buffer_load_dwordx4 v[96:99], v1, s[4:7], s32 offen offset:0 nt
    s_add_u32 s32, s32, 6144
    v_and_b32_dpp v8, v48, v20 row_newbcast:6 row_mask:0xf bank_mask:0xf
    v_and_b32_dpp v9, v48, v21 row_newbcast:6 row_mask:0xf bank_mask:0xf
    v_and_b32_dpp v10, v48, v22 row_newbcast:6 row_mask:0xf bank_mask:0xf
    v_and_b32_dpp v11, v48, v23 row_newbcast:6 row_mask:0xf bank_mask:0xf
    s_waitcnt vmcnt(15)
    s_nop 0
    v_mfma_f32_16x16x32_bf16 v[12:15], v[100:103], v[8:11], v[12:15]
    buffer_load_dwordx4 v[100:103], v1, s[4:7], s32 offen offset:0 nt
    s_add_u32 s32, s32, 6144
    s_cmp_eq_u32 s27, 9
    s_cbranch_scc1 L_BT
    v_and_b32_dpp v8, v48, v20 row_newbcast:10 row_mask:0xf bank_mask:0xf
    v_and_b32_dpp v9, v48, v21 row_newbcast:10 row_mask:0xf bank_mask:0xf
    v_and_b32_dpp v10, v48, v22 row_newbcast:10 row_mask:0xf bank_mask:0xf
    v_and_b32_dpp v11, v48, v23 row_newbcast:10 row_mask:0xf bank_mask:0xf
    s_waitcnt vmcnt(15)
    s_nop 0
    v_mfma_f32_16x16x32_bf16 v[12:15], v[104:107], v[8:11], v[12:15]
    buffer_load_dwordx4 v[104:107], v1, s[4:7], s32 offen offset:0 nt
    s_add_u32 s32, s32, 6144
    v_and_b32_dpp v8, v48, v20 row_newbcast:14 row_mask:0xf bank_mask:0xf
    v_and_b32_dpp v9, v48, v21 row_newbcast:14 row_mask:0xf bank_mask:0xf
    v_and_b32_dpp v10, v48, v22 row_newbcast:14 row_mask:0xf bank_mask:0xf
    v_and_b32_dpp v11, v48, v23 row_newbcast:14 row_mask:0xf bank_mask:0xf
    s_waitcnt vmcnt(15)
    s_nop 0
    v_mfma_f32_16x16x32_bf16 v[12:15], v[108:111], v[8:11], v[12:15]
    buffer_load_dwordx4 v[108:111], v1, s[4:7], s32 offen offset:0 nt
    s_add_u32 s32, s32, 6144
    s_cmp_lg_u32 s71, 3
    s_cbranch_scc1 L_BV_p3
    s_lshl_b32 s24, s27, 2
    s_add_u32 s24, s24, 3
    s_mov_b64 exec, 1
    v_mov_b32 v63, s24
    s_cmp_lg_u32 s75, 0
    s_cbranch_scc1 L_far7
    buffer_store_dword v63, off, s[12:15], s34 offset:64
    s_branch L_near7
L_far7:
    buffer_store_dword v63, off, s[12:15], s34 offset:64 sc1
L_near7:
    s_mov_b64 exec, -1
L_BV_p3:
    v_and_b32_dpp v8, v48, v20 row_newbcast:3 row_mask:0xf bank_mask:0xf
    v_and_b32_dpp v9, v48, v21 row_newbcast:3 row_mask:0xf bank_mask:0xf
    v_and_b32_dpp v10, v48, v22 row_newbcast:3 row_mask:0xf bank_mask:0xf
    v_and_b32_dpp v11, v48, v23 row_newbcast:3 row_mask:0xf bank_mask:0xf
    s_waitcnt vmcnt(15)
    s_nop 0
    v_mfma_f32_16x16x32_bf16 v[12:15], v[112:115], v[8:11], v[12:15]
    buffer_load_dwordx4 v[112:115], v1, s[4:7], s32 offen offset:0 nt
    s_add_u32 s32, s32, 6144
    s_cmp_lg_u32 s27, 0
    s_cbranch_scc1 L_BV_d
    v_fma_f32 v49, v49, v61, -v6
    v_fma_f32 v50, v50, v61, -v6
    v_fma_f32 v51, v51, v61, -v6
    v_fma_f32 v52, v52, v61, -v6
    v_fma_f32 v53, v53, v61, -v6
    v_fma_f32 v54, v54, v61, -v6
    v_fma_f32 v55, v55, v61, -v6
    v_fma_f32 v56, v56, v61, -v6
    v_fma_f32 v57, v57, v61, -v6
    v_fma_f32 v58, v58, v61, -v6
    v_exp_f32 v49, v49
    v_exp_f32 v50, v50
    v_exp_f32 v51, v51
    v_exp_f32 v52, v52
    v_exp_f32 v53, v53
    v_exp_f32 v54, v54
    v_exp_f32 v55, v55
    v_exp_f32 v56, v56
    v_exp_f32 v57, v57
    v_exp_f32 v58, v58
    v_add_f32 v7, v7, v49
    v_add_f32 v7, v7, v50
    v_add_f32 v7, v7, v51
    v_add_f32 v7, v7, v52
    v_add_f32 v7, v7, v53
    v_add_f32 v7, v7, v54
    v_add_f32 v7, v7, v55
    v_add_f32 v7, v7, v56
    v_add_f32 v7, v7, v57
    v_add_f32 v7, v7, v58
    v_cvt_pk_bf16_f32 v49, v49, v49
    v_cvt_pk_bf16_f32 v50, v50, v50
    v_cvt_pk_bf16_f32 v51, v51, v51
    v_cvt_pk_bf16_f32 v52, v52, v52
    v_cvt_pk_bf16_f32 v53, v53, v53
    v_cvt_pk_bf16_f32 v54, v54, v54
    v_cvt_pk_bf16_f32 v55, v55, v55
    v_cvt_pk_bf16_f32 v56, v56, v56
    v_cvt_pk_bf16_f32 v57, v57, v57
    v_cvt_pk_bf16_f32 v58, v58, v58
    v_add_f32_dpp v7, v7, v7 row_ror:8 row_mask:0xf bank_mask:0xf
    s_nop 1
    v_add_f32_dpp v7, v7, v7 row_ror:4 row_mask:0xf bank_mask:0xf
    s_nop 1
    v_add_f32_dpp v7, v7, v7 row_ror:2 row_mask:0xf bank_mask:0xf
    s_nop 1
    v_add_f32_dpp v7, v7, v7 row_ror:1 row_mask:0xf bank_mask:0xf
    s_nop 1
    v_add_f32_dpp v7, v7, v7 row_bcast:15 row_mask:0xa bank_mask:0xf
    s_nop 1
    v_add_f32_dpp v7, v7, v7 row_bcast:31 row_mask:0xc bank_mask:0xf
    s_nop 0
    v_readlane_b32 s70, v7, 63
    s_lshl_b32 s25, s3, 4
    s_add_u32 s25, s25, s34
    s_mov_b64 exec, 1
    v_mov_b32 v7, s70
    s_cmp_lg_u32 s75, 0
    s_cbranch_scc1 L_far8
    buffer_store_dwordx2 v[6:7], off, s[12:15], s25
    s_branch L_near8
L_far8:
    buffer_store_dwordx2 v[6:7], off, s[12:15], s25 sc1
L_near8:
    s_mov_b64 exec, -1
L_BV_d:
    v_and_b32_dpp v8, v48, v20 row_newbcast:7 row_mask:0xf bank_mask:0xf
    v_and_b32_dpp v9, v48, v21 row_newbcast:7 row_mask:0xf bank_mask:0xf
    v_and_b32_dpp v10, v48, v22 row_newbcast:7 row_mask:0xf bank_mask:0xf
    v_and_b32_dpp v11, v48, v23 row_newbcast:7 row_mask:0xf bank_mask:0xf
    s_waitcnt vmcnt(15)
    s_nop 0
    v_mfma_f32_16x16x32_bf16 v[12:15], v[116:119], v[8:11], v[12:15]
    buffer_load_dwordx4 v[116:119], v1, s[4:7], s32 offen offset:0 nt
    s_add_u32 s32, s32, 6144
    v_and_b32_dpp v8, v48, v20 row_newbcast:11 row_mask:0xf bank_mask:0xf
    v_and_b32_dpp v9, v48, v21 row_newbcast:11 row_mask:0xf bank_mask:0xf
    v_and_b32_dpp v10, v48, v22 row_newbcast:11 row_mask:0xf bank_mask:0xf
    v_and_b32_dpp v11, v48, v23 row_newbcast:11 row_mask:0xf bank_mask:0xf
    s_waitcnt vmcnt(15)
    s_nop 0
    v_mfma_f32_16x16x32_bf16 v[12:15], v[120:123], v[8:11], v[12:15]
    buffer_load_dwordx4 v[120:123], v1, s[4:7], s32 offen offset:0 nt
    s_add_u32 s32, s32, 6144
    v_and_b32_dpp v8, v48, v20 row_newbcast:15 row_mask:0xf bank_mask:0xf
    v_and_b32_dpp v9, v48, v21 row_newbcast:15 row_mask:0xf bank_mask:0xf
    v_and_b32_dpp v10, v48, v22 row_newbcast:15 row_mask:0xf bank_mask:0xf
    v_and_b32_dpp v11, v48, v23 row_newbcast:15 row_mask:0xf bank_mask:0xf
    s_waitcnt vmcnt(15)
    s_nop 0
    v_mfma_f32_16x16x32_bf16 v[12:15], v[124:127], v[8:11], v[12:15]
    buffer_load_dwordx4 v[124:127], v1, s[4:7], s32 offen offset:0 nt
    s_add_u32 s32, s32, 6144
    v_mov_b32 v48, v49
    v_mov_b32 v49, v50
    v_mov_b32 v50, v51
    v_mov_b32 v51, v52
    v_mov_b32 v52, v53
    v_mov_b32 v53, v54
    v_mov_b32 v54, v55
    v_mov_b32 v55, v56
    v_mov_b32 v56, v57
    v_mov_b32 v57, v58
    s_add_u32 s27, s27, 1
    s_branch L_BV
L_BT:
    v_and_b32_dpp v8, v48, v20 row_newbcast:10 row_mask:0xf bank_mask:0xf
    v_and_b32_dpp v9, v48, v21 row_newbcast:10 row_mask:0xf bank_mask:0xf
    v_and_b32_dpp v10, v48, v22 row_newbcast:10 row_mask:0xf bank_mask:0xf
    v_and_b32_dpp v11, v48, v23 row_newbcast:10 row_mask:0xf bank_mask:0xf
    s_waitcnt vmcnt(15)
    s_nop 0
    v_mfma_f32_16x16x32_bf16 v[12:15], v[104:107], v[8:11], v[12:15]
    buffer_load_dwordx4 v[104:107], v1, s[4:7], s28 offen offset:0 nt
    v_and_b32_dpp v8, v48, v20 row_newbcast:14 row_mask:0xf bank_mask:0xf
    v_and_b32_dpp v9, v48, v21 row_newbcast:14 row_mask:0xf bank_mask:0xf
    v_and_b32_dpp v10, v48, v22 row_newbcast:14 row_mask:0xf bank_mask:0xf
    v_and_b32_dpp v11, v48, v23 row_newbcast:14 row_mask:0xf bank_mask:0xf
    s_waitcnt vmcnt(15)
    s_nop 0
    v_mfma_f32_16x16x32_bf16 v[12:15], v[108:111], v[8:11], v[12:15]
    v_and_b32_dpp v8, v48, v20 row_newbcast:3 row_mask:0xf bank_mask:0xf
    v_and_b32_dpp v9, v48, v21 row_newbcast:3 row_mask:0xf bank_mask:0xf
    v_and_b32_dpp v10, v48, v22 row_newbcast:3 row_mask:0xf bank_mask:0xf
    v_and_b32_dpp v11, v48, v23 row_newbcast:3 row_mask:0xf bank_mask:0xf
    s_waitcnt vmcnt(14)
    s_nop 0
    v_mfma_f32_16x16x32_bf16 v[12:15], v[112:115], v[8:11], v[12:15]
    v_and_b32_dpp v8, v48, v20 row_newbcast:7 row_mask:0xf bank_mask:0xf
    v_and_b32_dpp v9, v48, v21 row_newbcast:7 row_mask:0xf bank_mask:0xf
    v_and_b32_dpp v10, v48, v22 row_newbcast:7 row_mask:0xf bank_mask:0xf
    v_and_b32_dpp v11, v48, v23 row_newbcast:7 row_mask:0xf bank_mask:0xf
    s_waitcnt vmcnt(13)
    s_nop 0
    v_mfma_f32_16x16x32_bf16 v[12:15], v[116:119], v[8:11], v[12:15]
    v_and_b32_dpp v8, v48, v20 row_newbcast:11 row_mask:0xf bank_mask:0xf
    v_and_b32_dpp v9, v48, v21 row_newbcast:11 row_mask:0xf bank_mask:0xf
    v_and_b32_dpp v10, v48, v22 row_newbcast:11 row_mask:0xf bank_mask:0xf
    v_and_b32_dpp v11, v48, v23 row_newbcast:11 row_mask:0xf bank_mask:0xf
    s_waitcnt vmcnt(12)
    s_nop 0
    v_mfma_f32_16x16x32_bf16 v[12:15], v[120:123], v[8:11], v[12:15]
    v_and_b32_dpp v8, v48, v20 row_newbcast:15 row_mask:0xf bank_mask:0xf
    v_and_b32_dpp v9, v48, v21 row_newbcast:15 row_mask:0xf bank_mask:0xf
    v_and_b32_dpp v10, v48, v22 row_newbcast:15 row_mask:0xf bank_mask:0xf
    v_and_b32_dpp v11, v48, v23 row_newbcast:15 row_mask:0xf bank_mask:0xf
    s_waitcnt vmcnt(11)
    s_nop 0
    v_mfma_f32_16x16x32_bf16 v[12:15], v[124:127], v[8:11], v[12:15]
    v_and_b32_dpp v8, v49, v20 row_newbcast:0 row_mask:0xf bank_mask:0xf
    v_and_b32_dpp v9, v49, v21 row_newbcast:0 row_mask:0xf bank_mask:0xf
    v_and_b32_dpp v10, v49, v22 row_newbcast:0 row_mask:0xf bank_mask:0xf
    v_and_b32_dpp v11, v49, v23 row_newbcast:0 row_mask:0xf bank_mask:0xf
    s_waitcnt vmcnt(10)
    s_nop 0
    v_mfma_f32_16x16x32_bf16 v[12:15], v[64:67], v[8:11], v[12:15]
    v_and_b32_dpp v8, v49, v20 row_newbcast:4 row_mask:0xf bank_mask:0xf
    v_and_b32_dpp v9, v49, v21 row_newbcast:4 row_mask:0xf bank_mask:0xf
    v_and_b32_dpp v10, v49, v22 row_newbcast:4 row_mask:0xf bank_mask:0xf
    v_and_b32_dpp v11, v49, v23 row_newbcast:4 row_mask:0xf bank_mask:0xf
    s_waitcnt vmcnt(9)
    s_nop 0
    v_mfma_f32_16x16x32_bf16 v[12:15], v[68:71], v[8:11], v[12:15]
    v_and_b32_dpp v8, v49, v20 row_newbcast:8 row_mask:0xf bank_mask:0xf
    v_and_b32_dpp v9, v49, v21 row_newbcast:8 row_mask:0xf bank_mask:0xf
    v_and_b32_dpp v10, v49, v22 row_newbcast:8 row_mask:0xf bank_mask:0xf
    v_and_b32_dpp v11, v49, v23 row_newbcast:8 row_mask:0xf bank_mask:0xf
    s_waitcnt vmcnt(8)
    s_nop 0
    v_mfma_f32_16x16x32_bf16 v[12:15], v[72:75], v[8:11], v[12:15]
    v_and_b32_dpp v8, v49, v20 row_newbcast:12 row_mask:0xf bank_mask:0xf
    v_and_b32_dpp v9, v49, v21 row_newbcast:12 row_mask:0xf bank_mask:0xf
    v_and_b32_dpp v10, v49, v22 row_newbcast:12 row_mask:0xf bank_mask:0xf
    v_and_b32_dpp v11, v49, v23 row_newbcast:12 row_mask:0xf bank_mask:0xf
    s_waitcnt vmcnt(7)
    s_nop 0
    v_mfma_f32_16x16x32_bf16 v[12:15], v[76:79], v[8:11], v[12:15]
    v_and_b32_dpp v8, v49, v20 row_newbcast:1 row_mask:0xf bank_mask:0xf
    v_and_b32_dpp v9, v49, v21 row_newbcast:1 row_mask:0xf bank_mask:0xf
    v_and_b32_dpp v10, v49, v22 row_newbcast:1 row_mask:0xf bank_mask:0xf
    v_and_b32_dpp v11, v49, v23 row_newbcast:1 row_mask:0xf bank_mask:0xf
    s_waitcnt vmcnt(6)
    s_nop 0
    v_mfma_f32_16x16x32_bf16 v[12:15], v[80:83], v[8:11], v[12:15]
    v_and_b32_dpp v8, v49, v20 row_newbcast:5 row_mask:0xf bank_mask:0xf
    v_and_b32_dpp v9, v49, v21 row_newbcast:5 row_mask:0xf bank_mask:0xf
    v_and_b32_dpp v10, v49, v22 row_newbcast:5 row_mask:0xf bank_mask:0xf
    v_and_b32_dpp v11, v49, v23 row_newbcast:5 row_mask:0xf bank_mask:0xf
    s_waitcnt vmcnt(5)
    s_nop 0
    v_mfma_f32_16x16x32_bf16 v[12:15], v[84:87], v[8:11], v[12:15]
    v_and_b32_dpp v8, v49, v20 row_newbcast:9 row_mask:0xf bank_mask:0xf
    v_and_b32_dpp v9, v49, v21 row_newbcast:9 row_mask:0xf bank_mask:0xf
    v_and_b32_dpp v10, v49, v22 row_newbcast:9 row_mask:0xf bank_mask:0xf
    v_and_b32_dpp v11, v49, v23 row_newbcast:9 row_mask:0xf bank_mask:0xf
    s_waitcnt vmcnt(4)
    s_nop 0
    v_mfma_f32_16x16x32_bf16 v[12:15], v[88:91], v[8:11], v[12:15]
    v_and_b32_dpp v8, v49, v20 row_newbcast:13 row_mask:0xf bank_mask:0xf
    v_and_b32_dpp v9, v49, v21 row_newbcast:13 row_mask:0xf bank_mask:0xf
    v_and_b32_dpp v10, v49, v22 row_newbcast:13 row_mask:0xf bank_mask:0xf
    v_and_b32_dpp v11, v49, v23 row_newbcast:13 row_mask:0xf bank_mask:0xf
    s_waitcnt vmcnt(3)
    s_nop 0
    v_mfma_f32_16x16x32_bf16 v[12:15], v[92:95], v[8:11], v[12:15]
    v_and_b32_dpp v8, v49, v20 row_newbcast:2 row_mask:0xf bank_mask:0xf
    v_and_b32_dpp v9, v49, v21 row_newbcast:2 row_mask:0xf bank_mask:0xf
    v_and_b32_dpp v10, v49, v22 row_newbcast:2 row_mask:0xf bank_mask:0xf
    v_and_b32_dpp v11, v49, v23 row_newbcast:2 row_mask:0xf bank_mask:0xf
    s_waitcnt vmcnt(2)
    s_nop 0
    v_mfma_f32_16x16x32_bf16 v[12:15], v[96:99], v[8:11], v[12:15]
    v_and_b32_dpp v8, v49, v20 row_newbcast:6 row_mask:0xf bank_mask:0xf
    v_and_b32_dpp v9, v49, v21 row_newbcast:6 row_mask:0xf bank_mask:0xf
    v_and_b32_dpp v10, v49, v22 row_newbcast:6 row_mask:0xf bank_mask:0xf
    v_and_b32_dpp v11, v49, v23 row_newbcast:6 row_mask:0xf bank_mask:0xf
    s_waitcnt vmcnt(1)
    s_nop 0
    v_mfma_f32_16x16x32_bf16 v[12:15], v[100:103], v[8:11], v[12:15]
    v_and_b32_dpp v8, v49, v20 row_newbcast:10 row_mask:0xf bank_mask:0xf
    v_and_b32_dpp v9, v49, v21 row_newbcast:10 row_mask:0xf bank_mask:0xf
    v_and_b32_dpp v10, v49, v22 row_newbcast:10 row_mask:0xf bank_mask:0xf
    v_and_b32_dpp v11, v49, v23 row_newbcast:10 row_mask:0xf bank_mask:0xf
    s_waitcnt vmcnt(0)
    s_nop 0
    v_mfma_f32_16x16x32_bf16 v[12:15], v[104:107], v[8:11], v[12:15]
    s_mov_b32 exec_lo, 0x00ff00ff
    s_mov_b32 exec_hi, 0x00ff00ff
    s_cmp_lg_u32 s75, 0
    s_nop 4
    v_cvt_pk_bf16_f32 v4, v12, v13
    v_cvt_pk_bf16_f32 v5, v14, v15
    s_cbranch_scc1 L_far9
    buffer_store_dwordx2 v[4:5], v60, s[12:15], s73 offen
    s_branch L_near9
L_far9:
    buffer_store_dwordx2 v[4:5], v60, s[12:15], s73 offen sc1
L_near9:
    s_endpgm
L_A:
    v_lshrrev_b32 v1, 6, v0
    v_and_b32 v0, 63, v0
    v_readfirstlane_b32 s3, v1
    v_lshlrev_b32 v2, 4, v0
    s_mov_b32 s74, s2
    s_and_b32 s72, s2, 31
    s_and_b32 s70, s2, 6
    s_and_b32 s25, s2, 7
    s_add_u32 s70, s70, s25
    s_lshr_b32 s26, s72, 3
    s_and_b32 s25, s26, 1
    s_lshl_b32 s25, s25, 1
    s_and_b32 s26, s26, 2
    s_lshl_b32 s26, s26, 3
    s_or_b32 s26, s26, s25
    s_or_b32 s26, s26, s70
    v_lshrrev_b32 v3, 4, v0
    v_and_b32 v4, 15, v0
    v_lshlrev_b32 v18, 18, v3
    v_lshl_add_u32 v18, v4, 4, v18
    v_lshrrev_b32 v6, 3, v4
    v_lshlrev_b32 v6, 10, v6
    v_lshl_add_u32 v19, v3, 6, v6
    v_bfe_u32 v1, v0, 2, 2
    v_lshlrev_b32 v64, 18, v1
    v_lshl_add_u32 v64, v3, 6, v64
    v_and_b32 v4, 3, v0
    v_lshl_add_u32 v64, v4, 4, v64
    v_lshlrev_b32 v65, 9, v1
    v_lshl_add_u32 v65, v3, 7, v65
    v_lshl_add_u32 v65, v4, 5, v65
    v_add_u32 v65, 135168, v65
    v_lshlrev_b32 v66, 17, v1
    v_lshl_add_u32 v66, v3, 6, v66
    v_lshl_add_u32 v66, v4, 4, v66
    v_and_b32 v4, 15, v0
    v_lshlrev_b32 v67, 10, v3
    v_lshl_add_u32 v67, v4, 4, v67
    s_lshl_b32 s35, s3, 20
    s_lshl_b32 s24, s26, 8
    s_add_u32 s35, s35, s24
    s_waitcnt lgkmcnt(0)
    s_cmp_lt_u32 s74, 32
    s_cselect_b64 s[4:5], s[40:41], s[54:55]
    s_mov_b32 s6, 0x400000
    s_mov_b32 s7, 0x20000
    s_cselect_b64 s[20:21], s[36:37], s[48:49]
    s_mov_b32 s22, 4096
    s_mov_b32 s23, 0x20000
    s_cselect_b32 s75, 0x400000, 0
    s_lshl_b32 s24, s3, 8
    s_mov_b32 s32, s35
    buffer_load_dwordx4 v[12:15], v67, s[20:23], s24 offen
    buffer_load_dwordx4 v[128:131], v18, s[4:7], s32 offen nt
    s_add_u32 s32, s32, 8192
    buffer_load_dwordx4 v[132:135], v18, s[4:7], s32 offen nt
    s_add_u32 s32, s32, 8192
    buffer_load_dwordx4 v[136:139], v18, s[4:7], s32 offen nt
    s_add_u32 s32, s32, 8192
    buffer_load_dwordx4 v[140:143], v18, s[4:7], s32 offen nt
    s_add_u32 s32, s32, 8192
    buffer_load_dwordx4 v[144:147], v18, s[4:7], s32 offen nt
    s_add_u32 s32, s32, 8192
    buffer_load_dwordx4 v[148:151], v18, s[4:7], s32 offen nt
    s_add_u32 s32, s32, 8192
    buffer_load_dwordx4 v[152:155], v18, s[4:7], s32 offen nt
    s_add_u32 s32, s32, 8192
    buffer_load_dwordx4 v[156:159], v18, s[4:7], s32 offen nt
    s_add_u32 s32, s32, 8192
    buffer_load_dwordx4 v[160:163], v18, s[4:7], s32 offen nt
    s_add_u32 s32, s32, 8192
    buffer_load_dwordx4 v[164:167], v18, s[4:7], s32 offen nt
    s_add_u32 s32, s32, 8192
    buffer_load_dwordx4 v[168:171], v18, s[4:7], s32 offen nt
    s_add_u32 s32, s32, 8192
    buffer_load_dwordx4 v[172:175], v18, s[4:7], s32 offen nt
    s_add_u32 s32, s32, 8192
    s_mov_b32 s12, s62
    s_mov_b32 s13, s63
    s_mov_b32 s14, 0x600000
    s_mov_b32 s15, 0x20000
    s_mov_b32 s16, s60
    s_mov_b32 s17, s61
    s_mov_b32 s18, 0x100
    s_mov_b32 s19, 0x20000
    v_and_b32 v3, 1, v0
    v_lshlrev_b32 v3, 4, v3
    v_mov_b32 v4, 0xffff
    v_lshlrev_b32 v4, v3, v4
    v_bfe_u32 v3, v0, 1, 2
    v_cmp_eq_u32 vcc, 0, v3
    s_nop 1
    v_cndmask_b32 v20, 0, v4, vcc
    v_cmp_eq_u32 vcc, 1, v3
    s_nop 1
    v_cndmask_b32 v21, 0, v4, vcc
    v_cmp_eq_u32 vcc, 2, v3
    s_nop 1
    v_cndmask_b32 v22, 0, v4, vcc
    v_cmp_eq_u32 vcc, 3, v3
    s_nop 1
    v_cndmask_b32 v23, 0, v4, vcc
    v_mov_b32 v3, 0x0c0c0c0c
    s_mov_b32 s24, 0x01000100
    s_mov_b32 s25, 0x03020302
    v_bfi_b32 v24, v20, s24, v3
    v_bfi_b32 v28, v20, s25, v3
    v_bfi_b32 v25, v21, s24, v3
    v_bfi_b32 v29, v21, s25, v3
    v_bfi_b32 v26, v22, s24, v3
    v_bfi_b32 v30, v22, s25, v3
    v_bfi_b32 v27, v23, s24, v3
    v_bfi_b32 v31, v23, s25, v3
    s_mov_b32 s64, 0x22222222
    s_mov_b32 s65, 0x22222222
    s_mov_b32 s66, 0x44444444
    s_mov_b32 s67, 0x44444444
    s_mov_b32 s68, 0x88888888
    s_mov_b32 s69, 0x88888888
    s_lshl_b32 s24, s3, 8
    s_add_u32 s24, s24, 145408
    v_add_u32 v3, s24, v67
    v_add_u32 v4, s24, v19
    s_waitcnt vmcnt(12)
    ds_write_b128 v3, v[12:15]
    s_waitcnt lgkmcnt(0)
    ds_read_b128 v[32:35], v4 offset:0
    ds_read_b128 v[36:39], v4 offset:16
    ds_read_b128 v[40:43], v4 offset:32
    ds_read_b128 v[44:47], v4 offset:48
    ds_read_b128 v[48:51], v4 offset:2048
    ds_read_b128 v[52:55], v4 offset:2064
    ds_read_b128 v[56:59], v4 offset:2080
    ds_read_b128 v[60:63], v4 offset:2096
    s_waitcnt lgkmcnt(0)
    v_mov_b32 v76, -1
    v_mov_b32 v77, -1
    v_mov_b32 v78, -1
    v_mov_b32 v79, -1
    s_lshl_b32 s71, s72, 2
    s_add_u32 s71, s71, s3
    s_lshl_b32 s71, s71, 12
    s_add_u32 s71, s71, 0x1c0000
    s_cmp_lt_u32 s74, 32
    s_cselect_b32 s71, 0x600000, s71
    v_perm_b32 v8, v32, v32, v24
    v_perm_b32 v9, v32, v32, v25
    v_perm_b32 v10, v32, v32, v26
    v_perm_b32 v11, v32, v32, v27
    v_perm_b32 v4, v48, v48, v24
    v_perm_b32 v5, v48, v48, v25
    v_perm_b32 v6, v48, v48, v26
    v_perm_b32 v7, v48, v48, v27
    s_waitcnt vmcnt(11)
    v_mfma_f32_16x16x32_bf16 v[12:15], v[128:131], v[8:11], 0
    v_mfma_f32_16x16x32_bf16 v[68:71], v[128:131], v[4:7], 0
    buffer_load_dwordx4 v[176:179], v18, s[4:7], s32 offen nt
    s_add_u32 s32, s32, 8192
    v_perm_b32 v8, v32, v32, v28
    v_perm_b32 v9, v32, v32, v29
    v_perm_b32 v10, v32, v32, v30
    v_perm_b32 v11, v32, v32, v31
    v_perm_b32 v4, v48, v48, v28
    v_perm_b32 v5, v48, v48, v29
    v_perm_b32 v6, v48, v48, v30
    v_perm_b32 v7, v48, v48, v31
    s_waitcnt vmcnt(11)
    v_mfma_f32_16x16x32_bf16 v[12:15], v[132:135], v[8:11], v[12:15]
    v_mfma_f32_16x16x32_bf16 v[68:71], v[132:135], v[4:7], v[68:71]
    buffer_load_dwordx4 v[180:183], v18, s[4:7], s32 offen nt
    s_add_u32 s32, s32, 8192
    v_perm_b32 v8, v33, v33, v24
    v_perm_b32 v9, v33, v33, v25
    v_perm_b32 v10, v33, v33, v26
    v_perm_b32 v11, v33, v33, v27
    v_perm_b32 v4, v49, v49, v24
    v_perm_b32 v5, v49, v49, v25
    v_perm_b32 v6, v49, v49, v26
    v_perm_b32 v7, v49, v49, v27
    s_waitcnt vmcnt(11)
    v_mfma_f32_16x16x32_bf16 v[12:15], v[136:139], v[8:11], v[12:15]
    v_mfma_f32_16x16x32_bf16 v[68:71], v[136:139], v[4:7], v[68:71]
    buffer_load_dwordx4 v[184:187], v18, s[4:7], s32 offen nt
    s_add_u32 s32, s32, 8192
    v_perm_b32 v8, v33, v33, v28
    v_perm_b32 v9, v33, v33, v29
    v_perm_b32 v10, v33, v33, v30
    v_perm_b32 v11, v33, v33, v31
    v_perm_b32 v4, v49, v49, v28
    v_perm_b32 v5, v49, v49, v29
    v_perm_b32 v6, v49, v49, v30
    v_perm_b32 v7, v49, v49, v31
    s_waitcnt vmcnt(11)
    v_mfma_f32_16x16x32_bf16 v[12:15], v[140:143], v[8:11], v[12:15]
    v_mfma_f32_16x16x32_bf16 v[68:71], v[140:143], v[4:7], v[68:71]
    buffer_load_dwordx4 v[188:191], v18, s[4:7], s32 offen nt
    s_add_u32 s32, s32, 8192
    v_perm_b32 v8, v34, v34, v24
    v_perm_b32 v9, v34, v34, v25
    v_perm_b32 v10, v34, v34, v26
    v_perm_b32 v11, v34, v34, v27
    v_perm_b32 v4, v50, v50, v24
    v_perm_b32 v5, v50, v50, v25
    v_perm_b32 v6, v50, v50, v26
    v_perm_b32 v7, v50, v50, v27
    s_waitcnt vmcnt(11)
    v_mfma_f32_16x16x32_bf16 v[12:15], v[144:147], v[8:11], v[12:15]
    v_mfma_f32_16x16x32_bf16 v[68:71], v[144:147], v[4:7], v[68:71]
    buffer_load_dwordx4 v[192:195], v18, s[4:7], s32 offen nt
    s_add_u32 s32, s32, 8192
    v_perm_b32 v8, v34, v34, v28
    v_perm_b32 v9, v34, v34, v29
    v_perm_b32 v10, v34, v34, v30
    v_perm_b32 v11, v34, v34, v31
    v_perm_b32 v4, v50, v50, v28
    v_perm_b32 v5, v50, v50, v29
    v_perm_b32 v6, v50, v50, v30
    v_perm_b32 v7, v50, v50, v31
    s_waitcnt vmcnt(11)
    v_mfma_f32_16x16x32_bf16 v[12:15], v[148:151], v[8:11], v[12:15]
    v_mfma_f32_16x16x32_bf16 v[68:71], v[148:151], v[4:7], v[68:71]
    buffer_load_dwordx4 v[196:199], v18, s[4:7], s32 offen nt
    s_add_u32 s32, s32, 8192
    v_perm_b32 v8, v35, v35, v24
    v_perm_b32 v9, v35, v35, v25
    v_perm_b32 v10, v35, v35, v26
    v_perm_b32 v11, v35, v35, v27
    v_perm_b32 v4, v51, v51, v24
    v_perm_b32 v5, v51, v51, v25
    v_perm_b32 v6, v51, v51, v26
    v_perm_b32 v7, v51, v51, v27
    s_waitcnt vmcnt(11)
    v_mfma_f32_16x16x32_bf16 v[12:15], v[152:155], v[8:11], v[12:15]
    v_mfma_f32_16x16x32_bf16 v[68:71], v[152:155], v[4:7], v[68:71]
    buffer_load_dwordx4 v[200:203], v18, s[4:7], s32 offen nt
    s_add_u32 s32, s32, 8192
    v_perm_b32 v8, v35, v35, v28
    v_perm_b32 v9, v35, v35, v29
    v_perm_b32 v10, v35, v35, v30
    v_perm_b32 v11, v35, v35, v31
    v_perm_b32 v4, v51, v51, v28
    v_perm_b32 v5, v51, v51, v29
    v_perm_b32 v6, v51, v51, v30
    v_perm_b32 v7, v51, v51, v31
    s_waitcnt vmcnt(11)
    v_mfma_f32_16x16x32_bf16 v[12:15], v[156:159], v[8:11], v[12:15]
    v_mfma_f32_16x16x32_bf16 v[68:71], v[156:159], v[4:7], v[68:71]
    buffer_load_dwordx4 v[204:207], v18, s[4:7], s32 offen nt
    s_add_u32 s32, s32, 8192
    v_perm_b32 v8, v36, v36, v24
    v_perm_b32 v9, v36, v36, v25
    v_perm_b32 v10, v36, v36, v26
    v_perm_b32 v11, v36, v36, v27
    v_perm_b32 v4, v52, v52, v24
    v_perm_b32 v5, v52, v52, v25
    v_perm_b32 v6, v52, v52, v26
    v_perm_b32 v7, v52, v52, v27
    s_waitcnt vmcnt(11)
    v_mfma_f32_16x16x32_bf16 v[12:15], v[160:163], v[8:11], v[12:15]
    v_mfma_f32_16x16x32_bf16 v[68:71], v[160:163], v[4:7], v[68:71]
    buffer_load_dwordx4 v[208:211], v18, s[4:7], s32 offen nt
    s_add_u32 s32, s32, 8192
    v_perm_b32 v8, v36, v36, v28
    v_perm_b32 v9, v36, v36, v29
    v_perm_b32 v10, v36, v36, v30
    v_perm_b32 v11, v36, v36, v31
    v_perm_b32 v4, v52, v52, v28
    v_perm_b32 v5, v52, v52, v29
    v_perm_b32 v6, v52, v52, v30
    v_perm_b32 v7, v52, v52, v31
    s_waitcnt vmcnt(11)
    v_mfma_f32_16x16x32_bf16 v[12:15], v[164:167], v[8:11], v[12:15]
    v_mfma_f32_16x16x32_bf16 v[68:71], v[164:167], v[4:7], v[68:71]
    buffer_load_dwordx4 v[212:215], v18, s[4:7], s32 offen nt
    s_add_u32 s32, s32, 8192
    v_perm_b32 v8, v37, v37, v24
    v_perm_b32 v9, v37, v37, v25
    v_perm_b32 v10, v37, v37, v26
    v_perm_b32 v11, v37, v37, v27
    v_perm_b32 v4, v53, v53, v24
    v_perm_b32 v5, v53, v53, v25
    v_perm_b32 v6, v53, v53, v26
    v_perm_b32 v7, v53, v53, v27
    s_waitcnt vmcnt(11)
    v_mfma_f32_16x16x32_bf16 v[12:15], v[168:171], v[8:11], v[12:15]
    v_mfma_f32_16x16x32_bf16 v[68:71], v[168:171], v[4:7], v[68:71]
    buffer_load_dwordx4 v[216:219], v18, s[4:7], s32 offen nt
    s_add_u32 s32, s32, 8192
    v_perm_b32 v8, v37, v37, v28
    v_perm_b32 v9, v37, v37, v29
    v_perm_b32 v10, v37, v37, v30
    v_perm_b32 v11, v37, v37, v31
    v_perm_b32 v4, v53, v53, v28
    v_perm_b32 v5, v53, v53, v29
    v_perm_b32 v6, v53, v53, v30
    v_perm_b32 v7, v53, v53, v31
    s_waitcnt vmcnt(11)
    v_mfma_f32_16x16x32_bf16 v[12:15], v[172:175], v[8:11], v[12:15]
    v_mfma_f32_16x16x32_bf16 v[68:71], v[172:175], v[4:7], v[68:71]
    buffer_load_dwordx4 v[220:223], v18, s[4:7], s32 offen nt
    s_add_u32 s32, s32, 8192
    v_perm_b32 v8, v38, v38, v24
    v_perm_b32 v9, v38, v38, v25
    v_perm_b32 v10, v38, v38, v26
    v_perm_b32 v11, v38, v38, v27
    v_perm_b32 v4, v54, v54, v24
    v_perm_b32 v5, v54, v54, v25
    v_perm_b32 v6, v54, v54, v26
    v_perm_b32 v7, v54, v54, v27
    s_waitcnt vmcnt(11)
    v_mfma_f32_16x16x32_bf16 v[12:15], v[176:179], v[8:11], v[12:15]
    v_mfma_f32_16x16x32_bf16 v[68:71], v[176:179], v[4:7], v[68:71]
    buffer_load_dwordx4 v[224:227], v18, s[4:7], s32 offen nt
    s_add_u32 s32, s32, 8192
    v_perm_b32 v8, v38, v38, v28
    v_perm_b32 v9, v38, v38, v29
    v_perm_b32 v10, v38, v38, v30
    v_perm_b32 v11, v38, v38, v31
    v_perm_b32 v4, v54, v54, v28
    v_perm_b32 v5, v54, v54, v29
    v_perm_b32 v6, v54, v54, v30
    v_perm_b32 v7, v54, v54, v31
    s_waitcnt vmcnt(11)
    v_mfma_f32_16x16x32_bf16 v[12:15], v[180:183], v[8:11], v[12:15]
    v_mfma_f32_16x16x32_bf16 v[68:71], v[180:183], v[4:7], v[68:71]
    buffer_load_dwordx4 v[228:231], v18, s[4:7], s32 offen nt
    s_add_u32 s32, s32, 8192
    v_perm_b32 v8, v39, v39, v24
    v_perm_b32 v9, v39, v39, v25
    v_perm_b32 v10, v39, v39, v26
    v_perm_b32 v11, v39, v39, v27
    v_perm_b32 v4, v55, v55, v24
    v_perm_b32 v5, v55, v55, v25
    v_perm_b32 v6, v55, v55, v26
    v_perm_b32 v7, v55, v55, v27
    s_waitcnt vmcnt(11)
    v_mfma_f32_16x16x32_bf16 v[12:15], v[184:187], v[8:11], v[12:15]
    v_mfma_f32_16x16x32_bf16 v[68:71], v[184:187], v[4:7], v[68:71]
    buffer_load_dwordx4 v[232:235], v18, s[4:7], s32 offen nt
    s_add_u32 s32, s32, 8192
    v_perm_b32 v8, v39, v39, v28
    v_perm_b32 v9, v39, v39, v29
    v_perm_b32 v10, v39, v39, v30
    v_perm_b32 v11, v39, v39, v31
    v_perm_b32 v4, v55, v55, v28
    v_perm_b32 v5, v55, v55, v29
    v_perm_b32 v6, v55, v55, v30
    v_perm_b32 v7, v55, v55, v31
    s_waitcnt vmcnt(11)
    v_mfma_f32_16x16x32_bf16 v[12:15], v[188:191], v[8:11], v[12:15]
    v_mfma_f32_16x16x32_bf16 v[68:71], v[188:191], v[4:7], v[68:71]
    buffer_load_dwordx4 v[236:239], v18, s[4:7], s32 offen nt
    s_add_u32 s32, s32, 8192
    v_perm_b32 v8, v40, v40, v24
    v_perm_b32 v9, v40, v40, v25
    v_perm_b32 v10, v40, v40, v26
    v_perm_b32 v11, v40, v40, v27
    v_perm_b32 v4, v56, v56, v24
    v_perm_b32 v5, v56, v56, v25
    v_perm_b32 v6, v56, v56, v26
    v_perm_b32 v7, v56, v56, v27
    s_waitcnt vmcnt(11)
    v_mfma_f32_16x16x32_bf16 v[12:15], v[192:195], v[8:11], v[12:15]
    v_mfma_f32_16x16x32_bf16 v[68:71], v[192:195], v[4:7], v[68:71]
    buffer_load_dwordx4 v[240:243], v18, s[4:7], s32 offen nt
    s_add_u32 s32, s32, 8192
    v_perm_b32 v8, v40, v40, v28
    v_perm_b32 v9, v40, v40, v29
    v_perm_b32 v10, v40, v40, v30
    v_perm_b32 v11, v40, v40, v31
    v_perm_b32 v4, v56, v56, v28
    v_perm_b32 v5, v56, v56, v29
    v_perm_b32 v6, v56, v56, v30
    v_perm_b32 v7, v56, v56, v31
    s_waitcnt vmcnt(11)
    v_mfma_f32_16x16x32_bf16 v[12:15], v[196:199], v[8:11], v[12:15]
    v_mfma_f32_16x16x32_bf16 v[68:71], v[196:199], v[4:7], v[68:71]
    buffer_load_dwordx4 v[244:247], v18, s[4:7], s32 offen nt
    s_add_u32 s32, s32, 8192
    v_perm_b32 v8, v41, v41, v24
    v_perm_b32 v9, v41, v41, v25
    v_perm_b32 v10, v41, v41, v26
    v_perm_b32 v11, v41, v41, v27
    v_perm_b32 v4, v57, v57, v24
    v_perm_b32 v5, v57, v57, v25
    v_perm_b32 v6, v57, v57, v26
    v_perm_b32 v7, v57, v57, v27
    s_waitcnt vmcnt(11)
    v_mfma_f32_16x16x32_bf16 v[12:15], v[200:203], v[8:11], v[12:15]
    v_mfma_f32_16x16x32_bf16 v[68:71], v[200:203], v[4:7], v[68:71]
    buffer_load_dwordx4 v[248:251], v18, s[4:7], s32 offen nt
    s_add_u32 s32, s32, 8192
    v_perm_b32 v8, v41, v41, v28
    v_perm_b32 v9, v41, v41, v29
    v_perm_b32 v10, v41, v41, v30
    v_perm_b32 v11, v41, v41, v31
    v_perm_b32 v4, v57, v57, v28
    v_perm_b32 v5, v57, v57, v29
    v_perm_b32 v6, v57, v57, v30
    v_perm_b32 v7, v57, v57, v31
    s_waitcnt vmcnt(11)
    v_mfma_f32_16x16x32_bf16 v[12:15], v[204:207], v[8:11], v[12:15]
    v_mfma_f32_16x16x32_bf16 v[68:71], v[204:207], v[4:7], v[68:71]
    buffer_load_dwordx4 v[252:255], v18, s[4:7], s32 offen nt
    s_add_u32 s32, s32, 8192
    v_perm_b32 v8, v42, v42, v24
    v_perm_b32 v9, v42, v42, v25
    v_perm_b32 v10, v42, v42, v26
    v_perm_b32 v11, v42, v42, v27
    v_perm_b32 v4, v58, v58, v24
    v_perm_b32 v5, v58, v58, v25
    v_perm_b32 v6, v58, v58, v26
    v_perm_b32 v7, v58, v58, v27
    s_waitcnt vmcnt(11)
    v_mfma_f32_16x16x32_bf16 v[12:15], v[208:211], v[8:11], v[12:15]
    v_mfma_f32_16x16x32_bf16 v[68:71], v[208:211], v[4:7], v[68:71]
    s_lshl_b32 s73, s74, 7
    s_add_u32 s73, s73, 0x170000
    s_cmp_lg_u32 s3, 0
    s_cbranch_scc1 L_A_nofl
    s_mov_b64 exec, 1
    buffer_store_dwordx4 v[76:79], off, s[12:15], s73 sc1
    s_mov_b64 exec, -1
L_A_nofl:
    s_cmp_ge_u32 s71, 0x1fe000
    s_cselect_b32 s71, 0x600000, s71
    buffer_store_dwordx4 v[76:79], v2, s[12:15], s71 offen sc1
    s_add_u32 s71, s71, 0x20000
    s_getpc_b64 s[24:25]
L_pc10:
    s_add_u32 s24, s24, L_A2-L_pc10
    s_addc_u32 s25, s25, 0
    v_lshl_add_u32 v16, v0, 2, s3
    v_lshlrev_b32 v16, 7, v16
    v_min_u32 v16, L_last-L_A2-4, v16
    v_mov_b32 v17, s25
    v_add_co_u32 v16, vcc, s24, v16
    s_nop 1
    v_addc_co_u32 v17, vcc, 0, v17, vcc
    global_load_dword v17, v[16:17], off
    s_mov_b32 s4, s42
    s_mov_b32 s5, s43
    s_mov_b32 s6, s75
    s_mov_b32 s32, s35
    buffer_load_dwordx4 v[128:131], v64, s[4:7], s32 offen nt
    s_add_u32 s32, s32, 8192
    v_perm_b32 v8, v42, v42, v28
    v_perm_b32 v9, v42, v42, v29
    v_perm_b32 v10, v42, v42, v30
    v_perm_b32 v11, v42, v42, v31
    v_perm_b32 v4, v58, v58, v28
    v_perm_b32 v5, v58, v58, v29
    v_perm_b32 v6, v58, v58, v30
    v_perm_b32 v7, v58, v58, v31
    s_waitcnt vmcnt(13)
    v_mfma_f32_16x16x32_bf16 v[12:15], v[212:215], v[8:11], v[12:15]
    v_mfma_f32_16x16x32_bf16 v[68:71], v[212:215], v[4:7], v[68:71]
    buffer_load_dwordx4 v[132:135], v64, s[4:7], s32 offen nt
    s_add_u32 s32, s32, 8192
    v_perm_b32 v8, v43, v43, v24
    v_perm_b32 v9, v43, v43, v25
    v_perm_b32 v10, v43, v43, v26
    v_perm_b32 v11, v43, v43, v27
    v_perm_b32 v4, v59, v59, v24
    v_perm_b32 v5, v59, v59, v25
    v_perm_b32 v6, v59, v59, v26
    v_perm_b32 v7, v59, v59, v27
    s_waitcnt vmcnt(13)
    v_mfma_f32_16x16x32_bf16 v[12:15], v[216:219], v[8:11], v[12:15]
    v_mfma_f32_16x16x32_bf16 v[68:71], v[216:219], v[4:7], v[68:71]
    buffer_load_dwordx4 v[136:139], v64, s[4:7], s32 offen nt
    s_add_u32 s32, s32, 8192
    v_perm_b32 v8, v43, v43, v28
    v_perm_b32 v9, v43, v43, v29
    v_perm_b32 v10, v43, v43, v30
    v_perm_b32 v11, v43, v43, v31
    v_perm_b32 v4, v59, v59, v28
    v_perm_b32 v5, v59, v59, v29
    v_perm_b32 v6, v59, v59, v30
    v_perm_b32 v7, v59, v59, v31
    s_waitcnt vmcnt(13)
    v_mfma_f32_16x16x32_bf16 v[12:15], v[220:223], v[8:11], v[12:15]
    v_mfma_f32_16x16x32_bf16 v[68:71], v[220:223], v[4:7], v[68:71]
    buffer_load_dwordx4 v[140:143], v64, s[4:7], s32 offen nt
    s_add_u32 s32, s32, 8192
    v_perm_b32 v8, v44, v44, v24
    v_perm_b32 v9, v44, v44, v25
    v_perm_b32 v10, v44, v44, v26
    v_perm_b32 v11, v44, v44, v27
    v_perm_b32 v4, v60, v60, v24
    v_perm_b32 v5, v60, v60, v25
    v_perm_b32 v6, v60, v60, v26
    v_perm_b32 v7, v60, v60, v27
    s_waitcnt vmcnt(13)
    v_mfma_f32_16x16x32_bf16 v[12:15], v[224:227], v[8:11], v[12:15]
    v_mfma_f32_16x16x32_bf16 v[68:71], v[224:227], v[4:7], v[68:71]
    buffer_load_dwordx4 v[144:147], v64, s[4:7], s32 offen nt
    s_add_u32 s32, s32, 8192
    v_perm_b32 v8, v44, v44, v28
    v_perm_b32 v9, v44, v44, v29
    v_perm_b32 v10, v44, v44, v30
    v_perm_b32 v11, v44, v44, v31
    v_perm_b32 v4, v60, v60, v28
    v_perm_b32 v5, v60, v60, v29
    v_perm_b32 v6, v60, v60, v30
    v_perm_b32 v7, v60, v60, v31
    s_waitcnt vmcnt(13)
    v_mfma_f32_16x16x32_bf16 v[12:15], v[228:231], v[8:11], v[12:15]
    v_mfma_f32_16x16x32_bf16 v[68:71], v[228:231], v[4:7], v[68:71]
    buffer_load_dwordx4 v[148:151], v64, s[4:7], s32 offen nt
    s_add_u32 s32, s32, 8192
    v_perm_b32 v8, v45, v45, v24
    v_perm_b32 v9, v45, v45, v25
    v_perm_b32 v10, v45, v45, v26
    v_perm_b32 v11, v45, v45, v27
    v_perm_b32 v4, v61, v61, v24
    v_perm_b32 v5, v61, v61, v25
    v_perm_b32 v6, v61, v61, v26
    v_perm_b32 v7, v61, v61, v27
    s_waitcnt vmcnt(13)
    v_mfma_f32_16x16x32_bf16 v[12:15], v[232:235], v[8:11], v[12:15]
    v_mfma_f32_16x16x32_bf16 v[68:71], v[232:235], v[4:7], v[68:71]
    buffer_load_dwordx4 v[152:155], v64, s[4:7], s32 offen nt
    s_add_u32 s32, s32, 8192
    v_perm_b32 v8, v45, v45, v28
    v_perm_b32 v9, v45, v45, v29
    v_perm_b32 v10, v45, v45, v30
    v_perm_b32 v11, v45, v45, v31
    v_perm_b32 v4, v61, v61, v28
    v_perm_b32 v5, v61, v61, v29
    v_perm_b32 v6, v61, v61, v30
    v_perm_b32 v7, v61, v61, v31
    s_waitcnt vmcnt(13)
    v_mfma_f32_16x16x32_bf16 v[12:15], v[236:239], v[8:11], v[12:15]
    v_mfma_f32_16x16x32_bf16 v[68:71], v[236:239], v[4:7], v[68:71]
    buffer_load_dwordx4 v[156:159], v64, s[4:7], s32 offen nt
    s_add_u32 s32, s32, 8192
    v_perm_b32 v8, v46, v46, v24
    v_perm_b32 v9, v46, v46, v25
    v_perm_b32 v10, v46, v46, v26
    v_perm_b32 v11, v46, v46, v27
    v_perm_b32 v4, v62, v62, v24
    v_perm_b32 v5, v62, v62, v25
    v_perm_b32 v6, v62, v62, v26
    v_perm_b32 v7, v62, v62, v27
    s_waitcnt vmcnt(13)
    v_mfma_f32_16x16x32_bf16 v[12:15], v[240:243], v[8:11], v[12:15]
    v_mfma_f32_16x16x32_bf16 v[68:71], v[240:243], v[4:7], v[68:71]
    buffer_load_dwordx4 v[160:163], v64, s[4:7], s32 offen nt
    s_add_u32 s32, s32, 8192
    v_perm_b32 v8, v46, v46, v28
    v_perm_b32 v9, v46, v46, v29
    v_perm_b32 v10, v46, v46, v30
    v_perm_b32 v11, v46, v46, v31
    v_perm_b32 v4, v62, v62, v28
    v_perm_b32 v5, v62, v62, v29
    v_perm_b32 v6, v62, v62, v30
    v_perm_b32 v7, v62, v62, v31
    s_waitcnt vmcnt(13)
    v_mfma_f32_16x16x32_bf16 v[12:15], v[244:247], v[8:11], v[12:15]
    v_mfma_f32_16x16x32_bf16 v[68:71], v[244:247], v[4:7], v[68:71]
    buffer_load_dwordx4 v[164:167], v64, s[4:7], s32 offen nt
    s_add_u32 s32, s32, 8192
    v_perm_b32 v8, v47, v47, v24
    v_perm_b32 v9, v47, v47, v25
    v_perm_b32 v10, v47, v47, v26
    v_perm_b32 v11, v47, v47, v27
    v_perm_b32 v4, v63, v63, v24
    v_perm_b32 v5, v63, v63, v25
    v_perm_b32 v6, v63, v63, v26
    v_perm_b32 v7, v63, v63, v27
    s_waitcnt vmcnt(13)
    v_mfma_f32_16x16x32_bf16 v[12:15], v[248:251], v[8:11], v[12:15]
    v_mfma_f32_16x16x32_bf16 v[68:71], v[248:251], v[4:7], v[68:71]
    buffer_load_dwordx4 v[168:171], v64, s[4:7], s32 offen nt
    s_add_u32 s32, s32, 8192
    v_perm_b32 v8, v47, v47, v28
    v_perm_b32 v9, v47, v47, v29
    v_perm_b32 v10, v47, v47, v30
    v_perm_b32 v11, v47, v47, v31
    v_perm_b32 v4, v63, v63, v28
    v_perm_b32 v5, v63, v63, v29
    v_perm_b32 v6, v63, v63, v30
    v_perm_b32 v7, v63, v63, v31
    s_waitcnt vmcnt(13)
    v_mfma_f32_16x16x32_bf16 v[12:15], v[252:255], v[8:11], v[12:15]
    v_mfma_f32_16x16x32_bf16 v[68:71], v[252:255], v[4:7], v[68:71]
    buffer_load_dwordx4 v[172:175], v64, s[4:7], s32 offen nt
    s_add_u32 s32, s32, 8192
    v_lshrrev_b32 v3, 4, v0
    v_lshlrev_b32 v3, 7, v3
    v_and_b32 v4, 7, v0
    v_lshl_add_u32 v3, v4, 2, v3
    v_bfe_u32 v4, v0, 3, 1
    v_lshl_add_u32 v3, v4, 9, v3
    s_lshl_b32 s24, s3, 11
    s_add_u32 s24, s24, 135168
    v_add_u32 v3, s24, v3
    ds_write_b32 v3, v12 offset:0
    ds_write_b32 v3, v13 offset:32
    ds_write_b32 v3, v14 offset:64
    ds_write_b32 v3, v15 offset:96
    ds_write_b32 v3, v68 offset:1024
    ds_write_b32 v3, v69 offset:1056
    ds_write_b32 v3, v70 offset:1088
    ds_write_b32 v3, v71 offset:1120
    s_waitcnt lgkmcnt(0)
    s_barrier
    ds_read_b128 v[72:75], v65 offset:0
    ds_read_b128 v[76:79], v65 offset:16
    ds_read_b128 v[80:83], v65 offset:2048
    ds_read_b128 v[84:87], v65 offset:2064
    ds_read_b128 v[88:91], v65 offset:4096
    ds_read_b128 v[92:95], v65 offset:4112
    ds_read_b128 v[96:99], v65 offset:6144
    ds_read_b128 v[100:103], v65 offset:6160
    s_waitcnt lgkmcnt(4)
    v_add_f32 v72, v72, v80
    v_add_f32 v73, v73, v81
    v_add_f32 v74, v74, v82
    v_add_f32 v75, v75, v83
    v_add_f32 v76, v76, v84
    v_add_f32 v77, v77, v85
    v_add_f32 v78, v78, v86
    v_add_f32 v79, v79, v87
    s_waitcnt lgkmcnt(2)
    v_add_f32 v72, v72, v88
    v_add_f32 v73, v73, v89
    v_add_f32 v74, v74, v90
    v_add_f32 v75, v75, v91
    v_add_f32 v76, v76, v92
    v_add_f32 v77, v77, v93
    v_add_f32 v78, v78, v94
    v_add_f32 v79, v79, v95
    s_waitcnt lgkmcnt(0)
    v_add_f32 v72, v72, v96
    v_add_f32 v73, v73, v97
    v_add_f32 v74, v74, v98
    v_add_f32 v75, v75, v99
    v_add_f32 v76, v76, v100
    v_add_f32 v77, v77, v101
    v_add_f32 v78, v78, v102
    v_add_f32 v79, v79, v103
    v_cvt_pk_bf16_f32 v8, v72, v73
    v_cvt_pk_bf16_f32 v9, v74, v75
    v_cvt_pk_bf16_f32 v10, v76, v77
    v_cvt_pk_bf16_f32 v11, v78, v79
    s_cmp_ge_u32 s74, 32
    s_cbranch_scc1 L_C
L_A2:
    buffer_load_dwordx4 v[176:179], v64, s[4:7], s32 offen nt
    s_add_u32 s32, s32, 8192
    buffer_load_dwordx4 v[180:183], v64, s[4:7], s32 offen nt
    s_add_u32 s32, s32, 8192
    buffer_load_dwordx4 v[184:187], v64, s[4:7], s32 offen nt
    s_add_u32 s32, s32, 8192
    buffer_load_dwordx4 v[188:191], v64, s[4:7], s32 offen nt
    s_add_u32 s32, s32, 8192
    buffer_load_dwordx4 v[192:195], v64, s[4:7], s32 offen nt
    s_add_u32 s32, s32, 8192
    buffer_load_dwordx4 v[196:199], v64, s[4:7], s32 offen nt
    s_add_u32 s32, s32, 8192
    buffer_load_dwordx4 v[200:203], v64, s[4:7], s32 offen nt
    s_add_u32 s32, s32, 8192
    buffer_load_dwordx4 v[204:207], v64, s[4:7], s32 offen nt
    s_add_u32 s32, s32, 8192
    buffer_load_dwordx4 v[208:211], v64, s[4:7], s32 offen nt
    s_add_u32 s32, s32, 8192
    buffer_load_dwordx4 v[212:215], v64, s[4:7], s32 offen nt
    s_add_u32 s32, s32, 8192
    buffer_load_dwordx4 v[216:219], v64, s[4:7], s32 offen nt
    s_add_u32 s32, s32, 8192
    buffer_load_dwordx4 v[220:223], v64, s[4:7], s32 offen nt
    s_add_u32 s32, s32, 8192
    buffer_load_dwordx4 v[224:227], v64, s[4:7], s32 offen nt
    s_add_u32 s32, s32, 8192
    buffer_load_dwordx4 v[228:231], v64, s[4:7], s32 offen nt
    s_add_u32 s32, s32, 8192
    buffer_load_dwordx4 v[232:235], v64, s[4:7], s32 offen nt
    s_add_u32 s32, s32, 8192
    buffer_load_dwordx4 v[236:239], v64, s[4:7], s32 offen nt
    s_add_u32 s32, s32, 8192
    buffer_load_dwordx4 v[240:243], v64, s[4:7], s32 offen nt
    s_add_u32 s32, s32, 8192
    buffer_load_dwordx4 v[244:247], v64, s[4:7], s32 offen nt
    s_add_u32 s32, s32, 8192
    buffer_load_dwordx4 v[248:251], v64, s[4:7], s32 offen nt
    s_add_u32 s32, s32, 8192
    buffer_load_dwordx4 v[252:255], v64, s[4:7], s32 offen nt
    s_add_u32 s32, s32, 8192
    s_waitcnt vmcnt(31)
    v_mfma_f32_16x16x32_bf16 v[80:83], v[128:131], v[8:11], 0
    s_waitcnt vmcnt(30)
    v_mfma_f32_16x16x32_bf16 v[84:87], v[132:135], v[8:11], 0
    s_waitcnt vmcnt(29)
    v_mfma_f32_16x16x32_bf16 v[88:91], v[136:139], v[8:11], 0
    s_waitcnt vmcnt(28)
    v_mfma_f32_16x16x32_bf16 v[92:95], v[140:143], v[8:11], 0
    s_waitcnt vmcnt(27)
    v_mfma_f32_16x16x32_bf16 v[96:99], v[144:147], v[8:11], 0
    s_waitcnt vmcnt(26)
    v_mfma_f32_16x16x32_bf16 v[100:103], v[148:151], v[8:11], 0
    s_waitcnt vmcnt(25)
    v_mfma_f32_16x16x32_bf16 v[104:107], v[152:155], v[8:11], 0
    s_waitcnt vmcnt(24)
    v_mfma_f32_16x16x32_bf16 v[108:111], v[156:159], v[8:11], 0
    v_add_f32_dpp v72, v81, v80 quad_perm:[1,1,1,1] row_mask:0xf bank_mask:0xf
    v_add_f32_dpp v73, v85, v84 quad_perm:[1,1,1,1] row_mask:0xf bank_mask:0xf
    v_add_f32_dpp v74, v89, v88 quad_perm:[1,1,1,1] row_mask:0xf bank_mask:0xf
    v_add_f32_dpp v75, v93, v92 quad_perm:[1,1,1,1] row_mask:0xf bank_mask:0xf
    v_add_f32_dpp v76, v97, v96 quad_perm:[1,1,1,1] row_mask:0xf bank_mask:0xf
    v_add_f32_dpp v77, v101, v100 quad_perm:[1,1,1,1] row_mask:0xf bank_mask:0xf
    v_add_f32_dpp v78, v105, v104 quad_perm:[1,1,1,1] row_mask:0xf bank_mask:0xf
    s_nop 0
    v_add_f32_dpp v79, v109, v108 quad_perm:[1,1,1,1] row_mask:0xf bank_mask:0xf
    v_add_f32_dpp v72, v82, v72 quad_perm:[2,2,2,2] row_mask:0xf bank_mask:0xf
    v_add_f32_dpp v73, v86, v73 quad_perm:[2,2,2,2] row_mask:0xf bank_mask:0xf
    v_add_f32_dpp v74, v90, v74 quad_perm:[2,2,2,2] row_mask:0xf bank_mask:0xf
    v_add_f32_dpp v75, v94, v75 quad_perm:[2,2,2,2] row_mask:0xf bank_mask:0xf
    v_add_f32_dpp v76, v98, v76 quad_perm:[2,2,2,2] row_mask:0xf bank_mask:0xf
    v_add_f32_dpp v77, v102, v77 quad_perm:[2,2,2,2] row_mask:0xf bank_mask:0xf
    v_add_f32_dpp v78, v106, v78 quad_perm:[2,2,2,2] row_mask:0xf bank_mask:0xf
    v_add_f32_dpp v79, v110, v79 quad_perm:[2,2,2,2] row_mask:0xf bank_mask:0xf
    v_add_f32_dpp v72, v83, v72 quad_perm:[3,3,3,3] row_mask:0xf bank_mask:0xf
    v_add_f32_dpp v73, v87, v73 quad_perm:[3,3,3,3] row_mask:0xf bank_mask:0xf
    v_add_f32_dpp v74, v91, v74 quad_perm:[3,3,3,3] row_mask:0xf bank_mask:0xf
    v_add_f32_dpp v75, v95, v75 quad_perm:[3,3,3,3] row_mask:0xf bank_mask:0xf
    v_add_f32_dpp v76, v99, v76 quad_perm:[3,3,3,3] row_mask:0xf bank_mask:0xf
    v_add_f32_dpp v77, v103, v77 quad_perm:[3,3,3,3] row_mask:0xf bank_mask:0xf
    v_add_f32_dpp v78, v107, v78 quad_perm:[3,3,3,3] row_mask:0xf bank_mask:0xf
    v_add_f32_dpp v79, v111, v79 quad_perm:[3,3,3,3] row_mask:0xf bank_mask:0xf
    s_waitcnt vmcnt(23)
    v_mfma_f32_16x16x32_bf16 v[80:83], v[160:163], v[8:11], 0
    s_waitcnt vmcnt(22)
    v_mfma_f32_16x16x32_bf16 v[84:87], v[164:167], v[8:11], 0
    s_waitcnt vmcnt(21)
    v_mfma_f32_16x16x32_bf16 v[88:91], v[168:171], v[8:11], 0
    s_waitcnt vmcnt(20)
    v_mfma_f32_16x16x32_bf16 v[92:95], v[172:175], v[8:11], 0
    s_waitcnt vmcnt(19)
    v_mfma_f32_16x16x32_bf16 v[96:99], v[176:179], v[8:11], 0
    s_waitcnt vmcnt(18)
    v_mfma_f32_16x16x32_bf16 v[100:103], v[180:183], v[8:11], 0
    s_waitcnt vmcnt(17)
    v_mfma_f32_16x16x32_bf16 v[104:107], v[184:187], v[8:11], 0
    s_waitcnt vmcnt(16)
    v_mfma_f32_16x16x32_bf16 v[108:111], v[188:191], v[8:11], 0
    v_add_f32_dpp v112, v80, v81 quad_perm:[0,0,0,0] row_mask:0xf bank_mask:0xf
    v_add_f32_dpp v113, v84, v85 quad_perm:[0,0,0,0] row_mask:0xf bank_mask:0xf
    v_add_f32_dpp v114, v88, v89 quad_perm:[0,0,0,0] row_mask:0xf bank_mask:0xf
    v_add_f32_dpp v115, v92, v93 quad_perm:[0,0,0,0] row_mask:0xf bank_mask:0xf
    v_add_f32_dpp v116, v96, v97 quad_perm:[0,0,0,0] row_mask:0xf bank_mask:0xf
    v_add_f32_dpp v117, v100, v101 quad_perm:[0,0,0,0] row_mask:0xf bank_mask:0xf
    v_add_f32_dpp v118, v104, v105 quad_perm:[0,0,0,0] row_mask:0xf bank_mask:0xf
    s_nop 0
    v_add_f32_dpp v119, v108, v109 quad_perm:[0,0,0,0] row_mask:0xf bank_mask:0xf
    v_add_f32_dpp v112, v82, v112 quad_perm:[2,2,2,2] row_mask:0xf bank_mask:0xf
    v_add_f32_dpp v113, v86, v113 quad_perm:[2,2,2,2] row_mask:0xf bank_mask:0xf
    v_add_f32_dpp v114, v90, v114 quad_perm:[2,2,2,2] row_mask:0xf bank_mask:0xf
    v_add_f32_dpp v115, v94, v115 quad_perm:[2,2,2,2] row_mask:0xf bank_mask:0xf
    v_add_f32_dpp v116, v98, v116 quad_perm:[2,2,2,2] row_mask:0xf bank_mask:0xf
    v_add_f32_dpp v117, v102, v117 quad_perm:[2,2,2,2] row_mask:0xf bank_mask:0xf
    v_add_f32_dpp v118, v106, v118 quad_perm:[2,2,2,2] row_mask:0xf bank_mask:0xf
    v_add_f32_dpp v119, v110, v119 quad_perm:[2,2,2,2] row_mask:0xf bank_mask:0xf
    v_add_f32_dpp v112, v83, v112 quad_perm:[3,3,3,3] row_mask:0xf bank_mask:0xf
    v_add_f32_dpp v113, v87, v113 quad_perm:[3,3,3,3] row_mask:0xf bank_mask:0xf
    v_add_f32_dpp v114, v91, v114 quad_perm:[3,3,3,3] row_mask:0xf bank_mask:0xf
    v_add_f32_dpp v115, v95, v115 quad_perm:[3,3,3,3] row_mask:0xf bank_mask:0xf
    v_add_f32_dpp v116, v99, v116 quad_perm:[3,3,3,3] row_mask:0xf bank_mask:0xf
    v_add_f32_dpp v117, v103, v117 quad_perm:[3,3,3,3] row_mask:0xf bank_mask:0xf
    v_add_f32_dpp v118, v107, v118 quad_perm:[3,3,3,3] row_mask:0xf bank_mask:0xf
    v_add_f32_dpp v119, v111, v119 quad_perm:[3,3,3,3] row_mask:0xf bank_mask:0xf
    v_cndmask_b32 v72, v72, v112, s[64:65]
    v_cndmask_b32 v73, v73, v113, s[64:65]
    v_cndmask_b32 v74, v74, v114, s[64:65]
    v_cndmask_b32 v75, v75, v115, s[64:65]
    v_cndmask_b32 v76, v76, v116, s[64:65]
    v_cndmask_b32 v77, v77, v117, s[64:65]
    v_cndmask_b32 v78, v78, v118, s[64:65]
    v_cndmask_b32 v79, v79, v119, s[64:65]
    s_waitcnt vmcnt(15)
    v_mfma_f32_16x16x32_bf16 v[80:83], v[192:195], v[8:11], 0
    s_waitcnt vmcnt(14)
    v_mfma_f32_16x16x32_bf16 v[84:87], v[196:199], v[8:11], 0
    s_waitcnt vmcnt(13)
    v_mfma_f32_16x16x32_bf16 v[88:91], v[200:203], v[8:11], 0
    s_waitcnt vmcnt(12)
    v_mfma_f32_16x16x32_bf16 v[92:95], v[204:207], v[8:11], 0
    s_waitcnt vmcnt(11)
    v_mfma_f32_16x16x32_bf16 v[96:99], v[208:211], v[8:11], 0
    s_waitcnt vmcnt(10)
    v_mfma_f32_16x16x32_bf16 v[100:103], v[212:215], v[8:11], 0
    s_waitcnt vmcnt(9)
    v_mfma_f32_16x16x32_bf16 v[104:107], v[216:219], v[8:11], 0
    s_waitcnt vmcnt(8)
    v_mfma_f32_16x16x32_bf16 v[108:111], v[220:223], v[8:11], 0
    v_add_f32_dpp v112, v80, v82 quad_perm:[0,0,0,0] row_mask:0xf bank_mask:0xf
    v_add_f32_dpp v113, v84, v86 quad_perm:[0,0,0,0] row_mask:0xf bank_mask:0xf
    v_add_f32_dpp v114, v88, v90 quad_perm:[0,0,0,0] row_mask:0xf bank_mask:0xf
    v_add_f32_dpp v115, v92, v94 quad_perm:[0,0,0,0] row_mask:0xf bank_mask:0xf
    v_add_f32_dpp v116, v96, v98 quad_perm:[0,0,0,0] row_mask:0xf bank_mask:0xf
    v_add_f32_dpp v117, v100, v102 quad_perm:[0,0,0,0] row_mask:0xf bank_mask:0xf
    v_add_f32_dpp v118, v104, v106 quad_perm:[0,0,0,0] row_mask:0xf bank_mask:0xf
    s_nop 0
    v_add_f32_dpp v119, v108, v110 quad_perm:[0,0,0,0] row_mask:0xf bank_mask:0xf
    v_add_f32_dpp v112, v81, v112 quad_perm:[1,1,1,1] row_mask:0xf bank_mask:0xf
    v_add_f32_dpp v113, v85, v113 quad_perm:[1,1,1,1] row_mask:0xf bank_mask:0xf
    v_add_f32_dpp v114, v89, v114 quad_perm:[1,1,1,1] row_mask:0xf bank_mask:0xf
    v_add_f32_dpp v115, v93, v115 quad_perm:[1,1,1,1] row_mask:0xf bank_mask:0xf
    v_add_f32_dpp v116, v97, v116 quad_perm:[1,1,1,1] row_mask:0xf bank_mask:0xf
    v_add_f32_dpp v117, v101, v117 quad_perm:[1,1,1,1] row_mask:0xf bank_mask:0xf
    v_add_f32_dpp v118, v105, v118 quad_perm:[1,1,1,1] row_mask:0xf bank_mask:0xf
    v_add_f32_dpp v119, v109, v119 quad_perm:[1,1,1,1] row_mask:0xf bank_mask:0xf
    v_add_f32_dpp v112, v83, v112 quad_perm:[3,3,3,3] row_mask:0xf bank_mask:0xf
    v_add_f32_dpp v113, v87, v113 quad_perm:[3,3,3,3] row_mask:0xf bank_mask:0xf
    v_add_f32_dpp v114, v91, v114 quad_perm:[3,3,3,3] row_mask:0xf bank_mask:0xf
    v_add_f32_dpp v115, v95, v115 quad_perm:[3,3,3,3] row_mask:0xf bank_mask:0xf
    v_add_f32_dpp v116, v99, v116 quad_perm:[3,3,3,3] row_mask:0xf bank_mask:0xf
    v_add_f32_dpp v117, v103, v117 quad_perm:[3,3,3,3] row_mask:0xf bank_mask:0xf
    v_add_f32_dpp v118, v107, v118 quad_perm:[3,3,3,3] row_mask:0xf bank_mask:0xf
    v_add_f32_dpp v119, v111, v119 quad_perm:[3,3,3,3] row_mask:0xf bank_mask:0xf
    v_cndmask_b32 v72, v72, v112, s[66:67]
    v_cndmask_b32 v73, v73, v113, s[66:67]
    v_cndmask_b32 v74, v74, v114, s[66:67]
    v_cndmask_b32 v75, v75, v115, s[66:67]
    v_cndmask_b32 v76, v76, v116, s[66:67]
    v_cndmask_b32 v77, v77, v117, s[66:67]
    v_cndmask_b32 v78, v78, v118, s[66:67]
    v_cndmask_b32 v79, v79, v119, s[66:67]
    s_waitcnt vmcnt(7)
    v_mfma_f32_16x16x32_bf16 v[80:83], v[224:227], v[8:11], 0
    s_waitcnt vmcnt(6)
    v_mfma_f32_16x16x32_bf16 v[84:87], v[228:231], v[8:11], 0
    s_waitcnt vmcnt(5)
    v_mfma_f32_16x16x32_bf16 v[88:91], v[232:235], v[8:11], 0
    s_waitcnt vmcnt(4)
    v_mfma_f32_16x16x32_bf16 v[92:95], v[236:239], v[8:11], 0
    s_waitcnt vmcnt(3)
    v_mfma_f32_16x16x32_bf16 v[96:99], v[240:243], v[8:11], 0
    s_waitcnt vmcnt(2)
    v_mfma_f32_16x16x32_bf16 v[100:103], v[244:247], v[8:11], 0
    s_waitcnt vmcnt(1)
    v_mfma_f32_16x16x32_bf16 v[104:107], v[248:251], v[8:11], 0
    s_waitcnt vmcnt(0)
    v_mfma_f32_16x16x32_bf16 v[108:111], v[252:255], v[8:11], 0
    v_add_f32_dpp v112, v80, v83 quad_perm:[0,0,0,0] row_mask:0xf bank_mask:0xf
    v_add_f32_dpp v113, v84, v87 quad_perm:[0,0,0,0] row_mask:0xf bank_mask:0xf
    v_add_f32_dpp v114, v88, v91 quad_perm:[0,0,0,0] row_mask:0xf bank_mask:0xf
    v_add_f32_dpp v115, v92, v95 quad_perm:[0,0,0,0] row_mask:0xf bank_mask:0xf
    v_add_f32_dpp v116, v96, v99 quad_perm:[0,0,0,0] row_mask:0xf bank_mask:0xf
    v_add_f32_dpp v117, v100, v103 quad_perm:[0,0,0,0] row_mask:0xf bank_mask:0xf
    v_add_f32_dpp v118, v104, v107 quad_perm:[0,0,0,0] row_mask:0xf bank_mask:0xf
    s_nop 0
    v_add_f32_dpp v119, v108, v111 quad_perm:[0,0,0,0] row_mask:0xf bank_mask:0xf
    v_add_f32_dpp v112, v81, v112 quad_perm:[1,1,1,1] row_mask:0xf bank_mask:0xf
    v_add_f32_dpp v113, v85, v113 quad_perm:[1,1,1,1] row_mask:0xf bank_mask:0xf
    v_add_f32_dpp v114, v89, v114 quad_perm:[1,1,1,1] row_mask:0xf bank_mask:0xf
    v_add_f32_dpp v115, v93, v115 quad_perm:[1,1,1,1] row_mask:0xf bank_mask:0xf
    v_add_f32_dpp v116, v97, v116 quad_perm:[1,1,1,1] row_mask:0xf bank_mask:0xf
    v_add_f32_dpp v117, v101, v117 quad_perm:[1,1,1,1] row_mask:0xf bank_mask:0xf
    v_add_f32_dpp v118, v105, v118 quad_perm:[1,1,1,1] row_mask:0xf bank_mask:0xf
    v_add_f32_dpp v119, v109, v119 quad_perm:[1,1,1,1] row_mask:0xf bank_mask:0xf
    v_add_f32_dpp v112, v82, v112 quad_perm:[2,2,2,2] row_mask:0xf bank_mask:0xf
    v_add_f32_dpp v113, v86, v113 quad_perm:[2,2,2,2] row_mask:0xf bank_mask:0xf
    v_add_f32_dpp v114, v90, v114 quad_perm:[2,2,2,2] row_mask:0xf bank_mask:0xf
    v_add_f32_dpp v115, v94, v115 quad_perm:[2,2,2,2] row_mask:0xf bank_mask:0xf
    v_add_f32_dpp v116, v98, v116 quad_perm:[2,2,2,2] row_mask:0xf bank_mask:0xf
    v_add_f32_dpp v117, v102, v117 quad_perm:[2,2,2,2] row_mask:0xf bank_mask:0xf
    v_add_f32_dpp v118, v106, v118 quad_perm:[2,2,2,2] row_mask:0xf bank_mask:0xf
    v_add_f32_dpp v119, v110, v119 quad_perm:[2,2,2,2] row_mask:0xf bank_mask:0xf
    v_cndmask_b32 v72, v72, v112, s[68:69]
    v_cndmask_b32 v73, v73, v113, s[68:69]
    v_cndmask_b32 v74, v74, v114, s[68:69]
    v_cndmask_b32 v75, v75, v115, s[68:69]
    v_cndmask_b32 v76, v76, v116, s[68:69]
    v_cndmask_b32 v77, v77, v117, s[68:69]
    v_cndmask_b32 v78, v78, v118, s[68:69]
    v_cndmask_b32 v79, v79, v119, s[68:69]
    s_mov_b32 s71, 0x3e0293ee
    v_mul_f32 v72, s71, v72
    v_mul_f32 v73, s71, v73
    v_mul_f32 v74, s71, v74
    v_mul_f32 v75, s71, v75
    v_mul_f32 v76, s71, v76
    v_mul_f32 v77, s71, v77
    v_mul_f32 v78, s71, v78
    v_mul_f32 v79, s71, v79
    v_cvt_pk_bf16_f32 v4, v72, v73
    v_cvt_pk_bf16_f32 v5, v74, v75
    v_cvt_pk_bf16_f32 v6, v76, v77
    v_cvt_pk_bf16_f32 v7, v78, v79
    s_lshl_b32 s24, s26, 12
    s_lshl_b32 s25, s3, 8
    s_add_u32 s24, s24, s25
    s_add_u32 s24, s24, 0x0
    buffer_store_dwordx4 v[4:7], v66, s[12:15], s24 offen sc1
    s_mov_b32 s8, s56
    s_mov_b32 s9, s57
    s_mov_b32 s10, 0x400000
    s_mov_b32 s11, 0x20000
    s_and_b32 s24, s3, 1
    s_lshl_b32 s24, s24, 1
    s_and_b32 s25, s3, 2
    s_lshl_b32 s25, s25, 3
    s_or_b32 s25, s25, s24
    s_and_b32 s24, s26, 13
    s_or_b32 s25, s25, s24
    s_lshl_b32 s25, s25, 17
    s_lshr_b32 s24, s74, 3
    s_lshl_b32 s24, s24, 7
    s_add_u32 s24, s24, s25
    v_lshrrev_b32 v3, 4, v0
    v_lshlrev_b32 v3, 15, v3
    v_and_b32 v4, 8, v0
    v_lshl_add_u32 v3, v4, 10, v3
    v_and_b32 v4, 0x70, v2
    v_add_u32 v3, v3, v4
    s_mul_i32 m0, s3, 16896
    s_nop 0
    buffer_load_dwordx4 v3, s[8:11], s24 offen nt lds
    s_add_u32 m0, m0, 1056
    s_add_u32 s24, s24, 2048
    buffer_load_dwordx4 v3, s[8:11], s24 offen nt lds
    s_add_u32 m0, m0, 1056
    s_add_u32 s24, s24, 2048
    buffer_load_dwordx4 v3, s[8:11], s24 offen nt lds
    s_add_u32 m0, m0, 1056
    s_add_u32 s24, s24, 2048
    buffer_load_dwordx4 v3, s[8:11], s24 offen nt lds
    s_add_u32 m0, m0, 1056
    s_add_u32 s24, s24, 10240
    buffer_load_dwordx4 v3, s[8:11], s24 offen nt lds
    s_add_u32 m0, m0, 1056
    s_add_u32 s24, s24, 2048
    buffer_load_dwordx4 v3, s[8:11], s24 offen nt lds
    s_add_u32 m0, m0, 1056
    s_add_u32 s24, s24, 2048
    buffer_load_dwordx4 v3, s[8:11], s24 offen nt lds
    s_add_u32 m0, m0, 1056
    s_add_u32 s24, s24, 2048
    buffer_load_dwordx4 v3, s[8:11], s24 offen nt lds
    s_add_u32 m0, m0, 1056
    s_add_u32 s24, s24, -21504
    buffer_load_dwordx4 v3, s[8:11], s24 offen nt lds
    s_add_u32 m0, m0, 1056
    s_add_u32 s24, s24, 2048
    buffer_load_dwordx4 v3, s[8:11], s24 offen nt lds
    s_add_u32 m0, m0, 1056
    s_add_u32 s24, s24, 2048
    buffer_load_dwordx4 v3, s[8:11], s24 offen nt lds
    s_add_u32 m0, m0, 1056
    s_add_u32 s24, s24, 2048
    buffer_load_dwordx4 v3, s[8:11], s24 offen nt lds
    s_add_u32 m0, m0, 1056
    s_add_u32 s24, s24, 10240
    buffer_load_dwordx4 v3, s[8:11], s24 offen nt lds
    s_add_u32 m0, m0, 1056
    s_add_u32 s24, s24, 2048
    buffer_load_dwordx4 v3, s[8:11], s24 offen nt lds
    s_add_u32 m0, m0, 1056
    s_add_u32 s24, s24, 2048
    buffer_load_dwordx4 v3, s[8:11], s24 offen nt lds
    s_add_u32 m0, m0, 1056
    s_add_u32 s24, s24, 2048
    buffer_load_dwordx4 v3, s[8:11], s24 offen nt lds
    s_waitcnt vmcnt(0)
    s_barrier
    s_cmp_lg_u32 s3, 0
    s_cbranch_scc1 L_sig11
    s_mov_b64 exec, 1
    v_mov_b32 v3, 1
    buffer_atomic_add v3, off, s[16:19], 0 offset:0 sc0
    s_waitcnt vmcnt(0)
    v_readfirstlane_b32 s24, v3
    s_mov_b64 exec, -1
    s_and_b32 s24, s24, 63
    s_cmp_lg_u32 s24, 63
    s_cbranch_scc1 L_sig11
    v_lshlrev_b32 v4, 7, v0
    v_mov_b32 v3, 1
    s_mov_b32 s24, 0x170000
    buffer_store_dword v3, v4, s[12:15], s24 offen offset:0 sc1
L_sig11:
    v_lshrrev_b32 v3, 2, v0
    v_mul_u32_u24 v3, 1056, v3
    v_and_b32 v4, 3, v0
    v_lshl_add_u32 v3, v4, 3, v3
    s_lshl_b32 s24, s3, 5
    v_add_u32 v3, s24, v3
    ds_read_b64_tr_b16 a[128:129], v3 offset:0
    ds_read_b64_tr_b16 a[130:131], v3 offset:128
    ds_read_b64_tr_b16 a[132:133], v3 offset:256
    ds_read_b64_tr_b16 a[134:135], v3 offset:384
    ds_read_b64_tr_b16 a[136:137], v3 offset:512
    ds_read_b64_tr_b16 a[138:139], v3 offset:640
    ds_read_b64_tr_b16 a[140:141], v3 offset:768
    ds_read_b64_tr_b16 a[142:143], v3 offset:896
    ds_read_b64_tr_b16 a[144:145], v3 offset:16896
    ds_read_b64_tr_b16 a[146:147], v3 offset:17024
    ds_read_b64_tr_b16 a[148:149], v3 offset:17152
    ds_read_b64_tr_b16 a[150:151], v3 offset:17280
    ds_read_b64_tr_b16 a[152:153], v3 offset:17408
    ds_read_b64_tr_b16 a[154:155], v3 offset:17536
    ds_read_b64_tr_b16 a[156:157], v3 offset:17664
    ds_read_b64_tr_b16 a[158:159], v3 offset:17792
    ds_read_b64_tr_b16 a[160:161], v3 offset:33792
    ds_read_b64_tr_b16 a[162:163], v3 offset:33920
    ds_read_b64_tr_b16 a[164:165], v3 offset:34048
    ds_read_b64_tr_b16 a[166:167], v3 offset:34176
    ds_read_b64_tr_b16 a[168:169], v3 offset:34304
    ds_read_b64_tr_b16 a[170:171], v3 offset:34432
    ds_read_b64_tr_b16 a[172:173], v3 offset:34560
    ds_read_b64_tr_b16 a[174:175], v3 offset:34688
    ds_read_b64_tr_b16 a[176:177], v3 offset:50688
    ds_read_b64_tr_b16 a[178:179], v3 offset:50816
    ds_read_b64_tr_b16 a[180:181], v3 offset:50944
    ds_read_b64_tr_b16 a[182:183], v3 offset:51072
    ds_read_b64_tr_b16 a[184:185], v3 offset:51200
    ds_read_b64_tr_b16 a[186:187], v3 offset:51328
    ds_read_b64_tr_b16 a[188:189], v3 offset:51456
    ds_read_b64_tr_b16 a[190:191], v3 offset:51584
    s_mov_b32 s4, s44
    s_mov_b32 s5, s45
    s_mov_b32 s6, 0x400000
    s_mov_b32 s7, 0x20000
    s_mov_b32 s8, s46
    s_mov_b32 s9, s47
    s_mov_b32 s10, 0x400000
    s_mov_b32 s11, 0x20000
    s_mov_b32 s32, s35
    buffer_load_dwordx4 v[128:131], v18, s[4:7], s32 offen nt
    s_add_u32 s32, s32, 8192
    buffer_load_dwordx4 v[132:135], v18, s[4:7], s32 offen nt
    s_add_u32 s32, s32, 8192
    buffer_load_dwordx4 v[136:139], v18, s[4:7], s32 offen nt
    s_add_u32 s32, s32, 8192
    buffer_load_dwordx4 v[140:143], v18, s[4:7], s32 offen nt
    s_add_u32 s32, s32, 8192
    buffer_load_dwordx4 v[144:147], v18, s[4:7], s32 offen nt
    s_add_u32 s32, s32, 8192
    buffer_load_dwordx4 v[148:151], v18, s[4:7], s32 offen nt
    s_add_u32 s32, s32, 8192
    buffer_load_dwordx4 v[152:155], v18, s[4:7], s32 offen nt
    s_add_u32 s32, s32, 8192
    buffer_load_dwordx4 v[156:159], v18, s[4:7], s32 offen nt
    s_add_u32 s32, s32, 8192
    buffer_load_dwordx4 v[160:163], v18, s[4:7], s32 offen nt
    s_add_u32 s32, s32, 8192
    buffer_load_dwordx4 v[164:167], v18, s[4:7], s32 offen nt
    s_add_u32 s32, s32, 8192
    buffer_load_dwordx4 v[168:171], v18, s[4:7], s32 offen nt
    s_add_u32 s32, s32, 8192
    buffer_load_dwordx4 v[172:175], v18, s[4:7], s32 offen nt
    s_add_u32 s32, s32, 8192
    buffer_load_dwordx4 v[176:179], v18, s[4:7], s32 offen nt
    s_add_u32 s32, s32, 8192
    buffer_load_dwordx4 v[180:183], v18, s[4:7], s32 offen nt
    s_add_u32 s32, s32, 8192
    buffer_load_dwordx4 v[184:187], v18, s[4:7], s32 offen nt
    s_add_u32 s32, s32, 8192
    buffer_load_dwordx4 v[188:191], v18, s[4:7], s32 offen nt
    s_add_u32 s32, s32, 8192
    buffer_load_dwordx4 v[192:195], v18, s[4:7], s32 offen nt
    s_add_u32 s32, s32, 8192
    buffer_load_dwordx4 v[196:199], v18, s[4:7], s32 offen nt
    s_add_u32 s32, s32, 8192
    buffer_load_dwordx4 v[200:203], v18, s[4:7], s32 offen nt
    s_add_u32 s32, s32, 8192
    buffer_load_dwordx4 v[204:207], v18, s[4:7], s32 offen nt
    s_add_u32 s32, s32, 8192
    buffer_load_dwordx4 v[208:211], v18, s[4:7], s32 offen nt
    s_add_u32 s32, s32, 8192
    buffer_load_dwordx4 v[212:215], v18, s[4:7], s32 offen nt
    s_add_u32 s32, s32, 8192
    buffer_load_dwordx4 v[216:219], v18, s[4:7], s32 offen nt
    s_add_u32 s32, s32, 8192
    buffer_load_dwordx4 v[220:223], v18, s[4:7], s32 offen nt
    s_add_u32 s32, s32, 8192
    buffer_load_dwordx4 v[224:227], v18, s[4:7], s32 offen nt
    s_add_u32 s32, s32, 8192
    buffer_load_dwordx4 v[228:231], v18, s[4:7], s32 offen nt
    s_add_u32 s32, s32, 8192
    buffer_load_dwordx4 v[232:235], v18, s[4:7], s32 offen nt
    s_add_u32 s32, s32, 8192
    buffer_load_dwordx4 v[236:239], v18, s[4:7], s32 offen nt
    s_add_u32 s32, s32, 8192
    buffer_load_dwordx4 v[240:243], v18, s[4:7], s32 offen nt
    s_add_u32 s32, s32, 8192
    buffer_load_dwordx4 v[244:247], v18, s[4:7], s32 offen nt
    s_add_u32 s32, s32, 8192
    buffer_load_dwordx4 v[248:251], v18, s[4:7], s32 offen nt
    s_add_u32 s32, s32, 8192
    buffer_load_dwordx4 v[252:255], v18, s[4:7], s32 offen nt
    s_add_u32 s32, s32, 8192
    s_lshl_b32 s33, s26, 17
    s_lshl_b32 s24, s3, 15
    s_add_u32 s33, s33, s24
    s_mul_i32 s34, s3, 33792
    s_waitcnt lgkmcnt(0)
    s_barrier
    s_mov_b32 s70, 0
L_woA:
    s_and_b32 s24, s70, 3
    s_lshl_b32 s24, s24, 1
    s_lshr_b32 s25, s70, 2
    s_or_b32 s24, s24, s25
    s_lshl_b32 s24, s24, 10
    s_add_u32 s24, s24, s33
    s_mul_i32 s25, s70, 4224
    s_add_u32 m0, s25, s34
    s_waitcnt vmcnt(24)
    buffer_load_dwordx4 v2, s[8:11], s24 offen nt lds
    s_add_u32 m0, m0, 1056
    s_add_u32 s24, s24, 8192
    s_waitcnt vmcnt(24)
    buffer_load_dwordx4 v2, s[8:11], s24 offen nt lds
    s_add_u32 m0, m0, 1056
    s_add_u32 s24, s24, 8192
    s_waitcnt vmcnt(24)
    buffer_load_dwordx4 v2, s[8:11], s24 offen nt lds
    s_add_u32 m0, m0, 1056
    s_add_u32 s24, s24, 8192
    s_waitcnt vmcnt(24)
    buffer_load_dwordx4 v2, s[8:11], s24 offen nt lds
    s_add_u32 s70, s70, 1
    s_cmp_lt_u32 s70, 8
    s_cbranch_scc1 L_woA
    s_waitcnt vmcnt(0)
    s_barrier
    v_lshrrev_b32 v3, 2, v0
    v_mul_u32_u24 v3, 1056, v3
    v_and_b32 v4, 3, v0
    v_lshl_add_u32 v3, v4, 3, v3
    s_lshl_b32 s24, s3, 8
    v_add_u32 v3, s24, v3
    v_add_u32 v4, 67584, v3
    ds_read_b64_tr_b16 a[0:1], v3 offset:0
    ds_read_b64_tr_b16 a[2:3], v3 offset:16896
    ds_read_b64_tr_b16 a[4:5], v3 offset:33792
    ds_read_b64_tr_b16 a[6:7], v3 offset:50688
    ds_read_b64_tr_b16 a[8:9], v4 offset:0
    ds_read_b64_tr_b16 a[10:11], v4 offset:16896
    ds_read_b64_tr_b16 a[12:13], v4 offset:33792
    ds_read_b64_tr_b16 a[14:15], v4 offset:50688
    ds_read_b64_tr_b16 a[16:17], v3 offset:32
    ds_read_b64_tr_b16 a[18:19], v3 offset:16928
    ds_read_b64_tr_b16 a[20:21], v3 offset:33824
    ds_read_b64_tr_b16 a[22:23], v3 offset:50720
    ds_read_b64_tr_b16 a[24:25], v4 offset:32
    ds_read_b64_tr_b16 a[26:27], v4 offset:16928
    ds_read_b64_tr_b16 a[28:29], v4 offset:33824
    ds_read_b64_tr_b16 a[30:31], v4 offset:50720
    ds_read_b64_tr_b16 a[32:33], v3 offset:64
    ds_read_b64_tr_b16 a[34:35], v3 offset:16960
    ds_read_b64_tr_b16 a[36:37], v3 offset:33856
    ds_read_b64_tr_b16 a[38:39], v3 offset:50752
    ds_read_b64_tr_b16 a[40:41], v4 offset:64
    ds_read_b64_tr_b16 a[42:43], v4 offset:16960
    ds_read_b64_tr_b16 a[44:45], v4 offset:33856
    ds_read_b64_tr_b16 a[46:47], v4 offset:50752
    ds_read_b64_tr_b16 a[48:49], v3 offset:96
    ds_read_b64_tr_b16 a[50:51], v3 offset:16992
    ds_read_b64_tr_b16 a[52:53], v3 offset:33888
    ds_read_b64_tr_b16 a[54:55], v3 offset:50784
    ds_read_b64_tr_b16 a[56:57], v4 offset:96
    ds_read_b64_tr_b16 a[58:59], v4 offset:16992
    ds_read_b64_tr_b16 a[60:61], v4 offset:33888
    ds_read_b64_tr_b16 a[62:63], v4 offset:50784
    ds_read_b64_tr_b16 a[64:65], v3 offset:128
    ds_read_b64_tr_b16 a[66:67], v3 offset:17024
    ds_read_b64_tr_b16 a[68:69], v3 offset:33920
    ds_read_b64_tr_b16 a[70:71], v3 offset:50816
    ds_read_b64_tr_b16 a[72:73], v4 offset:128
    ds_read_b64_tr_b16 a[74:75], v4 offset:17024
    ds_read_b64_tr_b16 a[76:77], v4 offset:33920
    ds_read_b64_tr_b16 a[78:79], v4 offset:50816
    ds_read_b64_tr_b16 a[80:81], v3 offset:160
    ds_read_b64_tr_b16 a[82:83], v3 offset:17056
    ds_read_b64_tr_b16 a[84:85], v3 offset:33952
    ds_read_b64_tr_b16 a[86:87], v3 offset:50848
    ds_read_b64_tr_b16 a[88:89], v4 offset:160
    ds_read_b64_tr_b16 a[90:91], v4 offset:17056
    ds_read_b64_tr_b16 a[92:93], v4 offset:33952
    ds_read_b64_tr_b16 a[94:95], v4 offset:50848
    ds_read_b64_tr_b16 a[96:97], v3 offset:192
    ds_read_b64_tr_b16 a[98:99], v3 offset:17088
    ds_read_b64_tr_b16 a[100:101], v3 offset:33984
    ds_read_b64_tr_b16 a[102:103], v3 offset:50880
    ds_read_b64_tr_b16 a[104:105], v4 offset:192
    ds_read_b64_tr_b16 a[106:107], v4 offset:17088
    ds_read_b64_tr_b16 a[108:109], v4 offset:33984
    ds_read_b64_tr_b16 a[110:111], v4 offset:50880
    ds_read_b64_tr_b16 a[112:113], v3 offset:224
    ds_read_b64_tr_b16 a[114:115], v3 offset:17120
    ds_read_b64_tr_b16 a[116:117], v3 offset:34016
    ds_read_b64_tr_b16 a[118:119], v3 offset:50912
    ds_read_b64_tr_b16 a[120:121], v4 offset:224
    ds_read_b64_tr_b16 a[122:123], v4 offset:17120
    ds_read_b64_tr_b16 a[124:125], v4 offset:34016
    ds_read_b64_tr_b16 a[126:127], v4 offset:50912
    s_waitcnt lgkmcnt(0)
    s_cmp_lg_u32 s3, 0
    s_cbranch_scc1 L_awx12
    s_mov_b32 s24, 262144
    s_mov_b64 exec, 1
L_aw13:
    buffer_load_dword v1, off, s[12:15], s73 offset:0 sc1
    s_waitcnt vmcnt(0)
    v_readfirstlane_b32 s25, v1
    s_nop 0
    s_cmp_eq_u32 s25, 1
    s_cbranch_scc1 L_awx12
    s_sleep 4
    s_sub_u32 s24, s24, 1
    s_cmp_lg_u32 s24, 0
    s_cbranch_scc1 L_aw13
L_awx12:
    s_mov_b64 exec, -1
    s_barrier
    s_cmp_lg_u32 s3, 0
    s_cbranch_scc1 L_xi14
    s_and_b32 s24, s74, 7
    s_lshl_b32 s24, s24, 5
    s_lshr_b32 s25, s74, 3
    s_add_u32 s24, s24, s25
    s_lshl_b32 s24, s24, 2
    s_add_u32 s24, s24, 0x1d8000
    s_getreg_b32 s25, hwreg(HW_REG_XCC_ID, 0, 4)
    s_mov_b64 exec, 1
    v_mov_b32 v3, s25
    buffer_store_dword v3, off, s[12:15], s24 sc1
    s_mov_b64 exec, -1
L_xi14:
    s_cmp_lg_u32 s3, 0
    s_cbranch_scc1 L_awx15
    s_mov_b32 s24, 262144
    s_mov_b64 exec, 1
L_aw16:
    buffer_load_dword v1, off, s[12:15], s73 offset:4 sc1
    s_waitcnt vmcnt(0)
    v_readfirstlane_b32 s25, v1
    s_nop 0
    s_cmp_eq_u32 s25, 1
    s_cbranch_scc1 L_awx15
    s_sleep 4
    s_sub_u32 s24, s24, 1
    s_cmp_lg_u32 s24, 0
    s_cbranch_scc1 L_aw16
L_awx15:
    s_mov_b64 exec, -1
    s_barrier
    s_lshl_b32 s24, s3, 10
    s_lshl_b32 s25, s26, 3
    s_add_u32 s25, s25, s24
    s_add_u32 s25, s25, 0x120000
    v_and_b32 v3, 3, v0
    v_lshlrev_b32 v3, 8, v3
    buffer_load_dwordx2 v[4:5], v3, s[12:15], s25 offen sc1
    s_lshl_b32 s24, s3, 18
    s_lshl_b32 s25, s26, 11
    s_add_u32 s24, s24, s25
    s_add_u32 s24, s24, 0x400000
    buffer_load_dwordx4 v[72:75], v2, s[12:15], s24 offen sc1 nt
    s_add_u32 s24, s24, 65536
    buffer_load_dwordx4 v[76:79], v2, s[12:15], s24 offen sc1 nt
    s_add_u32 s24, s24, 65536
    buffer_load_dwordx4 v[80:83], v2, s[12:15], s24 offen sc1 nt
    s_add_u32 s24, s24, 65536
    buffer_load_dwordx4 v[84:87], v2, s[12:15], s24 offen sc1 nt
    s_add_u32 s24, s24, 65536
    s_waitcnt vmcnt(4)
    v_mov_b32 v6, v4
    s_nop 1
    v_max_f32_dpp v6, v6, v6 row_ror:2 row_mask:0xf bank_mask:0xf
    s_nop 1
    v_max_f32_dpp v6, v6, v6 row_ror:1 row_mask:0xf bank_mask:0xf
    v_sub_f32 v4, v4, v6
    v_exp_f32 v4, v4
    s_nop 0
    v_mul_f32 v5, v4, v5
    s_nop 1
    v_add_f32_dpp v5, v5, v5 row_ror:2 row_mask:0xf bank_mask:0xf
    s_nop 1
    v_add_f32_dpp v5, v5, v5 row_ror:1 row_mask:0xf bank_mask:0xf
    v_rcp_f32 v5, v5
    s_nop 0
    v_mul_f32 v4, v4, v5
    s_nop 0
    v_readlane_b32 s24, v4, 0
    s_waitcnt vmcnt(3)
    v_lshlrev_b32 v5, 16, v72
    v_and_b32 v6, 0xffff0000, v72
    v_mul_f32 v104, s24, v5
    v_mul_f32 v105, s24, v6
    v_lshlrev_b32 v5, 16, v73
    v_and_b32 v6, 0xffff0000, v73
    v_mul_f32 v106, s24, v5
    v_mul_f32 v107, s24, v6
    v_lshlrev_b32 v5, 16, v74
    v_and_b32 v6, 0xffff0000, v74
    v_mul_f32 v108, s24, v5
    v_mul_f32 v109, s24, v6
    v_lshlrev_b32 v5, 16, v75
    v_and_b32 v6, 0xffff0000, v75
    v_mul_f32 v110, s24, v5
    v_mul_f32 v111, s24, v6
    v_readlane_b32 s24, v4, 1
    s_waitcnt vmcnt(2)
    v_lshlrev_b32 v5, 16, v76
    v_and_b32 v6, 0xffff0000, v76
    v_fmac_f32 v104, s24, v5
    v_fmac_f32 v105, s24, v6
    v_lshlrev_b32 v5, 16, v77
    v_and_b32 v6, 0xffff0000, v77
    v_fmac_f32 v106, s24, v5
    v_fmac_f32 v107, s24, v6
    v_lshlrev_b32 v5, 16, v78
    v_and_b32 v6, 0xffff0000, v78
    v_fmac_f32 v108, s24, v5
    v_fmac_f32 v109, s24, v6
    v_lshlrev_b32 v5, 16, v79
    v_and_b32 v6, 0xffff0000, v79
    v_fmac_f32 v110, s24, v5
    v_fmac_f32 v111, s24, v6
    v_readlane_b32 s24, v4, 2
    s_waitcnt vmcnt(1)
    v_lshlrev_b32 v5, 16, v80
    v_and_b32 v6, 0xffff0000, v80
    v_fmac_f32 v104, s24, v5
    v_fmac_f32 v105, s24, v6
    v_lshlrev_b32 v5, 16, v81
    v_and_b32 v6, 0xffff0000, v81
    v_fmac_f32 v106, s24, v5
    v_fmac_f32 v107, s24, v6
    v_lshlrev_b32 v5, 16, v82
    v_and_b32 v6, 0xffff0000, v82
    v_fmac_f32 v108, s24, v5
    v_fmac_f32 v109, s24, v6
    v_lshlrev_b32 v5, 16, v83
    v_and_b32 v6, 0xffff0000, v83
    v_fmac_f32 v110, s24, v5
    v_fmac_f32 v111, s24, v6
    v_readlane_b32 s24, v4, 3
    s_waitcnt vmcnt(0)
    v_lshlrev_b32 v5, 16, v84
    v_and_b32 v6, 0xffff0000, v84
    v_fmac_f32 v104, s24, v5
    v_fmac_f32 v105, s24, v6
    v_lshlrev_b32 v5, 16, v85
    v_and_b32 v6, 0xffff0000, v85
    v_fmac_f32 v106, s24, v5
    v_fmac_f32 v107, s24, v6
    v_lshlrev_b32 v5, 16, v86
    v_and_b32 v6, 0xffff0000, v86
    v_fmac_f32 v108, s24, v5
    v_fmac_f32 v109, s24, v6
    v_lshlrev_b32 v5, 16, v87
    v_and_b32 v6, 0xffff0000, v87
    v_fmac_f32 v110, s24, v5
    v_fmac_f32 v111, s24, v6
    v_cvt_pk_bf16_f32 v4, v104, v105
    v_cvt_pk_bf16_f32 v5, v106, v107
    v_cvt_pk_bf16_f32 v6, v108, v109
    v_cvt_pk_bf16_f32 v7, v110, v111
    s_lshl_b32 s24, s3, 10
    s_add_u32 s24, s24, 145408
    v_add_u32 v3, s24, v2
    ds_write_b128 v3, v[4:7]
    s_lshl_b32 s24, s3, 8
    s_add_u32 s24, s24, 145408
    v_add_u32 v3, s24, v19
    s_waitcnt lgkmcnt(0)
    s_barrier
    ds_read_b128 v[32:35], v3 offset:0
    ds_read_b128 v[36:39], v3 offset:16
    ds_read_b128 v[40:43], v3 offset:32
    ds_read_b128 v[44:47], v3 offset:48
    ds_read_b128 v[48:51], v3 offset:2048
    ds_read_b128 v[52:55], v3 offset:2064
    ds_read_b128 v[56:59], v3 offset:2080
    ds_read_b128 v[60:63], v3 offset:2096
    s_waitcnt lgkmcnt(0)
    v_perm_b32 v8, v32, v32, v24
    v_perm_b32 v9, v32, v32, v25
    v_perm_b32 v10, v32, v32, v26
    v_perm_b32 v11, v32, v32, v27
    v_perm_b32 v4, v48, v48, v24
    v_perm_b32 v5, v48, v48, v25
    v_perm_b32 v6, v48, v48, v26
    v_perm_b32 v7, v48, v48, v27
    v_mfma_f32_16x16x32_bf16 v[12:15], v[128:131], v[8:11], 0
    s_nop 0
    v_mfma_f32_16x16x32_bf16 v[68:71], v[128:131], v[4:7], 0
    v_perm_b32 v8, v32, v32, v28
    v_perm_b32 v9, v32, v32, v29
    v_perm_b32 v10, v32, v32, v30
    v_perm_b32 v11, v32, v32, v31
    v_perm_b32 v4, v48, v48, v28
    v_perm_b32 v5, v48, v48, v29
    v_perm_b32 v6, v48, v48, v30
    v_perm_b32 v7, v48, v48, v31
    v_mfma_f32_16x16x32_bf16 v[12:15], v[132:135], v[8:11], v[12:15]
    s_nop 0
    v_mfma_f32_16x16x32_bf16 v[68:71], v[132:135], v[4:7], v[68:71]
    v_perm_b32 v8, v33, v33, v24
    v_perm_b32 v9, v33, v33, v25
    v_perm_b32 v10, v33, v33, v26
    v_perm_b32 v11, v33, v33, v27
    v_perm_b32 v4, v49, v49, v24
    v_perm_b32 v5, v49, v49, v25
    v_perm_b32 v6, v49, v49, v26
    v_perm_b32 v7, v49, v49, v27
    v_mfma_f32_16x16x32_bf16 v[12:15], v[136:139], v[8:11], v[12:15]
    s_nop 0
    v_mfma_f32_16x16x32_bf16 v[68:71], v[136:139], v[4:7], v[68:71]
    v_perm_b32 v8, v33, v33, v28
    v_perm_b32 v9, v33, v33, v29
    v_perm_b32 v10, v33, v33, v30
    v_perm_b32 v11, v33, v33, v31
    v_perm_b32 v4, v49, v49, v28
    v_perm_b32 v5, v49, v49, v29
    v_perm_b32 v6, v49, v49, v30
    v_perm_b32 v7, v49, v49, v31
    v_mfma_f32_16x16x32_bf16 v[12:15], v[140:143], v[8:11], v[12:15]
    s_nop 0
    v_mfma_f32_16x16x32_bf16 v[68:71], v[140:143], v[4:7], v[68:71]
    v_perm_b32 v8, v34, v34, v24
    v_perm_b32 v9, v34, v34, v25
    v_perm_b32 v10, v34, v34, v26
    v_perm_b32 v11, v34, v34, v27
    v_perm_b32 v4, v50, v50, v24
    v_perm_b32 v5, v50, v50, v25
    v_perm_b32 v6, v50, v50, v26
    v_perm_b32 v7, v50, v50, v27
    v_mfma_f32_16x16x32_bf16 v[12:15], v[144:147], v[8:11], v[12:15]
    s_nop 0
    v_mfma_f32_16x16x32_bf16 v[68:71], v[144:147], v[4:7], v[68:71]
    v_perm_b32 v8, v34, v34, v28
    v_perm_b32 v9, v34, v34, v29
    v_perm_b32 v10, v34, v34, v30
    v_perm_b32 v11, v34, v34, v31
    v_perm_b32 v4, v50, v50, v28
    v_perm_b32 v5, v50, v50, v29
    v_perm_b32 v6, v50, v50, v30
    v_perm_b32 v7, v50, v50, v31
    v_mfma_f32_16x16x32_bf16 v[12:15], v[148:151], v[8:11], v[12:15]
    s_nop 0
    v_mfma_f32_16x16x32_bf16 v[68:71], v[148:151], v[4:7], v[68:71]
    v_perm_b32 v8, v35, v35, v24
    v_perm_b32 v9, v35, v35, v25
    v_perm_b32 v10, v35, v35, v26
    v_perm_b32 v11, v35, v35, v27
    v_perm_b32 v4, v51, v51, v24
    v_perm_b32 v5, v51, v51, v25
    v_perm_b32 v6, v51, v51, v26
    v_perm_b32 v7, v51, v51, v27
    v_mfma_f32_16x16x32_bf16 v[12:15], v[152:155], v[8:11], v[12:15]
    s_nop 0
    v_mfma_f32_16x16x32_bf16 v[68:71], v[152:155], v[4:7], v[68:71]
    v_perm_b32 v8, v35, v35, v28
    v_perm_b32 v9, v35, v35, v29
    v_perm_b32 v10, v35, v35, v30
    v_perm_b32 v11, v35, v35, v31
    v_perm_b32 v4, v51, v51, v28
    v_perm_b32 v5, v51, v51, v29
    v_perm_b32 v6, v51, v51, v30
    v_perm_b32 v7, v51, v51, v31
    v_mfma_f32_16x16x32_bf16 v[12:15], v[156:159], v[8:11], v[12:15]
    s_nop 0
    v_mfma_f32_16x16x32_bf16 v[68:71], v[156:159], v[4:7], v[68:71]
    v_perm_b32 v8, v36, v36, v24
    v_perm_b32 v9, v36, v36, v25
    v_perm_b32 v10, v36, v36, v26
    v_perm_b32 v11, v36, v36, v27
    v_perm_b32 v4, v52, v52, v24
    v_perm_b32 v5, v52, v52, v25
    v_perm_b32 v6, v52, v52, v26
    v_perm_b32 v7, v52, v52, v27
    v_mfma_f32_16x16x32_bf16 v[12:15], v[160:163], v[8:11], v[12:15]
    s_nop 0
    v_mfma_f32_16x16x32_bf16 v[68:71], v[160:163], v[4:7], v[68:71]
    v_perm_b32 v8, v36, v36, v28
    v_perm_b32 v9, v36, v36, v29
    v_perm_b32 v10, v36, v36, v30
    v_perm_b32 v11, v36, v36, v31
    v_perm_b32 v4, v52, v52, v28
    v_perm_b32 v5, v52, v52, v29
    v_perm_b32 v6, v52, v52, v30
    v_perm_b32 v7, v52, v52, v31
    v_mfma_f32_16x16x32_bf16 v[12:15], v[164:167], v[8:11], v[12:15]
    s_nop 0
    v_mfma_f32_16x16x32_bf16 v[68:71], v[164:167], v[4:7], v[68:71]
    v_perm_b32 v8, v37, v37, v24
    v_perm_b32 v9, v37, v37, v25
    v_perm_b32 v10, v37, v37, v26
    v_perm_b32 v11, v37, v37, v27
    v_perm_b32 v4, v53, v53, v24
    v_perm_b32 v5, v53, v53, v25
    v_perm_b32 v6, v53, v53, v26
    v_perm_b32 v7, v53, v53, v27
    v_mfma_f32_16x16x32_bf16 v[12:15], v[168:171], v[8:11], v[12:15]
    s_nop 0
    v_mfma_f32_16x16x32_bf16 v[68:71], v[168:171], v[4:7], v[68:71]
    v_perm_b32 v8, v37, v37, v28
    v_perm_b32 v9, v37, v37, v29
    v_perm_b32 v10, v37, v37, v30
    v_perm_b32 v11, v37, v37, v31
    v_perm_b32 v4, v53, v53, v28
    v_perm_b32 v5, v53, v53, v29
    v_perm_b32 v6, v53, v53, v30
    v_perm_b32 v7, v53, v53, v31
    v_mfma_f32_16x16x32_bf16 v[12:15], v[172:175], v[8:11], v[12:15]
    s_nop 0
    v_mfma_f32_16x16x32_bf16 v[68:71], v[172:175], v[4:7], v[68:71]
    v_perm_b32 v8, v38, v38, v24
    v_perm_b32 v9, v38, v38, v25
    v_perm_b32 v10, v38, v38, v26
    v_perm_b32 v11, v38, v38, v27
    v_perm_b32 v4, v54, v54, v24
    v_perm_b32 v5, v54, v54, v25
    v_perm_b32 v6, v54, v54, v26
    v_perm_b32 v7, v54, v54, v27
    v_mfma_f32_16x16x32_bf16 v[12:15], v[176:179], v[8:11], v[12:15]
    s_nop 0
    v_mfma_f32_16x16x32_bf16 v[68:71], v[176:179], v[4:7], v[68:71]
    v_perm_b32 v8, v38, v38, v28
    v_perm_b32 v9, v38, v38, v29
    v_perm_b32 v10, v38, v38, v30
    v_perm_b32 v11, v38, v38, v31
    v_perm_b32 v4, v54, v54, v28
    v_perm_b32 v5, v54, v54, v29
    v_perm_b32 v6, v54, v54, v30
    v_perm_b32 v7, v54, v54, v31
    v_mfma_f32_16x16x32_bf16 v[12:15], v[180:183], v[8:11], v[12:15]
    s_nop 0
    v_mfma_f32_16x16x32_bf16 v[68:71], v[180:183], v[4:7], v[68:71]
    v_perm_b32 v8, v39, v39, v24
    v_perm_b32 v9, v39, v39, v25
    v_perm_b32 v10, v39, v39, v26
    v_perm_b32 v11, v39, v39, v27
    v_perm_b32 v4, v55, v55, v24
    v_perm_b32 v5, v55, v55, v25
    v_perm_b32 v6, v55, v55, v26
    v_perm_b32 v7, v55, v55, v27
    v_mfma_f32_16x16x32_bf16 v[12:15], v[184:187], v[8:11], v[12:15]
    s_nop 0
    v_mfma_f32_16x16x32_bf16 v[68:71], v[184:187], v[4:7], v[68:71]
    v_perm_b32 v8, v39, v39, v28
    v_perm_b32 v9, v39, v39, v29
    v_perm_b32 v10, v39, v39, v30
    v_perm_b32 v11, v39, v39, v31
    v_perm_b32 v4, v55, v55, v28
    v_perm_b32 v5, v55, v55, v29
    v_perm_b32 v6, v55, v55, v30
    v_perm_b32 v7, v55, v55, v31
    v_mfma_f32_16x16x32_bf16 v[12:15], v[188:191], v[8:11], v[12:15]
    s_nop 0
    v_mfma_f32_16x16x32_bf16 v[68:71], v[188:191], v[4:7], v[68:71]
    v_perm_b32 v8, v40, v40, v24
    v_perm_b32 v9, v40, v40, v25
    v_perm_b32 v10, v40, v40, v26
    v_perm_b32 v11, v40, v40, v27
    v_perm_b32 v4, v56, v56, v24
    v_perm_b32 v5, v56, v56, v25
    v_perm_b32 v6, v56, v56, v26
    v_perm_b32 v7, v56, v56, v27
    v_mfma_f32_16x16x32_bf16 v[12:15], v[192:195], v[8:11], v[12:15]
    s_nop 0
    v_mfma_f32_16x16x32_bf16 v[68:71], v[192:195], v[4:7], v[68:71]
    v_perm_b32 v8, v40, v40, v28
    v_perm_b32 v9, v40, v40, v29
    v_perm_b32 v10, v40, v40, v30
    v_perm_b32 v11, v40, v40, v31
    v_perm_b32 v4, v56, v56, v28
    v_perm_b32 v5, v56, v56, v29
    v_perm_b32 v6, v56, v56, v30
    v_perm_b32 v7, v56, v56, v31
    v_mfma_f32_16x16x32_bf16 v[12:15], v[196:199], v[8:11], v[12:15]
    s_nop 0
    v_mfma_f32_16x16x32_bf16 v[68:71], v[196:199], v[4:7], v[68:71]
    v_perm_b32 v8, v41, v41, v24
    v_perm_b32 v9, v41, v41, v25
    v_perm_b32 v10, v41, v41, v26
    v_perm_b32 v11, v41, v41, v27
    v_perm_b32 v4, v57, v57, v24
    v_perm_b32 v5, v57, v57, v25
    v_perm_b32 v6, v57, v57, v26
    v_perm_b32 v7, v57, v57, v27
    v_mfma_f32_16x16x32_bf16 v[12:15], v[200:203], v[8:11], v[12:15]
    s_nop 0
    v_mfma_f32_16x16x32_bf16 v[68:71], v[200:203], v[4:7], v[68:71]
    v_perm_b32 v8, v41, v41, v28
    v_perm_b32 v9, v41, v41, v29
    v_perm_b32 v10, v41, v41, v30
    v_perm_b32 v11, v41, v41, v31
    v_perm_b32 v4, v57, v57, v28
    v_perm_b32 v5, v57, v57, v29
    v_perm_b32 v6, v57, v57, v30
    v_perm_b32 v7, v57, v57, v31
    v_mfma_f32_16x16x32_bf16 v[12:15], v[204:207], v[8:11], v[12:15]
    s_nop 0
    v_mfma_f32_16x16x32_bf16 v[68:71], v[204:207], v[4:7], v[68:71]
    v_perm_b32 v8, v42, v42, v24
    v_perm_b32 v9, v42, v42, v25
    v_perm_b32 v10, v42, v42, v26
    v_perm_b32 v11, v42, v42, v27
    v_perm_b32 v4, v58, v58, v24
    v_perm_b32 v5, v58, v58, v25
    v_perm_b32 v6, v58, v58, v26
    v_perm_b32 v7, v58, v58, v27
    v_mfma_f32_16x16x32_bf16 v[12:15], v[208:211], v[8:11], v[12:15]
    s_nop 0
    v_mfma_f32_16x16x32_bf16 v[68:71], v[208:211], v[4:7], v[68:71]
    v_perm_b32 v8, v42, v42, v28
    v_perm_b32 v9, v42, v42, v29
    v_perm_b32 v10, v42, v42, v30
    v_perm_b32 v11, v42, v42, v31
    v_perm_b32 v4, v58, v58, v28
    v_perm_b32 v5, v58, v58, v29
    v_perm_b32 v6, v58, v58, v30
    v_perm_b32 v7, v58, v58, v31
    v_mfma_f32_16x16x32_bf16 v[12:15], v[212:215], v[8:11], v[12:15]
    s_nop 0
    v_mfma_f32_16x16x32_bf16 v[68:71], v[212:215], v[4:7], v[68:71]
    v_perm_b32 v8, v43, v43, v24
    v_perm_b32 v9, v43, v43, v25
    v_perm_b32 v10, v43, v43, v26
    v_perm_b32 v11, v43, v43, v27
    v_perm_b32 v4, v59, v59, v24
    v_perm_b32 v5, v59, v59, v25
    v_perm_b32 v6, v59, v59, v26
    v_perm_b32 v7, v59, v59, v27
    v_mfma_f32_16x16x32_bf16 v[12:15], v[216:219], v[8:11], v[12:15]
    s_nop 0
    v_mfma_f32_16x16x32_bf16 v[68:71], v[216:219], v[4:7], v[68:71]
    v_perm_b32 v8, v43, v43, v28
    v_perm_b32 v9, v43, v43, v29
    v_perm_b32 v10, v43, v43, v30
    v_perm_b32 v11, v43, v43, v31
    v_perm_b32 v4, v59, v59, v28
    v_perm_b32 v5, v59, v59, v29
    v_perm_b32 v6, v59, v59, v30
    v_perm_b32 v7, v59, v59, v31
    v_mfma_f32_16x16x32_bf16 v[12:15], v[220:223], v[8:11], v[12:15]
    s_nop 0
    v_mfma_f32_16x16x32_bf16 v[68:71], v[220:223], v[4:7], v[68:71]
    v_perm_b32 v8, v44, v44, v24
    v_perm_b32 v9, v44, v44, v25
    v_perm_b32 v10, v44, v44, v26
    v_perm_b32 v11, v44, v44, v27
    v_perm_b32 v4, v60, v60, v24
    v_perm_b32 v5, v60, v60, v25
    v_perm_b32 v6, v60, v60, v26
    v_perm_b32 v7, v60, v60, v27
    v_mfma_f32_16x16x32_bf16 v[12:15], v[224:227], v[8:11], v[12:15]
    s_nop 0
    v_mfma_f32_16x16x32_bf16 v[68:71], v[224:227], v[4:7], v[68:71]
    v_perm_b32 v8, v44, v44, v28
    v_perm_b32 v9, v44, v44, v29
    v_perm_b32 v10, v44, v44, v30
    v_perm_b32 v11, v44, v44, v31
    v_perm_b32 v4, v60, v60, v28
    v_perm_b32 v5, v60, v60, v29
    v_perm_b32 v6, v60, v60, v30
    v_perm_b32 v7, v60, v60, v31
    v_mfma_f32_16x16x32_bf16 v[12:15], v[228:231], v[8:11], v[12:15]
    s_nop 0
    v_mfma_f32_16x16x32_bf16 v[68:71], v[228:231], v[4:7], v[68:71]
    v_perm_b32 v8, v45, v45, v24
    v_perm_b32 v9, v45, v45, v25
    v_perm_b32 v10, v45, v45, v26
    v_perm_b32 v11, v45, v45, v27
    v_perm_b32 v4, v61, v61, v24
    v_perm_b32 v5, v61, v61, v25
    v_perm_b32 v6, v61, v61, v26
    v_perm_b32 v7, v61, v61, v27
    v_mfma_f32_16x16x32_bf16 v[12:15], v[232:235], v[8:11], v[12:15]
    s_nop 0
    v_mfma_f32_16x16x32_bf16 v[68:71], v[232:235], v[4:7], v[68:71]
    v_perm_b32 v8, v45, v45, v28
    v_perm_b32 v9, v45, v45, v29
    v_perm_b32 v10, v45, v45, v30
    v_perm_b32 v11, v45, v45, v31
    v_perm_b32 v4, v61, v61, v28
    v_perm_b32 v5, v61, v61, v29
    v_perm_b32 v6, v61, v61, v30
    v_perm_b32 v7, v61, v61, v31
    v_mfma_f32_16x16x32_bf16 v[12:15], v[236:239], v[8:11], v[12:15]
    s_nop 0
    v_mfma_f32_16x16x32_bf16 v[68:71], v[236:239], v[4:7], v[68:71]
    v_perm_b32 v8, v46, v46, v24
    v_perm_b32 v9, v46, v46, v25
    v_perm_b32 v10, v46, v46, v26
    v_perm_b32 v11, v46, v46, v27
    v_perm_b32 v4, v62, v62, v24
    v_perm_b32 v5, v62, v62, v25
    v_perm_b32 v6, v62, v62, v26
    v_perm_b32 v7, v62, v62, v27
    v_mfma_f32_16x16x32_bf16 v[12:15], v[240:243], v[8:11], v[12:15]
    s_nop 0
    v_mfma_f32_16x16x32_bf16 v[68:71], v[240:243], v[4:7], v[68:71]
    v_perm_b32 v8, v46, v46, v28
    v_perm_b32 v9, v46, v46, v29
    v_perm_b32 v10, v46, v46, v30
    v_perm_b32 v11, v46, v46, v31
    v_perm_b32 v4, v62, v62, v28
    v_perm_b32 v5, v62, v62, v29
    v_perm_b32 v6, v62, v62, v30
    v_perm_b32 v7, v62, v62, v31
    v_mfma_f32_16x16x32_bf16 v[12:15], v[244:247], v[8:11], v[12:15]
    s_nop 0
    v_mfma_f32_16x16x32_bf16 v[68:71], v[244:247], v[4:7], v[68:71]
    v_perm_b32 v8, v47, v47, v24
    v_perm_b32 v9, v47, v47, v25
    v_perm_b32 v10, v47, v47, v26
    v_perm_b32 v11, v47, v47, v27
    v_perm_b32 v4, v63, v63, v24
    v_perm_b32 v5, v63, v63, v25
    v_perm_b32 v6, v63, v63, v26
    v_perm_b32 v7, v63, v63, v27
    v_mfma_f32_16x16x32_bf16 v[12:15], v[248:251], v[8:11], v[12:15]
    s_nop 0
    v_mfma_f32_16x16x32_bf16 v[68:71], v[248:251], v[4:7], v[68:71]
    v_perm_b32 v8, v47, v47, v28
    v_perm_b32 v9, v47, v47, v29
    v_perm_b32 v10, v47, v47, v30
    v_perm_b32 v11, v47, v47, v31
    v_perm_b32 v4, v63, v63, v28
    v_perm_b32 v5, v63, v63, v29
    v_perm_b32 v6, v63, v63, v30
    v_perm_b32 v7, v63, v63, v31
    v_mfma_f32_16x16x32_bf16 v[12:15], v[252:255], v[8:11], v[12:15]
    s_nop 0
    v_mfma_f32_16x16x32_bf16 v[68:71], v[252:255], v[4:7], v[68:71]
    v_lshrrev_b32 v3, 4, v0
    v_lshlrev_b32 v3, 7, v3
    v_and_b32 v4, 7, v0
    v_lshl_add_u32 v3, v4, 4, v3
    v_bfe_u32 v4, v0, 3, 1
    v_lshl_add_u32 v3, v4, 9, v3
    s_lshl_b32 s24, s3, 11
    s_add_u32 s24, s24, 135168
    v_add_u32 v3, s24, v3
    ds_write_b128 v3, v[12:15]
    ds_write_b128 v3, v[68:71] offset:1024
    s_waitcnt lgkmcnt(0)
    s_barrier
    v_and_b32 v5, 31, v0
    s_lshl_b32 s24, s3, 9
    s_add_u32 s24, s24, 135168
    v_lshl_add_u32 v3, v5, 4, s24
    ds_read_b128 v[72:75], v3 offset:0
    ds_read_b128 v[76:79], v3 offset:2048
    ds_read_b128 v[80:83], v3 offset:4096
    ds_read_b128 v[84:87], v3 offset:6144
    s_mul_i32 s24, s3, 320
    s_add_u32 s24, s24, 143360
    v_lshl_add_u32 v5, v5, 3, s24
    s_waitcnt lgkmcnt(0)
    v_add_f32 v72, v72, v76
    v_add_f32 v73, v73, v77
    v_add_f32 v74, v74, v78
    v_add_f32 v75, v75, v79
    v_add_f32 v72, v72, v80
    v_add_f32 v73, v73, v81
    v_add_f32 v74, v74, v82
    v_add_f32 v75, v75, v83
    v_add_f32 v72, v72, v84
    v_add_f32 v73, v73, v85
    v_add_f32 v74, v74, v86
    v_add_f32 v75, v75, v87
    v_cvt_pk_bf16_f32 v6, v72, v73
    v_cvt_pk_bf16_f32 v7, v74, v75
    ds_write_b64 v5, v[6:7]
    v_lshrrev_b32 v3, 4, v0
    v_and_b32 v4, 3, v0
    v_mul_u32_u24 v5, 320, v4
    v_lshl_add_u32 v5, v3, 4, v5
    v_add_u32 v5, 143360, v5
    s_waitcnt lgkmcnt(0)
    s_barrier
    ds_read_b128 v[32:35], v5 offset:0
    ds_read_b128 v[36:39], v5 offset:64
    ds_read_b128 v[40:43], v5 offset:128
    ds_read_b128 v[44:47], v5 offset:192
    s_waitcnt lgkmcnt(3)
    v_mfma_f32_16x16x32_bf16 v[72:75], v[32:35], a[0:3], 0
    s_waitcnt lgkmcnt(2)
    v_mfma_f32_16x16x32_bf16 v[72:75], v[36:39], a[4:7], v[72:75]
    s_waitcnt lgkmcnt(1)
    v_mfma_f32_16x16x32_bf16 v[72:75], v[40:43], a[8:11], v[72:75]
    s_waitcnt lgkmcnt(0)
    v_mfma_f32_16x16x32_bf16 v[72:75], v[44:47], a[12:15], v[72:75]
    v_mfma_f32_16x16x32_bf16 v[76:79], v[32:35], a[16:19], 0
    v_mfma_f32_16x16x32_bf16 v[76:79], v[36:39], a[20:23], v[76:79]
    v_mfma_f32_16x16x32_bf16 v[76:79], v[40:43], a[24:27], v[76:79]
    v_mfma_f32_16x16x32_bf16 v[76:79], v[44:47], a[28:31], v[76:79]
    v_mfma_f32_16x16x32_bf16 v[80:83], v[32:35], a[32:35], 0
    v_mfma_f32_16x16x32_bf16 v[80:83], v[36:39], a[36:39], v[80:83]
    v_mfma_f32_16x16x32_bf16 v[80:83], v[40:43], a[40:43], v[80:83]
    v_mfma_f32_16x16x32_bf16 v[80:83], v[44:47], a[44:47], v[80:83]
    v_mov_b32_dpp v4, v72 quad_perm:[0,1,2,3] row_mask:0x1 bank_mask:0xf
    v_mov_b32_dpp v5, v73 quad_perm:[0,1,2,3] row_mask:0x1 bank_mask:0xf
    v_mov_b32_dpp v6, v74 quad_perm:[0,1,2,3] row_mask:0x1 bank_mask:0xf
    v_mov_b32_dpp v7, v75 quad_perm:[0,1,2,3] row_mask:0x1 bank_mask:0xf
    v_mfma_f32_16x16x32_bf16 v[84:87], v[32:35], a[48:51], 0
    v_mfma_f32_16x16x32_bf16 v[84:87], v[36:39], a[52:55], v[84:87]
    v_mfma_f32_16x16x32_bf16 v[84:87], v[40:43], a[56:59], v[84:87]
    v_mfma_f32_16x16x32_bf16 v[84:87], v[44:47], a[60:63], v[84:87]
    v_mov_b32_dpp v4, v76 quad_perm:[0,1,2,3] row_mask:0x2 bank_mask:0xf
    v_mov_b32_dpp v5, v77 quad_perm:[0,1,2,3] row_mask:0x2 bank_mask:0xf
    v_mov_b32_dpp v6, v78 quad_perm:[0,1,2,3] row_mask:0x2 bank_mask:0xf
    v_mov_b32_dpp v7, v79 quad_perm:[0,1,2,3] row_mask:0x2 bank_mask:0xf
    v_mfma_f32_16x16x32_bf16 v[88:91], v[32:35], a[64:67], 0
    v_mfma_f32_16x16x32_bf16 v[88:91], v[36:39], a[68:71], v[88:91]
    v_mfma_f32_16x16x32_bf16 v[88:91], v[40:43], a[72:75], v[88:91]
    v_mfma_f32_16x16x32_bf16 v[88:91], v[44:47], a[76:79], v[88:91]
    v_mov_b32_dpp v4, v80 quad_perm:[0,1,2,3] row_mask:0x4 bank_mask:0xf
    v_mov_b32_dpp v5, v81 quad_perm:[0,1,2,3] row_mask:0x4 bank_mask:0xf
    v_mov_b32_dpp v6, v82 quad_perm:[0,1,2,3] row_mask:0x4 bank_mask:0xf
    v_mov_b32_dpp v7, v83 quad_perm:[0,1,2,3] row_mask:0x4 bank_mask:0xf
    v_mfma_f32_16x16x32_bf16 v[92:95], v[32:35], a[80:83], 0
    v_mfma_f32_16x16x32_bf16 v[92:95], v[36:39], a[84:87], v[92:95]
    v_mfma_f32_16x16x32_bf16 v[92:95], v[40:43], a[88:91], v[92:95]
    v_mfma_f32_16x16x32_bf16 v[92:95], v[44:47], a[92:95], v[92:95]
    v_mov_b32_dpp v4, v84 quad_perm:[0,1,2,3] row_mask:0x8 bank_mask:0xf
    v_mov_b32_dpp v5, v85 quad_perm:[0,1,2,3] row_mask:0x8 bank_mask:0xf
    v_mov_b32_dpp v6, v86 quad_perm:[0,1,2,3] row_mask:0x8 bank_mask:0xf
    v_mov_b32_dpp v7, v87 quad_perm:[0,1,2,3] row_mask:0x8 bank_mask:0xf
    v_mfma_f32_16x16x32_bf16 v[96:99], v[32:35], a[96:99], 0
    v_mfma_f32_16x16x32_bf16 v[96:99], v[36:39], a[100:103], v[96:99]
    v_mfma_f32_16x16x32_bf16 v[96:99], v[40:43], a[104:107], v[96:99]
    v_mfma_f32_16x16x32_bf16 v[96:99], v[44:47], a[108:111], v[96:99]
    v_mov_b32_dpp v8, v88 quad_perm:[0,1,2,3] row_mask:0x1 bank_mask:0xf
    v_mov_b32_dpp v9, v89 quad_perm:[0,1,2,3] row_mask:0x1 bank_mask:0xf
    v_mov_b32_dpp v10, v90 quad_perm:[0,1,2,3] row_mask:0x1 bank_mask:0xf
    v_mov_b32_dpp v11, v91 quad_perm:[0,1,2,3] row_mask:0x1 bank_mask:0xf
    v_mfma_f32_16x16x32_bf16 v[100:103], v[32:35], a[112:115], 0
    v_mfma_f32_16x16x32_bf16 v[100:103], v[36:39], a[116:119], v[100:103]
    v_mfma_f32_16x16x32_bf16 v[100:103], v[40:43], a[120:123], v[100:103]
    v_mfma_f32_16x16x32_bf16 v[100:103], v[44:47], a[124:127], v[100:103]
    v_mov_b32_dpp v8, v92 quad_perm:[0,1,2,3] row_mask:0x2 bank_mask:0xf
    v_mov_b32_dpp v9, v93 quad_perm:[0,1,2,3] row_mask:0x2 bank_mask:0xf
    v_mov_b32_dpp v10, v94 quad_perm:[0,1,2,3] row_mask:0x2 bank_mask:0xf
    v_mov_b32_dpp v11, v95 quad_perm:[0,1,2,3] row_mask:0x2 bank_mask:0xf
    v_mov_b32_dpp v8, v96 quad_perm:[0,1,2,3] row_mask:0x4 bank_mask:0xf
    v_mov_b32_dpp v9, v97 quad_perm:[0,1,2,3] row_mask:0x4 bank_mask:0xf
    v_mov_b32_dpp v10, v98 quad_perm:[0,1,2,3] row_mask:0x4 bank_mask:0xf
    v_mov_b32_dpp v11, v99 quad_perm:[0,1,2,3] row_mask:0x4 bank_mask:0xf
    v_mov_b32_dpp v8, v100 quad_perm:[0,1,2,3] row_mask:0x8 bank_mask:0xf
    v_mov_b32_dpp v9, v101 quad_perm:[0,1,2,3] row_mask:0x8 bank_mask:0xf
    v_mov_b32_dpp v10, v102 quad_perm:[0,1,2,3] row_mask:0x8 bank_mask:0xf
    v_mov_b32_dpp v11, v103 quad_perm:[0,1,2,3] row_mask:0x8 bank_mask:0xf
    v_cvt_pk_bf16_f32 v12, v4, v5
    v_cvt_pk_bf16_f32 v13, v6, v7
    v_cvt_pk_bf16_f32 v14, v8, v9
    v_cvt_pk_bf16_f32 v15, v10, v11
    s_mov_b32 s20, s58
    s_mov_b32 s21, s59
    s_mov_b32 s22, 0x2000
    s_mov_b32 s23, 0x20000
    v_and_b32 v3, 3, v0
    v_lshlrev_b32 v80, 4, v3
    v_bfe_u32 v4, v0, 2, 1
    v_lshl_add_u32 v80, v4, 3, v80
    v_lshrrev_b32 v5, 3, v0
    v_lshl_add_u32 v80, v5, 6, v80
    v_lshlrev_b32 v82, 11, v3
    v_lshl_add_u32 v82, v4, 3, v82
    v_lshrrev_b32 v3, 4, v0
    v_lshl_add_u32 v82, v3, 4, v82
    v_and_b32 v5, 1, v5
    v_lshl_add_u32 v82, v5, 6, v82
    v_and_b32 v81, 0xf0, v2
    v_lshl_add_u32 v81, v3, 14, v81
    v_cmp_eq_u32 vcc, 0, v5
    v_mov_b32 v3, 0x3f803f80
    s_nop 0
    v_cndmask_b32 v4, 0, v3, vcc
    v_xor_b32 v5, v3, v4
    v_and_b32 v84, v4, v20
    v_and_b32 v88, v5, v20
    v_and_b32 v85, v4, v21
    v_and_b32 v89, v5, v21
    v_and_b32 v86, v4, v22
    v_and_b32 v90, v5, v22
    v_and_b32 v87, v4, v23
    v_and_b32 v91, v5, v23
    s_lshl_b32 s30, s3, 12
    s_add_u32 s30, s30, 0x80000
    s_lshl_b32 s24, s26, 14
    s_add_u32 s24, s24, s30
    buffer_store_dwordx2 v[12:13], v80, s[12:15], s24 offen sc1 nt
    buffer_store_dwordx2 v[14:15], v80, s[12:15], s24 offen offset:512 sc1 nt
    s_lshl_b32 s24, s3, 7
    s_add_u32 s24, s24, 0x1d9000
    s_waitcnt vmcnt(0)
    s_mov_b64 exec, 1
    v_mov_b32 v83, 64
    buffer_atomic_add v83, off, s[12:15], s24 sc0
    s_mov_b64 exec, -1
    s_waitcnt vmcnt(0)
    v_readfirstlane_b32 s24, v83
    s_nop 0
    s_cmp_lg_u32 s24, 1983
    s_cbranch_scc1 L_W_x
    s_lshl_b32 s31, s3, 8
L_W_f:
    s_mov_b32 s25, 262144
L_fi17:
    s_mov_b32 s24, s30
    buffer_load_dwordx4 v[128:131], v81, s[12:15], s24 offen offset:0 sc1 nt
    buffer_load_dwordx4 v[132:135], v81, s[12:15], s24 offen offset:256 sc1 nt
    s_add_u32 s24, s24, 65536
    buffer_load_dwordx4 v[136:139], v81, s[12:15], s24 offen offset:0 sc1 nt
    buffer_load_dwordx4 v[140:143], v81, s[12:15], s24 offen offset:256 sc1 nt
    s_add_u32 s24, s24, 65536
    buffer_load_dwordx4 v[144:147], v81, s[12:15], s24 offen offset:0 sc1 nt
    buffer_load_dwordx4 v[148:151], v81, s[12:15], s24 offen offset:256 sc1 nt
    s_add_u32 s24, s24, 65536
    buffer_load_dwordx4 v[152:155], v81, s[12:15], s24 offen offset:0 sc1 nt
    buffer_load_dwordx4 v[156:159], v81, s[12:15], s24 offen offset:256 sc1 nt
    s_add_u32 s24, s24, 65536
    buffer_load_dwordx4 v[160:163], v81, s[12:15], s24 offen offset:0 sc1 nt
    buffer_load_dwordx4 v[164:167], v81, s[12:15], s24 offen offset:256 sc1 nt
    s_add_u32 s24, s24, 65536
    buffer_load_dwordx4 v[168:171], v81, s[12:15], s24 offen offset:0 sc1 nt
    buffer_load_dwordx4 v[172:175], v81, s[12:15], s24 offen offset:256 sc1 nt
    s_add_u32 s24, s24, 65536
    buffer_load_dwordx4 v[176:179], v81, s[12:15], s24 offen offset:0 sc1 nt
    buffer_load_dwordx4 v[180:183], v81, s[12:15], s24 offen offset:256 sc1 nt
    s_add_u32 s24, s24, 65536
    buffer_load_dwordx4 v[184:187], v81, s[12:15], s24 offen offset:0 sc1 nt
    buffer_load_dwordx4 v[188:191], v81, s[12:15], s24 offen offset:256 sc1 nt
    s_waitcnt vmcnt(15)
    v_mfma_f32_16x16x32_bf16 v[92:95], v[128:131], v[84:87], 0
    s_waitcnt vmcnt(14)
    v_mfma_f32_16x16x32_bf16 v[92:95], v[132:135], v[88:91], v[92:95]
    s_waitcnt vmcnt(13)
    v_mfma_f32_16x16x32_bf16 v[92:95], v[136:139], v[84:87], v[92:95]
    s_waitcnt vmcnt(12)
    v_mfma_f32_16x16x32_bf16 v[92:95], v[140:143], v[88:91], v[92:95]
    s_waitcnt vmcnt(11)
    v_mfma_f32_16x16x32_bf16 v[92:95], v[144:147], v[84:87], v[92:95]
    s_waitcnt vmcnt(10)
    v_mfma_f32_16x16x32_bf16 v[92:95], v[148:151], v[88:91], v[92:95]
    s_waitcnt vmcnt(9)
    v_mfma_f32_16x16x32_bf16 v[92:95], v[152:155], v[84:87], v[92:95]
    s_waitcnt vmcnt(8)
    v_mfma_f32_16x16x32_bf16 v[92:95], v[156:159], v[88:91], v[92:95]
    s_waitcnt vmcnt(7)
    v_mfma_f32_16x16x32_bf16 v[92:95], v[160:163], v[84:87], v[92:95]
    s_waitcnt vmcnt(6)
    v_mfma_f32_16x16x32_bf16 v[92:95], v[164:167], v[88:91], v[92:95]
    s_waitcnt vmcnt(5)
    v_mfma_f32_16x16x32_bf16 v[92:95], v[168:171], v[84:87], v[92:95]
    s_waitcnt vmcnt(4)
    v_mfma_f32_16x16x32_bf16 v[92:95], v[172:175], v[88:91], v[92:95]
    s_waitcnt vmcnt(3)
    v_mfma_f32_16x16x32_bf16 v[92:95], v[176:179], v[84:87], v[92:95]
    s_waitcnt vmcnt(2)
    v_mfma_f32_16x16x32_bf16 v[92:95], v[180:183], v[88:91], v[92:95]
    s_waitcnt vmcnt(1)
    v_mfma_f32_16x16x32_bf16 v[92:95], v[184:187], v[84:87], v[92:95]
    s_waitcnt vmcnt(0)
    v_mfma_f32_16x16x32_bf16 v[92:95], v[188:191], v[88:91], v[92:95]
    s_nop 7
    v_cmp_u_f32 vcc, v92, v93
    v_cmp_u_f32 s[68:69], v94, v95
    v_cvt_pk_bf16_f32 v4, v92, v93
    v_cvt_pk_bf16_f32 v5, v94, v95
    s_or_b64 vcc, vcc, s[68:69]
    s_cbranch_scc0 L_fi17_x
    v_max_u32 v3, v128, v129
    v_max3_u32 v3, v3, v130, v131
    v_max3_u32 v3, v3, v132, v133
    v_max3_u32 v3, v3, v134, v135
    v_max3_u32 v3, v3, v136, v137
    v_max3_u32 v3, v3, v138, v139
    v_max3_u32 v3, v3, v140, v141
    v_max3_u32 v3, v3, v142, v143
    v_max3_u32 v3, v3, v144, v145
    v_max3_u32 v3, v3, v146, v147
    v_max3_u32 v3, v3, v148, v149
    v_max3_u32 v3, v3, v150, v151
    v_max3_u32 v3, v3, v152, v153
    v_max3_u32 v3, v3, v154, v155
    v_max3_u32 v3, v3, v156, v157
    v_max3_u32 v3, v3, v158, v159
    v_max3_u32 v3, v3, v160, v161
    v_max3_u32 v3, v3, v162, v163
    v_max3_u32 v3, v3, v164, v165
    v_max3_u32 v3, v3, v166, v167
    v_max3_u32 v3, v3, v168, v169
    v_max3_u32 v3, v3, v170, v171
    v_max3_u32 v3, v3, v172, v173
    v_max3_u32 v3, v3, v174, v175
    v_max3_u32 v3, v3, v176, v177
    v_max3_u32 v3, v3, v178, v179
    v_max3_u32 v3, v3, v180, v181
    v_max3_u32 v3, v3, v182, v183
    v_max3_u32 v3, v3, v184, v185
    v_max3_u32 v3, v3, v186, v187
    v_max3_u32 v3, v3, v188, v189
    v_max3_u32 v3, v3, v190, v191
    v_cmp_eq_u32 vcc, -1, v3
    s_sub_u32 s25, s25, 1
    s_cmp_eq_u32 s25, 0
    s_cbranch_scc1 L_fi17_x
    s_cmp_lg_u64 vcc, 0
    s_cbranch_scc1 L_fi17
L_fi17_x:
    buffer_store_dwordx2 v[4:5], v82, s[20:23], s31 offen
    s_add_u32 s30, s30, 512
    s_add_u32 s31, s31, 128
    s_bitcmp1_b32 s31, 7
    s_cbranch_scc1 L_W_f
L_W_x:
    s_barrier
L_R:
    s_mov_b32 s20, s58
    s_mov_b32 s21, s59
    s_mov_b32 s22, 0x2000
    s_mov_b32 s23, 0x20000
    v_and_b32 v3, 1, v0
    v_lshlrev_b32 v3, 4, v3
    v_mov_b32 v4, 0xffff
    v_lshlrev_b32 v4, v3, v4
    v_bfe_u32 v3, v0, 1, 2
    v_cmp_eq_u32 vcc, 0, v3
    s_nop 1
    v_cndmask_b32 v20, 0, v4, vcc
    v_cmp_eq_u32 vcc, 1, v3
    s_nop 1
    v_cndmask_b32 v21, 0, v4, vcc
    v_cmp_eq_u32 vcc, 2, v3
    s_nop 1
    v_cndmask_b32 v22, 0, v4, vcc
    v_cmp_eq_u32 vcc, 3, v3
    s_nop 1
    v_cndmask_b32 v23, 0, v4, vcc
    v_lshrrev_b32 v3, 4, v0
    v_and_b32 v4, 7, v0
    v_bfe_u32 v7, v0, 3, 1
    v_lshl_add_u32 v5, v3, 3, v4
    v_mul_u32_u24 v6, 320, v7
    v_lshl_add_u32 v5, v5, 3, v6
    s_mul_i32 s24, s3, 1280
    s_add_u32 s24, s24, 135168
    v_add_u32 v24, s24, v5
    v_and_b32 v5, 3, v0
    v_mul_u32_u24 v25, 320, v5
    v_lshl_add_u32 v25, v3, 4, v25
    v_add_u32 v25, 135168, v25
    v_lshlrev_b32 v26, 4, v4
    v_lshl_add_u32 v26, v7, 3, v26
    v_and_b32 v5, 15, v0
    v_lshlrev_b32 v28, 11, v3
    v_lshl_add_u32 v28, v5, 1, v28
    s_and_b32 s24, s74, 7
    s_lshl_b32 s24, s24, 3
    s_bfm_b64 s[44:45], 8, s24
    s_not_b64 s[44:45], s[44:45]
    v_min_u32 v6, 5, v4
    v_lshrrev_b32 v5, 1, v6
    v_and_b32 v8, 1, v3
    v_mad_u32_u24 v5, v8, 3, v5
    v_lshlrev_b32 v31, 12, v5
    v_and_b32 v6, 1, v6
    v_lshl_add_u32 v6, v7, 1, v6
    v_lshl_add_u32 v31, v6, 4, v31
    s_and_b32 s35, s72, 7
    s_lshl_b32 s35, s35, 7
    s_add_u32 s35, s35, 0x1c0000
    s_lshr_b32 s34, s72, 3
    s_mul_i32 s34, s34, 6
    s_mul_i32 s29, s3, 24576
    s_add_u32 s29, s29, s35
    s_mov_b32 s24, 262144
    s_branch L_pd18_in
L_pd18:
    s_sleep 64
L_pd18_in:
    buffer_load_dwordx2 v[8:9], v31, s[12:15], s29 offen sc1
    s_waitcnt vmcnt(0)
    v_max_u32 v3, v8, v9
    v_cmp_eq_u32 vcc, -1, v3
    s_sub_u32 s24, s24, 1
    s_cmp_eq_u32 s24, 0
    s_cbranch_scc1 L_pd18_x
    s_and_b64 exec, exec, vcc
    s_cbranch_scc1 L_pd18
L_pd18_x:
    s_mov_b64 exec, -1
    v_mov_b32 v6, v8
    s_nop 1
    v_max_f32_dpp v6, v6, v6 quad_perm:[1,0,3,2] row_mask:0xf bank_mask:0xf
    s_nop 1
    v_max_f32_dpp v6, v6, v6 quad_perm:[2,3,0,1] row_mask:0xf bank_mask:0xf
    s_nop 1
    v_max_f32_dpp v6, v6, v6 row_half_mirror row_mask:0xf bank_mask:0xf
    v_sub_f32 v8, v8, v6
    v_exp_f32 v8, v8
    v_cmp_gt_u32 vcc, 6, v4
    s_nop 1
    v_cndmask_b32 v8, 0, v8, vcc
    v_mul_f32 v9, v8, v9
    s_nop 1
    v_add_f32_dpp v9, v9, v9 quad_perm:[1,0,3,2] row_mask:0xf bank_mask:0xf
    s_nop 1
    v_add_f32_dpp v9, v9, v9 quad_perm:[2,3,0,1] row_mask:0xf bank_mask:0xf
    s_nop 1
    v_add_f32_dpp v9, v9, v9 row_half_mirror row_mask:0xf bank_mask:0xf
    v_rcp_f32 v9, v9
    s_nop 0
    v_mul_f32 v8, v8, v9
    v_cvt_pk_bf16_f32 v8, v8, v8
    v_lshrrev_b32 v3, 4, v0
    v_mul_u32_u24 v9, 6, v7
    v_sub_u32 v3, v3, v9
    v_lshlrev_b32 v9, 3, v7
    v_add_u32 v5, 0, v3
    v_min_u32 v5, 6, v5
    v_add_u32 v5, v5, v9
    v_lshlrev_b32 v5, 2, v5
    ds_bpermute_b32 v10, v5, v8
    ds_bpermute_b32 v13, v5, v8 offset:64
    v_add_u32 v5, 4, v3
    v_min_u32 v5, 6, v5
    v_add_u32 v5, v5, v9
    v_lshlrev_b32 v5, 2, v5
    ds_bpermute_b32 v11, v5, v8
    ds_bpermute_b32 v14, v5, v8 offset:64
    v_add_u32 v5, 8, v3
    v_min_u32 v5, 6, v5
    v_add_u32 v5, v5, v9
    v_lshlrev_b32 v5, 2, v5
    ds_bpermute_b32 v12, v5, v8
    ds_bpermute_b32 v15, v5, v8 offset:64
    s_waitcnt lgkmcnt(0)
    v_and_b32 v32, v10, v20
    v_and_b32 v33, v10, v21
    v_and_b32 v34, v10, v22
    v_and_b32 v35, v10, v23
    v_and_b32 v36, v11, v20
    v_and_b32 v37, v11, v21
    v_and_b32 v38, v11, v22
    v_and_b32 v39, v11, v23
    v_and_b32 v40, v12, v20
    v_and_b32 v41, v12, v21
    v_and_b32 v42, v12, v22
    v_and_b32 v43, v12, v23
    v_and_b32 v44, v13, v20
    v_and_b32 v45, v13, v21
    v_and_b32 v46, v13, v22
    v_and_b32 v47, v13, v23
    v_and_b32 v48, v14, v20
    v_and_b32 v49, v14, v21
    v_and_b32 v50, v14, v22
    v_and_b32 v51, v14, v23
    v_and_b32 v52, v15, v20
    v_and_b32 v53, v15, v21
    v_and_b32 v54, v15, v22
    v_and_b32 v55, v15, v23
    s_mov_b32 s43, s29
    s_and_b32 s24, s3, 1
    s_lshl_b32 s24, s24, 1
    s_and_b32 s29, s3, 2
    s_lshl_b32 s29, s29, 3
    s_or_b32 s29, s29, s24
    s_and_b32 s24, s26, 13
    s_or_b32 s29, s29, s24
    s_mul_i32 s29, s29, 6144
    s_add_u32 s29, s29, 0x180000
    s_add_u32 s42, s29, 4096
    s_lshr_b32 s24, s74, 3
    s_lshl_b32 s24, s24, 2
    s_add_u32 s24, s24, s3
    s_lshl_b32 s36, s24, 12
    s_add_u32 s36, s36, 0x1de000
    s_and_b32 s37, s74, 7
    s_lshl_b32 s37, s37, 7
    s_add_u32 s37, s37, s36
    s_lshl_b32 s38, s3, 12
    s_andn2_b32 s25, s74, 7
    s_lshl_b32 s25, s25, 4
    s_add_u32 s38, s38, s25
    s_add_u32 s38, s38, 0x1da000
    s_lshl_b32 s39, s24, 5
    s_add_u32 s39, s39, 1024
    s_mov_b32 s30, 0x600000
    s_mov_b32 s31, s30
    s_mov_b32 s40, s30
    s_mov_b32 s41, s30
    s_mov_b32 s33, 0
    s_branch L_P_go
L_P:
    s_mov_b64 s[30:31], s[36:37]
    s_mov_b64 s[40:41], s[38:39]
    s_mov_b32 s33, 447
    s_cmp_lg_u32 s3, 0
    s_cbranch_scc1 L_H_x
    s_lshr_b32 s24, s74, 5
    s_mul_i32 s25, s24, 3
    s_add_u32 s34, s34, s25
    s_lshl_b32 s24, s24, 6
    s_add_u32 s24, s24, s26
    s_lshl_b32 s24, s24, 20
    s_add_u32 s4, s52, s24
    s_addc_u32 s5, s53, 0
    s_mov_b32 s6, 0x100000
    s_mov_b32 s7, 0x20000
    s_add_u32 s8, s4, 0x2000000
    s_addc_u32 s9, s5, 0
    s_mov_b32 s10, s6
    s_mov_b32 s11, 0x20000
    v_lshrrev_b32 v3, 4, v0
    v_mul_u32_u24 v16, 6144, v3
    v_and_b32 v3, 15, v0
    v_lshl_add_u32 v16, v3, 7, v16
    v_lshlrev_b32 v17, 12, v0
    v_mov_b32 v18, 0
    s_mov_b32 s27, 43
    s_mov_b32 s28, 43
    s_mov_b32 s32, 43
    s_mov_b32 s75, 1024
L_H:
    s_sub_u32 s75, s75, 1
    s_cmp_eq_u32 s75, 0
    s_cbranch_scc1 L_H_x
    s_mov_b64 exec, 0xffffff
    buffer_load_dword v18, v17, s[12:15], s35 offen offset:64 sc1
    s_mov_b64 exec, -1
    s_waitcnt vmcnt(0)
    v_max_i32 v19, 0, v18
    s_nop 1
    v_add_u32_dpp v3, v19, v19 row_ror:8 row_mask:0xf bank_mask:0xf
    s_nop 1
    v_add_u32_dpp v3, v3, v3 row_ror:4 row_mask:0xf bank_mask:0xf
    s_nop 1
    v_add_u32_dpp v3, v3, v3 row_ror:2 row_mask:0xf bank_mask:0xf
    s_nop 1
    v_add_u32_dpp v3, v3, v3 row_ror:1 row_mask:0xf bank_mask:0xf
    s_nop 0
    v_readlane_b32 s70, v3, 0
    v_readlane_b32 s24, v3, 16
    s_nop 0
    s_add_u32 s70, s70, s24
    s_add_u32 s24, s34, 0
    s_nop 0
    v_readlane_b32 s24, v19, s24
    s_sub_u32 s25, 43, s27
    s_mul_i32 s25, s25, 17
    s_mul_i32 s64, s24, 24
    s_add_u32 s64, s64, s25
    s_add_u32 s24, s24, 8
    s_cmp_gt_u32 s24, s27
    s_cselect_b32 s64, 0xffff, s64
    s_add_u32 s24, s34, 1
    v_readlane_b32 s24, v19, s24
    s_sub_u32 s25, 43, s28
    s_mul_i32 s25, s25, 17
    s_mul_i32 s65, s24, 24
    s_add_u32 s65, s65, s25
    s_add_u32 s24, s24, 8
    s_cmp_gt_u32 s24, s28
    s_cselect_b32 s65, 0xffff, s65
    s_add_u32 s24, s34, 2
    v_readlane_b32 s24, v19, s24
    s_sub_u32 s25, 43, s32
    s_mul_i32 s25, s25, 17
    s_mul_i32 s66, s24, 24
    s_add_u32 s66, s66, s25
    s_add_u32 s24, s24, 8
    s_cmp_gt_u32 s24, s32
    s_cselect_b32 s66, 0xffff, s66
    s_min_u32 s71, s64, s65
    s_min_u32 s71, s71, s66
    s_cmp_eq_u32 s71, 0xffff
    s_cbranch_scc1 L_H_x
    s_add_u32 s24, s71, 36
    s_cmp_lt_i32 s24, s70
    s_cbranch_scc1 L_H_go
    s_sleep 4
    s_branch L_H
L_H_go:
    s_cmp_lg_u32 s71, s64
    s_cbranch_scc1 L_H_n0
    s_sub_u32 s27, s27, 2
    s_mul_i32 s24, s27, 24576
    s_add_u32 s24, s24, 0
    s_branch L_H_ld
L_H_n0:
    s_cmp_lg_u32 s71, s65
    s_cbranch_scc1 L_H_n1
    s_sub_u32 s28, s28, 2
    s_mul_i32 s24, s28, 24576
    s_add_u32 s24, s24, 2048
    s_branch L_H_ld
L_H_n1:
    s_sub_u32 s32, s32, 2
    s_mul_i32 s24, s32, 24576
    s_add_u32 s24, s24, 4096
L_H_ld:
    buffer_load_dword v5, v16, s[4:7], s24 offen
    buffer_load_dword v5, v16, s[8:11], s24 offen
    s_add_u32 s24, s24, 24576
    buffer_load_dword v5, v16, s[4:7], s24 offen
    buffer_load_dword v5, v16, s[8:11], s24 offen
    s_branch L_H
L_H_x:
    s_barrier
    s_mov_b32 s24, 262144
    s_branch L_pd19_in
L_pd19:
    s_sleep 4
L_pd19_in:
    buffer_load_dwordx2 v[8:9], v31, s[12:15], s43 offen offset:8 sc1
    s_waitcnt vmcnt(0)
    v_max_u32 v3, v8, v9
    v_cmp_eq_u32 vcc, -1, v3
    s_sub_u32 s24, s24, 1
    s_cmp_eq_u32 s24, 0
    s_cbranch_scc1 L_pd19_x
    s_and_b64 exec, exec, vcc
    s_cbranch_scc1 L_pd19
L_pd19_x:
    s_mov_b64 exec, -1
    s_mov_b32 s24, 262144
L_pd20:
    buffer_load_dwordx4 v[56:59], v2, s[12:15], s29 offen offset:0 sc1
    buffer_load_dwordx4 v[60:63], v2, s[12:15], s29 offen offset:1024 sc1
    buffer_load_dwordx4 v[64:67], v2, s[12:15], s29 offen offset:2048 sc1
    buffer_load_dwordx4 v[68:71], v2, s[12:15], s29 offen offset:3072 sc1
    buffer_load_dwordx4 v[72:75], v2, s[12:15], s42 offen offset:0 sc1
    buffer_load_dwordx4 v[76:79], v2, s[12:15], s42 offen offset:1024 sc1
    s_waitcnt vmcnt(0)
    v_max_u32 v3, v56, v57
    v_max3_u32 v3, v3, v58, v59
    v_max3_u32 v3, v3, v60, v61
    v_max3_u32 v3, v3, v62, v63
    v_max3_u32 v3, v3, v64, v65
    v_max3_u32 v3, v3, v66, v67
    v_max3_u32 v3, v3, v68, v69
    v_max3_u32 v3, v3, v70, v71
    v_max3_u32 v3, v3, v72, v73
    v_max3_u32 v3, v3, v74, v75
    v_max3_u32 v3, v3, v76, v77
    v_max3_u32 v3, v3, v78, v79
    v_cmp_eq_u32 vcc, -1, v3
    s_sub_u32 s24, s24, 1
    s_cmp_eq_u32 s24, 0
    s_cbranch_scc1 L_pd20_x
    s_and_b64 exec, exec, vcc
    s_cbranch_scc1 L_pd20
L_pd20_x:
    s_mov_b64 exec, -1
L_P_go:
    v_mfma_f32_16x16x32_bf16 v[12:15], v[56:59], v[32:35], 0
    v_mfma_f32_16x16x32_bf16 v[16:19], v[68:71], v[44:47], 0
    v_mfma_f32_16x16x32_bf16 v[12:15], v[60:63], v[36:39], v[12:15]
    v_mfma_f32_16x16x32_bf16 v[16:19], v[72:75], v[48:51], v[16:19]
    v_mfma_f32_16x16x32_bf16 v[12:15], v[64:67], v[40:43], v[12:15]
    v_mfma_f32_16x16x32_bf16 v[16:19], v[76:79], v[52:55], v[16:19]
    s_barrier
    s_mov_b64 exec, 1
    v_mov_b32 v83, 64
    buffer_atomic_add v83, off, s[12:15], s40 sc0
    s_mov_b64 exec, -1
    s_nop 1
    v_cvt_pk_bf16_f32 v4, v12, v13
    v_cvt_pk_bf16_f32 v5, v14, v15
    ds_write_b64 v24, v[4:5]
    v_cvt_pk_bf16_f32 v6, v16, v17
    v_cvt_pk_bf16_f32 v7, v18, v19
    ds_write_b64 v24, v[6:7] offset:640
    s_waitcnt lgkmcnt(0)
    s_barrier
    ds_read_b128 v[128:131], v25 offset:0
    ds_read_b128 v[132:135], v25 offset:64
    ds_read_b128 v[136:139], v25 offset:128
    ds_read_b128 v[140:143], v25 offset:192
    ds_read_b128 v[144:147], v25 offset:1280
    ds_read_b128 v[148:151], v25 offset:1344
    ds_read_b128 v[152:155], v25 offset:1408
    ds_read_b128 v[156:159], v25 offset:1472
    ds_read_b128 v[160:163], v25 offset:2560
    s_waitcnt lgkmcnt(8)
    v_mfma_f32_16x16x32_bf16 v[12:15], v[128:131], a[128:131], 0
    ds_read_b128 v[164:167], v25 offset:2624
    s_waitcnt lgkmcnt(8)
    v_mfma_f32_16x16x32_bf16 v[12:15], v[132:135], a[132:135], v[12:15]
    ds_read_b128 v[168:171], v25 offset:2688
    s_waitcnt lgkmcnt(8)
    v_mfma_f32_16x16x32_bf16 v[12:15], v[136:139], a[136:139], v[12:15]
    ds_read_b128 v[172:175], v25 offset:2752
    s_waitcnt lgkmcnt(8)
    v_mfma_f32_16x16x32_bf16 v[12:15], v[140:143], a[140:143], v[12:15]
    ds_read_b128 v[176:179], v25 offset:3840
    s_waitcnt lgkmcnt(8)
    v_mfma_f32_16x16x32_bf16 v[12:15], v[144:147], a[144:147], v[12:15]
    ds_read_b128 v[180:183], v25 offset:3904
    s_waitcnt lgkmcnt(8)
    v_mfma_f32_16x16x32_bf16 v[12:15], v[148:151], a[148:151], v[12:15]
    ds_read_b128 v[184:187], v25 offset:3968
    s_waitcnt lgkmcnt(8)
    v_mfma_f32_16x16x32_bf16 v[12:15], v[152:155], a[152:155], v[12:15]
    ds_read_b128 v[188:191], v25 offset:4032
    s_waitcnt lgkmcnt(8)
    v_mfma_f32_16x16x32_bf16 v[12:15], v[156:159], a[156:159], v[12:15]
    s_waitcnt lgkmcnt(7)
    v_mfma_f32_16x16x32_bf16 v[12:15], v[160:163], a[160:163], v[12:15]
    s_waitcnt lgkmcnt(6)
    v_mfma_f32_16x16x32_bf16 v[12:15], v[164:167], a[164:167], v[12:15]
    s_waitcnt lgkmcnt(5)
    v_mfma_f32_16x16x32_bf16 v[12:15], v[168:171], a[168:171], v[12:15]
    s_waitcnt lgkmcnt(4)
    v_mfma_f32_16x16x32_bf16 v[12:15], v[172:175], a[172:175], v[12:15]
    s_waitcnt lgkmcnt(3)
    v_mfma_f32_16x16x32_bf16 v[12:15], v[176:179], a[176:179], v[12:15]
    s_waitcnt lgkmcnt(2)
    v_mfma_f32_16x16x32_bf16 v[12:15], v[180:183], a[180:183], v[12:15]
    s_waitcnt lgkmcnt(1)
    v_mfma_f32_16x16x32_bf16 v[12:15], v[184:187], a[184:187], v[12:15]
    s_waitcnt lgkmcnt(0)
    v_mfma_f32_16x16x32_bf16 v[12:15], v[188:191], a[188:191], v[12:15]
    s_nop 7
    v_cvt_pk_bf16_f32 v4, v12, v13
    v_cvt_pk_bf16_f32 v5, v14, v15
    s_mov_b64 exec, 0xffff
    buffer_store_dwordx2 v[4:5], v26, s[12:15], s31 offen sc1
    s_mov_b64 exec, -1
    v_mov_b32 v16, v4
    v_mov_b32 v17, v5
    v_mov_b32 v18, v4
    v_mov_b32 v19, v5
    v_mov_b32_dpp v16, v4 row_ror:8 row_mask:0xf bank_mask:0xc
    v_mov_b32_dpp v17, v5 row_ror:8 row_mask:0xf bank_mask:0xc
    v_mov_b32_dpp v18, v4 row_ror:8 row_mask:0xf bank_mask:0x3
    v_mov_b32_dpp v19, v5 row_ror:8 row_mask:0xf bank_mask:0x3
    s_waitcnt vmcnt(1)
    v_readfirstlane_b32 s24, v83
    s_nop 0
    s_cmp_eq_u32 s24, s33
    s_cbranch_scc1 L_P_f
    s_waitcnt vmcnt(0)
    v_readfirstlane_b32 s24, v83
    s_nop 0
    s_cmp_lg_u32 s24, s33
    s_cbranch_scc1 L_P_n
L_P_f:
    s_mov_b64 exec, s[44:45]
    s_mov_b32 s24, 262144
L_pd21:
    buffer_load_dwordx4 v[16:19], v2, s[12:15], s30 offen sc1
    s_waitcnt vmcnt(0)
    v_max_u32 v3, v16, v17
    v_max3_u32 v3, v3, v18, v19
    v_cmp_eq_u32 vcc, -1, v3
    s_sub_u32 s24, s24, 1
    s_cmp_eq_u32 s24, 0
    s_cbranch_scc1 L_pd21_x
    s_and_b64 exec, exec, vcc
    s_cbranch_scc1 L_pd21
L_pd21_x:
    s_mov_b64 exec, -1
    v_lshlrev_b32 v56, 16, v16
    v_and_b32 v57, 0xffff0000, v16
    v_lshlrev_b32 v58, 16, v17
    v_and_b32 v59, 0xffff0000, v17
    v_lshlrev_b32 v60, 16, v18
    v_and_b32 v61, 0xffff0000, v18
    v_lshlrev_b32 v62, 16, v19
    v_and_b32 v63, 0xffff0000, v19
    v_permlane32_swap_b32 v56, v58
    v_permlane32_swap_b32 v57, v59
    v_permlane32_swap_b32 v60, v62
    v_permlane32_swap_b32 v61, v63
    v_add_f32 v56, v56, v58
    v_add_f32 v57, v57, v59
    v_add_f32 v60, v60, v62
    v_add_f32 v61, v61, v63
    v_permlane16_swap_b32 v56, v57
    s_nop 0
    v_permlane16_swap_b32 v60, v61
    v_add_f32 v56, v56, v57
    v_add_f32 v60, v60, v61
    s_nop 0
    v_add_f32_dpp v4, v56, v56 row_ror:8 row_mask:0xf bank_mask:0x3
    s_nop 1
    v_add_f32_dpp v4, v60, v60 row_ror:8 row_mask:0xf bank_mask:0xc
    v_cvt_pk_bf16_f32 v4, v4, v4
    buffer_store_short v4, v28, s[20:23], s41 offen
L_P_n:
    s_cmp_lg_u32 s33, 0
    s_cbranch_scc1 L_P_x
    s_barrier
    s_branch L_P
L_P_x:
L_end:
    s_endpgm
L_C:
    s_cmp_lg_u32 s3, 0
    s_cbranch_scc1 L_C_q
    v_lshrrev_b32 v3, 4, v0
    v_and_b32 v4, 3, v0
    v_lshlrev_b32 v5, 6, v3
    v_lshl_add_u32 v5, v4, 4, v5
    v_bfe_u32 v4, v0, 2, 2
    v_lshl_add_u32 v5, v4, 8, v5
    s_lshl_b32 s24, s26, 12
    s_add_u32 s24, s24, 0x140000
    buffer_store_dwordx4 v[8:11], v5, s[12:15], s24 offen sc1
L_C_q:
    s_waitcnt vmcnt(0)
    s_barrier
    s_cmp_lg_u32 s3, 0
    s_cbranch_scc1 L_sig22
    s_mov_b64 exec, 1
    v_mov_b32 v3, 1
    v_mov_b32 v4, 1
    buffer_atomic_add v4, off, s[16:19], 0 offset:128
    buffer_atomic_add v3, off, s[16:19], 0 offset:0 sc0
    s_waitcnt vmcnt(0)
    v_readfirstlane_b32 s24, v3
    s_mov_b64 exec, -1
    s_and_b32 s24, s24, 63
    s_cmp_lg_u32 s24, 63
    s_cbranch_scc1 L_sig22
    v_lshlrev_b32 v4, 7, v0
    v_mov_b32 v3, 1
    s_mov_b32 s24, 0x170000
    buffer_store_dword v3, v4, s[12:15], s24 offen offset:0 sc1
L_sig22:
    s_mov_b32 s8, s56
    s_mov_b32 s9, s57
    s_mov_b32 s10, 0x400000
    s_mov_b32 s11, 0x20000
    s_and_b32 s24, s3, 1
    s_lshl_b32 s24, s24, 1
    s_and_b32 s25, s3, 2
    s_lshl_b32 s25, s25, 3
    s_or_b32 s25, s25, s24
    s_and_b32 s24, s26, 13
    s_or_b32 s25, s25, s24
    s_lshl_b32 s25, s25, 17
    s_lshr_b32 s24, s74, 3
    s_lshl_b32 s24, s24, 7
    s_add_u32 s24, s24, s25
    v_lshrrev_b32 v3, 4, v0
    v_lshlrev_b32 v3, 15, v3
    v_and_b32 v4, 8, v0
    v_lshl_add_u32 v3, v4, 10, v3
    v_and_b32 v4, 0x70, v2
    v_add_u32 v3, v3, v4
    s_mul_i32 m0, s3, 16896
    s_nop 0
    buffer_load_dwordx4 v3, s[8:11], s24 offen nt lds
    s_add_u32 m0, m0, 1056
    s_add_u32 s24, s24, 2048
    buffer_load_dwordx4 v3, s[8:11], s24 offen nt lds
    s_add_u32 m0, m0, 1056
    s_add_u32 s24, s24, 2048
    buffer_load_dwordx4 v3, s[8:11], s24 offen nt lds
    s_add_u32 m0, m0, 1056
    s_add_u32 s24, s24, 2048
    buffer_load_dwordx4 v3, s[8:11], s24 offen nt lds
    s_add_u32 m0, m0, 1056
    s_add_u32 s24, s24, 10240
    buffer_load_dwordx4 v3, s[8:11], s24 offen nt lds
    s_add_u32 m0, m0, 1056
    s_add_u32 s24, s24, 2048
    buffer_load_dwordx4 v3, s[8:11], s24 offen nt lds
    s_add_u32 m0, m0, 1056
    s_add_u32 s24, s24, 2048
    buffer_load_dwordx4 v3, s[8:11], s24 offen nt lds
    s_add_u32 m0, m0, 1056
    s_add_u32 s24, s24, 2048
    buffer_load_dwordx4 v3, s[8:11], s24 offen nt lds
    s_add_u32 m0, m0, 1056
    s_add_u32 s24, s24, -21504
    buffer_load_dwordx4 v3, s[8:11], s24 offen nt lds
    s_add_u32 m0, m0, 1056
    s_add_u32 s24, s24, 2048
    buffer_load_dwordx4 v3, s[8:11], s24 offen nt lds
    s_add_u32 m0, m0, 1056
    s_add_u32 s24, s24, 2048
    buffer_load_dwordx4 v3, s[8:11], s24 offen nt lds
    s_add_u32 m0, m0, 1056
    s_add_u32 s24, s24, 2048
    buffer_load_dwordx4 v3, s[8:11], s24 offen nt lds
    s_add_u32 m0, m0, 1056
    s_add_u32 s24, s24, 10240
    buffer_load_dwordx4 v3, s[8:11], s24 offen nt lds
    s_add_u32 m0, m0, 1056
    s_add_u32 s24, s24, 2048
    buffer_load_dwordx4 v3, s[8:11], s24 offen nt lds
    s_add_u32 m0, m0, 1056
    s_add_u32 s24, s24, 2048
    buffer_load_dwordx4 v3, s[8:11], s24 offen nt lds
    s_add_u32 m0, m0, 1056
    s_add_u32 s24, s24, 2048
    buffer_load_dwordx4 v3, s[8:11], s24 offen nt lds
    s_waitcnt vmcnt(0)
    s_barrier
    v_lshrrev_b32 v3, 2, v0
    v_mul_u32_u24 v3, 1056, v3
    v_and_b32 v4, 3, v0
    v_lshl_add_u32 v3, v4, 3, v3
    s_lshl_b32 s24, s3, 5
    v_add_u32 v3, s24, v3
    ds_read_b64_tr_b16 a[128:129], v3 offset:0
    ds_read_b64_tr_b16 a[130:131], v3 offset:128
    ds_read_b64_tr_b16 a[132:133], v3 offset:256
    ds_read_b64_tr_b16 a[134:135], v3 offset:384
    ds_read_b64_tr_b16 a[136:137], v3 offset:512
    ds_read_b64_tr_b16 a[138:139], v3 offset:640
    ds_read_b64_tr_b16 a[140:141], v3 offset:768
    ds_read_b64_tr_b16 a[142:143], v3 offset:896
    ds_read_b64_tr_b16 a[144:145], v3 offset:16896
    ds_read_b64_tr_b16 a[146:147], v3 offset:17024
    ds_read_b64_tr_b16 a[148:149], v3 offset:17152
    ds_read_b64_tr_b16 a[150:151], v3 offset:17280
    ds_read_b64_tr_b16 a[152:153], v3 offset:17408
    ds_read_b64_tr_b16 a[154:155], v3 offset:17536
    ds_read_b64_tr_b16 a[156:157], v3 offset:17664
    ds_read_b64_tr_b16 a[158:159], v3 offset:17792
    ds_read_b64_tr_b16 a[160:161], v3 offset:33792
    ds_read_b64_tr_b16 a[162:163], v3 offset:33920
    ds_read_b64_tr_b16 a[164:165], v3 offset:34048
    ds_read_b64_tr_b16 a[166:167], v3 offset:34176
    ds_read_b64_tr_b16 a[168:169], v3 offset:34304
    ds_read_b64_tr_b16 a[170:171], v3 offset:34432
    ds_read_b64_tr_b16 a[172:173], v3 offset:34560
    ds_read_b64_tr_b16 a[174:175], v3 offset:34688
    ds_read_b64_tr_b16 a[176:177], v3 offset:50688
    ds_read_b64_tr_b16 a[178:179], v3 offset:50816
    ds_read_b64_tr_b16 a[180:181], v3 offset:50944
    ds_read_b64_tr_b16 a[182:183], v3 offset:51072
    ds_read_b64_tr_b16 a[184:185], v3 offset:51200
    ds_read_b64_tr_b16 a[186:187], v3 offset:51328
    ds_read_b64_tr_b16 a[188:189], v3 offset:51456
    ds_read_b64_tr_b16 a[190:191], v3 offset:51584
    s_and_b32 s70, s72, 3
    s_lshr_b32 s71, s72, 4
    s_bfe_u32 s24, s72, 0x10002
    s_lshl_b32 s24, s24, 1
    s_add_u32 s71, s71, s24
    s_bfe_u32 s75, s72, 0x10003
    s_lshl_b32 s30, s71, 22
    s_add_u32 s4, s38, s30
    s_addc_u32 s5, s39, 0
    s_mov_b32 s6, 0x400000
    s_mov_b32 s7, 0x20000
    s_mul_i32 s32, s3, 65536
    s_lshl_b32 s24, s70, 10
    s_add_u32 s32, s32, s24
    s_mul_i32 s34, s3, 16896
    s_waitcnt lgkmcnt(0)
    s_barrier
    s_mov_b32 m0, s34
    s_nop 0
    buffer_load_dwordx4 v2, s[4:7], s32 offen lds
    s_add_u32 m0, m0, 1056
    s_add_u32 s32, s32, 4096
    buffer_load_dwordx4 v2, s[4:7], s32 offen lds
    s_add_u32 m0, m0, 1056
    s_add_u32 s32, s32, 4096
    buffer_load_dwordx4 v2, s[4:7], s32 offen lds
    s_add_u32 m0, m0, 1056
    s_add_u32 s32, s32, 4096
    buffer_load_dwordx4 v2, s[4:7], s32 offen lds
    s_add_u32 m0, m0, 1056
    s_add_u32 s32, s32, 4096
    buffer_load_dwordx4 v2, s[4:7], s32 offen lds
    s_add_u32 m0, m0, 1056
    s_add_u32 s32, s32, 4096
    buffer_load_dwordx4 v2, s[4:7], s32 offen lds
    s_add_u32 m0, m0, 1056
    s_add_u32 s32, s32, 4096
    buffer_load_dwordx4 v2, s[4:7], s32 offen lds
    s_add_u32 m0, m0, 1056
    s_add_u32 s32, s32, 4096
    buffer_load_dwordx4 v2, s[4:7], s32 offen lds
    s_add_u32 m0, m0, 1056
    s_add_u32 s32, s32, 4096
    buffer_load_dwordx4 v2, s[4:7], s32 offen lds
    s_add_u32 m0, m0, 1056
    s_add_u32 s32, s32, 4096
    buffer_load_dwordx4 v2, s[4:7], s32 offen lds
    s_add_u32 m0, m0, 1056
    s_add_u32 s32, s32, 4096
    buffer_load_dwordx4 v2, s[4:7], s32 offen lds
    s_add_u32 m0, m0, 1056
    s_add_u32 s32, s32, 4096
    buffer_load_dwordx4 v2, s[4:7], s32 offen lds
    s_add_u32 m0, m0, 1056
    s_add_u32 s32, s32, 4096
    buffer_load_dwordx4 v2, s[4:7], s32 offen lds
    s_add_u32 m0, m0, 1056
    s_add_u32 s32, s32, 4096
    buffer_load_dwordx4 v2, s[4:7], s32 offen lds
    s_add_u32 m0, m0, 1056
    s_add_u32 s32, s32, 4096
    buffer_load_dwordx4 v2, s[4:7], s32 offen lds
    s_add_u32 m0, m0, 1056
    s_add_u32 s32, s32, 4096
    buffer_load_dwordx4 v2, s[4:7], s32 offen lds
    s_add_u32 m0, m0, 1056
    s_add_u32 s32, s32, 200704
    s_lshr_b32 s28, s3, 1
    s_and_b32 s29, s3, 1
    v_and_b32 v3, 15, v0
    v_lshrrev_b32 v4, 4, v0
    v_mul_u32_u24 v19, 1056, v3
    v_lshl_add_u32 v19, v4, 4, v19
    v_lshrrev_b32 v5, 2, v0
    v_mul_u32_u24 v20, 1056, v5
    v_and_b32 v5, 3, v0
    v_lshl_add_u32 v20, v5, 3, v20
    s_lshl_b32 s24, s29, 9
    v_add_u32 v20, s24, v20
    v_and_b32 v3, 15, v0
    v_mul_u32_u24 v18, 1056, v3
    v_lshl_add_u32 v18, v4, 4, v18
    v_add_u32 v18, 101376, v18
    s_mul_i32 s24, s28, 33792
    v_add_u32 v19, s24, v19
    v_add_u32 v20, s24, v20
    v_mov_b32 v128, 0
    v_mov_b32 v129, 0
    v_mov_b32 v130, 0
    v_mov_b32 v131, 0
    v_mov_b32 v132, 0
    v_mov_b32 v133, 0
    v_mov_b32 v134, 0
    v_mov_b32 v135, 0
    v_mov_b32 v136, 0
    v_mov_b32 v137, 0
    v_mov_b32 v138, 0
    v_mov_b32 v139, 0
    v_mov_b32 v140, 0
    v_mov_b32 v141, 0
    v_mov_b32 v142, 0
    v_mov_b32 v143, 0
    v_mov_b32 v144, 0
    v_mov_b32 v145, 0
    v_mov_b32 v146, 0
    v_mov_b32 v147, 0
    v_mov_b32 v148, 0
    v_mov_b32 v149, 0
    v_mov_b32 v150, 0
    v_mov_b32 v151, 0
    v_mov_b32 v152, 0
    v_mov_b32 v153, 0
    v_mov_b32 v154, 0
    v_mov_b32 v155, 0
    v_mov_b32 v156, 0
    v_mov_b32 v157, 0
    v_mov_b32 v158, 0
    v_mov_b32 v159, 0
    v_mov_b32 v160, 0
    v_mov_b32 v161, 0
    v_mov_b32 v162, 0
    v_mov_b32 v163, 0
    v_mov_b32 v164, 0
    v_mov_b32 v165, 0
    v_mov_b32 v166, 0
    v_mov_b32 v167, 0
    v_mov_b32 v168, 0
    v_mov_b32 v169, 0
    v_mov_b32 v170, 0
    v_mov_b32 v171, 0
    v_mov_b32 v172, 0
    v_mov_b32 v173, 0
    v_mov_b32 v174, 0
    v_mov_b32 v175, 0
    v_mov_b32 v176, 0
    v_mov_b32 v177, 0
    v_mov_b32 v178, 0
    v_mov_b32 v179, 0
    v_mov_b32 v180, 0
    v_mov_b32 v181, 0
    v_mov_b32 v182, 0
    v_mov_b32 v183, 0
    v_mov_b32 v184, 0
    v_mov_b32 v185, 0
    v_mov_b32 v186, 0
    v_mov_b32 v187, 0
    v_mov_b32 v188, 0
    v_mov_b32 v189, 0
    v_mov_b32 v190, 0
    v_mov_b32 v191, 0
    v_mov_b32 v22, 0xff800000
    v_mov_b32 v23, 0
    s_cmp_lg_u32 s3, 0
    s_cbranch_scc1 L_awx23
    s_mov_b32 s24, 262144
    s_mov_b64 exec, 1
L_aw24:
    buffer_load_dword v1, off, s[12:15], s73 offset:0 sc1
    s_waitcnt vmcnt(0)
    v_readfirstlane_b32 s25, v1
    s_nop 0
    s_cmp_eq_u32 s25, 1
    s_cbranch_scc1 L_awx23
    s_sleep 4
    s_sub_u32 s24, s24, 1
    s_cmp_lg_u32 s24, 0
    s_cbranch_scc1 L_aw24
L_awx23:
    s_mov_b64 exec, -1
    s_barrier
    s_lshl_b32 s24, s71, 17
    s_mul_i32 s25, s3, 16384
    s_add_u32 s24, s24, s25
    s_add_u32 s24, s24, 0x0
    s_mul_i32 s25, s75, 65536
    s_add_u32 s24, s24, s25
    buffer_load_dwordx4 v[32:35], v2, s[12:15], s24 offen sc1
    s_add_u32 s24, s24, 4096
    buffer_load_dwordx4 v[36:39], v2, s[12:15], s24 offen sc1
    s_add_u32 s24, s24, 4096
    buffer_load_dwordx4 v[40:43], v2, s[12:15], s24 offen sc1
    s_add_u32 s24, s24, 4096
    buffer_load_dwordx4 v[44:47], v2, s[12:15], s24 offen sc1
    s_add_u32 s24, s24, 4096
    s_mul_i32 s24, s3, 4224
    s_add_u32 s24, s24, 101376
    v_add_u32 v3, s24, v2
    s_waitcnt vmcnt(3)
    ds_write_b128 v3, v[32:35] offset:0
    s_waitcnt vmcnt(2)
    ds_write_b128 v3, v[36:39] offset:1056
    s_waitcnt vmcnt(1)
    ds_write_b128 v3, v[40:43] offset:2112
    s_waitcnt vmcnt(0)
    ds_write_b128 v3, v[44:47] offset:3168
    s_waitcnt lgkmcnt(0)
    s_barrier
    ds_read_b128 a[0:3], v18 offset:0
    ds_read_b128 a[4:7], v18 offset:64
    ds_read_b128 a[8:11], v18 offset:128
    ds_read_b128 a[12:15], v18 offset:192
    ds_read_b128 a[16:19], v18 offset:256
    ds_read_b128 a[20:23], v18 offset:320
    ds_read_b128 a[24:27], v18 offset:384
    ds_read_b128 a[28:31], v18 offset:448
    ds_read_b128 a[32:35], v18 offset:512
    ds_read_b128 a[36:39], v18 offset:576
    ds_read_b128 a[40:43], v18 offset:640
    ds_read_b128 a[44:47], v18 offset:704
    ds_read_b128 a[48:51], v18 offset:768
    ds_read_b128 a[52:55], v18 offset:832
    ds_read_b128 a[56:59], v18 offset:896
    ds_read_b128 a[60:63], v18 offset:960
    s_cmp_lg_u32 s3, 0
    s_cbranch_scc1 L_xi25
    s_and_b32 s24, s74, 7
    s_lshl_b32 s24, s24, 5
    s_lshr_b32 s25, s74, 3
    s_add_u32 s24, s24, s25
    s_lshl_b32 s24, s24, 2
    s_add_u32 s24, s24, 0x1d8000
    s_getreg_b32 s25, hwreg(HW_REG_XCC_ID, 0, 4)
    s_mov_b64 exec, 1
    v_mov_b32 v3, s25
    buffer_store_dword v3, off, s[12:15], s24 sc1
    s_mov_b64 exec, -1
L_xi25:
    s_mov_b32 s27, 0
    s_mov_b32 s33, 67584
    s_mov_b32 s35, 0
    s_waitcnt lgkmcnt(0)
L_CT:
    s_waitcnt vmcnt(0)
    s_barrier
    v_add_u32 v24, s35, v19
    v_add_u32 v25, s35, v20
    ds_read_b128 v[32:35], v24 offset:0
    ds_read_b128 v[36:39], v24 offset:16896
    ds_read_b128 v[40:43], v24 offset:64
    ds_read_b128 v[44:47], v24 offset:16960
    ds_read_b128 v[48:51], v24 offset:128
    ds_read_b128 v[52:55], v24 offset:17024
    ds_read_b128 v[56:59], v24 offset:192
    s_add_u32 m0, s33, s34
    s_mov_b32 s33, s35
    s_add_u32 s35, s35, 67584
    s_cmp_eq_u32 s35, 135168
    s_cselect_b32 s35, 0, s35
    s_waitcnt lgkmcnt(6)
    v_mfma_f32_16x16x32_bf16 v[64:67], v[32:35], a[0:3], 0
    ds_read_b128 v[60:63], v24 offset:17088
    buffer_load_dwordx4 v2, s[4:7], s32 offen lds
    s_add_u32 m0, m0, 1056
    s_add_u32 s32, s32, 4096
    s_waitcnt lgkmcnt(6)
    v_mfma_f32_16x16x32_bf16 v[68:71], v[36:39], a[0:3], 0
    ds_read_b128 v[32:35], v24 offset:256
    s_waitcnt lgkmcnt(6)
    v_mfma_f32_16x16x32_bf16 v[64:67], v[40:43], a[4:7], v[64:67]
    ds_read_b128 v[36:39], v24 offset:17152
    s_waitcnt lgkmcnt(6)
    v_mfma_f32_16x16x32_bf16 v[68:71], v[44:47], a[4:7], v[68:71]
    ds_read_b128 v[40:43], v24 offset:320
    s_waitcnt lgkmcnt(6)
    v_mfma_f32_16x16x32_bf16 v[64:67], v[48:51], a[8:11], v[64:67]
    ds_read_b128 v[44:47], v24 offset:17216
    buffer_load_dwordx4 v2, s[4:7], s32 offen lds
    s_add_u32 m0, m0, 1056
    s_add_u32 s32, s32, 4096
    s_waitcnt lgkmcnt(6)
    v_mfma_f32_16x16x32_bf16 v[68:71], v[52:55], a[8:11], v[68:71]
    ds_read_b128 v[48:51], v24 offset:384
    s_waitcnt lgkmcnt(6)
    v_mfma_f32_16x16x32_bf16 v[64:67], v[56:59], a[12:15], v[64:67]
    ds_read_b128 v[52:55], v24 offset:17280
    s_waitcnt lgkmcnt(6)
    v_mfma_f32_16x16x32_bf16 v[68:71], v[60:63], a[12:15], v[68:71]
    ds_read_b128 v[56:59], v24 offset:448
    s_waitcnt lgkmcnt(6)
    v_mfma_f32_16x16x32_bf16 v[64:67], v[32:35], a[16:19], v[64:67]
    ds_read_b128 v[60:63], v24 offset:17344
    buffer_load_dwordx4 v2, s[4:7], s32 offen lds
    s_add_u32 m0, m0, 1056
    s_add_u32 s32, s32, 4096
    s_waitcnt lgkmcnt(6)
    v_mfma_f32_16x16x32_bf16 v[68:71], v[36:39], a[16:19], v[68:71]
    ds_read_b128 v[32:35], v24 offset:512
    s_waitcnt lgkmcnt(6)
    v_mfma_f32_16x16x32_bf16 v[64:67], v[40:43], a[20:23], v[64:67]
    ds_read_b128 v[36:39], v24 offset:17408
    s_waitcnt lgkmcnt(6)
    v_mfma_f32_16x16x32_bf16 v[68:71], v[44:47], a[20:23], v[68:71]
    ds_read_b128 v[40:43], v24 offset:576
    s_waitcnt lgkmcnt(6)
    v_mfma_f32_16x16x32_bf16 v[64:67], v[48:51], a[24:27], v[64:67]
    ds_read_b128 v[44:47], v24 offset:17472
    buffer_load_dwordx4 v2, s[4:7], s32 offen lds
    s_add_u32 m0, m0, 1056
    s_add_u32 s32, s32, 4096
    s_waitcnt lgkmcnt(6)
    v_mfma_f32_16x16x32_bf16 v[68:71], v[52:55], a[24:27], v[68:71]
    ds_read_b128 v[48:51], v24 offset:640
    s_waitcnt lgkmcnt(6)
    v_mfma_f32_16x16x32_bf16 v[64:67], v[56:59], a[28:31], v[64:67]
    ds_read_b128 v[52:55], v24 offset:17536
    s_waitcnt lgkmcnt(6)
    v_mfma_f32_16x16x32_bf16 v[68:71], v[60:63], a[28:31], v[68:71]
    ds_read_b128 v[56:59], v24 offset:704
    s_waitcnt lgkmcnt(6)
    v_mfma_f32_16x16x32_bf16 v[64:67], v[32:35], a[32:35], v[64:67]
    ds_read_b128 v[60:63], v24 offset:17600
    buffer_load_dwordx4 v2, s[4:7], s32 offen lds
    s_add_u32 m0, m0, 1056
    s_add_u32 s32, s32, 4096
    s_waitcnt lgkmcnt(6)
    v_mfma_f32_16x16x32_bf16 v[68:71], v[36:39], a[32:35], v[68:71]
    ds_read_b128 v[32:35], v24 offset:768
    s_waitcnt lgkmcnt(6)
    v_mfma_f32_16x16x32_bf16 v[64:67], v[40:43], a[36:39], v[64:67]
    ds_read_b128 v[36:39], v24 offset:17664
    s_waitcnt lgkmcnt(6)
    v_mfma_f32_16x16x32_bf16 v[68:71], v[44:47], a[36:39], v[68:71]
    ds_read_b128 v[40:43], v24 offset:832
    s_waitcnt lgkmcnt(6)
    v_mfma_f32_16x16x32_bf16 v[64:67], v[48:51], a[40:43], v[64:67]
    ds_read_b128 v[44:47], v24 offset:17728
    buffer_load_dwordx4 v2, s[4:7], s32 offen lds
    s_add_u32 m0, m0, 1056
    s_add_u32 s32, s32, 4096
    s_waitcnt lgkmcnt(6)
    v_mfma_f32_16x16x32_bf16 v[68:71], v[52:55], a[40:43], v[68:71]
    ds_read_b128 v[48:51], v24 offset:896
    s_waitcnt lgkmcnt(6)
    v_mfma_f32_16x16x32_bf16 v[64:67], v[56:59], a[44:47], v[64:67]
    ds_read_b128 v[52:55], v24 offset:17792
    s_waitcnt lgkmcnt(6)
    v_mfma_f32_16x16x32_bf16 v[68:71], v[60:63], a[44:47], v[68:71]
    ds_read_b128 v[56:59], v24 offset:960
    s_waitcnt lgkmcnt(6)
    v_mfma_f32_16x16x32_bf16 v[64:67], v[32:35], a[48:51], v[64:67]
    ds_read_b128 v[60:63], v24 offset:17856
    buffer_load_dwordx4 v2, s[4:7], s32 offen lds
    s_add_u32 m0, m0, 1056
    s_add_u32 s32, s32, 4096
    s_waitcnt lgkmcnt(6)
    v_mfma_f32_16x16x32_bf16 v[68:71], v[36:39], a[48:51], v[68:71]
    ds_read_b64_tr_b16 v[192:193], v25 offset:0
    s_waitcnt lgkmcnt(6)
    v_mfma_f32_16x16x32_bf16 v[64:67], v[40:43], a[52:55], v[64:67]
    ds_read_b64_tr_b16 v[194:195], v25 offset:16896
    s_waitcnt lgkmcnt(6)
    v_mfma_f32_16x16x32_bf16 v[68:71], v[44:47], a[52:55], v[68:71]
    ds_read_b64_tr_b16 v[196:197], v25 offset:32
    s_waitcnt lgkmcnt(6)
    v_mfma_f32_16x16x32_bf16 v[64:67], v[48:51], a[56:59], v[64:67]
    ds_read_b64_tr_b16 v[198:199], v25 offset:16928
    buffer_load_dwordx4 v2, s[4:7], s32 offen lds
    s_add_u32 m0, m0, 1056
    s_add_u32 s32, s32, 4096
    s_waitcnt lgkmcnt(6)
    v_mfma_f32_16x16x32_bf16 v[68:71], v[52:55], a[56:59], v[68:71]
    ds_read_b64_tr_b16 v[200:201], v25 offset:64
    s_waitcnt lgkmcnt(6)
    v_mfma_f32_16x16x32_bf16 v[64:67], v[56:59], a[60:63], v[64:67]
    ds_read_b64_tr_b16 v[202:203], v25 offset:16960
    s_waitcnt lgkmcnt(6)
    v_mfma_f32_16x16x32_bf16 v[68:71], v[60:63], a[60:63], v[68:71]
    ds_read_b64_tr_b16 v[204:205], v25 offset:96
    ds_read_b64_tr_b16 v[206:207], v25 offset:16992
    ds_read_b64_tr_b16 v[208:209], v25 offset:128
    ds_read_b64_tr_b16 v[210:211], v25 offset:17024
    ds_read_b64_tr_b16 v[212:213], v25 offset:160
    ds_read_b64_tr_b16 v[214:215], v25 offset:17056
    ds_read_b64_tr_b16 v[216:217], v25 offset:192
    ds_read_b64_tr_b16 v[218:219], v25 offset:17088
    v_max3_f32 v3, v64, v65, v22
    buffer_load_dwordx4 v2, s[4:7], s32 offen lds
    s_add_u32 m0, m0, 1056
    s_add_u32 s32, s32, 4096
    v_max3_f32 v3, v3, v66, v67
    v_max3_f32 v3, v3, v68, v69
    buffer_load_dwordx4 v2, s[4:7], s32 offen lds
    s_add_u32 m0, m0, 1056
    s_add_u32 s32, s32, 4096
    v_max3_f32 v3, v3, v70, v71
    v_mov_b32 v4, v3
    ds_read_b64_tr_b16 v[220:221], v25 offset:224
    buffer_load_dwordx4 v2, s[4:7], s32 offen lds
    s_add_u32 m0, m0, 1056
    s_add_u32 s32, s32, 4096
    v_permlane32_swap_b32 v3, v4
    ds_read_b64_tr_b16 v[222:223], v25 offset:17120
    v_max_f32 v3, v3, v4
    ds_read_b64_tr_b16 v[224:225], v25 offset:256
    buffer_load_dwordx4 v2, s[4:7], s32 offen lds
    s_add_u32 m0, m0, 1056
    s_add_u32 s32, s32, 4096
    v_mov_b32 v4, v3
    ds_read_b64_tr_b16 v[226:227], v25 offset:17152
    s_nop 0
    v_permlane16_swap_b32 v3, v4
    ds_read_b64_tr_b16 v[228:229], v25 offset:288
    buffer_load_dwordx4 v2, s[4:7], s32 offen lds
    s_add_u32 m0, m0, 1056
    s_add_u32 s32, s32, 4096
    v_max_f32 v3, v3, v4
    ds_read_b64_tr_b16 v[230:231], v25 offset:17184
    v_sub_f32 v4, v22, v3
    ds_read_b64_tr_b16 v[232:233], v25 offset:320
    buffer_load_dwordx4 v2, s[4:7], s32 offen lds
    s_add_u32 m0, m0, 1056
    s_add_u32 s32, s32, 4096
    v_exp_f32 v4, v4
    ds_read_b64_tr_b16 v[234:235], v25 offset:17216
    v_mov_b32 v22, v3
    ds_read_b64_tr_b16 v[236:237], v25 offset:352
    buffer_load_dwordx4 v2, s[4:7], s32 offen lds
    s_add_u32 m0, m0, 1056
    s_add_u32 s32, s32, 4096
    v_sub_f32 v64, v64, v3
    ds_read_b64_tr_b16 v[238:239], v25 offset:17248
    v_sub_f32 v65, v65, v3
    ds_read_b64_tr_b16 v[240:241], v25 offset:384
    buffer_load_dwordx4 v2, s[4:7], s32 offen lds
    s_add_u32 m0, m0, 1056
    s_add_u32 s32, s32, 200704
    v_sub_f32 v66, v66, v3
    ds_read_b64_tr_b16 v[242:243], v25 offset:17280
    v_sub_f32 v67, v67, v3
    ds_read_b64_tr_b16 v[244:245], v25 offset:416
    v_sub_f32 v68, v68, v3
    ds_read_b64_tr_b16 v[246:247], v25 offset:17312
    v_sub_f32 v69, v69, v3
    ds_read_b64_tr_b16 v[248:249], v25 offset:448
    v_sub_f32 v70, v70, v3
    ds_read_b64_tr_b16 v[250:251], v25 offset:17344
    v_sub_f32 v71, v71, v3
    ds_read_b64_tr_b16 v[252:253], v25 offset:480
    v_exp_f32 v64, v64
    ds_read_b64_tr_b16 v[254:255], v25 offset:17376
    v_exp_f32 v65, v65
    v_exp_f32 v66, v66
    v_exp_f32 v67, v67
    v_exp_f32 v68, v68
    v_exp_f32 v69, v69
    v_exp_f32 v70, v70
    v_exp_f32 v71, v71
    v_cvt_pk_bf16_f32 v72, v64, v65
    v_cvt_pk_bf16_f32 v73, v66, v67
    v_cvt_pk_bf16_f32 v74, v68, v69
    v_cvt_pk_bf16_f32 v75, v70, v71
    v_mul_f32 v128, v128, v4
    v_mul_f32 v129, v129, v4
    v_mul_f32 v130, v130, v4
    v_mul_f32 v131, v131, v4
    v_mul_f32 v132, v132, v4
    v_mul_f32 v133, v133, v4
    v_mul_f32 v134, v134, v4
    v_mul_f32 v135, v135, v4
    s_waitcnt lgkmcnt(0)
    v_mfma_f32_16x16x32_bf16 v[128:131], v[192:195], v[72:75], v[128:131]
    v_mul_f32 v136, v136, v4
    v_mul_f32 v137, v137, v4
    v_mul_f32 v138, v138, v4
    v_mul_f32 v139, v139, v4
    v_mfma_f32_16x16x32_bf16 v[132:135], v[196:199], v[72:75], v[132:135]
    v_mul_f32 v140, v140, v4
    v_mul_f32 v141, v141, v4
    v_mul_f32 v142, v142, v4
    v_mul_f32 v143, v143, v4
    v_mfma_f32_16x16x32_bf16 v[136:139], v[200:203], v[72:75], v[136:139]
    v_mul_f32 v144, v144, v4
    v_mul_f32 v145, v145, v4
    v_mul_f32 v146, v146, v4
    v_mul_f32 v147, v147, v4
    v_mfma_f32_16x16x32_bf16 v[140:143], v[204:207], v[72:75], v[140:143]
    v_mul_f32 v148, v148, v4
    v_mul_f32 v149, v149, v4
    v_mul_f32 v150, v150, v4
    v_mul_f32 v151, v151, v4
    v_mfma_f32_16x16x32_bf16 v[144:147], v[208:211], v[72:75], v[144:147]
    v_mul_f32 v152, v152, v4
    v_mul_f32 v153, v153, v4
    v_mul_f32 v154, v154, v4
    v_mul_f32 v155, v155, v4
    v_mfma_f32_16x16x32_bf16 v[148:151], v[212:215], v[72:75], v[148:151]
    v_mul_f32 v156, v156, v4
    v_mul_f32 v157, v157, v4
    v_mul_f32 v158, v158, v4
    v_mul_f32 v159, v159, v4
    v_mfma_f32_16x16x32_bf16 v[152:155], v[216:219], v[72:75], v[152:155]
    v_mul_f32 v160, v160, v4
    v_mul_f32 v161, v161, v4
    v_mul_f32 v162, v162, v4
    v_mul_f32 v163, v163, v4
    v_mfma_f32_16x16x32_bf16 v[156:159], v[220:223], v[72:75], v[156:159]
    v_mul_f32 v164, v164, v4
    v_mul_f32 v165, v165, v4
    v_mul_f32 v166, v166, v4
    v_mul_f32 v167, v167, v4
    v_mfma_f32_16x16x32_bf16 v[160:163], v[224:227], v[72:75], v[160:163]
    v_mul_f32 v168, v168, v4
    v_mul_f32 v169, v169, v4
    v_mul_f32 v170, v170, v4
    v_mul_f32 v171, v171, v4
    v_mfma_f32_16x16x32_bf16 v[164:167], v[228:231], v[72:75], v[164:167]
    v_mul_f32 v172, v172, v4
    v_mul_f32 v173, v173, v4
    v_mul_f32 v174, v174, v4
    v_mul_f32 v175, v175, v4
    v_mfma_f32_16x16x32_bf16 v[168:171], v[232:235], v[72:75], v[168:171]
    v_mul_f32 v176, v176, v4
    v_mul_f32 v177, v177, v4
    v_mul_f32 v178, v178, v4
    v_mul_f32 v179, v179, v4
    v_mfma_f32_16x16x32_bf16 v[172:175], v[236:239], v[72:75], v[172:175]
    v_mul_f32 v180, v180, v4
    v_mul_f32 v181, v181, v4
    v_mul_f32 v182, v182, v4
    v_mul_f32 v183, v183, v4
    v_mfma_f32_16x16x32_bf16 v[176:179], v[240:243], v[72:75], v[176:179]
    v_mul_f32 v184, v184, v4
    v_mul_f32 v185, v185, v4
    v_mul_f32 v186, v186, v4
    v_mul_f32 v187, v187, v4
    v_mfma_f32_16x16x32_bf16 v[180:183], v[244:247], v[72:75], v[180:183]
    v_mul_f32 v188, v188, v4
    v_mul_f32 v189, v189, v4
    v_mul_f32 v190, v190, v4
    v_mul_f32 v191, v191, v4
    v_mfma_f32_16x16x32_bf16 v[184:187], v[248:251], v[72:75], v[184:187]
    s_nop 0
    v_mfma_f32_16x16x32_bf16 v[188:191], v[252:255], v[72:75], v[188:191]
    v_fma_f32 v23, v23, v4, v64
    v_add_f32 v23, v23, v65
    v_add_f32 v23, v23, v66
    v_add_f32 v23, v23, v67
    v_add_f32 v23, v23, v68
    v_add_f32 v23, v23, v69
    v_add_f32 v23, v23, v70
    v_add_f32 v23, v23, v71
    s_add_u32 s27, s27, 1
    s_cmp_lt_u32 s27, 16
    s_cbranch_scc1 L_CT
    s_waitcnt vmcnt(0)
    s_barrier
    v_mov_b32 v4, v23
    s_nop 1
    v_permlane32_swap_b32 v23, v4
    v_add_f32 v23, v23, v4
    v_mov_b32 v4, v23
    s_nop 1
    v_permlane16_swap_b32 v23, v4
    v_add_f32 v23, v23, v4
    s_lshl_b32 s24, s3, 9
    v_lshl_add_u32 v3, v0, 3, s24
    ds_write_b64 v3, v[22:23] offset:0
    v_xor_b32 v3, 0x400, v3
    s_waitcnt lgkmcnt(0)
    s_barrier
    ds_read_b64 v[6:7], v3 offset:0
    s_waitcnt lgkmcnt(0)
    v_max_f32 v3, v22, v6
    v_sub_f32 v4, v22, v3
    v_sub_f32 v6, v6, v3
    v_exp_f32 v4, v4
    v_exp_f32 v6, v6
    v_mov_b32 v22, v3
    v_mul_f32 v23, v23, v4
    v_fmac_f32 v23, v7, v6
    v_and_b32 v3, 15, v0
    v_lshlrev_b32 v5, 3, v3
    s_lshl_b32 s24, s71, 2
    s_add_u32 s31, s24, s70
    s_lshl_b32 s24, s31, 8
    s_mul_i32 s25, s75, 128
    s_add_u32 s24, s24, s25
    s_add_u32 s24, s24, 0x120000
    s_cmp_lg_u32 s3, 0
    s_cbranch_scc1 L_C_ml
    s_mov_b64 exec, 0xffff
    buffer_store_dwordx2 v[22:23], v5, s[12:15], s24 offen sc1
    s_mov_b64 exec, -1
L_C_ml:
    v_pk_mul_f32 v[128:129], v[128:129], v[4:5] op_sel_hi:[1,0]
    v_pk_mul_f32 v[130:131], v[130:131], v[4:5] op_sel_hi:[1,0]
    v_pk_mul_f32 v[132:133], v[132:133], v[4:5] op_sel_hi:[1,0]
    v_pk_mul_f32 v[134:135], v[134:135], v[4:5] op_sel_hi:[1,0]
    v_pk_mul_f32 v[136:137], v[136:137], v[4:5] op_sel_hi:[1,0]
    v_pk_mul_f32 v[138:139], v[138:139], v[4:5] op_sel_hi:[1,0]
    v_pk_mul_f32 v[140:141], v[140:141], v[4:5] op_sel_hi:[1,0]
    v_pk_mul_f32 v[142:143], v[142:143], v[4:5] op_sel_hi:[1,0]
    v_pk_mul_f32 v[144:145], v[144:145], v[4:5] op_sel_hi:[1,0]
    v_pk_mul_f32 v[146:147], v[146:147], v[4:5] op_sel_hi:[1,0]
    v_pk_mul_f32 v[148:149], v[148:149], v[4:5] op_sel_hi:[1,0]
    v_pk_mul_f32 v[150:151], v[150:151], v[4:5] op_sel_hi:[1,0]
    v_pk_mul_f32 v[152:153], v[152:153], v[4:5] op_sel_hi:[1,0]
    v_pk_mul_f32 v[154:155], v[154:155], v[4:5] op_sel_hi:[1,0]
    v_pk_mul_f32 v[156:157], v[156:157], v[4:5] op_sel_hi:[1,0]
    v_pk_mul_f32 v[158:159], v[158:159], v[4:5] op_sel_hi:[1,0]
    v_pk_mul_f32 v[160:161], v[160:161], v[4:5] op_sel_hi:[1,0]
    v_pk_mul_f32 v[162:163], v[162:163], v[4:5] op_sel_hi:[1,0]
    v_pk_mul_f32 v[164:165], v[164:165], v[4:5] op_sel_hi:[1,0]
    v_pk_mul_f32 v[166:167], v[166:167], v[4:5] op_sel_hi:[1,0]
    v_pk_mul_f32 v[168:169], v[168:169], v[4:5] op_sel_hi:[1,0]
    v_pk_mul_f32 v[170:171], v[170:171], v[4:5] op_sel_hi:[1,0]
    v_pk_mul_f32 v[172:173], v[172:173], v[4:5] op_sel_hi:[1,0]
    v_pk_mul_f32 v[174:175], v[174:175], v[4:5] op_sel_hi:[1,0]
    v_pk_mul_f32 v[176:177], v[176:177], v[4:5] op_sel_hi:[1,0]
    v_pk_mul_f32 v[178:179], v[178:179], v[4:5] op_sel_hi:[1,0]
    v_pk_mul_f32 v[180:181], v[180:181], v[4:5] op_sel_hi:[1,0]
    v_pk_mul_f32 v[182:183], v[182:183], v[4:5] op_sel_hi:[1,0]
    v_pk_mul_f32 v[184:185], v[184:185], v[4:5] op_sel_hi:[1,0]
    v_pk_mul_f32 v[186:187], v[186:187], v[4:5] op_sel_hi:[1,0]
    v_pk_mul_f32 v[188:189], v[188:189], v[4:5] op_sel_hi:[1,0]
    v_pk_mul_f32 v[190:191], v[190:191], v[4:5] op_sel_hi:[1,0]
    s_lshl_b32 s24, s3, 13
    s_add_u32 s24, s24, 4096
    v_add_u32 v6, s24, v2
    s_xor_b32 s24, s3, 2
    s_lshl_b32 s24, s24, 13
    s_add_u32 s24, s24, 4096
    v_add_u32 v7, s24, v2
    s_cmp_lg_u32 s28, 0
    s_cbranch_scc1 L_C_x1
    ds_write_b128 v6, v[160:163] offset:0
    ds_write_b128 v6, v[164:167] offset:1024
    ds_write_b128 v6, v[168:171] offset:2048
    ds_write_b128 v6, v[172:175] offset:3072
    ds_write_b128 v6, v[176:179] offset:4096
    ds_write_b128 v6, v[180:183] offset:5120
    ds_write_b128 v6, v[184:187] offset:6144
    ds_write_b128 v6, v[188:191] offset:7168
    s_branch L_C_x2
L_C_x1:
    ds_write_b128 v6, v[128:131] offset:0
    ds_write_b128 v6, v[132:135] offset:1024
    ds_write_b128 v6, v[136:139] offset:2048
    ds_write_b128 v6, v[140:143] offset:3072
    ds_write_b128 v6, v[144:147] offset:4096
    ds_write_b128 v6, v[148:151] offset:5120
    ds_write_b128 v6, v[152:155] offset:6144
    ds_write_b128 v6, v[156:159] offset:7168
    s_waitcnt lgkmcnt(0)
    v_mov_b32 v128, v160
    v_mov_b32 v129, v161
    v_mov_b32 v130, v162
    v_mov_b32 v131, v163
    v_mov_b32 v132, v164
    v_mov_b32 v133, v165
    v_mov_b32 v134, v166
    v_mov_b32 v135, v167
    v_mov_b32 v136, v168
    v_mov_b32 v137, v169
    v_mov_b32 v138, v170
    v_mov_b32 v139, v171
    v_mov_b32 v140, v172
    v_mov_b32 v141, v173
    v_mov_b32 v142, v174
    v_mov_b32 v143, v175
    v_mov_b32 v144, v176
    v_mov_b32 v145, v177
    v_mov_b32 v146, v178
    v_mov_b32 v147, v179
    v_mov_b32 v148, v180
    v_mov_b32 v149, v181
    v_mov_b32 v150, v182
    v_mov_b32 v151, v183
    v_mov_b32 v152, v184
    v_mov_b32 v153, v185
    v_mov_b32 v154, v186
    v_mov_b32 v155, v187
    v_mov_b32 v156, v188
    v_mov_b32 v157, v189
    v_mov_b32 v158, v190
    v_mov_b32 v159, v191
L_C_x2:
    s_waitcnt lgkmcnt(0)
    s_barrier
    ds_read_b128 v[192:195], v7 offset:0
    ds_read_b128 v[196:199], v7 offset:1024
    ds_read_b128 v[200:203], v7 offset:2048
    ds_read_b128 v[204:207], v7 offset:3072
    ds_read_b128 v[208:211], v7 offset:4096
    ds_read_b128 v[212:215], v7 offset:5120
    ds_read_b128 v[216:219], v7 offset:6144
    ds_read_b128 v[220:223], v7 offset:7168
    v_lshrrev_b32 v4, 4, v0
    v_mul_u32_u24 v3, 272, v3
    v_lshl_add_u32 v3, v4, 3, v3
    s_mul_i32 s24, s3, 4352
    s_add_u32 s24, s24, 40960
    v_add_u32 v3, s24, v3
    s_waitcnt lgkmcnt(7)
    v_add_f32 v128, v128, v192
    v_add_f32 v129, v129, v193
    v_add_f32 v130, v130, v194
    v_add_f32 v131, v131, v195
    v_cvt_pk_bf16_f32 v32, v128, v129
    v_cvt_pk_bf16_f32 v33, v130, v131
    ds_write_b64 v3, v[32:33] offset:0
    s_waitcnt lgkmcnt(7)
    v_add_f32 v132, v132, v196
    v_add_f32 v133, v133, v197
    v_add_f32 v134, v134, v198
    v_add_f32 v135, v135, v199
    v_cvt_pk_bf16_f32 v34, v132, v133
    v_cvt_pk_bf16_f32 v35, v134, v135
    ds_write_b64 v3, v[34:35] offset:32
    s_waitcnt lgkmcnt(7)
    v_add_f32 v136, v136, v200
    v_add_f32 v137, v137, v201
    v_add_f32 v138, v138, v202
    v_add_f32 v139, v139, v203
    v_cvt_pk_bf16_f32 v36, v136, v137
    v_cvt_pk_bf16_f32 v37, v138, v139
    ds_write_b64 v3, v[36:37] offset:64
    s_waitcnt lgkmcnt(7)
    v_add_f32 v140, v140, v204
    v_add_f32 v141, v141, v205
    v_add_f32 v142, v142, v206
    v_add_f32 v143, v143, v207
    v_cvt_pk_bf16_f32 v38, v140, v141
    v_cvt_pk_bf16_f32 v39, v142, v143
    ds_write_b64 v3, v[38:39] offset:96
    s_waitcnt lgkmcnt(7)
    v_add_f32 v144, v144, v208
    v_add_f32 v145, v145, v209
    v_add_f32 v146, v146, v210
    v_add_f32 v147, v147, v211
    v_cvt_pk_bf16_f32 v40, v144, v145
    v_cvt_pk_bf16_f32 v41, v146, v147
    ds_write_b64 v3, v[40:41] offset:128
    s_waitcnt lgkmcnt(7)
    v_add_f32 v148, v148, v212
    v_add_f32 v149, v149, v213
    v_add_f32 v150, v150, v214
    v_add_f32 v151, v151, v215
    v_cvt_pk_bf16_f32 v42, v148, v149
    v_cvt_pk_bf16_f32 v43, v150, v151
    ds_write_b64 v3, v[42:43] offset:160
    s_waitcnt lgkmcnt(7)
    v_add_f32 v152, v152, v216
    v_add_f32 v153, v153, v217
    v_add_f32 v154, v154, v218
    v_add_f32 v155, v155, v219
    v_cvt_pk_bf16_f32 v44, v152, v153
    v_cvt_pk_bf16_f32 v45, v154, v155
    ds_write_b64 v3, v[44:45] offset:192
    s_waitcnt lgkmcnt(7)
    v_add_f32 v156, v156, v220
    v_add_f32 v157, v157, v221
    v_add_f32 v158, v158, v222
    v_add_f32 v159, v159, v223
    v_cvt_pk_bf16_f32 v46, v156, v157
    v_cvt_pk_bf16_f32 v47, v158, v159
    ds_write_b64 v3, v[46:47] offset:224
    v_and_b32 v5, 15, v0
    v_mul_u32_u24 v3, 272, v4
    v_lshl_add_u32 v3, v5, 4, v3
    v_add_u32 v3, s24, v3
    v_lshlrev_b32 v4, 11, v4
    v_lshl_add_u32 v4, v5, 4, v4
    s_waitcnt lgkmcnt(0)
    ds_read_b128 v[64:67], v3 offset:0
    ds_read_b128 v[68:71], v3 offset:1088
    ds_read_b128 v[72:75], v3 offset:2176
    ds_read_b128 v[76:79], v3 offset:3264
    s_lshl_b32 s24, s31, 16
    s_lshl_b32 s25, s29, 9
    s_add_u32 s24, s24, s25
    s_lshl_b32 s25, s28, 8
    s_add_u32 s24, s24, s25
    s_mul_i32 s25, s75, 32768
    s_add_u32 s24, s24, s25
    s_add_u32 s24, s24, 0x400000
    s_waitcnt lgkmcnt(3)
    buffer_store_dwordx4 v[64:67], v4, s[12:15], s24 offen sc1 nt
    s_add_u32 s24, s24, 8192
    s_waitcnt lgkmcnt(2)
    buffer_store_dwordx4 v[68:71], v4, s[12:15], s24 offen sc1 nt
    s_add_u32 s24, s24, 8192
    s_waitcnt lgkmcnt(1)
    buffer_store_dwordx4 v[72:75], v4, s[12:15], s24 offen sc1 nt
    s_add_u32 s24, s24, 8192
    s_waitcnt lgkmcnt(0)
    buffer_store_dwordx4 v[76:79], v4, s[12:15], s24 offen sc1 nt
    s_add_u32 s24, s24, 8192
    s_waitcnt vmcnt(0)
    s_barrier
    s_cmp_lg_u32 s3, 0
    s_cbranch_scc1 L_sig26
    s_mov_b64 exec, 1
    v_mov_b32 v3, 1
    buffer_atomic_add v3, off, s[16:19], 0 offset:4 sc0
    s_waitcnt vmcnt(0)
    v_readfirstlane_b32 s24, v3
    s_mov_b64 exec, -1
    s_and_b32 s24, s24, 31
    s_cmp_lg_u32 s24, 31
    s_cbranch_scc1 L_sig26
    v_lshlrev_b32 v4, 7, v0
    v_mov_b32 v3, 1
    s_mov_b32 s24, 0x170000
    s_mov_b32 exec_hi, 0
    buffer_store_dword v3, v4, s[12:15], s24 offen offset:4 sc1
    s_mov_b64 exec, -1
L_sig26:
    s_branch L_R
L_last:
    s_endpgm
.section .rodata,"a"
.p2align 6
.amdhsa_kernel concat_heads__compressed_kv_cla__mha_block_cached__decode_kernel
  .amdhsa_next_free_vgpr 448
  .amdhsa_next_free_sgpr 102
  .amdhsa_accum_offset 256
  .amdhsa_group_segment_fixed_size 0
  .amdhsa_kernarg_size 112
  .amdhsa_user_sgpr_count 2
  .amdhsa_user_sgpr_kernarg_segment_ptr 1
  .amdhsa_system_sgpr_workgroup_id_x 1
  .amdhsa_float_denorm_mode_32 3
.end_amdhsa_kernel
```

```asm
; @launch grid=(256,1,1) block=(256,1,1) lds=147456
.amdgcn_target "amdgcn-amd-amdhsa--gfx950"
.text
.globl concat_heads__compressed_kv_cla__mha_block_cached__decode_kernel
.p2align 8
.type concat_heads__compressed_kv_cla__mha_block_cached__decode_kernel,@function
concat_heads__compressed_kv_cla__mha_block_cached__decode_kernel:
    s_load_dwordx16 s[36:51], s[0:1], 0
    s_load_dwordx8 s[52:59], s[0:1], 64
    s_load_dwordx4 s[60:63], s[0:1], 96
    s_cmp_ge_u32 s2, 256
    s_cbranch_scc1 L_end
    s_cmp_lt_u32 s2, 64
    s_getpc_b64 s[24:25]
L_pc0:
    s_cselect_b32 s20, L_A-L_pc0, 0
    v_lshlrev_b32 v16, 7, v0
    v_min_u32 v16, L_A-L_pc0-4, v16
    v_add_u32 v16, s20, v16
    v_add_co_u32 v16, vcc, s24, v16
    v_mov_b32 v17, s25
    s_nop 0
    v_addc_co_u32 v17, vcc, 0, v17, vcc
    global_load_dword v17, v[16:17], off
    s_cbranch_scc1 L_A
L_B:
    s_and_b32 s70, s2, 6
    s_and_b32 s25, s2, 7
    s_add_u32 s70, s70, s25
    s_lshl_b32 s25, s70, 8
    v_and_b32 v6, 15, v0
    v_lshl_add_u32 v24, v6, 4, s25
    v_and_b32 v4, 16, v0
    v_lshl_add_u32 v24, v4, 5, v24
    v_lshrrev_b32 v4, 5, v0
    v_lshl_add_u32 v24, v4, 12, v24
    s_lshr_b32 s74, s2, 3
    s_lshl_b32 s74, s74, 2
    s_addk_i32 s74, -32
    s_mov_b32 s10, 0x400000
    s_mov_b32 s11, 0x20000
    s_waitcnt lgkmcnt(0)
    s_mov_b64 s[8:9], s[54:55]
L_pfb:
    s_lshl_b32 s24, s74, 13
    buffer_load_dwordx4 v[28:31], v24, s[8:11], s24 offen
    s_addk_i32 s74, 96
    s_cmpk_lt_u32 s74, 512
    s_cbranch_scc1 L_pfb
    s_addk_i32 s74, -512
    s_mov_b64 s[8:9], s[40:41]
L_pfq:
    s_lshl_b32 s24, s74, 13
    buffer_load_dwordx4 v[28:31], v24, s[8:11], s24 offen
    s_addk_i32 s74, 96
    s_cmpk_lt_u32 s74, 512
    s_cbranch_scc1 L_pfq
    s_addk_i32 s74, -512
    v_lshrrev_b32 v1, 6, v0
    v_and_b32 v0, 63, v0
    v_readfirstlane_b32 s3, v1
    v_lshlrev_b32 v2, 4, v0
    s_lshr_b32 s24, s2, 3
    s_sub_u32 s24, s24, 8
    s_mul_i32 s26, s24, 43
    s_lshr_b32 s26, s26, 8
    s_mul_i32 s27, s26, 6
    s_sub_u32 s27, s24, s27
    s_and_b32 s25, s26, 1
    s_lshl_b32 s25, s25, 1
    s_and_b32 s26, s26, 2
    s_lshl_b32 s26, s26, 3
    s_or_b32 s26, s26, s25
    s_or_b32 s26, s26, s70
    s_lshl_b32 s25, s70, 17
    s_lshl_b32 s24, s3, 8
    s_add_u32 s25, s25, s24
    v_lshl_add_u32 v25, v6, 4, s25
    v_and_b32 v4, 16, v0
    v_lshl_add_u32 v25, v4, 14, v25
    v_and_b32 v4, 32, v0
    v_lshl_add_u32 v25, v4, 16, v25
    s_and_b32 s25, s2, 3
    s_lshl_b32 s25, s25, 10
    s_lshl_b32 s24, s3, 12
    s_add_u32 s25, s25, s24
    s_bfe_u32 s24, s2, 0x10002
    s_lshl_b32 s24, s24, 23
    s_add_u32 s25, s25, s24
    v_add_u32 v26, s25, v2
    s_cmp_ge_u32 s27, 3
    s_cselect_b32 s28, 1, 0
    s_mul_i32 s29, s28, 3
    s_sub_u32 s29, s27, s29
    s_lshr_b32 s72, s3, 1
    s_lshl_b32 s24, s28, 1
    s_add_u32 s72, s72, s24
    s_and_b32 s31, s3, 1
    s_lshl_b32 s24, s29, 1
    s_add_u32 s31, s31, s24
    s_lshl_b32 s30, s72, 5
    s_add_u32 s30, s30, s26
    s_lshl_b32 s30, s30, 20
    v_lshrrev_b32 v3, 4, v0
    v_and_b32 v4, 3, v0
    v_lshlrev_b32 v5, 6, v3
    v_lshl_add_u32 v5, v4, 4, v5
    v_bfe_u32 v1, v0, 2, 2
    v_lshl_add_u32 v1, v1, 8, v5
    s_mul_i32 s35, s31, 1024
    s_add_u32 s32, s35, 983040
    s_mul_i32 s28, s31, 1024
    s_add_u32 s28, s28, 1044480
    s_mov_b32 s6, 0x100000
    s_mov_b32 s7, 0x20000
    s_add_u32 s4, s50, s30
    s_addc_u32 s5, s51, 0
    s_mov_b32 s12, s62
    s_mov_b32 s13, s63
    s_mov_b32 s14, 0x600000
    s_mov_b32 s15, 0x20000
    s_mov_b32 s16, s60
    s_mov_b32 s17, s61
    s_mov_b32 s18, 0x100
    s_mov_b32 s19, 0x20000
    v_and_b32 v3, 1, v0
    v_lshlrev_b32 v3, 4, v3
    v_mov_b32 v4, 0xffff
    v_lshlrev_b32 v4, v3, v4
    v_bfe_u32 v3, v0, 1, 2
    v_cmp_eq_u32 vcc, 0, v3
    s_nop 1
    v_cndmask_b32 v20, 0, v4, vcc
    v_cmp_eq_u32 vcc, 1, v3
    s_nop 1
    v_cndmask_b32 v21, 0, v4, vcc
    v_cmp_eq_u32 vcc, 2, v3
    s_nop 1
    v_cndmask_b32 v22, 0, v4, vcc
    v_cmp_eq_u32 vcc, 3, v3
    s_nop 1
    v_cndmask_b32 v23, 0, v4, vcc
    s_mov_b32 s64, 0x22222222
    s_mov_b32 s65, 0x22222222
    s_mov_b32 s66, 0x44444444
    s_mov_b32 s67, 0x44444444
    s_mov_b32 s68, 0x88888888
    s_mov_b32 s69, 0x88888888
    v_mov_b32 v32, 0
    v_mov_b32 v33, 0
    v_mov_b32 v34, 0
    v_mov_b32 v35, 0
    v_mov_b32 v36, 0
    v_mov_b32 v37, 0
    v_mov_b32 v38, 0
    v_mov_b32 v39, 0
    v_mov_b32 v40, 0
    v_mov_b32 v41, 0
    v_mov_b32 v42, 0
    v_mov_b32 v43, 0
    v_mov_b32 v44, 0
    v_mov_b32 v45, 0
    v_mov_b32 v46, 0
    v_mov_b32 v47, 0
    v_lshrrev_b32 v3, 4, v0
    v_lshlrev_b32 v60, 6, v3
    v_and_b32 v4, 7, v0
    v_lshl_add_u32 v60, v4, 3, v60
    s_lshl_b32 s33, s26, 2
    s_add_u32 s33, s33, s72
    s_lshl_b32 s34, s26, 12
    s_lshl_b32 s24, s72, 8
    s_add_u32 s34, s34, s24
    s_add_u32 s34, s34, 0x140000
    s_mul_i32 s73, s33, 6
    s_add_u32 s73, s73, s31
    s_lshl_b32 s73, s73, 8
    s_add_u32 s73, s73, 0x180000
    s_mov_b64 s[8:9], s[56:57]
L_pfo:
    s_lshl_b32 s24, s74, 8
    s_waitcnt vmcnt(6)
    buffer_load_dwordx4 v[28:31], v25, s[8:11], s24 offen
    s_addk_i32 s74, 96
    s_cmpk_lt_u32 s74, 512
    s_cbranch_scc1 L_pfo
    s_addk_i32 s74, -512
    s_mov_b64 s[8:9], s[42:43]
L_pfk:
    s_lshl_b32 s24, s74, 13
    s_waitcnt vmcnt(6)
    buffer_load_dwordx4 v[28:31], v24, s[8:11], s24 offen
    s_addk_i32 s74, 96
    s_cmpk_lt_u32 s74, 512
    s_cbranch_scc1 L_pfk
    s_addk_i32 s74, -512
    s_mov_b64 s[8:9], s[46:47]
L_pfv:
    s_lshl_b32 s24, s74, 8
    s_waitcnt vmcnt(6)
    buffer_load_dwordx4 v[28:31], v25, s[8:11], s24 offen
    s_addk_i32 s74, 96
    s_cmpk_lt_u32 s74, 512
    s_cbranch_scc1 L_pfv
    s_addk_i32 s74, -512
    s_mov_b64 s[8:9], s[44:45]
L_pfu:
    s_lshl_b32 s24, s74, 13
    s_waitcnt vmcnt(6)
    buffer_load_dwordx4 v[28:31], v24, s[8:11], s24 offen
    s_addk_i32 s74, 96
    s_cmpk_lt_u32 s74, 512
    s_cbranch_scc1 L_pfu
    s_addk_i32 s74, -512
    s_mov_b64 s[8:9], s[38:39]
    s_mov_b32 s10, 0x1000000
L_pfc:
    s_lshl_b32 s24, s74, 12
    s_waitcnt vmcnt(6)
    buffer_load_dwordx4 v[28:31], v26, s[8:11], s24 offen
    s_addk_i32 s74, 96
    s_cmpk_lt_u32 s74, 2048
    s_cbranch_scc1 L_pfc
    s_addk_i32 s74, -2048
    s_mov_b32 s10, 0x400000
    s_waitcnt vmcnt(15)
    buffer_load_dwordx4 a[0:3], v1, s[4:7], s32 offen offset:0 nt
    s_add_u32 s32, s32, 6144
    s_waitcnt vmcnt(15)
    buffer_load_dwordx4 a[4:7], v1, s[4:7], s32 offen offset:0 nt
    s_add_u32 s32, s32, 6144
    s_waitcnt vmcnt(15)
    buffer_load_dwordx4 a[8:11], v1, s[4:7], s32 offen offset:0 nt
    s_add_u32 s32, s32, 6144
    s_waitcnt vmcnt(15)
    buffer_load_dwordx4 a[12:15], v1, s[4:7], s32 offen offset:0 nt
    s_add_u32 s32, s32, 6144
    s_waitcnt vmcnt(15)
    buffer_load_dwordx4 a[16:19], v1, s[4:7], s32 offen offset:0 nt
    s_add_u32 s32, s32, 6144
    s_waitcnt vmcnt(15)
    buffer_load_dwordx4 a[20:23], v1, s[4:7], s32 offen offset:0 nt
    s_add_u32 s32, s32, 6144
    s_waitcnt vmcnt(15)
    buffer_load_dwordx4 a[24:27], v1, s[4:7], s32 offen offset:0 nt
    s_add_u32 s32, s32, 6144
    s_waitcnt vmcnt(15)
    buffer_load_dwordx4 a[28:31], v1, s[4:7], s32 offen offset:0 nt
    s_add_u32 s32, s32, 6144
    s_waitcnt vmcnt(15)
    buffer_load_dwordx4 a[32:35], v1, s[4:7], s32 offen offset:0 nt
    s_add_u32 s32, s32, 6144
    s_waitcnt vmcnt(15)
    buffer_load_dwordx4 a[36:39], v1, s[4:7], s32 offen offset:0 nt
    s_add_u32 s32, s32, 6144
    s_waitcnt vmcnt(15)
    buffer_load_dwordx4 a[40:43], v1, s[4:7], s28 offen offset:0 nt
    s_waitcnt vmcnt(15)
    s_mov_b32 s32, s35
    buffer_load_dwordx4 a[64:67], v1, s[4:7], s32 offen offset:0 nt
    s_add_u32 s32, s32, 6144
    s_waitcnt vmcnt(15)
    buffer_load_dwordx4 a[68:71], v1, s[4:7], s32 offen offset:0 nt
    s_add_u32 s32, s32, 6144
    s_waitcnt vmcnt(15)
    buffer_load_dwordx4 a[72:75], v1, s[4:7], s32 offen offset:0 nt
    s_add_u32 s32, s32, 6144
    s_waitcnt vmcnt(15)
    buffer_load_dwordx4 a[76:79], v1, s[4:7], s32 offen offset:0 nt
    s_add_u32 s32, s32, 6144
    s_waitcnt vmcnt(15)
    buffer_load_dwordx4 a[80:83], v1, s[4:7], s32 offen offset:0 nt
    s_add_u32 s32, s32, 6144
    s_mov_b64 exec, 1
    buffer_load_dword v61, off, s[16:19], 0 offset:128 sc1
    s_mov_b64 exec, -1
    s_waitcnt vmcnt(15)
    buffer_load_dwordx4 a[84:87], v1, s[4:7], s32 offen offset:0 nt
    s_add_u32 s32, s32, 6144
    s_waitcnt vmcnt(15)
    buffer_load_dwordx4 a[88:91], v1, s[4:7], s32 offen offset:0 nt
    s_add_u32 s32, s32, 6144
    s_waitcnt vmcnt(15)
    buffer_load_dwordx4 a[92:95], v1, s[4:7], s32 offen offset:0 nt
    s_add_u32 s32, s32, 6144
    s_waitcnt vmcnt(15)
    buffer_load_dwordx4 a[96:99], v1, s[4:7], s32 offen offset:0 nt
    s_add_u32 s32, s32, 6144
    s_waitcnt vmcnt(15)
    buffer_load_dwordx4 a[100:103], v1, s[4:7], s32 offen offset:0 nt
    s_add_u32 s32, s32, 6144
    s_waitcnt vmcnt(15)
    buffer_load_dwordx4 a[104:107], v1, s[4:7], s32 offen offset:0 nt
    s_add_u32 s32, s32, 6144
    s_waitcnt vmcnt(15)
    buffer_load_dwordx4 a[108:111], v1, s[4:7], s32 offen offset:0 nt
    s_add_u32 s32, s32, 6144
    s_waitcnt vmcnt(15)
    buffer_load_dwordx4 a[112:115], v1, s[4:7], s32 offen offset:0 nt
    s_add_u32 s32, s32, 6144
    s_waitcnt vmcnt(15)
    buffer_load_dwordx4 a[116:119], v1, s[4:7], s32 offen offset:0 nt
    s_add_u32 s32, s32, 6144
    s_waitcnt vmcnt(15)
    buffer_load_dwordx4 a[120:123], v1, s[4:7], s32 offen offset:0 nt
    s_add_u32 s32, s32, 6144
    s_waitcnt vmcnt(15)
    buffer_load_dwordx4 a[124:127], v1, s[4:7], s32 offen offset:0 nt
    s_add_u32 s32, s32, 6144
    s_waitcnt vmcnt(15)
    buffer_load_dwordx4 v[64:67], v1, s[4:7], s32 offen offset:0 nt
    s_add_u32 s32, s32, 6144
    s_waitcnt vmcnt(12)
    v_readfirstlane_b32 s25, v61
    s_nop 0
    s_cmp_ge_u32 s25, 32
    s_cbranch_scc1 L_B_q
    s_mov_b32 s24, 262144
    s_mov_b64 exec, 1
L_aw1:
    buffer_load_dword v61, off, s[16:19], 0 offset:128 sc1
    s_waitcnt vmcnt(0)
    v_readfirstlane_b32 s25, v61
    s_nop 0
    s_cmp_ge_u32 s25, 32
    s_cbranch_scc1 L_B_q
    s_sleep 16
    s_sub_u32 s24, s24, 1
    s_cmp_lg_u32 s24, 0
    s_cbranch_scc1 L_aw1
L_B_q:
    s_mov_b64 exec, -1
    buffer_load_dwordx4 v[8:11], v5, s[12:15], s34 offen sc1
    s_waitcnt vmcnt(15)
    buffer_load_dwordx4 v[68:71], v1, s[4:7], s32 offen offset:0 nt
    s_add_u32 s32, s32, 6144
    s_waitcnt vmcnt(15)
    buffer_load_dwordx4 v[72:75], v1, s[4:7], s32 offen offset:0 nt
    s_add_u32 s32, s32, 6144
    s_waitcnt vmcnt(15)
    buffer_load_dwordx4 v[76:79], v1, s[4:7], s32 offen offset:0 nt
    s_add_u32 s32, s32, 6144
    s_waitcnt vmcnt(15)
    buffer_load_dwordx4 v[80:83], v1, s[4:7], s32 offen offset:0 nt
    s_add_u32 s32, s32, 6144
    s_waitcnt vmcnt(15)
    buffer_load_dwordx4 v[84:87], v1, s[4:7], s32 offen offset:0 nt
    s_add_u32 s32, s32, 6144
    s_waitcnt vmcnt(15)
    buffer_load_dwordx4 v[88:91], v1, s[4:7], s32 offen offset:0 nt
    s_add_u32 s32, s32, 6144
    s_waitcnt vmcnt(15)
    buffer_load_dwordx4 v[92:95], v1, s[4:7], s32 offen offset:0 nt
    s_add_u32 s32, s32, 6144
    s_waitcnt vmcnt(15)
    buffer_load_dwordx4 v[96:99], v1, s[4:7], s32 offen offset:0 nt
    s_add_u32 s32, s32, 6144
    s_waitcnt vmcnt(15)
    buffer_load_dwordx4 v[100:103], v1, s[4:7], s32 offen offset:0 nt
    s_add_u32 s32, s32, 6144
    s_waitcnt vmcnt(15)
    buffer_load_dwordx4 v[104:107], v1, s[4:7], s32 offen offset:0 nt
    s_add_u32 s32, s32, 6144
    s_waitcnt vmcnt(15)
    buffer_load_dwordx4 v[108:111], v1, s[4:7], s32 offen offset:0 nt
    s_add_u32 s32, s32, 6144
    s_waitcnt vmcnt(15)
    buffer_load_dwordx4 v[112:115], v1, s[4:7], s32 offen offset:0 nt
    s_add_u32 s32, s32, 6144
    s_waitcnt vmcnt(15)
    buffer_load_dwordx4 v[116:119], v1, s[4:7], s32 offen offset:0 nt
    s_add_u32 s32, s32, 6144
    s_waitcnt vmcnt(15)
    buffer_load_dwordx4 v[120:123], v1, s[4:7], s32 offen offset:0 nt
    s_add_u32 s32, s32, 6144
    s_waitcnt vmcnt(15)
    buffer_load_dwordx4 v[124:127], v1, s[4:7], s32 offen offset:0 nt
    s_add_u32 s32, s32, 6144
    s_waitcnt vmcnt(15)
    v_mov_b32_dpp v32, v8 quad_perm:[0,1,2,3] row_mask:0xf bank_mask:0x1
    v_mov_b32_dpp v33, v9 quad_perm:[0,1,2,3] row_mask:0xf bank_mask:0x1
    v_mov_b32_dpp v34, v10 quad_perm:[0,1,2,3] row_mask:0xf bank_mask:0x1
    v_mov_b32_dpp v35, v11 quad_perm:[0,1,2,3] row_mask:0xf bank_mask:0x1
    v_mov_b32_dpp v36, v8 quad_perm:[0,1,2,3] row_mask:0xf bank_mask:0x2
    v_mov_b32_dpp v37, v9 quad_perm:[0,1,2,3] row_mask:0xf bank_mask:0x2
    v_mov_b32_dpp v38, v10 quad_perm:[0,1,2,3] row_mask:0xf bank_mask:0x2
    v_mov_b32_dpp v39, v11 quad_perm:[0,1,2,3] row_mask:0xf bank_mask:0x2
    v_mov_b32_dpp v40, v8 quad_perm:[0,1,2,3] row_mask:0xf bank_mask:0x4
    v_mov_b32_dpp v41, v9 quad_perm:[0,1,2,3] row_mask:0xf bank_mask:0x4
    v_mov_b32_dpp v42, v10 quad_perm:[0,1,2,3] row_mask:0xf bank_mask:0x4
    v_mov_b32_dpp v43, v11 quad_perm:[0,1,2,3] row_mask:0xf bank_mask:0x4
    v_mov_b32_dpp v44, v8 quad_perm:[0,1,2,3] row_mask:0xf bank_mask:0x8
    v_mov_b32_dpp v45, v9 quad_perm:[0,1,2,3] row_mask:0xf bank_mask:0x8
    v_mov_b32_dpp v46, v10 quad_perm:[0,1,2,3] row_mask:0xf bank_mask:0x8
    v_mov_b32_dpp v47, v11 quad_perm:[0,1,2,3] row_mask:0xf bank_mask:0x8
    s_mov_b32 s27, 1
L_BK:
    s_cmp_lg_u32 s27, 9
    s_cbranch_scc1 L_BK_a
    s_add_u32 s4, s52, s30
    s_addc_u32 s5, s53, 0
    s_mov_b32 s32, s35
    v_mov_b32 v1, v2
L_BK_a:
    s_barrier
    s_cmp_lg_u32 s27, 8
    s_cbranch_scc1 L_BK_x0
    s_and_b32 s24, s2, 7
    s_lshl_b32 s24, s24, 7
    s_add_u32 s24, s24, 0x1d0000
    v_and_b32 v63, 7, v0
    v_lshlrev_b32 v63, 2, v63
    buffer_load_dword v62, v63, s[12:15], s24 offen sc1
L_BK_x0:
    s_cmp_lg_u32 s27, 9
    s_cbranch_scc1 L_BK_x1
    s_getreg_b32 s24, hwreg(HW_REG_XCC_ID, 0, 4)
    v_cmp_ne_u32 vcc, s24, v62
    s_nop 0
    s_or_b32 s75, vcc_lo, vcc_hi
L_BK_x1:
    v_mov_b32 v49, v50
    v_mov_b32 v50, v51
    v_mov_b32 v51, v52
    v_mov_b32 v52, v53
    v_mov_b32 v53, v54
    v_mov_b32 v54, v55
    v_mov_b32 v55, v56
    v_mov_b32 v56, v57
    s_waitcnt vmcnt(15)
    v_mfma_f32_16x16x32_bf16 v[12:15], v[64:67], v[32:35], 0
    buffer_load_dwordx4 v[64:67], v1, s[4:7], s32 offen offset:0 nt
    s_add_u32 s32, s32, 6144
    s_waitcnt vmcnt(15)
    v_mfma_f32_16x16x32_bf16 v[12:15], v[68:71], v[36:39], v[12:15]
    buffer_load_dwordx4 v[68:71], v1, s[4:7], s32 offen offset:0 nt
    s_add_u32 s32, s32, 6144
    s_waitcnt vmcnt(15)
    v_mfma_f32_16x16x32_bf16 v[12:15], v[72:75], v[40:43], v[12:15]
    buffer_load_dwordx4 v[72:75], v1, s[4:7], s32 offen offset:0 nt
    s_add_u32 s32, s32, 6144
    s_waitcnt vmcnt(15)
    v_mfma_f32_16x16x32_bf16 v[12:15], v[76:79], v[44:47], v[12:15]
    buffer_load_dwordx4 v[76:79], v1, s[4:7], s32 offen offset:0 nt
    s_add_u32 s32, s32, 6144
    s_nop 5
    v_add_f32_dpp v57, v13, v12 quad_perm:[1,1,1,1] row_mask:0xf bank_mask:0xf
    s_nop 1
    v_add_f32_dpp v57, v14, v57 quad_perm:[2,2,2,2] row_mask:0xf bank_mask:0xf
    s_nop 1
    v_add_f32_dpp v57, v15, v57 quad_perm:[3,3,3,3] row_mask:0xf bank_mask:0xf
    s_waitcnt vmcnt(15)
    v_mfma_f32_16x16x32_bf16 v[16:19], v[80:83], v[32:35], 0
    buffer_load_dwordx4 v[80:83], v1, s[4:7], s32 offen offset:0 nt
    s_add_u32 s32, s32, 6144
    s_waitcnt vmcnt(15)
    v_mfma_f32_16x16x32_bf16 v[16:19], v[84:87], v[36:39], v[16:19]
    buffer_load_dwordx4 v[84:87], v1, s[4:7], s32 offen offset:0 nt
    s_add_u32 s32, s32, 6144
    s_waitcnt vmcnt(15)
    v_mfma_f32_16x16x32_bf16 v[16:19], v[88:91], v[40:43], v[16:19]
    buffer_load_dwordx4 v[88:91], v1, s[4:7], s32 offen offset:0 nt
    s_add_u32 s32, s32, 6144
    s_waitcnt vmcnt(15)
    v_mfma_f32_16x16x32_bf16 v[16:19], v[92:95], v[44:47], v[16:19]
    buffer_load_dwordx4 v[92:95], v1, s[4:7], s32 offen offset:0 nt
    s_add_u32 s32, s32, 6144
    s_nop 5
    v_add_f32_dpp v3, v16, v17 quad_perm:[0,0,0,0] row_mask:0xf bank_mask:0xf
    s_nop 1
    v_add_f32_dpp v3, v18, v3 quad_perm:[2,2,2,2] row_mask:0xf bank_mask:0xf
    s_nop 1
    v_add_f32_dpp v3, v19, v3 quad_perm:[3,3,3,3] row_mask:0xf bank_mask:0xf
    v_cndmask_b32 v57, v57, v3, s[64:65]
    s_waitcnt vmcnt(15)
    v_mfma_f32_16x16x32_bf16 v[12:15], v[96:99], v[32:35], 0
    buffer_load_dwordx4 v[96:99], v1, s[4:7], s32 offen offset:0 nt
    s_add_u32 s32, s32, 6144
    s_waitcnt vmcnt(15)
    v_mfma_f32_16x16x32_bf16 v[12:15], v[100:103], v[36:39], v[12:15]
    buffer_load_dwordx4 v[100:103], v1, s[4:7], s32 offen offset:0 nt
    s_add_u32 s32, s32, 6144
    s_waitcnt vmcnt(15)
    v_mfma_f32_16x16x32_bf16 v[12:15], v[104:107], v[40:43], v[12:15]
    buffer_load_dwordx4 v[104:107], v1, s[4:7], s32 offen offset:0 nt
    s_add_u32 s32, s32, 6144
    s_waitcnt vmcnt(15)
    v_mfma_f32_16x16x32_bf16 v[12:15], v[108:111], v[44:47], v[12:15]
    buffer_load_dwordx4 v[108:111], v1, s[4:7], s32 offen offset:0 nt
    s_add_u32 s32, s32, 6144
    s_nop 5
    v_add_f32_dpp v3, v12, v14 quad_perm:[0,0,0,0] row_mask:0xf bank_mask:0xf
    s_nop 1
    v_add_f32_dpp v3, v13, v3 quad_perm:[1,1,1,1] row_mask:0xf bank_mask:0xf
    s_nop 1
    v_add_f32_dpp v3, v15, v3 quad_perm:[3,3,3,3] row_mask:0xf bank_mask:0xf
    v_cndmask_b32 v57, v57, v3, s[66:67]
    s_waitcnt vmcnt(15)
    v_mfma_f32_16x16x32_bf16 v[16:19], v[112:115], v[32:35], 0
    buffer_load_dwordx4 v[112:115], v1, s[4:7], s32 offen offset:0 nt
    s_add_u32 s32, s32, 6144
    s_waitcnt vmcnt(15)
    v_mfma_f32_16x16x32_bf16 v[16:19], v[116:119], v[36:39], v[16:19]
    buffer_load_dwordx4 v[116:119], v1, s[4:7], s32 offen offset:0 nt
    s_add_u32 s32, s32, 6144
    s_waitcnt vmcnt(15)
    v_mfma_f32_16x16x32_bf16 v[16:19], v[120:123], v[40:43], v[16:19]
    buffer_load_dwordx4 v[120:123], v1, s[4:7], s32 offen offset:0 nt
    s_add_u32 s32, s32, 6144
    s_waitcnt vmcnt(15)
    v_mfma_f32_16x16x32_bf16 v[16:19], v[124:127], v[44:47], v[16:19]
    buffer_load_dwordx4 v[124:127], v1, s[4:7], s32 offen offset:0 nt
    s_add_u32 s32, s32, 6144
    s_nop 5
    v_add_f32_dpp v3, v16, v19 quad_perm:[0,0,0,0] row_mask:0xf bank_mask:0xf
    s_nop 1
    v_add_f32_dpp v3, v17, v3 quad_perm:[1,1,1,1] row_mask:0xf bank_mask:0xf
    s_nop 1
    v_add_f32_dpp v3, v18, v3 quad_perm:[2,2,2,2] row_mask:0xf bank_mask:0xf
    v_cndmask_b32 v57, v57, v3, s[68:69]
    s_cmp_lg_u32 s27, 3
    s_cbranch_scc1 L_BK_c0
    v_mfma_f32_16x16x32_bf16 v[12:15], a[64:67], v[32:35], 0
    v_mfma_f32_16x16x32_bf16 v[12:15], a[68:71], v[36:39], v[12:15]
    v_mfma_f32_16x16x32_bf16 v[12:15], a[72:75], v[40:43], v[12:15]
    v_mfma_f32_16x16x32_bf16 v[12:15], a[76:79], v[44:47], v[12:15]
    s_nop 7
    v_add_f32_dpp v48, v13, v12 quad_perm:[1,1,1,1] row_mask:0xf bank_mask:0xf
    s_nop 1
    v_add_f32_dpp v48, v14, v48 quad_perm:[2,2,2,2] row_mask:0xf bank_mask:0xf
    s_nop 1
    v_add_f32_dpp v48, v15, v48 quad_perm:[3,3,3,3] row_mask:0xf bank_mask:0xf
    v_mfma_f32_16x16x32_bf16 v[16:19], a[80:83], v[32:35], 0
    v_mfma_f32_16x16x32_bf16 v[16:19], a[84:87], v[36:39], v[16:19]
    v_mfma_f32_16x16x32_bf16 v[16:19], a[88:91], v[40:43], v[16:19]
    v_mfma_f32_16x16x32_bf16 v[16:19], a[92:95], v[44:47], v[16:19]
    s_nop 7
    v_add_f32_dpp v3, v16, v17 quad_perm:[0,0,0,0] row_mask:0xf bank_mask:0xf
    s_nop 1
    v_add_f32_dpp v3, v18, v3 quad_perm:[2,2,2,2] row_mask:0xf bank_mask:0xf
    s_nop 1
    v_add_f32_dpp v3, v19, v3 quad_perm:[3,3,3,3] row_mask:0xf bank_mask:0xf
    v_cndmask_b32 v48, v48, v3, s[64:65]
    v_mfma_f32_16x16x32_bf16 v[12:15], a[96:99], v[32:35], 0
    v_mfma_f32_16x16x32_bf16 v[12:15], a[100:103], v[36:39], v[12:15]
    v_mfma_f32_16x16x32_bf16 v[12:15], a[104:107], v[40:43], v[12:15]
    v_mfma_f32_16x16x32_bf16 v[12:15], a[108:111], v[44:47], v[12:15]
    s_nop 7
    v_add_f32_dpp v3, v12, v14 quad_perm:[0,0,0,0] row_mask:0xf bank_mask:0xf
    s_nop 1
    v_add_f32_dpp v3, v13, v3 quad_perm:[1,1,1,1] row_mask:0xf bank_mask:0xf
    s_nop 1
    v_add_f32_dpp v3, v15, v3 quad_perm:[3,3,3,3] row_mask:0xf bank_mask:0xf
    v_cndmask_b32 v48, v48, v3, s[66:67]
    v_mfma_f32_16x16x32_bf16 v[16:19], a[112:115], v[32:35], 0
    v_mfma_f32_16x16x32_bf16 v[16:19], a[116:119], v[36:39], v[16:19]
    v_mfma_f32_16x16x32_bf16 v[16:19], a[120:123], v[40:43], v[16:19]
    v_mfma_f32_16x16x32_bf16 v[16:19], a[124:127], v[44:47], v[16:19]
    s_nop 7
    v_add_f32_dpp v3, v16, v19 quad_perm:[0,0,0,0] row_mask:0xf bank_mask:0xf
    s_nop 1
    v_add_f32_dpp v3, v17, v3 quad_perm:[1,1,1,1] row_mask:0xf bank_mask:0xf
    s_nop 1
    v_add_f32_dpp v3, v18, v3 quad_perm:[2,2,2,2] row_mask:0xf bank_mask:0xf
    v_cndmask_b32 v48, v48, v3, s[68:69]
L_BK_c0:
    s_cmp_lg_u32 s27, 2
    s_cbranch_scc1 L_BK_b
    v_mfma_f32_16x16x32_bf16 v[12:15], a[0:3], v[32:35], 0
    v_mfma_f32_16x16x32_bf16 v[12:15], a[4:7], v[36:39], v[12:15]
    v_mfma_f32_16x16x32_bf16 v[12:15], a[8:11], v[40:43], v[12:15]
    v_mfma_f32_16x16x32_bf16 v[12:15], a[12:15], v[44:47], v[12:15]
    s_nop 7
    v_add_f32_dpp v58, v13, v12 quad_perm:[1,1,1,1] row_mask:0xf bank_mask:0xf
    s_nop 1
    v_add_f32_dpp v58, v14, v58 quad_perm:[2,2,2,2] row_mask:0xf bank_mask:0xf
    s_nop 1
    v_add_f32_dpp v58, v15, v58 quad_perm:[3,3,3,3] row_mask:0xf bank_mask:0xf
    v_mfma_f32_16x16x32_bf16 v[16:19], a[16:19], v[32:35], 0
    v_mfma_f32_16x16x32_bf16 v[16:19], a[20:23], v[36:39], v[16:19]
    v_mfma_f32_16x16x32_bf16 v[16:19], a[24:27], v[40:43], v[16:19]
    v_mfma_f32_16x16x32_bf16 v[16:19], a[28:31], v[44:47], v[16:19]
    s_nop 7
    v_add_f32_dpp v3, v16, v17 quad_perm:[0,0,0,0] row_mask:0xf bank_mask:0xf
    s_nop 1
    v_add_f32_dpp v3, v18, v3 quad_perm:[2,2,2,2] row_mask:0xf bank_mask:0xf
    s_nop 1
    v_add_f32_dpp v3, v19, v3 quad_perm:[3,3,3,3] row_mask:0xf bank_mask:0xf
    v_cndmask_b32 v58, v58, v3, s[64:65]
    v_mfma_f32_16x16x32_bf16 v[12:15], a[32:35], v[32:35], 0
    v_mfma_f32_16x16x32_bf16 v[12:15], a[36:39], v[36:39], v[12:15]
    v_mfma_f32_16x16x32_bf16 v[12:15], a[40:43], v[40:43], v[12:15]
    s_nop 7
    v_add_f32_dpp v3, v12, v14 quad_perm:[0,0,0,0] row_mask:0xf bank_mask:0xf
    s_nop 1
    v_add_f32_dpp v3, v13, v3 quad_perm:[1,1,1,1] row_mask:0xf bank_mask:0xf
    s_nop 1
    v_add_f32_dpp v3, v15, v3 quad_perm:[3,3,3,3] row_mask:0xf bank_mask:0xf
    v_cndmask_b32 v58, v58, v3, s[66:67]
    s_mul_i32 s24, s31, 1
    s_sub_i32 s24, 4, s24
    s_max_i32 s24, s24, 0
    s_min_i32 s24, s24, 1
    s_add_u32 s24, s24, 10
    v_and_b32 v3, 3, v0
    v_bfe_u32 v4, v0, 2, 2
    v_lshl_add_u32 v3, v3, 2, v4
    v_mov_b32 v4, 0xff800000
    v_cmp_gt_u32 vcc, s24, v3
    s_nop 1
    v_cndmask_b32 v58, v4, v58, vcc
    v_mov_b32 v61, 0x3e0293ee
    v_mov_b32 v7, 0
    s_lshr_b32 s34, s2, 3
    s_lshl_b32 s34, s34, 12
    s_and_b32 s24, s2, 7
    s_lshl_b32 s24, s24, 7
    s_add_u32 s34, s34, s24
    s_add_u32 s34, s34, 0x1b0000
L_BK_b:
    s_add_u32 s27, s27, 1
    s_cmp_lt_u32 s27, 10
    s_cbranch_scc1 L_BK
    v_max3_f32 v3, v48, v49, v50
    v_max3_f32 v3, v3, v51, v52
    v_max3_f32 v3, v3, v53, v54
    v_max3_f32 v3, v3, v55, v56
    v_max3_f32 v3, v3, v57, v58
    s_nop 1
    v_max_f32_dpp v3, v3, v3 row_ror:8 row_mask:0xf bank_mask:0xf
    s_nop 1
    v_max_f32_dpp v3, v3, v3 row_ror:4 row_mask:0xf bank_mask:0xf
    s_nop 1
    v_max_f32_dpp v3, v3, v3 row_ror:2 row_mask:0xf bank_mask:0xf
    s_nop 1
    v_max_f32_dpp v3, v3, v3 row_ror:1 row_mask:0xf bank_mask:0xf
    s_nop 1
    v_max_f32_dpp v3, v3, v3 row_bcast:15 row_mask:0xa bank_mask:0xf
    s_nop 1
    v_max_f32_dpp v3, v3, v3 row_bcast:31 row_mask:0xc bank_mask:0xf
    s_nop 0
    v_readlane_b32 s24, v3, 63
    s_nop 1
    v_mul_f32 v6, s24, v61
    v_mov_b32 v12, 0
    v_mov_b32 v13, 0
    v_mov_b32 v14, 0
    v_mov_b32 v15, 0
    v_fma_f32 v48, v48, v61, -v6
    v_exp_f32 v48, v48
    s_nop 0
    v_add_f32 v7, v7, v48
    v_cvt_pk_bf16_f32 v48, v48, v48
    s_mov_b32 s27, 0
L_BV:
    s_barrier
    s_cmp_lg_u32 s27, 7
    s_cbranch_scc1 L_BV_c0
    v_mov_b32 v28, -1
    v_mov_b32 v29, -1
    v_mov_b32 v30, -1
    v_mov_b32 v31, -1
    s_mov_b64 exec, 0xffff
    s_cmp_lg_u32 s75, 0
    s_cbranch_scc1 L_far2
    buffer_store_dwordx4 v[28:31], v2, s[12:15], s73 offen
    s_branch L_near2
L_far2:
    buffer_store_dwordx4 v[28:31], v2, s[12:15], s73 offen sc1
L_near2:
    s_mov_b64 exec, -1
L_BV_c0:
    s_cmp_lg_u32 s27, 8
    s_cbranch_scc1 L_BV_c1
    s_lshl_b32 s25, s3, 4
    s_add_u32 s25, s25, s34
    s_mov_b64 exec, 1
    v_mov_b32 v28, 0
    v_mov_b32 v29, 0
    s_cmp_lg_u32 s75, 0
    s_cbranch_scc1 L_far3
    buffer_store_dwordx2 v[28:29], off, s[12:15], s25 offset:8
    s_branch L_near3
L_far3:
    buffer_store_dwordx2 v[28:29], off, s[12:15], s25 offset:8 sc1
L_near3:
    s_mov_b64 exec, -1
L_BV_c1:
    s_cmp_ge_u32 s27, 1
    s_cselect_b32 s71, s3, 4
    s_cmp_lg_u32 s71, 0
    s_cbranch_scc1 L_BV_p0
    s_lshl_b32 s24, s27, 2
    s_add_u32 s24, s24, 0
    s_mov_b64 exec, 1
    v_mov_b32 v63, s24
    s_cmp_lg_u32 s75, 0
    s_cbranch_scc1 L_far4
    buffer_store_dword v63, off, s[12:15], s34 offset:64
    s_branch L_near4
L_far4:
    buffer_store_dword v63, off, s[12:15], s34 offset:64 sc1
L_near4:
    s_mov_b64 exec, -1
L_BV_p0:
    v_and_b32_dpp v8, v48, v20 row_newbcast:0 row_mask:0xf bank_mask:0xf
    v_and_b32_dpp v9, v48, v21 row_newbcast:0 row_mask:0xf bank_mask:0xf
    v_and_b32_dpp v10, v48, v22 row_newbcast:0 row_mask:0xf bank_mask:0xf
    v_and_b32_dpp v11, v48, v23 row_newbcast:0 row_mask:0xf bank_mask:0xf
    s_waitcnt vmcnt(15)
    s_nop 0
    v_mfma_f32_16x16x32_bf16 v[12:15], v[64:67], v[8:11], v[12:15]
    buffer_load_dwordx4 v[64:67], v1, s[4:7], s32 offen offset:0 nt
    s_add_u32 s32, s32, 6144
    v_and_b32_dpp v8, v48, v20 row_newbcast:4 row_mask:0xf bank_mask:0xf
    v_and_b32_dpp v9, v48, v21 row_newbcast:4 row_mask:0xf bank_mask:0xf
    v_and_b32_dpp v10, v48, v22 row_newbcast:4 row_mask:0xf bank_mask:0xf
    v_and_b32_dpp v11, v48, v23 row_newbcast:4 row_mask:0xf bank_mask:0xf
    s_waitcnt vmcnt(15)
    s_nop 0
    v_mfma_f32_16x16x32_bf16 v[12:15], v[68:71], v[8:11], v[12:15]
    buffer_load_dwordx4 v[68:71], v1, s[4:7], s32 offen offset:0 nt
    s_add_u32 s32, s32, 6144
    v_and_b32_dpp v8, v48, v20 row_newbcast:8 row_mask:0xf bank_mask:0xf
    v_and_b32_dpp v9, v48, v21 row_newbcast:8 row_mask:0xf bank_mask:0xf
    v_and_b32_dpp v10, v48, v22 row_newbcast:8 row_mask:0xf bank_mask:0xf
    v_and_b32_dpp v11, v48, v23 row_newbcast:8 row_mask:0xf bank_mask:0xf
    s_waitcnt vmcnt(15)
    s_nop 0
    v_mfma_f32_16x16x32_bf16 v[12:15], v[72:75], v[8:11], v[12:15]
    buffer_load_dwordx4 v[72:75], v1, s[4:7], s32 offen offset:0 nt
    s_add_u32 s32, s32, 6144
    v_and_b32_dpp v8, v48, v20 row_newbcast:12 row_mask:0xf bank_mask:0xf
    v_and_b32_dpp v9, v48, v21 row_newbcast:12 row_mask:0xf bank_mask:0xf
    v_and_b32_dpp v10, v48, v22 row_newbcast:12 row_mask:0xf bank_mask:0xf
    v_and_b32_dpp v11, v48, v23 row_newbcast:12 row_mask:0xf bank_mask:0xf
    s_waitcnt vmcnt(15)
    s_nop 0
    v_mfma_f32_16x16x32_bf16 v[12:15], v[76:79], v[8:11], v[12:15]
    buffer_load_dwordx4 v[76:79], v1, s[4:7], s32 offen offset:0 nt
    s_add_u32 s32, s32, 6144
    s_cmp_lg_u32 s71, 1
    s_cbranch_scc1 L_BV_p1
    s_lshl_b32 s24, s27, 2
    s_add_u32 s24, s24, 1
    s_mov_b64 exec, 1
    v_mov_b32 v63, s24
    s_cmp_lg_u32 s75, 0
    s_cbranch_scc1 L_far5
    buffer_store_dword v63, off, s[12:15], s34 offset:64
    s_branch L_near5
L_far5:
    buffer_store_dword v63, off, s[12:15], s34 offset:64 sc1
L_near5:
    s_mov_b64 exec, -1
L_BV_p1:
    v_and_b32_dpp v8, v48, v20 row_newbcast:1 row_mask:0xf bank_mask:0xf
    v_and_b32_dpp v9, v48, v21 row_newbcast:1 row_mask:0xf bank_mask:0xf
    v_and_b32_dpp v10, v48, v22 row_newbcast:1 row_mask:0xf bank_mask:0xf
    v_and_b32_dpp v11, v48, v23 row_newbcast:1 row_mask:0xf bank_mask:0xf
    s_waitcnt vmcnt(15)
    s_nop 0
    v_mfma_f32_16x16x32_bf16 v[12:15], v[80:83], v[8:11], v[12:15]
    buffer_load_dwordx4 v[80:83], v1, s[4:7], s32 offen offset:0 nt
    s_add_u32 s32, s32, 6144
    v_and_b32_dpp v8, v48, v20 row_newbcast:5 row_mask:0xf bank_mask:0xf
    v_and_b32_dpp v9, v48, v21 row_newbcast:5 row_mask:0xf bank_mask:0xf
    v_and_b32_dpp v10, v48, v22 row_newbcast:5 row_mask:0xf bank_mask:0xf
    v_and_b32_dpp v11, v48, v23 row_newbcast:5 row_mask:0xf bank_mask:0xf
    s_waitcnt vmcnt(15)
    s_nop 0
    v_mfma_f32_16x16x32_bf16 v[12:15], v[84:87], v[8:11], v[12:15]
    buffer_load_dwordx4 v[84:87], v1, s[4:7], s32 offen offset:0 nt
    s_add_u32 s32, s32, 6144
    v_and_b32_dpp v8, v48, v20 row_newbcast:9 row_mask:0xf bank_mask:0xf
    v_and_b32_dpp v9, v48, v21 row_newbcast:9 row_mask:0xf bank_mask:0xf
    v_and_b32_dpp v10, v48, v22 row_newbcast:9 row_mask:0xf bank_mask:0xf
    v_and_b32_dpp v11, v48, v23 row_newbcast:9 row_mask:0xf bank_mask:0xf
    s_waitcnt vmcnt(15)
    s_nop 0
    v_mfma_f32_16x16x32_bf16 v[12:15], v[88:91], v[8:11], v[12:15]
    buffer_load_dwordx4 v[88:91], v1, s[4:7], s32 offen offset:0 nt
    s_add_u32 s32, s32, 6144
    v_and_b32_dpp v8, v48, v20 row_newbcast:13 row_mask:0xf bank_mask:0xf
    v_and_b32_dpp v9, v48, v21 row_newbcast:13 row_mask:0xf bank_mask:0xf
    v_and_b32_dpp v10, v48, v22 row_newbcast:13 row_mask:0xf bank_mask:0xf
    v_and_b32_dpp v11, v48, v23 row_newbcast:13 row_mask:0xf bank_mask:0xf
    s_waitcnt vmcnt(15)
    s_nop 0
    v_mfma_f32_16x16x32_bf16 v[12:15], v[92:95], v[8:11], v[12:15]
    buffer_load_dwordx4 v[92:95], v1, s[4:7], s32 offen offset:0 nt
    s_add_u32 s32, s32, 6144
    s_cmp_lg_u32 s71, 2
    s_cbranch_scc1 L_BV_p2
    s_lshl_b32 s24, s27, 2
    s_add_u32 s24, s24, 2
    s_mov_b64 exec, 1
    v_mov_b32 v63, s24
    s_cmp_lg_u32 s75, 0
    s_cbranch_scc1 L_far6
    buffer_store_dword v63, off, s[12:15], s34 offset:64
    s_branch L_near6
L_far6:
    buffer_store_dword v63, off, s[12:15], s34 offset:64 sc1
L_near6:
    s_mov_b64 exec, -1
L_BV_p2:
    v_and_b32_dpp v8, v48, v20 row_newbcast:2 row_mask:0xf bank_mask:0xf
    v_and_b32_dpp v9, v48, v21 row_newbcast:2 row_mask:0xf bank_mask:0xf
    v_and_b32_dpp v10, v48, v22 row_newbcast:2 row_mask:0xf bank_mask:0xf
    v_and_b32_dpp v11, v48, v23 row_newbcast:2 row_mask:0xf bank_mask:0xf
    s_waitcnt vmcnt(15)
    s_nop 0
    v_mfma_f32_16x16x32_bf16 v[12:15], v[96:99], v[8:11], v[12:15]
    buffer_load_dwordx4 v[96:99], v1, s[4:7], s32 offen offset:0 nt
    s_add_u32 s32, s32, 6144
    v_and_b32_dpp v8, v48, v20 row_newbcast:6 row_mask:0xf bank_mask:0xf
    v_and_b32_dpp v9, v48, v21 row_newbcast:6 row_mask:0xf bank_mask:0xf
    v_and_b32_dpp v10, v48, v22 row_newbcast:6 row_mask:0xf bank_mask:0xf
    v_and_b32_dpp v11, v48, v23 row_newbcast:6 row_mask:0xf bank_mask:0xf
    s_waitcnt vmcnt(15)
    s_nop 0
    v_mfma_f32_16x16x32_bf16 v[12:15], v[100:103], v[8:11], v[12:15]
    buffer_load_dwordx4 v[100:103], v1, s[4:7], s32 offen offset:0 nt
    s_add_u32 s32, s32, 6144
    s_cmp_eq_u32 s27, 9
    s_cbranch_scc1 L_BT
    v_and_b32_dpp v8, v48, v20 row_newbcast:10 row_mask:0xf bank_mask:0xf
    v_and_b32_dpp v9, v48, v21 row_newbcast:10 row_mask:0xf bank_mask:0xf
    v_and_b32_dpp v10, v48, v22 row_newbcast:10 row_mask:0xf bank_mask:0xf
    v_and_b32_dpp v11, v48, v23 row_newbcast:10 row_mask:0xf bank_mask:0xf
    s_waitcnt vmcnt(15)
    s_nop 0
    v_mfma_f32_16x16x32_bf16 v[12:15], v[104:107], v[8:11], v[12:15]
    buffer_load_dwordx4 v[104:107], v1, s[4:7], s32 offen offset:0 nt
    s_add_u32 s32, s32, 6144
    v_and_b32_dpp v8, v48, v20 row_newbcast:14 row_mask:0xf bank_mask:0xf
    v_and_b32_dpp v9, v48, v21 row_newbcast:14 row_mask:0xf bank_mask:0xf
    v_and_b32_dpp v10, v48, v22 row_newbcast:14 row_mask:0xf bank_mask:0xf
    v_and_b32_dpp v11, v48, v23 row_newbcast:14 row_mask:0xf bank_mask:0xf
    s_waitcnt vmcnt(15)
    s_nop 0
    v_mfma_f32_16x16x32_bf16 v[12:15], v[108:111], v[8:11], v[12:15]
    buffer_load_dwordx4 v[108:111], v1, s[4:7], s32 offen offset:0 nt
    s_add_u32 s32, s32, 6144
    s_cmp_lg_u32 s71, 3
    s_cbranch_scc1 L_BV_p3
    s_lshl_b32 s24, s27, 2
    s_add_u32 s24, s24, 3
    s_mov_b64 exec, 1
    v_mov_b32 v63, s24
    s_cmp_lg_u32 s75, 0
    s_cbranch_scc1 L_far7
    buffer_store_dword v63, off, s[12:15], s34 offset:64
    s_branch L_near7
L_far7:
    buffer_store_dword v63, off, s[12:15], s34 offset:64 sc1
L_near7:
    s_mov_b64 exec, -1
L_BV_p3:
    v_and_b32_dpp v8, v48, v20 row_newbcast:3 row_mask:0xf bank_mask:0xf
    v_and_b32_dpp v9, v48, v21 row_newbcast:3 row_mask:0xf bank_mask:0xf
    v_and_b32_dpp v10, v48, v22 row_newbcast:3 row_mask:0xf bank_mask:0xf
    v_and_b32_dpp v11, v48, v23 row_newbcast:3 row_mask:0xf bank_mask:0xf
    s_waitcnt vmcnt(15)
    s_nop 0
    v_mfma_f32_16x16x32_bf16 v[12:15], v[112:115], v[8:11], v[12:15]
    buffer_load_dwordx4 v[112:115], v1, s[4:7], s32 offen offset:0 nt
    s_add_u32 s32, s32, 6144
    s_cmp_lg_u32 s27, 0
    s_cbranch_scc1 L_BV_d
    v_fma_f32 v49, v49, v61, -v6
    v_fma_f32 v50, v50, v61, -v6
    v_fma_f32 v51, v51, v61, -v6
    v_fma_f32 v52, v52, v61, -v6
    v_fma_f32 v53, v53, v61, -v6
    v_fma_f32 v54, v54, v61, -v6
    v_fma_f32 v55, v55, v61, -v6
    v_fma_f32 v56, v56, v61, -v6
    v_fma_f32 v57, v57, v61, -v6
    v_fma_f32 v58, v58, v61, -v6
    v_exp_f32 v49, v49
    v_exp_f32 v50, v50
    v_exp_f32 v51, v51
    v_exp_f32 v52, v52
    v_exp_f32 v53, v53
    v_exp_f32 v54, v54
    v_exp_f32 v55, v55
    v_exp_f32 v56, v56
    v_exp_f32 v57, v57
    v_exp_f32 v58, v58
    v_add_f32 v7, v7, v49
    v_add_f32 v7, v7, v50
    v_add_f32 v7, v7, v51
    v_add_f32 v7, v7, v52
    v_add_f32 v7, v7, v53
    v_add_f32 v7, v7, v54
    v_add_f32 v7, v7, v55
    v_add_f32 v7, v7, v56
    v_add_f32 v7, v7, v57
    v_add_f32 v7, v7, v58
    v_cvt_pk_bf16_f32 v49, v49, v49
    v_cvt_pk_bf16_f32 v50, v50, v50
    v_cvt_pk_bf16_f32 v51, v51, v51
    v_cvt_pk_bf16_f32 v52, v52, v52
    v_cvt_pk_bf16_f32 v53, v53, v53
    v_cvt_pk_bf16_f32 v54, v54, v54
    v_cvt_pk_bf16_f32 v55, v55, v55
    v_cvt_pk_bf16_f32 v56, v56, v56
    v_cvt_pk_bf16_f32 v57, v57, v57
    v_cvt_pk_bf16_f32 v58, v58, v58
    v_add_f32_dpp v7, v7, v7 row_ror:8 row_mask:0xf bank_mask:0xf
    s_nop 1
    v_add_f32_dpp v7, v7, v7 row_ror:4 row_mask:0xf bank_mask:0xf
    s_nop 1
    v_add_f32_dpp v7, v7, v7 row_ror:2 row_mask:0xf bank_mask:0xf
    s_nop 1
    v_add_f32_dpp v7, v7, v7 row_ror:1 row_mask:0xf bank_mask:0xf
    s_nop 1
    v_add_f32_dpp v7, v7, v7 row_bcast:15 row_mask:0xa bank_mask:0xf
    s_nop 1
    v_add_f32_dpp v7, v7, v7 row_bcast:31 row_mask:0xc bank_mask:0xf
    s_nop 0
    v_readlane_b32 s70, v7, 63
    s_lshl_b32 s25, s3, 4
    s_add_u32 s25, s25, s34
    s_mov_b64 exec, 1
    v_mov_b32 v7, s70
    s_cmp_lg_u32 s75, 0
    s_cbranch_scc1 L_far8
    buffer_store_dwordx2 v[6:7], off, s[12:15], s25
    s_branch L_near8
L_far8:
    buffer_store_dwordx2 v[6:7], off, s[12:15], s25 sc1
L_near8:
    s_mov_b64 exec, -1
L_BV_d:
    v_and_b32_dpp v8, v48, v20 row_newbcast:7 row_mask:0xf bank_mask:0xf
    v_and_b32_dpp v9, v48, v21 row_newbcast:7 row_mask:0xf bank_mask:0xf
    v_and_b32_dpp v10, v48, v22 row_newbcast:7 row_mask:0xf bank_mask:0xf
    v_and_b32_dpp v11, v48, v23 row_newbcast:7 row_mask:0xf bank_mask:0xf
    s_waitcnt vmcnt(15)
    s_nop 0
    v_mfma_f32_16x16x32_bf16 v[12:15], v[116:119], v[8:11], v[12:15]
    buffer_load_dwordx4 v[116:119], v1, s[4:7], s32 offen offset:0 nt
    s_add_u32 s32, s32, 6144
    v_and_b32_dpp v8, v48, v20 row_newbcast:11 row_mask:0xf bank_mask:0xf
    v_and_b32_dpp v9, v48, v21 row_newbcast:11 row_mask:0xf bank_mask:0xf
    v_and_b32_dpp v10, v48, v22 row_newbcast:11 row_mask:0xf bank_mask:0xf
    v_and_b32_dpp v11, v48, v23 row_newbcast:11 row_mask:0xf bank_mask:0xf
    s_waitcnt vmcnt(15)
    s_nop 0
    v_mfma_f32_16x16x32_bf16 v[12:15], v[120:123], v[8:11], v[12:15]
    buffer_load_dwordx4 v[120:123], v1, s[4:7], s32 offen offset:0 nt
    s_add_u32 s32, s32, 6144
    v_and_b32_dpp v8, v48, v20 row_newbcast:15 row_mask:0xf bank_mask:0xf
    v_and_b32_dpp v9, v48, v21 row_newbcast:15 row_mask:0xf bank_mask:0xf
    v_and_b32_dpp v10, v48, v22 row_newbcast:15 row_mask:0xf bank_mask:0xf
    v_and_b32_dpp v11, v48, v23 row_newbcast:15 row_mask:0xf bank_mask:0xf
    s_waitcnt vmcnt(15)
    s_nop 0
    v_mfma_f32_16x16x32_bf16 v[12:15], v[124:127], v[8:11], v[12:15]
    buffer_load_dwordx4 v[124:127], v1, s[4:7], s32 offen offset:0 nt
    s_add_u32 s32, s32, 6144
    v_mov_b32 v48, v49
    v_mov_b32 v49, v50
    v_mov_b32 v50, v51
    v_mov_b32 v51, v52
    v_mov_b32 v52, v53
    v_mov_b32 v53, v54
    v_mov_b32 v54, v55
    v_mov_b32 v55, v56
    v_mov_b32 v56, v57
    v_mov_b32 v57, v58
    s_add_u32 s27, s27, 1
    s_branch L_BV
L_BT:
    v_and_b32_dpp v8, v48, v20 row_newbcast:10 row_mask:0xf bank_mask:0xf
    v_and_b32_dpp v9, v48, v21 row_newbcast:10 row_mask:0xf bank_mask:0xf
    v_and_b32_dpp v10, v48, v22 row_newbcast:10 row_mask:0xf bank_mask:0xf
    v_and_b32_dpp v11, v48, v23 row_newbcast:10 row_mask:0xf bank_mask:0xf
    s_waitcnt vmcnt(15)
    s_nop 0
    v_mfma_f32_16x16x32_bf16 v[12:15], v[104:107], v[8:11], v[12:15]
    buffer_load_dwordx4 v[104:107], v1, s[4:7], s28 offen offset:0 nt
    v_and_b32_dpp v8, v48, v20 row_newbcast:14 row_mask:0xf bank_mask:0xf
    v_and_b32_dpp v9, v48, v21 row_newbcast:14 row_mask:0xf bank_mask:0xf
    v_and_b32_dpp v10, v48, v22 row_newbcast:14 row_mask:0xf bank_mask:0xf
    v_and_b32_dpp v11, v48, v23 row_newbcast:14 row_mask:0xf bank_mask:0xf
    s_waitcnt vmcnt(15)
    s_nop 0
    v_mfma_f32_16x16x32_bf16 v[12:15], v[108:111], v[8:11], v[12:15]
    v_and_b32_dpp v8, v48, v20 row_newbcast:3 row_mask:0xf bank_mask:0xf
    v_and_b32_dpp v9, v48, v21 row_newbcast:3 row_mask:0xf bank_mask:0xf
    v_and_b32_dpp v10, v48, v22 row_newbcast:3 row_mask:0xf bank_mask:0xf
    v_and_b32_dpp v11, v48, v23 row_newbcast:3 row_mask:0xf bank_mask:0xf
    s_waitcnt vmcnt(14)
    s_nop 0
    v_mfma_f32_16x16x32_bf16 v[12:15], v[112:115], v[8:11], v[12:15]
    v_and_b32_dpp v8, v48, v20 row_newbcast:7 row_mask:0xf bank_mask:0xf
    v_and_b32_dpp v9, v48, v21 row_newbcast:7 row_mask:0xf bank_mask:0xf
    v_and_b32_dpp v10, v48, v22 row_newbcast:7 row_mask:0xf bank_mask:0xf
    v_and_b32_dpp v11, v48, v23 row_newbcast:7 row_mask:0xf bank_mask:0xf
    s_waitcnt vmcnt(13)
    s_nop 0
    v_mfma_f32_16x16x32_bf16 v[12:15], v[116:119], v[8:11], v[12:15]
    v_and_b32_dpp v8, v48, v20 row_newbcast:11 row_mask:0xf bank_mask:0xf
    v_and_b32_dpp v9, v48, v21 row_newbcast:11 row_mask:0xf bank_mask:0xf
    v_and_b32_dpp v10, v48, v22 row_newbcast:11 row_mask:0xf bank_mask:0xf
    v_and_b32_dpp v11, v48, v23 row_newbcast:11 row_mask:0xf bank_mask:0xf
    s_waitcnt vmcnt(12)
    s_nop 0
    v_mfma_f32_16x16x32_bf16 v[12:15], v[120:123], v[8:11], v[12:15]
    v_and_b32_dpp v8, v48, v20 row_newbcast:15 row_mask:0xf bank_mask:0xf
    v_and_b32_dpp v9, v48, v21 row_newbcast:15 row_mask:0xf bank_mask:0xf
    v_and_b32_dpp v10, v48, v22 row_newbcast:15 row_mask:0xf bank_mask:0xf
    v_and_b32_dpp v11, v48, v23 row_newbcast:15 row_mask:0xf bank_mask:0xf
    s_waitcnt vmcnt(11)
    s_nop 0
    v_mfma_f32_16x16x32_bf16 v[12:15], v[124:127], v[8:11], v[12:15]
    v_and_b32_dpp v8, v49, v20 row_newbcast:0 row_mask:0xf bank_mask:0xf
    v_and_b32_dpp v9, v49, v21 row_newbcast:0 row_mask:0xf bank_mask:0xf
    v_and_b32_dpp v10, v49, v22 row_newbcast:0 row_mask:0xf bank_mask:0xf
    v_and_b32_dpp v11, v49, v23 row_newbcast:0 row_mask:0xf bank_mask:0xf
    s_waitcnt vmcnt(10)
    s_nop 0
    v_mfma_f32_16x16x32_bf16 v[12:15], v[64:67], v[8:11], v[12:15]
    v_and_b32_dpp v8, v49, v20 row_newbcast:4 row_mask:0xf bank_mask:0xf
    v_and_b32_dpp v9, v49, v21 row_newbcast:4 row_mask:0xf bank_mask:0xf
    v_and_b32_dpp v10, v49, v22 row_newbcast:4 row_mask:0xf bank_mask:0xf
    v_and_b32_dpp v11, v49, v23 row_newbcast:4 row_mask:0xf bank_mask:0xf
    s_waitcnt vmcnt(9)
    s_nop 0
    v_mfma_f32_16x16x32_bf16 v[12:15], v[68:71], v[8:11], v[12:15]
    v_and_b32_dpp v8, v49, v20 row_newbcast:8 row_mask:0xf bank_mask:0xf
    v_and_b32_dpp v9, v49, v21 row_newbcast:8 row_mask:0xf bank_mask:0xf
    v_and_b32_dpp v10, v49, v22 row_newbcast:8 row_mask:0xf bank_mask:0xf
    v_and_b32_dpp v11, v49, v23 row_newbcast:8 row_mask:0xf bank_mask:0xf
    s_waitcnt vmcnt(8)
    s_nop 0
    v_mfma_f32_16x16x32_bf16 v[12:15], v[72:75], v[8:11], v[12:15]
    v_and_b32_dpp v8, v49, v20 row_newbcast:12 row_mask:0xf bank_mask:0xf
    v_and_b32_dpp v9, v49, v21 row_newbcast:12 row_mask:0xf bank_mask:0xf
    v_and_b32_dpp v10, v49, v22 row_newbcast:12 row_mask:0xf bank_mask:0xf
    v_and_b32_dpp v11, v49, v23 row_newbcast:12 row_mask:0xf bank_mask:0xf
    s_waitcnt vmcnt(7)
    s_nop 0
    v_mfma_f32_16x16x32_bf16 v[12:15], v[76:79], v[8:11], v[12:15]
    v_and_b32_dpp v8, v49, v20 row_newbcast:1 row_mask:0xf bank_mask:0xf
    v_and_b32_dpp v9, v49, v21 row_newbcast:1 row_mask:0xf bank_mask:0xf
    v_and_b32_dpp v10, v49, v22 row_newbcast:1 row_mask:0xf bank_mask:0xf
    v_and_b32_dpp v11, v49, v23 row_newbcast:1 row_mask:0xf bank_mask:0xf
    s_waitcnt vmcnt(6)
    s_nop 0
    v_mfma_f32_16x16x32_bf16 v[12:15], v[80:83], v[8:11], v[12:15]
    v_and_b32_dpp v8, v49, v20 row_newbcast:5 row_mask:0xf bank_mask:0xf
    v_and_b32_dpp v9, v49, v21 row_newbcast:5 row_mask:0xf bank_mask:0xf
    v_and_b32_dpp v10, v49, v22 row_newbcast:5 row_mask:0xf bank_mask:0xf
    v_and_b32_dpp v11, v49, v23 row_newbcast:5 row_mask:0xf bank_mask:0xf
    s_waitcnt vmcnt(5)
    s_nop 0
    v_mfma_f32_16x16x32_bf16 v[12:15], v[84:87], v[8:11], v[12:15]
    v_and_b32_dpp v8, v49, v20 row_newbcast:9 row_mask:0xf bank_mask:0xf
    v_and_b32_dpp v9, v49, v21 row_newbcast:9 row_mask:0xf bank_mask:0xf
    v_and_b32_dpp v10, v49, v22 row_newbcast:9 row_mask:0xf bank_mask:0xf
    v_and_b32_dpp v11, v49, v23 row_newbcast:9 row_mask:0xf bank_mask:0xf
    s_waitcnt vmcnt(4)
    s_nop 0
    v_mfma_f32_16x16x32_bf16 v[12:15], v[88:91], v[8:11], v[12:15]
    v_and_b32_dpp v8, v49, v20 row_newbcast:13 row_mask:0xf bank_mask:0xf
    v_and_b32_dpp v9, v49, v21 row_newbcast:13 row_mask:0xf bank_mask:0xf
    v_and_b32_dpp v10, v49, v22 row_newbcast:13 row_mask:0xf bank_mask:0xf
    v_and_b32_dpp v11, v49, v23 row_newbcast:13 row_mask:0xf bank_mask:0xf
    s_waitcnt vmcnt(3)
    s_nop 0
    v_mfma_f32_16x16x32_bf16 v[12:15], v[92:95], v[8:11], v[12:15]
    v_and_b32_dpp v8, v49, v20 row_newbcast:2 row_mask:0xf bank_mask:0xf
    v_and_b32_dpp v9, v49, v21 row_newbcast:2 row_mask:0xf bank_mask:0xf
    v_and_b32_dpp v10, v49, v22 row_newbcast:2 row_mask:0xf bank_mask:0xf
    v_and_b32_dpp v11, v49, v23 row_newbcast:2 row_mask:0xf bank_mask:0xf
    s_waitcnt vmcnt(2)
    s_nop 0
    v_mfma_f32_16x16x32_bf16 v[12:15], v[96:99], v[8:11], v[12:15]
    v_and_b32_dpp v8, v49, v20 row_newbcast:6 row_mask:0xf bank_mask:0xf
    v_and_b32_dpp v9, v49, v21 row_newbcast:6 row_mask:0xf bank_mask:0xf
    v_and_b32_dpp v10, v49, v22 row_newbcast:6 row_mask:0xf bank_mask:0xf
    v_and_b32_dpp v11, v49, v23 row_newbcast:6 row_mask:0xf bank_mask:0xf
    s_waitcnt vmcnt(1)
    s_nop 0
    v_mfma_f32_16x16x32_bf16 v[12:15], v[100:103], v[8:11], v[12:15]
    v_and_b32_dpp v8, v49, v20 row_newbcast:10 row_mask:0xf bank_mask:0xf
    v_and_b32_dpp v9, v49, v21 row_newbcast:10 row_mask:0xf bank_mask:0xf
    v_and_b32_dpp v10, v49, v22 row_newbcast:10 row_mask:0xf bank_mask:0xf
    v_and_b32_dpp v11, v49, v23 row_newbcast:10 row_mask:0xf bank_mask:0xf
    s_waitcnt vmcnt(0)
    s_nop 0
    v_mfma_f32_16x16x32_bf16 v[12:15], v[104:107], v[8:11], v[12:15]
    s_mov_b32 exec_lo, 0x00ff00ff
    s_mov_b32 exec_hi, 0x00ff00ff
    s_cmp_lg_u32 s75, 0
    s_nop 4
    v_cvt_pk_bf16_f32 v4, v12, v13
    v_cvt_pk_bf16_f32 v5, v14, v15
    s_cbranch_scc1 L_far9
    buffer_store_dwordx2 v[4:5], v60, s[12:15], s73 offen
    s_branch L_near9
L_far9:
    buffer_store_dwordx2 v[4:5], v60, s[12:15], s73 offen sc1
L_near9:
    s_endpgm
L_A:
    v_lshrrev_b32 v1, 6, v0
    v_and_b32 v0, 63, v0
    v_readfirstlane_b32 s3, v1
    v_lshlrev_b32 v2, 4, v0
    s_mov_b32 s74, s2
    s_and_b32 s72, s2, 31
    s_and_b32 s70, s2, 6
    s_and_b32 s25, s2, 7
    s_add_u32 s70, s70, s25
    s_lshr_b32 s26, s72, 3
    s_and_b32 s25, s26, 1
    s_lshl_b32 s25, s25, 1
    s_and_b32 s26, s26, 2
    s_lshl_b32 s26, s26, 3
    s_or_b32 s26, s26, s25
    s_or_b32 s26, s26, s70
    v_lshrrev_b32 v3, 4, v0
    v_and_b32 v4, 15, v0
    v_lshlrev_b32 v18, 18, v3
    v_lshl_add_u32 v18, v4, 4, v18
    v_lshrrev_b32 v6, 3, v4
    v_lshlrev_b32 v6, 10, v6
    v_lshl_add_u32 v19, v3, 6, v6
    v_bfe_u32 v1, v0, 2, 2
    v_lshlrev_b32 v64, 18, v1
    v_lshl_add_u32 v64, v3, 6, v64
    v_and_b32 v4, 3, v0
    v_lshl_add_u32 v64, v4, 4, v64
    v_lshlrev_b32 v65, 9, v1
    v_lshl_add_u32 v65, v3, 7, v65
    v_lshl_add_u32 v65, v4, 5, v65
    v_add_u32 v65, 135168, v65
    v_lshlrev_b32 v66, 17, v1
    v_lshl_add_u32 v66, v3, 6, v66
    v_lshl_add_u32 v66, v4, 4, v66
    v_and_b32 v4, 15, v0
    v_lshlrev_b32 v67, 10, v3
    v_lshl_add_u32 v67, v4, 4, v67
    s_lshl_b32 s35, s3, 20
    s_lshl_b32 s24, s26, 8
    s_add_u32 s35, s35, s24
    s_waitcnt lgkmcnt(0)
    s_cmp_lt_u32 s74, 32
    s_cselect_b64 s[4:5], s[40:41], s[54:55]
    s_mov_b32 s6, 0x400000
    s_mov_b32 s7, 0x20000
    s_cselect_b64 s[20:21], s[36:37], s[48:49]
    s_mov_b32 s22, 4096
    s_mov_b32 s23, 0x20000
    s_cselect_b32 s75, 0x400000, 0
    s_lshl_b32 s24, s3, 8
    s_mov_b32 s32, s35
    buffer_load_dwordx4 v[12:15], v67, s[20:23], s24 offen
    buffer_load_dwordx4 v[128:131], v18, s[4:7], s32 offen nt
    s_add_u32 s32, s32, 8192
    buffer_load_dwordx4 v[132:135], v18, s[4:7], s32 offen nt
    s_add_u32 s32, s32, 8192
    buffer_load_dwordx4 v[136:139], v18, s[4:7], s32 offen nt
    s_add_u32 s32, s32, 8192
    buffer_load_dwordx4 v[140:143], v18, s[4:7], s32 offen nt
    s_add_u32 s32, s32, 8192
    buffer_load_dwordx4 v[144:147], v18, s[4:7], s32 offen nt
    s_add_u32 s32, s32, 8192
    buffer_load_dwordx4 v[148:151], v18, s[4:7], s32 offen nt
    s_add_u32 s32, s32, 8192
    buffer_load_dwordx4 v[152:155], v18, s[4:7], s32 offen nt
    s_add_u32 s32, s32, 8192
    buffer_load_dwordx4 v[156:159], v18, s[4:7], s32 offen nt
    s_add_u32 s32, s32, 8192
    buffer_load_dwordx4 v[160:163], v18, s[4:7], s32 offen nt
    s_add_u32 s32, s32, 8192
    buffer_load_dwordx4 v[164:167], v18, s[4:7], s32 offen nt
    s_add_u32 s32, s32, 8192
    buffer_load_dwordx4 v[168:171], v18, s[4:7], s32 offen nt
    s_add_u32 s32, s32, 8192
    buffer_load_dwordx4 v[172:175], v18, s[4:7], s32 offen nt
    s_add_u32 s32, s32, 8192
    s_mov_b32 s12, s62
    s_mov_b32 s13, s63
    s_mov_b32 s14, 0x600000
    s_mov_b32 s15, 0x20000
    s_mov_b32 s16, s60
    s_mov_b32 s17, s61
    s_mov_b32 s18, 0x100
    s_mov_b32 s19, 0x20000
    v_and_b32 v3, 1, v0
    v_lshlrev_b32 v3, 4, v3
    v_mov_b32 v4, 0xffff
    v_lshlrev_b32 v4, v3, v4
    v_bfe_u32 v3, v0, 1, 2
    v_cmp_eq_u32 vcc, 0, v3
    s_nop 1
    v_cndmask_b32 v20, 0, v4, vcc
    v_cmp_eq_u32 vcc, 1, v3
    s_nop 1
    v_cndmask_b32 v21, 0, v4, vcc
    v_cmp_eq_u32 vcc, 2, v3
    s_nop 1
    v_cndmask_b32 v22, 0, v4, vcc
    v_cmp_eq_u32 vcc, 3, v3
    s_nop 1
    v_cndmask_b32 v23, 0, v4, vcc
    v_mov_b32 v3, 0x0c0c0c0c
    s_mov_b32 s24, 0x01000100
    s_mov_b32 s25, 0x03020302
    v_bfi_b32 v24, v20, s24, v3
    v_bfi_b32 v28, v20, s25, v3
    v_bfi_b32 v25, v21, s24, v3
    v_bfi_b32 v29, v21, s25, v3
    v_bfi_b32 v26, v22, s24, v3
    v_bfi_b32 v30, v22, s25, v3
    v_bfi_b32 v27, v23, s24, v3
    v_bfi_b32 v31, v23, s25, v3
    s_mov_b32 s64, 0x22222222
    s_mov_b32 s65, 0x22222222
    s_mov_b32 s66, 0x44444444
    s_mov_b32 s67, 0x44444444
    s_mov_b32 s68, 0x88888888
    s_mov_b32 s69, 0x88888888
    s_lshl_b32 s24, s3, 8
    s_add_u32 s24, s24, 143360
    v_add_u32 v3, s24, v67
    v_add_u32 v4, s24, v19
    s_waitcnt vmcnt(12)
    ds_write_b128 v3, v[12:15]
    s_waitcnt lgkmcnt(0)
    ds_read_b128 v[32:35], v4 offset:0
    ds_read_b128 v[36:39], v4 offset:16
    ds_read_b128 v[40:43], v4 offset:32
    ds_read_b128 v[44:47], v4 offset:48
    ds_read_b128 v[48:51], v4 offset:2048
    ds_read_b128 v[52:55], v4 offset:2064
    ds_read_b128 v[56:59], v4 offset:2080
    ds_read_b128 v[60:63], v4 offset:2096
    s_waitcnt lgkmcnt(0)
    v_mov_b32 v76, -1
    v_mov_b32 v77, -1
    v_mov_b32 v78, -1
    v_mov_b32 v79, -1
    s_lshl_b32 s71, s72, 2
    s_add_u32 s71, s71, s3
    s_lshl_b32 s71, s71, 12
    s_add_u32 s71, s71, 0x1b8000
    s_cmp_lt_u32 s74, 32
    s_cselect_b32 s71, 0x600000, s71
    v_perm_b32 v8, v32, v32, v24
    v_perm_b32 v9, v32, v32, v25
    v_perm_b32 v10, v32, v32, v26
    v_perm_b32 v11, v32, v32, v27
    v_perm_b32 v4, v48, v48, v24
    v_perm_b32 v5, v48, v48, v25
    v_perm_b32 v6, v48, v48, v26
    v_perm_b32 v7, v48, v48, v27
    s_waitcnt vmcnt(11)
    v_mfma_f32_16x16x32_bf16 v[12:15], v[128:131], v[8:11], 0
    v_mfma_f32_16x16x32_bf16 v[68:71], v[128:131], v[4:7], 0
    buffer_load_dwordx4 v[176:179], v18, s[4:7], s32 offen nt
    s_add_u32 s32, s32, 8192
    v_perm_b32 v8, v32, v32, v28
    v_perm_b32 v9, v32, v32, v29
    v_perm_b32 v10, v32, v32, v30
    v_perm_b32 v11, v32, v32, v31
    v_perm_b32 v4, v48, v48, v28
    v_perm_b32 v5, v48, v48, v29
    v_perm_b32 v6, v48, v48, v30
    v_perm_b32 v7, v48, v48, v31
    s_waitcnt vmcnt(11)
    v_mfma_f32_16x16x32_bf16 v[12:15], v[132:135], v[8:11], v[12:15]
    v_mfma_f32_16x16x32_bf16 v[68:71], v[132:135], v[4:7], v[68:71]
    buffer_load_dwordx4 v[180:183], v18, s[4:7], s32 offen nt
    s_add_u32 s32, s32, 8192
    v_perm_b32 v8, v33, v33, v24
    v_perm_b32 v9, v33, v33, v25
    v_perm_b32 v10, v33, v33, v26
    v_perm_b32 v11, v33, v33, v27
    v_perm_b32 v4, v49, v49, v24
    v_perm_b32 v5, v49, v49, v25
    v_perm_b32 v6, v49, v49, v26
    v_perm_b32 v7, v49, v49, v27
    s_waitcnt vmcnt(11)
    v_mfma_f32_16x16x32_bf16 v[12:15], v[136:139], v[8:11], v[12:15]
    v_mfma_f32_16x16x32_bf16 v[68:71], v[136:139], v[4:7], v[68:71]
    buffer_load_dwordx4 v[184:187], v18, s[4:7], s32 offen nt
    s_add_u32 s32, s32, 8192
    v_perm_b32 v8, v33, v33, v28
    v_perm_b32 v9, v33, v33, v29
    v_perm_b32 v10, v33, v33, v30
    v_perm_b32 v11, v33, v33, v31
    v_perm_b32 v4, v49, v49, v28
    v_perm_b32 v5, v49, v49, v29
    v_perm_b32 v6, v49, v49, v30
    v_perm_b32 v7, v49, v49, v31
    s_waitcnt vmcnt(11)
    v_mfma_f32_16x16x32_bf16 v[12:15], v[140:143], v[8:11], v[12:15]
    v_mfma_f32_16x16x32_bf16 v[68:71], v[140:143], v[4:7], v[68:71]
    buffer_load_dwordx4 v[188:191], v18, s[4:7], s32 offen nt
    s_add_u32 s32, s32, 8192
    v_perm_b32 v8, v34, v34, v24
    v_perm_b32 v9, v34, v34, v25
    v_perm_b32 v10, v34, v34, v26
    v_perm_b32 v11, v34, v34, v27
    v_perm_b32 v4, v50, v50, v24
    v_perm_b32 v5, v50, v50, v25
    v_perm_b32 v6, v50, v50, v26
    v_perm_b32 v7, v50, v50, v27
    s_waitcnt vmcnt(11)
    v_mfma_f32_16x16x32_bf16 v[12:15], v[144:147], v[8:11], v[12:15]
    v_mfma_f32_16x16x32_bf16 v[68:71], v[144:147], v[4:7], v[68:71]
    buffer_load_dwordx4 v[192:195], v18, s[4:7], s32 offen nt
    s_add_u32 s32, s32, 8192
    v_perm_b32 v8, v34, v34, v28
    v_perm_b32 v9, v34, v34, v29
    v_perm_b32 v10, v34, v34, v30
    v_perm_b32 v11, v34, v34, v31
    v_perm_b32 v4, v50, v50, v28
    v_perm_b32 v5, v50, v50, v29
    v_perm_b32 v6, v50, v50, v30
    v_perm_b32 v7, v50, v50, v31
    s_waitcnt vmcnt(11)
    v_mfma_f32_16x16x32_bf16 v[12:15], v[148:151], v[8:11], v[12:15]
    v_mfma_f32_16x16x32_bf16 v[68:71], v[148:151], v[4:7], v[68:71]
    buffer_load_dwordx4 v[196:199], v18, s[4:7], s32 offen nt
    s_add_u32 s32, s32, 8192
    v_perm_b32 v8, v35, v35, v24
    v_perm_b32 v9, v35, v35, v25
    v_perm_b32 v10, v35, v35, v26
    v_perm_b32 v11, v35, v35, v27
    v_perm_b32 v4, v51, v51, v24
    v_perm_b32 v5, v51, v51, v25
    v_perm_b32 v6, v51, v51, v26
    v_perm_b32 v7, v51, v51, v27
    s_waitcnt vmcnt(11)
    v_mfma_f32_16x16x32_bf16 v[12:15], v[152:155], v[8:11], v[12:15]
    v_mfma_f32_16x16x32_bf16 v[68:71], v[152:155], v[4:7], v[68:71]
    buffer_load_dwordx4 v[200:203], v18, s[4:7], s32 offen nt
    s_add_u32 s32, s32, 8192
    v_perm_b32 v8, v35, v35, v28
    v_perm_b32 v9, v35, v35, v29
    v_perm_b32 v10, v35, v35, v30
    v_perm_b32 v11, v35, v35, v31
    v_perm_b32 v4, v51, v51, v28
    v_perm_b32 v5, v51, v51, v29
    v_perm_b32 v6, v51, v51, v30
    v_perm_b32 v7, v51, v51, v31
    s_waitcnt vmcnt(11)
    v_mfma_f32_16x16x32_bf16 v[12:15], v[156:159], v[8:11], v[12:15]
    v_mfma_f32_16x16x32_bf16 v[68:71], v[156:159], v[4:7], v[68:71]
    buffer_load_dwordx4 v[204:207], v18, s[4:7], s32 offen nt
    s_add_u32 s32, s32, 8192
    v_perm_b32 v8, v36, v36, v24
    v_perm_b32 v9, v36, v36, v25
    v_perm_b32 v10, v36, v36, v26
    v_perm_b32 v11, v36, v36, v27
    v_perm_b32 v4, v52, v52, v24
    v_perm_b32 v5, v52, v52, v25
    v_perm_b32 v6, v52, v52, v26
    v_perm_b32 v7, v52, v52, v27
    s_waitcnt vmcnt(11)
    v_mfma_f32_16x16x32_bf16 v[12:15], v[160:163], v[8:11], v[12:15]
    v_mfma_f32_16x16x32_bf16 v[68:71], v[160:163], v[4:7], v[68:71]
    buffer_load_dwordx4 v[208:211], v18, s[4:7], s32 offen nt
    s_add_u32 s32, s32, 8192
    v_perm_b32 v8, v36, v36, v28
    v_perm_b32 v9, v36, v36, v29
    v_perm_b32 v10, v36, v36, v30
    v_perm_b32 v11, v36, v36, v31
    v_perm_b32 v4, v52, v52, v28
    v_perm_b32 v5, v52, v52, v29
    v_perm_b32 v6, v52, v52, v30
    v_perm_b32 v7, v52, v52, v31
    s_waitcnt vmcnt(11)
    v_mfma_f32_16x16x32_bf16 v[12:15], v[164:167], v[8:11], v[12:15]
    v_mfma_f32_16x16x32_bf16 v[68:71], v[164:167], v[4:7], v[68:71]
    buffer_load_dwordx4 v[212:215], v18, s[4:7], s32 offen nt
    s_add_u32 s32, s32, 8192
    v_perm_b32 v8, v37, v37, v24
    v_perm_b32 v9, v37, v37, v25
    v_perm_b32 v10, v37, v37, v26
    v_perm_b32 v11, v37, v37, v27
    v_perm_b32 v4, v53, v53, v24
    v_perm_b32 v5, v53, v53, v25
    v_perm_b32 v6, v53, v53, v26
    v_perm_b32 v7, v53, v53, v27
    s_waitcnt vmcnt(11)
    v_mfma_f32_16x16x32_bf16 v[12:15], v[168:171], v[8:11], v[12:15]
    v_mfma_f32_16x16x32_bf16 v[68:71], v[168:171], v[4:7], v[68:71]
    buffer_load_dwordx4 v[216:219], v18, s[4:7], s32 offen nt
    s_add_u32 s32, s32, 8192
    v_perm_b32 v8, v37, v37, v28
    v_perm_b32 v9, v37, v37, v29
    v_perm_b32 v10, v37, v37, v30
    v_perm_b32 v11, v37, v37, v31
    v_perm_b32 v4, v53, v53, v28
    v_perm_b32 v5, v53, v53, v29
    v_perm_b32 v6, v53, v53, v30
    v_perm_b32 v7, v53, v53, v31
    s_waitcnt vmcnt(11)
    v_mfma_f32_16x16x32_bf16 v[12:15], v[172:175], v[8:11], v[12:15]
    v_mfma_f32_16x16x32_bf16 v[68:71], v[172:175], v[4:7], v[68:71]
    buffer_load_dwordx4 v[220:223], v18, s[4:7], s32 offen nt
    s_add_u32 s32, s32, 8192
    v_perm_b32 v8, v38, v38, v24
    v_perm_b32 v9, v38, v38, v25
    v_perm_b32 v10, v38, v38, v26
    v_perm_b32 v11, v38, v38, v27
    v_perm_b32 v4, v54, v54, v24
    v_perm_b32 v5, v54, v54, v25
    v_perm_b32 v6, v54, v54, v26
    v_perm_b32 v7, v54, v54, v27
    s_waitcnt vmcnt(11)
    v_mfma_f32_16x16x32_bf16 v[12:15], v[176:179], v[8:11], v[12:15]
    v_mfma_f32_16x16x32_bf16 v[68:71], v[176:179], v[4:7], v[68:71]
    buffer_load_dwordx4 v[224:227], v18, s[4:7], s32 offen nt
    s_add_u32 s32, s32, 8192
    v_perm_b32 v8, v38, v38, v28
    v_perm_b32 v9, v38, v38, v29
    v_perm_b32 v10, v38, v38, v30
    v_perm_b32 v11, v38, v38, v31
    v_perm_b32 v4, v54, v54, v28
    v_perm_b32 v5, v54, v54, v29
    v_perm_b32 v6, v54, v54, v30
    v_perm_b32 v7, v54, v54, v31
    s_waitcnt vmcnt(11)
    v_mfma_f32_16x16x32_bf16 v[12:15], v[180:183], v[8:11], v[12:15]
    v_mfma_f32_16x16x32_bf16 v[68:71], v[180:183], v[4:7], v[68:71]
    buffer_load_dwordx4 v[228:231], v18, s[4:7], s32 offen nt
    s_add_u32 s32, s32, 8192
    v_perm_b32 v8, v39, v39, v24
    v_perm_b32 v9, v39, v39, v25
    v_perm_b32 v10, v39, v39, v26
    v_perm_b32 v11, v39, v39, v27
    v_perm_b32 v4, v55, v55, v24
    v_perm_b32 v5, v55, v55, v25
    v_perm_b32 v6, v55, v55, v26
    v_perm_b32 v7, v55, v55, v27
    s_waitcnt vmcnt(11)
    v_mfma_f32_16x16x32_bf16 v[12:15], v[184:187], v[8:11], v[12:15]
    v_mfma_f32_16x16x32_bf16 v[68:71], v[184:187], v[4:7], v[68:71]
    buffer_load_dwordx4 v[232:235], v18, s[4:7], s32 offen nt
    s_add_u32 s32, s32, 8192
    v_perm_b32 v8, v39, v39, v28
    v_perm_b32 v9, v39, v39, v29
    v_perm_b32 v10, v39, v39, v30
    v_perm_b32 v11, v39, v39, v31
    v_perm_b32 v4, v55, v55, v28
    v_perm_b32 v5, v55, v55, v29
    v_perm_b32 v6, v55, v55, v30
    v_perm_b32 v7, v55, v55, v31
    s_waitcnt vmcnt(11)
    v_mfma_f32_16x16x32_bf16 v[12:15], v[188:191], v[8:11], v[12:15]
    v_mfma_f32_16x16x32_bf16 v[68:71], v[188:191], v[4:7], v[68:71]
    buffer_load_dwordx4 v[236:239], v18, s[4:7], s32 offen nt
    s_add_u32 s32, s32, 8192
    v_perm_b32 v8, v40, v40, v24
    v_perm_b32 v9, v40, v40, v25
    v_perm_b32 v10, v40, v40, v26
    v_perm_b32 v11, v40, v40, v27
    v_perm_b32 v4, v56, v56, v24
    v_perm_b32 v5, v56, v56, v25
    v_perm_b32 v6, v56, v56, v26
    v_perm_b32 v7, v56, v56, v27
    s_waitcnt vmcnt(11)
    v_mfma_f32_16x16x32_bf16 v[12:15], v[192:195], v[8:11], v[12:15]
    v_mfma_f32_16x16x32_bf16 v[68:71], v[192:195], v[4:7], v[68:71]
    buffer_load_dwordx4 v[240:243], v18, s[4:7], s32 offen nt
    s_add_u32 s32, s32, 8192
    v_perm_b32 v8, v40, v40, v28
    v_perm_b32 v9, v40, v40, v29
    v_perm_b32 v10, v40, v40, v30
    v_perm_b32 v11, v40, v40, v31
    v_perm_b32 v4, v56, v56, v28
    v_perm_b32 v5, v56, v56, v29
    v_perm_b32 v6, v56, v56, v30
    v_perm_b32 v7, v56, v56, v31
    s_waitcnt vmcnt(11)
    v_mfma_f32_16x16x32_bf16 v[12:15], v[196:199], v[8:11], v[12:15]
    v_mfma_f32_16x16x32_bf16 v[68:71], v[196:199], v[4:7], v[68:71]
    buffer_load_dwordx4 v[244:247], v18, s[4:7], s32 offen nt
    s_add_u32 s32, s32, 8192
    v_perm_b32 v8, v41, v41, v24
    v_perm_b32 v9, v41, v41, v25
    v_perm_b32 v10, v41, v41, v26
    v_perm_b32 v11, v41, v41, v27
    v_perm_b32 v4, v57, v57, v24
    v_perm_b32 v5, v57, v57, v25
    v_perm_b32 v6, v57, v57, v26
    v_perm_b32 v7, v57, v57, v27
    s_waitcnt vmcnt(11)
    v_mfma_f32_16x16x32_bf16 v[12:15], v[200:203], v[8:11], v[12:15]
    v_mfma_f32_16x16x32_bf16 v[68:71], v[200:203], v[4:7], v[68:71]
    buffer_load_dwordx4 v[248:251], v18, s[4:7], s32 offen nt
    s_add_u32 s32, s32, 8192
    v_perm_b32 v8, v41, v41, v28
    v_perm_b32 v9, v41, v41, v29
    v_perm_b32 v10, v41, v41, v30
    v_perm_b32 v11, v41, v41, v31
    v_perm_b32 v4, v57, v57, v28
    v_perm_b32 v5, v57, v57, v29
    v_perm_b32 v6, v57, v57, v30
    v_perm_b32 v7, v57, v57, v31
    s_waitcnt vmcnt(11)
    v_mfma_f32_16x16x32_bf16 v[12:15], v[204:207], v[8:11], v[12:15]
    v_mfma_f32_16x16x32_bf16 v[68:71], v[204:207], v[4:7], v[68:71]
    buffer_load_dwordx4 v[252:255], v18, s[4:7], s32 offen nt
    s_add_u32 s32, s32, 8192
    v_perm_b32 v8, v42, v42, v24
    v_perm_b32 v9, v42, v42, v25
    v_perm_b32 v10, v42, v42, v26
    v_perm_b32 v11, v42, v42, v27
    v_perm_b32 v4, v58, v58, v24
    v_perm_b32 v5, v58, v58, v25
    v_perm_b32 v6, v58, v58, v26
    v_perm_b32 v7, v58, v58, v27
    s_waitcnt vmcnt(11)
    v_mfma_f32_16x16x32_bf16 v[12:15], v[208:211], v[8:11], v[12:15]
    v_mfma_f32_16x16x32_bf16 v[68:71], v[208:211], v[4:7], v[68:71]
    s_lshl_b32 s73, s74, 7
    s_add_u32 s73, s73, 0x170000
    s_cmp_lg_u32 s3, 0
    s_cbranch_scc1 L_A_nofl
    s_mov_b64 exec, 1
    buffer_store_dwordx4 v[76:79], off, s[12:15], s73 sc1
    s_mov_b64 exec, -1
L_A_nofl:
    s_cmp_ge_u32 s71, 0x1f9000
    s_cselect_b32 s71, 0x600000, s71
    buffer_store_dwordx4 v[76:79], v2, s[12:15], s71 offen sc1
    s_add_u32 s71, s71, 0x20000
    s_getpc_b64 s[24:25]
L_pc10:
    s_add_u32 s24, s24, L_A2-L_pc10
    s_addc_u32 s25, s25, 0
    v_lshl_add_u32 v16, v0, 2, s3
    v_lshlrev_b32 v16, 7, v16
    v_min_u32 v16, L_last-L_A2-4, v16
    v_mov_b32 v17, s25
    v_add_co_u32 v16, vcc, s24, v16
    s_nop 1
    v_addc_co_u32 v17, vcc, 0, v17, vcc
    global_load_dword v17, v[16:17], off
    s_mov_b32 s4, s42
    s_mov_b32 s5, s43
    s_mov_b32 s6, s75
    s_mov_b32 s32, s35
    buffer_load_dwordx4 v[128:131], v64, s[4:7], s32 offen nt
    s_add_u32 s32, s32, 8192
    v_perm_b32 v8, v42, v42, v28
    v_perm_b32 v9, v42, v42, v29
    v_perm_b32 v10, v42, v42, v30
    v_perm_b32 v11, v42, v42, v31
    v_perm_b32 v4, v58, v58, v28
    v_perm_b32 v5, v58, v58, v29
    v_perm_b32 v6, v58, v58, v30
    v_perm_b32 v7, v58, v58, v31
    s_waitcnt vmcnt(13)
    v_mfma_f32_16x16x32_bf16 v[12:15], v[212:215], v[8:11], v[12:15]
    v_mfma_f32_16x16x32_bf16 v[68:71], v[212:215], v[4:7], v[68:71]
    buffer_load_dwordx4 v[132:135], v64, s[4:7], s32 offen nt
    s_add_u32 s32, s32, 8192
    v_perm_b32 v8, v43, v43, v24
    v_perm_b32 v9, v43, v43, v25
    v_perm_b32 v10, v43, v43, v26
    v_perm_b32 v11, v43, v43, v27
    v_perm_b32 v4, v59, v59, v24
    v_perm_b32 v5, v59, v59, v25
    v_perm_b32 v6, v59, v59, v26
    v_perm_b32 v7, v59, v59, v27
    s_waitcnt vmcnt(13)
    v_mfma_f32_16x16x32_bf16 v[12:15], v[216:219], v[8:11], v[12:15]
    v_mfma_f32_16x16x32_bf16 v[68:71], v[216:219], v[4:7], v[68:71]
    buffer_load_dwordx4 v[136:139], v64, s[4:7], s32 offen nt
    s_add_u32 s32, s32, 8192
    v_perm_b32 v8, v43, v43, v28
    v_perm_b32 v9, v43, v43, v29
    v_perm_b32 v10, v43, v43, v30
    v_perm_b32 v11, v43, v43, v31
    v_perm_b32 v4, v59, v59, v28
    v_perm_b32 v5, v59, v59, v29
    v_perm_b32 v6, v59, v59, v30
    v_perm_b32 v7, v59, v59, v31
    s_waitcnt vmcnt(13)
    v_mfma_f32_16x16x32_bf16 v[12:15], v[220:223], v[8:11], v[12:15]
    v_mfma_f32_16x16x32_bf16 v[68:71], v[220:223], v[4:7], v[68:71]
    buffer_load_dwordx4 v[140:143], v64, s[4:7], s32 offen nt
    s_add_u32 s32, s32, 8192
    v_perm_b32 v8, v44, v44, v24
    v_perm_b32 v9, v44, v44, v25
    v_perm_b32 v10, v44, v44, v26
    v_perm_b32 v11, v44, v44, v27
    v_perm_b32 v4, v60, v60, v24
    v_perm_b32 v5, v60, v60, v25
    v_perm_b32 v6, v60, v60, v26
    v_perm_b32 v7, v60, v60, v27
    s_waitcnt vmcnt(13)
    v_mfma_f32_16x16x32_bf16 v[12:15], v[224:227], v[8:11], v[12:15]
    v_mfma_f32_16x16x32_bf16 v[68:71], v[224:227], v[4:7], v[68:71]
    buffer_load_dwordx4 v[144:147], v64, s[4:7], s32 offen nt
    s_add_u32 s32, s32, 8192
    v_perm_b32 v8, v44, v44, v28
    v_perm_b32 v9, v44, v44, v29
    v_perm_b32 v10, v44, v44, v30
    v_perm_b32 v11, v44, v44, v31
    v_perm_b32 v4, v60, v60, v28
    v_perm_b32 v5, v60, v60, v29
    v_perm_b32 v6, v60, v60, v30
    v_perm_b32 v7, v60, v60, v31
    s_waitcnt vmcnt(13)
    v_mfma_f32_16x16x32_bf16 v[12:15], v[228:231], v[8:11], v[12:15]
    v_mfma_f32_16x16x32_bf16 v[68:71], v[228:231], v[4:7], v[68:71]
    buffer_load_dwordx4 v[148:151], v64, s[4:7], s32 offen nt
    s_add_u32 s32, s32, 8192
    v_perm_b32 v8, v45, v45, v24
    v_perm_b32 v9, v45, v45, v25
    v_perm_b32 v10, v45, v45, v26
    v_perm_b32 v11, v45, v45, v27
    v_perm_b32 v4, v61, v61, v24
    v_perm_b32 v5, v61, v61, v25
    v_perm_b32 v6, v61, v61, v26
    v_perm_b32 v7, v61, v61, v27
    s_waitcnt vmcnt(13)
    v_mfma_f32_16x16x32_bf16 v[12:15], v[232:235], v[8:11], v[12:15]
    v_mfma_f32_16x16x32_bf16 v[68:71], v[232:235], v[4:7], v[68:71]
    buffer_load_dwordx4 v[152:155], v64, s[4:7], s32 offen nt
    s_add_u32 s32, s32, 8192
    v_perm_b32 v8, v45, v45, v28
    v_perm_b32 v9, v45, v45, v29
    v_perm_b32 v10, v45, v45, v30
    v_perm_b32 v11, v45, v45, v31
    v_perm_b32 v4, v61, v61, v28
    v_perm_b32 v5, v61, v61, v29
    v_perm_b32 v6, v61, v61, v30
    v_perm_b32 v7, v61, v61, v31
    s_waitcnt vmcnt(13)
    v_mfma_f32_16x16x32_bf16 v[12:15], v[236:239], v[8:11], v[12:15]
    v_mfma_f32_16x16x32_bf16 v[68:71], v[236:239], v[4:7], v[68:71]
    buffer_load_dwordx4 v[156:159], v64, s[4:7], s32 offen nt
    s_add_u32 s32, s32, 8192
    v_perm_b32 v8, v46, v46, v24
    v_perm_b32 v9, v46, v46, v25
    v_perm_b32 v10, v46, v46, v26
    v_perm_b32 v11, v46, v46, v27
    v_perm_b32 v4, v62, v62, v24
    v_perm_b32 v5, v62, v62, v25
    v_perm_b32 v6, v62, v62, v26
    v_perm_b32 v7, v62, v62, v27
    s_waitcnt vmcnt(13)
    v_mfma_f32_16x16x32_bf16 v[12:15], v[240:243], v[8:11], v[12:15]
    v_mfma_f32_16x16x32_bf16 v[68:71], v[240:243], v[4:7], v[68:71]
    buffer_load_dwordx4 v[160:163], v64, s[4:7], s32 offen nt
    s_add_u32 s32, s32, 8192
    v_perm_b32 v8, v46, v46, v28
    v_perm_b32 v9, v46, v46, v29
    v_perm_b32 v10, v46, v46, v30
    v_perm_b32 v11, v46, v46, v31
    v_perm_b32 v4, v62, v62, v28
    v_perm_b32 v5, v62, v62, v29
    v_perm_b32 v6, v62, v62, v30
    v_perm_b32 v7, v62, v62, v31
    s_waitcnt vmcnt(13)
    v_mfma_f32_16x16x32_bf16 v[12:15], v[244:247], v[8:11], v[12:15]
    v_mfma_f32_16x16x32_bf16 v[68:71], v[244:247], v[4:7], v[68:71]
    buffer_load_dwordx4 v[164:167], v64, s[4:7], s32 offen nt
    s_add_u32 s32, s32, 8192
    v_perm_b32 v8, v47, v47, v24
    v_perm_b32 v9, v47, v47, v25
    v_perm_b32 v10, v47, v47, v26
    v_perm_b32 v11, v47, v47, v27
    v_perm_b32 v4, v63, v63, v24
    v_perm_b32 v5, v63, v63, v25
    v_perm_b32 v6, v63, v63, v26
    v_perm_b32 v7, v63, v63, v27
    s_waitcnt vmcnt(13)
    v_mfma_f32_16x16x32_bf16 v[12:15], v[248:251], v[8:11], v[12:15]
    v_mfma_f32_16x16x32_bf16 v[68:71], v[248:251], v[4:7], v[68:71]
    buffer_load_dwordx4 v[168:171], v64, s[4:7], s32 offen nt
    s_add_u32 s32, s32, 8192
    v_perm_b32 v8, v47, v47, v28
    v_perm_b32 v9, v47, v47, v29
    v_perm_b32 v10, v47, v47, v30
    v_perm_b32 v11, v47, v47, v31
    v_perm_b32 v4, v63, v63, v28
    v_perm_b32 v5, v63, v63, v29
    v_perm_b32 v6, v63, v63, v30
    v_perm_b32 v7, v63, v63, v31
    s_waitcnt vmcnt(13)
    v_mfma_f32_16x16x32_bf16 v[12:15], v[252:255], v[8:11], v[12:15]
    v_mfma_f32_16x16x32_bf16 v[68:71], v[252:255], v[4:7], v[68:71]
    buffer_load_dwordx4 v[172:175], v64, s[4:7], s32 offen nt
    s_add_u32 s32, s32, 8192
    v_lshrrev_b32 v3, 4, v0
    v_lshlrev_b32 v3, 7, v3
    v_and_b32 v4, 7, v0
    v_lshl_add_u32 v3, v4, 2, v3
    v_bfe_u32 v4, v0, 3, 1
    v_lshl_add_u32 v3, v4, 9, v3
    s_lshl_b32 s24, s3, 11
    s_add_u32 s24, s24, 135168
    v_add_u32 v3, s24, v3
    ds_write_b32 v3, v12 offset:0
    ds_write_b32 v3, v13 offset:32
    ds_write_b32 v3, v14 offset:64
    ds_write_b32 v3, v15 offset:96
    ds_write_b32 v3, v68 offset:1024
    ds_write_b32 v3, v69 offset:1056
    ds_write_b32 v3, v70 offset:1088
    ds_write_b32 v3, v71 offset:1120
    s_waitcnt lgkmcnt(0)
    s_barrier
    ds_read_b128 v[72:75], v65 offset:0
    ds_read_b128 v[76:79], v65 offset:16
    ds_read_b128 v[80:83], v65 offset:2048
    ds_read_b128 v[84:87], v65 offset:2064
    ds_read_b128 v[88:91], v65 offset:4096
    ds_read_b128 v[92:95], v65 offset:4112
    ds_read_b128 v[96:99], v65 offset:6144
    ds_read_b128 v[100:103], v65 offset:6160
    s_waitcnt lgkmcnt(4)
    v_add_f32 v72, v72, v80
    v_add_f32 v73, v73, v81
    v_add_f32 v74, v74, v82
    v_add_f32 v75, v75, v83
    v_add_f32 v76, v76, v84
    v_add_f32 v77, v77, v85
    v_add_f32 v78, v78, v86
    v_add_f32 v79, v79, v87
    s_waitcnt lgkmcnt(2)
    v_add_f32 v72, v72, v88
    v_add_f32 v73, v73, v89
    v_add_f32 v74, v74, v90
    v_add_f32 v75, v75, v91
    v_add_f32 v76, v76, v92
    v_add_f32 v77, v77, v93
    v_add_f32 v78, v78, v94
    v_add_f32 v79, v79, v95
    s_waitcnt lgkmcnt(0)
    v_add_f32 v72, v72, v96
    v_add_f32 v73, v73, v97
    v_add_f32 v74, v74, v98
    v_add_f32 v75, v75, v99
    v_add_f32 v76, v76, v100
    v_add_f32 v77, v77, v101
    v_add_f32 v78, v78, v102
    v_add_f32 v79, v79, v103
    v_cvt_pk_bf16_f32 v8, v72, v73
    v_cvt_pk_bf16_f32 v9, v74, v75
    v_cvt_pk_bf16_f32 v10, v76, v77
    v_cvt_pk_bf16_f32 v11, v78, v79
    s_cmp_ge_u32 s74, 32
    s_cbranch_scc1 L_C
L_A2:
    buffer_load_dwordx4 v[176:179], v64, s[4:7], s32 offen nt
    s_add_u32 s32, s32, 8192
    buffer_load_dwordx4 v[180:183], v64, s[4:7], s32 offen nt
    s_add_u32 s32, s32, 8192
    buffer_load_dwordx4 v[184:187], v64, s[4:7], s32 offen nt
    s_add_u32 s32, s32, 8192
    buffer_load_dwordx4 v[188:191], v64, s[4:7], s32 offen nt
    s_add_u32 s32, s32, 8192
    buffer_load_dwordx4 v[192:195], v64, s[4:7], s32 offen nt
    s_add_u32 s32, s32, 8192
    buffer_load_dwordx4 v[196:199], v64, s[4:7], s32 offen nt
    s_add_u32 s32, s32, 8192
    buffer_load_dwordx4 v[200:203], v64, s[4:7], s32 offen nt
    s_add_u32 s32, s32, 8192
    buffer_load_dwordx4 v[204:207], v64, s[4:7], s32 offen nt
    s_add_u32 s32, s32, 8192
    buffer_load_dwordx4 v[208:211], v64, s[4:7], s32 offen nt
    s_add_u32 s32, s32, 8192
    buffer_load_dwordx4 v[212:215], v64, s[4:7], s32 offen nt
    s_add_u32 s32, s32, 8192
    buffer_load_dwordx4 v[216:219], v64, s[4:7], s32 offen nt
    s_add_u32 s32, s32, 8192
    buffer_load_dwordx4 v[220:223], v64, s[4:7], s32 offen nt
    s_add_u32 s32, s32, 8192
    buffer_load_dwordx4 v[224:227], v64, s[4:7], s32 offen nt
    s_add_u32 s32, s32, 8192
    buffer_load_dwordx4 v[228:231], v64, s[4:7], s32 offen nt
    s_add_u32 s32, s32, 8192
    buffer_load_dwordx4 v[232:235], v64, s[4:7], s32 offen nt
    s_add_u32 s32, s32, 8192
    buffer_load_dwordx4 v[236:239], v64, s[4:7], s32 offen nt
    s_add_u32 s32, s32, 8192
    buffer_load_dwordx4 v[240:243], v64, s[4:7], s32 offen nt
    s_add_u32 s32, s32, 8192
    buffer_load_dwordx4 v[244:247], v64, s[4:7], s32 offen nt
    s_add_u32 s32, s32, 8192
    buffer_load_dwordx4 v[248:251], v64, s[4:7], s32 offen nt
    s_add_u32 s32, s32, 8192
    buffer_load_dwordx4 v[252:255], v64, s[4:7], s32 offen nt
    s_add_u32 s32, s32, 8192
    s_waitcnt vmcnt(31)
    v_mfma_f32_16x16x32_bf16 v[80:83], v[128:131], v[8:11], 0
    s_waitcnt vmcnt(30)
    v_mfma_f32_16x16x32_bf16 v[84:87], v[132:135], v[8:11], 0
    s_waitcnt vmcnt(29)
    v_mfma_f32_16x16x32_bf16 v[88:91], v[136:139], v[8:11], 0
    s_waitcnt vmcnt(28)
    v_mfma_f32_16x16x32_bf16 v[92:95], v[140:143], v[8:11], 0
    s_waitcnt vmcnt(27)
    v_mfma_f32_16x16x32_bf16 v[96:99], v[144:147], v[8:11], 0
    s_waitcnt vmcnt(26)
    v_mfma_f32_16x16x32_bf16 v[100:103], v[148:151], v[8:11], 0
    s_waitcnt vmcnt(25)
    v_mfma_f32_16x16x32_bf16 v[104:107], v[152:155], v[8:11], 0
    s_waitcnt vmcnt(24)
    v_mfma_f32_16x16x32_bf16 v[108:111], v[156:159], v[8:11], 0
    v_add_f32_dpp v72, v81, v80 quad_perm:[1,1,1,1] row_mask:0xf bank_mask:0xf
    v_add_f32_dpp v73, v85, v84 quad_perm:[1,1,1,1] row_mask:0xf bank_mask:0xf
    v_add_f32_dpp v74, v89, v88 quad_perm:[1,1,1,1] row_mask:0xf bank_mask:0xf
    v_add_f32_dpp v75, v93, v92 quad_perm:[1,1,1,1] row_mask:0xf bank_mask:0xf
    v_add_f32_dpp v76, v97, v96 quad_perm:[1,1,1,1] row_mask:0xf bank_mask:0xf
    v_add_f32_dpp v77, v101, v100 quad_perm:[1,1,1,1] row_mask:0xf bank_mask:0xf
    v_add_f32_dpp v78, v105, v104 quad_perm:[1,1,1,1] row_mask:0xf bank_mask:0xf
    s_nop 0
    v_add_f32_dpp v79, v109, v108 quad_perm:[1,1,1,1] row_mask:0xf bank_mask:0xf
    v_add_f32_dpp v72, v82, v72 quad_perm:[2,2,2,2] row_mask:0xf bank_mask:0xf
    v_add_f32_dpp v73, v86, v73 quad_perm:[2,2,2,2] row_mask:0xf bank_mask:0xf
    v_add_f32_dpp v74, v90, v74 quad_perm:[2,2,2,2] row_mask:0xf bank_mask:0xf
    v_add_f32_dpp v75, v94, v75 quad_perm:[2,2,2,2] row_mask:0xf bank_mask:0xf
    v_add_f32_dpp v76, v98, v76 quad_perm:[2,2,2,2] row_mask:0xf bank_mask:0xf
    v_add_f32_dpp v77, v102, v77 quad_perm:[2,2,2,2] row_mask:0xf bank_mask:0xf
    v_add_f32_dpp v78, v106, v78 quad_perm:[2,2,2,2] row_mask:0xf bank_mask:0xf
    v_add_f32_dpp v79, v110, v79 quad_perm:[2,2,2,2] row_mask:0xf bank_mask:0xf
    v_add_f32_dpp v72, v83, v72 quad_perm:[3,3,3,3] row_mask:0xf bank_mask:0xf
    v_add_f32_dpp v73, v87, v73 quad_perm:[3,3,3,3] row_mask:0xf bank_mask:0xf
    v_add_f32_dpp v74, v91, v74 quad_perm:[3,3,3,3] row_mask:0xf bank_mask:0xf
    v_add_f32_dpp v75, v95, v75 quad_perm:[3,3,3,3] row_mask:0xf bank_mask:0xf
    v_add_f32_dpp v76, v99, v76 quad_perm:[3,3,3,3] row_mask:0xf bank_mask:0xf
    v_add_f32_dpp v77, v103, v77 quad_perm:[3,3,3,3] row_mask:0xf bank_mask:0xf
    v_add_f32_dpp v78, v107, v78 quad_perm:[3,3,3,3] row_mask:0xf bank_mask:0xf
    v_add_f32_dpp v79, v111, v79 quad_perm:[3,3,3,3] row_mask:0xf bank_mask:0xf
    s_waitcnt vmcnt(23)
    v_mfma_f32_16x16x32_bf16 v[80:83], v[160:163], v[8:11], 0
    s_waitcnt vmcnt(22)
    v_mfma_f32_16x16x32_bf16 v[84:87], v[164:167], v[8:11], 0
    s_waitcnt vmcnt(21)
    v_mfma_f32_16x16x32_bf16 v[88:91], v[168:171], v[8:11], 0
    s_waitcnt vmcnt(20)
    v_mfma_f32_16x16x32_bf16 v[92:95], v[172:175], v[8:11], 0
    s_waitcnt vmcnt(19)
    v_mfma_f32_16x16x32_bf16 v[96:99], v[176:179], v[8:11], 0
    s_waitcnt vmcnt(18)
    v_mfma_f32_16x16x32_bf16 v[100:103], v[180:183], v[8:11], 0
    s_waitcnt vmcnt(17)
    v_mfma_f32_16x16x32_bf16 v[104:107], v[184:187], v[8:11], 0
    s_waitcnt vmcnt(16)
    v_mfma_f32_16x16x32_bf16 v[108:111], v[188:191], v[8:11], 0
    v_add_f32_dpp v112, v80, v81 quad_perm:[0,0,0,0] row_mask:0xf bank_mask:0xf
    v_add_f32_dpp v113, v84, v85 quad_perm:[0,0,0,0] row_mask:0xf bank_mask:0xf
    v_add_f32_dpp v114, v88, v89 quad_perm:[0,0,0,0] row_mask:0xf bank_mask:0xf
    v_add_f32_dpp v115, v92, v93 quad_perm:[0,0,0,0] row_mask:0xf bank_mask:0xf
    v_add_f32_dpp v116, v96, v97 quad_perm:[0,0,0,0] row_mask:0xf bank_mask:0xf
    v_add_f32_dpp v117, v100, v101 quad_perm:[0,0,0,0] row_mask:0xf bank_mask:0xf
    v_add_f32_dpp v118, v104, v105 quad_perm:[0,0,0,0] row_mask:0xf bank_mask:0xf
    s_nop 0
    v_add_f32_dpp v119, v108, v109 quad_perm:[0,0,0,0] row_mask:0xf bank_mask:0xf
    v_add_f32_dpp v112, v82, v112 quad_perm:[2,2,2,2] row_mask:0xf bank_mask:0xf
    v_add_f32_dpp v113, v86, v113 quad_perm:[2,2,2,2] row_mask:0xf bank_mask:0xf
    v_add_f32_dpp v114, v90, v114 quad_perm:[2,2,2,2] row_mask:0xf bank_mask:0xf
    v_add_f32_dpp v115, v94, v115 quad_perm:[2,2,2,2] row_mask:0xf bank_mask:0xf
    v_add_f32_dpp v116, v98, v116 quad_perm:[2,2,2,2] row_mask:0xf bank_mask:0xf
    v_add_f32_dpp v117, v102, v117 quad_perm:[2,2,2,2] row_mask:0xf bank_mask:0xf
    v_add_f32_dpp v118, v106, v118 quad_perm:[2,2,2,2] row_mask:0xf bank_mask:0xf
    v_add_f32_dpp v119, v110, v119 quad_perm:[2,2,2,2] row_mask:0xf bank_mask:0xf
    v_add_f32_dpp v112, v83, v112 quad_perm:[3,3,3,3] row_mask:0xf bank_mask:0xf
    v_add_f32_dpp v113, v87, v113 quad_perm:[3,3,3,3] row_mask:0xf bank_mask:0xf
    v_add_f32_dpp v114, v91, v114 quad_perm:[3,3,3,3] row_mask:0xf bank_mask:0xf
    v_add_f32_dpp v115, v95, v115 quad_perm:[3,3,3,3] row_mask:0xf bank_mask:0xf
    v_add_f32_dpp v116, v99, v116 quad_perm:[3,3,3,3] row_mask:0xf bank_mask:0xf
    v_add_f32_dpp v117, v103, v117 quad_perm:[3,3,3,3] row_mask:0xf bank_mask:0xf
    v_add_f32_dpp v118, v107, v118 quad_perm:[3,3,3,3] row_mask:0xf bank_mask:0xf
    v_add_f32_dpp v119, v111, v119 quad_perm:[3,3,3,3] row_mask:0xf bank_mask:0xf
    v_cndmask_b32 v72, v72, v112, s[64:65]
    v_cndmask_b32 v73, v73, v113, s[64:65]
    v_cndmask_b32 v74, v74, v114, s[64:65]
    v_cndmask_b32 v75, v75, v115, s[64:65]
    v_cndmask_b32 v76, v76, v116, s[64:65]
    v_cndmask_b32 v77, v77, v117, s[64:65]
    v_cndmask_b32 v78, v78, v118, s[64:65]
    v_cndmask_b32 v79, v79, v119, s[64:65]
    s_waitcnt vmcnt(15)
    v_mfma_f32_16x16x32_bf16 v[80:83], v[192:195], v[8:11], 0
    s_waitcnt vmcnt(14)
    v_mfma_f32_16x16x32_bf16 v[84:87], v[196:199], v[8:11], 0
    s_waitcnt vmcnt(13)
    v_mfma_f32_16x16x32_bf16 v[88:91], v[200:203], v[8:11], 0
    s_waitcnt vmcnt(12)
    v_mfma_f32_16x16x32_bf16 v[92:95], v[204:207], v[8:11], 0
    s_waitcnt vmcnt(11)
    v_mfma_f32_16x16x32_bf16 v[96:99], v[208:211], v[8:11], 0
    s_waitcnt vmcnt(10)
    v_mfma_f32_16x16x32_bf16 v[100:103], v[212:215], v[8:11], 0
    s_waitcnt vmcnt(9)
    v_mfma_f32_16x16x32_bf16 v[104:107], v[216:219], v[8:11], 0
    s_waitcnt vmcnt(8)
    v_mfma_f32_16x16x32_bf16 v[108:111], v[220:223], v[8:11], 0
    v_add_f32_dpp v112, v80, v82 quad_perm:[0,0,0,0] row_mask:0xf bank_mask:0xf
    v_add_f32_dpp v113, v84, v86 quad_perm:[0,0,0,0] row_mask:0xf bank_mask:0xf
    v_add_f32_dpp v114, v88, v90 quad_perm:[0,0,0,0] row_mask:0xf bank_mask:0xf
    v_add_f32_dpp v115, v92, v94 quad_perm:[0,0,0,0] row_mask:0xf bank_mask:0xf
    v_add_f32_dpp v116, v96, v98 quad_perm:[0,0,0,0] row_mask:0xf bank_mask:0xf
    v_add_f32_dpp v117, v100, v102 quad_perm:[0,0,0,0] row_mask:0xf bank_mask:0xf
    v_add_f32_dpp v118, v104, v106 quad_perm:[0,0,0,0] row_mask:0xf bank_mask:0xf
    s_nop 0
    v_add_f32_dpp v119, v108, v110 quad_perm:[0,0,0,0] row_mask:0xf bank_mask:0xf
    v_add_f32_dpp v112, v81, v112 quad_perm:[1,1,1,1] row_mask:0xf bank_mask:0xf
    v_add_f32_dpp v113, v85, v113 quad_perm:[1,1,1,1] row_mask:0xf bank_mask:0xf
    v_add_f32_dpp v114, v89, v114 quad_perm:[1,1,1,1] row_mask:0xf bank_mask:0xf
    v_add_f32_dpp v115, v93, v115 quad_perm:[1,1,1,1] row_mask:0xf bank_mask:0xf
    v_add_f32_dpp v116, v97, v116 quad_perm:[1,1,1,1] row_mask:0xf bank_mask:0xf
    v_add_f32_dpp v117, v101, v117 quad_perm:[1,1,1,1] row_mask:0xf bank_mask:0xf
    v_add_f32_dpp v118, v105, v118 quad_perm:[1,1,1,1] row_mask:0xf bank_mask:0xf
    v_add_f32_dpp v119, v109, v119 quad_perm:[1,1,1,1] row_mask:0xf bank_mask:0xf
    v_add_f32_dpp v112, v83, v112 quad_perm:[3,3,3,3] row_mask:0xf bank_mask:0xf
    v_add_f32_dpp v113, v87, v113 quad_perm:[3,3,3,3] row_mask:0xf bank_mask:0xf
    v_add_f32_dpp v114, v91, v114 quad_perm:[3,3,3,3] row_mask:0xf bank_mask:0xf
    v_add_f32_dpp v115, v95, v115 quad_perm:[3,3,3,3] row_mask:0xf bank_mask:0xf
    v_add_f32_dpp v116, v99, v116 quad_perm:[3,3,3,3] row_mask:0xf bank_mask:0xf
    v_add_f32_dpp v117, v103, v117 quad_perm:[3,3,3,3] row_mask:0xf bank_mask:0xf
    v_add_f32_dpp v118, v107, v118 quad_perm:[3,3,3,3] row_mask:0xf bank_mask:0xf
    v_add_f32_dpp v119, v111, v119 quad_perm:[3,3,3,3] row_mask:0xf bank_mask:0xf
    v_cndmask_b32 v72, v72, v112, s[66:67]
    v_cndmask_b32 v73, v73, v113, s[66:67]
    v_cndmask_b32 v74, v74, v114, s[66:67]
    v_cndmask_b32 v75, v75, v115, s[66:67]
    v_cndmask_b32 v76, v76, v116, s[66:67]
    v_cndmask_b32 v77, v77, v117, s[66:67]
    v_cndmask_b32 v78, v78, v118, s[66:67]
    v_cndmask_b32 v79, v79, v119, s[66:67]
    s_waitcnt vmcnt(7)
    v_mfma_f32_16x16x32_bf16 v[80:83], v[224:227], v[8:11], 0
    s_waitcnt vmcnt(6)
    v_mfma_f32_16x16x32_bf16 v[84:87], v[228:231], v[8:11], 0
    s_waitcnt vmcnt(5)
    v_mfma_f32_16x16x32_bf16 v[88:91], v[232:235], v[8:11], 0
    s_waitcnt vmcnt(4)
    v_mfma_f32_16x16x32_bf16 v[92:95], v[236:239], v[8:11], 0
    s_waitcnt vmcnt(3)
    v_mfma_f32_16x16x32_bf16 v[96:99], v[240:243], v[8:11], 0
    s_waitcnt vmcnt(2)
    v_mfma_f32_16x16x32_bf16 v[100:103], v[244:247], v[8:11], 0
    s_waitcnt vmcnt(1)
    v_mfma_f32_16x16x32_bf16 v[104:107], v[248:251], v[8:11], 0
    s_waitcnt vmcnt(0)
    v_mfma_f32_16x16x32_bf16 v[108:111], v[252:255], v[8:11], 0
    v_add_f32_dpp v112, v80, v83 quad_perm:[0,0,0,0] row_mask:0xf bank_mask:0xf
    v_add_f32_dpp v113, v84, v87 quad_perm:[0,0,0,0] row_mask:0xf bank_mask:0xf
    v_add_f32_dpp v114, v88, v91 quad_perm:[0,0,0,0] row_mask:0xf bank_mask:0xf
    v_add_f32_dpp v115, v92, v95 quad_perm:[0,0,0,0] row_mask:0xf bank_mask:0xf
    v_add_f32_dpp v116, v96, v99 quad_perm:[0,0,0,0] row_mask:0xf bank_mask:0xf
    v_add_f32_dpp v117, v100, v103 quad_perm:[0,0,0,0] row_mask:0xf bank_mask:0xf
    v_add_f32_dpp v118, v104, v107 quad_perm:[0,0,0,0] row_mask:0xf bank_mask:0xf
    s_nop 0
    v_add_f32_dpp v119, v108, v111 quad_perm:[0,0,0,0] row_mask:0xf bank_mask:0xf
    v_add_f32_dpp v112, v81, v112 quad_perm:[1,1,1,1] row_mask:0xf bank_mask:0xf
    v_add_f32_dpp v113, v85, v113 quad_perm:[1,1,1,1] row_mask:0xf bank_mask:0xf
    v_add_f32_dpp v114, v89, v114 quad_perm:[1,1,1,1] row_mask:0xf bank_mask:0xf
    v_add_f32_dpp v115, v93, v115 quad_perm:[1,1,1,1] row_mask:0xf bank_mask:0xf
    v_add_f32_dpp v116, v97, v116 quad_perm:[1,1,1,1] row_mask:0xf bank_mask:0xf
    v_add_f32_dpp v117, v101, v117 quad_perm:[1,1,1,1] row_mask:0xf bank_mask:0xf
    v_add_f32_dpp v118, v105, v118 quad_perm:[1,1,1,1] row_mask:0xf bank_mask:0xf
    v_add_f32_dpp v119, v109, v119 quad_perm:[1,1,1,1] row_mask:0xf bank_mask:0xf
    v_add_f32_dpp v112, v82, v112 quad_perm:[2,2,2,2] row_mask:0xf bank_mask:0xf
    v_add_f32_dpp v113, v86, v113 quad_perm:[2,2,2,2] row_mask:0xf bank_mask:0xf
    v_add_f32_dpp v114, v90, v114 quad_perm:[2,2,2,2] row_mask:0xf bank_mask:0xf
    v_add_f32_dpp v115, v94, v115 quad_perm:[2,2,2,2] row_mask:0xf bank_mask:0xf
    v_add_f32_dpp v116, v98, v116 quad_perm:[2,2,2,2] row_mask:0xf bank_mask:0xf
    v_add_f32_dpp v117, v102, v117 quad_perm:[2,2,2,2] row_mask:0xf bank_mask:0xf
    v_add_f32_dpp v118, v106, v118 quad_perm:[2,2,2,2] row_mask:0xf bank_mask:0xf
    v_add_f32_dpp v119, v110, v119 quad_perm:[2,2,2,2] row_mask:0xf bank_mask:0xf
    v_cndmask_b32 v72, v72, v112, s[68:69]
    v_cndmask_b32 v73, v73, v113, s[68:69]
    v_cndmask_b32 v74, v74, v114, s[68:69]
    v_cndmask_b32 v75, v75, v115, s[68:69]
    v_cndmask_b32 v76, v76, v116, s[68:69]
    v_cndmask_b32 v77, v77, v117, s[68:69]
    v_cndmask_b32 v78, v78, v118, s[68:69]
    v_cndmask_b32 v79, v79, v119, s[68:69]
    s_mov_b32 s71, 0x3e0293ee
    v_mul_f32 v72, s71, v72
    v_mul_f32 v73, s71, v73
    v_mul_f32 v74, s71, v74
    v_mul_f32 v75, s71, v75
    v_mul_f32 v76, s71, v76
    v_mul_f32 v77, s71, v77
    v_mul_f32 v78, s71, v78
    v_mul_f32 v79, s71, v79
    v_cvt_pk_bf16_f32 v4, v72, v73
    v_cvt_pk_bf16_f32 v5, v74, v75
    v_cvt_pk_bf16_f32 v6, v76, v77
    v_cvt_pk_bf16_f32 v7, v78, v79
    s_lshl_b32 s24, s26, 12
    s_lshl_b32 s25, s3, 8
    s_add_u32 s24, s24, s25
    s_add_u32 s24, s24, 0x0
    buffer_store_dwordx4 v[4:7], v66, s[12:15], s24 offen sc1
    s_and_b32 s24, s3, 1
    s_lshl_b32 s24, s24, 1
    s_and_b32 s25, s3, 2
    s_lshl_b32 s25, s25, 3
    s_or_b32 s25, s25, s24
    s_and_b32 s24, s26, 13
    s_or_b32 s25, s25, s24
    s_lshl_b32 s25, s25, 17
    s_lshr_b32 s24, s74, 3
    s_lshl_b32 s24, s24, 7
    s_add_u32 s25, s24, s25
    v_lshrrev_b32 v3, 4, v0
    v_lshlrev_b32 v3, 15, v3
    v_and_b32 v4, 8, v0
    v_lshl_add_u32 v3, v4, 10, v3
    v_and_b32 v4, 0x70, v2
    v_add_u32 v3, v3, v4
    s_mov_b32 s8, s56
    s_mov_b32 s9, s57
    s_mov_b32 s10, 0x400000
    s_mov_b32 s11, 0x20000
    s_mul_i32 s24, s3, 16896
    s_add_u32 m0, s24, 0
    s_mov_b32 s24, s25
    buffer_load_dwordx4 v3, s[8:11], s24 offen nt lds
    s_add_u32 m0, m0, 1056
    s_add_u32 s24, s24, 2048
    buffer_load_dwordx4 v3, s[8:11], s24 offen nt lds
    s_add_u32 m0, m0, 1056
    s_add_u32 s24, s24, 2048
    buffer_load_dwordx4 v3, s[8:11], s24 offen nt lds
    s_add_u32 m0, m0, 1056
    s_add_u32 s24, s24, 2048
    buffer_load_dwordx4 v3, s[8:11], s24 offen nt lds
    s_add_u32 m0, m0, 1056
    s_add_u32 s24, s24, 10240
    buffer_load_dwordx4 v3, s[8:11], s24 offen nt lds
    s_add_u32 m0, m0, 1056
    s_add_u32 s24, s24, 2048
    buffer_load_dwordx4 v3, s[8:11], s24 offen nt lds
    s_add_u32 m0, m0, 1056
    s_add_u32 s24, s24, 2048
    buffer_load_dwordx4 v3, s[8:11], s24 offen nt lds
    s_add_u32 m0, m0, 1056
    s_add_u32 s24, s24, 2048
    buffer_load_dwordx4 v3, s[8:11], s24 offen nt lds
    s_add_u32 m0, m0, 1056
    s_add_u32 s24, s24, -21504
    buffer_load_dwordx4 v3, s[8:11], s24 offen nt lds
    s_add_u32 m0, m0, 1056
    s_add_u32 s24, s24, 2048
    buffer_load_dwordx4 v3, s[8:11], s24 offen nt lds
    s_add_u32 m0, m0, 1056
    s_add_u32 s24, s24, 2048
    buffer_load_dwordx4 v3, s[8:11], s24 offen nt lds
    s_add_u32 m0, m0, 1056
    s_add_u32 s24, s24, 2048
    buffer_load_dwordx4 v3, s[8:11], s24 offen nt lds
    s_add_u32 m0, m0, 1056
    s_add_u32 s24, s24, 10240
    buffer_load_dwordx4 v3, s[8:11], s24 offen nt lds
    s_add_u32 m0, m0, 1056
    s_add_u32 s24, s24, 2048
    buffer_load_dwordx4 v3, s[8:11], s24 offen nt lds
    s_add_u32 m0, m0, 1056
    s_add_u32 s24, s24, 2048
    buffer_load_dwordx4 v3, s[8:11], s24 offen nt lds
    s_add_u32 m0, m0, 1056
    s_add_u32 s24, s24, 2048
    buffer_load_dwordx4 v3, s[8:11], s24 offen nt lds
    s_mov_b32 s8, s46
    s_mov_b32 s9, s47
    s_mov_b32 s10, 0x400000
    s_mov_b32 s11, 0x20000
    s_mul_i32 s24, s3, 16896
    s_add_u32 m0, s24, 67584
    s_mov_b32 s24, s25
    buffer_load_dwordx4 v3, s[8:11], s24 offen nt lds
    s_add_u32 m0, m0, 1056
    s_add_u32 s24, s24, 2048
    buffer_load_dwordx4 v3, s[8:11], s24 offen nt lds
    s_add_u32 m0, m0, 1056
    s_add_u32 s24, s24, 2048
    buffer_load_dwordx4 v3, s[8:11], s24 offen nt lds
    s_add_u32 m0, m0, 1056
    s_add_u32 s24, s24, 2048
    buffer_load_dwordx4 v3, s[8:11], s24 offen nt lds
    s_add_u32 m0, m0, 1056
    s_add_u32 s24, s24, 10240
    buffer_load_dwordx4 v3, s[8:11], s24 offen nt lds
    s_add_u32 m0, m0, 1056
    s_add_u32 s24, s24, 2048
    buffer_load_dwordx4 v3, s[8:11], s24 offen nt lds
    s_add_u32 m0, m0, 1056
    s_add_u32 s24, s24, 2048
    buffer_load_dwordx4 v3, s[8:11], s24 offen nt lds
    s_add_u32 m0, m0, 1056
    s_add_u32 s24, s24, 2048
    buffer_load_dwordx4 v3, s[8:11], s24 offen nt lds
    s_add_u32 m0, m0, 1056
    s_add_u32 s24, s24, -21504
    buffer_load_dwordx4 v3, s[8:11], s24 offen nt lds
    s_add_u32 m0, m0, 1056
    s_add_u32 s24, s24, 2048
    buffer_load_dwordx4 v3, s[8:11], s24 offen nt lds
    s_add_u32 m0, m0, 1056
    s_add_u32 s24, s24, 2048
    buffer_load_dwordx4 v3, s[8:11], s24 offen nt lds
    s_add_u32 m0, m0, 1056
    s_add_u32 s24, s24, 2048
    buffer_load_dwordx4 v3, s[8:11], s24 offen nt lds
    s_add_u32 m0, m0, 1056
    s_add_u32 s24, s24, 10240
    buffer_load_dwordx4 v3, s[8:11], s24 offen nt lds
    s_add_u32 m0, m0, 1056
    s_add_u32 s24, s24, 2048
    buffer_load_dwordx4 v3, s[8:11], s24 offen nt lds
    s_add_u32 m0, m0, 1056
    s_add_u32 s24, s24, 2048
    buffer_load_dwordx4 v3, s[8:11], s24 offen nt lds
    s_add_u32 m0, m0, 1056
    s_add_u32 s24, s24, 2048
    buffer_load_dwordx4 v3, s[8:11], s24 offen nt lds
    s_waitcnt vmcnt(0)
    s_barrier
    s_cmp_lg_u32 s3, 0
    s_cbranch_scc1 L_sig11
    s_mov_b64 exec, 1
    v_mov_b32 v3, 1
    buffer_atomic_add v3, off, s[16:19], 0 offset:0 sc0
    s_waitcnt vmcnt(0)
    v_readfirstlane_b32 s24, v3
    s_mov_b64 exec, -1
    s_and_b32 s24, s24, 63
    s_cmp_lg_u32 s24, 63
    s_cbranch_scc1 L_sig11
    v_lshlrev_b32 v4, 7, v0
    v_mov_b32 v3, 1
    s_mov_b32 s24, 0x170000
    buffer_store_dword v3, v4, s[12:15], s24 offen offset:0 sc1
L_sig11:
    s_mov_b32 s4, s44
    s_mov_b32 s5, s45
    s_mov_b32 s6, 0x400000
    s_mov_b32 s7, 0x20000
    s_mov_b32 s32, s35
    buffer_load_dwordx4 v[128:131], v18, s[4:7], s32 offen nt
    s_add_u32 s32, s32, 8192
    buffer_load_dwordx4 v[132:135], v18, s[4:7], s32 offen nt
    s_add_u32 s32, s32, 8192
    buffer_load_dwordx4 v[136:139], v18, s[4:7], s32 offen nt
    s_add_u32 s32, s32, 8192
    buffer_load_dwordx4 v[140:143], v18, s[4:7], s32 offen nt
    s_add_u32 s32, s32, 8192
    buffer_load_dwordx4 v[144:147], v18, s[4:7], s32 offen nt
    s_add_u32 s32, s32, 8192
    buffer_load_dwordx4 v[148:151], v18, s[4:7], s32 offen nt
    s_add_u32 s32, s32, 8192
    buffer_load_dwordx4 v[152:155], v18, s[4:7], s32 offen nt
    s_add_u32 s32, s32, 8192
    buffer_load_dwordx4 v[156:159], v18, s[4:7], s32 offen nt
    s_add_u32 s32, s32, 8192
    buffer_load_dwordx4 v[160:163], v18, s[4:7], s32 offen nt
    s_add_u32 s32, s32, 8192
    buffer_load_dwordx4 v[164:167], v18, s[4:7], s32 offen nt
    s_add_u32 s32, s32, 8192
    buffer_load_dwordx4 v[168:171], v18, s[4:7], s32 offen nt
    s_add_u32 s32, s32, 8192
    buffer_load_dwordx4 v[172:175], v18, s[4:7], s32 offen nt
    s_add_u32 s32, s32, 8192
    buffer_load_dwordx4 v[176:179], v18, s[4:7], s32 offen nt
    s_add_u32 s32, s32, 8192
    buffer_load_dwordx4 v[180:183], v18, s[4:7], s32 offen nt
    s_add_u32 s32, s32, 8192
    buffer_load_dwordx4 v[184:187], v18, s[4:7], s32 offen nt
    s_add_u32 s32, s32, 8192
    buffer_load_dwordx4 v[188:191], v18, s[4:7], s32 offen nt
    s_add_u32 s32, s32, 8192
    buffer_load_dwordx4 v[192:195], v18, s[4:7], s32 offen nt
    s_add_u32 s32, s32, 8192
    buffer_load_dwordx4 v[196:199], v18, s[4:7], s32 offen nt
    s_add_u32 s32, s32, 8192
    buffer_load_dwordx4 v[200:203], v18, s[4:7], s32 offen nt
    s_add_u32 s32, s32, 8192
    buffer_load_dwordx4 v[204:207], v18, s[4:7], s32 offen nt
    s_add_u32 s32, s32, 8192
    buffer_load_dwordx4 v[208:211], v18, s[4:7], s32 offen nt
    s_add_u32 s32, s32, 8192
    buffer_load_dwordx4 v[212:215], v18, s[4:7], s32 offen nt
    s_add_u32 s32, s32, 8192
    buffer_load_dwordx4 v[216:219], v18, s[4:7], s32 offen nt
    s_add_u32 s32, s32, 8192
    buffer_load_dwordx4 v[220:223], v18, s[4:7], s32 offen nt
    s_add_u32 s32, s32, 8192
    buffer_load_dwordx4 v[224:227], v18, s[4:7], s32 offen nt
    s_add_u32 s32, s32, 8192
    buffer_load_dwordx4 v[228:231], v18, s[4:7], s32 offen nt
    s_add_u32 s32, s32, 8192
    buffer_load_dwordx4 v[232:235], v18, s[4:7], s32 offen nt
    s_add_u32 s32, s32, 8192
    buffer_load_dwordx4 v[236:239], v18, s[4:7], s32 offen nt
    s_add_u32 s32, s32, 8192
    buffer_load_dwordx4 v[240:243], v18, s[4:7], s32 offen nt
    s_add_u32 s32, s32, 8192
    buffer_load_dwordx4 v[244:247], v18, s[4:7], s32 offen nt
    s_add_u32 s32, s32, 8192
    buffer_load_dwordx4 v[248:251], v18, s[4:7], s32 offen nt
    s_add_u32 s32, s32, 8192
    buffer_load_dwordx4 v[252:255], v18, s[4:7], s32 offen nt
    s_add_u32 s32, s32, 8192
    v_lshrrev_b32 v3, 2, v0
    v_mul_u32_u24 v3, 1056, v3
    v_and_b32 v4, 3, v0
    v_lshl_add_u32 v3, v4, 3, v3
    s_lshl_b32 s24, s3, 5
    v_add_u32 v3, s24, v3
    v_add_u32 v4, 67584, v3
    ds_read_b64_tr_b16 a[64:65], v3 offset:0
    ds_read_b64_tr_b16 a[66:67], v3 offset:128
    ds_read_b64_tr_b16 a[68:69], v3 offset:256
    ds_read_b64_tr_b16 a[70:71], v3 offset:384
    ds_read_b64_tr_b16 a[72:73], v3 offset:512
    ds_read_b64_tr_b16 a[74:75], v3 offset:640
    ds_read_b64_tr_b16 a[76:77], v3 offset:768
    ds_read_b64_tr_b16 a[78:79], v3 offset:896
    ds_read_b64_tr_b16 a[80:81], v3 offset:16896
    ds_read_b64_tr_b16 a[82:83], v3 offset:17024
    ds_read_b64_tr_b16 a[84:85], v3 offset:17152
    ds_read_b64_tr_b16 a[86:87], v3 offset:17280
    ds_read_b64_tr_b16 a[88:89], v3 offset:17408
    ds_read_b64_tr_b16 a[90:91], v3 offset:17536
    ds_read_b64_tr_b16 a[92:93], v3 offset:17664
    ds_read_b64_tr_b16 a[94:95], v3 offset:17792
    ds_read_b64_tr_b16 a[96:97], v3 offset:33792
    ds_read_b64_tr_b16 a[98:99], v3 offset:33920
    ds_read_b64_tr_b16 a[100:101], v3 offset:34048
    ds_read_b64_tr_b16 a[102:103], v3 offset:34176
    ds_read_b64_tr_b16 a[104:105], v3 offset:34304
    ds_read_b64_tr_b16 a[106:107], v3 offset:34432
    ds_read_b64_tr_b16 a[108:109], v3 offset:34560
    ds_read_b64_tr_b16 a[110:111], v3 offset:34688
    ds_read_b64_tr_b16 a[112:113], v3 offset:50688
    ds_read_b64_tr_b16 a[114:115], v3 offset:50816
    ds_read_b64_tr_b16 a[116:117], v3 offset:50944
    ds_read_b64_tr_b16 a[118:119], v3 offset:51072
    ds_read_b64_tr_b16 a[120:121], v3 offset:51200
    ds_read_b64_tr_b16 a[122:123], v3 offset:51328
    ds_read_b64_tr_b16 a[124:125], v3 offset:51456
    ds_read_b64_tr_b16 a[126:127], v3 offset:51584
    ds_read_b64_tr_b16 a[128:129], v4 offset:0
    ds_read_b64_tr_b16 a[130:131], v4 offset:128
    ds_read_b64_tr_b16 a[132:133], v4 offset:256
    ds_read_b64_tr_b16 a[134:135], v4 offset:384
    ds_read_b64_tr_b16 a[136:137], v4 offset:512
    ds_read_b64_tr_b16 a[138:139], v4 offset:640
    ds_read_b64_tr_b16 a[140:141], v4 offset:768
    ds_read_b64_tr_b16 a[142:143], v4 offset:896
    ds_read_b64_tr_b16 a[144:145], v4 offset:16896
    ds_read_b64_tr_b16 a[146:147], v4 offset:17024
    ds_read_b64_tr_b16 a[148:149], v4 offset:17152
    ds_read_b64_tr_b16 a[150:151], v4 offset:17280
    ds_read_b64_tr_b16 a[152:153], v4 offset:17408
    ds_read_b64_tr_b16 a[154:155], v4 offset:17536
    ds_read_b64_tr_b16 a[156:157], v4 offset:17664
    ds_read_b64_tr_b16 a[158:159], v4 offset:17792
    ds_read_b64_tr_b16 a[160:161], v4 offset:33792
    ds_read_b64_tr_b16 a[162:163], v4 offset:33920
    ds_read_b64_tr_b16 a[164:165], v4 offset:34048
    ds_read_b64_tr_b16 a[166:167], v4 offset:34176
    ds_read_b64_tr_b16 a[168:169], v4 offset:34304
    ds_read_b64_tr_b16 a[170:171], v4 offset:34432
    ds_read_b64_tr_b16 a[172:173], v4 offset:34560
    ds_read_b64_tr_b16 a[174:175], v4 offset:34688
    ds_read_b64_tr_b16 a[176:177], v4 offset:50688
    ds_read_b64_tr_b16 a[178:179], v4 offset:50816
    ds_read_b64_tr_b16 a[180:181], v4 offset:50944
    ds_read_b64_tr_b16 a[182:183], v4 offset:51072
    ds_read_b64_tr_b16 a[184:185], v4 offset:51200
    ds_read_b64_tr_b16 a[186:187], v4 offset:51328
    ds_read_b64_tr_b16 a[188:189], v4 offset:51456
    ds_read_b64_tr_b16 a[190:191], v4 offset:51584
    s_waitcnt lgkmcnt(0)
    s_cmp_lg_u32 s3, 0
    s_cbranch_scc1 L_awx12
    s_mov_b32 s24, 262144
    s_mov_b64 exec, 1
L_aw13:
    buffer_load_dword v1, off, s[12:15], s73 offset:0 sc1
    s_waitcnt vmcnt(0)
    v_readfirstlane_b32 s25, v1
    s_nop 0
    s_cmp_eq_u32 s25, 1
    s_cbranch_scc1 L_awx12
    s_sleep 4
    s_sub_u32 s24, s24, 1
    s_cmp_lg_u32 s24, 0
    s_cbranch_scc1 L_aw13
L_awx12:
    s_mov_b64 exec, -1
    s_barrier
    s_cmp_lg_u32 s3, 0
    s_cbranch_scc1 L_xi14
    s_and_b32 s24, s74, 7
    s_lshl_b32 s24, s24, 5
    s_lshr_b32 s25, s74, 3
    s_add_u32 s24, s24, s25
    s_lshl_b32 s24, s24, 2
    s_add_u32 s24, s24, 0x1d0000
    s_getreg_b32 s25, hwreg(HW_REG_XCC_ID, 0, 4)
    s_mov_b64 exec, 1
    v_mov_b32 v3, s25
    buffer_store_dword v3, off, s[12:15], s24 sc1
    s_mov_b64 exec, -1
L_xi14:
    s_cmp_lg_u32 s3, 0
    s_cbranch_scc1 L_awx15
    s_mov_b32 s24, 262144
    s_mov_b64 exec, 1
L_aw16:
    buffer_load_dword v1, off, s[12:15], s73 offset:4 sc1
    s_waitcnt vmcnt(0)
    v_readfirstlane_b32 s25, v1
    s_nop 0
    s_cmp_eq_u32 s25, 1
    s_cbranch_scc1 L_awx15
    s_sleep 4
    s_sub_u32 s24, s24, 1
    s_cmp_lg_u32 s24, 0
    s_cbranch_scc1 L_aw16
L_awx15:
    s_mov_b64 exec, -1
    s_barrier
    s_and_b32 s24, s2, 7
    s_lshl_b32 s24, s24, 7
    s_add_u32 s24, s24, 0x1d0000
    v_and_b32 v3, 7, v0
    v_lshlrev_b32 v3, 2, v3
    buffer_load_dword v16, v3, s[12:15], s24 offen sc1
    s_lshl_b32 s24, s3, 10
    s_lshl_b32 s25, s26, 3
    s_add_u32 s25, s25, s24
    s_add_u32 s25, s25, 0x120000
    v_and_b32 v3, 3, v0
    v_lshlrev_b32 v3, 8, v3
    buffer_load_dwordx2 v[4:5], v3, s[12:15], s25 offen sc1
    s_lshl_b32 s24, s3, 18
    s_lshl_b32 s25, s26, 11
    s_add_u32 s24, s24, s25
    s_add_u32 s24, s24, 0x400000
    buffer_load_dwordx4 v[72:75], v2, s[12:15], s24 offen sc1 nt
    s_add_u32 s24, s24, 65536
    buffer_load_dwordx4 v[76:79], v2, s[12:15], s24 offen sc1 nt
    s_add_u32 s24, s24, 65536
    buffer_load_dwordx4 v[80:83], v2, s[12:15], s24 offen sc1 nt
    s_add_u32 s24, s24, 65536
    buffer_load_dwordx4 v[84:87], v2, s[12:15], s24 offen sc1 nt
    s_add_u32 s24, s24, 65536
    s_waitcnt vmcnt(4)
    v_mov_b32 v6, v4
    s_nop 1
    v_max_f32_dpp v6, v6, v6 row_ror:2 row_mask:0xf bank_mask:0xf
    s_nop 1
    v_max_f32_dpp v6, v6, v6 row_ror:1 row_mask:0xf bank_mask:0xf
    v_sub_f32 v4, v4, v6
    v_exp_f32 v4, v4
    s_nop 0
    v_mul_f32 v5, v4, v5
    s_nop 1
    v_add_f32_dpp v5, v5, v5 row_ror:2 row_mask:0xf bank_mask:0xf
    s_nop 1
    v_add_f32_dpp v5, v5, v5 row_ror:1 row_mask:0xf bank_mask:0xf
    v_rcp_f32 v5, v5
    s_nop 0
    v_mul_f32 v4, v4, v5
    s_nop 0
    v_readlane_b32 s24, v4, 0
    s_waitcnt vmcnt(3)
    v_lshlrev_b32 v5, 16, v72
    v_and_b32 v6, 0xffff0000, v72
    v_mul_f32 v104, s24, v5
    v_mul_f32 v105, s24, v6
    v_lshlrev_b32 v5, 16, v73
    v_and_b32 v6, 0xffff0000, v73
    v_mul_f32 v106, s24, v5
    v_mul_f32 v107, s24, v6
    v_lshlrev_b32 v5, 16, v74
    v_and_b32 v6, 0xffff0000, v74
    v_mul_f32 v108, s24, v5
    v_mul_f32 v109, s24, v6
    v_lshlrev_b32 v5, 16, v75
    v_and_b32 v6, 0xffff0000, v75
    v_mul_f32 v110, s24, v5
    v_mul_f32 v111, s24, v6
    v_readlane_b32 s24, v4, 1
    s_waitcnt vmcnt(2)
    v_lshlrev_b32 v5, 16, v76
    v_and_b32 v6, 0xffff0000, v76
    v_fmac_f32 v104, s24, v5
    v_fmac_f32 v105, s24, v6
    v_lshlrev_b32 v5, 16, v77
    v_and_b32 v6, 0xffff0000, v77
    v_fmac_f32 v106, s24, v5
    v_fmac_f32 v107, s24, v6
    v_lshlrev_b32 v5, 16, v78
    v_and_b32 v6, 0xffff0000, v78
    v_fmac_f32 v108, s24, v5
    v_fmac_f32 v109, s24, v6
    v_lshlrev_b32 v5, 16, v79
    v_and_b32 v6, 0xffff0000, v79
    v_fmac_f32 v110, s24, v5
    v_fmac_f32 v111, s24, v6
    v_readlane_b32 s24, v4, 2
    s_waitcnt vmcnt(1)
    v_lshlrev_b32 v5, 16, v80
    v_and_b32 v6, 0xffff0000, v80
    v_fmac_f32 v104, s24, v5
    v_fmac_f32 v105, s24, v6
    v_lshlrev_b32 v5, 16, v81
    v_and_b32 v6, 0xffff0000, v81
    v_fmac_f32 v106, s24, v5
    v_fmac_f32 v107, s24, v6
    v_lshlrev_b32 v5, 16, v82
    v_and_b32 v6, 0xffff0000, v82
    v_fmac_f32 v108, s24, v5
    v_fmac_f32 v109, s24, v6
    v_lshlrev_b32 v5, 16, v83
    v_and_b32 v6, 0xffff0000, v83
    v_fmac_f32 v110, s24, v5
    v_fmac_f32 v111, s24, v6
    v_readlane_b32 s24, v4, 3
    s_waitcnt vmcnt(0)
    v_lshlrev_b32 v5, 16, v84
    v_and_b32 v6, 0xffff0000, v84
    v_fmac_f32 v104, s24, v5
    v_fmac_f32 v105, s24, v6
    v_lshlrev_b32 v5, 16, v85
    v_and_b32 v6, 0xffff0000, v85
    v_fmac_f32 v106, s24, v5
    v_fmac_f32 v107, s24, v6
    v_lshlrev_b32 v5, 16, v86
    v_and_b32 v6, 0xffff0000, v86
    v_fmac_f32 v108, s24, v5
    v_fmac_f32 v109, s24, v6
    v_lshlrev_b32 v5, 16, v87
    v_and_b32 v6, 0xffff0000, v87
    v_fmac_f32 v110, s24, v5
    v_fmac_f32 v111, s24, v6
    v_cvt_pk_bf16_f32 v4, v104, v105
    v_cvt_pk_bf16_f32 v5, v106, v107
    v_cvt_pk_bf16_f32 v6, v108, v109
    v_cvt_pk_bf16_f32 v7, v110, v111
    s_lshl_b32 s24, s3, 10
    s_add_u32 s24, s24, 143360
    v_add_u32 v3, s24, v2
    ds_write_b128 v3, v[4:7]
    s_lshl_b32 s24, s3, 8
    s_add_u32 s24, s24, 143360
    v_add_u32 v3, s24, v19
    s_waitcnt lgkmcnt(0)
    s_barrier
    ds_read_b128 v[32:35], v3 offset:0
    ds_read_b128 v[36:39], v3 offset:16
    ds_read_b128 v[40:43], v3 offset:32
    ds_read_b128 v[44:47], v3 offset:48
    ds_read_b128 v[48:51], v3 offset:2048
    ds_read_b128 v[52:55], v3 offset:2064
    ds_read_b128 v[56:59], v3 offset:2080
    ds_read_b128 v[60:63], v3 offset:2096
    s_waitcnt lgkmcnt(0)
    v_perm_b32 v8, v32, v32, v24
    v_perm_b32 v9, v32, v32, v25
    v_perm_b32 v10, v32, v32, v26
    v_perm_b32 v11, v32, v32, v27
    v_perm_b32 v4, v48, v48, v24
    v_perm_b32 v5, v48, v48, v25
    v_perm_b32 v6, v48, v48, v26
    v_perm_b32 v7, v48, v48, v27
    v_mfma_f32_16x16x32_bf16 v[12:15], v[128:131], v[8:11], 0
    s_nop 0
    v_mfma_f32_16x16x32_bf16 v[68:71], v[128:131], v[4:7], 0
    v_perm_b32 v8, v32, v32, v28
    v_perm_b32 v9, v32, v32, v29
    v_perm_b32 v10, v32, v32, v30
    v_perm_b32 v11, v32, v32, v31
    v_perm_b32 v4, v48, v48, v28
    v_perm_b32 v5, v48, v48, v29
    v_perm_b32 v6, v48, v48, v30
    v_perm_b32 v7, v48, v48, v31
    v_mfma_f32_16x16x32_bf16 v[12:15], v[132:135], v[8:11], v[12:15]
    s_nop 0
    v_mfma_f32_16x16x32_bf16 v[68:71], v[132:135], v[4:7], v[68:71]
    v_perm_b32 v8, v33, v33, v24
    v_perm_b32 v9, v33, v33, v25
    v_perm_b32 v10, v33, v33, v26
    v_perm_b32 v11, v33, v33, v27
    v_perm_b32 v4, v49, v49, v24
    v_perm_b32 v5, v49, v49, v25
    v_perm_b32 v6, v49, v49, v26
    v_perm_b32 v7, v49, v49, v27
    v_mfma_f32_16x16x32_bf16 v[12:15], v[136:139], v[8:11], v[12:15]
    s_nop 0
    v_mfma_f32_16x16x32_bf16 v[68:71], v[136:139], v[4:7], v[68:71]
    v_perm_b32 v8, v33, v33, v28
    v_perm_b32 v9, v33, v33, v29
    v_perm_b32 v10, v33, v33, v30
    v_perm_b32 v11, v33, v33, v31
    v_perm_b32 v4, v49, v49, v28
    v_perm_b32 v5, v49, v49, v29
    v_perm_b32 v6, v49, v49, v30
    v_perm_b32 v7, v49, v49, v31
    v_mfma_f32_16x16x32_bf16 v[12:15], v[140:143], v[8:11], v[12:15]
    s_nop 0
    v_mfma_f32_16x16x32_bf16 v[68:71], v[140:143], v[4:7], v[68:71]
    v_perm_b32 v8, v34, v34, v24
    v_perm_b32 v9, v34, v34, v25
    v_perm_b32 v10, v34, v34, v26
    v_perm_b32 v11, v34, v34, v27
    v_perm_b32 v4, v50, v50, v24
    v_perm_b32 v5, v50, v50, v25
    v_perm_b32 v6, v50, v50, v26
    v_perm_b32 v7, v50, v50, v27
    v_mfma_f32_16x16x32_bf16 v[12:15], v[144:147], v[8:11], v[12:15]
    s_nop 0
    v_mfma_f32_16x16x32_bf16 v[68:71], v[144:147], v[4:7], v[68:71]
    v_perm_b32 v8, v34, v34, v28
    v_perm_b32 v9, v34, v34, v29
    v_perm_b32 v10, v34, v34, v30
    v_perm_b32 v11, v34, v34, v31
    v_perm_b32 v4, v50, v50, v28
    v_perm_b32 v5, v50, v50, v29
    v_perm_b32 v6, v50, v50, v30
    v_perm_b32 v7, v50, v50, v31
    v_mfma_f32_16x16x32_bf16 v[12:15], v[148:151], v[8:11], v[12:15]
    s_nop 0
    v_mfma_f32_16x16x32_bf16 v[68:71], v[148:151], v[4:7], v[68:71]
    v_perm_b32 v8, v35, v35, v24
    v_perm_b32 v9, v35, v35, v25
    v_perm_b32 v10, v35, v35, v26
    v_perm_b32 v11, v35, v35, v27
    v_perm_b32 v4, v51, v51, v24
    v_perm_b32 v5, v51, v51, v25
    v_perm_b32 v6, v51, v51, v26
    v_perm_b32 v7, v51, v51, v27
    v_mfma_f32_16x16x32_bf16 v[12:15], v[152:155], v[8:11], v[12:15]
    s_nop 0
    v_mfma_f32_16x16x32_bf16 v[68:71], v[152:155], v[4:7], v[68:71]
    v_perm_b32 v8, v35, v35, v28
    v_perm_b32 v9, v35, v35, v29
    v_perm_b32 v10, v35, v35, v30
    v_perm_b32 v11, v35, v35, v31
    v_perm_b32 v4, v51, v51, v28
    v_perm_b32 v5, v51, v51, v29
    v_perm_b32 v6, v51, v51, v30
    v_perm_b32 v7, v51, v51, v31
    v_mfma_f32_16x16x32_bf16 v[12:15], v[156:159], v[8:11], v[12:15]
    s_nop 0
    v_mfma_f32_16x16x32_bf16 v[68:71], v[156:159], v[4:7], v[68:71]
    v_perm_b32 v8, v36, v36, v24
    v_perm_b32 v9, v36, v36, v25
    v_perm_b32 v10, v36, v36, v26
    v_perm_b32 v11, v36, v36, v27
    v_perm_b32 v4, v52, v52, v24
    v_perm_b32 v5, v52, v52, v25
    v_perm_b32 v6, v52, v52, v26
    v_perm_b32 v7, v52, v52, v27
    v_mfma_f32_16x16x32_bf16 v[12:15], v[160:163], v[8:11], v[12:15]
    s_nop 0
    v_mfma_f32_16x16x32_bf16 v[68:71], v[160:163], v[4:7], v[68:71]
    v_perm_b32 v8, v36, v36, v28
    v_perm_b32 v9, v36, v36, v29
    v_perm_b32 v10, v36, v36, v30
    v_perm_b32 v11, v36, v36, v31
    v_perm_b32 v4, v52, v52, v28
    v_perm_b32 v5, v52, v52, v29
    v_perm_b32 v6, v52, v52, v30
    v_perm_b32 v7, v52, v52, v31
    v_mfma_f32_16x16x32_bf16 v[12:15], v[164:167], v[8:11], v[12:15]
    s_nop 0
    v_mfma_f32_16x16x32_bf16 v[68:71], v[164:167], v[4:7], v[68:71]
    v_perm_b32 v8, v37, v37, v24
    v_perm_b32 v9, v37, v37, v25
    v_perm_b32 v10, v37, v37, v26
    v_perm_b32 v11, v37, v37, v27
    v_perm_b32 v4, v53, v53, v24
    v_perm_b32 v5, v53, v53, v25
    v_perm_b32 v6, v53, v53, v26
    v_perm_b32 v7, v53, v53, v27
    v_mfma_f32_16x16x32_bf16 v[12:15], v[168:171], v[8:11], v[12:15]
    s_nop 0
    v_mfma_f32_16x16x32_bf16 v[68:71], v[168:171], v[4:7], v[68:71]
    v_perm_b32 v8, v37, v37, v28
    v_perm_b32 v9, v37, v37, v29
    v_perm_b32 v10, v37, v37, v30
    v_perm_b32 v11, v37, v37, v31
    v_perm_b32 v4, v53, v53, v28
    v_perm_b32 v5, v53, v53, v29
    v_perm_b32 v6, v53, v53, v30
    v_perm_b32 v7, v53, v53, v31
    v_mfma_f32_16x16x32_bf16 v[12:15], v[172:175], v[8:11], v[12:15]
    s_nop 0
    v_mfma_f32_16x16x32_bf16 v[68:71], v[172:175], v[4:7], v[68:71]
    v_perm_b32 v8, v38, v38, v24
    v_perm_b32 v9, v38, v38, v25
    v_perm_b32 v10, v38, v38, v26
    v_perm_b32 v11, v38, v38, v27
    v_perm_b32 v4, v54, v54, v24
    v_perm_b32 v5, v54, v54, v25
    v_perm_b32 v6, v54, v54, v26
    v_perm_b32 v7, v54, v54, v27
    v_mfma_f32_16x16x32_bf16 v[12:15], v[176:179], v[8:11], v[12:15]
    s_nop 0
    v_mfma_f32_16x16x32_bf16 v[68:71], v[176:179], v[4:7], v[68:71]
    v_perm_b32 v8, v38, v38, v28
    v_perm_b32 v9, v38, v38, v29
    v_perm_b32 v10, v38, v38, v30
    v_perm_b32 v11, v38, v38, v31
    v_perm_b32 v4, v54, v54, v28
    v_perm_b32 v5, v54, v54, v29
    v_perm_b32 v6, v54, v54, v30
    v_perm_b32 v7, v54, v54, v31
    v_mfma_f32_16x16x32_bf16 v[12:15], v[180:183], v[8:11], v[12:15]
    s_nop 0
    v_mfma_f32_16x16x32_bf16 v[68:71], v[180:183], v[4:7], v[68:71]
    v_perm_b32 v8, v39, v39, v24
    v_perm_b32 v9, v39, v39, v25
    v_perm_b32 v10, v39, v39, v26
    v_perm_b32 v11, v39, v39, v27
    v_perm_b32 v4, v55, v55, v24
    v_perm_b32 v5, v55, v55, v25
    v_perm_b32 v6, v55, v55, v26
    v_perm_b32 v7, v55, v55, v27
    v_mfma_f32_16x16x32_bf16 v[12:15], v[184:187], v[8:11], v[12:15]
    s_nop 0
    v_mfma_f32_16x16x32_bf16 v[68:71], v[184:187], v[4:7], v[68:71]
    v_perm_b32 v8, v39, v39, v28
    v_perm_b32 v9, v39, v39, v29
    v_perm_b32 v10, v39, v39, v30
    v_perm_b32 v11, v39, v39, v31
    v_perm_b32 v4, v55, v55, v28
    v_perm_b32 v5, v55, v55, v29
    v_perm_b32 v6, v55, v55, v30
    v_perm_b32 v7, v55, v55, v31
    v_mfma_f32_16x16x32_bf16 v[12:15], v[188:191], v[8:11], v[12:15]
    s_nop 0
    v_mfma_f32_16x16x32_bf16 v[68:71], v[188:191], v[4:7], v[68:71]
    v_perm_b32 v8, v40, v40, v24
    v_perm_b32 v9, v40, v40, v25
    v_perm_b32 v10, v40, v40, v26
    v_perm_b32 v11, v40, v40, v27
    v_perm_b32 v4, v56, v56, v24
    v_perm_b32 v5, v56, v56, v25
    v_perm_b32 v6, v56, v56, v26
    v_perm_b32 v7, v56, v56, v27
    v_mfma_f32_16x16x32_bf16 v[12:15], v[192:195], v[8:11], v[12:15]
    s_nop 0
    v_mfma_f32_16x16x32_bf16 v[68:71], v[192:195], v[4:7], v[68:71]
    v_perm_b32 v8, v40, v40, v28
    v_perm_b32 v9, v40, v40, v29
    v_perm_b32 v10, v40, v40, v30
    v_perm_b32 v11, v40, v40, v31
    v_perm_b32 v4, v56, v56, v28
    v_perm_b32 v5, v56, v56, v29
    v_perm_b32 v6, v56, v56, v30
    v_perm_b32 v7, v56, v56, v31
    v_mfma_f32_16x16x32_bf16 v[12:15], v[196:199], v[8:11], v[12:15]
    s_nop 0
    v_mfma_f32_16x16x32_bf16 v[68:71], v[196:199], v[4:7], v[68:71]
    v_perm_b32 v8, v41, v41, v24
    v_perm_b32 v9, v41, v41, v25
    v_perm_b32 v10, v41, v41, v26
    v_perm_b32 v11, v41, v41, v27
    v_perm_b32 v4, v57, v57, v24
    v_perm_b32 v5, v57, v57, v25
    v_perm_b32 v6, v57, v57, v26
    v_perm_b32 v7, v57, v57, v27
    v_mfma_f32_16x16x32_bf16 v[12:15], v[200:203], v[8:11], v[12:15]
    s_nop 0
    v_mfma_f32_16x16x32_bf16 v[68:71], v[200:203], v[4:7], v[68:71]
    v_perm_b32 v8, v41, v41, v28
    v_perm_b32 v9, v41, v41, v29
    v_perm_b32 v10, v41, v41, v30
    v_perm_b32 v11, v41, v41, v31
    v_perm_b32 v4, v57, v57, v28
    v_perm_b32 v5, v57, v57, v29
    v_perm_b32 v6, v57, v57, v30
    v_perm_b32 v7, v57, v57, v31
    v_mfma_f32_16x16x32_bf16 v[12:15], v[204:207], v[8:11], v[12:15]
    s_nop 0
    v_mfma_f32_16x16x32_bf16 v[68:71], v[204:207], v[4:7], v[68:71]
    v_perm_b32 v8, v42, v42, v24
    v_perm_b32 v9, v42, v42, v25
    v_perm_b32 v10, v42, v42, v26
    v_perm_b32 v11, v42, v42, v27
    v_perm_b32 v4, v58, v58, v24
    v_perm_b32 v5, v58, v58, v25
    v_perm_b32 v6, v58, v58, v26
    v_perm_b32 v7, v58, v58, v27
    v_mfma_f32_16x16x32_bf16 v[12:15], v[208:211], v[8:11], v[12:15]
    s_nop 0
    v_mfma_f32_16x16x32_bf16 v[68:71], v[208:211], v[4:7], v[68:71]
    v_perm_b32 v8, v42, v42, v28
    v_perm_b32 v9, v42, v42, v29
    v_perm_b32 v10, v42, v42, v30
    v_perm_b32 v11, v42, v42, v31
    v_perm_b32 v4, v58, v58, v28
    v_perm_b32 v5, v58, v58, v29
    v_perm_b32 v6, v58, v58, v30
    v_perm_b32 v7, v58, v58, v31
    v_mfma_f32_16x16x32_bf16 v[12:15], v[212:215], v[8:11], v[12:15]
    s_nop 0
    v_mfma_f32_16x16x32_bf16 v[68:71], v[212:215], v[4:7], v[68:71]
    v_perm_b32 v8, v43, v43, v24
    v_perm_b32 v9, v43, v43, v25
    v_perm_b32 v10, v43, v43, v26
    v_perm_b32 v11, v43, v43, v27
    v_perm_b32 v4, v59, v59, v24
    v_perm_b32 v5, v59, v59, v25
    v_perm_b32 v6, v59, v59, v26
    v_perm_b32 v7, v59, v59, v27
    v_mfma_f32_16x16x32_bf16 v[12:15], v[216:219], v[8:11], v[12:15]
    s_nop 0
    v_mfma_f32_16x16x32_bf16 v[68:71], v[216:219], v[4:7], v[68:71]
    v_perm_b32 v8, v43, v43, v28
    v_perm_b32 v9, v43, v43, v29
    v_perm_b32 v10, v43, v43, v30
    v_perm_b32 v11, v43, v43, v31
    v_perm_b32 v4, v59, v59, v28
    v_perm_b32 v5, v59, v59, v29
    v_perm_b32 v6, v59, v59, v30
    v_perm_b32 v7, v59, v59, v31
    v_mfma_f32_16x16x32_bf16 v[12:15], v[220:223], v[8:11], v[12:15]
    s_nop 0
    v_mfma_f32_16x16x32_bf16 v[68:71], v[220:223], v[4:7], v[68:71]
    v_perm_b32 v8, v44, v44, v24
    v_perm_b32 v9, v44, v44, v25
    v_perm_b32 v10, v44, v44, v26
    v_perm_b32 v11, v44, v44, v27
    v_perm_b32 v4, v60, v60, v24
    v_perm_b32 v5, v60, v60, v25
    v_perm_b32 v6, v60, v60, v26
    v_perm_b32 v7, v60, v60, v27
    v_mfma_f32_16x16x32_bf16 v[12:15], v[224:227], v[8:11], v[12:15]
    s_nop 0
    v_mfma_f32_16x16x32_bf16 v[68:71], v[224:227], v[4:7], v[68:71]
    v_perm_b32 v8, v44, v44, v28
    v_perm_b32 v9, v44, v44, v29
    v_perm_b32 v10, v44, v44, v30
    v_perm_b32 v11, v44, v44, v31
    v_perm_b32 v4, v60, v60, v28
    v_perm_b32 v5, v60, v60, v29
    v_perm_b32 v6, v60, v60, v30
    v_perm_b32 v7, v60, v60, v31
    v_mfma_f32_16x16x32_bf16 v[12:15], v[228:231], v[8:11], v[12:15]
    s_nop 0
    v_mfma_f32_16x16x32_bf16 v[68:71], v[228:231], v[4:7], v[68:71]
    v_perm_b32 v8, v45, v45, v24
    v_perm_b32 v9, v45, v45, v25
    v_perm_b32 v10, v45, v45, v26
    v_perm_b32 v11, v45, v45, v27
    v_perm_b32 v4, v61, v61, v24
    v_perm_b32 v5, v61, v61, v25
    v_perm_b32 v6, v61, v61, v26
    v_perm_b32 v7, v61, v61, v27
    v_mfma_f32_16x16x32_bf16 v[12:15], v[232:235], v[8:11], v[12:15]
    s_nop 0
    v_mfma_f32_16x16x32_bf16 v[68:71], v[232:235], v[4:7], v[68:71]
    v_perm_b32 v8, v45, v45, v28
    v_perm_b32 v9, v45, v45, v29
    v_perm_b32 v10, v45, v45, v30
    v_perm_b32 v11, v45, v45, v31
    v_perm_b32 v4, v61, v61, v28
    v_perm_b32 v5, v61, v61, v29
    v_perm_b32 v6, v61, v61, v30
    v_perm_b32 v7, v61, v61, v31
    v_mfma_f32_16x16x32_bf16 v[12:15], v[236:239], v[8:11], v[12:15]
    s_nop 0
    v_mfma_f32_16x16x32_bf16 v[68:71], v[236:239], v[4:7], v[68:71]
    v_perm_b32 v8, v46, v46, v24
    v_perm_b32 v9, v46, v46, v25
    v_perm_b32 v10, v46, v46, v26
    v_perm_b32 v11, v46, v46, v27
    v_perm_b32 v4, v62, v62, v24
    v_perm_b32 v5, v62, v62, v25
    v_perm_b32 v6, v62, v62, v26
    v_perm_b32 v7, v62, v62, v27
    v_mfma_f32_16x16x32_bf16 v[12:15], v[240:243], v[8:11], v[12:15]
    s_nop 0
    v_mfma_f32_16x16x32_bf16 v[68:71], v[240:243], v[4:7], v[68:71]
    v_perm_b32 v8, v46, v46, v28
    v_perm_b32 v9, v46, v46, v29
    v_perm_b32 v10, v46, v46, v30
    v_perm_b32 v11, v46, v46, v31
    v_perm_b32 v4, v62, v62, v28
    v_perm_b32 v5, v62, v62, v29
    v_perm_b32 v6, v62, v62, v30
    v_perm_b32 v7, v62, v62, v31
    v_mfma_f32_16x16x32_bf16 v[12:15], v[244:247], v[8:11], v[12:15]
    s_nop 0
    v_mfma_f32_16x16x32_bf16 v[68:71], v[244:247], v[4:7], v[68:71]
    v_perm_b32 v8, v47, v47, v24
    v_perm_b32 v9, v47, v47, v25
    v_perm_b32 v10, v47, v47, v26
    v_perm_b32 v11, v47, v47, v27
    v_perm_b32 v4, v63, v63, v24
    v_perm_b32 v5, v63, v63, v25
    v_perm_b32 v6, v63, v63, v26
    v_perm_b32 v7, v63, v63, v27
    v_mfma_f32_16x16x32_bf16 v[12:15], v[248:251], v[8:11], v[12:15]
    s_nop 0
    v_mfma_f32_16x16x32_bf16 v[68:71], v[248:251], v[4:7], v[68:71]
    v_perm_b32 v8, v47, v47, v28
    v_perm_b32 v9, v47, v47, v29
    v_perm_b32 v10, v47, v47, v30
    v_perm_b32 v11, v47, v47, v31
    v_perm_b32 v4, v63, v63, v28
    v_perm_b32 v5, v63, v63, v29
    v_perm_b32 v6, v63, v63, v30
    v_perm_b32 v7, v63, v63, v31
    v_mfma_f32_16x16x32_bf16 v[12:15], v[252:255], v[8:11], v[12:15]
    s_nop 0
    v_mfma_f32_16x16x32_bf16 v[68:71], v[252:255], v[4:7], v[68:71]
    v_lshrrev_b32 v3, 4, v0
    v_lshlrev_b32 v3, 7, v3
    v_and_b32 v4, 7, v0
    v_lshl_add_u32 v3, v4, 4, v3
    v_bfe_u32 v4, v0, 3, 1
    v_lshl_add_u32 v3, v4, 9, v3
    s_lshl_b32 s24, s3, 11
    s_add_u32 s24, s24, 135168
    v_add_u32 v3, s24, v3
    ds_write_b128 v3, v[12:15]
    ds_write_b128 v3, v[68:71] offset:1024
    s_waitcnt lgkmcnt(0)
    s_barrier
    v_and_b32 v5, 31, v0
    s_lshl_b32 s24, s3, 9
    s_add_u32 s24, s24, 135168
    v_lshl_add_u32 v3, v5, 4, s24
    ds_read_b128 v[72:75], v3 offset:0
    ds_read_b128 v[76:79], v3 offset:2048
    ds_read_b128 v[80:83], v3 offset:4096
    ds_read_b128 v[84:87], v3 offset:6144
    v_lshlrev_b32 v5, 3, v5
    s_waitcnt lgkmcnt(0)
    v_add_f32 v72, v72, v76
    v_add_f32 v73, v73, v77
    v_add_f32 v74, v74, v78
    v_add_f32 v75, v75, v79
    v_add_f32 v72, v72, v80
    v_add_f32 v73, v73, v81
    v_add_f32 v74, v74, v82
    v_add_f32 v75, v75, v83
    v_add_f32 v72, v72, v84
    v_add_f32 v73, v73, v85
    v_add_f32 v74, v74, v86
    v_add_f32 v75, v75, v87
    v_cvt_pk_bf16_f32 v6, v72, v73
    v_cvt_pk_bf16_f32 v7, v74, v75
    s_getreg_b32 s24, hwreg(HW_REG_XCC_ID, 0, 4)
    v_cmp_ne_u32 vcc, s24, v16
    s_nop 0
    s_or_b32 s75, vcc_lo, vcc_hi
    s_lshl_b32 s24, s26, 10
    s_lshl_b32 s25, s3, 8
    s_add_u32 s24, s24, s25
    s_add_u32 s24, s24, 0x1b0000
    s_mov_b32 exec_hi, 0
    s_cmp_lg_u32 s75, 0
    s_cbranch_scc1 L_far17
    buffer_store_dwordx2 v[6:7], v5, s[12:15], s24 offen
    s_branch L_near17
L_far17:
    buffer_store_dwordx2 v[6:7], v5, s[12:15], s24 offen sc1
L_near17:
    s_lshr_b32 s24, s2, 3
    s_lshl_b32 s24, s24, 12
    s_and_b32 s25, s2, 7
    s_lshl_b32 s25, s25, 7
    s_add_u32 s24, s24, s25
    s_lshl_b32 s25, s3, 3
    s_add_u32 s24, s24, s25
    s_add_u32 s24, s24, 0x1d1000
    s_mov_b64 exec, 1
    v_mov_b32 v4, 0
    v_mov_b32 v5, 0
    s_waitcnt vmcnt(0)
    s_cmp_lg_u32 s75, 0
    s_cbranch_scc1 L_far18
    buffer_store_dwordx2 v[4:5], off, s[12:15], s24
    s_branch L_near18
L_far18:
    buffer_store_dwordx2 v[4:5], off, s[12:15], s24 sc1
L_near18:
    s_mov_b64 exec, -1
    s_barrier
L_R:
    s_mov_b32 s20, s58
    s_mov_b32 s21, s59
    s_mov_b32 s22, 0x2000
    s_mov_b32 s23, 0x20000
    v_and_b32 v3, 1, v0
    v_lshlrev_b32 v3, 4, v3
    v_mov_b32 v4, 0xffff
    v_lshlrev_b32 v4, v3, v4
    v_bfe_u32 v3, v0, 1, 2
    v_cmp_eq_u32 vcc, 0, v3
    s_nop 1
    v_cndmask_b32 v20, 0, v4, vcc
    v_cmp_eq_u32 vcc, 1, v3
    s_nop 1
    v_cndmask_b32 v21, 0, v4, vcc
    v_cmp_eq_u32 vcc, 2, v3
    s_nop 1
    v_cndmask_b32 v22, 0, v4, vcc
    v_cmp_eq_u32 vcc, 3, v3
    s_nop 1
    v_cndmask_b32 v23, 0, v4, vcc
    v_lshrrev_b32 v3, 4, v0
    v_and_b32 v4, 7, v0
    v_bfe_u32 v7, v0, 3, 1
    v_lshl_add_u32 v5, v3, 3, v4
    v_mul_u32_u24 v6, 320, v7
    v_lshl_add_u32 v5, v5, 3, v6
    s_mul_i32 s24, s3, 1280
    s_add_u32 s24, s24, 135168
    v_add_u32 v24, s24, v5
    v_and_b32 v5, 3, v0
    v_mul_u32_u24 v25, 320, v5
    v_lshl_add_u32 v25, v3, 4, v25
    v_add_u32 v25, 135168, v25
    v_lshlrev_b32 v26, 4, v4
    v_lshl_add_u32 v26, v7, 3, v26
    v_and_b32 v5, 15, v0
    v_lshlrev_b32 v28, 11, v3
    v_lshl_add_u32 v28, v5, 1, v28
    s_and_b32 s24, s74, 7
    s_lshl_b32 s24, s24, 3
    s_bfm_b64 s[44:45], 8, s24
    s_not_b64 s[44:45], s[44:45]
    v_min_u32 v6, 5, v4
    v_lshrrev_b32 v5, 1, v6
    v_and_b32 v8, 1, v3
    v_mad_u32_u24 v5, v8, 3, v5
    v_lshlrev_b32 v31, 12, v5
    v_and_b32 v6, 1, v6
    v_lshl_add_u32 v6, v7, 1, v6
    v_lshl_add_u32 v31, v6, 4, v31
    s_and_b32 s35, s72, 7
    s_lshl_b32 s35, s35, 7
    s_add_u32 s35, s35, 0x1b8000
    s_lshr_b32 s34, s72, 3
    s_mul_i32 s34, s34, 6
    s_mul_i32 s29, s3, 24576
    s_add_u32 s29, s29, s35
    s_mov_b32 s43, s29
    s_and_b32 s24, s3, 1
    s_lshl_b32 s24, s24, 1
    s_and_b32 s29, s3, 2
    s_lshl_b32 s29, s29, 3
    s_or_b32 s29, s29, s24
    s_and_b32 s24, s26, 13
    s_or_b32 s29, s29, s24
    s_lshl_b32 s46, s29, 10
    s_add_u32 s46, s46, 0x1b0000
    s_mul_i32 s29, s29, 6144
    s_add_u32 s29, s29, 0x180000
    s_add_u32 s42, s29, 4096
    s_lshr_b32 s24, s74, 3
    s_lshl_b32 s24, s24, 2
    s_add_u32 s24, s24, s3
    s_lshl_b32 s36, s24, 12
    s_add_u32 s36, s36, 0x1d9000
    s_and_b32 s37, s74, 7
    s_lshl_b32 s37, s37, 7
    s_add_u32 s37, s37, s36
    s_lshl_b32 s38, s3, 12
    s_andn2_b32 s25, s74, 7
    s_lshl_b32 s25, s25, 4
    s_add_u32 s38, s38, s25
    s_add_u32 s38, s38, 0x1d5000
    s_lshl_b32 s39, s24, 5
    s_add_u32 s39, s39, 1024
    s_add_u32 s30, s36, -1413120
    s_add_u32 s31, s37, -1413120
    s_mov_b32 s40, 0x600000
    s_sub_u32 s41, s39, 1024
    s_mov_b32 s33, 0
    s_lshl_b32 s47, s3, 12
    s_add_u32 s47, s47, s35
    s_add_u32 s47, s47, 102400
    v_and_b32 v6, 3, v0
    v_lshlrev_b32 v6, 3, v6
    s_mov_b32 s24, 262144
    s_branch L_pd19_in
L_pd19:
    s_sleep 8
L_pd19_in:
    buffer_load_dwordx2 v[8:9], v6, s[12:15], s47 offen sc1
    s_waitcnt vmcnt(0)
    v_max_u32 v3, v8, v9
    v_cmp_eq_u32 vcc, -1, v3
    s_sub_u32 s24, s24, 1
    s_cmp_eq_u32 s24, 0
    s_cbranch_scc1 L_pd19_x
    s_and_b64 exec, exec, vcc
    s_cbranch_scc1 L_pd19
L_pd19_x:
    s_mov_b64 exec, -1
    buffer_load_dwordx4 v[56:59], v2, s[12:15], s46 offen sc1
    buffer_load_dwordx4 v[68:71], v2, s[12:15], s46 offen sc1
    v_lshrrev_b32 v3, 4, v0
    v_sub_u32 v3, v3, v7
    v_mov_b32 v5, 0x3f803f80
    v_cmp_eq_u32 vcc, 0, v3
    s_nop 1
    v_cndmask_b32 v6, 0, v5, vcc
    v_and_b32 v32, v6, v20
    v_and_b32 v33, v6, v21
    v_and_b32 v34, v6, v22
    v_and_b32 v35, v6, v23
    v_mov_b32 v36, 0
    v_mov_b32 v60, 0
    v_mov_b32 v37, 0
    v_mov_b32 v61, 0
    v_mov_b32 v38, 0
    v_mov_b32 v62, 0
    v_mov_b32 v39, 0
    v_mov_b32 v63, 0
    v_mov_b32 v40, 0
    v_mov_b32 v64, 0
    v_mov_b32 v41, 0
    v_mov_b32 v65, 0
    v_mov_b32 v42, 0
    v_mov_b32 v66, 0
    v_mov_b32 v43, 0
    v_mov_b32 v67, 0
    v_cmp_eq_u32 vcc, 2, v3
    s_nop 1
    v_cndmask_b32 v6, 0, v5, vcc
    v_and_b32 v44, v6, v20
    v_and_b32 v45, v6, v21
    v_and_b32 v46, v6, v22
    v_and_b32 v47, v6, v23
    v_mov_b32 v48, 0
    v_mov_b32 v72, 0
    v_mov_b32 v49, 0
    v_mov_b32 v73, 0
    v_mov_b32 v50, 0
    v_mov_b32 v74, 0
    v_mov_b32 v51, 0
    v_mov_b32 v75, 0
    v_mov_b32 v52, 0
    v_mov_b32 v76, 0
    v_mov_b32 v53, 0
    v_mov_b32 v77, 0
    v_mov_b32 v54, 0
    v_mov_b32 v78, 0
    v_mov_b32 v55, 0
    v_mov_b32 v79, 0
    s_waitcnt vmcnt(0)
    s_branch L_P_go
L_P:
    s_mov_b64 s[30:31], s[36:37]
    s_mov_b64 s[40:41], s[38:39]
    s_mov_b32 s33, 1
    v_accvgpr_mov_b32 a128, a64
    v_accvgpr_mov_b32 a129, a65
    v_accvgpr_mov_b32 a130, a66
    v_accvgpr_mov_b32 a131, a67
    v_accvgpr_mov_b32 a132, a68
    v_accvgpr_mov_b32 a133, a69
    v_accvgpr_mov_b32 a134, a70
    v_accvgpr_mov_b32 a135, a71
    v_accvgpr_mov_b32 a136, a72
    v_accvgpr_mov_b32 a137, a73
    v_accvgpr_mov_b32 a138, a74
    v_accvgpr_mov_b32 a139, a75
    v_accvgpr_mov_b32 a140, a76
    v_accvgpr_mov_b32 a141, a77
    v_accvgpr_mov_b32 a142, a78
    v_accvgpr_mov_b32 a143, a79
    v_accvgpr_mov_b32 a144, a80
    v_accvgpr_mov_b32 a145, a81
    v_accvgpr_mov_b32 a146, a82
    v_accvgpr_mov_b32 a147, a83
    v_accvgpr_mov_b32 a148, a84
    v_accvgpr_mov_b32 a149, a85
    v_accvgpr_mov_b32 a150, a86
    v_accvgpr_mov_b32 a151, a87
    v_accvgpr_mov_b32 a152, a88
    v_accvgpr_mov_b32 a153, a89
    v_accvgpr_mov_b32 a154, a90
    v_accvgpr_mov_b32 a155, a91
    v_accvgpr_mov_b32 a156, a92
    v_accvgpr_mov_b32 a157, a93
    v_accvgpr_mov_b32 a158, a94
    v_accvgpr_mov_b32 a159, a95
    v_accvgpr_mov_b32 a160, a96
    v_accvgpr_mov_b32 a161, a97
    v_accvgpr_mov_b32 a162, a98
    v_accvgpr_mov_b32 a163, a99
    v_accvgpr_mov_b32 a164, a100
    v_accvgpr_mov_b32 a165, a101
    v_accvgpr_mov_b32 a166, a102
    v_accvgpr_mov_b32 a167, a103
    v_accvgpr_mov_b32 a168, a104
    v_accvgpr_mov_b32 a169, a105
    v_accvgpr_mov_b32 a170, a106
    v_accvgpr_mov_b32 a171, a107
    v_accvgpr_mov_b32 a172, a108
    v_accvgpr_mov_b32 a173, a109
    v_accvgpr_mov_b32 a174, a110
    v_accvgpr_mov_b32 a175, a111
    v_accvgpr_mov_b32 a176, a112
    v_accvgpr_mov_b32 a177, a113
    v_accvgpr_mov_b32 a178, a114
    v_accvgpr_mov_b32 a179, a115
    v_accvgpr_mov_b32 a180, a116
    v_accvgpr_mov_b32 a181, a117
    v_accvgpr_mov_b32 a182, a118
    v_accvgpr_mov_b32 a183, a119
    v_accvgpr_mov_b32 a184, a120
    v_accvgpr_mov_b32 a185, a121
    v_accvgpr_mov_b32 a186, a122
    v_accvgpr_mov_b32 a187, a123
    v_accvgpr_mov_b32 a188, a124
    v_accvgpr_mov_b32 a189, a125
    v_accvgpr_mov_b32 a190, a126
    v_accvgpr_mov_b32 a191, a127
    s_mov_b32 s24, 262144
    s_branch L_pd20_in
L_pd20:
    s_sleep 16
L_pd20_in:
    buffer_load_dwordx2 v[8:9], v31, s[12:15], s43 offen sc1
    s_waitcnt vmcnt(0)
    v_max_u32 v3, v8, v9
    v_cmp_eq_u32 vcc, -1, v3
    s_sub_u32 s24, s24, 1
    s_cmp_eq_u32 s24, 0
    s_cbranch_scc1 L_pd20_x
    s_and_b64 exec, exec, vcc
    s_cbranch_scc1 L_pd20
L_pd20_x:
    s_mov_b64 exec, -1
    v_and_b32 v4, 7, v0
    v_bfe_u32 v7, v0, 3, 1
    v_mov_b32 v6, v8
    s_nop 1
    v_max_f32_dpp v6, v6, v6 quad_perm:[1,0,3,2] row_mask:0xf bank_mask:0xf
    s_nop 1
    v_max_f32_dpp v6, v6, v6 quad_perm:[2,3,0,1] row_mask:0xf bank_mask:0xf
    s_nop 1
    v_max_f32_dpp v6, v6, v6 row_half_mirror row_mask:0xf bank_mask:0xf
    v_sub_f32 v8, v8, v6
    v_exp_f32 v8, v8
    v_cmp_gt_u32 vcc, 6, v4
    s_nop 1
    v_cndmask_b32 v8, 0, v8, vcc
    v_mul_f32 v9, v8, v9
    s_nop 1
    v_add_f32_dpp v9, v9, v9 quad_perm:[1,0,3,2] row_mask:0xf bank_mask:0xf
    s_nop 1
    v_add_f32_dpp v9, v9, v9 quad_perm:[2,3,0,1] row_mask:0xf bank_mask:0xf
    s_nop 1
    v_add_f32_dpp v9, v9, v9 row_half_mirror row_mask:0xf bank_mask:0xf
    v_rcp_f32 v9, v9
    s_nop 0
    v_mul_f32 v8, v8, v9
    v_cvt_pk_bf16_f32 v8, v8, v8
    v_lshrrev_b32 v3, 4, v0
    v_mul_u32_u24 v9, 6, v7
    v_sub_u32 v3, v3, v9
    v_lshlrev_b32 v9, 3, v7
    v_add_u32 v5, 0, v3
    v_min_u32 v5, 6, v5
    v_add_u32 v5, v5, v9
    v_lshlrev_b32 v5, 2, v5
    ds_bpermute_b32 v10, v5, v8
    ds_bpermute_b32 v13, v5, v8 offset:64
    v_add_u32 v5, 4, v3
    v_min_u32 v5, 6, v5
    v_add_u32 v5, v5, v9
    v_lshlrev_b32 v5, 2, v5
    ds_bpermute_b32 v11, v5, v8
    ds_bpermute_b32 v14, v5, v8 offset:64
    v_add_u32 v5, 8, v3
    v_min_u32 v5, 6, v5
    v_add_u32 v5, v5, v9
    v_lshlrev_b32 v5, 2, v5
    ds_bpermute_b32 v12, v5, v8
    ds_bpermute_b32 v15, v5, v8 offset:64
    s_waitcnt lgkmcnt(0)
    v_and_b32 v32, v10, v20
    v_and_b32 v33, v10, v21
    v_and_b32 v34, v10, v22
    v_and_b32 v35, v10, v23
    v_and_b32 v36, v11, v20
    v_and_b32 v37, v11, v21
    v_and_b32 v38, v11, v22
    v_and_b32 v39, v11, v23
    v_and_b32 v40, v12, v20
    v_and_b32 v41, v12, v21
    v_and_b32 v42, v12, v22
    v_and_b32 v43, v12, v23
    v_and_b32 v44, v13, v20
    v_and_b32 v45, v13, v21
    v_and_b32 v46, v13, v22
    v_and_b32 v47, v13, v23
    v_and_b32 v48, v14, v20
    v_and_b32 v49, v14, v21
    v_and_b32 v50, v14, v22
    v_and_b32 v51, v14, v23
    v_and_b32 v52, v15, v20
    v_and_b32 v53, v15, v21
    v_and_b32 v54, v15, v22
    v_and_b32 v55, v15, v23
    s_cmp_lg_u32 s3, 0
    s_cbranch_scc1 L_H_x
    s_lshr_b32 s24, s74, 5
    s_mul_i32 s25, s24, 3
    s_add_u32 s34, s34, s25
    s_lshl_b32 s24, s24, 6
    s_add_u32 s24, s24, s26
    s_lshl_b32 s24, s24, 20
    s_add_u32 s4, s52, s24
    s_addc_u32 s5, s53, 0
    s_mov_b32 s6, 0x100000
    s_mov_b32 s7, 0x20000
    s_add_u32 s8, s4, 0x2000000
    s_addc_u32 s9, s5, 0
    s_mov_b32 s10, s6
    s_mov_b32 s11, 0x20000
    v_lshrrev_b32 v3, 4, v0
    v_mul_u32_u24 v16, 6144, v3
    v_and_b32 v3, 15, v0
    v_lshl_add_u32 v16, v3, 7, v16
    v_lshlrev_b32 v17, 12, v0
    v_mov_b32 v18, 0
    s_mov_b32 s27, 43
    s_mov_b32 s28, 43
    s_mov_b32 s32, 43
    s_mov_b32 s75, 1024
L_H:
    s_sub_u32 s75, s75, 1
    s_cmp_eq_u32 s75, 0
    s_cbranch_scc1 L_H_x
    s_mov_b64 exec, 0xffffff
    buffer_load_dword v18, v17, s[12:15], s35 offen offset:64 sc1
    s_mov_b64 exec, -1
    s_waitcnt vmcnt(0)
    v_max_i32 v19, 0, v18
    s_nop 1
    v_add_u32_dpp v3, v19, v19 row_ror:8 row_mask:0xf bank_mask:0xf
    s_nop 1
    v_add_u32_dpp v3, v3, v3 row_ror:4 row_mask:0xf bank_mask:0xf
    s_nop 1
    v_add_u32_dpp v3, v3, v3 row_ror:2 row_mask:0xf bank_mask:0xf
    s_nop 1
    v_add_u32_dpp v3, v3, v3 row_ror:1 row_mask:0xf bank_mask:0xf
    s_nop 0
    v_readlane_b32 s70, v3, 0
    v_readlane_b32 s24, v3, 16
    s_nop 0
    s_add_u32 s70, s70, s24
    s_add_u32 s24, s34, 0
    s_nop 0
    v_readlane_b32 s24, v19, s24
    s_sub_u32 s25, 43, s27
    s_mul_i32 s25, s25, 17
    s_mul_i32 s64, s24, 24
    s_add_u32 s64, s64, s25
    s_add_u32 s24, s24, 8
    s_cmp_gt_u32 s24, s27
    s_cselect_b32 s64, 0xffff, s64
    s_add_u32 s24, s34, 1
    v_readlane_b32 s24, v19, s24
    s_sub_u32 s25, 43, s28
    s_mul_i32 s25, s25, 17
    s_mul_i32 s65, s24, 24
    s_add_u32 s65, s65, s25
    s_add_u32 s24, s24, 8
    s_cmp_gt_u32 s24, s28
    s_cselect_b32 s65, 0xffff, s65
    s_add_u32 s24, s34, 2
    v_readlane_b32 s24, v19, s24
    s_sub_u32 s25, 43, s32
    s_mul_i32 s25, s25, 17
    s_mul_i32 s66, s24, 24
    s_add_u32 s66, s66, s25
    s_add_u32 s24, s24, 8
    s_cmp_gt_u32 s24, s32
    s_cselect_b32 s66, 0xffff, s66
    s_min_u32 s71, s64, s65
    s_min_u32 s71, s71, s66
    s_cmp_eq_u32 s71, 0xffff
    s_cbranch_scc1 L_H_x
    s_add_u32 s24, s71, 36
    s_cmp_lt_i32 s24, s70
    s_cbranch_scc1 L_H_go
    s_sleep 4
    s_branch L_H
L_H_go:
    s_cmp_lg_u32 s71, s64
    s_cbranch_scc1 L_H_n0
    s_sub_u32 s27, s27, 2
    s_mul_i32 s24, s27, 24576
    s_add_u32 s24, s24, 0
    s_branch L_H_ld
L_H_n0:
    s_cmp_lg_u32 s71, s65
    s_cbranch_scc1 L_H_n1
    s_sub_u32 s28, s28, 2
    s_mul_i32 s24, s28, 24576
    s_add_u32 s24, s24, 2048
    s_branch L_H_ld
L_H_n1:
    s_sub_u32 s32, s32, 2
    s_mul_i32 s24, s32, 24576
    s_add_u32 s24, s24, 4096
L_H_ld:
    buffer_load_dword v5, v16, s[4:7], s24 offen
    buffer_load_dword v5, v16, s[8:11], s24 offen
    s_add_u32 s24, s24, 24576
    buffer_load_dword v5, v16, s[4:7], s24 offen
    buffer_load_dword v5, v16, s[8:11], s24 offen
    s_branch L_H
L_H_x:
    s_barrier
    s_mov_b32 s24, 262144
    s_branch L_pd21_in
L_pd21:
    s_sleep 4
L_pd21_in:
    buffer_load_dwordx2 v[8:9], v31, s[12:15], s43 offen offset:8 sc1
    s_waitcnt vmcnt(0)
    v_max_u32 v3, v8, v9
    v_cmp_eq_u32 vcc, -1, v3
    s_sub_u32 s24, s24, 1
    s_cmp_eq_u32 s24, 0
    s_cbranch_scc1 L_pd21_x
    s_and_b64 exec, exec, vcc
    s_cbranch_scc1 L_pd21
L_pd21_x:
    s_mov_b64 exec, -1
    s_mov_b32 s24, 262144
L_pd22:
    buffer_load_dwordx4 v[56:59], v2, s[12:15], s29 offen offset:0 sc1
    buffer_load_dwordx4 v[60:63], v2, s[12:15], s29 offen offset:1024 sc1
    buffer_load_dwordx4 v[64:67], v2, s[12:15], s29 offen offset:2048 sc1
    buffer_load_dwordx4 v[68:71], v2, s[12:15], s29 offen offset:3072 sc1
    buffer_load_dwordx4 v[72:75], v2, s[12:15], s42 offen offset:0 sc1
    buffer_load_dwordx4 v[76:79], v2, s[12:15], s42 offen offset:1024 sc1
    s_waitcnt vmcnt(0)
    v_max_u32 v3, v56, v57
    v_max3_u32 v3, v3, v58, v59
    v_max3_u32 v3, v3, v60, v61
    v_max3_u32 v3, v3, v62, v63
    v_max3_u32 v3, v3, v64, v65
    v_max3_u32 v3, v3, v66, v67
    v_max3_u32 v3, v3, v68, v69
    v_max3_u32 v3, v3, v70, v71
    v_max3_u32 v3, v3, v72, v73
    v_max3_u32 v3, v3, v74, v75
    v_max3_u32 v3, v3, v76, v77
    v_max3_u32 v3, v3, v78, v79
    v_cmp_eq_u32 vcc, -1, v3
    s_sub_u32 s24, s24, 1
    s_cmp_eq_u32 s24, 0
    s_cbranch_scc1 L_pd22_x
    s_and_b64 exec, exec, vcc
    s_cbranch_scc1 L_pd22
L_pd22_x:
    s_mov_b64 exec, -1
L_P_go:
    v_mfma_f32_16x16x32_bf16 v[12:15], v[56:59], v[32:35], 0
    v_mfma_f32_16x16x32_bf16 v[16:19], v[68:71], v[44:47], 0
    v_mfma_f32_16x16x32_bf16 v[12:15], v[60:63], v[36:39], v[12:15]
    v_mfma_f32_16x16x32_bf16 v[16:19], v[72:75], v[48:51], v[16:19]
    v_mfma_f32_16x16x32_bf16 v[12:15], v[64:67], v[40:43], v[12:15]
    v_mfma_f32_16x16x32_bf16 v[16:19], v[76:79], v[52:55], v[16:19]
    s_barrier
    s_mov_b64 exec, 1
    v_mov_b32 v83, 64
    buffer_atomic_add v83, off, s[12:15], s40 sc0
    s_mov_b64 exec, -1
    s_nop 1
    v_cvt_pk_bf16_f32 v4, v12, v13
    v_cvt_pk_bf16_f32 v5, v14, v15
    ds_write_b64 v24, v[4:5]
    v_cvt_pk_bf16_f32 v6, v16, v17
    v_cvt_pk_bf16_f32 v7, v18, v19
    ds_write_b64 v24, v[6:7] offset:640
    s_waitcnt lgkmcnt(0)
    s_barrier
    ds_read_b128 v[128:131], v25 offset:0
    ds_read_b128 v[132:135], v25 offset:64
    ds_read_b128 v[136:139], v25 offset:128
    ds_read_b128 v[140:143], v25 offset:192
    ds_read_b128 v[144:147], v25 offset:1280
    ds_read_b128 v[148:151], v25 offset:1344
    ds_read_b128 v[152:155], v25 offset:1408
    ds_read_b128 v[156:159], v25 offset:1472
    ds_read_b128 v[160:163], v25 offset:2560
    s_waitcnt lgkmcnt(8)
    v_mfma_f32_16x16x32_bf16 v[12:15], v[128:131], a[128:131], 0
    ds_read_b128 v[164:167], v25 offset:2624
    s_waitcnt lgkmcnt(8)
    v_mfma_f32_16x16x32_bf16 v[12:15], v[132:135], a[132:135], v[12:15]
    ds_read_b128 v[168:171], v25 offset:2688
    s_waitcnt lgkmcnt(8)
    v_mfma_f32_16x16x32_bf16 v[12:15], v[136:139], a[136:139], v[12:15]
    ds_read_b128 v[172:175], v25 offset:2752
    s_waitcnt lgkmcnt(8)
    v_mfma_f32_16x16x32_bf16 v[12:15], v[140:143], a[140:143], v[12:15]
    ds_read_b128 v[176:179], v25 offset:3840
    s_waitcnt lgkmcnt(8)
    v_mfma_f32_16x16x32_bf16 v[12:15], v[144:147], a[144:147], v[12:15]
    ds_read_b128 v[180:183], v25 offset:3904
    s_waitcnt lgkmcnt(8)
    v_mfma_f32_16x16x32_bf16 v[12:15], v[148:151], a[148:151], v[12:15]
    ds_read_b128 v[184:187], v25 offset:3968
    s_waitcnt lgkmcnt(8)
    v_mfma_f32_16x16x32_bf16 v[12:15], v[152:155], a[152:155], v[12:15]
    ds_read_b128 v[188:191], v25 offset:4032
    s_waitcnt lgkmcnt(8)
    v_mfma_f32_16x16x32_bf16 v[12:15], v[156:159], a[156:159], v[12:15]
    s_waitcnt lgkmcnt(7)
    v_mfma_f32_16x16x32_bf16 v[12:15], v[160:163], a[160:163], v[12:15]
    s_waitcnt lgkmcnt(6)
    v_mfma_f32_16x16x32_bf16 v[12:15], v[164:167], a[164:167], v[12:15]
    s_waitcnt lgkmcnt(5)
    v_mfma_f32_16x16x32_bf16 v[12:15], v[168:171], a[168:171], v[12:15]
    s_waitcnt lgkmcnt(4)
    v_mfma_f32_16x16x32_bf16 v[12:15], v[172:175], a[172:175], v[12:15]
    s_waitcnt lgkmcnt(3)
    v_mfma_f32_16x16x32_bf16 v[12:15], v[176:179], a[176:179], v[12:15]
    s_waitcnt lgkmcnt(2)
    v_mfma_f32_16x16x32_bf16 v[12:15], v[180:183], a[180:183], v[12:15]
    s_waitcnt lgkmcnt(1)
    v_mfma_f32_16x16x32_bf16 v[12:15], v[184:187], a[184:187], v[12:15]
    s_waitcnt lgkmcnt(0)
    v_mfma_f32_16x16x32_bf16 v[12:15], v[188:191], a[188:191], v[12:15]
    s_nop 7
    v_cvt_pk_bf16_f32 v4, v12, v13
    v_cvt_pk_bf16_f32 v5, v14, v15
    s_mov_b64 exec, 0xffff
    buffer_store_dwordx2 v[4:5], v26, s[12:15], s31 offen sc1
    s_mov_b64 exec, -1
    v_mov_b32 v16, v4
    v_mov_b32 v17, v5
    v_mov_b32 v18, v4
    v_mov_b32 v19, v5
    v_mov_b32_dpp v16, v4 row_ror:8 row_mask:0xf bank_mask:0xc
    v_mov_b32_dpp v17, v5 row_ror:8 row_mask:0xf bank_mask:0xc
    v_mov_b32_dpp v18, v4 row_ror:8 row_mask:0xf bank_mask:0x3
    v_mov_b32_dpp v19, v5 row_ror:8 row_mask:0xf bank_mask:0x3
    s_waitcnt vmcnt(1)
    v_readfirstlane_b32 s24, v83
    s_nop 0
    s_cmpk_eq_u32 s24, 447
    s_cbranch_scc1 L_P_f
    s_waitcnt vmcnt(0)
    s_cmp_eq_u32 s33, 0
    s_cbranch_scc1 L_P_a
    v_readfirstlane_b32 s24, v83
    s_nop 0
    s_cmpk_lg_u32 s24, 447
    s_cbranch_scc1 L_P_x
L_P_f:
    s_mov_b64 exec, s[44:45]
L_P_g:
    s_mov_b32 s24, 262144
L_pd23:
    buffer_load_dwordx4 v[16:19], v2, s[12:15], s30 offen sc1
    s_waitcnt vmcnt(0)
    v_max_u32 v3, v16, v17
    v_max3_u32 v3, v3, v18, v19
    v_cmp_eq_u32 vcc, -1, v3
    s_sub_u32 s24, s24, 1
    s_cmp_eq_u32 s24, 0
    s_cbranch_scc1 L_pd23_x
    s_and_b64 exec, exec, vcc
    s_cbranch_scc1 L_pd23
L_pd23_x:
    s_mov_b64 exec, -1
    v_lshlrev_b32 v56, 16, v16
    v_and_b32 v57, 0xffff0000, v16
    v_lshlrev_b32 v58, 16, v17
    v_and_b32 v59, 0xffff0000, v17
    v_lshlrev_b32 v60, 16, v18
    v_and_b32 v61, 0xffff0000, v18
    v_lshlrev_b32 v62, 16, v19
    v_and_b32 v63, 0xffff0000, v19
    v_permlane32_swap_b32 v56, v58
    v_permlane32_swap_b32 v57, v59
    v_permlane32_swap_b32 v60, v62
    v_permlane32_swap_b32 v61, v63
    v_add_f32 v56, v56, v58
    v_add_f32 v57, v57, v59
    v_add_f32 v60, v60, v62
    v_add_f32 v61, v61, v63
    v_permlane16_swap_b32 v56, v57
    s_nop 0
    v_permlane16_swap_b32 v60, v61
    v_add_f32 v56, v56, v57
    v_add_f32 v60, v60, v61
    s_nop 0
    v_add_f32_dpp v4, v56, v56 row_ror:8 row_mask:0xf bank_mask:0x3
    s_nop 1
    v_add_f32_dpp v4, v60, v60 row_ror:8 row_mask:0xf bank_mask:0xc
    v_cvt_pk_bf16_f32 v4, v4, v4
    buffer_store_short v4, v28, s[20:23], s41 offen
    s_cmp_lg_u32 s33, 0
    s_cbranch_scc1 L_P_x
    s_add_u32 s30, s30, 4096
    s_add_u32 s41, s41, 32
    s_and_b32 s24, s41, 96
    s_cbranch_scc1 L_P_g
    s_branch L_P
L_P_a:
    s_barrier
    s_cmp_lg_u32 s3, 1
    s_cbranch_scc1 L_P_w
    s_add_u32 s24, s38, 4
    s_sub_u32 s30, s30, 4096
    s_sub_u32 s41, s41, 32
    s_mov_b64 exec, 1
    v_mov_b32 v83, 64
    buffer_atomic_add v83, off, s[12:15], s24 sc0
    s_mov_b64 exec, -1
    s_waitcnt vmcnt(0)
    v_readfirstlane_b32 s24, v83
    s_nop 0
    s_cmpk_eq_u32 s24, 447
    s_cbranch_scc1 L_P_g
L_P_w:
    s_mov_b32 s30, 0x600000
    s_mov_b32 s41, 0x600060
    s_branch L_P_g
L_P_x:
L_end:
    s_endpgm
L_C:
    s_cmp_lg_u32 s3, 0
    s_cbranch_scc1 L_C_q
    v_lshrrev_b32 v3, 4, v0
    v_and_b32 v4, 3, v0
    v_lshlrev_b32 v5, 6, v3
    v_lshl_add_u32 v5, v4, 4, v5
    v_bfe_u32 v4, v0, 2, 2
    v_lshl_add_u32 v5, v4, 8, v5
    s_lshl_b32 s24, s26, 12
    s_add_u32 s24, s24, 0x140000
    buffer_store_dwordx4 v[8:11], v5, s[12:15], s24 offen sc1
L_C_q:
    s_waitcnt vmcnt(0)
    s_barrier
    s_cmp_lg_u32 s3, 0
    s_cbranch_scc1 L_sig24
    s_mov_b64 exec, 1
    v_mov_b32 v3, 1
    v_mov_b32 v4, 1
    buffer_atomic_add v4, off, s[16:19], 0 offset:128
    buffer_atomic_add v3, off, s[16:19], 0 offset:0 sc0
    s_waitcnt vmcnt(0)
    v_readfirstlane_b32 s24, v3
    s_mov_b64 exec, -1
    s_and_b32 s24, s24, 63
    s_cmp_lg_u32 s24, 63
    s_cbranch_scc1 L_sig24
    v_lshlrev_b32 v4, 7, v0
    v_mov_b32 v3, 1
    s_mov_b32 s24, 0x170000
    buffer_store_dword v3, v4, s[12:15], s24 offen offset:0 sc1
L_sig24:
    s_and_b32 s24, s3, 1
    s_lshl_b32 s24, s24, 1
    s_and_b32 s25, s3, 2
    s_lshl_b32 s25, s25, 3
    s_or_b32 s25, s25, s24
    s_and_b32 s24, s26, 13
    s_or_b32 s25, s25, s24
    s_lshl_b32 s25, s25, 17
    s_lshr_b32 s24, s74, 3
    s_lshl_b32 s24, s24, 7
    s_add_u32 s25, s24, s25
    v_lshrrev_b32 v3, 4, v0
    v_lshlrev_b32 v3, 15, v3
    v_and_b32 v4, 8, v0
    v_lshl_add_u32 v3, v4, 10, v3
    v_and_b32 v4, 0x70, v2
    v_add_u32 v3, v3, v4
    s_mov_b32 s8, s56
    s_mov_b32 s9, s57
    s_mov_b32 s10, 0x400000
    s_mov_b32 s11, 0x20000
    s_mul_i32 s24, s3, 16896
    s_add_u32 m0, s24, 0
    s_mov_b32 s24, s25
    buffer_load_dwordx4 v3, s[8:11], s24 offen nt lds
    s_add_u32 m0, m0, 1056
    s_add_u32 s24, s24, 2048
    buffer_load_dwordx4 v3, s[8:11], s24 offen nt lds
    s_add_u32 m0, m0, 1056
    s_add_u32 s24, s24, 2048
    buffer_load_dwordx4 v3, s[8:11], s24 offen nt lds
    s_add_u32 m0, m0, 1056
    s_add_u32 s24, s24, 2048
    buffer_load_dwordx4 v3, s[8:11], s24 offen nt lds
    s_add_u32 m0, m0, 1056
    s_add_u32 s24, s24, 10240
    buffer_load_dwordx4 v3, s[8:11], s24 offen nt lds
    s_add_u32 m0, m0, 1056
    s_add_u32 s24, s24, 2048
    buffer_load_dwordx4 v3, s[8:11], s24 offen nt lds
    s_add_u32 m0, m0, 1056
    s_add_u32 s24, s24, 2048
    buffer_load_dwordx4 v3, s[8:11], s24 offen nt lds
    s_add_u32 m0, m0, 1056
    s_add_u32 s24, s24, 2048
    buffer_load_dwordx4 v3, s[8:11], s24 offen nt lds
    s_add_u32 m0, m0, 1056
    s_add_u32 s24, s24, -21504
    buffer_load_dwordx4 v3, s[8:11], s24 offen nt lds
    s_add_u32 m0, m0, 1056
    s_add_u32 s24, s24, 2048
    buffer_load_dwordx4 v3, s[8:11], s24 offen nt lds
    s_add_u32 m0, m0, 1056
    s_add_u32 s24, s24, 2048
    buffer_load_dwordx4 v3, s[8:11], s24 offen nt lds
    s_add_u32 m0, m0, 1056
    s_add_u32 s24, s24, 2048
    buffer_load_dwordx4 v3, s[8:11], s24 offen nt lds
    s_add_u32 m0, m0, 1056
    s_add_u32 s24, s24, 10240
    buffer_load_dwordx4 v3, s[8:11], s24 offen nt lds
    s_add_u32 m0, m0, 1056
    s_add_u32 s24, s24, 2048
    buffer_load_dwordx4 v3, s[8:11], s24 offen nt lds
    s_add_u32 m0, m0, 1056
    s_add_u32 s24, s24, 2048
    buffer_load_dwordx4 v3, s[8:11], s24 offen nt lds
    s_add_u32 m0, m0, 1056
    s_add_u32 s24, s24, 2048
    buffer_load_dwordx4 v3, s[8:11], s24 offen nt lds
    s_mov_b32 s8, s46
    s_mov_b32 s9, s47
    s_mov_b32 s10, 0x400000
    s_mov_b32 s11, 0x20000
    s_mul_i32 s24, s3, 16896
    s_add_u32 m0, s24, 67584
    s_mov_b32 s24, s25
    buffer_load_dwordx4 v3, s[8:11], s24 offen nt lds
    s_add_u32 m0, m0, 1056
    s_add_u32 s24, s24, 2048
    buffer_load_dwordx4 v3, s[8:11], s24 offen nt lds
    s_add_u32 m0, m0, 1056
    s_add_u32 s24, s24, 2048
    buffer_load_dwordx4 v3, s[8:11], s24 offen nt lds
    s_add_u32 m0, m0, 1056
    s_add_u32 s24, s24, 2048
    buffer_load_dwordx4 v3, s[8:11], s24 offen nt lds
    s_add_u32 m0, m0, 1056
    s_add_u32 s24, s24, 10240
    buffer_load_dwordx4 v3, s[8:11], s24 offen nt lds
    s_add_u32 m0, m0, 1056
    s_add_u32 s24, s24, 2048
    buffer_load_dwordx4 v3, s[8:11], s24 offen nt lds
    s_add_u32 m0, m0, 1056
    s_add_u32 s24, s24, 2048
    buffer_load_dwordx4 v3, s[8:11], s24 offen nt lds
    s_add_u32 m0, m0, 1056
    s_add_u32 s24, s24, 2048
    buffer_load_dwordx4 v3, s[8:11], s24 offen nt lds
    s_add_u32 m0, m0, 1056
    s_add_u32 s24, s24, -21504
    buffer_load_dwordx4 v3, s[8:11], s24 offen nt lds
    s_add_u32 m0, m0, 1056
    s_add_u32 s24, s24, 2048
    buffer_load_dwordx4 v3, s[8:11], s24 offen nt lds
    s_add_u32 m0, m0, 1056
    s_add_u32 s24, s24, 2048
    buffer_load_dwordx4 v3, s[8:11], s24 offen nt lds
    s_add_u32 m0, m0, 1056
    s_add_u32 s24, s24, 2048
    buffer_load_dwordx4 v3, s[8:11], s24 offen nt lds
    s_add_u32 m0, m0, 1056
    s_add_u32 s24, s24, 10240
    buffer_load_dwordx4 v3, s[8:11], s24 offen nt lds
    s_add_u32 m0, m0, 1056
    s_add_u32 s24, s24, 2048
    buffer_load_dwordx4 v3, s[8:11], s24 offen nt lds
    s_add_u32 m0, m0, 1056
    s_add_u32 s24, s24, 2048
    buffer_load_dwordx4 v3, s[8:11], s24 offen nt lds
    s_add_u32 m0, m0, 1056
    s_add_u32 s24, s24, 2048
    buffer_load_dwordx4 v3, s[8:11], s24 offen nt lds
    s_waitcnt vmcnt(0)
    s_barrier
    v_lshrrev_b32 v3, 2, v0
    v_mul_u32_u24 v3, 1056, v3
    v_and_b32 v4, 3, v0
    v_lshl_add_u32 v3, v4, 3, v3
    s_lshl_b32 s24, s3, 5
    v_add_u32 v3, s24, v3
    v_add_u32 v4, 67584, v3
    ds_read_b64_tr_b16 a[64:65], v3 offset:0
    ds_read_b64_tr_b16 a[66:67], v3 offset:128
    ds_read_b64_tr_b16 a[68:69], v3 offset:256
    ds_read_b64_tr_b16 a[70:71], v3 offset:384
    ds_read_b64_tr_b16 a[72:73], v3 offset:512
    ds_read_b64_tr_b16 a[74:75], v3 offset:640
    ds_read_b64_tr_b16 a[76:77], v3 offset:768
    ds_read_b64_tr_b16 a[78:79], v3 offset:896
    ds_read_b64_tr_b16 a[80:81], v3 offset:16896
    ds_read_b64_tr_b16 a[82:83], v3 offset:17024
    ds_read_b64_tr_b16 a[84:85], v3 offset:17152
    ds_read_b64_tr_b16 a[86:87], v3 offset:17280
    ds_read_b64_tr_b16 a[88:89], v3 offset:17408
    ds_read_b64_tr_b16 a[90:91], v3 offset:17536
    ds_read_b64_tr_b16 a[92:93], v3 offset:17664
    ds_read_b64_tr_b16 a[94:95], v3 offset:17792
    ds_read_b64_tr_b16 a[96:97], v3 offset:33792
    ds_read_b64_tr_b16 a[98:99], v3 offset:33920
    ds_read_b64_tr_b16 a[100:101], v3 offset:34048
    ds_read_b64_tr_b16 a[102:103], v3 offset:34176
    ds_read_b64_tr_b16 a[104:105], v3 offset:34304
    ds_read_b64_tr_b16 a[106:107], v3 offset:34432
    ds_read_b64_tr_b16 a[108:109], v3 offset:34560
    ds_read_b64_tr_b16 a[110:111], v3 offset:34688
    ds_read_b64_tr_b16 a[112:113], v3 offset:50688
    ds_read_b64_tr_b16 a[114:115], v3 offset:50816
    ds_read_b64_tr_b16 a[116:117], v3 offset:50944
    ds_read_b64_tr_b16 a[118:119], v3 offset:51072
    ds_read_b64_tr_b16 a[120:121], v3 offset:51200
    ds_read_b64_tr_b16 a[122:123], v3 offset:51328
    ds_read_b64_tr_b16 a[124:125], v3 offset:51456
    ds_read_b64_tr_b16 a[126:127], v3 offset:51584
    ds_read_b64_tr_b16 a[128:129], v4 offset:0
    ds_read_b64_tr_b16 a[130:131], v4 offset:128
    ds_read_b64_tr_b16 a[132:133], v4 offset:256
    ds_read_b64_tr_b16 a[134:135], v4 offset:384
    ds_read_b64_tr_b16 a[136:137], v4 offset:512
    ds_read_b64_tr_b16 a[138:139], v4 offset:640
    ds_read_b64_tr_b16 a[140:141], v4 offset:768
    ds_read_b64_tr_b16 a[142:143], v4 offset:896
    ds_read_b64_tr_b16 a[144:145], v4 offset:16896
    ds_read_b64_tr_b16 a[146:147], v4 offset:17024
    ds_read_b64_tr_b16 a[148:149], v4 offset:17152
    ds_read_b64_tr_b16 a[150:151], v4 offset:17280
    ds_read_b64_tr_b16 a[152:153], v4 offset:17408
    ds_read_b64_tr_b16 a[154:155], v4 offset:17536
    ds_read_b64_tr_b16 a[156:157], v4 offset:17664
    ds_read_b64_tr_b16 a[158:159], v4 offset:17792
    ds_read_b64_tr_b16 a[160:161], v4 offset:33792
    ds_read_b64_tr_b16 a[162:163], v4 offset:33920
    ds_read_b64_tr_b16 a[164:165], v4 offset:34048
    ds_read_b64_tr_b16 a[166:167], v4 offset:34176
    ds_read_b64_tr_b16 a[168:169], v4 offset:34304
    ds_read_b64_tr_b16 a[170:171], v4 offset:34432
    ds_read_b64_tr_b16 a[172:173], v4 offset:34560
    ds_read_b64_tr_b16 a[174:175], v4 offset:34688
    ds_read_b64_tr_b16 a[176:177], v4 offset:50688
    ds_read_b64_tr_b16 a[178:179], v4 offset:50816
    ds_read_b64_tr_b16 a[180:181], v4 offset:50944
    ds_read_b64_tr_b16 a[182:183], v4 offset:51072
    ds_read_b64_tr_b16 a[184:185], v4 offset:51200
    ds_read_b64_tr_b16 a[186:187], v4 offset:51328
    ds_read_b64_tr_b16 a[188:189], v4 offset:51456
    ds_read_b64_tr_b16 a[190:191], v4 offset:51584
    s_and_b32 s70, s72, 3
    s_lshr_b32 s71, s72, 4
    s_bfe_u32 s24, s72, 0x10002
    s_lshl_b32 s24, s24, 1
    s_add_u32 s71, s71, s24
    s_bfe_u32 s75, s72, 0x10003
    s_lshl_b32 s30, s71, 22
    s_add_u32 s4, s38, s30
    s_addc_u32 s5, s39, 0
    s_mov_b32 s6, 0x400000
    s_mov_b32 s7, 0x20000
    s_mul_i32 s32, s3, 65536
    s_lshl_b32 s24, s70, 10
    s_add_u32 s32, s32, s24
    s_mul_i32 s34, s3, 16896
    s_waitcnt lgkmcnt(0)
    s_barrier
    s_mov_b32 m0, s34
    s_nop 0
    buffer_load_dwordx4 v2, s[4:7], s32 offen lds
    s_add_u32 m0, m0, 1056
    s_add_u32 s32, s32, 4096
    buffer_load_dwordx4 v2, s[4:7], s32 offen lds
    s_add_u32 m0, m0, 1056
    s_add_u32 s32, s32, 4096
    buffer_load_dwordx4 v2, s[4:7], s32 offen lds
    s_add_u32 m0, m0, 1056
    s_add_u32 s32, s32, 4096
    buffer_load_dwordx4 v2, s[4:7], s32 offen lds
    s_add_u32 m0, m0, 1056
    s_add_u32 s32, s32, 4096
    buffer_load_dwordx4 v2, s[4:7], s32 offen lds
    s_add_u32 m0, m0, 1056
    s_add_u32 s32, s32, 4096
    buffer_load_dwordx4 v2, s[4:7], s32 offen lds
    s_add_u32 m0, m0, 1056
    s_add_u32 s32, s32, 4096
    buffer_load_dwordx4 v2, s[4:7], s32 offen lds
    s_add_u32 m0, m0, 1056
    s_add_u32 s32, s32, 4096
    buffer_load_dwordx4 v2, s[4:7], s32 offen lds
    s_add_u32 m0, m0, 1056
    s_add_u32 s32, s32, 4096
    buffer_load_dwordx4 v2, s[4:7], s32 offen lds
    s_add_u32 m0, m0, 1056
    s_add_u32 s32, s32, 4096
    buffer_load_dwordx4 v2, s[4:7], s32 offen lds
    s_add_u32 m0, m0, 1056
    s_add_u32 s32, s32, 4096
    buffer_load_dwordx4 v2, s[4:7], s32 offen lds
    s_add_u32 m0, m0, 1056
    s_add_u32 s32, s32, 4096
    buffer_load_dwordx4 v2, s[4:7], s32 offen lds
    s_add_u32 m0, m0, 1056
    s_add_u32 s32, s32, 4096
    buffer_load_dwordx4 v2, s[4:7], s32 offen lds
    s_add_u32 m0, m0, 1056
    s_add_u32 s32, s32, 4096
    buffer_load_dwordx4 v2, s[4:7], s32 offen lds
    s_add_u32 m0, m0, 1056
    s_add_u32 s32, s32, 4096
    buffer_load_dwordx4 v2, s[4:7], s32 offen lds
    s_add_u32 m0, m0, 1056
    s_add_u32 s32, s32, 4096
    buffer_load_dwordx4 v2, s[4:7], s32 offen lds
    s_add_u32 m0, m0, 1056
    s_add_u32 s32, s32, 200704
    s_lshr_b32 s28, s3, 1
    s_and_b32 s29, s3, 1
    v_and_b32 v3, 15, v0
    v_lshrrev_b32 v4, 4, v0
    v_mul_u32_u24 v19, 1056, v3
    v_lshl_add_u32 v19, v4, 4, v19
    v_lshrrev_b32 v5, 2, v0
    v_mul_u32_u24 v20, 1056, v5
    v_and_b32 v5, 3, v0
    v_lshl_add_u32 v20, v5, 3, v20
    s_lshl_b32 s24, s29, 9
    v_add_u32 v20, s24, v20
    v_and_b32 v3, 15, v0
    v_mul_u32_u24 v18, 1056, v3
    v_lshl_add_u32 v18, v4, 4, v18
    v_add_u32 v18, 101376, v18
    s_mul_i32 s24, s28, 33792
    v_add_u32 v19, s24, v19
    v_add_u32 v20, s24, v20
    v_mov_b32 v128, 0
    v_mov_b32 v129, 0
    v_mov_b32 v130, 0
    v_mov_b32 v131, 0
    v_mov_b32 v132, 0
    v_mov_b32 v133, 0
    v_mov_b32 v134, 0
    v_mov_b32 v135, 0
    v_mov_b32 v136, 0
    v_mov_b32 v137, 0
    v_mov_b32 v138, 0
    v_mov_b32 v139, 0
    v_mov_b32 v140, 0
    v_mov_b32 v141, 0
    v_mov_b32 v142, 0
    v_mov_b32 v143, 0
    v_mov_b32 v144, 0
    v_mov_b32 v145, 0
    v_mov_b32 v146, 0
    v_mov_b32 v147, 0
    v_mov_b32 v148, 0
    v_mov_b32 v149, 0
    v_mov_b32 v150, 0
    v_mov_b32 v151, 0
    v_mov_b32 v152, 0
    v_mov_b32 v153, 0
    v_mov_b32 v154, 0
    v_mov_b32 v155, 0
    v_mov_b32 v156, 0
    v_mov_b32 v157, 0
    v_mov_b32 v158, 0
    v_mov_b32 v159, 0
    v_mov_b32 v160, 0
    v_mov_b32 v161, 0
    v_mov_b32 v162, 0
    v_mov_b32 v163, 0
    v_mov_b32 v164, 0
    v_mov_b32 v165, 0
    v_mov_b32 v166, 0
    v_mov_b32 v167, 0
    v_mov_b32 v168, 0
    v_mov_b32 v169, 0
    v_mov_b32 v170, 0
    v_mov_b32 v171, 0
    v_mov_b32 v172, 0
    v_mov_b32 v173, 0
    v_mov_b32 v174, 0
    v_mov_b32 v175, 0
    v_mov_b32 v176, 0
    v_mov_b32 v177, 0
    v_mov_b32 v178, 0
    v_mov_b32 v179, 0
    v_mov_b32 v180, 0
    v_mov_b32 v181, 0
    v_mov_b32 v182, 0
    v_mov_b32 v183, 0
    v_mov_b32 v184, 0
    v_mov_b32 v185, 0
    v_mov_b32 v186, 0
    v_mov_b32 v187, 0
    v_mov_b32 v188, 0
    v_mov_b32 v189, 0
    v_mov_b32 v190, 0
    v_mov_b32 v191, 0
    v_mov_b32 v22, 0xff800000
    v_mov_b32 v23, 0
    s_cmp_lg_u32 s3, 0
    s_cbranch_scc1 L_awx25
    s_mov_b32 s24, 262144
    s_mov_b64 exec, 1
L_aw26:
    buffer_load_dword v1, off, s[12:15], s73 offset:0 sc1
    s_waitcnt vmcnt(0)
    v_readfirstlane_b32 s25, v1
    s_nop 0
    s_cmp_eq_u32 s25, 1
    s_cbranch_scc1 L_awx25
    s_sleep 4
    s_sub_u32 s24, s24, 1
    s_cmp_lg_u32 s24, 0
    s_cbranch_scc1 L_aw26
L_awx25:
    s_mov_b64 exec, -1
    s_barrier
    s_lshl_b32 s24, s71, 17
    s_mul_i32 s25, s3, 16384
    s_add_u32 s24, s24, s25
    s_add_u32 s24, s24, 0x0
    s_mul_i32 s25, s75, 65536
    s_add_u32 s24, s24, s25
    buffer_load_dwordx4 v[32:35], v2, s[12:15], s24 offen sc1
    s_add_u32 s24, s24, 4096
    buffer_load_dwordx4 v[36:39], v2, s[12:15], s24 offen sc1
    s_add_u32 s24, s24, 4096
    buffer_load_dwordx4 v[40:43], v2, s[12:15], s24 offen sc1
    s_add_u32 s24, s24, 4096
    buffer_load_dwordx4 v[44:47], v2, s[12:15], s24 offen sc1
    s_add_u32 s24, s24, 4096
    s_mul_i32 s24, s3, 4224
    s_add_u32 s24, s24, 101376
    v_add_u32 v3, s24, v2
    s_waitcnt vmcnt(3)
    ds_write_b128 v3, v[32:35] offset:0
    s_waitcnt vmcnt(2)
    ds_write_b128 v3, v[36:39] offset:1056
    s_waitcnt vmcnt(1)
    ds_write_b128 v3, v[40:43] offset:2112
    s_waitcnt vmcnt(0)
    ds_write_b128 v3, v[44:47] offset:3168
    s_waitcnt lgkmcnt(0)
    s_barrier
    ds_read_b128 a[0:3], v18 offset:0
    ds_read_b128 a[4:7], v18 offset:64
    ds_read_b128 a[8:11], v18 offset:128
    ds_read_b128 a[12:15], v18 offset:192
    ds_read_b128 a[16:19], v18 offset:256
    ds_read_b128 a[20:23], v18 offset:320
    ds_read_b128 a[24:27], v18 offset:384
    ds_read_b128 a[28:31], v18 offset:448
    ds_read_b128 a[32:35], v18 offset:512
    ds_read_b128 a[36:39], v18 offset:576
    ds_read_b128 a[40:43], v18 offset:640
    ds_read_b128 a[44:47], v18 offset:704
    ds_read_b128 a[48:51], v18 offset:768
    ds_read_b128 a[52:55], v18 offset:832
    ds_read_b128 a[56:59], v18 offset:896
    ds_read_b128 a[60:63], v18 offset:960
    s_cmp_lg_u32 s3, 0
    s_cbranch_scc1 L_xi27
    s_and_b32 s24, s74, 7
    s_lshl_b32 s24, s24, 5
    s_lshr_b32 s25, s74, 3
    s_add_u32 s24, s24, s25
    s_lshl_b32 s24, s24, 2
    s_add_u32 s24, s24, 0x1d0000
    s_getreg_b32 s25, hwreg(HW_REG_XCC_ID, 0, 4)
    s_mov_b64 exec, 1
    v_mov_b32 v3, s25
    buffer_store_dword v3, off, s[12:15], s24 sc1
    s_mov_b64 exec, -1
L_xi27:
    s_mov_b32 s27, 0
    s_mov_b32 s33, 67584
    s_mov_b32 s35, 0
    s_waitcnt lgkmcnt(0)
L_CT:
    s_waitcnt vmcnt(0)
    s_barrier
    v_add_u32 v24, s35, v19
    v_add_u32 v25, s35, v20
    ds_read_b128 v[32:35], v24 offset:0
    ds_read_b128 v[36:39], v24 offset:16896
    ds_read_b128 v[40:43], v24 offset:64
    ds_read_b128 v[44:47], v24 offset:16960
    ds_read_b128 v[48:51], v24 offset:128
    ds_read_b128 v[52:55], v24 offset:17024
    ds_read_b128 v[56:59], v24 offset:192
    s_add_u32 m0, s33, s34
    s_mov_b32 s33, s35
    s_add_u32 s35, s35, 67584
    s_cmp_eq_u32 s35, 135168
    s_cselect_b32 s35, 0, s35
    s_waitcnt lgkmcnt(6)
    v_mfma_f32_16x16x32_bf16 v[64:67], v[32:35], a[0:3], 0
    ds_read_b128 v[60:63], v24 offset:17088
    buffer_load_dwordx4 v2, s[4:7], s32 offen lds
    s_add_u32 m0, m0, 1056
    s_add_u32 s32, s32, 4096
    s_waitcnt lgkmcnt(6)
    v_mfma_f32_16x16x32_bf16 v[68:71], v[36:39], a[0:3], 0
    ds_read_b128 v[32:35], v24 offset:256
    s_waitcnt lgkmcnt(6)
    v_mfma_f32_16x16x32_bf16 v[64:67], v[40:43], a[4:7], v[64:67]
    ds_read_b128 v[36:39], v24 offset:17152
    s_waitcnt lgkmcnt(6)
    v_mfma_f32_16x16x32_bf16 v[68:71], v[44:47], a[4:7], v[68:71]
    ds_read_b128 v[40:43], v24 offset:320
    s_waitcnt lgkmcnt(6)
    v_mfma_f32_16x16x32_bf16 v[64:67], v[48:51], a[8:11], v[64:67]
    ds_read_b128 v[44:47], v24 offset:17216
    buffer_load_dwordx4 v2, s[4:7], s32 offen lds
    s_add_u32 m0, m0, 1056
    s_add_u32 s32, s32, 4096
    s_waitcnt lgkmcnt(6)
    v_mfma_f32_16x16x32_bf16 v[68:71], v[52:55], a[8:11], v[68:71]
    ds_read_b128 v[48:51], v24 offset:384
    s_waitcnt lgkmcnt(6)
    v_mfma_f32_16x16x32_bf16 v[64:67], v[56:59], a[12:15], v[64:67]
    ds_read_b128 v[52:55], v24 offset:17280
    s_waitcnt lgkmcnt(6)
    v_mfma_f32_16x16x32_bf16 v[68:71], v[60:63], a[12:15], v[68:71]
    ds_read_b128 v[56:59], v24 offset:448
    s_waitcnt lgkmcnt(6)
    v_mfma_f32_16x16x32_bf16 v[64:67], v[32:35], a[16:19], v[64:67]
    ds_read_b128 v[60:63], v24 offset:17344
    buffer_load_dwordx4 v2, s[4:7], s32 offen lds
    s_add_u32 m0, m0, 1056
    s_add_u32 s32, s32, 4096
    s_waitcnt lgkmcnt(6)
    v_mfma_f32_16x16x32_bf16 v[68:71], v[36:39], a[16:19], v[68:71]
    ds_read_b128 v[32:35], v24 offset:512
    s_waitcnt lgkmcnt(6)
    v_mfma_f32_16x16x32_bf16 v[64:67], v[40:43], a[20:23], v[64:67]
    ds_read_b128 v[36:39], v24 offset:17408
    s_waitcnt lgkmcnt(6)
    v_mfma_f32_16x16x32_bf16 v[68:71], v[44:47], a[20:23], v[68:71]
    ds_read_b128 v[40:43], v24 offset:576
    s_waitcnt lgkmcnt(6)
    v_mfma_f32_16x16x32_bf16 v[64:67], v[48:51], a[24:27], v[64:67]
    ds_read_b128 v[44:47], v24 offset:17472
    buffer_load_dwordx4 v2, s[4:7], s32 offen lds
    s_add_u32 m0, m0, 1056
    s_add_u32 s32, s32, 4096
    s_waitcnt lgkmcnt(6)
    v_mfma_f32_16x16x32_bf16 v[68:71], v[52:55], a[24:27], v[68:71]
    ds_read_b128 v[48:51], v24 offset:640
    s_waitcnt lgkmcnt(6)
    v_mfma_f32_16x16x32_bf16 v[64:67], v[56:59], a[28:31], v[64:67]
    ds_read_b128 v[52:55], v24 offset:17536
    s_waitcnt lgkmcnt(6)
    v_mfma_f32_16x16x32_bf16 v[68:71], v[60:63], a[28:31], v[68:71]
    ds_read_b128 v[56:59], v24 offset:704
    s_waitcnt lgkmcnt(6)
    v_mfma_f32_16x16x32_bf16 v[64:67], v[32:35], a[32:35], v[64:67]
    ds_read_b128 v[60:63], v24 offset:17600
    buffer_load_dwordx4 v2, s[4:7], s32 offen lds
    s_add_u32 m0, m0, 1056
    s_add_u32 s32, s32, 4096
    s_waitcnt lgkmcnt(6)
    v_mfma_f32_16x16x32_bf16 v[68:71], v[36:39], a[32:35], v[68:71]
    ds_read_b128 v[32:35], v24 offset:768
    s_waitcnt lgkmcnt(6)
    v_mfma_f32_16x16x32_bf16 v[64:67], v[40:43], a[36:39], v[64:67]
    ds_read_b128 v[36:39], v24 offset:17664
    s_waitcnt lgkmcnt(6)
    v_mfma_f32_16x16x32_bf16 v[68:71], v[44:47], a[36:39], v[68:71]
    ds_read_b128 v[40:43], v24 offset:832
    s_waitcnt lgkmcnt(6)
    v_mfma_f32_16x16x32_bf16 v[64:67], v[48:51], a[40:43], v[64:67]
    ds_read_b128 v[44:47], v24 offset:17728
    buffer_load_dwordx4 v2, s[4:7], s32 offen lds
    s_add_u32 m0, m0, 1056
    s_add_u32 s32, s32, 4096
    s_waitcnt lgkmcnt(6)
    v_mfma_f32_16x16x32_bf16 v[68:71], v[52:55], a[40:43], v[68:71]
    ds_read_b128 v[48:51], v24 offset:896
    s_waitcnt lgkmcnt(6)
    v_mfma_f32_16x16x32_bf16 v[64:67], v[56:59], a[44:47], v[64:67]
    ds_read_b128 v[52:55], v24 offset:17792
    s_waitcnt lgkmcnt(6)
    v_mfma_f32_16x16x32_bf16 v[68:71], v[60:63], a[44:47], v[68:71]
    ds_read_b128 v[56:59], v24 offset:960
    s_waitcnt lgkmcnt(6)
    v_mfma_f32_16x16x32_bf16 v[64:67], v[32:35], a[48:51], v[64:67]
    ds_read_b128 v[60:63], v24 offset:17856
    buffer_load_dwordx4 v2, s[4:7], s32 offen lds
    s_add_u32 m0, m0, 1056
    s_add_u32 s32, s32, 4096
    s_waitcnt lgkmcnt(6)
    v_mfma_f32_16x16x32_bf16 v[68:71], v[36:39], a[48:51], v[68:71]
    ds_read_b64_tr_b16 v[192:193], v25 offset:0
    s_waitcnt lgkmcnt(6)
    v_mfma_f32_16x16x32_bf16 v[64:67], v[40:43], a[52:55], v[64:67]
    ds_read_b64_tr_b16 v[194:195], v25 offset:16896
    s_waitcnt lgkmcnt(6)
    v_mfma_f32_16x16x32_bf16 v[68:71], v[44:47], a[52:55], v[68:71]
    ds_read_b64_tr_b16 v[196:197], v25 offset:32
    s_waitcnt lgkmcnt(6)
    v_mfma_f32_16x16x32_bf16 v[64:67], v[48:51], a[56:59], v[64:67]
    ds_read_b64_tr_b16 v[198:199], v25 offset:16928
    buffer_load_dwordx4 v2, s[4:7], s32 offen lds
    s_add_u32 m0, m0, 1056
    s_add_u32 s32, s32, 4096
    s_waitcnt lgkmcnt(6)
    v_mfma_f32_16x16x32_bf16 v[68:71], v[52:55], a[56:59], v[68:71]
    ds_read_b64_tr_b16 v[200:201], v25 offset:64
    s_waitcnt lgkmcnt(6)
    v_mfma_f32_16x16x32_bf16 v[64:67], v[56:59], a[60:63], v[64:67]
    ds_read_b64_tr_b16 v[202:203], v25 offset:16960
    s_waitcnt lgkmcnt(6)
    v_mfma_f32_16x16x32_bf16 v[68:71], v[60:63], a[60:63], v[68:71]
    ds_read_b64_tr_b16 v[204:205], v25 offset:96
    ds_read_b64_tr_b16 v[206:207], v25 offset:16992
    ds_read_b64_tr_b16 v[208:209], v25 offset:128
    ds_read_b64_tr_b16 v[210:211], v25 offset:17024
    ds_read_b64_tr_b16 v[212:213], v25 offset:160
    ds_read_b64_tr_b16 v[214:215], v25 offset:17056
    ds_read_b64_tr_b16 v[216:217], v25 offset:192
    ds_read_b64_tr_b16 v[218:219], v25 offset:17088
    v_max3_f32 v3, v64, v65, v22
    buffer_load_dwordx4 v2, s[4:7], s32 offen lds
    s_add_u32 m0, m0, 1056
    s_add_u32 s32, s32, 4096
    v_max3_f32 v3, v3, v66, v67
    v_max3_f32 v3, v3, v68, v69
    buffer_load_dwordx4 v2, s[4:7], s32 offen lds
    s_add_u32 m0, m0, 1056
    s_add_u32 s32, s32, 4096
    v_max3_f32 v3, v3, v70, v71
    v_mov_b32 v4, v3
    ds_read_b64_tr_b16 v[220:221], v25 offset:224
    buffer_load_dwordx4 v2, s[4:7], s32 offen lds
    s_add_u32 m0, m0, 1056
    s_add_u32 s32, s32, 4096
    v_permlane32_swap_b32 v3, v4
    ds_read_b64_tr_b16 v[222:223], v25 offset:17120
    v_max_f32 v3, v3, v4
    ds_read_b64_tr_b16 v[224:225], v25 offset:256
    buffer_load_dwordx4 v2, s[4:7], s32 offen lds
    s_add_u32 m0, m0, 1056
    s_add_u32 s32, s32, 4096
    v_mov_b32 v4, v3
    ds_read_b64_tr_b16 v[226:227], v25 offset:17152
    s_nop 0
    v_permlane16_swap_b32 v3, v4
    ds_read_b64_tr_b16 v[228:229], v25 offset:288
    buffer_load_dwordx4 v2, s[4:7], s32 offen lds
    s_add_u32 m0, m0, 1056
    s_add_u32 s32, s32, 4096
    v_max_f32 v3, v3, v4
    ds_read_b64_tr_b16 v[230:231], v25 offset:17184
    v_sub_f32 v4, v22, v3
    ds_read_b64_tr_b16 v[232:233], v25 offset:320
    buffer_load_dwordx4 v2, s[4:7], s32 offen lds
    s_add_u32 m0, m0, 1056
    s_add_u32 s32, s32, 4096
    v_exp_f32 v4, v4
    ds_read_b64_tr_b16 v[234:235], v25 offset:17216
    v_mov_b32 v22, v3
    ds_read_b64_tr_b16 v[236:237], v25 offset:352
    buffer_load_dwordx4 v2, s[4:7], s32 offen lds
    s_add_u32 m0, m0, 1056
    s_add_u32 s32, s32, 4096
    v_sub_f32 v64, v64, v3
    ds_read_b64_tr_b16 v[238:239], v25 offset:17248
    v_sub_f32 v65, v65, v3
    ds_read_b64_tr_b16 v[240:241], v25 offset:384
    buffer_load_dwordx4 v2, s[4:7], s32 offen lds
    s_add_u32 m0, m0, 1056
    s_add_u32 s32, s32, 200704
    v_sub_f32 v66, v66, v3
    ds_read_b64_tr_b16 v[242:243], v25 offset:17280
    v_sub_f32 v67, v67, v3
    ds_read_b64_tr_b16 v[244:245], v25 offset:416
    v_sub_f32 v68, v68, v3
    ds_read_b64_tr_b16 v[246:247], v25 offset:17312
    v_sub_f32 v69, v69, v3
    ds_read_b64_tr_b16 v[248:249], v25 offset:448
    v_sub_f32 v70, v70, v3
    ds_read_b64_tr_b16 v[250:251], v25 offset:17344
    v_sub_f32 v71, v71, v3
    ds_read_b64_tr_b16 v[252:253], v25 offset:480
    v_exp_f32 v64, v64
    ds_read_b64_tr_b16 v[254:255], v25 offset:17376
    v_exp_f32 v65, v65
    v_exp_f32 v66, v66
    v_exp_f32 v67, v67
    v_exp_f32 v68, v68
    v_exp_f32 v69, v69
    v_exp_f32 v70, v70
    v_exp_f32 v71, v71
    v_cvt_pk_bf16_f32 v72, v64, v65
    v_cvt_pk_bf16_f32 v73, v66, v67
    v_cvt_pk_bf16_f32 v74, v68, v69
    v_cvt_pk_bf16_f32 v75, v70, v71
    v_mul_f32 v128, v128, v4
    v_mul_f32 v129, v129, v4
    v_mul_f32 v130, v130, v4
    v_mul_f32 v131, v131, v4
    v_mul_f32 v132, v132, v4
    v_mul_f32 v133, v133, v4
    v_mul_f32 v134, v134, v4
    v_mul_f32 v135, v135, v4
    s_waitcnt lgkmcnt(0)
    v_mfma_f32_16x16x32_bf16 v[128:131], v[192:195], v[72:75], v[128:131]
    v_mul_f32 v136, v136, v4
    v_mul_f32 v137, v137, v4
    v_mul_f32 v138, v138, v4
    v_mul_f32 v139, v139, v4
    v_mfma_f32_16x16x32_bf16 v[132:135], v[196:199], v[72:75], v[132:135]
    v_mul_f32 v140, v140, v4
    v_mul_f32 v141, v141, v4
    v_mul_f32 v142, v142, v4
    v_mul_f32 v143, v143, v4
    v_mfma_f32_16x16x32_bf16 v[136:139], v[200:203], v[72:75], v[136:139]
    v_mul_f32 v144, v144, v4
    v_mul_f32 v145, v145, v4
    v_mul_f32 v146, v146, v4
    v_mul_f32 v147, v147, v4
    v_mfma_f32_16x16x32_bf16 v[140:143], v[204:207], v[72:75], v[140:143]
    v_mul_f32 v148, v148, v4
    v_mul_f32 v149, v149, v4
    v_mul_f32 v150, v150, v4
    v_mul_f32 v151, v151, v4
    v_mfma_f32_16x16x32_bf16 v[144:147], v[208:211], v[72:75], v[144:147]
    v_mul_f32 v152, v152, v4
    v_mul_f32 v153, v153, v4
    v_mul_f32 v154, v154, v4
    v_mul_f32 v155, v155, v4
    v_mfma_f32_16x16x32_bf16 v[148:151], v[212:215], v[72:75], v[148:151]
    v_mul_f32 v156, v156, v4
    v_mul_f32 v157, v157, v4
    v_mul_f32 v158, v158, v4
    v_mul_f32 v159, v159, v4
    v_mfma_f32_16x16x32_bf16 v[152:155], v[216:219], v[72:75], v[152:155]
    v_mul_f32 v160, v160, v4
    v_mul_f32 v161, v161, v4
    v_mul_f32 v162, v162, v4
    v_mul_f32 v163, v163, v4
    v_mfma_f32_16x16x32_bf16 v[156:159], v[220:223], v[72:75], v[156:159]
    v_mul_f32 v164, v164, v4
    v_mul_f32 v165, v165, v4
    v_mul_f32 v166, v166, v4
    v_mul_f32 v167, v167, v4
    v_mfma_f32_16x16x32_bf16 v[160:163], v[224:227], v[72:75], v[160:163]
    v_mul_f32 v168, v168, v4
    v_mul_f32 v169, v169, v4
    v_mul_f32 v170, v170, v4
    v_mul_f32 v171, v171, v4
    v_mfma_f32_16x16x32_bf16 v[164:167], v[228:231], v[72:75], v[164:167]
    v_mul_f32 v172, v172, v4
    v_mul_f32 v173, v173, v4
    v_mul_f32 v174, v174, v4
    v_mul_f32 v175, v175, v4
    v_mfma_f32_16x16x32_bf16 v[168:171], v[232:235], v[72:75], v[168:171]
    v_mul_f32 v176, v176, v4
    v_mul_f32 v177, v177, v4
    v_mul_f32 v178, v178, v4
    v_mul_f32 v179, v179, v4
    v_mfma_f32_16x16x32_bf16 v[172:175], v[236:239], v[72:75], v[172:175]
    v_mul_f32 v180, v180, v4
    v_mul_f32 v181, v181, v4
    v_mul_f32 v182, v182, v4
    v_mul_f32 v183, v183, v4
    v_mfma_f32_16x16x32_bf16 v[176:179], v[240:243], v[72:75], v[176:179]
    v_mul_f32 v184, v184, v4
    v_mul_f32 v185, v185, v4
    v_mul_f32 v186, v186, v4
    v_mul_f32 v187, v187, v4
    v_mfma_f32_16x16x32_bf16 v[180:183], v[244:247], v[72:75], v[180:183]
    v_mul_f32 v188, v188, v4
    v_mul_f32 v189, v189, v4
    v_mul_f32 v190, v190, v4
    v_mul_f32 v191, v191, v4
    v_mfma_f32_16x16x32_bf16 v[184:187], v[248:251], v[72:75], v[184:187]
    s_nop 0
    v_mfma_f32_16x16x32_bf16 v[188:191], v[252:255], v[72:75], v[188:191]
    v_fma_f32 v23, v23, v4, v64
    v_add_f32 v23, v23, v65
    v_add_f32 v23, v23, v66
    v_add_f32 v23, v23, v67
    v_add_f32 v23, v23, v68
    v_add_f32 v23, v23, v69
    v_add_f32 v23, v23, v70
    v_add_f32 v23, v23, v71
    s_add_u32 s27, s27, 1
    s_cmp_lt_u32 s27, 16
    s_cbranch_scc1 L_CT
    s_waitcnt vmcnt(0)
    s_barrier
    v_mov_b32 v4, v23
    s_nop 1
    v_permlane32_swap_b32 v23, v4
    v_add_f32 v23, v23, v4
    v_mov_b32 v4, v23
    s_nop 1
    v_permlane16_swap_b32 v23, v4
    v_add_f32 v23, v23, v4
    s_lshl_b32 s24, s3, 9
    v_lshl_add_u32 v3, v0, 3, s24
    ds_write_b64 v3, v[22:23] offset:0
    v_xor_b32 v3, 0x400, v3
    s_waitcnt lgkmcnt(0)
    s_barrier
    ds_read_b64 v[6:7], v3 offset:0
    s_waitcnt lgkmcnt(0)
    v_max_f32 v3, v22, v6
    v_sub_f32 v4, v22, v3
    v_sub_f32 v6, v6, v3
    v_exp_f32 v4, v4
    v_exp_f32 v6, v6
    v_mov_b32 v22, v3
    v_mul_f32 v23, v23, v4
    v_fmac_f32 v23, v7, v6
    v_and_b32 v3, 15, v0
    v_lshlrev_b32 v5, 3, v3
    s_lshl_b32 s24, s71, 2
    s_add_u32 s31, s24, s70
    s_lshl_b32 s24, s31, 8
    s_mul_i32 s25, s75, 128
    s_add_u32 s24, s24, s25
    s_add_u32 s24, s24, 0x120000
    s_cmp_lg_u32 s3, 0
    s_cbranch_scc1 L_C_ml
    s_mov_b64 exec, 0xffff
    buffer_store_dwordx2 v[22:23], v5, s[12:15], s24 offen sc1
    s_mov_b64 exec, -1
L_C_ml:
    v_pk_mul_f32 v[128:129], v[128:129], v[4:5] op_sel_hi:[1,0]
    v_pk_mul_f32 v[130:131], v[130:131], v[4:5] op_sel_hi:[1,0]
    v_pk_mul_f32 v[132:133], v[132:133], v[4:5] op_sel_hi:[1,0]
    v_pk_mul_f32 v[134:135], v[134:135], v[4:5] op_sel_hi:[1,0]
    v_pk_mul_f32 v[136:137], v[136:137], v[4:5] op_sel_hi:[1,0]
    v_pk_mul_f32 v[138:139], v[138:139], v[4:5] op_sel_hi:[1,0]
    v_pk_mul_f32 v[140:141], v[140:141], v[4:5] op_sel_hi:[1,0]
    v_pk_mul_f32 v[142:143], v[142:143], v[4:5] op_sel_hi:[1,0]
    v_pk_mul_f32 v[144:145], v[144:145], v[4:5] op_sel_hi:[1,0]
    v_pk_mul_f32 v[146:147], v[146:147], v[4:5] op_sel_hi:[1,0]
    v_pk_mul_f32 v[148:149], v[148:149], v[4:5] op_sel_hi:[1,0]
    v_pk_mul_f32 v[150:151], v[150:151], v[4:5] op_sel_hi:[1,0]
    v_pk_mul_f32 v[152:153], v[152:153], v[4:5] op_sel_hi:[1,0]
    v_pk_mul_f32 v[154:155], v[154:155], v[4:5] op_sel_hi:[1,0]
    v_pk_mul_f32 v[156:157], v[156:157], v[4:5] op_sel_hi:[1,0]
    v_pk_mul_f32 v[158:159], v[158:159], v[4:5] op_sel_hi:[1,0]
    v_pk_mul_f32 v[160:161], v[160:161], v[4:5] op_sel_hi:[1,0]
    v_pk_mul_f32 v[162:163], v[162:163], v[4:5] op_sel_hi:[1,0]
    v_pk_mul_f32 v[164:165], v[164:165], v[4:5] op_sel_hi:[1,0]
    v_pk_mul_f32 v[166:167], v[166:167], v[4:5] op_sel_hi:[1,0]
    v_pk_mul_f32 v[168:169], v[168:169], v[4:5] op_sel_hi:[1,0]
    v_pk_mul_f32 v[170:171], v[170:171], v[4:5] op_sel_hi:[1,0]
    v_pk_mul_f32 v[172:173], v[172:173], v[4:5] op_sel_hi:[1,0]
    v_pk_mul_f32 v[174:175], v[174:175], v[4:5] op_sel_hi:[1,0]
    v_pk_mul_f32 v[176:177], v[176:177], v[4:5] op_sel_hi:[1,0]
    v_pk_mul_f32 v[178:179], v[178:179], v[4:5] op_sel_hi:[1,0]
    v_pk_mul_f32 v[180:181], v[180:181], v[4:5] op_sel_hi:[1,0]
    v_pk_mul_f32 v[182:183], v[182:183], v[4:5] op_sel_hi:[1,0]
    v_pk_mul_f32 v[184:185], v[184:185], v[4:5] op_sel_hi:[1,0]
    v_pk_mul_f32 v[186:187], v[186:187], v[4:5] op_sel_hi:[1,0]
    v_pk_mul_f32 v[188:189], v[188:189], v[4:5] op_sel_hi:[1,0]
    v_pk_mul_f32 v[190:191], v[190:191], v[4:5] op_sel_hi:[1,0]
    s_lshl_b32 s24, s3, 13
    s_add_u32 s24, s24, 4096
    v_add_u32 v6, s24, v2
    s_xor_b32 s24, s3, 2
    s_lshl_b32 s24, s24, 13
    s_add_u32 s24, s24, 4096
    v_add_u32 v7, s24, v2
    s_cmp_lg_u32 s28, 0
    s_cbranch_scc1 L_C_x1
    ds_write_b128 v6, v[160:163] offset:0
    ds_write_b128 v6, v[164:167] offset:1024
    ds_write_b128 v6, v[168:171] offset:2048
    ds_write_b128 v6, v[172:175] offset:3072
    ds_write_b128 v6, v[176:179] offset:4096
    ds_write_b128 v6, v[180:183] offset:5120
    ds_write_b128 v6, v[184:187] offset:6144
    ds_write_b128 v6, v[188:191] offset:7168
    s_branch L_C_x2
L_C_x1:
    ds_write_b128 v6, v[128:131] offset:0
    ds_write_b128 v6, v[132:135] offset:1024
    ds_write_b128 v6, v[136:139] offset:2048
    ds_write_b128 v6, v[140:143] offset:3072
    ds_write_b128 v6, v[144:147] offset:4096
    ds_write_b128 v6, v[148:151] offset:5120
    ds_write_b128 v6, v[152:155] offset:6144
    ds_write_b128 v6, v[156:159] offset:7168
    s_waitcnt lgkmcnt(0)
    v_mov_b32 v128, v160
    v_mov_b32 v129, v161
    v_mov_b32 v130, v162
    v_mov_b32 v131, v163
    v_mov_b32 v132, v164
    v_mov_b32 v133, v165
    v_mov_b32 v134, v166
    v_mov_b32 v135, v167
    v_mov_b32 v136, v168
    v_mov_b32 v137, v169
    v_mov_b32 v138, v170
    v_mov_b32 v139, v171
    v_mov_b32 v140, v172
    v_mov_b32 v141, v173
    v_mov_b32 v142, v174
    v_mov_b32 v143, v175
    v_mov_b32 v144, v176
    v_mov_b32 v145, v177
    v_mov_b32 v146, v178
    v_mov_b32 v147, v179
    v_mov_b32 v148, v180
    v_mov_b32 v149, v181
    v_mov_b32 v150, v182
    v_mov_b32 v151, v183
    v_mov_b32 v152, v184
    v_mov_b32 v153, v185
    v_mov_b32 v154, v186
    v_mov_b32 v155, v187
    v_mov_b32 v156, v188
    v_mov_b32 v157, v189
    v_mov_b32 v158, v190
    v_mov_b32 v159, v191
L_C_x2:
    s_waitcnt lgkmcnt(0)
    s_barrier
    ds_read_b128 v[192:195], v7 offset:0
    ds_read_b128 v[196:199], v7 offset:1024
    ds_read_b128 v[200:203], v7 offset:2048
    ds_read_b128 v[204:207], v7 offset:3072
    ds_read_b128 v[208:211], v7 offset:4096
    ds_read_b128 v[212:215], v7 offset:5120
    ds_read_b128 v[216:219], v7 offset:6144
    ds_read_b128 v[220:223], v7 offset:7168
    v_lshrrev_b32 v4, 4, v0
    v_mul_u32_u24 v3, 272, v3
    v_lshl_add_u32 v3, v4, 3, v3
    s_mul_i32 s24, s3, 4352
    s_add_u32 s24, s24, 40960
    v_add_u32 v3, s24, v3
    s_waitcnt lgkmcnt(7)
    v_add_f32 v128, v128, v192
    v_add_f32 v129, v129, v193
    v_add_f32 v130, v130, v194
    v_add_f32 v131, v131, v195
    v_cvt_pk_bf16_f32 v32, v128, v129
    v_cvt_pk_bf16_f32 v33, v130, v131
    ds_write_b64 v3, v[32:33] offset:0
    s_waitcnt lgkmcnt(7)
    v_add_f32 v132, v132, v196
    v_add_f32 v133, v133, v197
    v_add_f32 v134, v134, v198
    v_add_f32 v135, v135, v199
    v_cvt_pk_bf16_f32 v34, v132, v133
    v_cvt_pk_bf16_f32 v35, v134, v135
    ds_write_b64 v3, v[34:35] offset:32
    s_waitcnt lgkmcnt(7)
    v_add_f32 v136, v136, v200
    v_add_f32 v137, v137, v201
    v_add_f32 v138, v138, v202
    v_add_f32 v139, v139, v203
    v_cvt_pk_bf16_f32 v36, v136, v137
    v_cvt_pk_bf16_f32 v37, v138, v139
    ds_write_b64 v3, v[36:37] offset:64
    s_waitcnt lgkmcnt(7)
    v_add_f32 v140, v140, v204
    v_add_f32 v141, v141, v205
    v_add_f32 v142, v142, v206
    v_add_f32 v143, v143, v207
    v_cvt_pk_bf16_f32 v38, v140, v141
    v_cvt_pk_bf16_f32 v39, v142, v143
    ds_write_b64 v3, v[38:39] offset:96
    s_waitcnt lgkmcnt(7)
    v_add_f32 v144, v144, v208
    v_add_f32 v145, v145, v209
    v_add_f32 v146, v146, v210
    v_add_f32 v147, v147, v211
    v_cvt_pk_bf16_f32 v40, v144, v145
    v_cvt_pk_bf16_f32 v41, v146, v147
    ds_write_b64 v3, v[40:41] offset:128
    s_waitcnt lgkmcnt(7)
    v_add_f32 v148, v148, v212
    v_add_f32 v149, v149, v213
    v_add_f32 v150, v150, v214
    v_add_f32 v151, v151, v215
    v_cvt_pk_bf16_f32 v42, v148, v149
    v_cvt_pk_bf16_f32 v43, v150, v151
    ds_write_b64 v3, v[42:43] offset:160
    s_waitcnt lgkmcnt(7)
    v_add_f32 v152, v152, v216
    v_add_f32 v153, v153, v217
    v_add_f32 v154, v154, v218
    v_add_f32 v155, v155, v219
    v_cvt_pk_bf16_f32 v44, v152, v153
    v_cvt_pk_bf16_f32 v45, v154, v155
    ds_write_b64 v3, v[44:45] offset:192
    s_waitcnt lgkmcnt(7)
    v_add_f32 v156, v156, v220
    v_add_f32 v157, v157, v221
    v_add_f32 v158, v158, v222
    v_add_f32 v159, v159, v223
    v_cvt_pk_bf16_f32 v46, v156, v157
    v_cvt_pk_bf16_f32 v47, v158, v159
    ds_write_b64 v3, v[46:47] offset:224
    v_and_b32 v5, 15, v0
    v_mul_u32_u24 v3, 272, v4
    v_lshl_add_u32 v3, v5, 4, v3
    v_add_u32 v3, s24, v3
    v_lshlrev_b32 v4, 11, v4
    v_lshl_add_u32 v4, v5, 4, v4
    s_waitcnt lgkmcnt(0)
    ds_read_b128 v[64:67], v3 offset:0
    ds_read_b128 v[68:71], v3 offset:1088
    ds_read_b128 v[72:75], v3 offset:2176
    ds_read_b128 v[76:79], v3 offset:3264
    s_lshl_b32 s24, s31, 16
    s_lshl_b32 s25, s29, 9
    s_add_u32 s24, s24, s25
    s_lshl_b32 s25, s28, 8
    s_add_u32 s24, s24, s25
    s_mul_i32 s25, s75, 32768
    s_add_u32 s24, s24, s25
    s_add_u32 s24, s24, 0x400000
    s_waitcnt lgkmcnt(3)
    buffer_store_dwordx4 v[64:67], v4, s[12:15], s24 offen sc1 nt
    s_add_u32 s24, s24, 8192
    s_waitcnt lgkmcnt(2)
    buffer_store_dwordx4 v[68:71], v4, s[12:15], s24 offen sc1 nt
    s_add_u32 s24, s24, 8192
    s_waitcnt lgkmcnt(1)
    buffer_store_dwordx4 v[72:75], v4, s[12:15], s24 offen sc1 nt
    s_add_u32 s24, s24, 8192
    s_waitcnt lgkmcnt(0)
    buffer_store_dwordx4 v[76:79], v4, s[12:15], s24 offen sc1 nt
    s_add_u32 s24, s24, 8192
    s_waitcnt vmcnt(0)
    s_barrier
    s_cmp_lg_u32 s3, 0
    s_cbranch_scc1 L_sig28
    s_mov_b64 exec, 1
    v_mov_b32 v3, 1
    buffer_atomic_add v3, off, s[16:19], 0 offset:4 sc0
    s_waitcnt vmcnt(0)
    v_readfirstlane_b32 s24, v3
    s_mov_b64 exec, -1
    s_and_b32 s24, s24, 31
    s_cmp_lg_u32 s24, 31
    s_cbranch_scc1 L_sig28
    v_lshlrev_b32 v4, 7, v0
    v_mov_b32 v3, 1
    s_mov_b32 s24, 0x170000
    s_mov_b32 exec_hi, 0
    buffer_store_dword v3, v4, s[12:15], s24 offen offset:4 sc1
    s_mov_b64 exec, -1
L_sig28:
    s_branch L_R
L_last:
    s_endpgm
.section .rodata,"a"
.p2align 6
.amdhsa_kernel concat_heads__compressed_kv_cla__mha_block_cached__decode_kernel
  .amdhsa_next_free_vgpr 448
  .amdhsa_next_free_sgpr 102
  .amdhsa_accum_offset 256
  .amdhsa_group_segment_fixed_size 0
  .amdhsa_kernarg_size 112
  .amdhsa_user_sgpr_count 2
  .amdhsa_user_sgpr_kernarg_segment_ptr 1
  .amdhsa_system_sgpr_workgroup_id_x 1
  .amdhsa_float_denorm_mode_32 3
.end_amdhsa_kernel
```
